```python
import torch

def _softmax(x, axis=-1):
    return torch.softmax(x, dim=axis)

def _gelu(x):
    return torch.nn.functional.gelu(x, approximate='tanh')

def _silu(x):
    return torch.nn.functional.silu(x)

def _sigmoid(x):
    return torch.sigmoid(x)

def _layernorm(x, axis=-1, eps=1e-05):
    m = x.mean(dim=axis, keepdim=True)
    v = x.var(dim=axis, keepdim=True, unbiased=False)
    return (x - m) / torch.sqrt(v + eps)

def _scatter_add(tgt, idx, src, axis=0):
    return tgt.clone().index_add_(axis, idx, src)

def _segment_sum(src, seg, n):
    out = torch.zeros((n,) + src.shape[1:], dtype=src.dtype)
    return out.index_add_(0, seg, src)

def _pad(x, pw):
    flat = tuple((v for pair in reversed(pw) for v in pair))
    return torch.nn.functional.pad(x, flat)
kernel_name = 'interleave_layers__memory_aug_recurrent_mem_tr__glu_gated_glu__prompt'

def setup_inputs():

    _w = lambda a: (lambda t: t.to(torch.bfloat16) if t.is_floating_point() else t)(torch.as_tensor(a))

    def _A_setup():
        B, S, Dm = (1, 2048, 640)
        H, Dh = (32, 192)
        M, seg = (8, 32)
        seg = min(seg, S)
        S = S // seg * seg
        return {'x': _w((lambda *s: torch.randn(*s, dtype=torch.bfloat16) * 0.05)(B, S, Dm)), 'mem0': _w((lambda *s: torch.randn(*s, dtype=torch.bfloat16) * 0.8)(B, M, Dm)), 'Wq': _w((lambda *s: torch.randn(*s, dtype=torch.bfloat16) * 0.8)(Dm, H, Dh) * Dm ** (-0.5)), 'Wk': _w((lambda *s: torch.randn(*s, dtype=torch.bfloat16) * 0.8)(Dm, H, Dh) * Dm ** (-0.5)), 'Wv': _w((lambda *s: torch.randn(*s, dtype=torch.bfloat16) * 0.8)(Dm, H, Dh) * Dm ** (-0.5)), 'Wo': _w((lambda *s: torch.randn(*s, dtype=torch.bfloat16) * 0.8)(H, Dh, Dm) * (H * Dh) ** (-0.5)), 'seg_len': seg}
    _A_in = _A_setup()

    def _B_setup():
        B, S, D, F = (1, 2048, 640, 1536)
        return {'x': _w((lambda *s: torch.randn(*s, dtype=torch.bfloat16) * 0.05)(B, S, D)), 'w_gate': _w((lambda *s: torch.randn(*s, dtype=torch.bfloat16) * 0.05)(D, F)), 'w_up': _w((lambda *s: torch.randn(*s, dtype=torch.bfloat16) * 0.05)(D, F)), 'w_down': _w((lambda *s: torch.randn(*s, dtype=torch.bfloat16) * 0.05)(F, D))}
    _B_in = _B_setup()
    return {'A_x': _A_in['x'], 'A_mem0': _A_in['mem0'], 'A_Wq': _A_in['Wq'], 'A_Wk': _A_in['Wk'], 'A_Wv': _A_in['Wv'], 'A_Wo': _A_in['Wo'], 'A_seg_len': _A_in['seg_len'], 'B_x': _B_in['x'], 'B_w_gate': _B_in['w_gate'], 'B_w_up': _B_in['w_up'], 'B_w_down': _B_in['w_down']}

def reference(A_x, A_mem0, A_Wq, A_Wk, A_Wv, A_Wo, A_seg_len, B_x, B_w_gate, B_w_up, B_w_down):

    def _A_ref(x, mem0, Wq, Wk, Wv, Wo, seg_len):
        B, S, Dm = x.shape
        H, Dh = (Wq.shape[1], Wq.shape[2])
        M = mem0.shape[1]
        scale = Dh ** (-0.5)
        n_seg = S // seg_len
        L = M + seg_len
        idx = torch.arange(L)
        mask = (idx[:, None] < M) | (idx[:, None] >= idx[None, :])
        mem = mem0
        outs = []
        for s in range(n_seg):
            xs = x[:, s * seg_len:(s + 1) * seg_len, :].clone()
            h = torch.concatenate([mem, xs], axis=1)
            q = torch.einsum('btd,dhe->bhte', h, Wq)
            k = torch.einsum('btd,dhe->bhte', h, Wk)
            v = torch.einsum('btd,dhe->bhte', h, Wv)
            scores = torch.einsum('bhqe,bhke->bhqk', q, k) * scale
            scores = torch.where(mask[None, None], scores, -1000000000.0)
            p = _softmax(scores, axis=-1)
            o = torch.einsum('bhqk,bhke->bhqe', p, v)
            o = torch.einsum('bhte,hed->btd', o, Wo)
            mem = o[:, :M, :].clone()
            outs.append(o[:, M:, :])
        return torch.concatenate(outs, axis=1)

    def _B_ref(x, w_gate, w_up, w_down):
        g = torch.einsum('bsd,df->bsf', x, w_gate)
        u = torch.einsum('bsd,df->bsf', x, w_up)
        h = _sigmoid(g) * u
        return torch.einsum('bsf,fd->bsd', h, w_down)
    x = A_x
    x = x + _A_ref(_layernorm(x, axis=-1), A_mem0, A_Wq, A_Wk, A_Wv, A_Wo, A_seg_len)
    x = x + _B_ref(_layernorm(x, axis=-1), B_w_gate, B_w_up, B_w_down)
    x = x + _A_ref(_layernorm(x, axis=-1), A_mem0, A_Wq, A_Wk, A_Wv, A_Wo, A_seg_len)
    x = x + _B_ref(_layernorm(x, axis=-1), B_w_gate, B_w_up, B_w_down)
    return x
```

```asm
; @launch kernel=pro_kernel grid=(256,1,1) block=(256,1,1) lds=0
; @launch kernel=main_kernel grid=(256,1,1) block=(256,1,1) lds=163840
.amdgcn_target "amdgcn-amd-amdhsa--gfx950"
.text
.globl pro_kernel
.p2align 8
.type pro_kernel,@function
pro_kernel:
 s_cmp_ge_u32 s2, 256
 s_cbranch_scc1 L_pro_exit
 s_load_dwordx2 s[4:5], s[0:1], 0
 s_load_dwordx2 s[8:9], s[0:1], 104
 v_lshrrev_b32 v3, 5, v0
 s_lshl_b32 s20, s2, 3
 v_add_u32 v3, s20, v3
 v_mul_u32_u24 v2, 1280, v3
 v_and_b32 v4, 31, v0
 v_lshl_add_u32 v2, v4, 3, v2
 v_lshlrev_b32 v1, 1, v2
 s_mov_b32 s21, 0x3acccccd
 s_waitcnt lgkmcnt(0)
 s_mov_b32 s6, 2621440
 s_mov_b32 s7, 0x20000
 s_mov_b32 s10, 0x10000000
 s_mov_b32 s11, 0x20000
 s_mov_b32 s12, s8
 s_mov_b32 s13, s9
 s_mov_b32 s14, 2277376
 s_mov_b32 s15, 0x20000
 buffer_load_dwordx2 v[46:47], v2, s[4:7], 0 offen offset:0
 buffer_load_dwordx2 v[48:49], v2, s[4:7], 0 offen offset:256
 buffer_load_dwordx2 v[50:51], v2, s[4:7], 0 offen offset:512
 buffer_load_dwordx2 v[52:53], v2, s[4:7], 0 offen offset:768
 buffer_load_dwordx2 v[54:55], v2, s[4:7], 0 offen offset:1024
 v_mov_b32 v56, -1
 v_mov_b32 v57, -1
 v_mov_b32 v58, -1
 v_mov_b32 v59, -1
 v_lshlrev_b32 v3, 4, v0
 s_mul_i32 s20, s2, 12288
 s_add_u32 s20, s20, 16384
 buffer_store_dwordx4 v[56:59], v3, s[12:15], s20 offen
 s_add_u32 s20, s20, 4096
 buffer_store_dwordx4 v[56:59], v3, s[12:15], s20 offen
 s_add_u32 s20, s20, 4096
 buffer_store_dwordx4 v[56:59], v3, s[12:15], s20 offen
 s_add_u32 s20, s20, 4096
 s_cmp_ge_u32 s2, 4
 s_cbranch_scc1 L_pro_nf
 v_mov_b32 v26, 0
 v_mov_b32 v27, 0
 v_mov_b32 v28, 0
 v_mov_b32 v29, 0
 s_lshl_b32 s20, s2, 12
 s_add_u32 s20, s20, 0
 buffer_store_dwordx4 v[26:29], v3, s[12:15], s20 offen
L_pro_nf:
 s_waitcnt vmcnt(0)
 v_lshlrev_b32 v6, 16, v46
 v_and_b32 v7, 0xffff0000, v46
 v_lshlrev_b32 v8, 16, v47
 v_and_b32 v9, 0xffff0000, v47
 v_lshlrev_b32 v10, 16, v48
 v_and_b32 v11, 0xffff0000, v48
 v_lshlrev_b32 v12, 16, v49
 v_and_b32 v13, 0xffff0000, v49
 v_lshlrev_b32 v14, 16, v50
 v_and_b32 v15, 0xffff0000, v50
 v_lshlrev_b32 v16, 16, v51
 v_and_b32 v17, 0xffff0000, v51
 v_lshlrev_b32 v18, 16, v52
 v_and_b32 v19, 0xffff0000, v52
 v_lshlrev_b32 v20, 16, v53
 v_and_b32 v21, 0xffff0000, v53
 v_lshlrev_b32 v22, 16, v54
 v_and_b32 v23, 0xffff0000, v54
 v_lshlrev_b32 v24, 16, v55
 v_and_b32 v25, 0xffff0000, v55
 s_mov_b32 s20, 197836800
 s_mov_b32 s22, 184729600
 buffer_store_dwordx4 v[6:9], v1, s[8:11], s20 offen offset:0
 buffer_store_dwordx4 v[10:13], v1, s[8:11], s20 offen offset:512
 buffer_store_dwordx4 v[14:17], v1, s[8:11], s20 offen offset:1024
 buffer_store_dwordx4 v[18:21], v1, s[8:11], s20 offen offset:1536
 buffer_store_dwordx4 v[22:25], v1, s[8:11], s20 offen offset:2048
 v_add_f32 v3, v6, v7
 v_add_f32 v4, v8, v9
 v_add_f32 v3, v3, v10
 v_add_f32 v4, v4, v11
 v_add_f32 v3, v3, v12
 v_add_f32 v4, v4, v13
 v_add_f32 v3, v3, v14
 v_add_f32 v4, v4, v15
 v_add_f32 v3, v3, v16
 v_add_f32 v4, v4, v17
 v_add_f32 v3, v3, v18
 v_add_f32 v4, v4, v19
 v_add_f32 v3, v3, v20
 v_add_f32 v4, v4, v21
 v_add_f32 v3, v3, v22
 v_add_f32 v4, v4, v23
 v_add_f32 v3, v3, v24
 v_add_f32 v4, v4, v25
 v_add_f32 v3, v3, v4
 s_nop 1
 v_add_f32_dpp v3, v3, v3 row_ror:8 row_mask:0xf bank_mask:0xf
 s_nop 1
 v_add_f32_dpp v3, v3, v3 row_ror:4 row_mask:0xf bank_mask:0xf
 s_nop 1
 v_add_f32_dpp v3, v3, v3 row_ror:2 row_mask:0xf bank_mask:0xf
 s_nop 1
 v_add_f32_dpp v3, v3, v3 row_ror:1 row_mask:0xf bank_mask:0xf
 v_mov_b32 v4, v3
 s_nop 1
 v_permlane16_swap_b32 v3, v4
 v_add_f32 v3, v3, v4
 v_mul_f32 v3, s21, v3
 v_sub_f32 v26, v6, v3
 v_sub_f32 v27, v7, v3
 v_sub_f32 v28, v8, v3
 v_sub_f32 v29, v9, v3
 v_sub_f32 v30, v10, v3
 v_sub_f32 v31, v11, v3
 v_sub_f32 v32, v12, v3
 v_sub_f32 v33, v13, v3
 v_sub_f32 v34, v14, v3
 v_sub_f32 v35, v15, v3
 v_sub_f32 v36, v16, v3
 v_sub_f32 v37, v17, v3
 v_sub_f32 v38, v18, v3
 v_sub_f32 v39, v19, v3
 v_sub_f32 v40, v20, v3
 v_sub_f32 v41, v21, v3
 v_sub_f32 v42, v22, v3
 v_sub_f32 v43, v23, v3
 v_sub_f32 v44, v24, v3
 v_sub_f32 v45, v25, v3
 v_mul_f32 v3, v26, v26
 v_mul_f32 v4, v27, v27
 v_fmac_f32 v3, v28, v28
 v_fmac_f32 v4, v29, v29
 v_fmac_f32 v3, v30, v30
 v_fmac_f32 v4, v31, v31
 v_fmac_f32 v3, v32, v32
 v_fmac_f32 v4, v33, v33
 v_fmac_f32 v3, v34, v34
 v_fmac_f32 v4, v35, v35
 v_fmac_f32 v3, v36, v36
 v_fmac_f32 v4, v37, v37
 v_fmac_f32 v3, v38, v38
 v_fmac_f32 v4, v39, v39
 v_fmac_f32 v3, v40, v40
 v_fmac_f32 v4, v41, v41
 v_fmac_f32 v3, v42, v42
 v_fmac_f32 v4, v43, v43
 v_fmac_f32 v3, v44, v44
 v_fmac_f32 v4, v45, v45
 v_add_f32 v3, v3, v4
 s_nop 1
 v_add_f32_dpp v3, v3, v3 row_ror:8 row_mask:0xf bank_mask:0xf
 s_nop 1
 v_add_f32_dpp v3, v3, v3 row_ror:4 row_mask:0xf bank_mask:0xf
 s_nop 1
 v_add_f32_dpp v3, v3, v3 row_ror:2 row_mask:0xf bank_mask:0xf
 s_nop 1
 v_add_f32_dpp v3, v3, v3 row_ror:1 row_mask:0xf bank_mask:0xf
 v_mov_b32 v4, v3
 s_nop 1
 v_permlane16_swap_b32 v3, v4
 v_add_f32 v3, v3, v4
 v_mov_b32 v4, 0x3727c5ac
 v_fma_f32 v3, v3, s21, v4
 v_rsq_f32 v3, v3
 s_nop 0
 v_mul_f32 v26, v26, v3
 v_mul_f32 v27, v27, v3
 v_mul_f32 v28, v28, v3
 v_mul_f32 v29, v29, v3
 v_mul_f32 v30, v30, v3
 v_mul_f32 v31, v31, v3
 v_mul_f32 v32, v32, v3
 v_mul_f32 v33, v33, v3
 v_mul_f32 v34, v34, v3
 v_mul_f32 v35, v35, v3
 v_mul_f32 v36, v36, v3
 v_mul_f32 v37, v37, v3
 v_mul_f32 v38, v38, v3
 v_mul_f32 v39, v39, v3
 v_mul_f32 v40, v40, v3
 v_mul_f32 v41, v41, v3
 v_mul_f32 v42, v42, v3
 v_mul_f32 v43, v43, v3
 v_mul_f32 v44, v44, v3
 v_mul_f32 v45, v45, v3
 v_cvt_pk_bf16_f32 v46, v26, v27
 v_cvt_pk_bf16_f32 v47, v28, v29
 v_cvt_pk_bf16_f32 v48, v30, v31
 v_cvt_pk_bf16_f32 v49, v32, v33
 v_cvt_pk_bf16_f32 v50, v34, v35
 v_cvt_pk_bf16_f32 v51, v36, v37
 v_cvt_pk_bf16_f32 v52, v38, v39
 v_cvt_pk_bf16_f32 v53, v40, v41
 v_cvt_pk_bf16_f32 v54, v42, v43
 v_cvt_pk_bf16_f32 v55, v44, v45
 buffer_store_dwordx2 v[46:47], v2, s[8:11], s22 offen offset:0
 buffer_store_dwordx2 v[48:49], v2, s[8:11], s22 offen offset:256
 buffer_store_dwordx2 v[50:51], v2, s[8:11], s22 offen offset:512
 buffer_store_dwordx2 v[52:53], v2, s[8:11], s22 offen offset:768
 buffer_store_dwordx2 v[54:55], v2, s[8:11], s22 offen offset:1024
L_pro_exit:
 s_endpgm
.globl main_kernel
.p2align 8
.type main_kernel,@function
main_kernel:
 s_cmp_ge_u32 s2, 256
 s_cbranch_scc1 L_exit
 s_load_dwordx2 s[8:9], s[0:1], 96
 s_load_dwordx2 s[4:5], s[0:1], 104
 s_getreg_b32 s14, hwreg(HW_REG_XCC_ID, 0, 4)
 s_and_b32 s14, s14, 7
 v_lshrrev_b32 v1, 6, v0
 s_nop 0
 v_readfirstlane_b32 s3, v1
 s_waitcnt lgkmcnt(0)
 s_mov_b32 s10, 256
 s_mov_b32 s11, 0x20000
 s_mov_b32 s6, 0x10000000
 s_mov_b32 s7, 0x20000
 v_mov_b32 v3, 0
 s_cmp_eq_u32 s3, 0
 s_cbranch_scc0 L_noticket
 s_lshl_b32 s17, s14, 2
 v_mov_b32 v1, s17
 v_mov_b32 v2, 32
 v_cmp_eq_u32 vcc, 0, v0
 s_nop 1
 v_cndmask_b32 v1, v2, v1, vcc
 v_mov_b32 v2, 1
 s_mov_b64 exec, 3
 buffer_atomic_add v2, v1, s[8:11], 0 offen sc0
 v_lshlrev_b32 v1, 2, v0
 s_waitcnt vmcnt(0)
 ds_write_b32 v1, v2
 s_mov_b64 exec, -1
 s_waitcnt lgkmcnt(0)
L_noticket:
 s_barrier
 ds_read_b64 v[4:5], v3
 s_waitcnt lgkmcnt(0)
 v_readfirstlane_b32 s15, v4
 v_readfirstlane_b32 s16, v5
 s_barrier
 s_lshl_b32 s12, s14, 5
 s_add_u32 s12, s12, s15
 s_mov_b32 s13, 0
 s_cmp_lt_u32 s15, 32
 s_cbranch_scc1 L_dispatch
L_fallback:
 s_mov_b32 s12, s16
 s_mov_b32 s13, 1
 s_waitcnt vmcnt(0) lgkmcnt(0)
 s_barrier
L_dispatch:
 s_cmp_lt_u32 s12, 64
 s_cbranch_scc1 L_role_rec
 s_cmp_lt_u32 s12, 136
 s_cbranch_scc1 L_role_qkv
 s_cmp_lt_u32 s12, 176
 s_cbranch_scc1 L_role_o
 s_cmp_lt_u32 s12, 208
 s_cbranch_scc1 L_role_at
 s_cmp_lt_u32 s12, 232
 s_cbranch_scc1 L_role_gu
 s_cmp_lt_u32 s12, 242
 s_cbranch_scc1 L_role_d
 s_cmp_lt_u32 s12, 250
 s_cbranch_scc1 L_role_r1
 s_cmp_lt_u32 s12, 254
 s_cbranch_scc1 L_role_r2
 s_branch L_exit
L_fail:
 s_mov_b64 exec, 1
 v_mov_b32 v1, 0xdead
 buffer_store_dword v1, off, s[8:11], 0 offset:64 sc1
L_exit:
 s_endpgm
L_role_rec:
 s_and_b32 s19, s12, 31
 s_lshr_b32 s24, s12, 5
 v_and_b32 v1, 63, v0
 v_lshlrev_b32 v2, 4, v1
 s_load_dwordx8 s[32:39], s[0:1], 16
 v_add_u32 v115, 0, v1
 v_mul_u32_u24 v3, 0x1556, v115
 v_lshrrev_b32 v3, 16, v3
 v_mul_u32_u24 v116, 12, v3
 v_sub_u32 v115, v115, v116
 v_mul_u32_u24 v3, 12288, v3
 v_lshl_add_u32 v3, v115, 4, v3
 v_add_u32 v115, 64, v1
 v_mul_u32_u24 v108, 0x1556, v115
 v_lshrrev_b32 v108, 16, v108
 v_mul_u32_u24 v116, 12, v108
 v_sub_u32 v115, v115, v116
 v_mul_u32_u24 v108, 12288, v108
 v_lshl_add_u32 v108, v115, 4, v108
 v_add_u32 v115, 128, v1
 v_mul_u32_u24 v109, 0x1556, v115
 v_lshrrev_b32 v109, 16, v109
 v_mul_u32_u24 v116, 12, v109
 v_sub_u32 v115, v115, v116
 v_mul_u32_u24 v109, 12288, v109
 v_lshl_add_u32 v109, v115, 4, v109
 v_add_u32 v115, 0, v1
 v_mul_u32_u24 v110, 0x199a, v115
 v_lshrrev_b32 v110, 16, v110
 v_mul_u32_u24 v116, 10, v110
 v_sub_u32 v115, v115, v116
 v_mul_u32_u24 v110, 1280, v110
 v_lshl_add_u32 v110, v115, 4, v110
 v_add_u32 v115, 64, v1
 v_mul_u32_u24 v111, 0x199a, v115
 v_lshrrev_b32 v111, 16, v111
 v_mul_u32_u24 v116, 10, v111
 v_sub_u32 v115, v115, v116
 v_mul_u32_u24 v111, 1280, v111
 v_lshl_add_u32 v111, v115, 4, v111
 v_add_u32 v115, 128, v1
 v_mul_u32_u24 v112, 0x199a, v115
 v_lshrrev_b32 v112, 16, v112
 v_mul_u32_u24 v116, 10, v112
 v_sub_u32 v115, v115, v116
 v_mul_u32_u24 v112, 1280, v112
 v_lshl_add_u32 v112, v115, 4, v112
 v_add_u32 v115, 192, v1
 v_mul_u32_u24 v113, 0x199a, v115
 v_lshrrev_b32 v113, 16, v113
 v_mul_u32_u24 v116, 10, v113
 v_sub_u32 v115, v115, v116
 v_mul_u32_u24 v113, 1280, v113
 v_lshl_add_u32 v113, v115, 4, v113
 v_add_u32 v115, 256, v1
 v_mul_u32_u24 v114, 0x199a, v115
 v_lshrrev_b32 v114, 16, v114
 v_mul_u32_u24 v116, 10, v114
 v_sub_u32 v115, v115, v116
 v_mul_u32_u24 v114, 1280, v114
 v_lshl_add_u32 v114, v115, 4, v114
 v_lshrrev_b32 v115, 4, v1
 v_bfe_u32 v116, v1, 2, 2
 v_lshl_add_u32 v117, v115, 3, v116
 v_lshl_add_u32 v121, v115, 2, v116
 v_mul_u32_u24 v117, 192, v117
 v_mul_u32_u24 v121, 160, v121
 v_and_b32 v115, 3, v1
 v_lshl_add_u32 v117, v115, 3, v117
 s_mul_i32 s27, s3, 15360
 v_add_u32 v121, s27, v121
 v_add_u32 v123, s27, v2
 v_lshl_add_u32 v122, v115, 3, v121
 v_lshl_add_u32 v121, v115, 4, v121
 s_lshl_b32 s27, s3, 5
 v_add_u32 v119, s27, v117
 s_and_b32 s26, s3, 1
 s_lshl_b32 s27, s26, 5
 s_add_u32 s27, s27, 128
 v_add_u32 v120, s27, v117
 s_lshr_b32 s25, s3, 1
 s_mul_i32 s27, s25, 30720
 s_mul_i32 s28, s26, 96
 s_add_u32 s27, s27, s28
 v_add_u32 v117, s27, v117
 v_add_u32 v118, 61440, v117
 s_waitcnt lgkmcnt(0)
 s_mul_i32 s29, s12, 192
 s_lshr_b32 s25, s12, 3
 s_lshl_b32 s25, s25, 2
 s_add_u32 s25, s25, s3
 s_mul_i32 s30, s25, 245760
 s_and_b32 s25, s12, 7
 s_mul_i32 s25, s25, 160
 s_add_u32 s30, s30, s25
 s_cmp_lt_u32 s3, 2
 s_cselect_b32 s20, s32, s34
 s_cselect_b32 s21, s33, s35
 s_mov_b32 s22, 7864320
 s_mov_b32 s23, 0x20000
 s_mul_i32 s25, s3, 15360
 s_add_u32 s25, s25, 0
 s_and_b32 s26, s3, 1
 s_mul_i32 s26, s26, 983040
 s_add_u32 s26, s26, 0
 s_add_u32 s26, s26, s29
 s_add_u32 m0, s25, 0
 s_add_u32 s27, s26, 0
 buffer_load_dwordx4 v3, s[20:23], s27 offen lds
 s_add_u32 m0, s25, 1024
 s_add_u32 s27, s26, 0
 buffer_load_dwordx4 v108, s[20:23], s27 offen lds
 s_add_u32 m0, s25, 2048
 s_add_u32 s27, s26, 0
 buffer_load_dwordx4 v109, s[20:23], s27 offen lds
 s_add_u32 m0, s25, 3072
 s_add_u32 s27, s26, 196608
 buffer_load_dwordx4 v3, s[20:23], s27 offen lds
 s_add_u32 m0, s25, 4096
 s_add_u32 s27, s26, 196608
 buffer_load_dwordx4 v108, s[20:23], s27 offen lds
 s_add_u32 m0, s25, 5120
 s_add_u32 s27, s26, 196608
 buffer_load_dwordx4 v109, s[20:23], s27 offen lds
 s_add_u32 m0, s25, 6144
 s_add_u32 s27, s26, 393216
 buffer_load_dwordx4 v3, s[20:23], s27 offen lds
 s_add_u32 m0, s25, 7168
 s_add_u32 s27, s26, 393216
 buffer_load_dwordx4 v108, s[20:23], s27 offen lds
 s_add_u32 m0, s25, 8192
 s_add_u32 s27, s26, 393216
 buffer_load_dwordx4 v109, s[20:23], s27 offen lds
 s_add_u32 m0, s25, 9216
 s_add_u32 s27, s26, 589824
 buffer_load_dwordx4 v3, s[20:23], s27 offen lds
 s_add_u32 m0, s25, 10240
 s_add_u32 s27, s26, 589824
 buffer_load_dwordx4 v108, s[20:23], s27 offen lds
 s_add_u32 m0, s25, 11264
 s_add_u32 s27, s26, 589824
 buffer_load_dwordx4 v109, s[20:23], s27 offen lds
 s_add_u32 m0, s25, 12288
 s_add_u32 s27, s26, 786432
 buffer_load_dwordx4 v3, s[20:23], s27 offen lds
 s_add_u32 m0, s25, 13312
 s_add_u32 s27, s26, 786432
 buffer_load_dwordx4 v108, s[20:23], s27 offen lds
 s_add_u32 m0, s25, 14336
 s_add_u32 s27, s26, 786432
 buffer_load_dwordx4 v109, s[20:23], s27 offen lds
 s_cmp_lt_u32 s3, 2
 s_cselect_b32 s20, s32, s34
 s_cselect_b32 s21, s33, s35
 s_mov_b32 s22, 7864320
 s_mov_b32 s23, 0x20000
 s_mul_i32 s25, s3, 15360
 s_add_u32 s25, s25, 61440
 s_and_b32 s26, s3, 1
 s_mul_i32 s26, s26, 983040
 s_add_u32 s26, s26, 1966080
 s_add_u32 s26, s26, s29
 s_add_u32 m0, s25, 0
 s_add_u32 s27, s26, 0
 buffer_load_dwordx4 v3, s[20:23], s27 offen lds
 s_add_u32 m0, s25, 1024
 s_add_u32 s27, s26, 0
 buffer_load_dwordx4 v108, s[20:23], s27 offen lds
 s_add_u32 m0, s25, 2048
 s_add_u32 s27, s26, 0
 buffer_load_dwordx4 v109, s[20:23], s27 offen lds
 s_add_u32 m0, s25, 3072
 s_add_u32 s27, s26, 196608
 buffer_load_dwordx4 v3, s[20:23], s27 offen lds
 s_add_u32 m0, s25, 4096
 s_add_u32 s27, s26, 196608
 buffer_load_dwordx4 v108, s[20:23], s27 offen lds
 s_add_u32 m0, s25, 5120
 s_add_u32 s27, s26, 196608
 buffer_load_dwordx4 v109, s[20:23], s27 offen lds
 s_add_u32 m0, s25, 6144
 s_add_u32 s27, s26, 393216
 buffer_load_dwordx4 v3, s[20:23], s27 offen lds
 s_add_u32 m0, s25, 7168
 s_add_u32 s27, s26, 393216
 buffer_load_dwordx4 v108, s[20:23], s27 offen lds
 s_add_u32 m0, s25, 8192
 s_add_u32 s27, s26, 393216
 buffer_load_dwordx4 v109, s[20:23], s27 offen lds
 s_add_u32 m0, s25, 9216
 s_add_u32 s27, s26, 589824
 buffer_load_dwordx4 v3, s[20:23], s27 offen lds
 s_add_u32 m0, s25, 10240
 s_add_u32 s27, s26, 589824
 buffer_load_dwordx4 v108, s[20:23], s27 offen lds
 s_add_u32 m0, s25, 11264
 s_add_u32 s27, s26, 589824
 buffer_load_dwordx4 v109, s[20:23], s27 offen lds
 s_add_u32 m0, s25, 12288
 s_add_u32 s27, s26, 786432
 buffer_load_dwordx4 v3, s[20:23], s27 offen lds
 s_add_u32 m0, s25, 13312
 s_add_u32 s27, s26, 786432
 buffer_load_dwordx4 v108, s[20:23], s27 offen lds
 s_add_u32 m0, s25, 14336
 s_add_u32 s27, s26, 786432
 buffer_load_dwordx4 v109, s[20:23], s27 offen lds
 s_waitcnt vmcnt(15)
 s_barrier
 s_cmp_eq_u32 s3, 0
 s_cbranch_scc0 Lpwn_2
 ds_read_b64_tr_b16 a[0:1], v117 offset:0
 ds_read_b64_tr_b16 a[2:3], v117 offset:768
 ds_read_b64_tr_b16 a[80:81], v117 offset:32
 ds_read_b64_tr_b16 a[82:83], v117 offset:800
 ds_read_b64_tr_b16 a[160:161], v117 offset:64
 ds_read_b64_tr_b16 a[162:163], v117 offset:832
 ds_read_b64_tr_b16 a[4:5], v117 offset:6144
 ds_read_b64_tr_b16 a[6:7], v117 offset:6912
 ds_read_b64_tr_b16 a[84:85], v117 offset:6176
 ds_read_b64_tr_b16 a[86:87], v117 offset:6944
 ds_read_b64_tr_b16 a[164:165], v117 offset:6208
 ds_read_b64_tr_b16 a[166:167], v117 offset:6976
 ds_read_b64_tr_b16 a[8:9], v117 offset:12288
 ds_read_b64_tr_b16 a[10:11], v117 offset:13056
 ds_read_b64_tr_b16 a[88:89], v117 offset:12320
 ds_read_b64_tr_b16 a[90:91], v117 offset:13088
 ds_read_b64_tr_b16 a[168:169], v117 offset:12352
 ds_read_b64_tr_b16 a[170:171], v117 offset:13120
 ds_read_b64_tr_b16 a[12:13], v117 offset:18432
 ds_read_b64_tr_b16 a[14:15], v117 offset:19200
 ds_read_b64_tr_b16 a[92:93], v117 offset:18464
 ds_read_b64_tr_b16 a[94:95], v117 offset:19232
 ds_read_b64_tr_b16 a[172:173], v117 offset:18496
 ds_read_b64_tr_b16 a[174:175], v117 offset:19264
 ds_read_b64_tr_b16 a[16:17], v117 offset:24576
 ds_read_b64_tr_b16 a[18:19], v117 offset:25344
 ds_read_b64_tr_b16 a[96:97], v117 offset:24608
 ds_read_b64_tr_b16 a[98:99], v117 offset:25376
 ds_read_b64_tr_b16 a[176:177], v117 offset:24640
 ds_read_b64_tr_b16 a[178:179], v117 offset:25408
 s_branch Lpw_1
Lpwn_2:
 s_cmp_eq_u32 s3, 1
 s_cbranch_scc0 Lpwn_3
 ds_read_b64_tr_b16 a[60:61], v117 offset:0
 ds_read_b64_tr_b16 a[62:63], v117 offset:768
 ds_read_b64_tr_b16 a[140:141], v117 offset:32
 ds_read_b64_tr_b16 a[142:143], v117 offset:800
 ds_read_b64_tr_b16 a[220:221], v117 offset:64
 ds_read_b64_tr_b16 a[222:223], v117 offset:832
 ds_read_b64_tr_b16 a[64:65], v117 offset:6144
 ds_read_b64_tr_b16 a[66:67], v117 offset:6912
 ds_read_b64_tr_b16 a[144:145], v117 offset:6176
 ds_read_b64_tr_b16 a[146:147], v117 offset:6944
 ds_read_b64_tr_b16 a[224:225], v117 offset:6208
 ds_read_b64_tr_b16 a[226:227], v117 offset:6976
 ds_read_b64_tr_b16 a[68:69], v117 offset:12288
 ds_read_b64_tr_b16 a[70:71], v117 offset:13056
 ds_read_b64_tr_b16 a[148:149], v117 offset:12320
 ds_read_b64_tr_b16 a[150:151], v117 offset:13088
 ds_read_b64_tr_b16 a[228:229], v117 offset:12352
 ds_read_b64_tr_b16 a[230:231], v117 offset:13120
 ds_read_b64_tr_b16 a[72:73], v117 offset:18432
 ds_read_b64_tr_b16 a[74:75], v117 offset:19200
 ds_read_b64_tr_b16 a[152:153], v117 offset:18464
 ds_read_b64_tr_b16 a[154:155], v117 offset:19232
 ds_read_b64_tr_b16 a[232:233], v117 offset:18496
 ds_read_b64_tr_b16 a[234:235], v117 offset:19264
 ds_read_b64_tr_b16 a[76:77], v117 offset:24576
 ds_read_b64_tr_b16 a[78:79], v117 offset:25344
 ds_read_b64_tr_b16 a[156:157], v117 offset:24608
 ds_read_b64_tr_b16 a[158:159], v117 offset:25376
 ds_read_b64_tr_b16 a[236:237], v117 offset:24640
 ds_read_b64_tr_b16 a[238:239], v117 offset:25408
 s_branch Lpw_1
Lpwn_3:
 s_cmp_eq_u32 s3, 2
 s_cbranch_scc0 Lpwn_4
 ds_read_b64_tr_b16 a[40:41], v117 offset:0
 ds_read_b64_tr_b16 a[42:43], v117 offset:768
 ds_read_b64_tr_b16 a[120:121], v117 offset:32
 ds_read_b64_tr_b16 a[122:123], v117 offset:800
 ds_read_b64_tr_b16 a[200:201], v117 offset:64
 ds_read_b64_tr_b16 a[202:203], v117 offset:832
 ds_read_b64_tr_b16 a[44:45], v117 offset:6144
 ds_read_b64_tr_b16 a[46:47], v117 offset:6912
 ds_read_b64_tr_b16 a[124:125], v117 offset:6176
 ds_read_b64_tr_b16 a[126:127], v117 offset:6944
 ds_read_b64_tr_b16 a[204:205], v117 offset:6208
 ds_read_b64_tr_b16 a[206:207], v117 offset:6976
 ds_read_b64_tr_b16 a[48:49], v117 offset:12288
 ds_read_b64_tr_b16 a[50:51], v117 offset:13056
 ds_read_b64_tr_b16 a[128:129], v117 offset:12320
 ds_read_b64_tr_b16 a[130:131], v117 offset:13088
 ds_read_b64_tr_b16 a[208:209], v117 offset:12352
 ds_read_b64_tr_b16 a[210:211], v117 offset:13120
 ds_read_b64_tr_b16 a[52:53], v117 offset:18432
 ds_read_b64_tr_b16 a[54:55], v117 offset:19200
 ds_read_b64_tr_b16 a[132:133], v117 offset:18464
 ds_read_b64_tr_b16 a[134:135], v117 offset:19232
 ds_read_b64_tr_b16 a[212:213], v117 offset:18496
 ds_read_b64_tr_b16 a[214:215], v117 offset:19264
 ds_read_b64_tr_b16 a[56:57], v117 offset:24576
 ds_read_b64_tr_b16 a[58:59], v117 offset:25344
 ds_read_b64_tr_b16 a[136:137], v117 offset:24608
 ds_read_b64_tr_b16 a[138:139], v117 offset:25376
 ds_read_b64_tr_b16 a[216:217], v117 offset:24640
 ds_read_b64_tr_b16 a[218:219], v117 offset:25408
 s_branch Lpw_1
Lpwn_4:
 ds_read_b64_tr_b16 a[20:21], v117 offset:0
 ds_read_b64_tr_b16 a[22:23], v117 offset:768
 ds_read_b64_tr_b16 a[100:101], v117 offset:32
 ds_read_b64_tr_b16 a[102:103], v117 offset:800
 ds_read_b64_tr_b16 a[180:181], v117 offset:64
 ds_read_b64_tr_b16 a[182:183], v117 offset:832
 ds_read_b64_tr_b16 a[24:25], v117 offset:6144
 ds_read_b64_tr_b16 a[26:27], v117 offset:6912
 ds_read_b64_tr_b16 a[104:105], v117 offset:6176
 ds_read_b64_tr_b16 a[106:107], v117 offset:6944
 ds_read_b64_tr_b16 a[184:185], v117 offset:6208
 ds_read_b64_tr_b16 a[186:187], v117 offset:6976
 ds_read_b64_tr_b16 a[28:29], v117 offset:12288
 ds_read_b64_tr_b16 a[30:31], v117 offset:13056
 ds_read_b64_tr_b16 a[108:109], v117 offset:12320
 ds_read_b64_tr_b16 a[110:111], v117 offset:13088
 ds_read_b64_tr_b16 a[188:189], v117 offset:12352
 ds_read_b64_tr_b16 a[190:191], v117 offset:13120
 ds_read_b64_tr_b16 a[32:33], v117 offset:18432
 ds_read_b64_tr_b16 a[34:35], v117 offset:19200
 ds_read_b64_tr_b16 a[112:113], v117 offset:18464
 ds_read_b64_tr_b16 a[114:115], v117 offset:19232
 ds_read_b64_tr_b16 a[192:193], v117 offset:18496
 ds_read_b64_tr_b16 a[194:195], v117 offset:19264
 ds_read_b64_tr_b16 a[36:37], v117 offset:24576
 ds_read_b64_tr_b16 a[38:39], v117 offset:25344
 ds_read_b64_tr_b16 a[116:117], v117 offset:24608
 ds_read_b64_tr_b16 a[118:119], v117 offset:25376
 ds_read_b64_tr_b16 a[196:197], v117 offset:24640
 ds_read_b64_tr_b16 a[198:199], v117 offset:25408
Lpw_1:
 s_waitcnt lgkmcnt(0)
 s_barrier
 s_cmp_lt_u32 s3, 2
 s_cselect_b32 s20, s32, s34
 s_cselect_b32 s21, s33, s35
 s_mov_b32 s22, 7864320
 s_mov_b32 s23, 0x20000
 s_mul_i32 s25, s3, 15360
 s_add_u32 s25, s25, 0
 s_and_b32 s26, s3, 1
 s_mul_i32 s26, s26, 983040
 s_add_u32 s26, s26, 3932160
 s_add_u32 s26, s26, s29
 s_add_u32 m0, s25, 0
 s_add_u32 s27, s26, 0
 buffer_load_dwordx4 v3, s[20:23], s27 offen lds
 s_add_u32 m0, s25, 1024
 s_add_u32 s27, s26, 0
 buffer_load_dwordx4 v108, s[20:23], s27 offen lds
 s_add_u32 m0, s25, 2048
 s_add_u32 s27, s26, 0
 buffer_load_dwordx4 v109, s[20:23], s27 offen lds
 s_add_u32 m0, s25, 3072
 s_add_u32 s27, s26, 196608
 buffer_load_dwordx4 v3, s[20:23], s27 offen lds
 s_add_u32 m0, s25, 4096
 s_add_u32 s27, s26, 196608
 buffer_load_dwordx4 v108, s[20:23], s27 offen lds
 s_add_u32 m0, s25, 5120
 s_add_u32 s27, s26, 196608
 buffer_load_dwordx4 v109, s[20:23], s27 offen lds
 s_add_u32 m0, s25, 6144
 s_add_u32 s27, s26, 393216
 buffer_load_dwordx4 v3, s[20:23], s27 offen lds
 s_add_u32 m0, s25, 7168
 s_add_u32 s27, s26, 393216
 buffer_load_dwordx4 v108, s[20:23], s27 offen lds
 s_add_u32 m0, s25, 8192
 s_add_u32 s27, s26, 393216
 buffer_load_dwordx4 v109, s[20:23], s27 offen lds
 s_add_u32 m0, s25, 9216
 s_add_u32 s27, s26, 589824
 buffer_load_dwordx4 v3, s[20:23], s27 offen lds
 s_add_u32 m0, s25, 10240
 s_add_u32 s27, s26, 589824
 buffer_load_dwordx4 v108, s[20:23], s27 offen lds
 s_add_u32 m0, s25, 11264
 s_add_u32 s27, s26, 589824
 buffer_load_dwordx4 v109, s[20:23], s27 offen lds
 s_add_u32 m0, s25, 12288
 s_add_u32 s27, s26, 786432
 buffer_load_dwordx4 v3, s[20:23], s27 offen lds
 s_add_u32 m0, s25, 13312
 s_add_u32 s27, s26, 786432
 buffer_load_dwordx4 v108, s[20:23], s27 offen lds
 s_add_u32 m0, s25, 14336
 s_add_u32 s27, s26, 786432
 buffer_load_dwordx4 v109, s[20:23], s27 offen lds
 s_waitcnt vmcnt(15)
 s_barrier
 s_cmp_eq_u32 s3, 0
 s_cbranch_scc0 Lpwn_7
 ds_read_b64_tr_b16 a[20:21], v118 offset:0
 ds_read_b64_tr_b16 a[22:23], v118 offset:768
 ds_read_b64_tr_b16 a[100:101], v118 offset:32
 ds_read_b64_tr_b16 a[102:103], v118 offset:800
 ds_read_b64_tr_b16 a[180:181], v118 offset:64
 ds_read_b64_tr_b16 a[182:183], v118 offset:832
 ds_read_b64_tr_b16 a[24:25], v118 offset:6144
 ds_read_b64_tr_b16 a[26:27], v118 offset:6912
 ds_read_b64_tr_b16 a[104:105], v118 offset:6176
 ds_read_b64_tr_b16 a[106:107], v118 offset:6944
 ds_read_b64_tr_b16 a[184:185], v118 offset:6208
 ds_read_b64_tr_b16 a[186:187], v118 offset:6976
 ds_read_b64_tr_b16 a[28:29], v118 offset:12288
 ds_read_b64_tr_b16 a[30:31], v118 offset:13056
 ds_read_b64_tr_b16 a[108:109], v118 offset:12320
 ds_read_b64_tr_b16 a[110:111], v118 offset:13088
 ds_read_b64_tr_b16 a[188:189], v118 offset:12352
 ds_read_b64_tr_b16 a[190:191], v118 offset:13120
 ds_read_b64_tr_b16 a[32:33], v118 offset:18432
 ds_read_b64_tr_b16 a[34:35], v118 offset:19200
 ds_read_b64_tr_b16 a[112:113], v118 offset:18464
 ds_read_b64_tr_b16 a[114:115], v118 offset:19232
 ds_read_b64_tr_b16 a[192:193], v118 offset:18496
 ds_read_b64_tr_b16 a[194:195], v118 offset:19264
 ds_read_b64_tr_b16 a[36:37], v118 offset:24576
 ds_read_b64_tr_b16 a[38:39], v118 offset:25344
 ds_read_b64_tr_b16 a[116:117], v118 offset:24608
 ds_read_b64_tr_b16 a[118:119], v118 offset:25376
 ds_read_b64_tr_b16 a[196:197], v118 offset:24640
 ds_read_b64_tr_b16 a[198:199], v118 offset:25408
 s_branch Lpw_6
Lpwn_7:
 s_cmp_eq_u32 s3, 1
 s_cbranch_scc0 Lpwn_8
 ds_read_b64_tr_b16 a[0:1], v118 offset:0
 ds_read_b64_tr_b16 a[2:3], v118 offset:768
 ds_read_b64_tr_b16 a[80:81], v118 offset:32
 ds_read_b64_tr_b16 a[82:83], v118 offset:800
 ds_read_b64_tr_b16 a[160:161], v118 offset:64
 ds_read_b64_tr_b16 a[162:163], v118 offset:832
 ds_read_b64_tr_b16 a[4:5], v118 offset:6144
 ds_read_b64_tr_b16 a[6:7], v118 offset:6912
 ds_read_b64_tr_b16 a[84:85], v118 offset:6176
 ds_read_b64_tr_b16 a[86:87], v118 offset:6944
 ds_read_b64_tr_b16 a[164:165], v118 offset:6208
 ds_read_b64_tr_b16 a[166:167], v118 offset:6976
 ds_read_b64_tr_b16 a[8:9], v118 offset:12288
 ds_read_b64_tr_b16 a[10:11], v118 offset:13056
 ds_read_b64_tr_b16 a[88:89], v118 offset:12320
 ds_read_b64_tr_b16 a[90:91], v118 offset:13088
 ds_read_b64_tr_b16 a[168:169], v118 offset:12352
 ds_read_b64_tr_b16 a[170:171], v118 offset:13120
 ds_read_b64_tr_b16 a[12:13], v118 offset:18432
 ds_read_b64_tr_b16 a[14:15], v118 offset:19200
 ds_read_b64_tr_b16 a[92:93], v118 offset:18464
 ds_read_b64_tr_b16 a[94:95], v118 offset:19232
 ds_read_b64_tr_b16 a[172:173], v118 offset:18496
 ds_read_b64_tr_b16 a[174:175], v118 offset:19264
 ds_read_b64_tr_b16 a[16:17], v118 offset:24576
 ds_read_b64_tr_b16 a[18:19], v118 offset:25344
 ds_read_b64_tr_b16 a[96:97], v118 offset:24608
 ds_read_b64_tr_b16 a[98:99], v118 offset:25376
 ds_read_b64_tr_b16 a[176:177], v118 offset:24640
 ds_read_b64_tr_b16 a[178:179], v118 offset:25408
 s_branch Lpw_6
Lpwn_8:
 s_cmp_eq_u32 s3, 2
 s_cbranch_scc0 Lpwn_9
 ds_read_b64_tr_b16 a[60:61], v118 offset:0
 ds_read_b64_tr_b16 a[62:63], v118 offset:768
 ds_read_b64_tr_b16 a[140:141], v118 offset:32
 ds_read_b64_tr_b16 a[142:143], v118 offset:800
 ds_read_b64_tr_b16 a[220:221], v118 offset:64
 ds_read_b64_tr_b16 a[222:223], v118 offset:832
 ds_read_b64_tr_b16 a[64:65], v118 offset:6144
 ds_read_b64_tr_b16 a[66:67], v118 offset:6912
 ds_read_b64_tr_b16 a[144:145], v118 offset:6176
 ds_read_b64_tr_b16 a[146:147], v118 offset:6944
 ds_read_b64_tr_b16 a[224:225], v118 offset:6208
 ds_read_b64_tr_b16 a[226:227], v118 offset:6976
 ds_read_b64_tr_b16 a[68:69], v118 offset:12288
 ds_read_b64_tr_b16 a[70:71], v118 offset:13056
 ds_read_b64_tr_b16 a[148:149], v118 offset:12320
 ds_read_b64_tr_b16 a[150:151], v118 offset:13088
 ds_read_b64_tr_b16 a[228:229], v118 offset:12352
 ds_read_b64_tr_b16 a[230:231], v118 offset:13120
 ds_read_b64_tr_b16 a[72:73], v118 offset:18432
 ds_read_b64_tr_b16 a[74:75], v118 offset:19200
 ds_read_b64_tr_b16 a[152:153], v118 offset:18464
 ds_read_b64_tr_b16 a[154:155], v118 offset:19232
 ds_read_b64_tr_b16 a[232:233], v118 offset:18496
 ds_read_b64_tr_b16 a[234:235], v118 offset:19264
 ds_read_b64_tr_b16 a[76:77], v118 offset:24576
 ds_read_b64_tr_b16 a[78:79], v118 offset:25344
 ds_read_b64_tr_b16 a[156:157], v118 offset:24608
 ds_read_b64_tr_b16 a[158:159], v118 offset:25376
 ds_read_b64_tr_b16 a[236:237], v118 offset:24640
 ds_read_b64_tr_b16 a[238:239], v118 offset:25408
 s_branch Lpw_6
Lpwn_9:
 ds_read_b64_tr_b16 a[40:41], v118 offset:0
 ds_read_b64_tr_b16 a[42:43], v118 offset:768
 ds_read_b64_tr_b16 a[120:121], v118 offset:32
 ds_read_b64_tr_b16 a[122:123], v118 offset:800
 ds_read_b64_tr_b16 a[200:201], v118 offset:64
 ds_read_b64_tr_b16 a[202:203], v118 offset:832
 ds_read_b64_tr_b16 a[44:45], v118 offset:6144
 ds_read_b64_tr_b16 a[46:47], v118 offset:6912
 ds_read_b64_tr_b16 a[124:125], v118 offset:6176
 ds_read_b64_tr_b16 a[126:127], v118 offset:6944
 ds_read_b64_tr_b16 a[204:205], v118 offset:6208
 ds_read_b64_tr_b16 a[206:207], v118 offset:6976
 ds_read_b64_tr_b16 a[48:49], v118 offset:12288
 ds_read_b64_tr_b16 a[50:51], v118 offset:13056
 ds_read_b64_tr_b16 a[128:129], v118 offset:12320
 ds_read_b64_tr_b16 a[130:131], v118 offset:13088
 ds_read_b64_tr_b16 a[208:209], v118 offset:12352
 ds_read_b64_tr_b16 a[210:211], v118 offset:13120
 ds_read_b64_tr_b16 a[52:53], v118 offset:18432
 ds_read_b64_tr_b16 a[54:55], v118 offset:19200
 ds_read_b64_tr_b16 a[132:133], v118 offset:18464
 ds_read_b64_tr_b16 a[134:135], v118 offset:19232
 ds_read_b64_tr_b16 a[212:213], v118 offset:18496
 ds_read_b64_tr_b16 a[214:215], v118 offset:19264
 ds_read_b64_tr_b16 a[56:57], v118 offset:24576
 ds_read_b64_tr_b16 a[58:59], v118 offset:25344
 ds_read_b64_tr_b16 a[136:137], v118 offset:24608
 ds_read_b64_tr_b16 a[138:139], v118 offset:25376
 ds_read_b64_tr_b16 a[216:217], v118 offset:24640
 ds_read_b64_tr_b16 a[218:219], v118 offset:25408
Lpw_6:
 s_waitcnt lgkmcnt(0)
 s_barrier
 s_cmp_lt_u32 s3, 2
 s_cselect_b32 s20, s32, s34
 s_cselect_b32 s21, s33, s35
 s_mov_b32 s22, 7864320
 s_mov_b32 s23, 0x20000
 s_mul_i32 s25, s3, 15360
 s_add_u32 s25, s25, 61440
 s_and_b32 s26, s3, 1
 s_mul_i32 s26, s26, 983040
 s_add_u32 s26, s26, 5898240
 s_add_u32 s26, s26, s29
 s_add_u32 m0, s25, 0
 s_add_u32 s27, s26, 0
 buffer_load_dwordx4 v3, s[20:23], s27 offen lds
 s_add_u32 m0, s25, 1024
 s_add_u32 s27, s26, 0
 buffer_load_dwordx4 v108, s[20:23], s27 offen lds
 s_add_u32 m0, s25, 2048
 s_add_u32 s27, s26, 0
 buffer_load_dwordx4 v109, s[20:23], s27 offen lds
 s_add_u32 m0, s25, 3072
 s_add_u32 s27, s26, 196608
 buffer_load_dwordx4 v3, s[20:23], s27 offen lds
 s_add_u32 m0, s25, 4096
 s_add_u32 s27, s26, 196608
 buffer_load_dwordx4 v108, s[20:23], s27 offen lds
 s_add_u32 m0, s25, 5120
 s_add_u32 s27, s26, 196608
 buffer_load_dwordx4 v109, s[20:23], s27 offen lds
 s_add_u32 m0, s25, 6144
 s_add_u32 s27, s26, 393216
 buffer_load_dwordx4 v3, s[20:23], s27 offen lds
 s_add_u32 m0, s25, 7168
 s_add_u32 s27, s26, 393216
 buffer_load_dwordx4 v108, s[20:23], s27 offen lds
 s_add_u32 m0, s25, 8192
 s_add_u32 s27, s26, 393216
 buffer_load_dwordx4 v109, s[20:23], s27 offen lds
 s_add_u32 m0, s25, 9216
 s_add_u32 s27, s26, 589824
 buffer_load_dwordx4 v3, s[20:23], s27 offen lds
 s_add_u32 m0, s25, 10240
 s_add_u32 s27, s26, 589824
 buffer_load_dwordx4 v108, s[20:23], s27 offen lds
 s_add_u32 m0, s25, 11264
 s_add_u32 s27, s26, 589824
 buffer_load_dwordx4 v109, s[20:23], s27 offen lds
 s_add_u32 m0, s25, 12288
 s_add_u32 s27, s26, 786432
 buffer_load_dwordx4 v3, s[20:23], s27 offen lds
 s_add_u32 m0, s25, 13312
 s_add_u32 s27, s26, 786432
 buffer_load_dwordx4 v108, s[20:23], s27 offen lds
 s_add_u32 m0, s25, 14336
 s_add_u32 s27, s26, 786432
 buffer_load_dwordx4 v109, s[20:23], s27 offen lds
 s_waitcnt vmcnt(15)
 s_barrier
 s_cmp_eq_u32 s3, 0
 s_cbranch_scc0 Lpwn_12
 ds_read_b64_tr_b16 a[40:41], v117 offset:0
 ds_read_b64_tr_b16 a[42:43], v117 offset:768
 ds_read_b64_tr_b16 a[120:121], v117 offset:32
 ds_read_b64_tr_b16 a[122:123], v117 offset:800
 ds_read_b64_tr_b16 a[200:201], v117 offset:64
 ds_read_b64_tr_b16 a[202:203], v117 offset:832
 ds_read_b64_tr_b16 a[44:45], v117 offset:6144
 ds_read_b64_tr_b16 a[46:47], v117 offset:6912
 ds_read_b64_tr_b16 a[124:125], v117 offset:6176
 ds_read_b64_tr_b16 a[126:127], v117 offset:6944
 ds_read_b64_tr_b16 a[204:205], v117 offset:6208
 ds_read_b64_tr_b16 a[206:207], v117 offset:6976
 ds_read_b64_tr_b16 a[48:49], v117 offset:12288
 ds_read_b64_tr_b16 a[50:51], v117 offset:13056
 ds_read_b64_tr_b16 a[128:129], v117 offset:12320
 ds_read_b64_tr_b16 a[130:131], v117 offset:13088
 ds_read_b64_tr_b16 a[208:209], v117 offset:12352
 ds_read_b64_tr_b16 a[210:211], v117 offset:13120
 ds_read_b64_tr_b16 a[52:53], v117 offset:18432
 ds_read_b64_tr_b16 a[54:55], v117 offset:19200
 ds_read_b64_tr_b16 a[132:133], v117 offset:18464
 ds_read_b64_tr_b16 a[134:135], v117 offset:19232
 ds_read_b64_tr_b16 a[212:213], v117 offset:18496
 ds_read_b64_tr_b16 a[214:215], v117 offset:19264
 ds_read_b64_tr_b16 a[56:57], v117 offset:24576
 ds_read_b64_tr_b16 a[58:59], v117 offset:25344
 ds_read_b64_tr_b16 a[136:137], v117 offset:24608
 ds_read_b64_tr_b16 a[138:139], v117 offset:25376
 ds_read_b64_tr_b16 a[216:217], v117 offset:24640
 ds_read_b64_tr_b16 a[218:219], v117 offset:25408
 s_branch Lpw_11
Lpwn_12:
 s_cmp_eq_u32 s3, 1
 s_cbranch_scc0 Lpwn_13
 ds_read_b64_tr_b16 a[20:21], v117 offset:0
 ds_read_b64_tr_b16 a[22:23], v117 offset:768
 ds_read_b64_tr_b16 a[100:101], v117 offset:32
 ds_read_b64_tr_b16 a[102:103], v117 offset:800
 ds_read_b64_tr_b16 a[180:181], v117 offset:64
 ds_read_b64_tr_b16 a[182:183], v117 offset:832
 ds_read_b64_tr_b16 a[24:25], v117 offset:6144
 ds_read_b64_tr_b16 a[26:27], v117 offset:6912
 ds_read_b64_tr_b16 a[104:105], v117 offset:6176
 ds_read_b64_tr_b16 a[106:107], v117 offset:6944
 ds_read_b64_tr_b16 a[184:185], v117 offset:6208
 ds_read_b64_tr_b16 a[186:187], v117 offset:6976
 ds_read_b64_tr_b16 a[28:29], v117 offset:12288
 ds_read_b64_tr_b16 a[30:31], v117 offset:13056
 ds_read_b64_tr_b16 a[108:109], v117 offset:12320
 ds_read_b64_tr_b16 a[110:111], v117 offset:13088
 ds_read_b64_tr_b16 a[188:189], v117 offset:12352
 ds_read_b64_tr_b16 a[190:191], v117 offset:13120
 ds_read_b64_tr_b16 a[32:33], v117 offset:18432
 ds_read_b64_tr_b16 a[34:35], v117 offset:19200
 ds_read_b64_tr_b16 a[112:113], v117 offset:18464
 ds_read_b64_tr_b16 a[114:115], v117 offset:19232
 ds_read_b64_tr_b16 a[192:193], v117 offset:18496
 ds_read_b64_tr_b16 a[194:195], v117 offset:19264
 ds_read_b64_tr_b16 a[36:37], v117 offset:24576
 ds_read_b64_tr_b16 a[38:39], v117 offset:25344
 ds_read_b64_tr_b16 a[116:117], v117 offset:24608
 ds_read_b64_tr_b16 a[118:119], v117 offset:25376
 ds_read_b64_tr_b16 a[196:197], v117 offset:24640
 ds_read_b64_tr_b16 a[198:199], v117 offset:25408
 s_branch Lpw_11
Lpwn_13:
 s_cmp_eq_u32 s3, 2
 s_cbranch_scc0 Lpwn_14
 ds_read_b64_tr_b16 a[0:1], v117 offset:0
 ds_read_b64_tr_b16 a[2:3], v117 offset:768
 ds_read_b64_tr_b16 a[80:81], v117 offset:32
 ds_read_b64_tr_b16 a[82:83], v117 offset:800
 ds_read_b64_tr_b16 a[160:161], v117 offset:64
 ds_read_b64_tr_b16 a[162:163], v117 offset:832
 ds_read_b64_tr_b16 a[4:5], v117 offset:6144
 ds_read_b64_tr_b16 a[6:7], v117 offset:6912
 ds_read_b64_tr_b16 a[84:85], v117 offset:6176
 ds_read_b64_tr_b16 a[86:87], v117 offset:6944
 ds_read_b64_tr_b16 a[164:165], v117 offset:6208
 ds_read_b64_tr_b16 a[166:167], v117 offset:6976
 ds_read_b64_tr_b16 a[8:9], v117 offset:12288
 ds_read_b64_tr_b16 a[10:11], v117 offset:13056
 ds_read_b64_tr_b16 a[88:89], v117 offset:12320
 ds_read_b64_tr_b16 a[90:91], v117 offset:13088
 ds_read_b64_tr_b16 a[168:169], v117 offset:12352
 ds_read_b64_tr_b16 a[170:171], v117 offset:13120
 ds_read_b64_tr_b16 a[12:13], v117 offset:18432
 ds_read_b64_tr_b16 a[14:15], v117 offset:19200
 ds_read_b64_tr_b16 a[92:93], v117 offset:18464
 ds_read_b64_tr_b16 a[94:95], v117 offset:19232
 ds_read_b64_tr_b16 a[172:173], v117 offset:18496
 ds_read_b64_tr_b16 a[174:175], v117 offset:19264
 ds_read_b64_tr_b16 a[16:17], v117 offset:24576
 ds_read_b64_tr_b16 a[18:19], v117 offset:25344
 ds_read_b64_tr_b16 a[96:97], v117 offset:24608
 ds_read_b64_tr_b16 a[98:99], v117 offset:25376
 ds_read_b64_tr_b16 a[176:177], v117 offset:24640
 ds_read_b64_tr_b16 a[178:179], v117 offset:25408
 s_branch Lpw_11
Lpwn_14:
 ds_read_b64_tr_b16 a[60:61], v117 offset:0
 ds_read_b64_tr_b16 a[62:63], v117 offset:768
 ds_read_b64_tr_b16 a[140:141], v117 offset:32
 ds_read_b64_tr_b16 a[142:143], v117 offset:800
 ds_read_b64_tr_b16 a[220:221], v117 offset:64
 ds_read_b64_tr_b16 a[222:223], v117 offset:832
 ds_read_b64_tr_b16 a[64:65], v117 offset:6144
 ds_read_b64_tr_b16 a[66:67], v117 offset:6912
 ds_read_b64_tr_b16 a[144:145], v117 offset:6176
 ds_read_b64_tr_b16 a[146:147], v117 offset:6944
 ds_read_b64_tr_b16 a[224:225], v117 offset:6208
 ds_read_b64_tr_b16 a[226:227], v117 offset:6976
 ds_read_b64_tr_b16 a[68:69], v117 offset:12288
 ds_read_b64_tr_b16 a[70:71], v117 offset:13056
 ds_read_b64_tr_b16 a[148:149], v117 offset:12320
 ds_read_b64_tr_b16 a[150:151], v117 offset:13088
 ds_read_b64_tr_b16 a[228:229], v117 offset:12352
 ds_read_b64_tr_b16 a[230:231], v117 offset:13120
 ds_read_b64_tr_b16 a[72:73], v117 offset:18432
 ds_read_b64_tr_b16 a[74:75], v117 offset:19200
 ds_read_b64_tr_b16 a[152:153], v117 offset:18464
 ds_read_b64_tr_b16 a[154:155], v117 offset:19232
 ds_read_b64_tr_b16 a[232:233], v117 offset:18496
 ds_read_b64_tr_b16 a[234:235], v117 offset:19264
 ds_read_b64_tr_b16 a[76:77], v117 offset:24576
 ds_read_b64_tr_b16 a[78:79], v117 offset:25344
 ds_read_b64_tr_b16 a[156:157], v117 offset:24608
 ds_read_b64_tr_b16 a[158:159], v117 offset:25376
 ds_read_b64_tr_b16 a[236:237], v117 offset:24640
 ds_read_b64_tr_b16 a[238:239], v117 offset:25408
Lpw_11:
 s_waitcnt lgkmcnt(0)
 s_barrier
 s_mov_b32 s20, s36
 s_mov_b32 s21, s37
 s_mov_b32 s22, 7864320
 s_mov_b32 s23, 0x20000
 s_mul_i32 s25, s3, 15360
 s_add_u32 s25, s25, 0
 s_mul_i32 s26, s3, 983040
 s_add_u32 s26, s26, 0
 s_add_u32 s26, s26, s29
 s_add_u32 m0, s25, 0
 s_add_u32 s27, s26, 0
 buffer_load_dwordx4 v3, s[20:23], s27 offen lds
 s_add_u32 m0, s25, 1024
 s_add_u32 s27, s26, 0
 buffer_load_dwordx4 v108, s[20:23], s27 offen lds
 s_add_u32 m0, s25, 2048
 s_add_u32 s27, s26, 0
 buffer_load_dwordx4 v109, s[20:23], s27 offen lds
 s_add_u32 m0, s25, 3072
 s_add_u32 s27, s26, 196608
 buffer_load_dwordx4 v3, s[20:23], s27 offen lds
 s_add_u32 m0, s25, 4096
 s_add_u32 s27, s26, 196608
 buffer_load_dwordx4 v108, s[20:23], s27 offen lds
 s_add_u32 m0, s25, 5120
 s_add_u32 s27, s26, 196608
 buffer_load_dwordx4 v109, s[20:23], s27 offen lds
 s_add_u32 m0, s25, 6144
 s_add_u32 s27, s26, 393216
 buffer_load_dwordx4 v3, s[20:23], s27 offen lds
 s_add_u32 m0, s25, 7168
 s_add_u32 s27, s26, 393216
 buffer_load_dwordx4 v108, s[20:23], s27 offen lds
 s_add_u32 m0, s25, 8192
 s_add_u32 s27, s26, 393216
 buffer_load_dwordx4 v109, s[20:23], s27 offen lds
 s_add_u32 m0, s25, 9216
 s_add_u32 s27, s26, 589824
 buffer_load_dwordx4 v3, s[20:23], s27 offen lds
 s_add_u32 m0, s25, 10240
 s_add_u32 s27, s26, 589824
 buffer_load_dwordx4 v108, s[20:23], s27 offen lds
 s_add_u32 m0, s25, 11264
 s_add_u32 s27, s26, 589824
 buffer_load_dwordx4 v109, s[20:23], s27 offen lds
 s_add_u32 m0, s25, 12288
 s_add_u32 s27, s26, 786432
 buffer_load_dwordx4 v3, s[20:23], s27 offen lds
 s_add_u32 m0, s25, 13312
 s_add_u32 s27, s26, 786432
 buffer_load_dwordx4 v108, s[20:23], s27 offen lds
 s_add_u32 m0, s25, 14336
 s_add_u32 s27, s26, 786432
 buffer_load_dwordx4 v109, s[20:23], s27 offen lds
 s_waitcnt vmcnt(15)
 s_barrier
 s_cmp_eq_u32 s3, 0
 s_cbranch_scc0 Lpwn_17
 ds_read_b64_tr_b16 a[60:61], v118 offset:0
 ds_read_b64_tr_b16 a[62:63], v118 offset:768
 ds_read_b64_tr_b16 a[140:141], v118 offset:32
 ds_read_b64_tr_b16 a[142:143], v118 offset:800
 ds_read_b64_tr_b16 a[220:221], v118 offset:64
 ds_read_b64_tr_b16 a[222:223], v118 offset:832
 ds_read_b64_tr_b16 a[64:65], v118 offset:6144
 ds_read_b64_tr_b16 a[66:67], v118 offset:6912
 ds_read_b64_tr_b16 a[144:145], v118 offset:6176
 ds_read_b64_tr_b16 a[146:147], v118 offset:6944
 ds_read_b64_tr_b16 a[224:225], v118 offset:6208
 ds_read_b64_tr_b16 a[226:227], v118 offset:6976
 ds_read_b64_tr_b16 a[68:69], v118 offset:12288
 ds_read_b64_tr_b16 a[70:71], v118 offset:13056
 ds_read_b64_tr_b16 a[148:149], v118 offset:12320
 ds_read_b64_tr_b16 a[150:151], v118 offset:13088
 ds_read_b64_tr_b16 a[228:229], v118 offset:12352
 ds_read_b64_tr_b16 a[230:231], v118 offset:13120
 ds_read_b64_tr_b16 a[72:73], v118 offset:18432
 ds_read_b64_tr_b16 a[74:75], v118 offset:19200
 ds_read_b64_tr_b16 a[152:153], v118 offset:18464
 ds_read_b64_tr_b16 a[154:155], v118 offset:19232
 ds_read_b64_tr_b16 a[232:233], v118 offset:18496
 ds_read_b64_tr_b16 a[234:235], v118 offset:19264
 ds_read_b64_tr_b16 a[76:77], v118 offset:24576
 ds_read_b64_tr_b16 a[78:79], v118 offset:25344
 ds_read_b64_tr_b16 a[156:157], v118 offset:24608
 ds_read_b64_tr_b16 a[158:159], v118 offset:25376
 ds_read_b64_tr_b16 a[236:237], v118 offset:24640
 ds_read_b64_tr_b16 a[238:239], v118 offset:25408
 s_branch Lpw_16
Lpwn_17:
 s_cmp_eq_u32 s3, 1
 s_cbranch_scc0 Lpwn_18
 ds_read_b64_tr_b16 a[40:41], v118 offset:0
 ds_read_b64_tr_b16 a[42:43], v118 offset:768
 ds_read_b64_tr_b16 a[120:121], v118 offset:32
 ds_read_b64_tr_b16 a[122:123], v118 offset:800
 ds_read_b64_tr_b16 a[200:201], v118 offset:64
 ds_read_b64_tr_b16 a[202:203], v118 offset:832
 ds_read_b64_tr_b16 a[44:45], v118 offset:6144
 ds_read_b64_tr_b16 a[46:47], v118 offset:6912
 ds_read_b64_tr_b16 a[124:125], v118 offset:6176
 ds_read_b64_tr_b16 a[126:127], v118 offset:6944
 ds_read_b64_tr_b16 a[204:205], v118 offset:6208
 ds_read_b64_tr_b16 a[206:207], v118 offset:6976
 ds_read_b64_tr_b16 a[48:49], v118 offset:12288
 ds_read_b64_tr_b16 a[50:51], v118 offset:13056
 ds_read_b64_tr_b16 a[128:129], v118 offset:12320
 ds_read_b64_tr_b16 a[130:131], v118 offset:13088
 ds_read_b64_tr_b16 a[208:209], v118 offset:12352
 ds_read_b64_tr_b16 a[210:211], v118 offset:13120
 ds_read_b64_tr_b16 a[52:53], v118 offset:18432
 ds_read_b64_tr_b16 a[54:55], v118 offset:19200
 ds_read_b64_tr_b16 a[132:133], v118 offset:18464
 ds_read_b64_tr_b16 a[134:135], v118 offset:19232
 ds_read_b64_tr_b16 a[212:213], v118 offset:18496
 ds_read_b64_tr_b16 a[214:215], v118 offset:19264
 ds_read_b64_tr_b16 a[56:57], v118 offset:24576
 ds_read_b64_tr_b16 a[58:59], v118 offset:25344
 ds_read_b64_tr_b16 a[136:137], v118 offset:24608
 ds_read_b64_tr_b16 a[138:139], v118 offset:25376
 ds_read_b64_tr_b16 a[216:217], v118 offset:24640
 ds_read_b64_tr_b16 a[218:219], v118 offset:25408
 s_branch Lpw_16
Lpwn_18:
 s_cmp_eq_u32 s3, 2
 s_cbranch_scc0 Lpwn_19
 ds_read_b64_tr_b16 a[20:21], v118 offset:0
 ds_read_b64_tr_b16 a[22:23], v118 offset:768
 ds_read_b64_tr_b16 a[100:101], v118 offset:32
 ds_read_b64_tr_b16 a[102:103], v118 offset:800
 ds_read_b64_tr_b16 a[180:181], v118 offset:64
 ds_read_b64_tr_b16 a[182:183], v118 offset:832
 ds_read_b64_tr_b16 a[24:25], v118 offset:6144
 ds_read_b64_tr_b16 a[26:27], v118 offset:6912
 ds_read_b64_tr_b16 a[104:105], v118 offset:6176
 ds_read_b64_tr_b16 a[106:107], v118 offset:6944
 ds_read_b64_tr_b16 a[184:185], v118 offset:6208
 ds_read_b64_tr_b16 a[186:187], v118 offset:6976
 ds_read_b64_tr_b16 a[28:29], v118 offset:12288
 ds_read_b64_tr_b16 a[30:31], v118 offset:13056
 ds_read_b64_tr_b16 a[108:109], v118 offset:12320
 ds_read_b64_tr_b16 a[110:111], v118 offset:13088
 ds_read_b64_tr_b16 a[188:189], v118 offset:12352
 ds_read_b64_tr_b16 a[190:191], v118 offset:13120
 ds_read_b64_tr_b16 a[32:33], v118 offset:18432
 ds_read_b64_tr_b16 a[34:35], v118 offset:19200
 ds_read_b64_tr_b16 a[112:113], v118 offset:18464
 ds_read_b64_tr_b16 a[114:115], v118 offset:19232
 ds_read_b64_tr_b16 a[192:193], v118 offset:18496
 ds_read_b64_tr_b16 a[194:195], v118 offset:19264
 ds_read_b64_tr_b16 a[36:37], v118 offset:24576
 ds_read_b64_tr_b16 a[38:39], v118 offset:25344
 ds_read_b64_tr_b16 a[116:117], v118 offset:24608
 ds_read_b64_tr_b16 a[118:119], v118 offset:25376
 ds_read_b64_tr_b16 a[196:197], v118 offset:24640
 ds_read_b64_tr_b16 a[198:199], v118 offset:25408
 s_branch Lpw_16
Lpwn_19:
 ds_read_b64_tr_b16 a[0:1], v118 offset:0
 ds_read_b64_tr_b16 a[2:3], v118 offset:768
 ds_read_b64_tr_b16 a[80:81], v118 offset:32
 ds_read_b64_tr_b16 a[82:83], v118 offset:800
 ds_read_b64_tr_b16 a[160:161], v118 offset:64
 ds_read_b64_tr_b16 a[162:163], v118 offset:832
 ds_read_b64_tr_b16 a[4:5], v118 offset:6144
 ds_read_b64_tr_b16 a[6:7], v118 offset:6912
 ds_read_b64_tr_b16 a[84:85], v118 offset:6176
 ds_read_b64_tr_b16 a[86:87], v118 offset:6944
 ds_read_b64_tr_b16 a[164:165], v118 offset:6208
 ds_read_b64_tr_b16 a[166:167], v118 offset:6976
 ds_read_b64_tr_b16 a[8:9], v118 offset:12288
 ds_read_b64_tr_b16 a[10:11], v118 offset:13056
 ds_read_b64_tr_b16 a[88:89], v118 offset:12320
 ds_read_b64_tr_b16 a[90:91], v118 offset:13088
 ds_read_b64_tr_b16 a[168:169], v118 offset:12352
 ds_read_b64_tr_b16 a[170:171], v118 offset:13120
 ds_read_b64_tr_b16 a[12:13], v118 offset:18432
 ds_read_b64_tr_b16 a[14:15], v118 offset:19200
 ds_read_b64_tr_b16 a[92:93], v118 offset:18464
 ds_read_b64_tr_b16 a[94:95], v118 offset:19232
 ds_read_b64_tr_b16 a[172:173], v118 offset:18496
 ds_read_b64_tr_b16 a[174:175], v118 offset:19264
 ds_read_b64_tr_b16 a[16:17], v118 offset:24576
 ds_read_b64_tr_b16 a[18:19], v118 offset:25344
 ds_read_b64_tr_b16 a[96:97], v118 offset:24608
 ds_read_b64_tr_b16 a[98:99], v118 offset:25376
 ds_read_b64_tr_b16 a[176:177], v118 offset:24640
 ds_read_b64_tr_b16 a[178:179], v118 offset:25408
Lpw_16:
 s_waitcnt lgkmcnt(0)
 s_barrier
 s_mov_b32 s20, s36
 s_mov_b32 s21, s37
 s_mov_b32 s22, 7864320
 s_mov_b32 s23, 0x20000
 s_mul_i32 s25, s3, 15360
 s_add_u32 s25, s25, 61440
 s_mul_i32 s26, s3, 983040
 s_add_u32 s26, s26, 3932160
 s_add_u32 s26, s26, s29
 s_add_u32 m0, s25, 0
 s_add_u32 s27, s26, 0
 buffer_load_dwordx4 v3, s[20:23], s27 offen lds
 s_add_u32 m0, s25, 1024
 s_add_u32 s27, s26, 0
 buffer_load_dwordx4 v108, s[20:23], s27 offen lds
 s_add_u32 m0, s25, 2048
 s_add_u32 s27, s26, 0
 buffer_load_dwordx4 v109, s[20:23], s27 offen lds
 s_add_u32 m0, s25, 3072
 s_add_u32 s27, s26, 196608
 buffer_load_dwordx4 v3, s[20:23], s27 offen lds
 s_add_u32 m0, s25, 4096
 s_add_u32 s27, s26, 196608
 buffer_load_dwordx4 v108, s[20:23], s27 offen lds
 s_add_u32 m0, s25, 5120
 s_add_u32 s27, s26, 196608
 buffer_load_dwordx4 v109, s[20:23], s27 offen lds
 s_add_u32 m0, s25, 6144
 s_add_u32 s27, s26, 393216
 buffer_load_dwordx4 v3, s[20:23], s27 offen lds
 s_add_u32 m0, s25, 7168
 s_add_u32 s27, s26, 393216
 buffer_load_dwordx4 v108, s[20:23], s27 offen lds
 s_add_u32 m0, s25, 8192
 s_add_u32 s27, s26, 393216
 buffer_load_dwordx4 v109, s[20:23], s27 offen lds
 s_add_u32 m0, s25, 9216
 s_add_u32 s27, s26, 589824
 buffer_load_dwordx4 v3, s[20:23], s27 offen lds
 s_add_u32 m0, s25, 10240
 s_add_u32 s27, s26, 589824
 buffer_load_dwordx4 v108, s[20:23], s27 offen lds
 s_add_u32 m0, s25, 11264
 s_add_u32 s27, s26, 589824
 buffer_load_dwordx4 v109, s[20:23], s27 offen lds
 s_add_u32 m0, s25, 12288
 s_add_u32 s27, s26, 786432
 buffer_load_dwordx4 v3, s[20:23], s27 offen lds
 s_add_u32 m0, s25, 13312
 s_add_u32 s27, s26, 786432
 buffer_load_dwordx4 v108, s[20:23], s27 offen lds
 s_add_u32 m0, s25, 14336
 s_add_u32 s27, s26, 786432
 buffer_load_dwordx4 v109, s[20:23], s27 offen lds
 s_waitcnt vmcnt(15)
 s_barrier
 s_cmp_eq_u32 s3, 0
 s_cbranch_scc0 Lpwn_22
 ds_read_b64_tr_b16 a[240:241], v119 offset:0
 ds_read_b64_tr_b16 v[68:69], v120 offset:0
 ds_read_b64_tr_b16 a[242:243], v119 offset:768
 ds_read_b64_tr_b16 v[70:71], v120 offset:768
 ds_read_b64_tr_b16 a[244:245], v119 offset:6144
 ds_read_b64_tr_b16 v[72:73], v120 offset:6144
 ds_read_b64_tr_b16 a[246:247], v119 offset:6912
 ds_read_b64_tr_b16 v[74:75], v120 offset:6912
 ds_read_b64_tr_b16 a[248:249], v119 offset:12288
 ds_read_b64_tr_b16 v[76:77], v120 offset:12288
 ds_read_b64_tr_b16 a[250:251], v119 offset:13056
 ds_read_b64_tr_b16 v[78:79], v120 offset:13056
 ds_read_b64_tr_b16 a[252:253], v119 offset:18432
 ds_read_b64_tr_b16 v[80:81], v120 offset:18432
 ds_read_b64_tr_b16 a[254:255], v119 offset:19200
 ds_read_b64_tr_b16 v[82:83], v120 offset:19200
 ds_read_b64_tr_b16 v[4:5], v119 offset:24576
 ds_read_b64_tr_b16 v[84:85], v120 offset:24576
 ds_read_b64_tr_b16 v[6:7], v119 offset:25344
 ds_read_b64_tr_b16 v[86:87], v120 offset:25344
 ds_read_b64_tr_b16 v[8:9], v119 offset:30720
 ds_read_b64_tr_b16 v[88:89], v120 offset:30720
 ds_read_b64_tr_b16 v[10:11], v119 offset:31488
 ds_read_b64_tr_b16 v[90:91], v120 offset:31488
 ds_read_b64_tr_b16 v[12:13], v119 offset:36864
 ds_read_b64_tr_b16 v[92:93], v120 offset:36864
 ds_read_b64_tr_b16 v[14:15], v119 offset:37632
 ds_read_b64_tr_b16 v[94:95], v120 offset:37632
 ds_read_b64_tr_b16 v[16:17], v119 offset:43008
 ds_read_b64_tr_b16 v[96:97], v120 offset:43008
 ds_read_b64_tr_b16 v[18:19], v119 offset:43776
 ds_read_b64_tr_b16 v[98:99], v120 offset:43776
 ds_read_b64_tr_b16 v[20:21], v119 offset:49152
 ds_read_b64_tr_b16 v[100:101], v120 offset:49152
 ds_read_b64_tr_b16 v[22:23], v119 offset:49920
 ds_read_b64_tr_b16 v[102:103], v120 offset:49920
 ds_read_b64_tr_b16 v[24:25], v119 offset:55296
 ds_read_b64_tr_b16 v[104:105], v120 offset:55296
 ds_read_b64_tr_b16 v[26:27], v119 offset:56064
 ds_read_b64_tr_b16 v[106:107], v120 offset:56064
 s_branch Lpw_21
Lpwn_22:
 s_cmp_eq_u32 s3, 1
 s_cbranch_scc0 Lpwn_23
 ds_read_b64_tr_b16 v[48:49], v119 offset:0
 ds_read_b64_tr_b16 v[50:51], v119 offset:768
 ds_read_b64_tr_b16 v[52:53], v119 offset:6144
 ds_read_b64_tr_b16 v[54:55], v119 offset:6912
 ds_read_b64_tr_b16 v[56:57], v119 offset:12288
 ds_read_b64_tr_b16 v[58:59], v119 offset:13056
 ds_read_b64_tr_b16 v[60:61], v119 offset:18432
 ds_read_b64_tr_b16 v[62:63], v119 offset:19200
 ds_read_b64_tr_b16 v[64:65], v119 offset:24576
 ds_read_b64_tr_b16 v[66:67], v119 offset:25344
 ds_read_b64_tr_b16 a[240:241], v119 offset:30720
 ds_read_b64_tr_b16 v[68:69], v120 offset:30720
 ds_read_b64_tr_b16 a[242:243], v119 offset:31488
 ds_read_b64_tr_b16 v[70:71], v120 offset:31488
 ds_read_b64_tr_b16 a[244:245], v119 offset:36864
 ds_read_b64_tr_b16 v[72:73], v120 offset:36864
 ds_read_b64_tr_b16 a[246:247], v119 offset:37632
 ds_read_b64_tr_b16 v[74:75], v120 offset:37632
 ds_read_b64_tr_b16 a[248:249], v119 offset:43008
 ds_read_b64_tr_b16 v[76:77], v120 offset:43008
 ds_read_b64_tr_b16 a[250:251], v119 offset:43776
 ds_read_b64_tr_b16 v[78:79], v120 offset:43776
 ds_read_b64_tr_b16 a[252:253], v119 offset:49152
 ds_read_b64_tr_b16 v[80:81], v120 offset:49152
 ds_read_b64_tr_b16 a[254:255], v119 offset:49920
 ds_read_b64_tr_b16 v[82:83], v120 offset:49920
 ds_read_b64_tr_b16 v[4:5], v119 offset:55296
 ds_read_b64_tr_b16 v[84:85], v120 offset:55296
 ds_read_b64_tr_b16 v[6:7], v119 offset:56064
 ds_read_b64_tr_b16 v[86:87], v120 offset:56064
 s_branch Lpw_21
Lpwn_23:
 s_cmp_eq_u32 s3, 2
 s_cbranch_scc0 Lpwn_24
 ds_read_b64_tr_b16 v[28:29], v119 offset:0
 ds_read_b64_tr_b16 v[30:31], v119 offset:768
 ds_read_b64_tr_b16 v[32:33], v119 offset:6144
 ds_read_b64_tr_b16 v[34:35], v119 offset:6912
 ds_read_b64_tr_b16 v[36:37], v119 offset:12288
 ds_read_b64_tr_b16 v[38:39], v119 offset:13056
 ds_read_b64_tr_b16 v[40:41], v119 offset:18432
 ds_read_b64_tr_b16 v[42:43], v119 offset:19200
 ds_read_b64_tr_b16 v[44:45], v119 offset:24576
 ds_read_b64_tr_b16 v[46:47], v119 offset:25344
 ds_read_b64_tr_b16 v[48:49], v119 offset:30720
 ds_read_b64_tr_b16 v[50:51], v119 offset:31488
 ds_read_b64_tr_b16 v[52:53], v119 offset:36864
 ds_read_b64_tr_b16 v[54:55], v119 offset:37632
 ds_read_b64_tr_b16 v[56:57], v119 offset:43008
 ds_read_b64_tr_b16 v[58:59], v119 offset:43776
 ds_read_b64_tr_b16 v[60:61], v119 offset:49152
 ds_read_b64_tr_b16 v[62:63], v119 offset:49920
 ds_read_b64_tr_b16 v[64:65], v119 offset:55296
 ds_read_b64_tr_b16 v[66:67], v119 offset:56064
 s_branch Lpw_21
Lpwn_24:
 ds_read_b64_tr_b16 v[8:9], v119 offset:0
 ds_read_b64_tr_b16 v[88:89], v120 offset:0
 ds_read_b64_tr_b16 v[10:11], v119 offset:768
 ds_read_b64_tr_b16 v[90:91], v120 offset:768
 ds_read_b64_tr_b16 v[12:13], v119 offset:6144
 ds_read_b64_tr_b16 v[92:93], v120 offset:6144
 ds_read_b64_tr_b16 v[14:15], v119 offset:6912
 ds_read_b64_tr_b16 v[94:95], v120 offset:6912
 ds_read_b64_tr_b16 v[16:17], v119 offset:12288
 ds_read_b64_tr_b16 v[96:97], v120 offset:12288
 ds_read_b64_tr_b16 v[18:19], v119 offset:13056
 ds_read_b64_tr_b16 v[98:99], v120 offset:13056
 ds_read_b64_tr_b16 v[20:21], v119 offset:18432
 ds_read_b64_tr_b16 v[100:101], v120 offset:18432
 ds_read_b64_tr_b16 v[22:23], v119 offset:19200
 ds_read_b64_tr_b16 v[102:103], v120 offset:19200
 ds_read_b64_tr_b16 v[24:25], v119 offset:24576
 ds_read_b64_tr_b16 v[104:105], v120 offset:24576
 ds_read_b64_tr_b16 v[26:27], v119 offset:25344
 ds_read_b64_tr_b16 v[106:107], v120 offset:25344
 ds_read_b64_tr_b16 v[28:29], v119 offset:30720
 ds_read_b64_tr_b16 v[30:31], v119 offset:31488
 ds_read_b64_tr_b16 v[32:33], v119 offset:36864
 ds_read_b64_tr_b16 v[34:35], v119 offset:37632
 ds_read_b64_tr_b16 v[36:37], v119 offset:43008
 ds_read_b64_tr_b16 v[38:39], v119 offset:43776
 ds_read_b64_tr_b16 v[40:41], v119 offset:49152
 ds_read_b64_tr_b16 v[42:43], v119 offset:49920
 ds_read_b64_tr_b16 v[44:45], v119 offset:55296
 ds_read_b64_tr_b16 v[46:47], v119 offset:56064
Lpw_21:
 s_waitcnt lgkmcnt(0)
 s_barrier
 s_mov_b32 s20, s38
 s_mov_b32 s21, s39
 s_mov_b32 s22, 7864320
 s_mov_b32 s23, 0x20000
 s_mul_i32 s25, s3, 15360
 s_add_u32 s25, s25, 0
 s_add_u32 s26, s30, 0
 s_add_u32 m0, s25, 0
 s_add_u32 s27, s26, 0
 buffer_load_dwordx4 v110, s[20:23], s27 offen lds
 s_add_u32 m0, s25, 1024
 s_add_u32 s27, s26, 0
 buffer_load_dwordx4 v111, s[20:23], s27 offen lds
 s_add_u32 m0, s25, 2048
 s_add_u32 s27, s26, 0
 buffer_load_dwordx4 v112, s[20:23], s27 offen lds
 s_add_u32 m0, s25, 3072
 s_add_u32 s27, s26, 0
 buffer_load_dwordx4 v113, s[20:23], s27 offen lds
 s_add_u32 m0, s25, 4096
 s_add_u32 s27, s26, 0
 buffer_load_dwordx4 v114, s[20:23], s27 offen lds
 s_add_u32 m0, s25, 5120
 s_add_u32 s27, s26, 40960
 buffer_load_dwordx4 v110, s[20:23], s27 offen lds
 s_add_u32 m0, s25, 6144
 s_add_u32 s27, s26, 40960
 buffer_load_dwordx4 v111, s[20:23], s27 offen lds
 s_add_u32 m0, s25, 7168
 s_add_u32 s27, s26, 40960
 buffer_load_dwordx4 v112, s[20:23], s27 offen lds
 s_add_u32 m0, s25, 8192
 s_add_u32 s27, s26, 40960
 buffer_load_dwordx4 v113, s[20:23], s27 offen lds
 s_add_u32 m0, s25, 9216
 s_add_u32 s27, s26, 40960
 buffer_load_dwordx4 v114, s[20:23], s27 offen lds
 s_add_u32 m0, s25, 10240
 s_add_u32 s27, s26, 81920
 buffer_load_dwordx4 v110, s[20:23], s27 offen lds
 s_add_u32 m0, s25, 11264
 s_add_u32 s27, s26, 81920
 buffer_load_dwordx4 v111, s[20:23], s27 offen lds
 s_add_u32 m0, s25, 12288
 s_add_u32 s27, s26, 81920
 buffer_load_dwordx4 v112, s[20:23], s27 offen lds
 s_add_u32 m0, s25, 13312
 s_add_u32 s27, s26, 81920
 buffer_load_dwordx4 v113, s[20:23], s27 offen lds
 s_add_u32 m0, s25, 14336
 s_add_u32 s27, s26, 81920
 buffer_load_dwordx4 v114, s[20:23], s27 offen lds
 s_waitcnt vmcnt(15)
 s_barrier
 v_add_u32 v119, 61440, v119
 v_add_u32 v120, 61440, v120
 s_cmp_eq_u32 s3, 0
 s_cbranch_scc0 Lpwn_27
 ds_read_b64_tr_b16 v[28:29], v119 offset:0
 ds_read_b64_tr_b16 v[30:31], v119 offset:768
 ds_read_b64_tr_b16 v[32:33], v119 offset:6144
 ds_read_b64_tr_b16 v[34:35], v119 offset:6912
 ds_read_b64_tr_b16 v[36:37], v119 offset:12288
 ds_read_b64_tr_b16 v[38:39], v119 offset:13056
 ds_read_b64_tr_b16 v[40:41], v119 offset:18432
 ds_read_b64_tr_b16 v[42:43], v119 offset:19200
 ds_read_b64_tr_b16 v[44:45], v119 offset:24576
 ds_read_b64_tr_b16 v[46:47], v119 offset:25344
 ds_read_b64_tr_b16 v[48:49], v119 offset:30720
 ds_read_b64_tr_b16 v[50:51], v119 offset:31488
 ds_read_b64_tr_b16 v[52:53], v119 offset:36864
 ds_read_b64_tr_b16 v[54:55], v119 offset:37632
 ds_read_b64_tr_b16 v[56:57], v119 offset:43008
 ds_read_b64_tr_b16 v[58:59], v119 offset:43776
 ds_read_b64_tr_b16 v[60:61], v119 offset:49152
 ds_read_b64_tr_b16 v[62:63], v119 offset:49920
 ds_read_b64_tr_b16 v[64:65], v119 offset:55296
 ds_read_b64_tr_b16 v[66:67], v119 offset:56064
 s_branch Lpw_26
Lpwn_27:
 s_cmp_eq_u32 s3, 1
 s_cbranch_scc0 Lpwn_28
 ds_read_b64_tr_b16 v[8:9], v119 offset:0
 ds_read_b64_tr_b16 v[88:89], v120 offset:0
 ds_read_b64_tr_b16 v[10:11], v119 offset:768
 ds_read_b64_tr_b16 v[90:91], v120 offset:768
 ds_read_b64_tr_b16 v[12:13], v119 offset:6144
 ds_read_b64_tr_b16 v[92:93], v120 offset:6144
 ds_read_b64_tr_b16 v[14:15], v119 offset:6912
 ds_read_b64_tr_b16 v[94:95], v120 offset:6912
 ds_read_b64_tr_b16 v[16:17], v119 offset:12288
 ds_read_b64_tr_b16 v[96:97], v120 offset:12288
 ds_read_b64_tr_b16 v[18:19], v119 offset:13056
 ds_read_b64_tr_b16 v[98:99], v120 offset:13056
 ds_read_b64_tr_b16 v[20:21], v119 offset:18432
 ds_read_b64_tr_b16 v[100:101], v120 offset:18432
 ds_read_b64_tr_b16 v[22:23], v119 offset:19200
 ds_read_b64_tr_b16 v[102:103], v120 offset:19200
 ds_read_b64_tr_b16 v[24:25], v119 offset:24576
 ds_read_b64_tr_b16 v[104:105], v120 offset:24576
 ds_read_b64_tr_b16 v[26:27], v119 offset:25344
 ds_read_b64_tr_b16 v[106:107], v120 offset:25344
 ds_read_b64_tr_b16 v[28:29], v119 offset:30720
 ds_read_b64_tr_b16 v[30:31], v119 offset:31488
 ds_read_b64_tr_b16 v[32:33], v119 offset:36864
 ds_read_b64_tr_b16 v[34:35], v119 offset:37632
 ds_read_b64_tr_b16 v[36:37], v119 offset:43008
 ds_read_b64_tr_b16 v[38:39], v119 offset:43776
 ds_read_b64_tr_b16 v[40:41], v119 offset:49152
 ds_read_b64_tr_b16 v[42:43], v119 offset:49920
 ds_read_b64_tr_b16 v[44:45], v119 offset:55296
 ds_read_b64_tr_b16 v[46:47], v119 offset:56064
 s_branch Lpw_26
Lpwn_28:
 s_cmp_eq_u32 s3, 2
 s_cbranch_scc0 Lpwn_29
 ds_read_b64_tr_b16 a[240:241], v119 offset:0
 ds_read_b64_tr_b16 v[68:69], v120 offset:0
 ds_read_b64_tr_b16 a[242:243], v119 offset:768
 ds_read_b64_tr_b16 v[70:71], v120 offset:768
 ds_read_b64_tr_b16 a[244:245], v119 offset:6144
 ds_read_b64_tr_b16 v[72:73], v120 offset:6144
 ds_read_b64_tr_b16 a[246:247], v119 offset:6912
 ds_read_b64_tr_b16 v[74:75], v120 offset:6912
 ds_read_b64_tr_b16 a[248:249], v119 offset:12288
 ds_read_b64_tr_b16 v[76:77], v120 offset:12288
 ds_read_b64_tr_b16 a[250:251], v119 offset:13056
 ds_read_b64_tr_b16 v[78:79], v120 offset:13056
 ds_read_b64_tr_b16 a[252:253], v119 offset:18432
 ds_read_b64_tr_b16 v[80:81], v120 offset:18432
 ds_read_b64_tr_b16 a[254:255], v119 offset:19200
 ds_read_b64_tr_b16 v[82:83], v120 offset:19200
 ds_read_b64_tr_b16 v[4:5], v119 offset:24576
 ds_read_b64_tr_b16 v[84:85], v120 offset:24576
 ds_read_b64_tr_b16 v[6:7], v119 offset:25344
 ds_read_b64_tr_b16 v[86:87], v120 offset:25344
 ds_read_b64_tr_b16 v[8:9], v119 offset:30720
 ds_read_b64_tr_b16 v[88:89], v120 offset:30720
 ds_read_b64_tr_b16 v[10:11], v119 offset:31488
 ds_read_b64_tr_b16 v[90:91], v120 offset:31488
 ds_read_b64_tr_b16 v[12:13], v119 offset:36864
 ds_read_b64_tr_b16 v[92:93], v120 offset:36864
 ds_read_b64_tr_b16 v[14:15], v119 offset:37632
 ds_read_b64_tr_b16 v[94:95], v120 offset:37632
 ds_read_b64_tr_b16 v[16:17], v119 offset:43008
 ds_read_b64_tr_b16 v[96:97], v120 offset:43008
 ds_read_b64_tr_b16 v[18:19], v119 offset:43776
 ds_read_b64_tr_b16 v[98:99], v120 offset:43776
 ds_read_b64_tr_b16 v[20:21], v119 offset:49152
 ds_read_b64_tr_b16 v[100:101], v120 offset:49152
 ds_read_b64_tr_b16 v[22:23], v119 offset:49920
 ds_read_b64_tr_b16 v[102:103], v120 offset:49920
 ds_read_b64_tr_b16 v[24:25], v119 offset:55296
 ds_read_b64_tr_b16 v[104:105], v120 offset:55296
 ds_read_b64_tr_b16 v[26:27], v119 offset:56064
 ds_read_b64_tr_b16 v[106:107], v120 offset:56064
 s_branch Lpw_26
Lpwn_29:
 ds_read_b64_tr_b16 v[48:49], v119 offset:0
 ds_read_b64_tr_b16 v[50:51], v119 offset:768
 ds_read_b64_tr_b16 v[52:53], v119 offset:6144
 ds_read_b64_tr_b16 v[54:55], v119 offset:6912
 ds_read_b64_tr_b16 v[56:57], v119 offset:12288
 ds_read_b64_tr_b16 v[58:59], v119 offset:13056
 ds_read_b64_tr_b16 v[60:61], v119 offset:18432
 ds_read_b64_tr_b16 v[62:63], v119 offset:19200
 ds_read_b64_tr_b16 v[64:65], v119 offset:24576
 ds_read_b64_tr_b16 v[66:67], v119 offset:25344
 ds_read_b64_tr_b16 a[240:241], v119 offset:30720
 ds_read_b64_tr_b16 v[68:69], v120 offset:30720
 ds_read_b64_tr_b16 a[242:243], v119 offset:31488
 ds_read_b64_tr_b16 v[70:71], v120 offset:31488
 ds_read_b64_tr_b16 a[244:245], v119 offset:36864
 ds_read_b64_tr_b16 v[72:73], v120 offset:36864
 ds_read_b64_tr_b16 a[246:247], v119 offset:37632
 ds_read_b64_tr_b16 v[74:75], v120 offset:37632
 ds_read_b64_tr_b16 a[248:249], v119 offset:43008
 ds_read_b64_tr_b16 v[76:77], v120 offset:43008
 ds_read_b64_tr_b16 a[250:251], v119 offset:43776
 ds_read_b64_tr_b16 v[78:79], v120 offset:43776
 ds_read_b64_tr_b16 a[252:253], v119 offset:49152
 ds_read_b64_tr_b16 v[80:81], v120 offset:49152
 ds_read_b64_tr_b16 a[254:255], v119 offset:49920
 ds_read_b64_tr_b16 v[82:83], v120 offset:49920
 ds_read_b64_tr_b16 v[4:5], v119 offset:55296
 ds_read_b64_tr_b16 v[84:85], v120 offset:55296
 ds_read_b64_tr_b16 v[6:7], v119 offset:56064
 ds_read_b64_tr_b16 v[86:87], v120 offset:56064
Lpw_26:
 s_waitcnt lgkmcnt(0)
 s_barrier
 s_mov_b32 s20, s38
 s_mov_b32 s21, s39
 s_mov_b32 s22, 7864320
 s_mov_b32 s23, 0x20000
 s_mul_i32 s25, s3, 15360
 s_add_u32 s25, s25, 61440
 s_add_u32 s26, s30, 122880
 s_add_u32 m0, s25, 0
 s_add_u32 s27, s26, 0
 buffer_load_dwordx4 v110, s[20:23], s27 offen lds
 s_add_u32 m0, s25, 1024
 s_add_u32 s27, s26, 0
 buffer_load_dwordx4 v111, s[20:23], s27 offen lds
 s_add_u32 m0, s25, 2048
 s_add_u32 s27, s26, 0
 buffer_load_dwordx4 v112, s[20:23], s27 offen lds
 s_add_u32 m0, s25, 3072
 s_add_u32 s27, s26, 0
 buffer_load_dwordx4 v113, s[20:23], s27 offen lds
 s_add_u32 m0, s25, 4096
 s_add_u32 s27, s26, 0
 buffer_load_dwordx4 v114, s[20:23], s27 offen lds
 s_add_u32 m0, s25, 5120
 s_add_u32 s27, s26, 40960
 buffer_load_dwordx4 v110, s[20:23], s27 offen lds
 s_add_u32 m0, s25, 6144
 s_add_u32 s27, s26, 40960
 buffer_load_dwordx4 v111, s[20:23], s27 offen lds
 s_add_u32 m0, s25, 7168
 s_add_u32 s27, s26, 40960
 buffer_load_dwordx4 v112, s[20:23], s27 offen lds
 s_add_u32 m0, s25, 8192
 s_add_u32 s27, s26, 40960
 buffer_load_dwordx4 v113, s[20:23], s27 offen lds
 s_add_u32 m0, s25, 9216
 s_add_u32 s27, s26, 40960
 buffer_load_dwordx4 v114, s[20:23], s27 offen lds
 s_add_u32 m0, s25, 10240
 s_add_u32 s27, s26, 81920
 buffer_load_dwordx4 v110, s[20:23], s27 offen lds
 s_add_u32 m0, s25, 11264
 s_add_u32 s27, s26, 81920
 buffer_load_dwordx4 v111, s[20:23], s27 offen lds
 s_add_u32 m0, s25, 12288
 s_add_u32 s27, s26, 81920
 buffer_load_dwordx4 v112, s[20:23], s27 offen lds
 s_add_u32 m0, s25, 13312
 s_add_u32 s27, s26, 81920
 buffer_load_dwordx4 v113, s[20:23], s27 offen lds
 s_add_u32 m0, s25, 14336
 s_add_u32 s27, s26, 81920
 buffer_load_dwordx4 v114, s[20:23], s27 offen lds
 s_waitcnt vmcnt(15)
 s_barrier
 ds_read_b64_tr_b16 v[124:125], v121 offset:0
 ds_read_b64_tr_b16 v[126:127], v121 offset:10240
 ds_read_b64_tr_b16 v[128:129], v121 offset:8
 ds_read_b64_tr_b16 v[130:131], v121 offset:10248
 ds_read_b64_tr_b16 v[132:133], v121 offset:64
 ds_read_b64_tr_b16 v[134:135], v121 offset:10304
 ds_read_b64_tr_b16 v[136:137], v121 offset:72
 ds_read_b64_tr_b16 v[138:139], v121 offset:10312
 ds_read_b64_tr_b16 v[140:141], v122 offset:128
 ds_read_b64_tr_b16 v[142:143], v122 offset:10368
 ds_read_b64_tr_b16 v[144:145], v121 offset:2560
 ds_read_b64_tr_b16 v[146:147], v121 offset:12800
 ds_read_b64_tr_b16 v[148:149], v121 offset:2568
 ds_read_b64_tr_b16 v[150:151], v121 offset:12808
 ds_read_b64_tr_b16 v[152:153], v121 offset:2624
 ds_read_b64_tr_b16 v[154:155], v121 offset:12864
 ds_read_b64_tr_b16 v[156:157], v121 offset:2632
 ds_read_b64_tr_b16 v[158:159], v121 offset:12872
 ds_read_b64_tr_b16 v[160:161], v122 offset:2688
 ds_read_b64_tr_b16 v[162:163], v122 offset:12928
 ds_read_b64_tr_b16 v[164:165], v121 offset:5120
 ds_read_b64_tr_b16 v[166:167], v121 offset:7680
 ds_read_b64_tr_b16 v[168:169], v121 offset:5128
 ds_read_b64_tr_b16 v[170:171], v121 offset:7688
 ds_read_b64_tr_b16 v[172:173], v121 offset:5184
 ds_read_b64_tr_b16 v[174:175], v121 offset:7744
 ds_read_b64_tr_b16 v[176:177], v121 offset:5192
 ds_read_b64_tr_b16 v[178:179], v121 offset:7752
 ds_read_b64_tr_b16 v[180:181], v122 offset:5248
 ds_read_b64_tr_b16 v[182:183], v122 offset:7808
 s_waitcnt lgkmcnt(0)
 s_barrier
 ds_write_b128 v123, v[124:127] offset:0
 ds_write_b128 v123, v[128:131] offset:1024
 ds_write_b128 v123, v[132:135] offset:2048
 ds_write_b128 v123, v[136:139] offset:3072
 ds_write_b128 v123, v[140:143] offset:4096
 ds_write_b128 v123, v[144:147] offset:5120
 ds_write_b128 v123, v[148:151] offset:6144
 ds_write_b128 v123, v[152:155] offset:7168
 ds_write_b128 v123, v[156:159] offset:8192
 ds_write_b128 v123, v[160:163] offset:9216
 ds_write_b128 v123, v[164:167] offset:10240
 ds_write_b128 v123, v[168:171] offset:11264
 ds_write_b128 v123, v[172:175] offset:12288
 ds_write_b128 v123, v[176:179] offset:13312
 ds_write_b128 v123, v[180:183] offset:14336
 s_waitcnt vmcnt(0)
 s_barrier
 v_add_u32 v121, 61440, v121
 v_add_u32 v122, 61440, v122
 v_add_u32 v123, 61440, v123
 ds_read_b64_tr_b16 v[124:125], v121 offset:0
 ds_read_b64_tr_b16 v[126:127], v121 offset:10240
 ds_read_b64_tr_b16 v[128:129], v121 offset:8
 ds_read_b64_tr_b16 v[130:131], v121 offset:10248
 ds_read_b64_tr_b16 v[132:133], v121 offset:64
 ds_read_b64_tr_b16 v[134:135], v121 offset:10304
 ds_read_b64_tr_b16 v[136:137], v121 offset:72
 ds_read_b64_tr_b16 v[138:139], v121 offset:10312
 ds_read_b64_tr_b16 v[140:141], v122 offset:128
 ds_read_b64_tr_b16 v[142:143], v122 offset:10368
 ds_read_b64_tr_b16 v[144:145], v121 offset:2560
 ds_read_b64_tr_b16 v[146:147], v121 offset:12800
 ds_read_b64_tr_b16 v[148:149], v121 offset:2568
 ds_read_b64_tr_b16 v[150:151], v121 offset:12808
 ds_read_b64_tr_b16 v[152:153], v121 offset:2624
 ds_read_b64_tr_b16 v[154:155], v121 offset:12864
 ds_read_b64_tr_b16 v[156:157], v121 offset:2632
 ds_read_b64_tr_b16 v[158:159], v121 offset:12872
 ds_read_b64_tr_b16 v[160:161], v122 offset:2688
 ds_read_b64_tr_b16 v[162:163], v122 offset:12928
 ds_read_b64_tr_b16 v[164:165], v121 offset:5120
 ds_read_b64_tr_b16 v[166:167], v121 offset:7680
 ds_read_b64_tr_b16 v[168:169], v121 offset:5128
 ds_read_b64_tr_b16 v[170:171], v121 offset:7688
 ds_read_b64_tr_b16 v[172:173], v121 offset:5184
 ds_read_b64_tr_b16 v[174:175], v121 offset:7744
 ds_read_b64_tr_b16 v[176:177], v121 offset:5192
 ds_read_b64_tr_b16 v[178:179], v121 offset:7752
 ds_read_b64_tr_b16 v[180:181], v122 offset:5248
 ds_read_b64_tr_b16 v[182:183], v122 offset:7808
 s_waitcnt lgkmcnt(0)
 s_barrier
 ds_write_b128 v123, v[124:127] offset:0
 ds_write_b128 v123, v[128:131] offset:1024
 ds_write_b128 v123, v[132:135] offset:2048
 ds_write_b128 v123, v[136:139] offset:3072
 ds_write_b128 v123, v[140:143] offset:4096
 ds_write_b128 v123, v[144:147] offset:5120
 ds_write_b128 v123, v[148:151] offset:6144
 ds_write_b128 v123, v[152:155] offset:7168
 ds_write_b128 v123, v[156:159] offset:8192
 ds_write_b128 v123, v[160:163] offset:9216
 ds_write_b128 v123, v[164:167] offset:10240
 ds_write_b128 v123, v[168:171] offset:11264
 ds_write_b128 v123, v[172:175] offset:12288
 ds_write_b128 v123, v[176:179] offset:13312
 ds_write_b128 v123, v[180:183] offset:14336
 s_waitcnt lgkmcnt(0)
 s_cmp_eq_u32 s13, 1
 s_cbranch_scc1 Lverok_32
 s_mov_b32 s18, 0
Lver_31:
 s_add_u32 s18, s18, 1
 s_cmp_gt_u32 s18, 200000
 s_cbranch_scc1 L_fail
 v_and_b32 v254, 7, v0
 v_lshlrev_b32 v254, 2, v254
 buffer_load_dword v255, v254, s[8:11], 0 offen sc1
 s_waitcnt vmcnt(0)
 v_cmp_eq_u32 vcc, 32, v255
 s_nop 0
 s_cmp_eq_u64 vcc, -1
 s_cbranch_scc1 Lverok_32
 s_mov_b32 s17, 0
 v_readlane_b32 s14, v255, 0
 s_nop 0
 s_add_u32 s17, s17, s14
 v_readlane_b32 s14, v255, 1
 s_nop 0
 s_add_u32 s17, s17, s14
 v_readlane_b32 s14, v255, 2
 s_nop 0
 s_add_u32 s17, s17, s14
 v_readlane_b32 s14, v255, 3
 s_nop 0
 s_add_u32 s17, s17, s14
 v_readlane_b32 s14, v255, 4
 s_nop 0
 s_add_u32 s17, s17, s14
 v_readlane_b32 s14, v255, 5
 s_nop 0
 s_add_u32 s17, s17, s14
 v_readlane_b32 s14, v255, 6
 s_nop 0
 s_add_u32 s17, s17, s14
 v_readlane_b32 s14, v255, 7
 s_nop 0
 s_add_u32 s17, s17, s14
 s_cmp_eq_u32 s17, 256
 s_cbranch_scc1 L_fallback
 s_branch Lver_31
Lverok_32:
 s_mov_b32 s71, 0x3dd53b95
 v_lshlrev_b32 v108, 3, v1
 v_add_u32 v3, 122880, v2
 v_add_u32 v118, 153600, v108
 s_mul_i32 s25, s3, 5120
 s_mul_i32 s26, s24, 81920
 s_add_u32 s26, s26, 409600
 s_add_u32 s42, s25, s26
 s_add_u32 s25, s3, 0
 s_and_b32 s25, s25, 3
 s_mul_i32 s25, s25, 5120
 v_add_u32 v109, s25, v3
 s_add_u32 s25, s3, 1
 s_and_b32 s25, s25, 3
 s_mul_i32 s25, s25, 5120
 v_add_u32 v110, s25, v3
 s_add_u32 s25, s3, 2
 s_and_b32 s25, s25, 3
 s_mul_i32 s25, s25, 5120
 v_add_u32 v111, s25, v3
 s_add_u32 s25, s3, 3
 s_and_b32 s25, s25, 3
 s_mul_i32 s25, s25, 5120
 v_add_u32 v112, s25, v3
 s_bitcmp1_b32 s3, 0
 s_mov_b32 s26, 20480
 s_cselect_b32 s25, 21512, s26
 s_lshr_b32 s26, s3, 1
 s_mul_i32 s26, s26, 3072
 s_add_u32 s25, s25, s26
 v_add_u32 v113, s25, v3
 s_bitcmp1_b32 s3, 0
 s_mov_b32 s26, 20488
 s_cselect_b32 s25, 22528, s26
 s_lshr_b32 s26, s3, 1
 s_mul_i32 s26, s26, 3072
 s_add_u32 s25, s25, s26
 v_add_u32 v114, s25, v3
 s_and_b32 s28, s3, 1
 s_lshl_b32 s26, s28, 10
 v_add_u32 v117, s26, v3
 s_mul_i32 s25, s12, 3072
 s_add_u32 s44, s25, 16384
 s_xor_b32 s26, s12, 1
 s_mul_i32 s26, s26, 3072
 s_add_u32 s45, s26, 16384
 s_min_u32 s26, s3, 2
 s_lshl_b32 s26, s26, 10
 s_add_u32 s26, s26, s25
 s_cmp_eq_u32 s3, 3
 s_cselect_b32 s27, 8, 0
 s_add_u32 s26, s26, s27
 s_add_u32 s55, s26, 1884160
 s_lshr_b32 s26, s12, 3
 s_lshl_b32 s26, s26, 2
 s_add_u32 s26, s26, s3
 s_mul_i32 s26, s26, 6144
 s_add_u32 s56, s26, 1884160
 s_mul_i32 s26, s3, 15360
 v_add_u32 v115, s26, v2
 v_add_u32 v116, 61440, v115
 v_lshrrev_b32 v127, 4, v1
 v_and_b32 v190, 15, v1
 s_lshl_b32 s26, s3, 8
 s_add_u32 s26, s26, 122880
 v_lshl_add_u32 v120, v190, 4, s26
 v_lshl_add_u32 v119, v127, 10, v120
 v_lshrrev_b32 v191, 5, v1
 v_lshl_add_u32 v120, v191, 10, v120
 v_bfe_u32 v126, v1, 4, 1
 v_lshl_add_u32 v120, v126, 3, v120
 s_lshl_b32 s26, s3, 11
 v_add_u32 v121, s26, v3
 v_lshlrev_b32 v122, 10, v191
 v_lshl_add_u32 v122, v190, 4, v122
 v_lshl_add_u32 v122, v126, 3, v122
 s_and_b32 s26, s12, 7
 s_mul_i32 s26, s26, 10240
 s_bfe_u32 s27, s12, 0x20003
 s_lshl_b32 s27, s27, 8
 s_add_u32 s26, s26, s27
 s_mul_i32 s27, s24, 81920
 s_add_u32 s26, s26, s27
 s_add_u32 s26, s26, 573440
 s_add_u32 s47, s26, 8192
 s_lshl_b32 s27, s3, 11
 s_add_u32 s46, s26, s27
 s_lshl_b32 s25, s3, 5
 s_add_u32 s25, s25, s19
 s_cmp_lt_u32 s25, 80
 s_cselect_b32 s40, 1, 0
 s_cselect_b32 s25, s25, 0
 s_lshl_b32 s26, s25, 10
 s_cmp_eq_u32 s24, 0
 s_mov_b32 s27, 573440
 s_cselect_b32 s48, 1228800, s27
 s_mov_b32 s27, 1310720
 s_cselect_b32 s49, 655360, s27
 s_add_u32 s48, s48, s26
 s_add_u32 s49, s49, s26
 s_lshl_b32 s26, s25, 8
 s_mul_i32 s27, s24, 81920
 s_add_u32 s26, s26, s27
 s_add_u32 s43, s26, 409600
 v_lshlrev_b32 v123, 4, v190
 v_lshl_add_u32 v123, v127, 3, v123
 s_load_dwordx2 s[32:33], s[0:1], 8
 v_and_b32 v191, 7, v1
 v_mul_u32_u24 v191, 1280, v191
 v_lshl_add_u32 v191, v127, 3, v191
 s_lshl_b32 s26, s25, 4
 v_add_u32 v191, s26, v191
 s_waitcnt lgkmcnt(0)
 s_mov_b32 s20, s32
 s_mov_b32 s21, s33
 s_mov_b32 s22, 10240
 s_mov_b32 s23, 0x20000
 buffer_load_dwordx2 v[128:129], v191, s[20:23], 0 offen
 s_mul_i32 s25, s12, 6144
 s_lshl_b32 s27, s28, 10
 s_add_u32 s50, s27, s25
 s_lshl_b32 s27, s3, 10
 s_add_u32 s51, s27, s25
 s_add_u32 s27, s28, 4
 s_lshl_b32 s27, s27, 10
 s_add_u32 s52, s27, s25
 s_mul_i32 s25, s12, 3072
 s_add_u32 s53, s25, 2277376
 s_lshl_b32 s54, s12, 2
 s_add_u32 s54, s54, 4096
 s_mul_i32 s25, s12, 96
 v_and_b32 v124, 3, v1
 v_mul_u32_u24 v124, 48, v124
 v_min_u32 v124, 95, v124
 v_add_u32 v124, s25, v124
 v_lshrrev_b32 v124, 6, v124
 v_bfe_u32 v126, v1, 2, 1
 v_add_u32 v126, 1, v126
 v_mul_u32_u24 v126, 96, v126
 v_add_u32 v124, v126, v124
 v_bfe_u32 v126, v1, 3, 1
 v_lshl_add_u32 v124, v126, 9, v124
 v_lshlrev_b32 v124, 2, v124
 v_add_u32 v124, 0, v124
 v_mul_u32_u24 v125, 8, v126
 v_sub_u32 v125, 1, v125
 v_lshrrev_b32 v191, 5, v1
 v_bfe_u32 v126, v1, 3, 1
 v_cmp_eq_u32 vcc, v191, v126
 v_mov_b32 v191, 0xf149f2ca
 s_nop 0
 v_cndmask_b32 v158, v191, 0, vcc
 v_mov_b32 v159, v158
 v_mov_b32 v160, v158
 v_mov_b32 v161, v158
 v_mov_b32 v162, 0
 v_mov_b32 v166, 0
 v_mov_b32 v182, -1
 v_mov_b32 v186, 0x3f803f80
 v_mov_b32 v178, 0
 v_mov_b32 v170, 0
 v_mov_b32 v191, 0x3f80
 v_cmp_eq_u32 vcc, 0, v190
 s_nop 1
 v_cndmask_b32 v170, v170, v191, vcc
 v_mov_b32 v191, 0x3f800000
 v_cmp_eq_u32 vcc, 1, v190
 s_nop 1
 v_cndmask_b32 v170, v170, v191, vcc
 v_mov_b32 v174, 0
 v_mov_b32 v191, 0x3f80
 v_cmp_eq_u32 vcc, 8, v190
 s_nop 1
 v_cndmask_b32 v174, v174, v191, vcc
 v_mov_b32 v191, 0x3f800000
 v_cmp_eq_u32 vcc, 9, v190
 s_nop 1
 v_cndmask_b32 v174, v174, v191, vcc
 v_mov_b32 v163, 0
 v_mov_b32 v167, 0
 v_mov_b32 v183, -1
 v_mov_b32 v187, 0x3f803f80
 v_mov_b32 v179, 0
 v_mov_b32 v171, 0
 v_mov_b32 v191, 0x3f80
 v_cmp_eq_u32 vcc, 2, v190
 s_nop 1
 v_cndmask_b32 v171, v171, v191, vcc
 v_mov_b32 v191, 0x3f800000
 v_cmp_eq_u32 vcc, 3, v190
 s_nop 1
 v_cndmask_b32 v171, v171, v191, vcc
 v_mov_b32 v175, 0
 v_mov_b32 v191, 0x3f80
 v_cmp_eq_u32 vcc, 10, v190
 s_nop 1
 v_cndmask_b32 v175, v175, v191, vcc
 v_mov_b32 v191, 0x3f800000
 v_cmp_eq_u32 vcc, 11, v190
 s_nop 1
 v_cndmask_b32 v175, v175, v191, vcc
 v_mov_b32 v164, 0
 v_mov_b32 v168, 0
 v_mov_b32 v184, -1
 v_mov_b32 v188, 0x3f803f80
 v_mov_b32 v180, 0
 v_mov_b32 v172, 0
 v_mov_b32 v191, 0x3f80
 v_cmp_eq_u32 vcc, 4, v190
 s_nop 1
 v_cndmask_b32 v172, v172, v191, vcc
 v_mov_b32 v191, 0x3f800000
 v_cmp_eq_u32 vcc, 5, v190
 s_nop 1
 v_cndmask_b32 v172, v172, v191, vcc
 v_mov_b32 v176, 0
 v_mov_b32 v191, 0x3f80
 v_cmp_eq_u32 vcc, 12, v190
 s_nop 1
 v_cndmask_b32 v176, v176, v191, vcc
 v_mov_b32 v191, 0x3f800000
 v_cmp_eq_u32 vcc, 13, v190
 s_nop 1
 v_cndmask_b32 v176, v176, v191, vcc
 v_mov_b32 v165, 0
 v_mov_b32 v169, 0
 v_mov_b32 v185, -1
 v_mov_b32 v189, 0x3f803f80
 v_mov_b32 v181, 0
 v_mov_b32 v173, 0
 v_mov_b32 v191, 0x3f80
 v_cmp_eq_u32 vcc, 6, v190
 s_nop 1
 v_cndmask_b32 v173, v173, v191, vcc
 v_mov_b32 v191, 0x3f800000
 v_cmp_eq_u32 vcc, 7, v190
 s_nop 1
 v_cndmask_b32 v173, v173, v191, vcc
 v_mov_b32 v177, 0
 v_mov_b32 v191, 0x3f80
 v_cmp_eq_u32 vcc, 14, v190
 s_nop 1
 v_cndmask_b32 v177, v177, v191, vcc
 v_mov_b32 v191, 0x3f800000
 v_cmp_eq_u32 vcc, 15, v190
 s_nop 1
 v_cndmask_b32 v177, v177, v191, vcc
 s_mov_b32 s31, 0
 s_mov_b32 s41, 0
 v_min_i32 v1, 64, v125
Lfl_33:
 s_add_u32 s41, s41, 1
 s_cmp_gt_u32 s41, 200000
 s_cbranch_scc1 L_fail
 buffer_load_dword v126, v124, s[4:7], 0 offen sc1
 s_waitcnt vmcnt(0)
 v_cmp_ge_i32 vcc, v126, v1
 s_nop 0
 s_cmp_eq_u64 vcc, -1
 s_cbranch_scc0 Lfl_33
Lflok_34:
 v_add_u32 v125, 1, v125
 s_add_u32 s25, s31, 0
 s_mul_i32 s68, s25, 393216
 s_add_u32 s68, s68, 84066304
 s_cmp_lt_u32 s25, 64
 s_cselect_b32 s68, s68, 2146435072
 s_sub_u32 s26, s25, 8
 s_mul_i32 s69, s26, 393216
 s_add_u32 s69, s69, 134397952
 s_cmp_lt_u32 s26, 64
 s_cselect_b32 s69, s69, 2146435072
 s_add_u32 s25, s68, 4269801472
 s_add_u32 s26, s69, 4269801472
 s_cmp_lt_u32 s3, 2
 s_cselect_b32 s67, s25, s26
 s_add_u32 s67, s67, s50
 buffer_load_dwordx4 v[130:133], v2, s[4:7], s67 offen sc1
 buffer_load_dwordx4 v[134:137], v2, s[4:7], s67 offen offset:2048 sc1
 s_add_u32 s25, s67, 4096
 buffer_load_dwordx4 v[138:141], v2, s[4:7], s25 offen sc1
 s_add_u32 s70, s31, 0
 s_and_b32 s25, s70, 3
 s_mul_i32 s26, s25, 20480
 s_add_u32 s57, s26, s42
 s_add_u32 s58, s57, 4096
 s_add_u32 s59, s26, s43
 s_mul_i32 s63, s25, 163840
 s_xor_b32 s26, s25, 2
 s_mul_i32 s64, s26, 163840
 s_add_u32 s25, s25, 3
 s_and_b32 s25, s25, 3
 s_mul_i32 s26, s25, 20480
 s_add_u32 s60, s26, s43
 s_and_b32 s25, s70, 1
 s_mul_i32 s61, s25, 196608
 s_xor_b32 s25, s25, 1
 s_mul_i32 s62, s25, 196608
 s_mul_i32 s70, s70, 196608
 s_cmp_eq_u32 s13, 0
 s_cbranch_scc0 L_rec_remote
 s_cmp_eq_u32 s3, 0
 s_cbranch_scc0 Lpwn_36
 s_waitcnt vmcnt(0)
 s_cmp_eq_u32 s40, 0
 s_cbranch_scc1 Lz0_37
 s_mov_b64 exec, 0xffffffff
 buffer_store_dwordx2 v[128:129], v123, s[4:7], s43 offen
 s_mov_b64 exec, -1
Lz0_37:
 s_barrier
L_rec_top_0l:
 s_sleep 2
 buffer_load_dwordx4 v[190:193], v2, s[4:7], s57 offen offset:0 sc1
 buffer_load_dwordx4 v[194:197], v2, s[4:7], s57 offen offset:1024 sc1
 buffer_load_dwordx4 v[198:201], v2, s[4:7], s57 offen offset:2048 sc1
 buffer_load_dwordx4 v[202:205], v2, s[4:7], s57 offen offset:3072 sc1
 buffer_load_dwordx4 v[206:209], v2, s[4:7], s58 offen offset:0 sc1
 s_mov_b32 s41, 0
Lz_38:
 s_waitcnt vmcnt(4)
 ds_write_b128 v109, v[190:193] offset:0
 v_mfma_f32_16x16x32_bf16 v[226:229], a[0:3], v[190:193], 0
 v_max3_u32 v1, v190, v191, v192
 v_max_u32 v1, v1, v193
 v_mfma_f32_16x16x32_bf16 v[230:233], a[80:83], v[190:193], 0
 v_cmp_eq_u32 vcc, -1, v1
 v_mfma_f32_16x16x32_bf16 v[234:237], a[160:163], v[190:193], 0
 s_cbranch_vccnz Lzs_39
Lz_40:
 s_waitcnt vmcnt(3)
 ds_write_b128 v109, v[194:197] offset:1024
 v_max3_u32 v1, v194, v195, v196
 v_max_u32 v1, v1, v197
 v_cmp_eq_u32 vcc, -1, v1
 s_cbranch_vccnz Lzs_41
 v_mfma_f32_16x16x32_bf16 v[226:229], a[4:7], v[194:197], v[226:229]
 v_mfma_f32_16x16x32_bf16 v[230:233], a[84:87], v[194:197], v[230:233]
 v_mfma_f32_16x16x32_bf16 v[234:237], a[164:167], v[194:197], v[234:237]
Lz_42:
 s_waitcnt vmcnt(2)
 ds_write_b128 v109, v[198:201] offset:2048
 v_max3_u32 v1, v198, v199, v200
 v_max_u32 v1, v1, v201
 v_cmp_eq_u32 vcc, -1, v1
 s_cbranch_vccnz Lzs_43
 v_mfma_f32_16x16x32_bf16 v[226:229], a[8:11], v[198:201], v[226:229]
 v_mfma_f32_16x16x32_bf16 v[230:233], a[88:91], v[198:201], v[230:233]
 v_mfma_f32_16x16x32_bf16 v[234:237], a[168:171], v[198:201], v[234:237]
Lz_44:
 s_waitcnt vmcnt(1)
 ds_write_b128 v109, v[202:205] offset:3072
 v_max3_u32 v1, v202, v203, v204
 v_max_u32 v1, v1, v205
 v_cmp_eq_u32 vcc, -1, v1
 s_cbranch_vccnz Lzs_45
Lz_46:
 s_waitcnt vmcnt(0)
 ds_write_b128 v109, v[206:209] offset:4096
 v_max3_u32 v1, v206, v207, v208
 v_max_u32 v1, v1, v209
 v_cmp_eq_u32 vcc, -1, v1
 s_cbranch_vccnz Lzs_47
 s_waitcnt lgkmcnt(0)
 s_barrier
 ds_read_b128 v[214:217], v110 offset:0
 ds_read_b128 v[218:221], v110 offset:1024
 ds_read_b128 v[222:225], v110 offset:2048
 v_mfma_f32_16x16x32_bf16 v[226:229], a[12:15], v[202:205], v[226:229]
 s_mov_b64 exec, 1
 v_mov_b32 v127, s31
 v_mfma_f32_16x16x32_bf16 v[230:233], a[92:95], v[202:205], v[230:233]
 buffer_store_dword v127, off, s[4:7], s54 sc1
 v_mfma_f32_16x16x32_bf16 v[234:237], a[172:175], v[202:205], v[234:237]
 s_mov_b64 exec, -1
 v_mfma_f32_16x16x32_bf16 v[226:229], a[16:19], v[206:209], v[226:229]
 s_add_u32 s25, s68, s51
 v_mfma_f32_16x16x32_bf16 v[230:233], a[96:99], v[206:209], v[230:233]
 buffer_load_dwordx4 v[142:145], v2, s[4:7], s25 offen sc1
 v_mfma_f32_16x16x32_bf16 v[234:237], a[176:179], v[206:209], v[234:237]
 ds_read_b128 v[210:213], v110 offset:3072
 s_waitcnt lgkmcnt(3)
 v_mfma_f32_16x16x32_bf16 v[226:229], a[20:23], v[214:217], v[226:229]
 s_add_u32 s25, s68, s52
 v_mfma_f32_16x16x32_bf16 v[230:233], a[100:103], v[214:217], v[230:233]
 buffer_load_dwordx4 v[146:149], v2, s[4:7], s25 offen sc1
 v_mfma_f32_16x16x32_bf16 v[234:237], a[180:183], v[214:217], v[234:237]
 ds_read_b128 v[214:217], v110 offset:4096
 s_waitcnt lgkmcnt(3)
 v_mfma_f32_16x16x32_bf16 v[226:229], a[24:27], v[218:221], v[226:229]
 s_add_u32 s25, s69, s51
 v_mfma_f32_16x16x32_bf16 v[230:233], a[104:107], v[218:221], v[230:233]
 buffer_load_dwordx4 v[150:153], v2, s[4:7], s25 offen sc1
 v_mfma_f32_16x16x32_bf16 v[234:237], a[184:187], v[218:221], v[234:237]
 ds_read_b128 v[218:221], v111 offset:0
 s_waitcnt lgkmcnt(3)
 v_mfma_f32_16x16x32_bf16 v[226:229], a[28:31], v[222:225], v[226:229]
 s_add_u32 s25, s69, s52
 v_mfma_f32_16x16x32_bf16 v[230:233], a[108:111], v[222:225], v[230:233]
 buffer_load_dwordx4 v[154:157], v2, s[4:7], s25 offen sc1
 v_mfma_f32_16x16x32_bf16 v[234:237], a[188:191], v[222:225], v[234:237]
 ds_read_b128 v[222:225], v111 offset:1024
 s_waitcnt lgkmcnt(3)
 v_mfma_f32_16x16x32_bf16 v[226:229], a[32:35], v[210:213], v[226:229]
 s_add_u32 s25, s46, s64
 v_mfma_f32_16x16x32_bf16 v[230:233], a[112:115], v[210:213], v[230:233]
 buffer_store_dwordx2 v[182:183], v122, s[4:7], s25 offen sc1
 v_mfma_f32_16x16x32_bf16 v[234:237], a[192:195], v[210:213], v[234:237]
 ds_read_b128 v[210:213], v111 offset:2048
 s_waitcnt lgkmcnt(3)
 v_mfma_f32_16x16x32_bf16 v[226:229], a[36:39], v[214:217], v[226:229]
 s_add_u32 s25, s25, 655360
 v_mfma_f32_16x16x32_bf16 v[230:233], a[116:119], v[214:217], v[230:233]
 buffer_store_dwordx2 v[182:183], v122, s[4:7], s25 offen
 v_mfma_f32_16x16x32_bf16 v[234:237], a[196:199], v[214:217], v[234:237]
 ds_read_b128 v[214:217], v111 offset:3072
 s_waitcnt lgkmcnt(3)
 v_mfma_f32_16x16x32_bf16 v[226:229], a[40:43], v[218:221], v[226:229]
 s_add_u32 s25, s31, 1
 s_mul_i32 s68, s25, 393216
 v_mfma_f32_16x16x32_bf16 v[230:233], a[120:123], v[218:221], v[230:233]
 s_add_u32 s68, s68, 84066304
 s_cmp_lt_u32 s25, 64
 v_mfma_f32_16x16x32_bf16 v[234:237], a[200:203], v[218:221], v[234:237]
 s_cselect_b32 s68, s68, 2146435072
 ds_read_b128 v[218:221], v111 offset:4096
 s_waitcnt lgkmcnt(3)
 v_mfma_f32_16x16x32_bf16 v[226:229], a[44:47], v[222:225], v[226:229]
 s_sub_u32 s26, s25, 8
 s_mul_i32 s69, s26, 393216
 v_mfma_f32_16x16x32_bf16 v[230:233], a[124:127], v[222:225], v[230:233]
 s_add_u32 s69, s69, 134397952
 s_cmp_lt_u32 s26, 64
 v_mfma_f32_16x16x32_bf16 v[234:237], a[204:207], v[222:225], v[234:237]
 s_cselect_b32 s69, s69, 2146435072
 ds_read_b128 v[222:225], v112 offset:0
 s_waitcnt lgkmcnt(3)
 v_mfma_f32_16x16x32_bf16 v[226:229], a[48:51], v[210:213], v[226:229]
 s_add_u32 s25, s68, 4269801472
 s_add_u32 s26, s69, 4269801472
 v_mfma_f32_16x16x32_bf16 v[230:233], a[128:131], v[210:213], v[230:233]
 s_cmp_lt_u32 s3, 2
 s_cselect_b32 s67, s25, s26
 v_mfma_f32_16x16x32_bf16 v[234:237], a[208:211], v[210:213], v[234:237]
 s_add_u32 s67, s67, s50
 ds_read_b128 v[210:213], v112 offset:1024
 s_waitcnt lgkmcnt(3)
 v_mfma_f32_16x16x32_bf16 v[226:229], a[52:55], v[214:217], v[226:229]
 v_mfma_f32_16x16x32_bf16 v[230:233], a[132:135], v[214:217], v[230:233]
 v_mfma_f32_16x16x32_bf16 v[234:237], a[212:215], v[214:217], v[234:237]
 ds_read_b128 v[214:217], v112 offset:2048
 s_waitcnt lgkmcnt(3)
 v_mfma_f32_16x16x32_bf16 v[226:229], a[56:59], v[218:221], v[226:229]
 v_mfma_f32_16x16x32_bf16 v[230:233], a[136:139], v[218:221], v[230:233]
 v_mfma_f32_16x16x32_bf16 v[234:237], a[216:219], v[218:221], v[234:237]
 ds_read_b128 v[218:221], v112 offset:3072
 s_waitcnt lgkmcnt(3)
 v_mfma_f32_16x16x32_bf16 v[226:229], a[60:63], v[222:225], v[226:229]
 v_mfma_f32_16x16x32_bf16 v[230:233], a[140:143], v[222:225], v[230:233]
 v_mfma_f32_16x16x32_bf16 v[234:237], a[220:223], v[222:225], v[234:237]
 ds_read_b128 v[222:225], v112 offset:4096
 s_waitcnt lgkmcnt(3)
 v_mfma_f32_16x16x32_bf16 v[226:229], a[64:67], v[210:213], v[226:229]
 v_mfma_f32_16x16x32_bf16 v[230:233], a[144:147], v[210:213], v[230:233]
 v_mfma_f32_16x16x32_bf16 v[234:237], a[224:227], v[210:213], v[234:237]
 s_waitcnt lgkmcnt(2)
 v_mfma_f32_16x16x32_bf16 v[226:229], a[68:71], v[214:217], v[226:229]
 v_mfma_f32_16x16x32_bf16 v[230:233], a[148:151], v[214:217], v[230:233]
 v_mfma_f32_16x16x32_bf16 v[234:237], a[228:231], v[214:217], v[234:237]
 s_waitcnt lgkmcnt(1)
 v_mfma_f32_16x16x32_bf16 v[226:229], a[72:75], v[218:221], v[226:229]
 v_mfma_f32_16x16x32_bf16 v[230:233], a[152:155], v[218:221], v[230:233]
 v_mfma_f32_16x16x32_bf16 v[234:237], a[232:235], v[218:221], v[234:237]
 s_waitcnt lgkmcnt(0)
 v_mfma_f32_16x16x32_bf16 v[226:229], a[76:79], v[222:225], v[226:229]
 v_mfma_f32_16x16x32_bf16 v[230:233], a[156:159], v[222:225], v[230:233]
 v_mfma_f32_16x16x32_bf16 v[234:237], a[236:239], v[222:225], v[234:237]
 s_nop 1
 v_cvt_pk_bf16_f32 v190, v226, v227
 v_cvt_pk_bf16_f32 v191, v228, v229
 ds_write_b64 v113, v[190:191] offset:0
 v_cvt_pk_bf16_f32 v192, v230, v231
 v_cvt_pk_bf16_f32 v193, v232, v233
 ds_write_b64 v114, v[192:193] offset:0
 v_cvt_pk_bf16_f32 v194, v234, v235
 v_cvt_pk_bf16_f32 v195, v236, v237
 ds_write_b64 v113, v[194:195] offset:1024
 s_add_u32 s26, s61, s44
 s_add_u32 s27, s61, s45
 s_waitcnt lgkmcnt(0)
 s_barrier
 ds_read_b128 v[198:201], v3 offset:20480
 ds_read_b128 v[202:205], v3 offset:21504
 ds_read_b128 v[206:209], v3 offset:22528
 ds_read_b128 v[226:229], v3 offset:23552
 ds_read_b128 v[230:233], v3 offset:24576
 ds_read_b128 v[234:237], v3 offset:25600
 ds_read_b128 v[210:213], v109 offset:0
 ds_read_b128 v[214:217], v109 offset:1024
 ds_read_b128 v[218:221], v109 offset:2048
 s_waitcnt lgkmcnt(8)
 v_mfma_f32_16x16x32_bf16 v[194:197], v[130:133], v[198:201], 0
 s_waitcnt lgkmcnt(7)
 v_mfma_f32_16x16x32_bf16 v[194:197], v[134:137], v[202:205], v[194:197]
 s_waitcnt lgkmcnt(6)
 v_mfma_f32_16x16x32_bf16 v[194:197], v[138:141], v[206:209], v[194:197]
 s_waitcnt lgkmcnt(5)
 v_mfma_f32_16x16x32_bf16 v[190:193], v[226:229], v[198:201], v[158:161]
 s_waitcnt lgkmcnt(4)
 v_mfma_f32_16x16x32_bf16 v[190:193], v[230:233], v[202:205], v[190:193]
 s_mov_b32 exec_lo, 0x00ff00ff
 s_mov_b32 exec_hi, 0x00ff00ff
 s_waitcnt lgkmcnt(3)
 v_mfma_f32_16x16x32_bf16 v[190:193], v[234:237], v[206:209], v[190:193]
 buffer_store_dwordx4 v[194:197], v2, s[4:7], s26 offen offset:0
 ds_write_b128 v117, v[194:197] offset:26624
 s_mov_b64 exec, -1
 ds_read_b128 v[222:225], v109 offset:3072
 s_waitcnt lgkmcnt(4)
 v_mfma_f32_16x16x32_bf16 v[226:229], v[210:213], a[240:243], 0
 v_mfma_f32_16x16x32_bf16 v[230:233], v[210:213], v[68:71], 0
 ds_read_b128 v[210:213], v109 offset:4096
 s_waitcnt lgkmcnt(4)
 v_mfma_f32_16x16x32_bf16 v[226:229], v[214:217], a[244:247], v[226:229]
 v_mfma_f32_16x16x32_bf16 v[230:233], v[214:217], v[72:75], v[230:233]
 ds_read_b128 v[214:217], v110 offset:0
 s_waitcnt lgkmcnt(4)
 v_mfma_f32_16x16x32_bf16 v[226:229], v[218:221], a[248:251], v[226:229]
 v_mfma_f32_16x16x32_bf16 v[230:233], v[218:221], v[76:79], v[230:233]
 buffer_load_dword v126, v124, s[4:7], 0 offen sc1
 ds_read_b128 v[218:221], v110 offset:1024
 s_waitcnt lgkmcnt(3)
 v_mfma_f32_16x16x32_bf16 v[226:229], v[222:225], a[252:255], v[226:229]
 v_mfma_f32_16x16x32_bf16 v[230:233], v[222:225], v[80:83], v[230:233]
 ds_read_b128 v[222:225], v110 offset:2048
 s_waitcnt lgkmcnt(3)
 v_mfma_f32_16x16x32_bf16 v[226:229], v[210:213], v[4:7], v[226:229]
 v_mfma_f32_16x16x32_bf16 v[230:233], v[210:213], v[84:87], v[230:233]
 s_barrier
 ds_read_b128 v[234:237], v3 offset:26624
 ds_read_b128 v[238:241], v3 offset:27648
 ds_read_b128 v[210:213], v110 offset:3072
 s_waitcnt lgkmcnt(5)
 v_mfma_f32_16x16x32_bf16 v[226:229], v[214:217], v[8:11], v[226:229]
 v_mfma_f32_16x16x32_bf16 v[230:233], v[214:217], v[88:91], v[230:233]
 ds_read_b128 v[214:217], v110 offset:4096
 s_waitcnt lgkmcnt(5)
 v_mfma_f32_16x16x32_bf16 v[226:229], v[218:221], v[12:15], v[226:229]
 v_mfma_f32_16x16x32_bf16 v[230:233], v[218:221], v[92:95], v[230:233]
 ds_read_b128 v[218:221], v111 offset:0
 s_waitcnt lgkmcnt(5)
 v_mfma_f32_16x16x32_bf16 v[226:229], v[222:225], v[16:19], v[226:229]
 v_mfma_f32_16x16x32_bf16 v[230:233], v[222:225], v[96:99], v[230:233]
 ds_read_b128 v[222:225], v111 offset:1024
 s_waitcnt lgkmcnt(3)
 v_mfma_f32_16x16x32_bf16 v[226:229], v[210:213], v[20:23], v[226:229]
 v_mfma_f32_16x16x32_bf16 v[230:233], v[210:213], v[100:103], v[230:233]
 buffer_load_dwordx4 v[194:197], v2, s[4:7], s27 offen offset:0 sc1
 ds_read_b128 v[210:213], v111 offset:2048
 s_waitcnt lgkmcnt(3)
 v_mfma_f32_16x16x32_bf16 v[226:229], v[214:217], v[24:27], v[226:229]
 v_mfma_f32_16x16x32_bf16 v[230:233], v[214:217], v[104:107], v[230:233]
 ds_read_b128 v[214:217], v111 offset:3072
 s_waitcnt lgkmcnt(3)
 v_mfma_f32_16x16x32_bf16 v[226:229], v[218:221], v[28:31], v[226:229]
 ds_read_b128 v[218:221], v111 offset:4096
 s_waitcnt lgkmcnt(3)
 v_mfma_f32_16x16x32_bf16 v[226:229], v[222:225], v[32:35], v[226:229]
 buffer_load_dwordx4 v[198:201], v2, s[4:7], s27 offen offset:1024 sc1
 ds_read_b128 v[222:225], v112 offset:0
 s_waitcnt lgkmcnt(3)
 v_mfma_f32_16x16x32_bf16 v[226:229], v[210:213], v[36:39], v[226:229]
 ds_read_b128 v[210:213], v112 offset:1024
 s_waitcnt lgkmcnt(3)
 v_mfma_f32_16x16x32_bf16 v[226:229], v[214:217], v[40:43], v[226:229]
 ds_read_b128 v[214:217], v112 offset:2048
 s_waitcnt lgkmcnt(3)
 v_mfma_f32_16x16x32_bf16 v[226:229], v[218:221], v[44:47], v[226:229]
 buffer_load_dwordx4 v[202:205], v2, s[4:7], s27 offen offset:2048 sc1
 ds_read_b128 v[218:221], v112 offset:3072
 s_waitcnt lgkmcnt(3)
 v_mfma_f32_16x16x32_bf16 v[226:229], v[222:225], v[48:51], v[226:229]
 ds_read_b128 v[222:225], v112 offset:4096
 s_waitcnt lgkmcnt(3)
 v_mfma_f32_16x16x32_bf16 v[226:229], v[210:213], v[52:55], v[226:229]
 s_waitcnt lgkmcnt(2)
 v_mfma_f32_16x16x32_bf16 v[226:229], v[214:217], v[56:59], v[226:229]
 s_barrier
 ds_read_b128 v[206:209], v117 offset:28672
 s_waitcnt lgkmcnt(2)
 v_mfma_f32_16x16x32_bf16 v[226:229], v[218:221], v[60:63], v[226:229]
 s_waitcnt vmcnt(3)
 s_mov_b32 s41, 0
 v_min_i32 v1, 64, v125
 v_cmp_ge_i32 vcc, v126, v1
 s_nop 0
 s_cmp_eq_u64 vcc, -1
 s_cbranch_scc1 Lflok_49
Lfl_48:
 s_add_u32 s41, s41, 1
 s_cmp_gt_u32 s41, 200000
 s_cbranch_scc1 L_fail
 buffer_load_dword v126, v124, s[4:7], 0 offen sc1
 s_waitcnt vmcnt(0)
 v_cmp_ge_i32 vcc, v126, v1
 s_nop 0
 s_cmp_eq_u64 vcc, -1
 s_cbranch_scc0 Lfl_48
 buffer_load_dwordx4 v[194:197], v2, s[4:7], s27 offen offset:0 sc1
 buffer_load_dwordx4 v[198:201], v2, s[4:7], s27 offen offset:1024 sc1
 buffer_load_dwordx4 v[202:205], v2, s[4:7], s27 offen offset:2048 sc1
Lflok_49:
 v_add_u32 v125, 1, v125
 s_waitcnt lgkmcnt(1)
 v_mfma_f32_16x16x32_bf16 v[226:229], v[222:225], v[64:67], v[226:229]
 s_mov_b32 s41, 0
Lf_50:
 s_waitcnt vmcnt(2)
 v_add_f32 v210, v234, v194
 v_add_f32 v211, v235, v195
 v_add_f32 v212, v236, v196
 v_add_f32 v213, v237, v197
 s_waitcnt vmcnt(1)
 v_add_f32 v214, v238, v198
 v_add_f32 v215, v239, v199
 v_add_f32 v216, v240, v200
 v_add_f32 v217, v241, v201
 v_maximum3_f32 v1, v210, v211, v212
 v_maximum3_f32 v127, v213, v214, v215
 v_maximum3_f32 v1, v1, v216, v217
 s_waitcnt vmcnt(0)
 v_add_f32 v218, v190, v202
 v_add_f32 v219, v191, v203
 v_add_f32 v220, v192, v204
 v_add_f32 v221, v193, v205
 v_maximum3_f32 v127, v127, v218, v219
 v_maximum3_f32 v1, v1, v220, v221
 v_maximum3_f32 v1, v1, v127, v127
 v_cmp_u_f32 vcc, v1, v1
 v_mov_b32 v127, v1
 s_cbranch_vccnz Lfs_51
Lfok_52:
 s_nop 0
 v_permlane32_swap_b32 v1, v127
 v_max_f32 v1, v1, v127
 v_mov_b32 v127, v1
 v_cvt_pk_bf16_f32 v178, v226, v227
 v_cvt_pk_bf16_f32 v179, v228, v229
 v_permlane16_swap_b32 v1, v127
 v_max_f32 v1, v1, v127
 v_mul_f32 v1, s71, v1
 v_fma_f32 v210, v210, s71, -v1
 v_fma_f32 v211, v211, s71, -v1
 v_fma_f32 v212, v212, s71, -v1
 v_fma_f32 v213, v213, s71, -v1
 v_fma_f32 v214, v214, s71, -v1
 v_fma_f32 v215, v215, s71, -v1
 v_fma_f32 v216, v216, s71, -v1
 v_fma_f32 v217, v217, s71, -v1
 v_fma_f32 v218, v218, s71, -v1
 v_fma_f32 v219, v219, s71, -v1
 v_fma_f32 v220, v220, s71, -v1
 v_fma_f32 v221, v221, s71, -v1
 v_exp_f32 v210, v210
 v_exp_f32 v211, v211
 v_exp_f32 v212, v212
 v_exp_f32 v213, v213
 v_exp_f32 v214, v214
 v_exp_f32 v215, v215
 v_exp_f32 v216, v216
 v_exp_f32 v217, v217
 s_mov_b32 exec_lo, 0x00ff00ff
 s_mov_b32 exec_hi, 0x00ff00ff
 v_cvt_pk_bf16_f32 v162, v210, v211
 v_cvt_pk_bf16_f32 v163, v212, v213
 v_cvt_pk_bf16_f32 v164, v214, v215
 v_cvt_pk_bf16_f32 v165, v216, v217
 s_not_b64 exec, exec
 v_cvt_pk_bf16_f32 v166, v210, v211
 v_cvt_pk_bf16_f32 v167, v212, v213
 v_cvt_pk_bf16_f32 v168, v214, v215
 v_cvt_pk_bf16_f32 v169, v216, v217
 s_mov_b64 exec, -1
 v_mfma_f32_16x16x32_bf16 v[200:203], v[186:189], v[162:165], 0
 v_exp_f32 v218, v218
 v_exp_f32 v219, v219
 v_mfma_f32_16x16x32_bf16 v[192:195], v[142:145], v[162:165], 0
 v_exp_f32 v220, v220
 v_mfma_f32_16x16x32_bf16 v[196:199], v[146:149], v[162:165], 0
 v_exp_f32 v221, v221
 v_mfma_f32_16x16x32_bf16 v[200:203], v[186:189], v[166:169], v[200:203]
 v_cvt_pk_bf16_f32 v190, v218, v219
 v_cvt_pk_bf16_f32 v191, v220, v221
 s_waitcnt lgkmcnt(0)
 v_mfma_f32_16x16x32_bf16 v[192:195], v[150:153], v[166:169], v[192:195]
 v_add_f32 v230, v230, v206
 v_add_f32 v231, v231, v207
 v_add_f32 v232, v232, v208
 v_mfma_f32_16x16x32_bf16 v[196:199], v[154:157], v[166:169], v[196:199]
 v_add_f32 v233, v233, v209
 v_cvt_pk_bf16_f32 v180, v230, v231
 v_cvt_pk_bf16_f32 v181, v232, v233
 v_mfma_f32_16x16x16_bf16 v[200:203], v[186:187], v[190:191], v[200:203]
 s_add_u32 s25, s61, s55
 s_add_u32 s27, s61, s56
 v_mfma_f32_16x16x16_bf16 v[192:195], v[178:179], v[190:191], v[192:195]
 s_add_u32 s28, s27, 4096
 v_mfma_f32_16x16x16_bf16 v[196:199], v[180:181], v[190:191], v[196:199]
 s_mov_b32 s41, 0
 s_nop 0
 v_rcp_f32 v127, v200
 s_nop 1
 v_mul_f32 v192, v192, v127
 v_mul_f32 v193, v193, v127
 v_mul_f32 v194, v194, v127
 v_mul_f32 v195, v195, v127
 v_cvt_pk_bf16_f32 v204, v192, v193
 v_cvt_pk_bf16_f32 v205, v194, v195
 v_mul_f32 v196, v196, v127
 v_mul_f32 v197, v197, v127
 v_mul_f32 v198, v198, v127
 v_mul_f32 v199, v199, v127
 v_cvt_pk_bf16_f32 v206, v196, v197
 v_cvt_pk_bf16_f32 v207, v198, v199
 buffer_store_dwordx4 v[204:207], v2, s[4:7], s25 offen
 ds_write_b64 v118, v[178:179] offset:0
 ds_write_b64 v118, v[180:181] offset:2048
 ds_read_b128 v[142:145], v115 offset:0
 ds_read_b128 v[146:149], v115 offset:1024
 ds_read_b128 v[150:153], v115 offset:2048
 ds_read_b128 v[154:157], v115 offset:3072
 ds_read_b128 v[234:237], v115 offset:4096
 ds_read_b128 v[238:241], v115 offset:5120
 ds_read_b128 v[242:245], v115 offset:6144
 ds_read_b128 v[246:249], v115 offset:7168
 ds_read_b128 v[250:253], v115 offset:8192
 s_sleep 2
 buffer_load_dwordx4 v[190:193], v2, s[4:7], s27 offen offset:0 sc1
 buffer_load_dwordx4 v[194:197], v2, s[4:7], s27 offen offset:1024 sc1
 buffer_load_dwordx4 v[198:201], v2, s[4:7], s27 offen offset:2048 sc1
 buffer_load_dwordx4 v[202:205], v2, s[4:7], s27 offen offset:3072 sc1
 buffer_load_dwordx4 v[206:209], v2, s[4:7], s28 offen offset:0 sc1
 buffer_load_dwordx4 v[210:213], v2, s[4:7], s28 offen offset:1024 sc1
 s_waitcnt lgkmcnt(0)
Lo_53:
 s_waitcnt vmcnt(5)
 v_max3_u32 v1, v190, v191, v192
 v_max_u32 v1, v1, v193
 v_cmp_eq_u32 vcc, -1, v1
 s_cbranch_vccnz Los_54
 v_mfma_f32_16x16x32_bf16 v[214:217], v[142:145], v[190:193], 0
 ds_read_b128 v[142:145], v115 offset:9216
 v_mfma_f32_16x16x32_bf16 v[218:221], v[146:149], v[190:193], 0
 ds_read_b128 v[146:149], v115 offset:10240
 s_waitcnt vmcnt(4)
 v_max3_u32 v1, v194, v195, v196
 v_mfma_f32_16x16x32_bf16 v[222:225], v[150:153], v[190:193], 0
 ds_read_b128 v[150:153], v115 offset:11264
 v_max_u32 v1, v1, v197
 v_mfma_f32_16x16x32_bf16 v[226:229], v[154:157], v[190:193], 0
 ds_read_b128 v[154:157], v115 offset:12288
 v_cmp_eq_u32 vcc, -1, v1
 v_mfma_f32_16x16x32_bf16 v[230:233], v[234:237], v[190:193], 0
 ds_read_b128 v[234:237], v115 offset:13312
Lo_55:
 s_cbranch_vccnz Los_56
 v_mfma_f32_16x16x32_bf16 v[214:217], v[238:241], v[194:197], v[214:217]
 ds_read_b128 v[238:241], v115 offset:14336
 v_mfma_f32_16x16x32_bf16 v[218:221], v[242:245], v[194:197], v[218:221]
 ds_read_b128 v[242:245], v116 offset:0
 s_waitcnt vmcnt(3)
 v_max3_u32 v1, v198, v199, v200
 v_mfma_f32_16x16x32_bf16 v[222:225], v[246:249], v[194:197], v[222:225]
 ds_read_b128 v[246:249], v116 offset:1024
 v_max_u32 v1, v1, v201
 v_mfma_f32_16x16x32_bf16 v[226:229], v[250:253], v[194:197], v[226:229]
 ds_read_b128 v[250:253], v116 offset:2048
 v_cmp_eq_u32 vcc, -1, v1
 s_waitcnt lgkmcnt(7)
 v_mfma_f32_16x16x32_bf16 v[230:233], v[142:145], v[194:197], v[230:233]
 ds_read_b128 v[142:145], v116 offset:3072
Lo_57:
 s_cbranch_vccnz Los_58
 v_mfma_f32_16x16x32_bf16 v[214:217], v[146:149], v[198:201], v[214:217]
 ds_read_b128 v[146:149], v116 offset:4096
 s_waitcnt lgkmcnt(7)
 v_mfma_f32_16x16x32_bf16 v[218:221], v[150:153], v[198:201], v[218:221]
 ds_read_b128 v[150:153], v116 offset:5120
 s_waitcnt vmcnt(2)
 v_max3_u32 v1, v202, v203, v204
 v_mfma_f32_16x16x32_bf16 v[222:225], v[154:157], v[198:201], v[222:225]
 ds_read_b128 v[154:157], v116 offset:6144
 v_max_u32 v1, v1, v205
 s_waitcnt lgkmcnt(7)
 v_mfma_f32_16x16x32_bf16 v[226:229], v[234:237], v[198:201], v[226:229]
 ds_read_b128 v[234:237], v116 offset:7168
 v_cmp_eq_u32 vcc, -1, v1
 v_mfma_f32_16x16x32_bf16 v[230:233], v[238:241], v[198:201], v[230:233]
 ds_read_b128 v[238:241], v116 offset:8192
Lo_59:
 s_cbranch_vccnz Los_60
 s_waitcnt lgkmcnt(7)
 v_mfma_f32_16x16x32_bf16 v[214:217], v[242:245], v[202:205], v[214:217]
 ds_read_b128 v[242:245], v116 offset:9216
 v_mfma_f32_16x16x32_bf16 v[218:221], v[246:249], v[202:205], v[218:221]
 ds_read_b128 v[246:249], v116 offset:10240
 s_waitcnt vmcnt(1)
 v_max3_u32 v1, v206, v207, v208
 s_waitcnt lgkmcnt(7)
 v_mfma_f32_16x16x32_bf16 v[222:225], v[250:253], v[202:205], v[222:225]
 ds_read_b128 v[250:253], v116 offset:11264
 v_max_u32 v1, v1, v209
 v_mfma_f32_16x16x32_bf16 v[226:229], v[142:145], v[202:205], v[226:229]
 ds_read_b128 v[142:145], v116 offset:12288
 v_cmp_eq_u32 vcc, -1, v1
 s_waitcnt lgkmcnt(7)
 v_mfma_f32_16x16x32_bf16 v[230:233], v[146:149], v[202:205], v[230:233]
 ds_read_b128 v[146:149], v116 offset:13312
Lo_61:
 s_cbranch_vccnz Los_62
 v_mfma_f32_16x16x32_bf16 v[214:217], v[150:153], v[206:209], v[214:217]
 ds_read_b128 v[150:153], v116 offset:14336
 s_waitcnt lgkmcnt(7)
 v_mfma_f32_16x16x32_bf16 v[218:221], v[154:157], v[206:209], v[218:221]
 s_waitcnt vmcnt(0)
 v_max3_u32 v1, v210, v211, v212
 v_mfma_f32_16x16x32_bf16 v[222:225], v[234:237], v[206:209], v[222:225]
 v_max_u32 v1, v1, v213
 s_waitcnt lgkmcnt(5)
 v_mfma_f32_16x16x32_bf16 v[226:229], v[238:241], v[206:209], v[226:229]
 v_cmp_eq_u32 vcc, -1, v1
 v_mfma_f32_16x16x32_bf16 v[230:233], v[242:245], v[206:209], v[230:233]
Lo_63:
 s_cbranch_vccnz Los_64
 s_waitcnt lgkmcnt(3)
 v_mfma_f32_16x16x32_bf16 v[214:217], v[246:249], v[210:213], v[214:217]
 buffer_load_dwordx4 v[130:133], v2, s[4:7], s67 offen sc1
 v_mfma_f32_16x16x32_bf16 v[218:221], v[250:253], v[210:213], v[218:221]
 buffer_load_dwordx4 v[134:137], v2, s[4:7], s67 offen offset:2048 sc1
 s_waitcnt lgkmcnt(1)
 v_mfma_f32_16x16x32_bf16 v[222:225], v[142:145], v[210:213], v[222:225]
 s_add_u32 s25, s67, 4096
 buffer_load_dwordx4 v[138:141], v2, s[4:7], s25 offen sc1
 v_mfma_f32_16x16x32_bf16 v[226:229], v[146:149], v[210:213], v[226:229]
 s_waitcnt lgkmcnt(0)
 v_mfma_f32_16x16x32_bf16 v[230:233], v[150:153], v[210:213], v[230:233]
 v_cvt_pk_bf16_f32 v190, v214, v215
 v_cvt_pk_bf16_f32 v191, v216, v217
 v_cvt_pk_bf16_f32 v192, v218, v219
 v_cvt_pk_bf16_f32 v193, v220, v221
 ds_write_b128 v119, v[190:193]
 v_cvt_pk_bf16_f32 v194, v222, v223
 v_cvt_pk_bf16_f32 v195, v224, v225
 v_cvt_pk_bf16_f32 v196, v226, v227
 v_cvt_pk_bf16_f32 v197, v228, v229
 ds_write_b128 v119, v[194:197] offset:4096
 v_cvt_pk_bf16_f32 v198, v230, v231
 v_cvt_pk_bf16_f32 v199, v232, v233
 ds_write_b64 v120, v[198:199] offset:8192
 s_add_u32 s25, s63, s46
 s_add_u32 s26, s63, s47
 s_add_u32 s27, s25, 655360
 s_add_u32 s28, s26, 655360
 s_waitcnt lgkmcnt(0)
 s_barrier
 ds_read_b128 v[190:193], v121 offset:0
 ds_read_b128 v[194:197], v121 offset:1024
 s_waitcnt lgkmcnt(1)
 v_mfma_f32_16x16x32_bf16 v[206:209], v[170:173], v[190:193], 0
 s_waitcnt lgkmcnt(0)
 v_mfma_f32_16x16x32_bf16 v[206:209], v[174:177], v[194:197], v[206:209]
 s_nop 7
 v_cvt_pk_bf16_f32 v214, v206, v207
 v_cvt_pk_bf16_f32 v215, v208, v209
 buffer_store_dwordx2 v[214:215], v122, s[4:7], s25 offen sc1
 buffer_store_dwordx2 v[214:215], v122, s[4:7], s27 offen
 s_add_u32 s27, s63, s48
 s_add_u32 s28, s63, s49
 s_add_u32 s70, s31, 1
 s_and_b32 s25, s70, 3
 s_mul_i32 s26, s25, 20480
 s_add_u32 s57, s26, s42
 s_add_u32 s58, s57, 4096
 s_add_u32 s59, s26, s43
 s_mul_i32 s63, s25, 163840
 s_xor_b32 s26, s25, 2
 s_mul_i32 s64, s26, 163840
 s_add_u32 s25, s25, 3
 s_and_b32 s25, s25, 3
 s_mul_i32 s26, s25, 20480
 s_add_u32 s60, s26, s43
 s_and_b32 s25, s70, 1
 s_mul_i32 s61, s25, 196608
 s_xor_b32 s25, s25, 1
 s_mul_i32 s62, s25, 196608
 s_mul_i32 s70, s70, 196608
 s_sleep 6
 s_mov_b32 s41, 0
 buffer_load_dwordx4 v[190:193], v2, s[4:7], s27 offen sc1
 buffer_load_dwordx4 v[194:197], v2, s[4:7], s28 offen sc1
Lj_66:
 s_waitcnt vmcnt(1)
 v_mfma_f32_16x16x32_bf16 v[198:201], v[170:173], v[190:193], 0
 s_waitcnt vmcnt(0)
 v_mfma_f32_16x16x32_bf16 v[198:201], v[170:173], v[194:197], v[198:201]
 v_max3_u32 v202, v190, v191, v192
 v_max3_u32 v202, v202, v193, v194
 v_max3_u32 v202, v202, v195, v196
 v_max_u32 v202, v202, v197
 v_cmp_eq_u32 vcc, -1, v202
 s_cbranch_vccnz Ljs_67
 s_nop 1
 v_cvt_pk_bf16_f32 v202, v198, v199
 v_cvt_pk_bf16_f32 v203, v200, v201
 s_mov_b64 exec, 0xffffffff
 s_cmp_eq_u32 s31, 7
 s_cbranch_scc1 Lov_68
Lnov_69:
 buffer_store_dwordx2 v[202:203], v123, s[4:7], s59 offen
 buffer_store_dwordx2 v[182:183], v123, s[4:7], s60 offen
 s_mov_b64 exec, -1
Lnr_65:
 s_add_u32 s31, s31, 1
 s_cmp_lt_u32 s31, 72
 s_barrier
 s_cbranch_scc1 L_rec_top_0l
 s_waitcnt vmcnt(0)
 s_barrier
 s_mov_b64 exec, 1
 v_mov_b32 v1, s31
 buffer_store_dword v1, off, s[4:7], s54 sc1
 s_mov_b64 exec, -1
 s_endpgm
Lzs_39:
 buffer_load_dwordx4 v[190:193], v2, s[4:7], s57 offen offset:0 sc1
 buffer_load_dwordx4 v[194:197], v2, s[4:7], s57 offen offset:1024 sc1
 buffer_load_dwordx4 v[198:201], v2, s[4:7], s57 offen offset:2048 sc1
 buffer_load_dwordx4 v[202:205], v2, s[4:7], s57 offen offset:3072 sc1
 buffer_load_dwordx4 v[206:209], v2, s[4:7], s58 offen offset:0 sc1
 s_add_u32 s41, s41, 1
 s_cmp_gt_u32 s41, 200000
 s_cbranch_scc1 L_fail
 s_branch Lz_38
Lzs_41:
 buffer_load_dwordx4 v[194:197], v2, s[4:7], s57 offen offset:1024 sc1
 buffer_load_dwordx4 v[198:201], v2, s[4:7], s57 offen offset:2048 sc1
 buffer_load_dwordx4 v[202:205], v2, s[4:7], s57 offen offset:3072 sc1
 buffer_load_dwordx4 v[206:209], v2, s[4:7], s58 offen offset:0 sc1
 s_add_u32 s41, s41, 1
 s_cmp_gt_u32 s41, 200000
 s_cbranch_scc1 L_fail
 s_branch Lz_40
Lzs_43:
 buffer_load_dwordx4 v[198:201], v2, s[4:7], s57 offen offset:2048 sc1
 buffer_load_dwordx4 v[202:205], v2, s[4:7], s57 offen offset:3072 sc1
 buffer_load_dwordx4 v[206:209], v2, s[4:7], s58 offen offset:0 sc1
 s_add_u32 s41, s41, 1
 s_cmp_gt_u32 s41, 200000
 s_cbranch_scc1 L_fail
 s_branch Lz_42
Lzs_45:
 buffer_load_dwordx4 v[202:205], v2, s[4:7], s57 offen offset:3072 sc1
 buffer_load_dwordx4 v[206:209], v2, s[4:7], s58 offen offset:0 sc1
 s_add_u32 s41, s41, 1
 s_cmp_gt_u32 s41, 200000
 s_cbranch_scc1 L_fail
 s_branch Lz_44
Lzs_47:
 buffer_load_dwordx4 v[206:209], v2, s[4:7], s58 offen offset:0 sc1
 s_add_u32 s41, s41, 1
 s_cmp_gt_u32 s41, 200000
 s_cbranch_scc1 L_fail
 s_branch Lz_46
Lfs_51:
 v_max3_u32 v222, v194, v195, v196
 v_max3_u32 v222, v222, v197, v198
 v_max3_u32 v222, v222, v199, v200
 v_max3_u32 v222, v222, v201, v202
 v_max3_u32 v222, v222, v203, v204
 v_max_u32 v222, v222, v205
 v_cmp_eq_u32 vcc, -1, v222
 s_cbranch_vccz Lfok_52
 buffer_load_dwordx4 v[194:197], v2, s[4:7], s27 offen offset:0 sc1
 buffer_load_dwordx4 v[198:201], v2, s[4:7], s27 offen offset:1024 sc1
 buffer_load_dwordx4 v[202:205], v2, s[4:7], s27 offen offset:2048 sc1
 s_add_u32 s41, s41, 1
 s_cmp_gt_u32 s41, 200000
 s_cbranch_scc1 L_fail
 s_branch Lf_50
Los_54:
 buffer_load_dwordx4 v[190:193], v2, s[4:7], s27 offen offset:0 sc1
 buffer_load_dwordx4 v[194:197], v2, s[4:7], s27 offen offset:1024 sc1
 buffer_load_dwordx4 v[198:201], v2, s[4:7], s27 offen offset:2048 sc1
 buffer_load_dwordx4 v[202:205], v2, s[4:7], s27 offen offset:3072 sc1
 buffer_load_dwordx4 v[206:209], v2, s[4:7], s28 offen offset:0 sc1
 buffer_load_dwordx4 v[210:213], v2, s[4:7], s28 offen offset:1024 sc1
 s_add_u32 s41, s41, 1
 s_cmp_gt_u32 s41, 200000
 s_cbranch_scc1 L_fail
 s_branch Lo_53
Los_56:
 buffer_load_dwordx4 v[194:197], v2, s[4:7], s27 offen offset:1024 sc1
 buffer_load_dwordx4 v[198:201], v2, s[4:7], s27 offen offset:2048 sc1
 buffer_load_dwordx4 v[202:205], v2, s[4:7], s27 offen offset:3072 sc1
 buffer_load_dwordx4 v[206:209], v2, s[4:7], s28 offen offset:0 sc1
 buffer_load_dwordx4 v[210:213], v2, s[4:7], s28 offen offset:1024 sc1
 s_waitcnt vmcnt(4)
 v_max3_u32 v1, v194, v195, v196
 v_max_u32 v1, v1, v197
 v_cmp_eq_u32 vcc, -1, v1
 s_add_u32 s41, s41, 1
 s_cmp_gt_u32 s41, 200000
 s_cbranch_scc1 L_fail
 s_branch Lo_55
Los_58:
 buffer_load_dwordx4 v[198:201], v2, s[4:7], s27 offen offset:2048 sc1
 buffer_load_dwordx4 v[202:205], v2, s[4:7], s27 offen offset:3072 sc1
 buffer_load_dwordx4 v[206:209], v2, s[4:7], s28 offen offset:0 sc1
 buffer_load_dwordx4 v[210:213], v2, s[4:7], s28 offen offset:1024 sc1
 s_waitcnt vmcnt(3)
 v_max3_u32 v1, v198, v199, v200
 v_max_u32 v1, v1, v201
 v_cmp_eq_u32 vcc, -1, v1
 s_add_u32 s41, s41, 1
 s_cmp_gt_u32 s41, 200000
 s_cbranch_scc1 L_fail
 s_branch Lo_57
Los_60:
 buffer_load_dwordx4 v[202:205], v2, s[4:7], s27 offen offset:3072 sc1
 buffer_load_dwordx4 v[206:209], v2, s[4:7], s28 offen offset:0 sc1
 buffer_load_dwordx4 v[210:213], v2, s[4:7], s28 offen offset:1024 sc1
 s_waitcnt vmcnt(2)
 v_max3_u32 v1, v202, v203, v204
 v_max_u32 v1, v1, v205
 v_cmp_eq_u32 vcc, -1, v1
 s_add_u32 s41, s41, 1
 s_cmp_gt_u32 s41, 200000
 s_cbranch_scc1 L_fail
 s_branch Lo_59
Los_62:
 buffer_load_dwordx4 v[206:209], v2, s[4:7], s28 offen offset:0 sc1
 buffer_load_dwordx4 v[210:213], v2, s[4:7], s28 offen offset:1024 sc1
 s_waitcnt vmcnt(1)
 v_max3_u32 v1, v206, v207, v208
 v_max_u32 v1, v1, v209
 v_cmp_eq_u32 vcc, -1, v1
 s_add_u32 s41, s41, 1
 s_cmp_gt_u32 s41, 200000
 s_cbranch_scc1 L_fail
 s_branch Lo_61
Los_64:
 buffer_load_dwordx4 v[210:213], v2, s[4:7], s28 offen offset:1024 sc1
 s_waitcnt vmcnt(0)
 v_max3_u32 v1, v210, v211, v212
 v_max_u32 v1, v1, v213
 v_cmp_eq_u32 vcc, -1, v1
 s_add_u32 s41, s41, 1
 s_cmp_gt_u32 s41, 200000
 s_cbranch_scc1 L_fail
 s_branch Lo_63
Ljs_67:
 buffer_load_dwordx4 v[190:193], v2, s[4:7], s27 offen sc1
 buffer_load_dwordx4 v[194:197], v2, s[4:7], s28 offen sc1
 s_add_u32 s41, s41, 1
 s_cmp_gt_u32 s41, 200000
 s_cbranch_scc1 L_fail
 s_branch Lj_66
Lov_68:
 s_mov_b32 exec_lo, 0xff00ff00
 v_mov_b32 v202, v128
 v_mov_b32 v203, v129
 s_mov_b32 exec_lo, -1
 s_add_u32 s41, s41, 1
 s_cmp_gt_u32 s41, 200000
 s_cbranch_scc1 L_fail
 s_branch Lnov_69
Lpwn_36:
 s_cmp_eq_u32 s3, 1
 s_cbranch_scc0 Lpwn_71
 s_waitcnt vmcnt(0)
 s_cmp_eq_u32 s40, 0
 s_cbranch_scc1 Lz0_72
 s_mov_b64 exec, 0xffffffff
 buffer_store_dwordx2 v[128:129], v123, s[4:7], s43 offen
 s_mov_b64 exec, -1
Lz0_72:
 s_barrier
L_rec_top_1l:
 s_sleep 2
 buffer_load_dwordx4 v[190:193], v2, s[4:7], s57 offen offset:0 sc1
 buffer_load_dwordx4 v[194:197], v2, s[4:7], s57 offen offset:1024 sc1
 buffer_load_dwordx4 v[198:201], v2, s[4:7], s57 offen offset:2048 sc1
 buffer_load_dwordx4 v[202:205], v2, s[4:7], s57 offen offset:3072 sc1
 buffer_load_dwordx4 v[206:209], v2, s[4:7], s58 offen offset:0 sc1
 s_mov_b32 s41, 0
Lz_73:
 s_waitcnt vmcnt(4)
 ds_write_b128 v109, v[190:193] offset:0
 v_mfma_f32_16x16x32_bf16 v[226:229], a[0:3], v[190:193], 0
 v_max3_u32 v1, v190, v191, v192
 v_max_u32 v1, v1, v193
 v_mfma_f32_16x16x32_bf16 v[230:233], a[80:83], v[190:193], 0
 v_cmp_eq_u32 vcc, -1, v1
 v_mfma_f32_16x16x32_bf16 v[234:237], a[160:163], v[190:193], 0
 s_cbranch_vccnz Lzs_74
Lz_75:
 s_waitcnt vmcnt(3)
 ds_write_b128 v109, v[194:197] offset:1024
 v_max3_u32 v1, v194, v195, v196
 v_max_u32 v1, v1, v197
 v_cmp_eq_u32 vcc, -1, v1
 s_cbranch_vccnz Lzs_76
 v_mfma_f32_16x16x32_bf16 v[226:229], a[4:7], v[194:197], v[226:229]
 v_mfma_f32_16x16x32_bf16 v[230:233], a[84:87], v[194:197], v[230:233]
 v_mfma_f32_16x16x32_bf16 v[234:237], a[164:167], v[194:197], v[234:237]
Lz_77:
 s_waitcnt vmcnt(2)
 ds_write_b128 v109, v[198:201] offset:2048
 v_max3_u32 v1, v198, v199, v200
 v_max_u32 v1, v1, v201
 v_cmp_eq_u32 vcc, -1, v1
 s_cbranch_vccnz Lzs_78
 v_mfma_f32_16x16x32_bf16 v[226:229], a[8:11], v[198:201], v[226:229]
 v_mfma_f32_16x16x32_bf16 v[230:233], a[88:91], v[198:201], v[230:233]
 v_mfma_f32_16x16x32_bf16 v[234:237], a[168:171], v[198:201], v[234:237]
Lz_79:
 s_waitcnt vmcnt(1)
 ds_write_b128 v109, v[202:205] offset:3072
 v_max3_u32 v1, v202, v203, v204
 v_max_u32 v1, v1, v205
 v_cmp_eq_u32 vcc, -1, v1
 s_cbranch_vccnz Lzs_80
Lz_81:
 s_waitcnt vmcnt(0)
 ds_write_b128 v109, v[206:209] offset:4096
 v_max3_u32 v1, v206, v207, v208
 v_max_u32 v1, v1, v209
 v_cmp_eq_u32 vcc, -1, v1
 s_cbranch_vccnz Lzs_82
 s_waitcnt lgkmcnt(0)
 s_barrier
 ds_read_b128 v[214:217], v110 offset:0
 ds_read_b128 v[218:221], v110 offset:1024
 ds_read_b128 v[222:225], v110 offset:2048
 v_mfma_f32_16x16x32_bf16 v[226:229], a[12:15], v[202:205], v[226:229]
 s_add_u32 s25, s68, s51
 v_mfma_f32_16x16x32_bf16 v[230:233], a[92:95], v[202:205], v[230:233]
 buffer_load_dwordx4 v[142:145], v2, s[4:7], s25 offen sc1
 v_mfma_f32_16x16x32_bf16 v[234:237], a[172:175], v[202:205], v[234:237]
 v_mfma_f32_16x16x32_bf16 v[226:229], a[16:19], v[206:209], v[226:229]
 s_add_u32 s25, s68, s52
 v_mfma_f32_16x16x32_bf16 v[230:233], a[96:99], v[206:209], v[230:233]
 buffer_load_dwordx4 v[146:149], v2, s[4:7], s25 offen sc1
 v_mfma_f32_16x16x32_bf16 v[234:237], a[176:179], v[206:209], v[234:237]
 ds_read_b128 v[210:213], v110 offset:3072
 s_waitcnt lgkmcnt(3)
 v_mfma_f32_16x16x32_bf16 v[226:229], a[20:23], v[214:217], v[226:229]
 s_add_u32 s25, s69, s51
 v_mfma_f32_16x16x32_bf16 v[230:233], a[100:103], v[214:217], v[230:233]
 buffer_load_dwordx4 v[150:153], v2, s[4:7], s25 offen sc1
 v_mfma_f32_16x16x32_bf16 v[234:237], a[180:183], v[214:217], v[234:237]
 ds_read_b128 v[214:217], v110 offset:4096
 s_waitcnt lgkmcnt(3)
 v_mfma_f32_16x16x32_bf16 v[226:229], a[24:27], v[218:221], v[226:229]
 s_add_u32 s25, s69, s52
 v_mfma_f32_16x16x32_bf16 v[230:233], a[104:107], v[218:221], v[230:233]
 buffer_load_dwordx4 v[154:157], v2, s[4:7], s25 offen sc1
 v_mfma_f32_16x16x32_bf16 v[234:237], a[184:187], v[218:221], v[234:237]
 ds_read_b128 v[218:221], v111 offset:0
 s_waitcnt lgkmcnt(3)
 v_mfma_f32_16x16x32_bf16 v[226:229], a[28:31], v[222:225], v[226:229]
 s_add_u32 s25, s44, s62
 v_mfma_f32_16x16x32_bf16 v[230:233], a[108:111], v[222:225], v[230:233]
 buffer_store_dwordx4 v[182:185], v2, s[4:7], s25 offen offset:0
 v_mfma_f32_16x16x32_bf16 v[234:237], a[188:191], v[222:225], v[234:237]
 ds_read_b128 v[222:225], v111 offset:1024
 s_waitcnt lgkmcnt(3)
 v_mfma_f32_16x16x32_bf16 v[226:229], a[32:35], v[210:213], v[226:229]
 s_add_u32 s25, s44, s62
 v_mfma_f32_16x16x32_bf16 v[230:233], a[112:115], v[210:213], v[230:233]
 s_add_u32 s25, s25, 1867776
 v_mfma_f32_16x16x32_bf16 v[234:237], a[192:195], v[210:213], v[234:237]
 buffer_store_dwordx4 v[182:185], v2, s[4:7], s25 offen offset:0
 ds_read_b128 v[210:213], v111 offset:2048
 s_waitcnt lgkmcnt(3)
 v_mfma_f32_16x16x32_bf16 v[226:229], a[36:39], v[214:217], v[226:229]
 s_add_u32 s25, s46, s64
 v_mfma_f32_16x16x32_bf16 v[230:233], a[116:119], v[214:217], v[230:233]
 buffer_store_dwordx2 v[182:183], v122, s[4:7], s25 offen sc1
 v_mfma_f32_16x16x32_bf16 v[234:237], a[196:199], v[214:217], v[234:237]
 ds_read_b128 v[214:217], v111 offset:3072
 s_waitcnt lgkmcnt(3)
 v_mfma_f32_16x16x32_bf16 v[226:229], a[40:43], v[218:221], v[226:229]
 s_add_u32 s25, s25, 655360
 v_mfma_f32_16x16x32_bf16 v[230:233], a[120:123], v[218:221], v[230:233]
 buffer_store_dwordx2 v[182:183], v122, s[4:7], s25 offen
 v_mfma_f32_16x16x32_bf16 v[234:237], a[200:203], v[218:221], v[234:237]
 ds_read_b128 v[218:221], v111 offset:4096
 s_waitcnt lgkmcnt(3)
 v_mfma_f32_16x16x32_bf16 v[226:229], a[44:47], v[222:225], v[226:229]
 s_add_u32 s25, s31, 1
 s_mul_i32 s68, s25, 393216
 v_mfma_f32_16x16x32_bf16 v[230:233], a[124:127], v[222:225], v[230:233]
 s_add_u32 s68, s68, 84066304
 s_cmp_lt_u32 s25, 64
 v_mfma_f32_16x16x32_bf16 v[234:237], a[204:207], v[222:225], v[234:237]
 s_cselect_b32 s68, s68, 2146435072
 ds_read_b128 v[222:225], v112 offset:0
 s_waitcnt lgkmcnt(3)
 v_mfma_f32_16x16x32_bf16 v[226:229], a[48:51], v[210:213], v[226:229]
 s_sub_u32 s26, s25, 8
 s_mul_i32 s69, s26, 393216
 v_mfma_f32_16x16x32_bf16 v[230:233], a[128:131], v[210:213], v[230:233]
 s_add_u32 s69, s69, 134397952
 s_cmp_lt_u32 s26, 64
 v_mfma_f32_16x16x32_bf16 v[234:237], a[208:211], v[210:213], v[234:237]
 s_cselect_b32 s69, s69, 2146435072
 ds_read_b128 v[210:213], v112 offset:1024
 s_waitcnt lgkmcnt(3)
 v_mfma_f32_16x16x32_bf16 v[226:229], a[52:55], v[214:217], v[226:229]
 s_add_u32 s25, s68, 4269801472
 s_add_u32 s26, s69, 4269801472
 v_mfma_f32_16x16x32_bf16 v[230:233], a[132:135], v[214:217], v[230:233]
 s_cmp_lt_u32 s3, 2
 s_cselect_b32 s67, s25, s26
 v_mfma_f32_16x16x32_bf16 v[234:237], a[212:215], v[214:217], v[234:237]
 s_add_u32 s67, s67, s50
 ds_read_b128 v[214:217], v112 offset:2048
 s_waitcnt lgkmcnt(3)
 v_mfma_f32_16x16x32_bf16 v[226:229], a[56:59], v[218:221], v[226:229]
 v_mfma_f32_16x16x32_bf16 v[230:233], a[136:139], v[218:221], v[230:233]
 v_mfma_f32_16x16x32_bf16 v[234:237], a[216:219], v[218:221], v[234:237]
 ds_read_b128 v[218:221], v112 offset:3072
 s_waitcnt lgkmcnt(3)
 v_mfma_f32_16x16x32_bf16 v[226:229], a[60:63], v[222:225], v[226:229]
 v_mfma_f32_16x16x32_bf16 v[230:233], a[140:143], v[222:225], v[230:233]
 v_mfma_f32_16x16x32_bf16 v[234:237], a[220:223], v[222:225], v[234:237]
 ds_read_b128 v[222:225], v112 offset:4096
 s_waitcnt lgkmcnt(3)
 v_mfma_f32_16x16x32_bf16 v[226:229], a[64:67], v[210:213], v[226:229]
 v_mfma_f32_16x16x32_bf16 v[230:233], a[144:147], v[210:213], v[230:233]
 v_mfma_f32_16x16x32_bf16 v[234:237], a[224:227], v[210:213], v[234:237]
 s_waitcnt lgkmcnt(2)
 v_mfma_f32_16x16x32_bf16 v[226:229], a[68:71], v[214:217], v[226:229]
 v_mfma_f32_16x16x32_bf16 v[230:233], a[148:151], v[214:217], v[230:233]
 v_mfma_f32_16x16x32_bf16 v[234:237], a[228:231], v[214:217], v[234:237]
 s_waitcnt lgkmcnt(1)
 v_mfma_f32_16x16x32_bf16 v[226:229], a[72:75], v[218:221], v[226:229]
 v_mfma_f32_16x16x32_bf16 v[230:233], a[152:155], v[218:221], v[230:233]
 v_mfma_f32_16x16x32_bf16 v[234:237], a[232:235], v[218:221], v[234:237]
 s_waitcnt lgkmcnt(0)
 v_mfma_f32_16x16x32_bf16 v[226:229], a[76:79], v[222:225], v[226:229]
 v_mfma_f32_16x16x32_bf16 v[230:233], a[156:159], v[222:225], v[230:233]
 v_mfma_f32_16x16x32_bf16 v[234:237], a[236:239], v[222:225], v[234:237]
 s_nop 1
 v_cvt_pk_bf16_f32 v190, v226, v227
 v_cvt_pk_bf16_f32 v191, v228, v229
 ds_write_b64 v113, v[190:191] offset:0
 v_cvt_pk_bf16_f32 v192, v230, v231
 v_cvt_pk_bf16_f32 v193, v232, v233
 ds_write_b64 v114, v[192:193] offset:0
 v_cvt_pk_bf16_f32 v194, v234, v235
 v_cvt_pk_bf16_f32 v195, v236, v237
 ds_write_b64 v113, v[194:195] offset:1024
 s_add_u32 s26, s61, s44
 s_add_u32 s27, s61, s45
 s_waitcnt lgkmcnt(0)
 s_barrier
 ds_read_b128 v[198:201], v3 offset:20480
 ds_read_b128 v[202:205], v3 offset:21504
 ds_read_b128 v[206:209], v3 offset:22528
 ds_read_b128 v[226:229], v3 offset:23552
 ds_read_b128 v[230:233], v3 offset:24576
 ds_read_b128 v[234:237], v3 offset:25600
 ds_read_b128 v[210:213], v109 offset:0
 ds_read_b128 v[214:217], v109 offset:1024
 ds_read_b128 v[218:221], v109 offset:2048
 s_waitcnt lgkmcnt(8)
 v_mfma_f32_16x16x32_bf16 v[194:197], v[130:133], v[198:201], 0
 s_waitcnt lgkmcnt(7)
 v_mfma_f32_16x16x32_bf16 v[194:197], v[134:137], v[202:205], v[194:197]
 s_waitcnt lgkmcnt(6)
 v_mfma_f32_16x16x32_bf16 v[194:197], v[138:141], v[206:209], v[194:197]
 s_waitcnt lgkmcnt(5)
 v_mfma_f32_16x16x32_bf16 v[190:193], v[226:229], v[198:201], v[158:161]
 s_waitcnt lgkmcnt(4)
 v_mfma_f32_16x16x32_bf16 v[190:193], v[230:233], v[202:205], v[190:193]
 s_mov_b32 exec_lo, 0x00ff00ff
 s_mov_b32 exec_hi, 0x00ff00ff
 s_waitcnt lgkmcnt(3)
 v_mfma_f32_16x16x32_bf16 v[190:193], v[234:237], v[206:209], v[190:193]
 buffer_store_dwordx4 v[194:197], v2, s[4:7], s26 offen offset:1024
 ds_write_b128 v117, v[194:197] offset:26624
 s_mov_b64 exec, -1
 ds_read_b128 v[222:225], v109 offset:3072
 s_waitcnt lgkmcnt(4)
 v_mfma_f32_16x16x32_bf16 v[226:229], v[210:213], a[240:243], 0
 v_mfma_f32_16x16x32_bf16 v[230:233], v[210:213], v[68:71], 0
 ds_read_b128 v[210:213], v109 offset:4096
 s_waitcnt lgkmcnt(4)
 v_mfma_f32_16x16x32_bf16 v[226:229], v[214:217], a[244:247], v[226:229]
 v_mfma_f32_16x16x32_bf16 v[230:233], v[214:217], v[72:75], v[230:233]
 ds_read_b128 v[214:217], v110 offset:0
 s_waitcnt lgkmcnt(4)
 v_mfma_f32_16x16x32_bf16 v[226:229], v[218:221], a[248:251], v[226:229]
 v_mfma_f32_16x16x32_bf16 v[230:233], v[218:221], v[76:79], v[230:233]
 buffer_load_dword v126, v124, s[4:7], 0 offen sc1
 ds_read_b128 v[218:221], v110 offset:1024
 s_waitcnt lgkmcnt(3)
 v_mfma_f32_16x16x32_bf16 v[226:229], v[222:225], a[252:255], v[226:229]
 v_mfma_f32_16x16x32_bf16 v[230:233], v[222:225], v[80:83], v[230:233]
 ds_read_b128 v[222:225], v110 offset:2048
 s_waitcnt lgkmcnt(3)
 v_mfma_f32_16x16x32_bf16 v[226:229], v[210:213], v[4:7], v[226:229]
 v_mfma_f32_16x16x32_bf16 v[230:233], v[210:213], v[84:87], v[230:233]
 s_barrier
 ds_read_b128 v[234:237], v3 offset:26624
 ds_read_b128 v[238:241], v3 offset:27648
 ds_read_b128 v[210:213], v110 offset:3072
 s_waitcnt lgkmcnt(5)
 v_mfma_f32_16x16x32_bf16 v[226:229], v[214:217], v[8:11], v[226:229]
 v_mfma_f32_16x16x32_bf16 v[230:233], v[214:217], v[88:91], v[230:233]
 ds_read_b128 v[214:217], v110 offset:4096
 s_waitcnt lgkmcnt(5)
 v_mfma_f32_16x16x32_bf16 v[226:229], v[218:221], v[12:15], v[226:229]
 v_mfma_f32_16x16x32_bf16 v[230:233], v[218:221], v[92:95], v[230:233]
 ds_read_b128 v[218:221], v111 offset:0
 s_waitcnt lgkmcnt(5)
 v_mfma_f32_16x16x32_bf16 v[226:229], v[222:225], v[16:19], v[226:229]
 v_mfma_f32_16x16x32_bf16 v[230:233], v[222:225], v[96:99], v[230:233]
 ds_read_b128 v[222:225], v111 offset:1024
 s_waitcnt lgkmcnt(3)
 v_mfma_f32_16x16x32_bf16 v[226:229], v[210:213], v[20:23], v[226:229]
 v_mfma_f32_16x16x32_bf16 v[230:233], v[210:213], v[100:103], v[230:233]
 buffer_load_dwordx4 v[194:197], v2, s[4:7], s27 offen offset:0 sc1
 ds_read_b128 v[210:213], v111 offset:2048
 s_waitcnt lgkmcnt(3)
 v_mfma_f32_16x16x32_bf16 v[226:229], v[214:217], v[24:27], v[226:229]
 v_mfma_f32_16x16x32_bf16 v[230:233], v[214:217], v[104:107], v[230:233]
 ds_read_b128 v[214:217], v111 offset:3072
 s_waitcnt lgkmcnt(3)
 v_mfma_f32_16x16x32_bf16 v[226:229], v[218:221], v[28:31], v[226:229]
 ds_read_b128 v[218:221], v111 offset:4096
 s_waitcnt lgkmcnt(3)
 v_mfma_f32_16x16x32_bf16 v[226:229], v[222:225], v[32:35], v[226:229]
 buffer_load_dwordx4 v[198:201], v2, s[4:7], s27 offen offset:1024 sc1
 ds_read_b128 v[222:225], v112 offset:0
 s_waitcnt lgkmcnt(3)
 v_mfma_f32_16x16x32_bf16 v[226:229], v[210:213], v[36:39], v[226:229]
 ds_read_b128 v[210:213], v112 offset:1024
 s_waitcnt lgkmcnt(3)
 v_mfma_f32_16x16x32_bf16 v[226:229], v[214:217], v[40:43], v[226:229]
 ds_read_b128 v[214:217], v112 offset:2048
 s_waitcnt lgkmcnt(3)
 v_mfma_f32_16x16x32_bf16 v[226:229], v[218:221], v[44:47], v[226:229]
 buffer_load_dwordx4 v[202:205], v2, s[4:7], s27 offen offset:2048 sc1
 ds_read_b128 v[218:221], v112 offset:3072
 s_waitcnt lgkmcnt(3)
 v_mfma_f32_16x16x32_bf16 v[226:229], v[222:225], v[48:51], v[226:229]
 ds_read_b128 v[222:225], v112 offset:4096
 s_waitcnt lgkmcnt(3)
 v_mfma_f32_16x16x32_bf16 v[226:229], v[210:213], v[52:55], v[226:229]
 s_waitcnt lgkmcnt(2)
 v_mfma_f32_16x16x32_bf16 v[226:229], v[214:217], v[56:59], v[226:229]
 s_barrier
 ds_read_b128 v[206:209], v117 offset:28672
 s_waitcnt lgkmcnt(2)
 v_mfma_f32_16x16x32_bf16 v[226:229], v[218:221], v[60:63], v[226:229]
 s_waitcnt vmcnt(3)
 s_mov_b32 s41, 0
 v_min_i32 v1, 64, v125
 v_cmp_ge_i32 vcc, v126, v1
 s_nop 0
 s_cmp_eq_u64 vcc, -1
 s_cbranch_scc1 Lflok_84
Lfl_83:
 s_add_u32 s41, s41, 1
 s_cmp_gt_u32 s41, 200000
 s_cbranch_scc1 L_fail
 buffer_load_dword v126, v124, s[4:7], 0 offen sc1
 s_waitcnt vmcnt(0)
 v_cmp_ge_i32 vcc, v126, v1
 s_nop 0
 s_cmp_eq_u64 vcc, -1
 s_cbranch_scc0 Lfl_83
 buffer_load_dwordx4 v[194:197], v2, s[4:7], s27 offen offset:0 sc1
 buffer_load_dwordx4 v[198:201], v2, s[4:7], s27 offen offset:1024 sc1
 buffer_load_dwordx4 v[202:205], v2, s[4:7], s27 offen offset:2048 sc1
Lflok_84:
 v_add_u32 v125, 1, v125
 s_waitcnt lgkmcnt(1)
 v_mfma_f32_16x16x32_bf16 v[226:229], v[222:225], v[64:67], v[226:229]
 s_mov_b32 s41, 0
Lf_85:
 s_waitcnt vmcnt(2)
 v_add_f32 v210, v234, v194
 v_add_f32 v211, v235, v195
 v_add_f32 v212, v236, v196
 v_add_f32 v213, v237, v197
 s_waitcnt vmcnt(1)
 v_add_f32 v214, v238, v198
 v_add_f32 v215, v239, v199
 v_add_f32 v216, v240, v200
 v_add_f32 v217, v241, v201
 v_maximum3_f32 v1, v210, v211, v212
 v_maximum3_f32 v127, v213, v214, v215
 v_maximum3_f32 v1, v1, v216, v217
 s_waitcnt vmcnt(0)
 v_add_f32 v218, v190, v202
 v_add_f32 v219, v191, v203
 v_add_f32 v220, v192, v204
 v_add_f32 v221, v193, v205
 v_maximum3_f32 v127, v127, v218, v219
 v_maximum3_f32 v1, v1, v220, v221
 v_maximum3_f32 v1, v1, v127, v127
 v_cmp_u_f32 vcc, v1, v1
 v_mov_b32 v127, v1
 s_cbranch_vccnz Lfs_86
Lfok_87:
 s_nop 0
 v_permlane32_swap_b32 v1, v127
 v_max_f32 v1, v1, v127
 v_mov_b32 v127, v1
 v_cvt_pk_bf16_f32 v178, v226, v227
 v_cvt_pk_bf16_f32 v179, v228, v229
 v_permlane16_swap_b32 v1, v127
 v_max_f32 v1, v1, v127
 v_mul_f32 v1, s71, v1
 v_fma_f32 v210, v210, s71, -v1
 v_fma_f32 v211, v211, s71, -v1
 v_fma_f32 v212, v212, s71, -v1
 v_fma_f32 v213, v213, s71, -v1
 v_fma_f32 v214, v214, s71, -v1
 v_fma_f32 v215, v215, s71, -v1
 v_fma_f32 v216, v216, s71, -v1
 v_fma_f32 v217, v217, s71, -v1
 v_fma_f32 v218, v218, s71, -v1
 v_fma_f32 v219, v219, s71, -v1
 v_fma_f32 v220, v220, s71, -v1
 v_fma_f32 v221, v221, s71, -v1
 v_exp_f32 v210, v210
 v_exp_f32 v211, v211
 v_exp_f32 v212, v212
 v_exp_f32 v213, v213
 v_exp_f32 v214, v214
 v_exp_f32 v215, v215
 v_exp_f32 v216, v216
 v_exp_f32 v217, v217
 s_mov_b32 exec_lo, 0x00ff00ff
 s_mov_b32 exec_hi, 0x00ff00ff
 v_cvt_pk_bf16_f32 v162, v210, v211
 v_cvt_pk_bf16_f32 v163, v212, v213
 v_cvt_pk_bf16_f32 v164, v214, v215
 v_cvt_pk_bf16_f32 v165, v216, v217
 s_not_b64 exec, exec
 v_cvt_pk_bf16_f32 v166, v210, v211
 v_cvt_pk_bf16_f32 v167, v212, v213
 v_cvt_pk_bf16_f32 v168, v214, v215
 v_cvt_pk_bf16_f32 v169, v216, v217
 s_mov_b64 exec, -1
 v_mfma_f32_16x16x32_bf16 v[200:203], v[186:189], v[162:165], 0
 v_exp_f32 v218, v218
 v_exp_f32 v219, v219
 v_mfma_f32_16x16x32_bf16 v[192:195], v[142:145], v[162:165], 0
 v_exp_f32 v220, v220
 v_mfma_f32_16x16x32_bf16 v[196:199], v[146:149], v[162:165], 0
 v_exp_f32 v221, v221
 v_mfma_f32_16x16x32_bf16 v[200:203], v[186:189], v[166:169], v[200:203]
 v_cvt_pk_bf16_f32 v190, v218, v219
 v_cvt_pk_bf16_f32 v191, v220, v221
 s_waitcnt lgkmcnt(0)
 v_mfma_f32_16x16x32_bf16 v[192:195], v[150:153], v[166:169], v[192:195]
 v_add_f32 v230, v230, v206
 v_add_f32 v231, v231, v207
 v_add_f32 v232, v232, v208
 v_mfma_f32_16x16x32_bf16 v[196:199], v[154:157], v[166:169], v[196:199]
 v_add_f32 v233, v233, v209
 v_cvt_pk_bf16_f32 v180, v230, v231
 v_cvt_pk_bf16_f32 v181, v232, v233
 v_mfma_f32_16x16x16_bf16 v[200:203], v[186:187], v[190:191], v[200:203]
 s_add_u32 s25, s61, s55
 s_add_u32 s27, s61, s56
 v_mfma_f32_16x16x16_bf16 v[192:195], v[178:179], v[190:191], v[192:195]
 s_add_u32 s28, s27, 4096
 v_mfma_f32_16x16x16_bf16 v[196:199], v[180:181], v[190:191], v[196:199]
 s_mov_b32 s41, 0
 s_nop 0
 v_rcp_f32 v127, v200
 s_nop 1
 v_mul_f32 v192, v192, v127
 v_mul_f32 v193, v193, v127
 v_mul_f32 v194, v194, v127
 v_mul_f32 v195, v195, v127
 v_cvt_pk_bf16_f32 v204, v192, v193
 v_cvt_pk_bf16_f32 v205, v194, v195
 v_mul_f32 v196, v196, v127
 v_mul_f32 v197, v197, v127
 v_mul_f32 v198, v198, v127
 v_mul_f32 v199, v199, v127
 v_cvt_pk_bf16_f32 v206, v196, v197
 v_cvt_pk_bf16_f32 v207, v198, v199
 buffer_store_dwordx4 v[204:207], v2, s[4:7], s25 offen
 ds_write_b64 v118, v[178:179] offset:512
 ds_write_b64 v118, v[180:181] offset:2560
 ds_read_b128 v[142:145], v115 offset:0
 ds_read_b128 v[146:149], v115 offset:1024
 ds_read_b128 v[150:153], v115 offset:2048
 ds_read_b128 v[154:157], v115 offset:3072
 ds_read_b128 v[234:237], v115 offset:4096
 ds_read_b128 v[238:241], v115 offset:5120
 ds_read_b128 v[242:245], v115 offset:6144
 ds_read_b128 v[246:249], v115 offset:7168
 ds_read_b128 v[250:253], v115 offset:8192
 s_sleep 2
 buffer_load_dwordx4 v[190:193], v2, s[4:7], s27 offen offset:0 sc1
 buffer_load_dwordx4 v[194:197], v2, s[4:7], s27 offen offset:1024 sc1
 buffer_load_dwordx4 v[198:201], v2, s[4:7], s27 offen offset:2048 sc1
 buffer_load_dwordx4 v[202:205], v2, s[4:7], s27 offen offset:3072 sc1
 buffer_load_dwordx4 v[206:209], v2, s[4:7], s28 offen offset:0 sc1
 buffer_load_dwordx4 v[210:213], v2, s[4:7], s28 offen offset:1024 sc1
 s_waitcnt lgkmcnt(0)
Lo_88:
 s_waitcnt vmcnt(5)
 v_max3_u32 v1, v190, v191, v192
 v_max_u32 v1, v1, v193
 v_cmp_eq_u32 vcc, -1, v1
 s_cbranch_vccnz Los_89
 v_mfma_f32_16x16x32_bf16 v[214:217], v[142:145], v[190:193], 0
 ds_read_b128 v[142:145], v115 offset:9216
 v_mfma_f32_16x16x32_bf16 v[218:221], v[146:149], v[190:193], 0
 ds_read_b128 v[146:149], v115 offset:10240
 s_waitcnt vmcnt(4)
 v_max3_u32 v1, v194, v195, v196
 v_mfma_f32_16x16x32_bf16 v[222:225], v[150:153], v[190:193], 0
 ds_read_b128 v[150:153], v115 offset:11264
 v_max_u32 v1, v1, v197
 v_mfma_f32_16x16x32_bf16 v[226:229], v[154:157], v[190:193], 0
 ds_read_b128 v[154:157], v115 offset:12288
 v_cmp_eq_u32 vcc, -1, v1
 v_mfma_f32_16x16x32_bf16 v[230:233], v[234:237], v[190:193], 0
 ds_read_b128 v[234:237], v115 offset:13312
Lo_90:
 s_cbranch_vccnz Los_91
 v_mfma_f32_16x16x32_bf16 v[214:217], v[238:241], v[194:197], v[214:217]
 ds_read_b128 v[238:241], v115 offset:14336
 v_mfma_f32_16x16x32_bf16 v[218:221], v[242:245], v[194:197], v[218:221]
 ds_read_b128 v[242:245], v116 offset:0
 s_waitcnt vmcnt(3)
 v_max3_u32 v1, v198, v199, v200
 v_mfma_f32_16x16x32_bf16 v[222:225], v[246:249], v[194:197], v[222:225]
 ds_read_b128 v[246:249], v116 offset:1024
 v_max_u32 v1, v1, v201
 v_mfma_f32_16x16x32_bf16 v[226:229], v[250:253], v[194:197], v[226:229]
 ds_read_b128 v[250:253], v116 offset:2048
 v_cmp_eq_u32 vcc, -1, v1
 s_waitcnt lgkmcnt(7)
 v_mfma_f32_16x16x32_bf16 v[230:233], v[142:145], v[194:197], v[230:233]
 ds_read_b128 v[142:145], v116 offset:3072
Lo_92:
 s_cbranch_vccnz Los_93
 v_mfma_f32_16x16x32_bf16 v[214:217], v[146:149], v[198:201], v[214:217]
 ds_read_b128 v[146:149], v116 offset:4096
 s_waitcnt lgkmcnt(7)
 v_mfma_f32_16x16x32_bf16 v[218:221], v[150:153], v[198:201], v[218:221]
 ds_read_b128 v[150:153], v116 offset:5120
 s_waitcnt vmcnt(2)
 v_max3_u32 v1, v202, v203, v204
 v_mfma_f32_16x16x32_bf16 v[222:225], v[154:157], v[198:201], v[222:225]
 ds_read_b128 v[154:157], v116 offset:6144
 v_max_u32 v1, v1, v205
 s_waitcnt lgkmcnt(7)
 v_mfma_f32_16x16x32_bf16 v[226:229], v[234:237], v[198:201], v[226:229]
 ds_read_b128 v[234:237], v116 offset:7168
 v_cmp_eq_u32 vcc, -1, v1
 v_mfma_f32_16x16x32_bf16 v[230:233], v[238:241], v[198:201], v[230:233]
 ds_read_b128 v[238:241], v116 offset:8192
Lo_94:
 s_cbranch_vccnz Los_95
 s_waitcnt lgkmcnt(7)
 v_mfma_f32_16x16x32_bf16 v[214:217], v[242:245], v[202:205], v[214:217]
 ds_read_b128 v[242:245], v116 offset:9216
 v_mfma_f32_16x16x32_bf16 v[218:221], v[246:249], v[202:205], v[218:221]
 ds_read_b128 v[246:249], v116 offset:10240
 s_waitcnt vmcnt(1)
 v_max3_u32 v1, v206, v207, v208
 s_waitcnt lgkmcnt(7)
 v_mfma_f32_16x16x32_bf16 v[222:225], v[250:253], v[202:205], v[222:225]
 ds_read_b128 v[250:253], v116 offset:11264
 v_max_u32 v1, v1, v209
 v_mfma_f32_16x16x32_bf16 v[226:229], v[142:145], v[202:205], v[226:229]
 ds_read_b128 v[142:145], v116 offset:12288
 v_cmp_eq_u32 vcc, -1, v1
 s_waitcnt lgkmcnt(7)
 v_mfma_f32_16x16x32_bf16 v[230:233], v[146:149], v[202:205], v[230:233]
 ds_read_b128 v[146:149], v116 offset:13312
Lo_96:
 s_cbranch_vccnz Los_97
 v_mfma_f32_16x16x32_bf16 v[214:217], v[150:153], v[206:209], v[214:217]
 ds_read_b128 v[150:153], v116 offset:14336
 s_waitcnt lgkmcnt(7)
 v_mfma_f32_16x16x32_bf16 v[218:221], v[154:157], v[206:209], v[218:221]
 s_waitcnt vmcnt(0)
 v_max3_u32 v1, v210, v211, v212
 v_mfma_f32_16x16x32_bf16 v[222:225], v[234:237], v[206:209], v[222:225]
 v_max_u32 v1, v1, v213
 s_waitcnt lgkmcnt(5)
 v_mfma_f32_16x16x32_bf16 v[226:229], v[238:241], v[206:209], v[226:229]
 v_cmp_eq_u32 vcc, -1, v1
 v_mfma_f32_16x16x32_bf16 v[230:233], v[242:245], v[206:209], v[230:233]
Lo_98:
 s_cbranch_vccnz Los_99
 s_waitcnt lgkmcnt(3)
 v_mfma_f32_16x16x32_bf16 v[214:217], v[246:249], v[210:213], v[214:217]
 buffer_load_dwordx4 v[130:133], v2, s[4:7], s67 offen sc1
 v_mfma_f32_16x16x32_bf16 v[218:221], v[250:253], v[210:213], v[218:221]
 buffer_load_dwordx4 v[134:137], v2, s[4:7], s67 offen offset:2048 sc1
 s_waitcnt lgkmcnt(1)
 v_mfma_f32_16x16x32_bf16 v[222:225], v[142:145], v[210:213], v[222:225]
 s_add_u32 s25, s67, 4096
 buffer_load_dwordx4 v[138:141], v2, s[4:7], s25 offen sc1
 v_mfma_f32_16x16x32_bf16 v[226:229], v[146:149], v[210:213], v[226:229]
 s_waitcnt lgkmcnt(0)
 v_mfma_f32_16x16x32_bf16 v[230:233], v[150:153], v[210:213], v[230:233]
 v_cvt_pk_bf16_f32 v190, v214, v215
 v_cvt_pk_bf16_f32 v191, v216, v217
 v_cvt_pk_bf16_f32 v192, v218, v219
 v_cvt_pk_bf16_f32 v193, v220, v221
 ds_write_b128 v119, v[190:193]
 v_cvt_pk_bf16_f32 v194, v222, v223
 v_cvt_pk_bf16_f32 v195, v224, v225
 v_cvt_pk_bf16_f32 v196, v226, v227
 v_cvt_pk_bf16_f32 v197, v228, v229
 ds_write_b128 v119, v[194:197] offset:4096
 v_cvt_pk_bf16_f32 v198, v230, v231
 v_cvt_pk_bf16_f32 v199, v232, v233
 ds_write_b64 v120, v[198:199] offset:8192
 s_add_u32 s25, s63, s46
 s_add_u32 s26, s63, s47
 s_add_u32 s27, s25, 655360
 s_add_u32 s28, s26, 655360
 s_waitcnt lgkmcnt(0)
 s_barrier
 ds_read_b128 v[190:193], v121 offset:0
 ds_read_b128 v[194:197], v121 offset:1024
 s_waitcnt lgkmcnt(1)
 v_mfma_f32_16x16x32_bf16 v[206:209], v[170:173], v[190:193], 0
 s_waitcnt lgkmcnt(0)
 v_mfma_f32_16x16x32_bf16 v[206:209], v[174:177], v[194:197], v[206:209]
 s_nop 7
 v_cvt_pk_bf16_f32 v214, v206, v207
 v_cvt_pk_bf16_f32 v215, v208, v209
 buffer_store_dwordx2 v[214:215], v122, s[4:7], s25 offen sc1
 buffer_store_dwordx2 v[214:215], v122, s[4:7], s27 offen
 s_add_u32 s27, s63, s48
 s_add_u32 s28, s63, s49
 s_add_u32 s70, s31, 1
 s_and_b32 s25, s70, 3
 s_mul_i32 s26, s25, 20480
 s_add_u32 s57, s26, s42
 s_add_u32 s58, s57, 4096
 s_add_u32 s59, s26, s43
 s_mul_i32 s63, s25, 163840
 s_xor_b32 s26, s25, 2
 s_mul_i32 s64, s26, 163840
 s_add_u32 s25, s25, 3
 s_and_b32 s25, s25, 3
 s_mul_i32 s26, s25, 20480
 s_add_u32 s60, s26, s43
 s_and_b32 s25, s70, 1
 s_mul_i32 s61, s25, 196608
 s_xor_b32 s25, s25, 1
 s_mul_i32 s62, s25, 196608
 s_mul_i32 s70, s70, 196608
 s_sleep 6
 s_mov_b32 s41, 0
 buffer_load_dwordx4 v[190:193], v2, s[4:7], s27 offen sc1
 buffer_load_dwordx4 v[194:197], v2, s[4:7], s28 offen sc1
Lj_101:
 s_waitcnt vmcnt(1)
 v_mfma_f32_16x16x32_bf16 v[198:201], v[170:173], v[190:193], 0
 s_waitcnt vmcnt(0)
 v_mfma_f32_16x16x32_bf16 v[198:201], v[170:173], v[194:197], v[198:201]
 v_max3_u32 v202, v190, v191, v192
 v_max3_u32 v202, v202, v193, v194
 v_max3_u32 v202, v202, v195, v196
 v_max_u32 v202, v202, v197
 v_cmp_eq_u32 vcc, -1, v202
 s_cbranch_vccnz Ljs_102
 s_nop 1
 v_cvt_pk_bf16_f32 v202, v198, v199
 v_cvt_pk_bf16_f32 v203, v200, v201
 s_mov_b64 exec, 0xffffffff
 s_cmp_eq_u32 s31, 7
 s_cbranch_scc1 Lov_103
Lnov_104:
 buffer_store_dwordx2 v[202:203], v123, s[4:7], s59 offen
 buffer_store_dwordx2 v[182:183], v123, s[4:7], s60 offen
 s_mov_b64 exec, -1
Lnr_100:
 s_add_u32 s31, s31, 1
 s_cmp_lt_u32 s31, 72
 s_barrier
 s_cbranch_scc1 L_rec_top_1l
 s_waitcnt vmcnt(0)
 s_barrier
 s_endpgm
Lzs_74:
 buffer_load_dwordx4 v[190:193], v2, s[4:7], s57 offen offset:0 sc1
 buffer_load_dwordx4 v[194:197], v2, s[4:7], s57 offen offset:1024 sc1
 buffer_load_dwordx4 v[198:201], v2, s[4:7], s57 offen offset:2048 sc1
 buffer_load_dwordx4 v[202:205], v2, s[4:7], s57 offen offset:3072 sc1
 buffer_load_dwordx4 v[206:209], v2, s[4:7], s58 offen offset:0 sc1
 s_add_u32 s41, s41, 1
 s_cmp_gt_u32 s41, 200000
 s_cbranch_scc1 L_fail
 s_branch Lz_73
Lzs_76:
 buffer_load_dwordx4 v[194:197], v2, s[4:7], s57 offen offset:1024 sc1
 buffer_load_dwordx4 v[198:201], v2, s[4:7], s57 offen offset:2048 sc1
 buffer_load_dwordx4 v[202:205], v2, s[4:7], s57 offen offset:3072 sc1
 buffer_load_dwordx4 v[206:209], v2, s[4:7], s58 offen offset:0 sc1
 s_add_u32 s41, s41, 1
 s_cmp_gt_u32 s41, 200000
 s_cbranch_scc1 L_fail
 s_branch Lz_75
Lzs_78:
 buffer_load_dwordx4 v[198:201], v2, s[4:7], s57 offen offset:2048 sc1
 buffer_load_dwordx4 v[202:205], v2, s[4:7], s57 offen offset:3072 sc1
 buffer_load_dwordx4 v[206:209], v2, s[4:7], s58 offen offset:0 sc1
 s_add_u32 s41, s41, 1
 s_cmp_gt_u32 s41, 200000
 s_cbranch_scc1 L_fail
 s_branch Lz_77
Lzs_80:
 buffer_load_dwordx4 v[202:205], v2, s[4:7], s57 offen offset:3072 sc1
 buffer_load_dwordx4 v[206:209], v2, s[4:7], s58 offen offset:0 sc1
 s_add_u32 s41, s41, 1
 s_cmp_gt_u32 s41, 200000
 s_cbranch_scc1 L_fail
 s_branch Lz_79
Lzs_82:
 buffer_load_dwordx4 v[206:209], v2, s[4:7], s58 offen offset:0 sc1
 s_add_u32 s41, s41, 1
 s_cmp_gt_u32 s41, 200000
 s_cbranch_scc1 L_fail
 s_branch Lz_81
Lfs_86:
 v_max3_u32 v222, v194, v195, v196
 v_max3_u32 v222, v222, v197, v198
 v_max3_u32 v222, v222, v199, v200
 v_max3_u32 v222, v222, v201, v202
 v_max3_u32 v222, v222, v203, v204
 v_max_u32 v222, v222, v205
 v_cmp_eq_u32 vcc, -1, v222
 s_cbranch_vccz Lfok_87
 buffer_load_dwordx4 v[194:197], v2, s[4:7], s27 offen offset:0 sc1
 buffer_load_dwordx4 v[198:201], v2, s[4:7], s27 offen offset:1024 sc1
 buffer_load_dwordx4 v[202:205], v2, s[4:7], s27 offen offset:2048 sc1
 s_add_u32 s41, s41, 1
 s_cmp_gt_u32 s41, 200000
 s_cbranch_scc1 L_fail
 s_branch Lf_85
Los_89:
 buffer_load_dwordx4 v[190:193], v2, s[4:7], s27 offen offset:0 sc1
 buffer_load_dwordx4 v[194:197], v2, s[4:7], s27 offen offset:1024 sc1
 buffer_load_dwordx4 v[198:201], v2, s[4:7], s27 offen offset:2048 sc1
 buffer_load_dwordx4 v[202:205], v2, s[4:7], s27 offen offset:3072 sc1
 buffer_load_dwordx4 v[206:209], v2, s[4:7], s28 offen offset:0 sc1
 buffer_load_dwordx4 v[210:213], v2, s[4:7], s28 offen offset:1024 sc1
 s_add_u32 s41, s41, 1
 s_cmp_gt_u32 s41, 200000
 s_cbranch_scc1 L_fail
 s_branch Lo_88
Los_91:
 buffer_load_dwordx4 v[194:197], v2, s[4:7], s27 offen offset:1024 sc1
 buffer_load_dwordx4 v[198:201], v2, s[4:7], s27 offen offset:2048 sc1
 buffer_load_dwordx4 v[202:205], v2, s[4:7], s27 offen offset:3072 sc1
 buffer_load_dwordx4 v[206:209], v2, s[4:7], s28 offen offset:0 sc1
 buffer_load_dwordx4 v[210:213], v2, s[4:7], s28 offen offset:1024 sc1
 s_waitcnt vmcnt(4)
 v_max3_u32 v1, v194, v195, v196
 v_max_u32 v1, v1, v197
 v_cmp_eq_u32 vcc, -1, v1
 s_add_u32 s41, s41, 1
 s_cmp_gt_u32 s41, 200000
 s_cbranch_scc1 L_fail
 s_branch Lo_90
Los_93:
 buffer_load_dwordx4 v[198:201], v2, s[4:7], s27 offen offset:2048 sc1
 buffer_load_dwordx4 v[202:205], v2, s[4:7], s27 offen offset:3072 sc1
 buffer_load_dwordx4 v[206:209], v2, s[4:7], s28 offen offset:0 sc1
 buffer_load_dwordx4 v[210:213], v2, s[4:7], s28 offen offset:1024 sc1
 s_waitcnt vmcnt(3)
 v_max3_u32 v1, v198, v199, v200
 v_max_u32 v1, v1, v201
 v_cmp_eq_u32 vcc, -1, v1
 s_add_u32 s41, s41, 1
 s_cmp_gt_u32 s41, 200000
 s_cbranch_scc1 L_fail
 s_branch Lo_92
Los_95:
 buffer_load_dwordx4 v[202:205], v2, s[4:7], s27 offen offset:3072 sc1
 buffer_load_dwordx4 v[206:209], v2, s[4:7], s28 offen offset:0 sc1
 buffer_load_dwordx4 v[210:213], v2, s[4:7], s28 offen offset:1024 sc1
 s_waitcnt vmcnt(2)
 v_max3_u32 v1, v202, v203, v204
 v_max_u32 v1, v1, v205
 v_cmp_eq_u32 vcc, -1, v1
 s_add_u32 s41, s41, 1
 s_cmp_gt_u32 s41, 200000
 s_cbranch_scc1 L_fail
 s_branch Lo_94
Los_97:
 buffer_load_dwordx4 v[206:209], v2, s[4:7], s28 offen offset:0 sc1
 buffer_load_dwordx4 v[210:213], v2, s[4:7], s28 offen offset:1024 sc1
 s_waitcnt vmcnt(1)
 v_max3_u32 v1, v206, v207, v208
 v_max_u32 v1, v1, v209
 v_cmp_eq_u32 vcc, -1, v1
 s_add_u32 s41, s41, 1
 s_cmp_gt_u32 s41, 200000
 s_cbranch_scc1 L_fail
 s_branch Lo_96
Los_99:
 buffer_load_dwordx4 v[210:213], v2, s[4:7], s28 offen offset:1024 sc1
 s_waitcnt vmcnt(0)
 v_max3_u32 v1, v210, v211, v212
 v_max_u32 v1, v1, v213
 v_cmp_eq_u32 vcc, -1, v1
 s_add_u32 s41, s41, 1
 s_cmp_gt_u32 s41, 200000
 s_cbranch_scc1 L_fail
 s_branch Lo_98
Ljs_102:
 buffer_load_dwordx4 v[190:193], v2, s[4:7], s27 offen sc1
 buffer_load_dwordx4 v[194:197], v2, s[4:7], s28 offen sc1
 s_add_u32 s41, s41, 1
 s_cmp_gt_u32 s41, 200000
 s_cbranch_scc1 L_fail
 s_branch Lj_101
Lov_103:
 s_mov_b32 exec_lo, 0xff00ff00
 v_mov_b32 v202, v128
 v_mov_b32 v203, v129
 s_mov_b32 exec_lo, -1
 s_add_u32 s41, s41, 1
 s_cmp_gt_u32 s41, 200000
 s_cbranch_scc1 L_fail
 s_branch Lnov_104
Lpwn_71:
 s_cmp_eq_u32 s3, 2
 s_cbranch_scc0 Lpwn_106
 s_waitcnt vmcnt(0)
 s_cmp_eq_u32 s40, 0
 s_cbranch_scc1 Lz0_107
 s_mov_b64 exec, 0xffffffff
 buffer_store_dwordx2 v[128:129], v123, s[4:7], s43 offen
 s_mov_b64 exec, -1
Lz0_107:
 s_barrier
L_rec_top_2l:
 s_sleep 2
 buffer_load_dwordx4 v[190:193], v2, s[4:7], s57 offen offset:0 sc1
 buffer_load_dwordx4 v[194:197], v2, s[4:7], s57 offen offset:1024 sc1
 buffer_load_dwordx4 v[198:201], v2, s[4:7], s57 offen offset:2048 sc1
 buffer_load_dwordx4 v[202:205], v2, s[4:7], s57 offen offset:3072 sc1
 buffer_load_dwordx4 v[206:209], v2, s[4:7], s58 offen offset:0 sc1
 s_mov_b32 s41, 0
Lz_108:
 s_waitcnt vmcnt(4)
 ds_write_b128 v109, v[190:193] offset:0
 v_mfma_f32_16x16x32_bf16 v[226:229], a[0:3], v[190:193], 0
 v_max3_u32 v1, v190, v191, v192
 v_max_u32 v1, v1, v193
 v_mfma_f32_16x16x32_bf16 v[230:233], a[80:83], v[190:193], 0
 v_cmp_eq_u32 vcc, -1, v1
 v_mfma_f32_16x16x32_bf16 v[234:237], a[160:163], v[190:193], 0
 s_cbranch_vccnz Lzs_109
Lz_110:
 s_waitcnt vmcnt(3)
 ds_write_b128 v109, v[194:197] offset:1024
 v_max3_u32 v1, v194, v195, v196
 v_max_u32 v1, v1, v197
 v_cmp_eq_u32 vcc, -1, v1
 s_cbranch_vccnz Lzs_111
 v_mfma_f32_16x16x32_bf16 v[226:229], a[4:7], v[194:197], v[226:229]
 v_mfma_f32_16x16x32_bf16 v[230:233], a[84:87], v[194:197], v[230:233]
 v_mfma_f32_16x16x32_bf16 v[234:237], a[164:167], v[194:197], v[234:237]
Lz_112:
 s_waitcnt vmcnt(2)
 ds_write_b128 v109, v[198:201] offset:2048
 v_max3_u32 v1, v198, v199, v200
 v_max_u32 v1, v1, v201
 v_cmp_eq_u32 vcc, -1, v1
 s_cbranch_vccnz Lzs_113
 v_mfma_f32_16x16x32_bf16 v[226:229], a[8:11], v[198:201], v[226:229]
 v_mfma_f32_16x16x32_bf16 v[230:233], a[88:91], v[198:201], v[230:233]
 v_mfma_f32_16x16x32_bf16 v[234:237], a[168:171], v[198:201], v[234:237]
Lz_114:
 s_waitcnt vmcnt(1)
 ds_write_b128 v109, v[202:205] offset:3072
 v_max3_u32 v1, v202, v203, v204
 v_max_u32 v1, v1, v205
 v_cmp_eq_u32 vcc, -1, v1
 s_cbranch_vccnz Lzs_115
Lz_116:
 s_waitcnt vmcnt(0)
 ds_write_b128 v109, v[206:209] offset:4096
 v_max3_u32 v1, v206, v207, v208
 v_max_u32 v1, v1, v209
 v_cmp_eq_u32 vcc, -1, v1
 s_cbranch_vccnz Lzs_117
 s_waitcnt lgkmcnt(0)
 s_barrier
 ds_read_b128 v[214:217], v110 offset:0
 ds_read_b128 v[218:221], v110 offset:1024
 ds_read_b128 v[222:225], v110 offset:2048
 v_mfma_f32_16x16x32_bf16 v[226:229], a[12:15], v[202:205], v[226:229]
 s_add_u32 s25, s68, s51
 v_mfma_f32_16x16x32_bf16 v[230:233], a[92:95], v[202:205], v[230:233]
 buffer_load_dwordx4 v[142:145], v2, s[4:7], s25 offen sc1
 v_mfma_f32_16x16x32_bf16 v[234:237], a[172:175], v[202:205], v[234:237]
 v_mfma_f32_16x16x32_bf16 v[226:229], a[16:19], v[206:209], v[226:229]
 s_add_u32 s25, s69, s51
 v_mfma_f32_16x16x32_bf16 v[230:233], a[96:99], v[206:209], v[230:233]
 buffer_load_dwordx4 v[150:153], v2, s[4:7], s25 offen sc1
 v_mfma_f32_16x16x32_bf16 v[234:237], a[176:179], v[206:209], v[234:237]
 ds_read_b128 v[210:213], v110 offset:3072
 s_waitcnt lgkmcnt(3)
 v_mfma_f32_16x16x32_bf16 v[226:229], a[20:23], v[214:217], v[226:229]
 s_add_u32 s25, s44, s62
 v_mfma_f32_16x16x32_bf16 v[230:233], a[100:103], v[214:217], v[230:233]
 buffer_store_dwordx4 v[182:185], v2, s[4:7], s25 offen offset:1024
 v_mfma_f32_16x16x32_bf16 v[234:237], a[180:183], v[214:217], v[234:237]
 ds_read_b128 v[214:217], v110 offset:4096
 s_waitcnt lgkmcnt(3)
 v_mfma_f32_16x16x32_bf16 v[226:229], a[24:27], v[218:221], v[226:229]
 s_add_u32 s25, s44, s62
 v_mfma_f32_16x16x32_bf16 v[230:233], a[104:107], v[218:221], v[230:233]
 s_add_u32 s25, s25, 1867776
 v_mfma_f32_16x16x32_bf16 v[234:237], a[184:187], v[218:221], v[234:237]
 buffer_store_dwordx4 v[182:185], v2, s[4:7], s25 offen offset:1024
 ds_read_b128 v[218:221], v111 offset:0
 s_waitcnt lgkmcnt(3)
 v_mfma_f32_16x16x32_bf16 v[226:229], a[28:31], v[222:225], v[226:229]
 s_add_u32 s25, s46, s64
 v_mfma_f32_16x16x32_bf16 v[230:233], a[108:111], v[222:225], v[230:233]
 buffer_store_dwordx2 v[182:183], v122, s[4:7], s25 offen sc1
 v_mfma_f32_16x16x32_bf16 v[234:237], a[188:191], v[222:225], v[234:237]
 ds_read_b128 v[222:225], v111 offset:1024
 s_waitcnt lgkmcnt(3)
 v_mfma_f32_16x16x32_bf16 v[226:229], a[32:35], v[210:213], v[226:229]
 s_add_u32 s25, s25, 655360
 v_mfma_f32_16x16x32_bf16 v[230:233], a[112:115], v[210:213], v[230:233]
 buffer_store_dwordx2 v[182:183], v122, s[4:7], s25 offen
 v_mfma_f32_16x16x32_bf16 v[234:237], a[192:195], v[210:213], v[234:237]
 ds_read_b128 v[210:213], v111 offset:2048
 s_waitcnt lgkmcnt(3)
 v_mfma_f32_16x16x32_bf16 v[226:229], a[36:39], v[214:217], v[226:229]
 s_add_u32 s25, s31, 1
 s_mul_i32 s68, s25, 393216
 v_mfma_f32_16x16x32_bf16 v[230:233], a[116:119], v[214:217], v[230:233]
 s_add_u32 s68, s68, 84066304
 s_cmp_lt_u32 s25, 64
 v_mfma_f32_16x16x32_bf16 v[234:237], a[196:199], v[214:217], v[234:237]
 s_cselect_b32 s68, s68, 2146435072
 ds_read_b128 v[214:217], v111 offset:3072
 s_waitcnt lgkmcnt(3)
 v_mfma_f32_16x16x32_bf16 v[226:229], a[40:43], v[218:221], v[226:229]
 s_sub_u32 s26, s25, 8
 s_mul_i32 s69, s26, 393216
 v_mfma_f32_16x16x32_bf16 v[230:233], a[120:123], v[218:221], v[230:233]
 s_add_u32 s69, s69, 134397952
 s_cmp_lt_u32 s26, 64
 v_mfma_f32_16x16x32_bf16 v[234:237], a[200:203], v[218:221], v[234:237]
 s_cselect_b32 s69, s69, 2146435072
 ds_read_b128 v[218:221], v111 offset:4096
 s_waitcnt lgkmcnt(3)
 v_mfma_f32_16x16x32_bf16 v[226:229], a[44:47], v[222:225], v[226:229]
 s_add_u32 s25, s68, 4269801472
 s_add_u32 s26, s69, 4269801472
 v_mfma_f32_16x16x32_bf16 v[230:233], a[124:127], v[222:225], v[230:233]
 s_cmp_lt_u32 s3, 2
 s_cselect_b32 s67, s25, s26
 v_mfma_f32_16x16x32_bf16 v[234:237], a[204:207], v[222:225], v[234:237]
 s_add_u32 s67, s67, s50
 ds_read_b128 v[222:225], v112 offset:0
 s_waitcnt lgkmcnt(3)
 v_mfma_f32_16x16x32_bf16 v[226:229], a[48:51], v[210:213], v[226:229]
 v_mfma_f32_16x16x32_bf16 v[230:233], a[128:131], v[210:213], v[230:233]
 v_mfma_f32_16x16x32_bf16 v[234:237], a[208:211], v[210:213], v[234:237]
 ds_read_b128 v[210:213], v112 offset:1024
 s_waitcnt lgkmcnt(3)
 v_mfma_f32_16x16x32_bf16 v[226:229], a[52:55], v[214:217], v[226:229]
 v_mfma_f32_16x16x32_bf16 v[230:233], a[132:135], v[214:217], v[230:233]
 v_mfma_f32_16x16x32_bf16 v[234:237], a[212:215], v[214:217], v[234:237]
 ds_read_b128 v[214:217], v112 offset:2048
 s_waitcnt lgkmcnt(3)
 v_mfma_f32_16x16x32_bf16 v[226:229], a[56:59], v[218:221], v[226:229]
 v_mfma_f32_16x16x32_bf16 v[230:233], a[136:139], v[218:221], v[230:233]
 v_mfma_f32_16x16x32_bf16 v[234:237], a[216:219], v[218:221], v[234:237]
 ds_read_b128 v[218:221], v112 offset:3072
 s_waitcnt lgkmcnt(3)
 v_mfma_f32_16x16x32_bf16 v[226:229], a[60:63], v[222:225], v[226:229]
 v_mfma_f32_16x16x32_bf16 v[230:233], a[140:143], v[222:225], v[230:233]
 v_mfma_f32_16x16x32_bf16 v[234:237], a[220:223], v[222:225], v[234:237]
 ds_read_b128 v[222:225], v112 offset:4096
 s_waitcnt lgkmcnt(3)
 v_mfma_f32_16x16x32_bf16 v[226:229], a[64:67], v[210:213], v[226:229]
 v_mfma_f32_16x16x32_bf16 v[230:233], a[144:147], v[210:213], v[230:233]
 v_mfma_f32_16x16x32_bf16 v[234:237], a[224:227], v[210:213], v[234:237]
 s_waitcnt lgkmcnt(2)
 v_mfma_f32_16x16x32_bf16 v[226:229], a[68:71], v[214:217], v[226:229]
 v_mfma_f32_16x16x32_bf16 v[230:233], a[148:151], v[214:217], v[230:233]
 v_mfma_f32_16x16x32_bf16 v[234:237], a[228:231], v[214:217], v[234:237]
 s_waitcnt lgkmcnt(1)
 v_mfma_f32_16x16x32_bf16 v[226:229], a[72:75], v[218:221], v[226:229]
 v_mfma_f32_16x16x32_bf16 v[230:233], a[152:155], v[218:221], v[230:233]
 v_mfma_f32_16x16x32_bf16 v[234:237], a[232:235], v[218:221], v[234:237]
 s_waitcnt lgkmcnt(0)
 v_mfma_f32_16x16x32_bf16 v[226:229], a[76:79], v[222:225], v[226:229]
 v_mfma_f32_16x16x32_bf16 v[230:233], a[156:159], v[222:225], v[230:233]
 v_mfma_f32_16x16x32_bf16 v[234:237], a[236:239], v[222:225], v[234:237]
 s_nop 1
 v_cvt_pk_bf16_f32 v190, v226, v227
 v_cvt_pk_bf16_f32 v191, v228, v229
 ds_write_b64 v113, v[190:191] offset:0
 v_cvt_pk_bf16_f32 v192, v230, v231
 v_cvt_pk_bf16_f32 v193, v232, v233
 ds_write_b64 v114, v[192:193] offset:0
 v_cvt_pk_bf16_f32 v194, v234, v235
 v_cvt_pk_bf16_f32 v195, v236, v237
 ds_write_b64 v113, v[194:195] offset:1024
 s_add_u32 s26, s61, s44
 s_add_u32 s27, s61, s45
 s_waitcnt lgkmcnt(0)
 s_barrier
 ds_read_b128 v[198:201], v3 offset:20480
 ds_read_b128 v[202:205], v3 offset:21504
 ds_read_b128 v[206:209], v3 offset:22528
 ds_read_b128 v[226:229], v3 offset:23552
 ds_read_b128 v[230:233], v3 offset:24576
 ds_read_b128 v[234:237], v3 offset:25600
 ds_read_b128 v[210:213], v109 offset:0
 ds_read_b128 v[214:217], v109 offset:1024
 ds_read_b128 v[218:221], v109 offset:2048
 s_waitcnt lgkmcnt(8)
 v_mfma_f32_16x16x32_bf16 v[194:197], v[130:133], v[198:201], 0
 s_waitcnt lgkmcnt(7)
 v_mfma_f32_16x16x32_bf16 v[194:197], v[134:137], v[202:205], v[194:197]
 s_waitcnt lgkmcnt(6)
 v_mfma_f32_16x16x32_bf16 v[194:197], v[138:141], v[206:209], v[194:197]
 s_waitcnt lgkmcnt(5)
 v_mfma_f32_16x16x32_bf16 v[190:193], v[226:229], v[198:201], v[158:161]
 s_waitcnt lgkmcnt(4)
 v_mfma_f32_16x16x32_bf16 v[190:193], v[230:233], v[202:205], v[190:193]
 s_mov_b32 exec_lo, 0xff00ff00
 s_mov_b32 exec_hi, 0xff00ff00
 s_waitcnt lgkmcnt(3)
 v_mfma_f32_16x16x32_bf16 v[190:193], v[234:237], v[206:209], v[190:193]
 buffer_store_dwordx4 v[194:197], v2, s[4:7], s26 offen offset:0
 ds_write_b128 v117, v[194:197] offset:26624
 s_mov_b64 exec, -1
 ds_read_b128 v[222:225], v109 offset:3072
 s_waitcnt lgkmcnt(4)
 v_mfma_f32_16x16x32_bf16 v[226:229], v[210:213], a[240:243], 0
 v_mfma_f32_16x16x32_bf16 v[230:233], v[210:213], v[68:71], 0
 ds_read_b128 v[210:213], v109 offset:4096
 s_waitcnt lgkmcnt(4)
 v_mfma_f32_16x16x32_bf16 v[226:229], v[214:217], a[244:247], v[226:229]
 v_mfma_f32_16x16x32_bf16 v[230:233], v[214:217], v[72:75], v[230:233]
 ds_read_b128 v[214:217], v110 offset:0
 s_waitcnt lgkmcnt(4)
 v_mfma_f32_16x16x32_bf16 v[226:229], v[218:221], a[248:251], v[226:229]
 v_mfma_f32_16x16x32_bf16 v[230:233], v[218:221], v[76:79], v[230:233]
 buffer_load_dword v126, v124, s[4:7], 0 offen sc1
 ds_read_b128 v[218:221], v110 offset:1024
 s_waitcnt lgkmcnt(3)
 v_mfma_f32_16x16x32_bf16 v[226:229], v[222:225], a[252:255], v[226:229]
 v_mfma_f32_16x16x32_bf16 v[230:233], v[222:225], v[80:83], v[230:233]
 ds_read_b128 v[222:225], v110 offset:2048
 s_waitcnt lgkmcnt(3)
 v_mfma_f32_16x16x32_bf16 v[226:229], v[210:213], v[4:7], v[226:229]
 v_mfma_f32_16x16x32_bf16 v[230:233], v[210:213], v[84:87], v[230:233]
 s_barrier
 ds_read_b128 v[234:237], v3 offset:26624
 ds_read_b128 v[238:241], v3 offset:27648
 ds_read_b128 v[210:213], v110 offset:3072
 s_waitcnt lgkmcnt(5)
 v_mfma_f32_16x16x32_bf16 v[226:229], v[214:217], v[8:11], v[226:229]
 v_mfma_f32_16x16x32_bf16 v[230:233], v[214:217], v[88:91], v[230:233]
 ds_read_b128 v[214:217], v110 offset:4096
 s_waitcnt lgkmcnt(5)
 v_mfma_f32_16x16x32_bf16 v[226:229], v[218:221], v[12:15], v[226:229]
 v_mfma_f32_16x16x32_bf16 v[230:233], v[218:221], v[92:95], v[230:233]
 ds_read_b128 v[218:221], v111 offset:0
 s_waitcnt lgkmcnt(5)
 v_mfma_f32_16x16x32_bf16 v[226:229], v[222:225], v[16:19], v[226:229]
 v_mfma_f32_16x16x32_bf16 v[230:233], v[222:225], v[96:99], v[230:233]
 ds_read_b128 v[222:225], v111 offset:1024
 s_waitcnt lgkmcnt(3)
 v_mfma_f32_16x16x32_bf16 v[226:229], v[210:213], v[20:23], v[226:229]
 v_mfma_f32_16x16x32_bf16 v[230:233], v[210:213], v[100:103], v[230:233]
 buffer_load_dwordx4 v[194:197], v2, s[4:7], s27 offen offset:0 sc1
 ds_read_b128 v[210:213], v111 offset:2048
 s_waitcnt lgkmcnt(3)
 v_mfma_f32_16x16x32_bf16 v[226:229], v[214:217], v[24:27], v[226:229]
 v_mfma_f32_16x16x32_bf16 v[230:233], v[214:217], v[104:107], v[230:233]
 ds_read_b128 v[214:217], v111 offset:3072
 s_waitcnt lgkmcnt(3)
 v_mfma_f32_16x16x32_bf16 v[226:229], v[218:221], v[28:31], v[226:229]
 ds_read_b128 v[218:221], v111 offset:4096
 s_waitcnt lgkmcnt(3)
 v_mfma_f32_16x16x32_bf16 v[226:229], v[222:225], v[32:35], v[226:229]
 buffer_load_dwordx4 v[198:201], v2, s[4:7], s27 offen offset:1024 sc1
 ds_read_b128 v[222:225], v112 offset:0
 s_waitcnt lgkmcnt(3)
 v_mfma_f32_16x16x32_bf16 v[226:229], v[210:213], v[36:39], v[226:229]
 ds_write_b128 v117, v[230:233] offset:28672
 ds_read_b128 v[210:213], v112 offset:1024
 s_waitcnt lgkmcnt(4)
 v_mfma_f32_16x16x32_bf16 v[226:229], v[214:217], v[40:43], v[226:229]
 ds_read_b128 v[214:217], v112 offset:2048
 s_waitcnt lgkmcnt(4)
 v_mfma_f32_16x16x32_bf16 v[226:229], v[218:221], v[44:47], v[226:229]
 buffer_load_dwordx4 v[202:205], v2, s[4:7], s27 offen offset:2048 sc1
 ds_read_b128 v[218:221], v112 offset:3072
 s_waitcnt lgkmcnt(4)
 v_mfma_f32_16x16x32_bf16 v[226:229], v[222:225], v[48:51], v[226:229]
 ds_read_b128 v[222:225], v112 offset:4096
 s_waitcnt lgkmcnt(3)
 v_mfma_f32_16x16x32_bf16 v[226:229], v[210:213], v[52:55], v[226:229]
 s_waitcnt lgkmcnt(2)
 v_mfma_f32_16x16x32_bf16 v[226:229], v[214:217], v[56:59], v[226:229]
 s_barrier
 s_waitcnt lgkmcnt(1)
 v_mfma_f32_16x16x32_bf16 v[226:229], v[218:221], v[60:63], v[226:229]
 s_waitcnt vmcnt(3)
 s_mov_b32 s41, 0
 v_min_i32 v1, 64, v125
 v_cmp_ge_i32 vcc, v126, v1
 s_nop 0
 s_cmp_eq_u64 vcc, -1
 s_cbranch_scc1 Lflok_119
Lfl_118:
 s_add_u32 s41, s41, 1
 s_cmp_gt_u32 s41, 200000
 s_cbranch_scc1 L_fail
 buffer_load_dword v126, v124, s[4:7], 0 offen sc1
 s_waitcnt vmcnt(0)
 v_cmp_ge_i32 vcc, v126, v1
 s_nop 0
 s_cmp_eq_u64 vcc, -1
 s_cbranch_scc0 Lfl_118
 buffer_load_dwordx4 v[194:197], v2, s[4:7], s27 offen offset:0 sc1
 buffer_load_dwordx4 v[198:201], v2, s[4:7], s27 offen offset:1024 sc1
 buffer_load_dwordx4 v[202:205], v2, s[4:7], s27 offen offset:2048 sc1
Lflok_119:
 v_add_u32 v125, 1, v125
 s_waitcnt lgkmcnt(0)
 v_mfma_f32_16x16x32_bf16 v[226:229], v[222:225], v[64:67], v[226:229]
 s_mov_b32 s41, 0
Lf_120:
 s_waitcnt vmcnt(2)
 v_add_f32 v210, v234, v194
 v_add_f32 v211, v235, v195
 v_add_f32 v212, v236, v196
 v_add_f32 v213, v237, v197
 s_waitcnt vmcnt(1)
 v_add_f32 v214, v238, v198
 v_add_f32 v215, v239, v199
 v_add_f32 v216, v240, v200
 v_add_f32 v217, v241, v201
 v_maximum3_f32 v1, v210, v211, v212
 v_maximum3_f32 v127, v213, v214, v215
 v_maximum3_f32 v1, v1, v216, v217
 s_waitcnt vmcnt(0)
 v_add_f32 v218, v190, v202
 v_add_f32 v219, v191, v203
 v_add_f32 v220, v192, v204
 v_add_f32 v221, v193, v205
 v_maximum3_f32 v127, v127, v218, v219
 v_maximum3_f32 v1, v1, v220, v221
 v_maximum3_f32 v1, v1, v127, v127
 v_cmp_u_f32 vcc, v1, v1
 v_mov_b32 v127, v1
 s_cbranch_vccnz Lfs_121
Lfok_122:
 s_nop 0
 v_permlane32_swap_b32 v1, v127
 v_max_f32 v1, v1, v127
 v_mov_b32 v127, v1
 v_cvt_pk_bf16_f32 v178, v226, v227
 v_cvt_pk_bf16_f32 v179, v228, v229
 v_permlane16_swap_b32 v1, v127
 v_max_f32 v1, v1, v127
 v_mul_f32 v1, s71, v1
 v_fma_f32 v210, v210, s71, -v1
 v_fma_f32 v211, v211, s71, -v1
 v_fma_f32 v212, v212, s71, -v1
 v_fma_f32 v213, v213, s71, -v1
 v_fma_f32 v214, v214, s71, -v1
 v_fma_f32 v215, v215, s71, -v1
 v_fma_f32 v216, v216, s71, -v1
 v_fma_f32 v217, v217, s71, -v1
 v_fma_f32 v218, v218, s71, -v1
 v_fma_f32 v219, v219, s71, -v1
 v_fma_f32 v220, v220, s71, -v1
 v_fma_f32 v221, v221, s71, -v1
 v_exp_f32 v210, v210
 v_exp_f32 v211, v211
 v_exp_f32 v212, v212
 v_exp_f32 v213, v213
 v_exp_f32 v214, v214
 v_exp_f32 v215, v215
 v_exp_f32 v216, v216
 v_exp_f32 v217, v217
 s_mov_b32 exec_lo, 0x00ff00ff
 s_mov_b32 exec_hi, 0x00ff00ff
 v_cvt_pk_bf16_f32 v162, v210, v211
 v_cvt_pk_bf16_f32 v163, v212, v213
 v_cvt_pk_bf16_f32 v164, v214, v215
 v_cvt_pk_bf16_f32 v165, v216, v217
 s_not_b64 exec, exec
 v_cvt_pk_bf16_f32 v166, v210, v211
 v_cvt_pk_bf16_f32 v167, v212, v213
 v_cvt_pk_bf16_f32 v168, v214, v215
 v_cvt_pk_bf16_f32 v169, v216, v217
 s_mov_b64 exec, -1
 v_mfma_f32_16x16x32_bf16 v[200:203], v[186:189], v[162:165], 0
 v_exp_f32 v218, v218
 v_exp_f32 v219, v219
 v_mfma_f32_16x16x32_bf16 v[192:195], v[142:145], v[162:165], 0
 v_exp_f32 v220, v220
 v_exp_f32 v221, v221
 v_mfma_f32_16x16x32_bf16 v[200:203], v[186:189], v[166:169], v[200:203]
 v_cvt_pk_bf16_f32 v190, v218, v219
 v_mfma_f32_16x16x32_bf16 v[192:195], v[150:153], v[166:169], v[192:195]
 v_cvt_pk_bf16_f32 v191, v220, v221
 s_nop 1
 v_mfma_f32_16x16x16_bf16 v[200:203], v[186:187], v[190:191], v[200:203]
 s_add_u32 s25, s61, s55
 s_add_u32 s27, s61, s56
 v_mfma_f32_16x16x16_bf16 v[192:195], v[178:179], v[190:191], v[192:195]
 s_add_u32 s28, s27, 4096
 s_mov_b32 s41, 0
 s_nop 2
 v_rcp_f32 v127, v200
 s_nop 1
 v_mul_f32 v192, v192, v127
 v_mul_f32 v193, v193, v127
 v_mul_f32 v194, v194, v127
 v_mul_f32 v195, v195, v127
 v_cvt_pk_bf16_f32 v204, v192, v193
 v_cvt_pk_bf16_f32 v205, v194, v195
 buffer_store_dwordx2 v[204:205], v2, s[4:7], s25 offen
 ds_write_b64 v118, v[178:179] offset:1024
 ds_read_b128 v[142:145], v115 offset:0
 ds_read_b128 v[146:149], v115 offset:1024
 ds_read_b128 v[150:153], v115 offset:2048
 ds_read_b128 v[154:157], v115 offset:3072
 ds_read_b128 v[234:237], v115 offset:4096
 ds_read_b128 v[238:241], v115 offset:5120
 ds_read_b128 v[242:245], v115 offset:6144
 ds_read_b128 v[246:249], v115 offset:7168
 ds_read_b128 v[250:253], v115 offset:8192
 s_sleep 2
 buffer_load_dwordx4 v[190:193], v2, s[4:7], s27 offen offset:0 sc1
 buffer_load_dwordx4 v[194:197], v2, s[4:7], s27 offen offset:1024 sc1
 buffer_load_dwordx4 v[198:201], v2, s[4:7], s27 offen offset:2048 sc1
 buffer_load_dwordx4 v[202:205], v2, s[4:7], s27 offen offset:3072 sc1
 buffer_load_dwordx4 v[206:209], v2, s[4:7], s28 offen offset:0 sc1
 buffer_load_dwordx4 v[210:213], v2, s[4:7], s28 offen offset:1024 sc1
 s_waitcnt lgkmcnt(0)
Lo_123:
 s_waitcnt vmcnt(5)
 v_max3_u32 v1, v190, v191, v192
 v_max_u32 v1, v1, v193
 v_cmp_eq_u32 vcc, -1, v1
 s_cbranch_vccnz Los_124
 v_mfma_f32_16x16x32_bf16 v[214:217], v[142:145], v[190:193], 0
 ds_read_b128 v[142:145], v115 offset:9216
 v_mfma_f32_16x16x32_bf16 v[218:221], v[146:149], v[190:193], 0
 ds_read_b128 v[146:149], v115 offset:10240
 s_waitcnt vmcnt(4)
 v_max3_u32 v1, v194, v195, v196
 v_mfma_f32_16x16x32_bf16 v[222:225], v[150:153], v[190:193], 0
 ds_read_b128 v[150:153], v115 offset:11264
 v_max_u32 v1, v1, v197
 v_mfma_f32_16x16x32_bf16 v[226:229], v[154:157], v[190:193], 0
 ds_read_b128 v[154:157], v115 offset:12288
 v_cmp_eq_u32 vcc, -1, v1
 v_mfma_f32_16x16x32_bf16 v[230:233], v[234:237], v[190:193], 0
 ds_read_b128 v[234:237], v115 offset:13312
Lo_125:
 s_cbranch_vccnz Los_126
 v_mfma_f32_16x16x32_bf16 v[214:217], v[238:241], v[194:197], v[214:217]
 ds_read_b128 v[238:241], v115 offset:14336
 v_mfma_f32_16x16x32_bf16 v[218:221], v[242:245], v[194:197], v[218:221]
 ds_read_b128 v[242:245], v116 offset:0
 s_waitcnt vmcnt(3)
 v_max3_u32 v1, v198, v199, v200
 v_mfma_f32_16x16x32_bf16 v[222:225], v[246:249], v[194:197], v[222:225]
 ds_read_b128 v[246:249], v116 offset:1024
 v_max_u32 v1, v1, v201
 v_mfma_f32_16x16x32_bf16 v[226:229], v[250:253], v[194:197], v[226:229]
 ds_read_b128 v[250:253], v116 offset:2048
 v_cmp_eq_u32 vcc, -1, v1
 s_waitcnt lgkmcnt(7)
 v_mfma_f32_16x16x32_bf16 v[230:233], v[142:145], v[194:197], v[230:233]
 ds_read_b128 v[142:145], v116 offset:3072
Lo_127:
 s_cbranch_vccnz Los_128
 v_mfma_f32_16x16x32_bf16 v[214:217], v[146:149], v[198:201], v[214:217]
 ds_read_b128 v[146:149], v116 offset:4096
 s_waitcnt lgkmcnt(7)
 v_mfma_f32_16x16x32_bf16 v[218:221], v[150:153], v[198:201], v[218:221]
 ds_read_b128 v[150:153], v116 offset:5120
 s_waitcnt vmcnt(2)
 v_max3_u32 v1, v202, v203, v204
 v_mfma_f32_16x16x32_bf16 v[222:225], v[154:157], v[198:201], v[222:225]
 ds_read_b128 v[154:157], v116 offset:6144
 v_max_u32 v1, v1, v205
 s_waitcnt lgkmcnt(7)
 v_mfma_f32_16x16x32_bf16 v[226:229], v[234:237], v[198:201], v[226:229]
 ds_read_b128 v[234:237], v116 offset:7168
 v_cmp_eq_u32 vcc, -1, v1
 v_mfma_f32_16x16x32_bf16 v[230:233], v[238:241], v[198:201], v[230:233]
 ds_read_b128 v[238:241], v116 offset:8192
Lo_129:
 s_cbranch_vccnz Los_130
 s_waitcnt lgkmcnt(7)
 v_mfma_f32_16x16x32_bf16 v[214:217], v[242:245], v[202:205], v[214:217]
 ds_read_b128 v[242:245], v116 offset:9216
 v_mfma_f32_16x16x32_bf16 v[218:221], v[246:249], v[202:205], v[218:221]
 ds_read_b128 v[246:249], v116 offset:10240
 s_waitcnt vmcnt(1)
 v_max3_u32 v1, v206, v207, v208
 s_waitcnt lgkmcnt(7)
 v_mfma_f32_16x16x32_bf16 v[222:225], v[250:253], v[202:205], v[222:225]
 ds_read_b128 v[250:253], v116 offset:11264
 v_max_u32 v1, v1, v209
 v_mfma_f32_16x16x32_bf16 v[226:229], v[142:145], v[202:205], v[226:229]
 ds_read_b128 v[142:145], v116 offset:12288
 v_cmp_eq_u32 vcc, -1, v1
 s_waitcnt lgkmcnt(7)
 v_mfma_f32_16x16x32_bf16 v[230:233], v[146:149], v[202:205], v[230:233]
 ds_read_b128 v[146:149], v116 offset:13312
Lo_131:
 s_cbranch_vccnz Los_132
 v_mfma_f32_16x16x32_bf16 v[214:217], v[150:153], v[206:209], v[214:217]
 ds_read_b128 v[150:153], v116 offset:14336
 s_waitcnt lgkmcnt(7)
 v_mfma_f32_16x16x32_bf16 v[218:221], v[154:157], v[206:209], v[218:221]
 s_waitcnt vmcnt(0)
 v_max3_u32 v1, v210, v211, v212
 v_mfma_f32_16x16x32_bf16 v[222:225], v[234:237], v[206:209], v[222:225]
 v_max_u32 v1, v1, v213
 s_waitcnt lgkmcnt(5)
 v_mfma_f32_16x16x32_bf16 v[226:229], v[238:241], v[206:209], v[226:229]
 v_cmp_eq_u32 vcc, -1, v1
 v_mfma_f32_16x16x32_bf16 v[230:233], v[242:245], v[206:209], v[230:233]
Lo_133:
 s_cbranch_vccnz Los_134
 s_waitcnt lgkmcnt(3)
 v_mfma_f32_16x16x32_bf16 v[214:217], v[246:249], v[210:213], v[214:217]
 buffer_load_dwordx4 v[130:133], v2, s[4:7], s67 offen sc1
 v_mfma_f32_16x16x32_bf16 v[218:221], v[250:253], v[210:213], v[218:221]
 buffer_load_dwordx4 v[134:137], v2, s[4:7], s67 offen offset:2048 sc1
 s_waitcnt lgkmcnt(1)
 v_mfma_f32_16x16x32_bf16 v[222:225], v[142:145], v[210:213], v[222:225]
 s_add_u32 s25, s67, 4096
 buffer_load_dwordx4 v[138:141], v2, s[4:7], s25 offen sc1
 v_mfma_f32_16x16x32_bf16 v[226:229], v[146:149], v[210:213], v[226:229]
 s_waitcnt lgkmcnt(0)
 v_mfma_f32_16x16x32_bf16 v[230:233], v[150:153], v[210:213], v[230:233]
 v_cvt_pk_bf16_f32 v190, v214, v215
 v_cvt_pk_bf16_f32 v191, v216, v217
 v_cvt_pk_bf16_f32 v192, v218, v219
 v_cvt_pk_bf16_f32 v193, v220, v221
 ds_write_b128 v119, v[190:193]
 v_cvt_pk_bf16_f32 v194, v222, v223
 v_cvt_pk_bf16_f32 v195, v224, v225
 v_cvt_pk_bf16_f32 v196, v226, v227
 v_cvt_pk_bf16_f32 v197, v228, v229
 ds_write_b128 v119, v[194:197] offset:4096
 v_cvt_pk_bf16_f32 v198, v230, v231
 v_cvt_pk_bf16_f32 v199, v232, v233
 ds_write_b64 v120, v[198:199] offset:8192
 s_add_u32 s25, s63, s46
 s_add_u32 s26, s63, s47
 s_add_u32 s27, s25, 655360
 s_add_u32 s28, s26, 655360
 s_waitcnt lgkmcnt(0)
 s_barrier
 ds_read_b128 v[190:193], v121 offset:0
 ds_read_b128 v[194:197], v121 offset:1024
 s_waitcnt lgkmcnt(1)
 v_mfma_f32_16x16x32_bf16 v[206:209], v[170:173], v[190:193], 0
 s_waitcnt lgkmcnt(0)
 v_mfma_f32_16x16x32_bf16 v[206:209], v[174:177], v[194:197], v[206:209]
 s_nop 7
 v_cvt_pk_bf16_f32 v214, v206, v207
 v_cvt_pk_bf16_f32 v215, v208, v209
 buffer_store_dwordx2 v[214:215], v122, s[4:7], s25 offen sc1
 buffer_store_dwordx2 v[214:215], v122, s[4:7], s27 offen
 s_add_u32 s27, s63, s48
 s_add_u32 s28, s63, s49
 s_add_u32 s70, s31, 1
 s_and_b32 s25, s70, 3
 s_mul_i32 s26, s25, 20480
 s_add_u32 s57, s26, s42
 s_add_u32 s58, s57, 4096
 s_add_u32 s59, s26, s43
 s_mul_i32 s63, s25, 163840
 s_xor_b32 s26, s25, 2
 s_mul_i32 s64, s26, 163840
 s_add_u32 s25, s25, 3
 s_and_b32 s25, s25, 3
 s_mul_i32 s26, s25, 20480
 s_add_u32 s60, s26, s43
 s_and_b32 s25, s70, 1
 s_mul_i32 s61, s25, 196608
 s_xor_b32 s25, s25, 1
 s_mul_i32 s62, s25, 196608
 s_mul_i32 s70, s70, 196608
 s_cmp_eq_u32 s40, 0
 s_cbranch_scc1 Lnr_135
 s_sleep 6
 s_mov_b32 s41, 0
 buffer_load_dwordx4 v[190:193], v2, s[4:7], s27 offen sc1
 buffer_load_dwordx4 v[194:197], v2, s[4:7], s28 offen sc1
Lj_136:
 s_waitcnt vmcnt(1)
 v_mfma_f32_16x16x32_bf16 v[198:201], v[170:173], v[190:193], 0
 s_waitcnt vmcnt(0)
 v_mfma_f32_16x16x32_bf16 v[198:201], v[170:173], v[194:197], v[198:201]
 v_max3_u32 v202, v190, v191, v192
 v_max3_u32 v202, v202, v193, v194
 v_max3_u32 v202, v202, v195, v196
 v_max_u32 v202, v202, v197
 v_cmp_eq_u32 vcc, -1, v202
 s_cbranch_vccnz Ljs_137
 s_nop 1
 v_cvt_pk_bf16_f32 v202, v198, v199
 v_cvt_pk_bf16_f32 v203, v200, v201
 s_mov_b64 exec, 0xffffffff
 s_cmp_eq_u32 s31, 7
 s_cbranch_scc1 Lov_138
Lnov_139:
 buffer_store_dwordx2 v[202:203], v123, s[4:7], s59 offen
 buffer_store_dwordx2 v[182:183], v123, s[4:7], s60 offen
 s_mov_b64 exec, -1
Lnr_135:
 s_add_u32 s31, s31, 1
 s_cmp_lt_u32 s31, 72
 s_barrier
 s_cbranch_scc1 L_rec_top_2l
 s_waitcnt vmcnt(0)
 s_barrier
 s_endpgm
Lzs_109:
 buffer_load_dwordx4 v[190:193], v2, s[4:7], s57 offen offset:0 sc1
 buffer_load_dwordx4 v[194:197], v2, s[4:7], s57 offen offset:1024 sc1
 buffer_load_dwordx4 v[198:201], v2, s[4:7], s57 offen offset:2048 sc1
 buffer_load_dwordx4 v[202:205], v2, s[4:7], s57 offen offset:3072 sc1
 buffer_load_dwordx4 v[206:209], v2, s[4:7], s58 offen offset:0 sc1
 s_add_u32 s41, s41, 1
 s_cmp_gt_u32 s41, 200000
 s_cbranch_scc1 L_fail
 s_branch Lz_108
Lzs_111:
 buffer_load_dwordx4 v[194:197], v2, s[4:7], s57 offen offset:1024 sc1
 buffer_load_dwordx4 v[198:201], v2, s[4:7], s57 offen offset:2048 sc1
 buffer_load_dwordx4 v[202:205], v2, s[4:7], s57 offen offset:3072 sc1
 buffer_load_dwordx4 v[206:209], v2, s[4:7], s58 offen offset:0 sc1
 s_add_u32 s41, s41, 1
 s_cmp_gt_u32 s41, 200000
 s_cbranch_scc1 L_fail
 s_branch Lz_110
Lzs_113:
 buffer_load_dwordx4 v[198:201], v2, s[4:7], s57 offen offset:2048 sc1
 buffer_load_dwordx4 v[202:205], v2, s[4:7], s57 offen offset:3072 sc1
 buffer_load_dwordx4 v[206:209], v2, s[4:7], s58 offen offset:0 sc1
 s_add_u32 s41, s41, 1
 s_cmp_gt_u32 s41, 200000
 s_cbranch_scc1 L_fail
 s_branch Lz_112
Lzs_115:
 buffer_load_dwordx4 v[202:205], v2, s[4:7], s57 offen offset:3072 sc1
 buffer_load_dwordx4 v[206:209], v2, s[4:7], s58 offen offset:0 sc1
 s_add_u32 s41, s41, 1
 s_cmp_gt_u32 s41, 200000
 s_cbranch_scc1 L_fail
 s_branch Lz_114
Lzs_117:
 buffer_load_dwordx4 v[206:209], v2, s[4:7], s58 offen offset:0 sc1
 s_add_u32 s41, s41, 1
 s_cmp_gt_u32 s41, 200000
 s_cbranch_scc1 L_fail
 s_branch Lz_116
Lfs_121:
 v_max3_u32 v222, v194, v195, v196
 v_max3_u32 v222, v222, v197, v198
 v_max3_u32 v222, v222, v199, v200
 v_max3_u32 v222, v222, v201, v202
 v_max3_u32 v222, v222, v203, v204
 v_max_u32 v222, v222, v205
 v_cmp_eq_u32 vcc, -1, v222
 s_cbranch_vccz Lfok_122
 buffer_load_dwordx4 v[194:197], v2, s[4:7], s27 offen offset:0 sc1
 buffer_load_dwordx4 v[198:201], v2, s[4:7], s27 offen offset:1024 sc1
 buffer_load_dwordx4 v[202:205], v2, s[4:7], s27 offen offset:2048 sc1
 s_add_u32 s41, s41, 1
 s_cmp_gt_u32 s41, 200000
 s_cbranch_scc1 L_fail
 s_branch Lf_120
Los_124:
 buffer_load_dwordx4 v[190:193], v2, s[4:7], s27 offen offset:0 sc1
 buffer_load_dwordx4 v[194:197], v2, s[4:7], s27 offen offset:1024 sc1
 buffer_load_dwordx4 v[198:201], v2, s[4:7], s27 offen offset:2048 sc1
 buffer_load_dwordx4 v[202:205], v2, s[4:7], s27 offen offset:3072 sc1
 buffer_load_dwordx4 v[206:209], v2, s[4:7], s28 offen offset:0 sc1
 buffer_load_dwordx4 v[210:213], v2, s[4:7], s28 offen offset:1024 sc1
 s_add_u32 s41, s41, 1
 s_cmp_gt_u32 s41, 200000
 s_cbranch_scc1 L_fail
 s_branch Lo_123
Los_126:
 buffer_load_dwordx4 v[194:197], v2, s[4:7], s27 offen offset:1024 sc1
 buffer_load_dwordx4 v[198:201], v2, s[4:7], s27 offen offset:2048 sc1
 buffer_load_dwordx4 v[202:205], v2, s[4:7], s27 offen offset:3072 sc1
 buffer_load_dwordx4 v[206:209], v2, s[4:7], s28 offen offset:0 sc1
 buffer_load_dwordx4 v[210:213], v2, s[4:7], s28 offen offset:1024 sc1
 s_waitcnt vmcnt(4)
 v_max3_u32 v1, v194, v195, v196
 v_max_u32 v1, v1, v197
 v_cmp_eq_u32 vcc, -1, v1
 s_add_u32 s41, s41, 1
 s_cmp_gt_u32 s41, 200000
 s_cbranch_scc1 L_fail
 s_branch Lo_125
Los_128:
 buffer_load_dwordx4 v[198:201], v2, s[4:7], s27 offen offset:2048 sc1
 buffer_load_dwordx4 v[202:205], v2, s[4:7], s27 offen offset:3072 sc1
 buffer_load_dwordx4 v[206:209], v2, s[4:7], s28 offen offset:0 sc1
 buffer_load_dwordx4 v[210:213], v2, s[4:7], s28 offen offset:1024 sc1
 s_waitcnt vmcnt(3)
 v_max3_u32 v1, v198, v199, v200
 v_max_u32 v1, v1, v201
 v_cmp_eq_u32 vcc, -1, v1
 s_add_u32 s41, s41, 1
 s_cmp_gt_u32 s41, 200000
 s_cbranch_scc1 L_fail
 s_branch Lo_127
Los_130:
 buffer_load_dwordx4 v[202:205], v2, s[4:7], s27 offen offset:3072 sc1
 buffer_load_dwordx4 v[206:209], v2, s[4:7], s28 offen offset:0 sc1
 buffer_load_dwordx4 v[210:213], v2, s[4:7], s28 offen offset:1024 sc1
 s_waitcnt vmcnt(2)
 v_max3_u32 v1, v202, v203, v204
 v_max_u32 v1, v1, v205
 v_cmp_eq_u32 vcc, -1, v1
 s_add_u32 s41, s41, 1
 s_cmp_gt_u32 s41, 200000
 s_cbranch_scc1 L_fail
 s_branch Lo_129
Los_132:
 buffer_load_dwordx4 v[206:209], v2, s[4:7], s28 offen offset:0 sc1
 buffer_load_dwordx4 v[210:213], v2, s[4:7], s28 offen offset:1024 sc1
 s_waitcnt vmcnt(1)
 v_max3_u32 v1, v206, v207, v208
 v_max_u32 v1, v1, v209
 v_cmp_eq_u32 vcc, -1, v1
 s_add_u32 s41, s41, 1
 s_cmp_gt_u32 s41, 200000
 s_cbranch_scc1 L_fail
 s_branch Lo_131
Los_134:
 buffer_load_dwordx4 v[210:213], v2, s[4:7], s28 offen offset:1024 sc1
 s_waitcnt vmcnt(0)
 v_max3_u32 v1, v210, v211, v212
 v_max_u32 v1, v1, v213
 v_cmp_eq_u32 vcc, -1, v1
 s_add_u32 s41, s41, 1
 s_cmp_gt_u32 s41, 200000
 s_cbranch_scc1 L_fail
 s_branch Lo_133
Ljs_137:
 buffer_load_dwordx4 v[190:193], v2, s[4:7], s27 offen sc1
 buffer_load_dwordx4 v[194:197], v2, s[4:7], s28 offen sc1
 s_add_u32 s41, s41, 1
 s_cmp_gt_u32 s41, 200000
 s_cbranch_scc1 L_fail
 s_branch Lj_136
Lov_138:
 s_mov_b32 exec_lo, 0xff00ff00
 v_mov_b32 v202, v128
 v_mov_b32 v203, v129
 s_mov_b32 exec_lo, -1
 s_add_u32 s41, s41, 1
 s_cmp_gt_u32 s41, 200000
 s_cbranch_scc1 L_fail
 s_branch Lnov_139
Lpwn_106:
 s_waitcnt vmcnt(0)
 s_barrier
L_rec_top_3l:
 s_sleep 2
 buffer_load_dwordx4 v[190:193], v2, s[4:7], s57 offen offset:0 sc1
 buffer_load_dwordx4 v[194:197], v2, s[4:7], s57 offen offset:1024 sc1
 buffer_load_dwordx4 v[198:201], v2, s[4:7], s57 offen offset:2048 sc1
 buffer_load_dwordx4 v[202:205], v2, s[4:7], s57 offen offset:3072 sc1
 buffer_load_dwordx4 v[206:209], v2, s[4:7], s58 offen offset:0 sc1
 s_mov_b32 s41, 0
Lz_142:
 s_waitcnt vmcnt(4)
 ds_write_b128 v109, v[190:193] offset:0
 v_mfma_f32_16x16x32_bf16 v[226:229], a[0:3], v[190:193], 0
 v_max3_u32 v1, v190, v191, v192
 v_max_u32 v1, v1, v193
 v_mfma_f32_16x16x32_bf16 v[230:233], a[80:83], v[190:193], 0
 v_cmp_eq_u32 vcc, -1, v1
 v_mfma_f32_16x16x32_bf16 v[234:237], a[160:163], v[190:193], 0
 s_cbranch_vccnz Lzs_143
Lz_144:
 s_waitcnt vmcnt(3)
 ds_write_b128 v109, v[194:197] offset:1024
 v_max3_u32 v1, v194, v195, v196
 v_max_u32 v1, v1, v197
 v_cmp_eq_u32 vcc, -1, v1
 s_cbranch_vccnz Lzs_145
 v_mfma_f32_16x16x32_bf16 v[226:229], a[4:7], v[194:197], v[226:229]
 v_mfma_f32_16x16x32_bf16 v[230:233], a[84:87], v[194:197], v[230:233]
 v_mfma_f32_16x16x32_bf16 v[234:237], a[164:167], v[194:197], v[234:237]
Lz_146:
 s_waitcnt vmcnt(2)
 ds_write_b128 v109, v[198:201] offset:2048
 v_max3_u32 v1, v198, v199, v200
 v_max_u32 v1, v1, v201
 v_cmp_eq_u32 vcc, -1, v1
 s_cbranch_vccnz Lzs_147
 v_mfma_f32_16x16x32_bf16 v[226:229], a[8:11], v[198:201], v[226:229]
 v_mfma_f32_16x16x32_bf16 v[230:233], a[88:91], v[198:201], v[230:233]
 v_mfma_f32_16x16x32_bf16 v[234:237], a[168:171], v[198:201], v[234:237]
Lz_148:
 s_waitcnt vmcnt(1)
 ds_write_b128 v109, v[202:205] offset:3072
 v_max3_u32 v1, v202, v203, v204
 v_max_u32 v1, v1, v205
 v_cmp_eq_u32 vcc, -1, v1
 s_cbranch_vccnz Lzs_149
Lz_150:
 s_waitcnt vmcnt(0)
 ds_write_b128 v109, v[206:209] offset:4096
 v_max3_u32 v1, v206, v207, v208
 v_max_u32 v1, v1, v209
 v_cmp_eq_u32 vcc, -1, v1
 s_cbranch_vccnz Lzs_151
 s_waitcnt lgkmcnt(0)
 s_barrier
 ds_read_b128 v[214:217], v110 offset:0
 ds_read_b128 v[218:221], v110 offset:1024
 ds_read_b128 v[222:225], v110 offset:2048
 v_mfma_f32_16x16x32_bf16 v[226:229], a[12:15], v[202:205], v[226:229]
 s_add_u32 s25, s68, s51
 v_mfma_f32_16x16x32_bf16 v[230:233], a[92:95], v[202:205], v[230:233]
 buffer_load_dwordx4 v[142:145], v2, s[4:7], s25 offen sc1
 v_mfma_f32_16x16x32_bf16 v[234:237], a[172:175], v[202:205], v[234:237]
 v_mfma_f32_16x16x32_bf16 v[226:229], a[16:19], v[206:209], v[226:229]
 s_add_u32 s25, s69, s51
 v_mfma_f32_16x16x32_bf16 v[230:233], a[96:99], v[206:209], v[230:233]
 buffer_load_dwordx4 v[150:153], v2, s[4:7], s25 offen sc1
 v_mfma_f32_16x16x32_bf16 v[234:237], a[176:179], v[206:209], v[234:237]
 ds_read_b128 v[210:213], v110 offset:3072
 s_waitcnt lgkmcnt(3)
 v_mfma_f32_16x16x32_bf16 v[226:229], a[20:23], v[214:217], v[226:229]
 s_add_u32 s25, s44, s62
 v_mfma_f32_16x16x32_bf16 v[230:233], a[100:103], v[214:217], v[230:233]
 buffer_store_dwordx4 v[182:185], v2, s[4:7], s25 offen offset:2048
 v_mfma_f32_16x16x32_bf16 v[234:237], a[180:183], v[214:217], v[234:237]
 ds_read_b128 v[214:217], v110 offset:4096
 s_waitcnt lgkmcnt(3)
 v_mfma_f32_16x16x32_bf16 v[226:229], a[24:27], v[218:221], v[226:229]
 s_add_u32 s25, s44, s62
 v_mfma_f32_16x16x32_bf16 v[230:233], a[104:107], v[218:221], v[230:233]
 s_add_u32 s25, s25, 1867776
 v_mfma_f32_16x16x32_bf16 v[234:237], a[184:187], v[218:221], v[234:237]
 buffer_store_dwordx4 v[182:185], v2, s[4:7], s25 offen offset:2048
 ds_read_b128 v[218:221], v111 offset:0
 s_waitcnt lgkmcnt(3)
 v_mfma_f32_16x16x32_bf16 v[226:229], a[28:31], v[222:225], v[226:229]
 s_add_u32 s25, s46, s64
 v_mfma_f32_16x16x32_bf16 v[230:233], a[108:111], v[222:225], v[230:233]
 buffer_store_dwordx2 v[182:183], v122, s[4:7], s25 offen sc1
 v_mfma_f32_16x16x32_bf16 v[234:237], a[188:191], v[222:225], v[234:237]
 ds_read_b128 v[222:225], v111 offset:1024
 s_waitcnt lgkmcnt(3)
 v_mfma_f32_16x16x32_bf16 v[226:229], a[32:35], v[210:213], v[226:229]
 s_add_u32 s25, s25, 655360
 v_mfma_f32_16x16x32_bf16 v[230:233], a[112:115], v[210:213], v[230:233]
 buffer_store_dwordx2 v[182:183], v122, s[4:7], s25 offen
 v_mfma_f32_16x16x32_bf16 v[234:237], a[192:195], v[210:213], v[234:237]
 ds_read_b128 v[210:213], v111 offset:2048
 s_waitcnt lgkmcnt(3)
 v_mfma_f32_16x16x32_bf16 v[226:229], a[36:39], v[214:217], v[226:229]
 s_add_u32 s25, s47, s64
 v_mfma_f32_16x16x32_bf16 v[230:233], a[116:119], v[214:217], v[230:233]
 buffer_store_dwordx2 v[182:183], v122, s[4:7], s25 offen sc1
 v_mfma_f32_16x16x32_bf16 v[234:237], a[196:199], v[214:217], v[234:237]
 ds_read_b128 v[214:217], v111 offset:3072
 s_waitcnt lgkmcnt(3)
 v_mfma_f32_16x16x32_bf16 v[226:229], a[40:43], v[218:221], v[226:229]
 s_add_u32 s25, s25, 655360
 v_mfma_f32_16x16x32_bf16 v[230:233], a[120:123], v[218:221], v[230:233]
 buffer_store_dwordx2 v[182:183], v122, s[4:7], s25 offen
 v_mfma_f32_16x16x32_bf16 v[234:237], a[200:203], v[218:221], v[234:237]
 ds_read_b128 v[218:221], v111 offset:4096
 s_waitcnt lgkmcnt(3)
 v_mfma_f32_16x16x32_bf16 v[226:229], a[44:47], v[222:225], v[226:229]
 s_add_u32 s25, s31, 1
 s_mul_i32 s68, s25, 393216
 v_mfma_f32_16x16x32_bf16 v[230:233], a[124:127], v[222:225], v[230:233]
 s_add_u32 s68, s68, 84066304
 s_cmp_lt_u32 s25, 64
 v_mfma_f32_16x16x32_bf16 v[234:237], a[204:207], v[222:225], v[234:237]
 s_cselect_b32 s68, s68, 2146435072
 ds_read_b128 v[222:225], v112 offset:0
 s_waitcnt lgkmcnt(3)
 v_mfma_f32_16x16x32_bf16 v[226:229], a[48:51], v[210:213], v[226:229]
 s_sub_u32 s26, s25, 8
 s_mul_i32 s69, s26, 393216
 v_mfma_f32_16x16x32_bf16 v[230:233], a[128:131], v[210:213], v[230:233]
 s_add_u32 s69, s69, 134397952
 s_cmp_lt_u32 s26, 64
 v_mfma_f32_16x16x32_bf16 v[234:237], a[208:211], v[210:213], v[234:237]
 s_cselect_b32 s69, s69, 2146435072
 ds_read_b128 v[210:213], v112 offset:1024
 s_waitcnt lgkmcnt(3)
 v_mfma_f32_16x16x32_bf16 v[226:229], a[52:55], v[214:217], v[226:229]
 s_add_u32 s25, s68, 4269801472
 s_add_u32 s26, s69, 4269801472
 v_mfma_f32_16x16x32_bf16 v[230:233], a[132:135], v[214:217], v[230:233]
 s_cmp_lt_u32 s3, 2
 s_cselect_b32 s67, s25, s26
 v_mfma_f32_16x16x32_bf16 v[234:237], a[212:215], v[214:217], v[234:237]
 s_add_u32 s67, s67, s50
 ds_read_b128 v[214:217], v112 offset:2048
 s_waitcnt lgkmcnt(3)
 v_mfma_f32_16x16x32_bf16 v[226:229], a[56:59], v[218:221], v[226:229]
 v_mfma_f32_16x16x32_bf16 v[230:233], a[136:139], v[218:221], v[230:233]
 v_mfma_f32_16x16x32_bf16 v[234:237], a[216:219], v[218:221], v[234:237]
 ds_read_b128 v[218:221], v112 offset:3072
 s_waitcnt lgkmcnt(3)
 v_mfma_f32_16x16x32_bf16 v[226:229], a[60:63], v[222:225], v[226:229]
 v_mfma_f32_16x16x32_bf16 v[230:233], a[140:143], v[222:225], v[230:233]
 v_mfma_f32_16x16x32_bf16 v[234:237], a[220:223], v[222:225], v[234:237]
 ds_read_b128 v[222:225], v112 offset:4096
 s_waitcnt lgkmcnt(3)
 v_mfma_f32_16x16x32_bf16 v[226:229], a[64:67], v[210:213], v[226:229]
 v_mfma_f32_16x16x32_bf16 v[230:233], a[144:147], v[210:213], v[230:233]
 v_mfma_f32_16x16x32_bf16 v[234:237], a[224:227], v[210:213], v[234:237]
 s_waitcnt lgkmcnt(2)
 v_mfma_f32_16x16x32_bf16 v[226:229], a[68:71], v[214:217], v[226:229]
 v_mfma_f32_16x16x32_bf16 v[230:233], a[148:151], v[214:217], v[230:233]
 v_mfma_f32_16x16x32_bf16 v[234:237], a[228:231], v[214:217], v[234:237]
 s_waitcnt lgkmcnt(1)
 v_mfma_f32_16x16x32_bf16 v[226:229], a[72:75], v[218:221], v[226:229]
 v_mfma_f32_16x16x32_bf16 v[230:233], a[152:155], v[218:221], v[230:233]
 v_mfma_f32_16x16x32_bf16 v[234:237], a[232:235], v[218:221], v[234:237]
 s_waitcnt lgkmcnt(0)
 v_mfma_f32_16x16x32_bf16 v[226:229], a[76:79], v[222:225], v[226:229]
 v_mfma_f32_16x16x32_bf16 v[230:233], a[156:159], v[222:225], v[230:233]
 v_mfma_f32_16x16x32_bf16 v[234:237], a[236:239], v[222:225], v[234:237]
 s_nop 1
 v_cvt_pk_bf16_f32 v190, v226, v227
 v_cvt_pk_bf16_f32 v191, v228, v229
 ds_write_b64 v113, v[190:191] offset:0
 v_cvt_pk_bf16_f32 v192, v230, v231
 v_cvt_pk_bf16_f32 v193, v232, v233
 ds_write_b64 v114, v[192:193] offset:0
 v_cvt_pk_bf16_f32 v194, v234, v235
 v_cvt_pk_bf16_f32 v195, v236, v237
 ds_write_b64 v113, v[194:195] offset:1024
 s_add_u32 s26, s61, s44
 s_add_u32 s27, s61, s45
 s_waitcnt lgkmcnt(0)
 s_barrier
 ds_read_b128 v[198:201], v3 offset:20480
 ds_read_b128 v[202:205], v3 offset:21504
 ds_read_b128 v[206:209], v3 offset:22528
 ds_read_b128 v[226:229], v3 offset:23552
 ds_read_b128 v[230:233], v3 offset:24576
 ds_read_b128 v[234:237], v3 offset:25600
 ds_read_b128 v[210:213], v109 offset:0
 ds_read_b128 v[214:217], v109 offset:1024
 ds_read_b128 v[218:221], v109 offset:2048
 s_waitcnt lgkmcnt(8)
 v_mfma_f32_16x16x32_bf16 v[194:197], v[130:133], v[198:201], 0
 s_waitcnt lgkmcnt(7)
 v_mfma_f32_16x16x32_bf16 v[194:197], v[134:137], v[202:205], v[194:197]
 s_waitcnt lgkmcnt(6)
 v_mfma_f32_16x16x32_bf16 v[194:197], v[138:141], v[206:209], v[194:197]
 s_waitcnt lgkmcnt(5)
 v_mfma_f32_16x16x32_bf16 v[190:193], v[226:229], v[198:201], v[158:161]
 s_waitcnt lgkmcnt(4)
 v_mfma_f32_16x16x32_bf16 v[190:193], v[230:233], v[202:205], v[190:193]
 s_mov_b32 exec_lo, 0xff00ff00
 s_mov_b32 exec_hi, 0xff00ff00
 s_waitcnt lgkmcnt(3)
 v_mfma_f32_16x16x32_bf16 v[190:193], v[234:237], v[206:209], v[190:193]
 buffer_store_dwordx4 v[194:197], v2, s[4:7], s26 offen offset:1024
 ds_write_b128 v117, v[194:197] offset:26624
 s_mov_b64 exec, -1
 ds_read_b128 v[222:225], v109 offset:3072
 s_waitcnt lgkmcnt(4)
 v_mfma_f32_16x16x32_bf16 v[226:229], v[210:213], a[240:243], 0
 v_mfma_f32_16x16x32_bf16 v[230:233], v[210:213], v[68:71], 0
 s_nop 0
 buffer_store_dwordx4 v[190:193], v2, s[4:7], s26 offen offset:2048
 ds_read_b128 v[210:213], v109 offset:4096
 s_waitcnt lgkmcnt(4)
 v_mfma_f32_16x16x32_bf16 v[226:229], v[214:217], a[244:247], v[226:229]
 v_mfma_f32_16x16x32_bf16 v[230:233], v[214:217], v[72:75], v[230:233]
 ds_read_b128 v[214:217], v110 offset:0
 s_waitcnt lgkmcnt(4)
 v_mfma_f32_16x16x32_bf16 v[226:229], v[218:221], a[248:251], v[226:229]
 v_mfma_f32_16x16x32_bf16 v[230:233], v[218:221], v[76:79], v[230:233]
 buffer_load_dword v126, v124, s[4:7], 0 offen sc1
 ds_read_b128 v[218:221], v110 offset:1024
 s_waitcnt lgkmcnt(3)
 v_mfma_f32_16x16x32_bf16 v[226:229], v[222:225], a[252:255], v[226:229]
 v_mfma_f32_16x16x32_bf16 v[230:233], v[222:225], v[80:83], v[230:233]
 ds_read_b128 v[222:225], v110 offset:2048
 s_waitcnt lgkmcnt(3)
 v_mfma_f32_16x16x32_bf16 v[226:229], v[210:213], v[4:7], v[226:229]
 v_mfma_f32_16x16x32_bf16 v[230:233], v[210:213], v[84:87], v[230:233]
 s_barrier
 ds_read_b128 v[234:237], v3 offset:26624
 ds_read_b128 v[238:241], v3 offset:27648
 ds_read_b128 v[210:213], v110 offset:3072
 s_waitcnt lgkmcnt(5)
 v_mfma_f32_16x16x32_bf16 v[226:229], v[214:217], v[8:11], v[226:229]
 v_mfma_f32_16x16x32_bf16 v[230:233], v[214:217], v[88:91], v[230:233]
 ds_read_b128 v[214:217], v110 offset:4096
 s_waitcnt lgkmcnt(5)
 v_mfma_f32_16x16x32_bf16 v[226:229], v[218:221], v[12:15], v[226:229]
 v_mfma_f32_16x16x32_bf16 v[230:233], v[218:221], v[92:95], v[230:233]
 ds_read_b128 v[218:221], v111 offset:0
 s_waitcnt lgkmcnt(5)
 v_mfma_f32_16x16x32_bf16 v[226:229], v[222:225], v[16:19], v[226:229]
 v_mfma_f32_16x16x32_bf16 v[230:233], v[222:225], v[96:99], v[230:233]
 ds_read_b128 v[222:225], v111 offset:1024
 s_waitcnt lgkmcnt(3)
 v_mfma_f32_16x16x32_bf16 v[226:229], v[210:213], v[20:23], v[226:229]
 v_mfma_f32_16x16x32_bf16 v[230:233], v[210:213], v[100:103], v[230:233]
 buffer_load_dwordx4 v[194:197], v2, s[4:7], s27 offen offset:0 sc1
 ds_read_b128 v[210:213], v111 offset:2048
 s_waitcnt lgkmcnt(3)
 v_mfma_f32_16x16x32_bf16 v[226:229], v[214:217], v[24:27], v[226:229]
 v_mfma_f32_16x16x32_bf16 v[230:233], v[214:217], v[104:107], v[230:233]
 ds_read_b128 v[214:217], v111 offset:3072
 s_waitcnt lgkmcnt(3)
 v_mfma_f32_16x16x32_bf16 v[226:229], v[218:221], v[28:31], v[226:229]
 ds_read_b128 v[218:221], v111 offset:4096
 s_waitcnt lgkmcnt(3)
 v_mfma_f32_16x16x32_bf16 v[226:229], v[222:225], v[32:35], v[226:229]
 buffer_load_dwordx4 v[198:201], v2, s[4:7], s27 offen offset:1024 sc1
 ds_read_b128 v[222:225], v112 offset:0
 s_waitcnt lgkmcnt(3)
 v_mfma_f32_16x16x32_bf16 v[226:229], v[210:213], v[36:39], v[226:229]
 ds_write_b128 v117, v[230:233] offset:28672
 ds_read_b128 v[210:213], v112 offset:1024
 s_waitcnt lgkmcnt(4)
 v_mfma_f32_16x16x32_bf16 v[226:229], v[214:217], v[40:43], v[226:229]
 ds_read_b128 v[214:217], v112 offset:2048
 s_waitcnt lgkmcnt(4)
 v_mfma_f32_16x16x32_bf16 v[226:229], v[218:221], v[44:47], v[226:229]
 buffer_load_dwordx4 v[202:205], v2, s[4:7], s27 offen offset:2048 sc1
 ds_read_b128 v[218:221], v112 offset:3072
 s_waitcnt lgkmcnt(4)
 v_mfma_f32_16x16x32_bf16 v[226:229], v[222:225], v[48:51], v[226:229]
 ds_read_b128 v[222:225], v112 offset:4096
 s_waitcnt lgkmcnt(3)
 v_mfma_f32_16x16x32_bf16 v[226:229], v[210:213], v[52:55], v[226:229]
 s_waitcnt lgkmcnt(2)
 v_mfma_f32_16x16x32_bf16 v[226:229], v[214:217], v[56:59], v[226:229]
 s_barrier
 s_waitcnt lgkmcnt(1)
 v_mfma_f32_16x16x32_bf16 v[226:229], v[218:221], v[60:63], v[226:229]
 s_waitcnt vmcnt(3)
 s_mov_b32 s41, 0
 v_min_i32 v1, 64, v125
 v_cmp_ge_i32 vcc, v126, v1
 s_nop 0
 s_cmp_eq_u64 vcc, -1
 s_cbranch_scc1 Lflok_153
Lfl_152:
 s_add_u32 s41, s41, 1
 s_cmp_gt_u32 s41, 200000
 s_cbranch_scc1 L_fail
 buffer_load_dword v126, v124, s[4:7], 0 offen sc1
 s_waitcnt vmcnt(0)
 v_cmp_ge_i32 vcc, v126, v1
 s_nop 0
 s_cmp_eq_u64 vcc, -1
 s_cbranch_scc0 Lfl_152
 buffer_load_dwordx4 v[194:197], v2, s[4:7], s27 offen offset:0 sc1
 buffer_load_dwordx4 v[198:201], v2, s[4:7], s27 offen offset:1024 sc1
 buffer_load_dwordx4 v[202:205], v2, s[4:7], s27 offen offset:2048 sc1
Lflok_153:
 v_add_u32 v125, 1, v125
 s_waitcnt lgkmcnt(0)
 v_mfma_f32_16x16x32_bf16 v[226:229], v[222:225], v[64:67], v[226:229]
 s_mov_b32 s41, 0
Lf_154:
 s_waitcnt vmcnt(2)
 v_add_f32 v210, v234, v194
 v_add_f32 v211, v235, v195
 v_add_f32 v212, v236, v196
 v_add_f32 v213, v237, v197
 s_waitcnt vmcnt(1)
 v_add_f32 v214, v238, v198
 v_add_f32 v215, v239, v199
 v_add_f32 v216, v240, v200
 v_add_f32 v217, v241, v201
 v_maximum3_f32 v1, v210, v211, v212
 v_maximum3_f32 v127, v213, v214, v215
 v_maximum3_f32 v1, v1, v216, v217
 s_waitcnt vmcnt(0)
 v_add_f32 v218, v190, v202
 v_add_f32 v219, v191, v203
 v_add_f32 v220, v192, v204
 v_add_f32 v221, v193, v205
 v_maximum3_f32 v127, v127, v218, v219
 v_maximum3_f32 v1, v1, v220, v221
 v_maximum3_f32 v1, v1, v127, v127
 v_cmp_u_f32 vcc, v1, v1
 v_mov_b32 v127, v1
 s_cbranch_vccnz Lfs_155
Lfok_156:
 s_nop 0
 v_permlane32_swap_b32 v1, v127
 v_max_f32 v1, v1, v127
 v_mov_b32 v127, v1
 v_cvt_pk_bf16_f32 v178, v226, v227
 v_cvt_pk_bf16_f32 v179, v228, v229
 v_permlane16_swap_b32 v1, v127
 v_max_f32 v1, v1, v127
 v_mul_f32 v1, s71, v1
 v_fma_f32 v210, v210, s71, -v1
 v_fma_f32 v211, v211, s71, -v1
 v_fma_f32 v212, v212, s71, -v1
 v_fma_f32 v213, v213, s71, -v1
 v_fma_f32 v214, v214, s71, -v1
 v_fma_f32 v215, v215, s71, -v1
 v_fma_f32 v216, v216, s71, -v1
 v_fma_f32 v217, v217, s71, -v1
 v_fma_f32 v218, v218, s71, -v1
 v_fma_f32 v219, v219, s71, -v1
 v_fma_f32 v220, v220, s71, -v1
 v_fma_f32 v221, v221, s71, -v1
 v_exp_f32 v210, v210
 v_exp_f32 v211, v211
 v_exp_f32 v212, v212
 v_exp_f32 v213, v213
 v_exp_f32 v214, v214
 v_exp_f32 v215, v215
 v_exp_f32 v216, v216
 v_exp_f32 v217, v217
 s_mov_b32 exec_lo, 0x00ff00ff
 s_mov_b32 exec_hi, 0x00ff00ff
 v_cvt_pk_bf16_f32 v162, v210, v211
 v_cvt_pk_bf16_f32 v163, v212, v213
 v_cvt_pk_bf16_f32 v164, v214, v215
 v_cvt_pk_bf16_f32 v165, v216, v217
 s_not_b64 exec, exec
 v_cvt_pk_bf16_f32 v166, v210, v211
 v_cvt_pk_bf16_f32 v167, v212, v213
 v_cvt_pk_bf16_f32 v168, v214, v215
 v_cvt_pk_bf16_f32 v169, v216, v217
 s_mov_b64 exec, -1
 v_mfma_f32_16x16x32_bf16 v[200:203], v[186:189], v[162:165], 0
 v_exp_f32 v218, v218
 v_exp_f32 v219, v219
 v_mfma_f32_16x16x32_bf16 v[192:195], v[142:145], v[162:165], 0
 v_exp_f32 v220, v220
 v_exp_f32 v221, v221
 v_mfma_f32_16x16x32_bf16 v[200:203], v[186:189], v[166:169], v[200:203]
 v_cvt_pk_bf16_f32 v190, v218, v219
 v_mfma_f32_16x16x32_bf16 v[192:195], v[150:153], v[166:169], v[192:195]
 v_cvt_pk_bf16_f32 v191, v220, v221
 s_nop 1
 v_mfma_f32_16x16x16_bf16 v[200:203], v[186:187], v[190:191], v[200:203]
 s_add_u32 s25, s61, s55
 s_add_u32 s27, s61, s56
 v_mfma_f32_16x16x16_bf16 v[192:195], v[178:179], v[190:191], v[192:195]
 s_add_u32 s28, s27, 4096
 s_mov_b32 s41, 0
 s_nop 2
 v_rcp_f32 v127, v200
 s_nop 1
 v_mul_f32 v192, v192, v127
 v_mul_f32 v193, v193, v127
 v_mul_f32 v194, v194, v127
 v_mul_f32 v195, v195, v127
 v_cvt_pk_bf16_f32 v204, v192, v193
 v_cvt_pk_bf16_f32 v205, v194, v195
 buffer_store_dwordx2 v[204:205], v2, s[4:7], s25 offen
 ds_read_b128 v[142:145], v115 offset:0
 ds_read_b128 v[146:149], v115 offset:1024
 ds_read_b128 v[150:153], v115 offset:2048
 ds_read_b128 v[154:157], v115 offset:3072
 ds_read_b128 v[234:237], v115 offset:4096
 ds_read_b128 v[238:241], v115 offset:5120
 ds_read_b128 v[242:245], v115 offset:6144
 ds_read_b128 v[246:249], v115 offset:7168
 ds_read_b128 v[250:253], v115 offset:8192
 s_sleep 2
 buffer_load_dwordx4 v[190:193], v2, s[4:7], s27 offen offset:0 sc1
 buffer_load_dwordx4 v[194:197], v2, s[4:7], s27 offen offset:1024 sc1
 buffer_load_dwordx4 v[198:201], v2, s[4:7], s27 offen offset:2048 sc1
 buffer_load_dwordx4 v[202:205], v2, s[4:7], s27 offen offset:3072 sc1
 buffer_load_dwordx4 v[206:209], v2, s[4:7], s28 offen offset:0 sc1
 buffer_load_dwordx4 v[210:213], v2, s[4:7], s28 offen offset:1024 sc1
 s_waitcnt lgkmcnt(0)
Lo_157:
 s_waitcnt vmcnt(5)
 v_max3_u32 v1, v190, v191, v192
 v_max_u32 v1, v1, v193
 v_cmp_eq_u32 vcc, -1, v1
 s_cbranch_vccnz Los_158
 v_mfma_f32_16x16x32_bf16 v[214:217], v[142:145], v[190:193], 0
 ds_read_b128 v[142:145], v115 offset:9216
 v_mfma_f32_16x16x32_bf16 v[218:221], v[146:149], v[190:193], 0
 ds_read_b128 v[146:149], v115 offset:10240
 s_waitcnt vmcnt(4)
 v_max3_u32 v1, v194, v195, v196
 v_mfma_f32_16x16x32_bf16 v[222:225], v[150:153], v[190:193], 0
 ds_read_b128 v[150:153], v115 offset:11264
 v_max_u32 v1, v1, v197
 v_mfma_f32_16x16x32_bf16 v[226:229], v[154:157], v[190:193], 0
 ds_read_b128 v[154:157], v115 offset:12288
 v_cmp_eq_u32 vcc, -1, v1
 v_mfma_f32_16x16x32_bf16 v[230:233], v[234:237], v[190:193], 0
 ds_read_b128 v[234:237], v115 offset:13312
Lo_159:
 s_cbranch_vccnz Los_160
 v_mfma_f32_16x16x32_bf16 v[214:217], v[238:241], v[194:197], v[214:217]
 ds_read_b128 v[238:241], v115 offset:14336
 v_mfma_f32_16x16x32_bf16 v[218:221], v[242:245], v[194:197], v[218:221]
 ds_read_b128 v[242:245], v116 offset:0
 s_waitcnt vmcnt(3)
 v_max3_u32 v1, v198, v199, v200
 v_mfma_f32_16x16x32_bf16 v[222:225], v[246:249], v[194:197], v[222:225]
 ds_read_b128 v[246:249], v116 offset:1024
 v_max_u32 v1, v1, v201
 v_mfma_f32_16x16x32_bf16 v[226:229], v[250:253], v[194:197], v[226:229]
 ds_read_b128 v[250:253], v116 offset:2048
 v_cmp_eq_u32 vcc, -1, v1
 s_waitcnt lgkmcnt(7)
 v_mfma_f32_16x16x32_bf16 v[230:233], v[142:145], v[194:197], v[230:233]
 ds_read_b128 v[142:145], v116 offset:3072
Lo_161:
 s_cbranch_vccnz Los_162
 v_mfma_f32_16x16x32_bf16 v[214:217], v[146:149], v[198:201], v[214:217]
 ds_read_b128 v[146:149], v116 offset:4096
 s_waitcnt lgkmcnt(7)
 v_mfma_f32_16x16x32_bf16 v[218:221], v[150:153], v[198:201], v[218:221]
 ds_read_b128 v[150:153], v116 offset:5120
 s_waitcnt vmcnt(2)
 v_max3_u32 v1, v202, v203, v204
 v_mfma_f32_16x16x32_bf16 v[222:225], v[154:157], v[198:201], v[222:225]
 ds_read_b128 v[154:157], v116 offset:6144
 v_max_u32 v1, v1, v205
 s_waitcnt lgkmcnt(7)
 v_mfma_f32_16x16x32_bf16 v[226:229], v[234:237], v[198:201], v[226:229]
 ds_read_b128 v[234:237], v116 offset:7168
 v_cmp_eq_u32 vcc, -1, v1
 v_mfma_f32_16x16x32_bf16 v[230:233], v[238:241], v[198:201], v[230:233]
 ds_read_b128 v[238:241], v116 offset:8192
Lo_163:
 s_cbranch_vccnz Los_164
 s_waitcnt lgkmcnt(7)
 v_mfma_f32_16x16x32_bf16 v[214:217], v[242:245], v[202:205], v[214:217]
 ds_read_b128 v[242:245], v116 offset:9216
 v_mfma_f32_16x16x32_bf16 v[218:221], v[246:249], v[202:205], v[218:221]
 ds_read_b128 v[246:249], v116 offset:10240
 s_waitcnt vmcnt(1)
 v_max3_u32 v1, v206, v207, v208
 s_waitcnt lgkmcnt(7)
 v_mfma_f32_16x16x32_bf16 v[222:225], v[250:253], v[202:205], v[222:225]
 ds_read_b128 v[250:253], v116 offset:11264
 v_max_u32 v1, v1, v209
 v_mfma_f32_16x16x32_bf16 v[226:229], v[142:145], v[202:205], v[226:229]
 ds_read_b128 v[142:145], v116 offset:12288
 v_cmp_eq_u32 vcc, -1, v1
 s_waitcnt lgkmcnt(7)
 v_mfma_f32_16x16x32_bf16 v[230:233], v[146:149], v[202:205], v[230:233]
 ds_read_b128 v[146:149], v116 offset:13312
Lo_165:
 s_cbranch_vccnz Los_166
 v_mfma_f32_16x16x32_bf16 v[214:217], v[150:153], v[206:209], v[214:217]
 ds_read_b128 v[150:153], v116 offset:14336
 s_waitcnt lgkmcnt(7)
 v_mfma_f32_16x16x32_bf16 v[218:221], v[154:157], v[206:209], v[218:221]
 s_waitcnt vmcnt(0)
 v_max3_u32 v1, v210, v211, v212
 v_mfma_f32_16x16x32_bf16 v[222:225], v[234:237], v[206:209], v[222:225]
 v_max_u32 v1, v1, v213
 s_waitcnt lgkmcnt(5)
 v_mfma_f32_16x16x32_bf16 v[226:229], v[238:241], v[206:209], v[226:229]
 v_cmp_eq_u32 vcc, -1, v1
 v_mfma_f32_16x16x32_bf16 v[230:233], v[242:245], v[206:209], v[230:233]
Lo_167:
 s_cbranch_vccnz Los_168
 s_waitcnt lgkmcnt(3)
 v_mfma_f32_16x16x32_bf16 v[214:217], v[246:249], v[210:213], v[214:217]
 buffer_load_dwordx4 v[130:133], v2, s[4:7], s67 offen sc1
 v_mfma_f32_16x16x32_bf16 v[218:221], v[250:253], v[210:213], v[218:221]
 buffer_load_dwordx4 v[134:137], v2, s[4:7], s67 offen offset:2048 sc1
 s_waitcnt lgkmcnt(1)
 v_mfma_f32_16x16x32_bf16 v[222:225], v[142:145], v[210:213], v[222:225]
 s_add_u32 s25, s67, 4096
 buffer_load_dwordx4 v[138:141], v2, s[4:7], s25 offen sc1
 v_mfma_f32_16x16x32_bf16 v[226:229], v[146:149], v[210:213], v[226:229]
 s_waitcnt lgkmcnt(0)
 v_mfma_f32_16x16x32_bf16 v[230:233], v[150:153], v[210:213], v[230:233]
 v_cvt_pk_bf16_f32 v190, v214, v215
 v_cvt_pk_bf16_f32 v191, v216, v217
 v_cvt_pk_bf16_f32 v192, v218, v219
 v_cvt_pk_bf16_f32 v193, v220, v221
 ds_write_b128 v119, v[190:193]
 v_cvt_pk_bf16_f32 v194, v222, v223
 v_cvt_pk_bf16_f32 v195, v224, v225
 v_cvt_pk_bf16_f32 v196, v226, v227
 v_cvt_pk_bf16_f32 v197, v228, v229
 ds_write_b128 v119, v[194:197] offset:4096
 v_cvt_pk_bf16_f32 v198, v230, v231
 v_cvt_pk_bf16_f32 v199, v232, v233
 ds_write_b64 v120, v[198:199] offset:8192
 s_add_u32 s25, s63, s46
 s_add_u32 s26, s63, s47
 s_add_u32 s27, s25, 655360
 s_add_u32 s28, s26, 655360
 s_waitcnt lgkmcnt(0)
 s_barrier
 ds_read_b128 v[190:193], v121 offset:0
 ds_read_b128 v[194:197], v121 offset:1024
 ds_read_b128 v[198:201], v3 offset:8192
 ds_read_b128 v[202:205], v3 offset:9216
 s_waitcnt lgkmcnt(3)
 v_mfma_f32_16x16x32_bf16 v[206:209], v[170:173], v[190:193], 0
 s_waitcnt lgkmcnt(2)
 v_mfma_f32_16x16x32_bf16 v[206:209], v[174:177], v[194:197], v[206:209]
 s_waitcnt lgkmcnt(1)
 v_mfma_f32_16x16x32_bf16 v[210:213], v[170:173], v[198:201], 0
 s_waitcnt lgkmcnt(0)
 v_mfma_f32_16x16x32_bf16 v[210:213], v[174:177], v[202:205], v[210:213]
 s_nop 1
 v_cvt_pk_bf16_f32 v214, v206, v207
 v_cvt_pk_bf16_f32 v215, v208, v209
 buffer_store_dwordx2 v[214:215], v122, s[4:7], s25 offen sc1
 s_nop 2
 v_cvt_pk_bf16_f32 v216, v210, v211
 v_cvt_pk_bf16_f32 v217, v212, v213
 buffer_store_dwordx2 v[216:217], v122, s[4:7], s26 offen sc1
 buffer_store_dwordx2 v[216:217], v122, s[4:7], s28 offen
 buffer_store_dwordx2 v[214:215], v122, s[4:7], s27 offen
 ds_read_b128 v[190:193], v3 offset:23552
 ds_read_b128 v[194:197], v3 offset:24576
 ds_read_b128 v[198:201], v3 offset:25600
 ds_read_b64 v[202:203], v118 offset:0
 ds_read_b64 v[204:205], v118 offset:512
 ds_read_b64 v[206:207], v118 offset:1024
 ds_read_b64 v[210:211], v118 offset:2048
 ds_read_b64 v[212:213], v118 offset:2560
 s_add_u32 s25, s70, s53
 s_add_u32 s26, s25, 15728640
 s_waitcnt lgkmcnt(0)
 buffer_store_dwordx4 v[190:193], v2, s[4:7], s25 offen offset:0 sc1
 buffer_store_dwordx4 v[194:197], v2, s[4:7], s25 offen offset:1024 sc1
 buffer_store_dwordx4 v[198:201], v2, s[4:7], s25 offen offset:2048 sc1
 buffer_store_dwordx2 v[202:203], v108, s[4:7], s26 offen offset:0 sc1
 buffer_store_dwordx2 v[204:205], v108, s[4:7], s26 offen offset:512 sc1
 buffer_store_dwordx2 v[206:207], v108, s[4:7], s26 offen offset:1024 sc1
 buffer_store_dwordx2 v[178:179], v108, s[4:7], s26 offen offset:1536 sc1
 buffer_store_dwordx2 v[210:211], v108, s[4:7], s26 offen offset:2048 sc1
 buffer_store_dwordx2 v[212:213], v108, s[4:7], s26 offen offset:2560 sc1
 s_add_u32 s27, s63, s48
 s_add_u32 s28, s63, s49
 s_add_u32 s70, s31, 1
 s_and_b32 s25, s70, 3
 s_mul_i32 s26, s25, 20480
 s_add_u32 s57, s26, s42
 s_add_u32 s58, s57, 4096
 s_add_u32 s59, s26, s43
 s_mul_i32 s63, s25, 163840
 s_xor_b32 s26, s25, 2
 s_mul_i32 s64, s26, 163840
 s_add_u32 s25, s25, 3
 s_and_b32 s25, s25, 3
 s_mul_i32 s26, s25, 20480
 s_add_u32 s60, s26, s43
 s_and_b32 s25, s70, 1
 s_mul_i32 s61, s25, 196608
 s_xor_b32 s25, s25, 1
 s_mul_i32 s62, s25, 196608
 s_mul_i32 s70, s70, 196608
 s_add_u32 s31, s31, 1
 s_cmp_lt_u32 s31, 72
 s_barrier
 s_cbranch_scc1 L_rec_top_3l
 s_waitcnt vmcnt(0)
 s_barrier
 s_endpgm
Lzs_143:
 buffer_load_dwordx4 v[190:193], v2, s[4:7], s57 offen offset:0 sc1
 buffer_load_dwordx4 v[194:197], v2, s[4:7], s57 offen offset:1024 sc1
 buffer_load_dwordx4 v[198:201], v2, s[4:7], s57 offen offset:2048 sc1
 buffer_load_dwordx4 v[202:205], v2, s[4:7], s57 offen offset:3072 sc1
 buffer_load_dwordx4 v[206:209], v2, s[4:7], s58 offen offset:0 sc1
 s_add_u32 s41, s41, 1
 s_cmp_gt_u32 s41, 200000
 s_cbranch_scc1 L_fail
 s_branch Lz_142
Lzs_145:
 buffer_load_dwordx4 v[194:197], v2, s[4:7], s57 offen offset:1024 sc1
 buffer_load_dwordx4 v[198:201], v2, s[4:7], s57 offen offset:2048 sc1
 buffer_load_dwordx4 v[202:205], v2, s[4:7], s57 offen offset:3072 sc1
 buffer_load_dwordx4 v[206:209], v2, s[4:7], s58 offen offset:0 sc1
 s_add_u32 s41, s41, 1
 s_cmp_gt_u32 s41, 200000
 s_cbranch_scc1 L_fail
 s_branch Lz_144
Lzs_147:
 buffer_load_dwordx4 v[198:201], v2, s[4:7], s57 offen offset:2048 sc1
 buffer_load_dwordx4 v[202:205], v2, s[4:7], s57 offen offset:3072 sc1
 buffer_load_dwordx4 v[206:209], v2, s[4:7], s58 offen offset:0 sc1
 s_add_u32 s41, s41, 1
 s_cmp_gt_u32 s41, 200000
 s_cbranch_scc1 L_fail
 s_branch Lz_146
Lzs_149:
 buffer_load_dwordx4 v[202:205], v2, s[4:7], s57 offen offset:3072 sc1
 buffer_load_dwordx4 v[206:209], v2, s[4:7], s58 offen offset:0 sc1
 s_add_u32 s41, s41, 1
 s_cmp_gt_u32 s41, 200000
 s_cbranch_scc1 L_fail
 s_branch Lz_148
Lzs_151:
 buffer_load_dwordx4 v[206:209], v2, s[4:7], s58 offen offset:0 sc1
 s_add_u32 s41, s41, 1
 s_cmp_gt_u32 s41, 200000
 s_cbranch_scc1 L_fail
 s_branch Lz_150
Lfs_155:
 v_max3_u32 v222, v194, v195, v196
 v_max3_u32 v222, v222, v197, v198
 v_max3_u32 v222, v222, v199, v200
 v_max3_u32 v222, v222, v201, v202
 v_max3_u32 v222, v222, v203, v204
 v_max_u32 v222, v222, v205
 v_cmp_eq_u32 vcc, -1, v222
 s_cbranch_vccz Lfok_156
 buffer_load_dwordx4 v[194:197], v2, s[4:7], s27 offen offset:0 sc1
 buffer_load_dwordx4 v[198:201], v2, s[4:7], s27 offen offset:1024 sc1
 buffer_load_dwordx4 v[202:205], v2, s[4:7], s27 offen offset:2048 sc1
 s_add_u32 s41, s41, 1
 s_cmp_gt_u32 s41, 200000
 s_cbranch_scc1 L_fail
 s_branch Lf_154
Los_158:
 buffer_load_dwordx4 v[190:193], v2, s[4:7], s27 offen offset:0 sc1
 buffer_load_dwordx4 v[194:197], v2, s[4:7], s27 offen offset:1024 sc1
 buffer_load_dwordx4 v[198:201], v2, s[4:7], s27 offen offset:2048 sc1
 buffer_load_dwordx4 v[202:205], v2, s[4:7], s27 offen offset:3072 sc1
 buffer_load_dwordx4 v[206:209], v2, s[4:7], s28 offen offset:0 sc1
 buffer_load_dwordx4 v[210:213], v2, s[4:7], s28 offen offset:1024 sc1
 s_add_u32 s41, s41, 1
 s_cmp_gt_u32 s41, 200000
 s_cbranch_scc1 L_fail
 s_branch Lo_157
Los_160:
 buffer_load_dwordx4 v[194:197], v2, s[4:7], s27 offen offset:1024 sc1
 buffer_load_dwordx4 v[198:201], v2, s[4:7], s27 offen offset:2048 sc1
 buffer_load_dwordx4 v[202:205], v2, s[4:7], s27 offen offset:3072 sc1
 buffer_load_dwordx4 v[206:209], v2, s[4:7], s28 offen offset:0 sc1
 buffer_load_dwordx4 v[210:213], v2, s[4:7], s28 offen offset:1024 sc1
 s_waitcnt vmcnt(4)
 v_max3_u32 v1, v194, v195, v196
 v_max_u32 v1, v1, v197
 v_cmp_eq_u32 vcc, -1, v1
 s_add_u32 s41, s41, 1
 s_cmp_gt_u32 s41, 200000
 s_cbranch_scc1 L_fail
 s_branch Lo_159
Los_162:
 buffer_load_dwordx4 v[198:201], v2, s[4:7], s27 offen offset:2048 sc1
 buffer_load_dwordx4 v[202:205], v2, s[4:7], s27 offen offset:3072 sc1
 buffer_load_dwordx4 v[206:209], v2, s[4:7], s28 offen offset:0 sc1
 buffer_load_dwordx4 v[210:213], v2, s[4:7], s28 offen offset:1024 sc1
 s_waitcnt vmcnt(3)
 v_max3_u32 v1, v198, v199, v200
 v_max_u32 v1, v1, v201
 v_cmp_eq_u32 vcc, -1, v1
 s_add_u32 s41, s41, 1
 s_cmp_gt_u32 s41, 200000
 s_cbranch_scc1 L_fail
 s_branch Lo_161
Los_164:
 buffer_load_dwordx4 v[202:205], v2, s[4:7], s27 offen offset:3072 sc1
 buffer_load_dwordx4 v[206:209], v2, s[4:7], s28 offen offset:0 sc1
 buffer_load_dwordx4 v[210:213], v2, s[4:7], s28 offen offset:1024 sc1
 s_waitcnt vmcnt(2)
 v_max3_u32 v1, v202, v203, v204
 v_max_u32 v1, v1, v205
 v_cmp_eq_u32 vcc, -1, v1
 s_add_u32 s41, s41, 1
 s_cmp_gt_u32 s41, 200000
 s_cbranch_scc1 L_fail
 s_branch Lo_163
Los_166:
 buffer_load_dwordx4 v[206:209], v2, s[4:7], s28 offen offset:0 sc1
 buffer_load_dwordx4 v[210:213], v2, s[4:7], s28 offen offset:1024 sc1
 s_waitcnt vmcnt(1)
 v_max3_u32 v1, v206, v207, v208
 v_max_u32 v1, v1, v209
 v_cmp_eq_u32 vcc, -1, v1
 s_add_u32 s41, s41, 1
 s_cmp_gt_u32 s41, 200000
 s_cbranch_scc1 L_fail
 s_branch Lo_165
Los_168:
 buffer_load_dwordx4 v[210:213], v2, s[4:7], s28 offen offset:1024 sc1
 s_waitcnt vmcnt(0)
 v_max3_u32 v1, v210, v211, v212
 v_max_u32 v1, v1, v213
 v_cmp_eq_u32 vcc, -1, v1
 s_add_u32 s41, s41, 1
 s_cmp_gt_u32 s41, 200000
 s_cbranch_scc1 L_fail
 s_branch Lo_167
L_rec_remote:
 s_cmp_eq_u32 s3, 0
 s_cbranch_scc0 Lpwn_171
 s_waitcnt vmcnt(0)
 s_cmp_eq_u32 s40, 0
 s_cbranch_scc1 Lz0_172
 s_mov_b64 exec, 0xffffffff
 buffer_store_dwordx2 v[128:129], v123, s[4:7], s43 offen sc1
 s_mov_b64 exec, -1
Lz0_172:
 s_barrier
L_rec_top_0r:
 s_sleep 2
 buffer_load_dwordx4 v[190:193], v2, s[4:7], s57 offen offset:0 sc1
 buffer_load_dwordx4 v[194:197], v2, s[4:7], s57 offen offset:1024 sc1
 buffer_load_dwordx4 v[198:201], v2, s[4:7], s57 offen offset:2048 sc1
 buffer_load_dwordx4 v[202:205], v2, s[4:7], s57 offen offset:3072 sc1
 buffer_load_dwordx4 v[206:209], v2, s[4:7], s58 offen offset:0 sc1
 s_mov_b32 s41, 0
Lz_173:
 s_waitcnt vmcnt(4)
 ds_write_b128 v109, v[190:193] offset:0
 v_mfma_f32_16x16x32_bf16 v[226:229], a[0:3], v[190:193], 0
 v_max3_u32 v1, v190, v191, v192
 v_max_u32 v1, v1, v193
 v_mfma_f32_16x16x32_bf16 v[230:233], a[80:83], v[190:193], 0
 v_cmp_eq_u32 vcc, -1, v1
 v_mfma_f32_16x16x32_bf16 v[234:237], a[160:163], v[190:193], 0
 s_cbranch_vccnz Lzs_174
Lz_175:
 s_waitcnt vmcnt(3)
 ds_write_b128 v109, v[194:197] offset:1024
 v_max3_u32 v1, v194, v195, v196
 v_max_u32 v1, v1, v197
 v_cmp_eq_u32 vcc, -1, v1
 s_cbranch_vccnz Lzs_176
 v_mfma_f32_16x16x32_bf16 v[226:229], a[4:7], v[194:197], v[226:229]
 v_mfma_f32_16x16x32_bf16 v[230:233], a[84:87], v[194:197], v[230:233]
 v_mfma_f32_16x16x32_bf16 v[234:237], a[164:167], v[194:197], v[234:237]
Lz_177:
 s_waitcnt vmcnt(2)
 ds_write_b128 v109, v[198:201] offset:2048
 v_max3_u32 v1, v198, v199, v200
 v_max_u32 v1, v1, v201
 v_cmp_eq_u32 vcc, -1, v1
 s_cbranch_vccnz Lzs_178
 v_mfma_f32_16x16x32_bf16 v[226:229], a[8:11], v[198:201], v[226:229]
 v_mfma_f32_16x16x32_bf16 v[230:233], a[88:91], v[198:201], v[230:233]
 v_mfma_f32_16x16x32_bf16 v[234:237], a[168:171], v[198:201], v[234:237]
Lz_179:
 s_waitcnt vmcnt(1)
 ds_write_b128 v109, v[202:205] offset:3072
 v_max3_u32 v1, v202, v203, v204
 v_max_u32 v1, v1, v205
 v_cmp_eq_u32 vcc, -1, v1
 s_cbranch_vccnz Lzs_180
Lz_181:
 s_waitcnt vmcnt(0)
 ds_write_b128 v109, v[206:209] offset:4096
 v_max3_u32 v1, v206, v207, v208
 v_max_u32 v1, v1, v209
 v_cmp_eq_u32 vcc, -1, v1
 s_cbranch_vccnz Lzs_182
 s_waitcnt lgkmcnt(0)
 s_barrier
 ds_read_b128 v[214:217], v110 offset:0
 ds_read_b128 v[218:221], v110 offset:1024
 ds_read_b128 v[222:225], v110 offset:2048
 v_mfma_f32_16x16x32_bf16 v[226:229], a[12:15], v[202:205], v[226:229]
 s_mov_b64 exec, 1
 v_mov_b32 v127, s31
 v_mfma_f32_16x16x32_bf16 v[230:233], a[92:95], v[202:205], v[230:233]
 buffer_store_dword v127, off, s[4:7], s54 sc1
 v_mfma_f32_16x16x32_bf16 v[234:237], a[172:175], v[202:205], v[234:237]
 s_mov_b64 exec, -1
 v_mfma_f32_16x16x32_bf16 v[226:229], a[16:19], v[206:209], v[226:229]
 s_add_u32 s25, s68, s51
 v_mfma_f32_16x16x32_bf16 v[230:233], a[96:99], v[206:209], v[230:233]
 buffer_load_dwordx4 v[142:145], v2, s[4:7], s25 offen sc1
 v_mfma_f32_16x16x32_bf16 v[234:237], a[176:179], v[206:209], v[234:237]
 ds_read_b128 v[210:213], v110 offset:3072
 s_waitcnt lgkmcnt(3)
 v_mfma_f32_16x16x32_bf16 v[226:229], a[20:23], v[214:217], v[226:229]
 s_add_u32 s25, s68, s52
 v_mfma_f32_16x16x32_bf16 v[230:233], a[100:103], v[214:217], v[230:233]
 buffer_load_dwordx4 v[146:149], v2, s[4:7], s25 offen sc1
 v_mfma_f32_16x16x32_bf16 v[234:237], a[180:183], v[214:217], v[234:237]
 ds_read_b128 v[214:217], v110 offset:4096
 s_waitcnt lgkmcnt(3)
 v_mfma_f32_16x16x32_bf16 v[226:229], a[24:27], v[218:221], v[226:229]
 s_add_u32 s25, s69, s51
 v_mfma_f32_16x16x32_bf16 v[230:233], a[104:107], v[218:221], v[230:233]
 buffer_load_dwordx4 v[150:153], v2, s[4:7], s25 offen sc1
 v_mfma_f32_16x16x32_bf16 v[234:237], a[184:187], v[218:221], v[234:237]
 ds_read_b128 v[218:221], v111 offset:0
 s_waitcnt lgkmcnt(3)
 v_mfma_f32_16x16x32_bf16 v[226:229], a[28:31], v[222:225], v[226:229]
 s_add_u32 s25, s69, s52
 v_mfma_f32_16x16x32_bf16 v[230:233], a[108:111], v[222:225], v[230:233]
 buffer_load_dwordx4 v[154:157], v2, s[4:7], s25 offen sc1
 v_mfma_f32_16x16x32_bf16 v[234:237], a[188:191], v[222:225], v[234:237]
 ds_read_b128 v[222:225], v111 offset:1024
 s_waitcnt lgkmcnt(3)
 v_mfma_f32_16x16x32_bf16 v[226:229], a[32:35], v[210:213], v[226:229]
 s_add_u32 s25, s46, s64
 v_mfma_f32_16x16x32_bf16 v[230:233], a[112:115], v[210:213], v[230:233]
 buffer_store_dwordx2 v[182:183], v122, s[4:7], s25 offen sc1
 v_mfma_f32_16x16x32_bf16 v[234:237], a[192:195], v[210:213], v[234:237]
 ds_read_b128 v[210:213], v111 offset:2048
 s_waitcnt lgkmcnt(3)
 v_mfma_f32_16x16x32_bf16 v[226:229], a[36:39], v[214:217], v[226:229]
 s_add_u32 s25, s25, 655360
 v_mfma_f32_16x16x32_bf16 v[230:233], a[116:119], v[214:217], v[230:233]
 buffer_store_dwordx2 v[182:183], v122, s[4:7], s25 offen sc1
 v_mfma_f32_16x16x32_bf16 v[234:237], a[196:199], v[214:217], v[234:237]
 ds_read_b128 v[214:217], v111 offset:3072
 s_waitcnt lgkmcnt(3)
 v_mfma_f32_16x16x32_bf16 v[226:229], a[40:43], v[218:221], v[226:229]
 s_add_u32 s25, s31, 1
 s_mul_i32 s68, s25, 393216
 v_mfma_f32_16x16x32_bf16 v[230:233], a[120:123], v[218:221], v[230:233]
 s_add_u32 s68, s68, 84066304
 s_cmp_lt_u32 s25, 64
 v_mfma_f32_16x16x32_bf16 v[234:237], a[200:203], v[218:221], v[234:237]
 s_cselect_b32 s68, s68, 2146435072
 ds_read_b128 v[218:221], v111 offset:4096
 s_waitcnt lgkmcnt(3)
 v_mfma_f32_16x16x32_bf16 v[226:229], a[44:47], v[222:225], v[226:229]
 s_sub_u32 s26, s25, 8
 s_mul_i32 s69, s26, 393216
 v_mfma_f32_16x16x32_bf16 v[230:233], a[124:127], v[222:225], v[230:233]
 s_add_u32 s69, s69, 134397952
 s_cmp_lt_u32 s26, 64
 v_mfma_f32_16x16x32_bf16 v[234:237], a[204:207], v[222:225], v[234:237]
 s_cselect_b32 s69, s69, 2146435072
 ds_read_b128 v[222:225], v112 offset:0
 s_waitcnt lgkmcnt(3)
 v_mfma_f32_16x16x32_bf16 v[226:229], a[48:51], v[210:213], v[226:229]
 s_add_u32 s25, s68, 4269801472
 s_add_u32 s26, s69, 4269801472
 v_mfma_f32_16x16x32_bf16 v[230:233], a[128:131], v[210:213], v[230:233]
 s_cmp_lt_u32 s3, 2
 s_cselect_b32 s67, s25, s26
 v_mfma_f32_16x16x32_bf16 v[234:237], a[208:211], v[210:213], v[234:237]
 s_add_u32 s67, s67, s50
 ds_read_b128 v[210:213], v112 offset:1024
 s_waitcnt lgkmcnt(3)
 v_mfma_f32_16x16x32_bf16 v[226:229], a[52:55], v[214:217], v[226:229]
 v_mfma_f32_16x16x32_bf16 v[230:233], a[132:135], v[214:217], v[230:233]
 v_mfma_f32_16x16x32_bf16 v[234:237], a[212:215], v[214:217], v[234:237]
 ds_read_b128 v[214:217], v112 offset:2048
 s_waitcnt lgkmcnt(3)
 v_mfma_f32_16x16x32_bf16 v[226:229], a[56:59], v[218:221], v[226:229]
 v_mfma_f32_16x16x32_bf16 v[230:233], a[136:139], v[218:221], v[230:233]
 v_mfma_f32_16x16x32_bf16 v[234:237], a[216:219], v[218:221], v[234:237]
 ds_read_b128 v[218:221], v112 offset:3072
 s_waitcnt lgkmcnt(3)
 v_mfma_f32_16x16x32_bf16 v[226:229], a[60:63], v[222:225], v[226:229]
 v_mfma_f32_16x16x32_bf16 v[230:233], a[140:143], v[222:225], v[230:233]
 v_mfma_f32_16x16x32_bf16 v[234:237], a[220:223], v[222:225], v[234:237]
 ds_read_b128 v[222:225], v112 offset:4096
 s_waitcnt lgkmcnt(3)
 v_mfma_f32_16x16x32_bf16 v[226:229], a[64:67], v[210:213], v[226:229]
 v_mfma_f32_16x16x32_bf16 v[230:233], a[144:147], v[210:213], v[230:233]
 v_mfma_f32_16x16x32_bf16 v[234:237], a[224:227], v[210:213], v[234:237]
 s_waitcnt lgkmcnt(2)
 v_mfma_f32_16x16x32_bf16 v[226:229], a[68:71], v[214:217], v[226:229]
 v_mfma_f32_16x16x32_bf16 v[230:233], a[148:151], v[214:217], v[230:233]
 v_mfma_f32_16x16x32_bf16 v[234:237], a[228:231], v[214:217], v[234:237]
 s_waitcnt lgkmcnt(1)
 v_mfma_f32_16x16x32_bf16 v[226:229], a[72:75], v[218:221], v[226:229]
 v_mfma_f32_16x16x32_bf16 v[230:233], a[152:155], v[218:221], v[230:233]
 v_mfma_f32_16x16x32_bf16 v[234:237], a[232:235], v[218:221], v[234:237]
 s_waitcnt lgkmcnt(0)
 v_mfma_f32_16x16x32_bf16 v[226:229], a[76:79], v[222:225], v[226:229]
 v_mfma_f32_16x16x32_bf16 v[230:233], a[156:159], v[222:225], v[230:233]
 v_mfma_f32_16x16x32_bf16 v[234:237], a[236:239], v[222:225], v[234:237]
 s_nop 1
 v_cvt_pk_bf16_f32 v190, v226, v227
 v_cvt_pk_bf16_f32 v191, v228, v229
 ds_write_b64 v113, v[190:191] offset:0
 v_cvt_pk_bf16_f32 v192, v230, v231
 v_cvt_pk_bf16_f32 v193, v232, v233
 ds_write_b64 v114, v[192:193] offset:0
 v_cvt_pk_bf16_f32 v194, v234, v235
 v_cvt_pk_bf16_f32 v195, v236, v237
 ds_write_b64 v113, v[194:195] offset:1024
 s_add_u32 s26, s61, s44
 s_add_u32 s27, s61, s45
 s_waitcnt lgkmcnt(0)
 s_barrier
 ds_read_b128 v[198:201], v3 offset:20480
 ds_read_b128 v[202:205], v3 offset:21504
 ds_read_b128 v[206:209], v3 offset:22528
 ds_read_b128 v[226:229], v3 offset:23552
 ds_read_b128 v[230:233], v3 offset:24576
 ds_read_b128 v[234:237], v3 offset:25600
 ds_read_b128 v[210:213], v109 offset:0
 ds_read_b128 v[214:217], v109 offset:1024
 ds_read_b128 v[218:221], v109 offset:2048
 s_waitcnt lgkmcnt(8)
 v_mfma_f32_16x16x32_bf16 v[194:197], v[130:133], v[198:201], 0
 s_waitcnt lgkmcnt(7)
 v_mfma_f32_16x16x32_bf16 v[194:197], v[134:137], v[202:205], v[194:197]
 s_waitcnt lgkmcnt(6)
 v_mfma_f32_16x16x32_bf16 v[194:197], v[138:141], v[206:209], v[194:197]
 s_waitcnt lgkmcnt(5)
 v_mfma_f32_16x16x32_bf16 v[190:193], v[226:229], v[198:201], v[158:161]
 s_waitcnt lgkmcnt(4)
 v_mfma_f32_16x16x32_bf16 v[190:193], v[230:233], v[202:205], v[190:193]
 s_mov_b32 exec_lo, 0x00ff00ff
 s_mov_b32 exec_hi, 0x00ff00ff
 s_waitcnt lgkmcnt(3)
 v_mfma_f32_16x16x32_bf16 v[190:193], v[234:237], v[206:209], v[190:193]
 buffer_store_dwordx4 v[194:197], v2, s[4:7], s26 offen offset:0 sc1
 ds_write_b128 v117, v[194:197] offset:26624
 s_mov_b64 exec, -1
 ds_read_b128 v[222:225], v109 offset:3072
 s_waitcnt lgkmcnt(4)
 v_mfma_f32_16x16x32_bf16 v[226:229], v[210:213], a[240:243], 0
 v_mfma_f32_16x16x32_bf16 v[230:233], v[210:213], v[68:71], 0
 ds_read_b128 v[210:213], v109 offset:4096
 s_waitcnt lgkmcnt(4)
 v_mfma_f32_16x16x32_bf16 v[226:229], v[214:217], a[244:247], v[226:229]
 v_mfma_f32_16x16x32_bf16 v[230:233], v[214:217], v[72:75], v[230:233]
 ds_read_b128 v[214:217], v110 offset:0
 s_waitcnt lgkmcnt(4)
 v_mfma_f32_16x16x32_bf16 v[226:229], v[218:221], a[248:251], v[226:229]
 v_mfma_f32_16x16x32_bf16 v[230:233], v[218:221], v[76:79], v[230:233]
 buffer_load_dword v126, v124, s[4:7], 0 offen sc1
 ds_read_b128 v[218:221], v110 offset:1024
 s_waitcnt lgkmcnt(3)
 v_mfma_f32_16x16x32_bf16 v[226:229], v[222:225], a[252:255], v[226:229]
 v_mfma_f32_16x16x32_bf16 v[230:233], v[222:225], v[80:83], v[230:233]
 ds_read_b128 v[222:225], v110 offset:2048
 s_waitcnt lgkmcnt(3)
 v_mfma_f32_16x16x32_bf16 v[226:229], v[210:213], v[4:7], v[226:229]
 v_mfma_f32_16x16x32_bf16 v[230:233], v[210:213], v[84:87], v[230:233]
 s_barrier
 ds_read_b128 v[234:237], v3 offset:26624
 ds_read_b128 v[238:241], v3 offset:27648
 ds_read_b128 v[210:213], v110 offset:3072
 s_waitcnt lgkmcnt(5)
 v_mfma_f32_16x16x32_bf16 v[226:229], v[214:217], v[8:11], v[226:229]
 v_mfma_f32_16x16x32_bf16 v[230:233], v[214:217], v[88:91], v[230:233]
 ds_read_b128 v[214:217], v110 offset:4096
 s_waitcnt lgkmcnt(5)
 v_mfma_f32_16x16x32_bf16 v[226:229], v[218:221], v[12:15], v[226:229]
 v_mfma_f32_16x16x32_bf16 v[230:233], v[218:221], v[92:95], v[230:233]
 ds_read_b128 v[218:221], v111 offset:0
 s_waitcnt lgkmcnt(5)
 v_mfma_f32_16x16x32_bf16 v[226:229], v[222:225], v[16:19], v[226:229]
 v_mfma_f32_16x16x32_bf16 v[230:233], v[222:225], v[96:99], v[230:233]
 ds_read_b128 v[222:225], v111 offset:1024
 s_waitcnt lgkmcnt(3)
 v_mfma_f32_16x16x32_bf16 v[226:229], v[210:213], v[20:23], v[226:229]
 v_mfma_f32_16x16x32_bf16 v[230:233], v[210:213], v[100:103], v[230:233]
 buffer_load_dwordx4 v[194:197], v2, s[4:7], s27 offen offset:0 sc1
 ds_read_b128 v[210:213], v111 offset:2048
 s_waitcnt lgkmcnt(3)
 v_mfma_f32_16x16x32_bf16 v[226:229], v[214:217], v[24:27], v[226:229]
 v_mfma_f32_16x16x32_bf16 v[230:233], v[214:217], v[104:107], v[230:233]
 ds_read_b128 v[214:217], v111 offset:3072
 s_waitcnt lgkmcnt(3)
 v_mfma_f32_16x16x32_bf16 v[226:229], v[218:221], v[28:31], v[226:229]
 ds_read_b128 v[218:221], v111 offset:4096
 s_waitcnt lgkmcnt(3)
 v_mfma_f32_16x16x32_bf16 v[226:229], v[222:225], v[32:35], v[226:229]
 buffer_load_dwordx4 v[198:201], v2, s[4:7], s27 offen offset:1024 sc1
 ds_read_b128 v[222:225], v112 offset:0
 s_waitcnt lgkmcnt(3)
 v_mfma_f32_16x16x32_bf16 v[226:229], v[210:213], v[36:39], v[226:229]
 ds_read_b128 v[210:213], v112 offset:1024
 s_waitcnt lgkmcnt(3)
 v_mfma_f32_16x16x32_bf16 v[226:229], v[214:217], v[40:43], v[226:229]
 ds_read_b128 v[214:217], v112 offset:2048
 s_waitcnt lgkmcnt(3)
 v_mfma_f32_16x16x32_bf16 v[226:229], v[218:221], v[44:47], v[226:229]
 buffer_load_dwordx4 v[202:205], v2, s[4:7], s27 offen offset:2048 sc1
 ds_read_b128 v[218:221], v112 offset:3072
 s_waitcnt lgkmcnt(3)
 v_mfma_f32_16x16x32_bf16 v[226:229], v[222:225], v[48:51], v[226:229]
 ds_read_b128 v[222:225], v112 offset:4096
 s_waitcnt lgkmcnt(3)
 v_mfma_f32_16x16x32_bf16 v[226:229], v[210:213], v[52:55], v[226:229]
 s_waitcnt lgkmcnt(2)
 v_mfma_f32_16x16x32_bf16 v[226:229], v[214:217], v[56:59], v[226:229]
 s_barrier
 ds_read_b128 v[206:209], v117 offset:28672
 s_waitcnt lgkmcnt(2)
 v_mfma_f32_16x16x32_bf16 v[226:229], v[218:221], v[60:63], v[226:229]
 s_waitcnt vmcnt(3)
 s_mov_b32 s41, 0
 v_min_i32 v1, 64, v125
 v_cmp_ge_i32 vcc, v126, v1
 s_nop 0
 s_cmp_eq_u64 vcc, -1
 s_cbranch_scc1 Lflok_184
Lfl_183:
 s_add_u32 s41, s41, 1
 s_cmp_gt_u32 s41, 200000
 s_cbranch_scc1 L_fail
 buffer_load_dword v126, v124, s[4:7], 0 offen sc1
 s_waitcnt vmcnt(0)
 v_cmp_ge_i32 vcc, v126, v1
 s_nop 0
 s_cmp_eq_u64 vcc, -1
 s_cbranch_scc0 Lfl_183
 buffer_load_dwordx4 v[194:197], v2, s[4:7], s27 offen offset:0 sc1
 buffer_load_dwordx4 v[198:201], v2, s[4:7], s27 offen offset:1024 sc1
 buffer_load_dwordx4 v[202:205], v2, s[4:7], s27 offen offset:2048 sc1
Lflok_184:
 v_add_u32 v125, 1, v125
 s_waitcnt lgkmcnt(1)
 v_mfma_f32_16x16x32_bf16 v[226:229], v[222:225], v[64:67], v[226:229]
 s_mov_b32 s41, 0
Lf_185:
 s_waitcnt vmcnt(2)
 v_add_f32 v210, v234, v194
 v_add_f32 v211, v235, v195
 v_add_f32 v212, v236, v196
 v_add_f32 v213, v237, v197
 s_waitcnt vmcnt(1)
 v_add_f32 v214, v238, v198
 v_add_f32 v215, v239, v199
 v_add_f32 v216, v240, v200
 v_add_f32 v217, v241, v201
 v_maximum3_f32 v1, v210, v211, v212
 v_maximum3_f32 v127, v213, v214, v215
 v_maximum3_f32 v1, v1, v216, v217
 s_waitcnt vmcnt(0)
 v_add_f32 v218, v190, v202
 v_add_f32 v219, v191, v203
 v_add_f32 v220, v192, v204
 v_add_f32 v221, v193, v205
 v_maximum3_f32 v127, v127, v218, v219
 v_maximum3_f32 v1, v1, v220, v221
 v_maximum3_f32 v1, v1, v127, v127
 v_cmp_u_f32 vcc, v1, v1
 v_mov_b32 v127, v1
 s_cbranch_vccnz Lfs_186
Lfok_187:
 s_nop 0
 v_permlane32_swap_b32 v1, v127
 v_max_f32 v1, v1, v127
 v_mov_b32 v127, v1
 v_cvt_pk_bf16_f32 v178, v226, v227
 v_cvt_pk_bf16_f32 v179, v228, v229
 v_permlane16_swap_b32 v1, v127
 v_max_f32 v1, v1, v127
 v_mul_f32 v1, s71, v1
 v_fma_f32 v210, v210, s71, -v1
 v_fma_f32 v211, v211, s71, -v1
 v_fma_f32 v212, v212, s71, -v1
 v_fma_f32 v213, v213, s71, -v1
 v_fma_f32 v214, v214, s71, -v1
 v_fma_f32 v215, v215, s71, -v1
 v_fma_f32 v216, v216, s71, -v1
 v_fma_f32 v217, v217, s71, -v1
 v_fma_f32 v218, v218, s71, -v1
 v_fma_f32 v219, v219, s71, -v1
 v_fma_f32 v220, v220, s71, -v1
 v_fma_f32 v221, v221, s71, -v1
 v_exp_f32 v210, v210
 v_exp_f32 v211, v211
 v_exp_f32 v212, v212
 v_exp_f32 v213, v213
 v_exp_f32 v214, v214
 v_exp_f32 v215, v215
 v_exp_f32 v216, v216
 v_exp_f32 v217, v217
 s_mov_b32 exec_lo, 0x00ff00ff
 s_mov_b32 exec_hi, 0x00ff00ff
 v_cvt_pk_bf16_f32 v162, v210, v211
 v_cvt_pk_bf16_f32 v163, v212, v213
 v_cvt_pk_bf16_f32 v164, v214, v215
 v_cvt_pk_bf16_f32 v165, v216, v217
 s_not_b64 exec, exec
 v_cvt_pk_bf16_f32 v166, v210, v211
 v_cvt_pk_bf16_f32 v167, v212, v213
 v_cvt_pk_bf16_f32 v168, v214, v215
 v_cvt_pk_bf16_f32 v169, v216, v217
 s_mov_b64 exec, -1
 v_mfma_f32_16x16x32_bf16 v[200:203], v[186:189], v[162:165], 0
 v_exp_f32 v218, v218
 v_exp_f32 v219, v219
 v_mfma_f32_16x16x32_bf16 v[192:195], v[142:145], v[162:165], 0
 v_exp_f32 v220, v220
 v_mfma_f32_16x16x32_bf16 v[196:199], v[146:149], v[162:165], 0
 v_exp_f32 v221, v221
 v_mfma_f32_16x16x32_bf16 v[200:203], v[186:189], v[166:169], v[200:203]
 v_cvt_pk_bf16_f32 v190, v218, v219
 v_cvt_pk_bf16_f32 v191, v220, v221
 s_waitcnt lgkmcnt(0)
 v_mfma_f32_16x16x32_bf16 v[192:195], v[150:153], v[166:169], v[192:195]
 v_add_f32 v230, v230, v206
 v_add_f32 v231, v231, v207
 v_add_f32 v232, v232, v208
 v_mfma_f32_16x16x32_bf16 v[196:199], v[154:157], v[166:169], v[196:199]
 v_add_f32 v233, v233, v209
 v_cvt_pk_bf16_f32 v180, v230, v231
 v_cvt_pk_bf16_f32 v181, v232, v233
 v_mfma_f32_16x16x16_bf16 v[200:203], v[186:187], v[190:191], v[200:203]
 s_add_u32 s25, s61, s55
 s_add_u32 s27, s61, s56
 v_mfma_f32_16x16x16_bf16 v[192:195], v[178:179], v[190:191], v[192:195]
 s_add_u32 s28, s27, 4096
 v_mfma_f32_16x16x16_bf16 v[196:199], v[180:181], v[190:191], v[196:199]
 s_mov_b32 s41, 0
 s_nop 0
 v_rcp_f32 v127, v200
 s_nop 1
 v_mul_f32 v192, v192, v127
 v_mul_f32 v193, v193, v127
 v_mul_f32 v194, v194, v127
 v_mul_f32 v195, v195, v127
 v_cvt_pk_bf16_f32 v204, v192, v193
 v_cvt_pk_bf16_f32 v205, v194, v195
 v_mul_f32 v196, v196, v127
 v_mul_f32 v197, v197, v127
 v_mul_f32 v198, v198, v127
 v_mul_f32 v199, v199, v127
 v_cvt_pk_bf16_f32 v206, v196, v197
 v_cvt_pk_bf16_f32 v207, v198, v199
 buffer_store_dwordx4 v[204:207], v2, s[4:7], s25 offen sc1
 ds_write_b64 v118, v[178:179] offset:0
 ds_write_b64 v118, v[180:181] offset:2048
 ds_read_b128 v[142:145], v115 offset:0
 ds_read_b128 v[146:149], v115 offset:1024
 ds_read_b128 v[150:153], v115 offset:2048
 ds_read_b128 v[154:157], v115 offset:3072
 ds_read_b128 v[234:237], v115 offset:4096
 ds_read_b128 v[238:241], v115 offset:5120
 ds_read_b128 v[242:245], v115 offset:6144
 ds_read_b128 v[246:249], v115 offset:7168
 ds_read_b128 v[250:253], v115 offset:8192
 s_sleep 2
 buffer_load_dwordx4 v[190:193], v2, s[4:7], s27 offen offset:0 sc1
 buffer_load_dwordx4 v[194:197], v2, s[4:7], s27 offen offset:1024 sc1
 buffer_load_dwordx4 v[198:201], v2, s[4:7], s27 offen offset:2048 sc1
 buffer_load_dwordx4 v[202:205], v2, s[4:7], s27 offen offset:3072 sc1
 buffer_load_dwordx4 v[206:209], v2, s[4:7], s28 offen offset:0 sc1
 buffer_load_dwordx4 v[210:213], v2, s[4:7], s28 offen offset:1024 sc1
 s_waitcnt lgkmcnt(0)
Lo_188:
 s_waitcnt vmcnt(5)
 v_max3_u32 v1, v190, v191, v192
 v_max_u32 v1, v1, v193
 v_cmp_eq_u32 vcc, -1, v1
 s_cbranch_vccnz Los_189
 v_mfma_f32_16x16x32_bf16 v[214:217], v[142:145], v[190:193], 0
 ds_read_b128 v[142:145], v115 offset:9216
 v_mfma_f32_16x16x32_bf16 v[218:221], v[146:149], v[190:193], 0
 ds_read_b128 v[146:149], v115 offset:10240
 s_waitcnt vmcnt(4)
 v_max3_u32 v1, v194, v195, v196
 v_mfma_f32_16x16x32_bf16 v[222:225], v[150:153], v[190:193], 0
 ds_read_b128 v[150:153], v115 offset:11264
 v_max_u32 v1, v1, v197
 v_mfma_f32_16x16x32_bf16 v[226:229], v[154:157], v[190:193], 0
 ds_read_b128 v[154:157], v115 offset:12288
 v_cmp_eq_u32 vcc, -1, v1
 v_mfma_f32_16x16x32_bf16 v[230:233], v[234:237], v[190:193], 0
 ds_read_b128 v[234:237], v115 offset:13312
Lo_190:
 s_cbranch_vccnz Los_191
 v_mfma_f32_16x16x32_bf16 v[214:217], v[238:241], v[194:197], v[214:217]
 ds_read_b128 v[238:241], v115 offset:14336
 v_mfma_f32_16x16x32_bf16 v[218:221], v[242:245], v[194:197], v[218:221]
 ds_read_b128 v[242:245], v116 offset:0
 s_waitcnt vmcnt(3)
 v_max3_u32 v1, v198, v199, v200
 v_mfma_f32_16x16x32_bf16 v[222:225], v[246:249], v[194:197], v[222:225]
 ds_read_b128 v[246:249], v116 offset:1024
 v_max_u32 v1, v1, v201
 v_mfma_f32_16x16x32_bf16 v[226:229], v[250:253], v[194:197], v[226:229]
 ds_read_b128 v[250:253], v116 offset:2048
 v_cmp_eq_u32 vcc, -1, v1
 s_waitcnt lgkmcnt(7)
 v_mfma_f32_16x16x32_bf16 v[230:233], v[142:145], v[194:197], v[230:233]
 ds_read_b128 v[142:145], v116 offset:3072
Lo_192:
 s_cbranch_vccnz Los_193
 v_mfma_f32_16x16x32_bf16 v[214:217], v[146:149], v[198:201], v[214:217]
 ds_read_b128 v[146:149], v116 offset:4096
 s_waitcnt lgkmcnt(7)
 v_mfma_f32_16x16x32_bf16 v[218:221], v[150:153], v[198:201], v[218:221]
 ds_read_b128 v[150:153], v116 offset:5120
 s_waitcnt vmcnt(2)
 v_max3_u32 v1, v202, v203, v204
 v_mfma_f32_16x16x32_bf16 v[222:225], v[154:157], v[198:201], v[222:225]
 ds_read_b128 v[154:157], v116 offset:6144
 v_max_u32 v1, v1, v205
 s_waitcnt lgkmcnt(7)
 v_mfma_f32_16x16x32_bf16 v[226:229], v[234:237], v[198:201], v[226:229]
 ds_read_b128 v[234:237], v116 offset:7168
 v_cmp_eq_u32 vcc, -1, v1
 v_mfma_f32_16x16x32_bf16 v[230:233], v[238:241], v[198:201], v[230:233]
 ds_read_b128 v[238:241], v116 offset:8192
Lo_194:
 s_cbranch_vccnz Los_195
 s_waitcnt lgkmcnt(7)
 v_mfma_f32_16x16x32_bf16 v[214:217], v[242:245], v[202:205], v[214:217]
 ds_read_b128 v[242:245], v116 offset:9216
 v_mfma_f32_16x16x32_bf16 v[218:221], v[246:249], v[202:205], v[218:221]
 ds_read_b128 v[246:249], v116 offset:10240
 s_waitcnt vmcnt(1)
 v_max3_u32 v1, v206, v207, v208
 s_waitcnt lgkmcnt(7)
 v_mfma_f32_16x16x32_bf16 v[222:225], v[250:253], v[202:205], v[222:225]
 ds_read_b128 v[250:253], v116 offset:11264
 v_max_u32 v1, v1, v209
 v_mfma_f32_16x16x32_bf16 v[226:229], v[142:145], v[202:205], v[226:229]
 ds_read_b128 v[142:145], v116 offset:12288
 v_cmp_eq_u32 vcc, -1, v1
 s_waitcnt lgkmcnt(7)
 v_mfma_f32_16x16x32_bf16 v[230:233], v[146:149], v[202:205], v[230:233]
 ds_read_b128 v[146:149], v116 offset:13312
Lo_196:
 s_cbranch_vccnz Los_197
 v_mfma_f32_16x16x32_bf16 v[214:217], v[150:153], v[206:209], v[214:217]
 ds_read_b128 v[150:153], v116 offset:14336
 s_waitcnt lgkmcnt(7)
 v_mfma_f32_16x16x32_bf16 v[218:221], v[154:157], v[206:209], v[218:221]
 s_waitcnt vmcnt(0)
 v_max3_u32 v1, v210, v211, v212
 v_mfma_f32_16x16x32_bf16 v[222:225], v[234:237], v[206:209], v[222:225]
 v_max_u32 v1, v1, v213
 s_waitcnt lgkmcnt(5)
 v_mfma_f32_16x16x32_bf16 v[226:229], v[238:241], v[206:209], v[226:229]
 v_cmp_eq_u32 vcc, -1, v1
 v_mfma_f32_16x16x32_bf16 v[230:233], v[242:245], v[206:209], v[230:233]
Lo_198:
 s_cbranch_vccnz Los_199
 s_waitcnt lgkmcnt(3)
 v_mfma_f32_16x16x32_bf16 v[214:217], v[246:249], v[210:213], v[214:217]
 buffer_load_dwordx4 v[130:133], v2, s[4:7], s67 offen sc1
 v_mfma_f32_16x16x32_bf16 v[218:221], v[250:253], v[210:213], v[218:221]
 buffer_load_dwordx4 v[134:137], v2, s[4:7], s67 offen offset:2048 sc1
 s_waitcnt lgkmcnt(1)
 v_mfma_f32_16x16x32_bf16 v[222:225], v[142:145], v[210:213], v[222:225]
 s_add_u32 s25, s67, 4096
 buffer_load_dwordx4 v[138:141], v2, s[4:7], s25 offen sc1
 v_mfma_f32_16x16x32_bf16 v[226:229], v[146:149], v[210:213], v[226:229]
 s_waitcnt lgkmcnt(0)
 v_mfma_f32_16x16x32_bf16 v[230:233], v[150:153], v[210:213], v[230:233]
 v_cvt_pk_bf16_f32 v190, v214, v215
 v_cvt_pk_bf16_f32 v191, v216, v217
 v_cvt_pk_bf16_f32 v192, v218, v219
 v_cvt_pk_bf16_f32 v193, v220, v221
 ds_write_b128 v119, v[190:193]
 v_cvt_pk_bf16_f32 v194, v222, v223
 v_cvt_pk_bf16_f32 v195, v224, v225
 v_cvt_pk_bf16_f32 v196, v226, v227
 v_cvt_pk_bf16_f32 v197, v228, v229
 ds_write_b128 v119, v[194:197] offset:4096
 v_cvt_pk_bf16_f32 v198, v230, v231
 v_cvt_pk_bf16_f32 v199, v232, v233
 ds_write_b64 v120, v[198:199] offset:8192
 s_add_u32 s25, s63, s46
 s_add_u32 s26, s63, s47
 s_add_u32 s27, s25, 655360
 s_add_u32 s28, s26, 655360
 s_waitcnt lgkmcnt(0)
 s_barrier
 ds_read_b128 v[190:193], v121 offset:0
 ds_read_b128 v[194:197], v121 offset:1024
 s_waitcnt lgkmcnt(1)
 v_mfma_f32_16x16x32_bf16 v[206:209], v[170:173], v[190:193], 0
 s_waitcnt lgkmcnt(0)
 v_mfma_f32_16x16x32_bf16 v[206:209], v[174:177], v[194:197], v[206:209]
 s_nop 7
 v_cvt_pk_bf16_f32 v214, v206, v207
 v_cvt_pk_bf16_f32 v215, v208, v209
 buffer_store_dwordx2 v[214:215], v122, s[4:7], s25 offen sc1
 buffer_store_dwordx2 v[214:215], v122, s[4:7], s27 offen sc1
 s_add_u32 s27, s63, s48
 s_add_u32 s28, s63, s49
 s_add_u32 s70, s31, 1
 s_and_b32 s25, s70, 3
 s_mul_i32 s26, s25, 20480
 s_add_u32 s57, s26, s42
 s_add_u32 s58, s57, 4096
 s_add_u32 s59, s26, s43
 s_mul_i32 s63, s25, 163840
 s_xor_b32 s26, s25, 2
 s_mul_i32 s64, s26, 163840
 s_add_u32 s25, s25, 3
 s_and_b32 s25, s25, 3
 s_mul_i32 s26, s25, 20480
 s_add_u32 s60, s26, s43
 s_and_b32 s25, s70, 1
 s_mul_i32 s61, s25, 196608
 s_xor_b32 s25, s25, 1
 s_mul_i32 s62, s25, 196608
 s_mul_i32 s70, s70, 196608
 s_sleep 6
 s_mov_b32 s41, 0
 buffer_load_dwordx4 v[190:193], v2, s[4:7], s27 offen sc1
 buffer_load_dwordx4 v[194:197], v2, s[4:7], s28 offen sc1
Lj_201:
 s_waitcnt vmcnt(1)
 v_mfma_f32_16x16x32_bf16 v[198:201], v[170:173], v[190:193], 0
 s_waitcnt vmcnt(0)
 v_mfma_f32_16x16x32_bf16 v[198:201], v[170:173], v[194:197], v[198:201]
 v_max3_u32 v202, v190, v191, v192
 v_max3_u32 v202, v202, v193, v194
 v_max3_u32 v202, v202, v195, v196
 v_max_u32 v202, v202, v197
 v_cmp_eq_u32 vcc, -1, v202
 s_cbranch_vccnz Ljs_202
 s_nop 1
 v_cvt_pk_bf16_f32 v202, v198, v199
 v_cvt_pk_bf16_f32 v203, v200, v201
 s_mov_b64 exec, 0xffffffff
 s_cmp_eq_u32 s31, 7
 s_cbranch_scc1 Lov_203
Lnov_204:
 buffer_store_dwordx2 v[202:203], v123, s[4:7], s59 offen sc1
 buffer_store_dwordx2 v[182:183], v123, s[4:7], s60 offen sc1
 s_mov_b64 exec, -1
Lnr_200:
 s_add_u32 s31, s31, 1
 s_cmp_lt_u32 s31, 72
 s_barrier
 s_cbranch_scc1 L_rec_top_0r
 s_waitcnt vmcnt(0)
 s_barrier
 s_mov_b64 exec, 1
 v_mov_b32 v1, s31
 buffer_store_dword v1, off, s[4:7], s54 sc1
 s_mov_b64 exec, -1
 s_endpgm
Lzs_174:
 buffer_load_dwordx4 v[190:193], v2, s[4:7], s57 offen offset:0 sc1
 buffer_load_dwordx4 v[194:197], v2, s[4:7], s57 offen offset:1024 sc1
 buffer_load_dwordx4 v[198:201], v2, s[4:7], s57 offen offset:2048 sc1
 buffer_load_dwordx4 v[202:205], v2, s[4:7], s57 offen offset:3072 sc1
 buffer_load_dwordx4 v[206:209], v2, s[4:7], s58 offen offset:0 sc1
 s_add_u32 s41, s41, 1
 s_cmp_gt_u32 s41, 200000
 s_cbranch_scc1 L_fail
 s_branch Lz_173
Lzs_176:
 buffer_load_dwordx4 v[194:197], v2, s[4:7], s57 offen offset:1024 sc1
 buffer_load_dwordx4 v[198:201], v2, s[4:7], s57 offen offset:2048 sc1
 buffer_load_dwordx4 v[202:205], v2, s[4:7], s57 offen offset:3072 sc1
 buffer_load_dwordx4 v[206:209], v2, s[4:7], s58 offen offset:0 sc1
 s_add_u32 s41, s41, 1
 s_cmp_gt_u32 s41, 200000
 s_cbranch_scc1 L_fail
 s_branch Lz_175
Lzs_178:
 buffer_load_dwordx4 v[198:201], v2, s[4:7], s57 offen offset:2048 sc1
 buffer_load_dwordx4 v[202:205], v2, s[4:7], s57 offen offset:3072 sc1
 buffer_load_dwordx4 v[206:209], v2, s[4:7], s58 offen offset:0 sc1
 s_add_u32 s41, s41, 1
 s_cmp_gt_u32 s41, 200000
 s_cbranch_scc1 L_fail
 s_branch Lz_177
Lzs_180:
 buffer_load_dwordx4 v[202:205], v2, s[4:7], s57 offen offset:3072 sc1
 buffer_load_dwordx4 v[206:209], v2, s[4:7], s58 offen offset:0 sc1
 s_add_u32 s41, s41, 1
 s_cmp_gt_u32 s41, 200000
 s_cbranch_scc1 L_fail
 s_branch Lz_179
Lzs_182:
 buffer_load_dwordx4 v[206:209], v2, s[4:7], s58 offen offset:0 sc1
 s_add_u32 s41, s41, 1
 s_cmp_gt_u32 s41, 200000
 s_cbranch_scc1 L_fail
 s_branch Lz_181
Lfs_186:
 v_max3_u32 v222, v194, v195, v196
 v_max3_u32 v222, v222, v197, v198
 v_max3_u32 v222, v222, v199, v200
 v_max3_u32 v222, v222, v201, v202
 v_max3_u32 v222, v222, v203, v204
 v_max_u32 v222, v222, v205
 v_cmp_eq_u32 vcc, -1, v222
 s_cbranch_vccz Lfok_187
 buffer_load_dwordx4 v[194:197], v2, s[4:7], s27 offen offset:0 sc1
 buffer_load_dwordx4 v[198:201], v2, s[4:7], s27 offen offset:1024 sc1
 buffer_load_dwordx4 v[202:205], v2, s[4:7], s27 offen offset:2048 sc1
 s_add_u32 s41, s41, 1
 s_cmp_gt_u32 s41, 200000
 s_cbranch_scc1 L_fail
 s_branch Lf_185
Los_189:
 buffer_load_dwordx4 v[190:193], v2, s[4:7], s27 offen offset:0 sc1
 buffer_load_dwordx4 v[194:197], v2, s[4:7], s27 offen offset:1024 sc1
 buffer_load_dwordx4 v[198:201], v2, s[4:7], s27 offen offset:2048 sc1
 buffer_load_dwordx4 v[202:205], v2, s[4:7], s27 offen offset:3072 sc1
 buffer_load_dwordx4 v[206:209], v2, s[4:7], s28 offen offset:0 sc1
 buffer_load_dwordx4 v[210:213], v2, s[4:7], s28 offen offset:1024 sc1
 s_add_u32 s41, s41, 1
 s_cmp_gt_u32 s41, 200000
 s_cbranch_scc1 L_fail
 s_branch Lo_188
Los_191:
 buffer_load_dwordx4 v[194:197], v2, s[4:7], s27 offen offset:1024 sc1
 buffer_load_dwordx4 v[198:201], v2, s[4:7], s27 offen offset:2048 sc1
 buffer_load_dwordx4 v[202:205], v2, s[4:7], s27 offen offset:3072 sc1
 buffer_load_dwordx4 v[206:209], v2, s[4:7], s28 offen offset:0 sc1
 buffer_load_dwordx4 v[210:213], v2, s[4:7], s28 offen offset:1024 sc1
 s_waitcnt vmcnt(4)
 v_max3_u32 v1, v194, v195, v196
 v_max_u32 v1, v1, v197
 v_cmp_eq_u32 vcc, -1, v1
 s_add_u32 s41, s41, 1
 s_cmp_gt_u32 s41, 200000
 s_cbranch_scc1 L_fail
 s_branch Lo_190
Los_193:
 buffer_load_dwordx4 v[198:201], v2, s[4:7], s27 offen offset:2048 sc1
 buffer_load_dwordx4 v[202:205], v2, s[4:7], s27 offen offset:3072 sc1
 buffer_load_dwordx4 v[206:209], v2, s[4:7], s28 offen offset:0 sc1
 buffer_load_dwordx4 v[210:213], v2, s[4:7], s28 offen offset:1024 sc1
 s_waitcnt vmcnt(3)
 v_max3_u32 v1, v198, v199, v200
 v_max_u32 v1, v1, v201
 v_cmp_eq_u32 vcc, -1, v1
 s_add_u32 s41, s41, 1
 s_cmp_gt_u32 s41, 200000
 s_cbranch_scc1 L_fail
 s_branch Lo_192
Los_195:
 buffer_load_dwordx4 v[202:205], v2, s[4:7], s27 offen offset:3072 sc1
 buffer_load_dwordx4 v[206:209], v2, s[4:7], s28 offen offset:0 sc1
 buffer_load_dwordx4 v[210:213], v2, s[4:7], s28 offen offset:1024 sc1
 s_waitcnt vmcnt(2)
 v_max3_u32 v1, v202, v203, v204
 v_max_u32 v1, v1, v205
 v_cmp_eq_u32 vcc, -1, v1
 s_add_u32 s41, s41, 1
 s_cmp_gt_u32 s41, 200000
 s_cbranch_scc1 L_fail
 s_branch Lo_194
Los_197:
 buffer_load_dwordx4 v[206:209], v2, s[4:7], s28 offen offset:0 sc1
 buffer_load_dwordx4 v[210:213], v2, s[4:7], s28 offen offset:1024 sc1
 s_waitcnt vmcnt(1)
 v_max3_u32 v1, v206, v207, v208
 v_max_u32 v1, v1, v209
 v_cmp_eq_u32 vcc, -1, v1
 s_add_u32 s41, s41, 1
 s_cmp_gt_u32 s41, 200000
 s_cbranch_scc1 L_fail
 s_branch Lo_196
Los_199:
 buffer_load_dwordx4 v[210:213], v2, s[4:7], s28 offen offset:1024 sc1
 s_waitcnt vmcnt(0)
 v_max3_u32 v1, v210, v211, v212
 v_max_u32 v1, v1, v213
 v_cmp_eq_u32 vcc, -1, v1
 s_add_u32 s41, s41, 1
 s_cmp_gt_u32 s41, 200000
 s_cbranch_scc1 L_fail
 s_branch Lo_198
Ljs_202:
 buffer_load_dwordx4 v[190:193], v2, s[4:7], s27 offen sc1
 buffer_load_dwordx4 v[194:197], v2, s[4:7], s28 offen sc1
 s_add_u32 s41, s41, 1
 s_cmp_gt_u32 s41, 200000
 s_cbranch_scc1 L_fail
 s_branch Lj_201
Lov_203:
 s_mov_b32 exec_lo, 0xff00ff00
 v_mov_b32 v202, v128
 v_mov_b32 v203, v129
 s_mov_b32 exec_lo, -1
 s_add_u32 s41, s41, 1
 s_cmp_gt_u32 s41, 200000
 s_cbranch_scc1 L_fail
 s_branch Lnov_204
Lpwn_171:
 s_cmp_eq_u32 s3, 1
 s_cbranch_scc0 Lpwn_206
 s_waitcnt vmcnt(0)
 s_cmp_eq_u32 s40, 0
 s_cbranch_scc1 Lz0_207
 s_mov_b64 exec, 0xffffffff
 buffer_store_dwordx2 v[128:129], v123, s[4:7], s43 offen sc1
 s_mov_b64 exec, -1
Lz0_207:
 s_barrier
L_rec_top_1r:
 s_sleep 2
 buffer_load_dwordx4 v[190:193], v2, s[4:7], s57 offen offset:0 sc1
 buffer_load_dwordx4 v[194:197], v2, s[4:7], s57 offen offset:1024 sc1
 buffer_load_dwordx4 v[198:201], v2, s[4:7], s57 offen offset:2048 sc1
 buffer_load_dwordx4 v[202:205], v2, s[4:7], s57 offen offset:3072 sc1
 buffer_load_dwordx4 v[206:209], v2, s[4:7], s58 offen offset:0 sc1
 s_mov_b32 s41, 0
Lz_208:
 s_waitcnt vmcnt(4)
 ds_write_b128 v109, v[190:193] offset:0
 v_mfma_f32_16x16x32_bf16 v[226:229], a[0:3], v[190:193], 0
 v_max3_u32 v1, v190, v191, v192
 v_max_u32 v1, v1, v193
 v_mfma_f32_16x16x32_bf16 v[230:233], a[80:83], v[190:193], 0
 v_cmp_eq_u32 vcc, -1, v1
 v_mfma_f32_16x16x32_bf16 v[234:237], a[160:163], v[190:193], 0
 s_cbranch_vccnz Lzs_209
Lz_210:
 s_waitcnt vmcnt(3)
 ds_write_b128 v109, v[194:197] offset:1024
 v_max3_u32 v1, v194, v195, v196
 v_max_u32 v1, v1, v197
 v_cmp_eq_u32 vcc, -1, v1
 s_cbranch_vccnz Lzs_211
 v_mfma_f32_16x16x32_bf16 v[226:229], a[4:7], v[194:197], v[226:229]
 v_mfma_f32_16x16x32_bf16 v[230:233], a[84:87], v[194:197], v[230:233]
 v_mfma_f32_16x16x32_bf16 v[234:237], a[164:167], v[194:197], v[234:237]
Lz_212:
 s_waitcnt vmcnt(2)
 ds_write_b128 v109, v[198:201] offset:2048
 v_max3_u32 v1, v198, v199, v200
 v_max_u32 v1, v1, v201
 v_cmp_eq_u32 vcc, -1, v1
 s_cbranch_vccnz Lzs_213
 v_mfma_f32_16x16x32_bf16 v[226:229], a[8:11], v[198:201], v[226:229]
 v_mfma_f32_16x16x32_bf16 v[230:233], a[88:91], v[198:201], v[230:233]
 v_mfma_f32_16x16x32_bf16 v[234:237], a[168:171], v[198:201], v[234:237]
Lz_214:
 s_waitcnt vmcnt(1)
 ds_write_b128 v109, v[202:205] offset:3072
 v_max3_u32 v1, v202, v203, v204
 v_max_u32 v1, v1, v205
 v_cmp_eq_u32 vcc, -1, v1
 s_cbranch_vccnz Lzs_215
Lz_216:
 s_waitcnt vmcnt(0)
 ds_write_b128 v109, v[206:209] offset:4096
 v_max3_u32 v1, v206, v207, v208
 v_max_u32 v1, v1, v209
 v_cmp_eq_u32 vcc, -1, v1
 s_cbranch_vccnz Lzs_217
 s_waitcnt lgkmcnt(0)
 s_barrier
 ds_read_b128 v[214:217], v110 offset:0
 ds_read_b128 v[218:221], v110 offset:1024
 ds_read_b128 v[222:225], v110 offset:2048
 v_mfma_f32_16x16x32_bf16 v[226:229], a[12:15], v[202:205], v[226:229]
 s_add_u32 s25, s68, s51
 v_mfma_f32_16x16x32_bf16 v[230:233], a[92:95], v[202:205], v[230:233]
 buffer_load_dwordx4 v[142:145], v2, s[4:7], s25 offen sc1
 v_mfma_f32_16x16x32_bf16 v[234:237], a[172:175], v[202:205], v[234:237]
 v_mfma_f32_16x16x32_bf16 v[226:229], a[16:19], v[206:209], v[226:229]
 s_add_u32 s25, s68, s52
 v_mfma_f32_16x16x32_bf16 v[230:233], a[96:99], v[206:209], v[230:233]
 buffer_load_dwordx4 v[146:149], v2, s[4:7], s25 offen sc1
 v_mfma_f32_16x16x32_bf16 v[234:237], a[176:179], v[206:209], v[234:237]
 ds_read_b128 v[210:213], v110 offset:3072
 s_waitcnt lgkmcnt(3)
 v_mfma_f32_16x16x32_bf16 v[226:229], a[20:23], v[214:217], v[226:229]
 s_add_u32 s25, s69, s51
 v_mfma_f32_16x16x32_bf16 v[230:233], a[100:103], v[214:217], v[230:233]
 buffer_load_dwordx4 v[150:153], v2, s[4:7], s25 offen sc1
 v_mfma_f32_16x16x32_bf16 v[234:237], a[180:183], v[214:217], v[234:237]
 ds_read_b128 v[214:217], v110 offset:4096
 s_waitcnt lgkmcnt(3)
 v_mfma_f32_16x16x32_bf16 v[226:229], a[24:27], v[218:221], v[226:229]
 s_add_u32 s25, s69, s52
 v_mfma_f32_16x16x32_bf16 v[230:233], a[104:107], v[218:221], v[230:233]
 buffer_load_dwordx4 v[154:157], v2, s[4:7], s25 offen sc1
 v_mfma_f32_16x16x32_bf16 v[234:237], a[184:187], v[218:221], v[234:237]
 ds_read_b128 v[218:221], v111 offset:0
 s_waitcnt lgkmcnt(3)
 v_mfma_f32_16x16x32_bf16 v[226:229], a[28:31], v[222:225], v[226:229]
 s_add_u32 s25, s44, s62
 v_mfma_f32_16x16x32_bf16 v[230:233], a[108:111], v[222:225], v[230:233]
 buffer_store_dwordx4 v[182:185], v2, s[4:7], s25 offen offset:0 sc1
 v_mfma_f32_16x16x32_bf16 v[234:237], a[188:191], v[222:225], v[234:237]
 ds_read_b128 v[222:225], v111 offset:1024
 s_waitcnt lgkmcnt(3)
 v_mfma_f32_16x16x32_bf16 v[226:229], a[32:35], v[210:213], v[226:229]
 s_add_u32 s25, s44, s62
 v_mfma_f32_16x16x32_bf16 v[230:233], a[112:115], v[210:213], v[230:233]
 s_add_u32 s25, s25, 1867776
 v_mfma_f32_16x16x32_bf16 v[234:237], a[192:195], v[210:213], v[234:237]
 buffer_store_dwordx4 v[182:185], v2, s[4:7], s25 offen offset:0 sc1
 ds_read_b128 v[210:213], v111 offset:2048
 s_waitcnt lgkmcnt(3)
 v_mfma_f32_16x16x32_bf16 v[226:229], a[36:39], v[214:217], v[226:229]
 s_add_u32 s25, s46, s64
 v_mfma_f32_16x16x32_bf16 v[230:233], a[116:119], v[214:217], v[230:233]
 buffer_store_dwordx2 v[182:183], v122, s[4:7], s25 offen sc1
 v_mfma_f32_16x16x32_bf16 v[234:237], a[196:199], v[214:217], v[234:237]
 ds_read_b128 v[214:217], v111 offset:3072
 s_waitcnt lgkmcnt(3)
 v_mfma_f32_16x16x32_bf16 v[226:229], a[40:43], v[218:221], v[226:229]
 s_add_u32 s25, s25, 655360
 v_mfma_f32_16x16x32_bf16 v[230:233], a[120:123], v[218:221], v[230:233]
 buffer_store_dwordx2 v[182:183], v122, s[4:7], s25 offen sc1
 v_mfma_f32_16x16x32_bf16 v[234:237], a[200:203], v[218:221], v[234:237]
 ds_read_b128 v[218:221], v111 offset:4096
 s_waitcnt lgkmcnt(3)
 v_mfma_f32_16x16x32_bf16 v[226:229], a[44:47], v[222:225], v[226:229]
 s_add_u32 s25, s31, 1
 s_mul_i32 s68, s25, 393216
 v_mfma_f32_16x16x32_bf16 v[230:233], a[124:127], v[222:225], v[230:233]
 s_add_u32 s68, s68, 84066304
 s_cmp_lt_u32 s25, 64
 v_mfma_f32_16x16x32_bf16 v[234:237], a[204:207], v[222:225], v[234:237]
 s_cselect_b32 s68, s68, 2146435072
 ds_read_b128 v[222:225], v112 offset:0
 s_waitcnt lgkmcnt(3)
 v_mfma_f32_16x16x32_bf16 v[226:229], a[48:51], v[210:213], v[226:229]
 s_sub_u32 s26, s25, 8
 s_mul_i32 s69, s26, 393216
 v_mfma_f32_16x16x32_bf16 v[230:233], a[128:131], v[210:213], v[230:233]
 s_add_u32 s69, s69, 134397952
 s_cmp_lt_u32 s26, 64
 v_mfma_f32_16x16x32_bf16 v[234:237], a[208:211], v[210:213], v[234:237]
 s_cselect_b32 s69, s69, 2146435072
 ds_read_b128 v[210:213], v112 offset:1024
 s_waitcnt lgkmcnt(3)
 v_mfma_f32_16x16x32_bf16 v[226:229], a[52:55], v[214:217], v[226:229]
 s_add_u32 s25, s68, 4269801472
 s_add_u32 s26, s69, 4269801472
 v_mfma_f32_16x16x32_bf16 v[230:233], a[132:135], v[214:217], v[230:233]
 s_cmp_lt_u32 s3, 2
 s_cselect_b32 s67, s25, s26
 v_mfma_f32_16x16x32_bf16 v[234:237], a[212:215], v[214:217], v[234:237]
 s_add_u32 s67, s67, s50
 ds_read_b128 v[214:217], v112 offset:2048
 s_waitcnt lgkmcnt(3)
 v_mfma_f32_16x16x32_bf16 v[226:229], a[56:59], v[218:221], v[226:229]
 v_mfma_f32_16x16x32_bf16 v[230:233], a[136:139], v[218:221], v[230:233]
 v_mfma_f32_16x16x32_bf16 v[234:237], a[216:219], v[218:221], v[234:237]
 ds_read_b128 v[218:221], v112 offset:3072
 s_waitcnt lgkmcnt(3)
 v_mfma_f32_16x16x32_bf16 v[226:229], a[60:63], v[222:225], v[226:229]
 v_mfma_f32_16x16x32_bf16 v[230:233], a[140:143], v[222:225], v[230:233]
 v_mfma_f32_16x16x32_bf16 v[234:237], a[220:223], v[222:225], v[234:237]
 ds_read_b128 v[222:225], v112 offset:4096
 s_waitcnt lgkmcnt(3)
 v_mfma_f32_16x16x32_bf16 v[226:229], a[64:67], v[210:213], v[226:229]
 v_mfma_f32_16x16x32_bf16 v[230:233], a[144:147], v[210:213], v[230:233]
 v_mfma_f32_16x16x32_bf16 v[234:237], a[224:227], v[210:213], v[234:237]
 s_waitcnt lgkmcnt(2)
 v_mfma_f32_16x16x32_bf16 v[226:229], a[68:71], v[214:217], v[226:229]
 v_mfma_f32_16x16x32_bf16 v[230:233], a[148:151], v[214:217], v[230:233]
 v_mfma_f32_16x16x32_bf16 v[234:237], a[228:231], v[214:217], v[234:237]
 s_waitcnt lgkmcnt(1)
 v_mfma_f32_16x16x32_bf16 v[226:229], a[72:75], v[218:221], v[226:229]
 v_mfma_f32_16x16x32_bf16 v[230:233], a[152:155], v[218:221], v[230:233]
 v_mfma_f32_16x16x32_bf16 v[234:237], a[232:235], v[218:221], v[234:237]
 s_waitcnt lgkmcnt(0)
 v_mfma_f32_16x16x32_bf16 v[226:229], a[76:79], v[222:225], v[226:229]
 v_mfma_f32_16x16x32_bf16 v[230:233], a[156:159], v[222:225], v[230:233]
 v_mfma_f32_16x16x32_bf16 v[234:237], a[236:239], v[222:225], v[234:237]
 s_nop 1
 v_cvt_pk_bf16_f32 v190, v226, v227
 v_cvt_pk_bf16_f32 v191, v228, v229
 ds_write_b64 v113, v[190:191] offset:0
 v_cvt_pk_bf16_f32 v192, v230, v231
 v_cvt_pk_bf16_f32 v193, v232, v233
 ds_write_b64 v114, v[192:193] offset:0
 v_cvt_pk_bf16_f32 v194, v234, v235
 v_cvt_pk_bf16_f32 v195, v236, v237
 ds_write_b64 v113, v[194:195] offset:1024
 s_add_u32 s26, s61, s44
 s_add_u32 s27, s61, s45
 s_waitcnt lgkmcnt(0)
 s_barrier
 ds_read_b128 v[198:201], v3 offset:20480
 ds_read_b128 v[202:205], v3 offset:21504
 ds_read_b128 v[206:209], v3 offset:22528
 ds_read_b128 v[226:229], v3 offset:23552
 ds_read_b128 v[230:233], v3 offset:24576
 ds_read_b128 v[234:237], v3 offset:25600
 ds_read_b128 v[210:213], v109 offset:0
 ds_read_b128 v[214:217], v109 offset:1024
 ds_read_b128 v[218:221], v109 offset:2048
 s_waitcnt lgkmcnt(8)
 v_mfma_f32_16x16x32_bf16 v[194:197], v[130:133], v[198:201], 0
 s_waitcnt lgkmcnt(7)
 v_mfma_f32_16x16x32_bf16 v[194:197], v[134:137], v[202:205], v[194:197]
 s_waitcnt lgkmcnt(6)
 v_mfma_f32_16x16x32_bf16 v[194:197], v[138:141], v[206:209], v[194:197]
 s_waitcnt lgkmcnt(5)
 v_mfma_f32_16x16x32_bf16 v[190:193], v[226:229], v[198:201], v[158:161]
 s_waitcnt lgkmcnt(4)
 v_mfma_f32_16x16x32_bf16 v[190:193], v[230:233], v[202:205], v[190:193]
 s_mov_b32 exec_lo, 0x00ff00ff
 s_mov_b32 exec_hi, 0x00ff00ff
 s_waitcnt lgkmcnt(3)
 v_mfma_f32_16x16x32_bf16 v[190:193], v[234:237], v[206:209], v[190:193]
 buffer_store_dwordx4 v[194:197], v2, s[4:7], s26 offen offset:1024 sc1
 ds_write_b128 v117, v[194:197] offset:26624
 s_mov_b64 exec, -1
 ds_read_b128 v[222:225], v109 offset:3072
 s_waitcnt lgkmcnt(4)
 v_mfma_f32_16x16x32_bf16 v[226:229], v[210:213], a[240:243], 0
 v_mfma_f32_16x16x32_bf16 v[230:233], v[210:213], v[68:71], 0
 ds_read_b128 v[210:213], v109 offset:4096
 s_waitcnt lgkmcnt(4)
 v_mfma_f32_16x16x32_bf16 v[226:229], v[214:217], a[244:247], v[226:229]
 v_mfma_f32_16x16x32_bf16 v[230:233], v[214:217], v[72:75], v[230:233]
 ds_read_b128 v[214:217], v110 offset:0
 s_waitcnt lgkmcnt(4)
 v_mfma_f32_16x16x32_bf16 v[226:229], v[218:221], a[248:251], v[226:229]
 v_mfma_f32_16x16x32_bf16 v[230:233], v[218:221], v[76:79], v[230:233]
 buffer_load_dword v126, v124, s[4:7], 0 offen sc1
 ds_read_b128 v[218:221], v110 offset:1024
 s_waitcnt lgkmcnt(3)
 v_mfma_f32_16x16x32_bf16 v[226:229], v[222:225], a[252:255], v[226:229]
 v_mfma_f32_16x16x32_bf16 v[230:233], v[222:225], v[80:83], v[230:233]
 ds_read_b128 v[222:225], v110 offset:2048
 s_waitcnt lgkmcnt(3)
 v_mfma_f32_16x16x32_bf16 v[226:229], v[210:213], v[4:7], v[226:229]
 v_mfma_f32_16x16x32_bf16 v[230:233], v[210:213], v[84:87], v[230:233]
 s_barrier
 ds_read_b128 v[234:237], v3 offset:26624
 ds_read_b128 v[238:241], v3 offset:27648
 ds_read_b128 v[210:213], v110 offset:3072
 s_waitcnt lgkmcnt(5)
 v_mfma_f32_16x16x32_bf16 v[226:229], v[214:217], v[8:11], v[226:229]
 v_mfma_f32_16x16x32_bf16 v[230:233], v[214:217], v[88:91], v[230:233]
 ds_read_b128 v[214:217], v110 offset:4096
 s_waitcnt lgkmcnt(5)
 v_mfma_f32_16x16x32_bf16 v[226:229], v[218:221], v[12:15], v[226:229]
 v_mfma_f32_16x16x32_bf16 v[230:233], v[218:221], v[92:95], v[230:233]
 ds_read_b128 v[218:221], v111 offset:0
 s_waitcnt lgkmcnt(5)
 v_mfma_f32_16x16x32_bf16 v[226:229], v[222:225], v[16:19], v[226:229]
 v_mfma_f32_16x16x32_bf16 v[230:233], v[222:225], v[96:99], v[230:233]
 ds_read_b128 v[222:225], v111 offset:1024
 s_waitcnt lgkmcnt(3)
 v_mfma_f32_16x16x32_bf16 v[226:229], v[210:213], v[20:23], v[226:229]
 v_mfma_f32_16x16x32_bf16 v[230:233], v[210:213], v[100:103], v[230:233]
 buffer_load_dwordx4 v[194:197], v2, s[4:7], s27 offen offset:0 sc1
 ds_read_b128 v[210:213], v111 offset:2048
 s_waitcnt lgkmcnt(3)
 v_mfma_f32_16x16x32_bf16 v[226:229], v[214:217], v[24:27], v[226:229]
 v_mfma_f32_16x16x32_bf16 v[230:233], v[214:217], v[104:107], v[230:233]
 ds_read_b128 v[214:217], v111 offset:3072
 s_waitcnt lgkmcnt(3)
 v_mfma_f32_16x16x32_bf16 v[226:229], v[218:221], v[28:31], v[226:229]
 ds_read_b128 v[218:221], v111 offset:4096
 s_waitcnt lgkmcnt(3)
 v_mfma_f32_16x16x32_bf16 v[226:229], v[222:225], v[32:35], v[226:229]
 buffer_load_dwordx4 v[198:201], v2, s[4:7], s27 offen offset:1024 sc1
 ds_read_b128 v[222:225], v112 offset:0
 s_waitcnt lgkmcnt(3)
 v_mfma_f32_16x16x32_bf16 v[226:229], v[210:213], v[36:39], v[226:229]
 ds_read_b128 v[210:213], v112 offset:1024
 s_waitcnt lgkmcnt(3)
 v_mfma_f32_16x16x32_bf16 v[226:229], v[214:217], v[40:43], v[226:229]
 ds_read_b128 v[214:217], v112 offset:2048
 s_waitcnt lgkmcnt(3)
 v_mfma_f32_16x16x32_bf16 v[226:229], v[218:221], v[44:47], v[226:229]
 buffer_load_dwordx4 v[202:205], v2, s[4:7], s27 offen offset:2048 sc1
 ds_read_b128 v[218:221], v112 offset:3072
 s_waitcnt lgkmcnt(3)
 v_mfma_f32_16x16x32_bf16 v[226:229], v[222:225], v[48:51], v[226:229]
 ds_read_b128 v[222:225], v112 offset:4096
 s_waitcnt lgkmcnt(3)
 v_mfma_f32_16x16x32_bf16 v[226:229], v[210:213], v[52:55], v[226:229]
 s_waitcnt lgkmcnt(2)
 v_mfma_f32_16x16x32_bf16 v[226:229], v[214:217], v[56:59], v[226:229]
 s_barrier
 ds_read_b128 v[206:209], v117 offset:28672
 s_waitcnt lgkmcnt(2)
 v_mfma_f32_16x16x32_bf16 v[226:229], v[218:221], v[60:63], v[226:229]
 s_waitcnt vmcnt(3)
 s_mov_b32 s41, 0
 v_min_i32 v1, 64, v125
 v_cmp_ge_i32 vcc, v126, v1
 s_nop 0
 s_cmp_eq_u64 vcc, -1
 s_cbranch_scc1 Lflok_219
Lfl_218:
 s_add_u32 s41, s41, 1
 s_cmp_gt_u32 s41, 200000
 s_cbranch_scc1 L_fail
 buffer_load_dword v126, v124, s[4:7], 0 offen sc1
 s_waitcnt vmcnt(0)
 v_cmp_ge_i32 vcc, v126, v1
 s_nop 0
 s_cmp_eq_u64 vcc, -1
 s_cbranch_scc0 Lfl_218
 buffer_load_dwordx4 v[194:197], v2, s[4:7], s27 offen offset:0 sc1
 buffer_load_dwordx4 v[198:201], v2, s[4:7], s27 offen offset:1024 sc1
 buffer_load_dwordx4 v[202:205], v2, s[4:7], s27 offen offset:2048 sc1
Lflok_219:
 v_add_u32 v125, 1, v125
 s_waitcnt lgkmcnt(1)
 v_mfma_f32_16x16x32_bf16 v[226:229], v[222:225], v[64:67], v[226:229]
 s_mov_b32 s41, 0
Lf_220:
 s_waitcnt vmcnt(2)
 v_add_f32 v210, v234, v194
 v_add_f32 v211, v235, v195
 v_add_f32 v212, v236, v196
 v_add_f32 v213, v237, v197
 s_waitcnt vmcnt(1)
 v_add_f32 v214, v238, v198
 v_add_f32 v215, v239, v199
 v_add_f32 v216, v240, v200
 v_add_f32 v217, v241, v201
 v_maximum3_f32 v1, v210, v211, v212
 v_maximum3_f32 v127, v213, v214, v215
 v_maximum3_f32 v1, v1, v216, v217
 s_waitcnt vmcnt(0)
 v_add_f32 v218, v190, v202
 v_add_f32 v219, v191, v203
 v_add_f32 v220, v192, v204
 v_add_f32 v221, v193, v205
 v_maximum3_f32 v127, v127, v218, v219
 v_maximum3_f32 v1, v1, v220, v221
 v_maximum3_f32 v1, v1, v127, v127
 v_cmp_u_f32 vcc, v1, v1
 v_mov_b32 v127, v1
 s_cbranch_vccnz Lfs_221
Lfok_222:
 s_nop 0
 v_permlane32_swap_b32 v1, v127
 v_max_f32 v1, v1, v127
 v_mov_b32 v127, v1
 v_cvt_pk_bf16_f32 v178, v226, v227
 v_cvt_pk_bf16_f32 v179, v228, v229
 v_permlane16_swap_b32 v1, v127
 v_max_f32 v1, v1, v127
 v_mul_f32 v1, s71, v1
 v_fma_f32 v210, v210, s71, -v1
 v_fma_f32 v211, v211, s71, -v1
 v_fma_f32 v212, v212, s71, -v1
 v_fma_f32 v213, v213, s71, -v1
 v_fma_f32 v214, v214, s71, -v1
 v_fma_f32 v215, v215, s71, -v1
 v_fma_f32 v216, v216, s71, -v1
 v_fma_f32 v217, v217, s71, -v1
 v_fma_f32 v218, v218, s71, -v1
 v_fma_f32 v219, v219, s71, -v1
 v_fma_f32 v220, v220, s71, -v1
 v_fma_f32 v221, v221, s71, -v1
 v_exp_f32 v210, v210
 v_exp_f32 v211, v211
 v_exp_f32 v212, v212
 v_exp_f32 v213, v213
 v_exp_f32 v214, v214
 v_exp_f32 v215, v215
 v_exp_f32 v216, v216
 v_exp_f32 v217, v217
 s_mov_b32 exec_lo, 0x00ff00ff
 s_mov_b32 exec_hi, 0x00ff00ff
 v_cvt_pk_bf16_f32 v162, v210, v211
 v_cvt_pk_bf16_f32 v163, v212, v213
 v_cvt_pk_bf16_f32 v164, v214, v215
 v_cvt_pk_bf16_f32 v165, v216, v217
 s_not_b64 exec, exec
 v_cvt_pk_bf16_f32 v166, v210, v211
 v_cvt_pk_bf16_f32 v167, v212, v213
 v_cvt_pk_bf16_f32 v168, v214, v215
 v_cvt_pk_bf16_f32 v169, v216, v217
 s_mov_b64 exec, -1
 v_mfma_f32_16x16x32_bf16 v[200:203], v[186:189], v[162:165], 0
 v_exp_f32 v218, v218
 v_exp_f32 v219, v219
 v_mfma_f32_16x16x32_bf16 v[192:195], v[142:145], v[162:165], 0
 v_exp_f32 v220, v220
 v_mfma_f32_16x16x32_bf16 v[196:199], v[146:149], v[162:165], 0
 v_exp_f32 v221, v221
 v_mfma_f32_16x16x32_bf16 v[200:203], v[186:189], v[166:169], v[200:203]
 v_cvt_pk_bf16_f32 v190, v218, v219
 v_cvt_pk_bf16_f32 v191, v220, v221
 s_waitcnt lgkmcnt(0)
 v_mfma_f32_16x16x32_bf16 v[192:195], v[150:153], v[166:169], v[192:195]
 v_add_f32 v230, v230, v206
 v_add_f32 v231, v231, v207
 v_add_f32 v232, v232, v208
 v_mfma_f32_16x16x32_bf16 v[196:199], v[154:157], v[166:169], v[196:199]
 v_add_f32 v233, v233, v209
 v_cvt_pk_bf16_f32 v180, v230, v231
 v_cvt_pk_bf16_f32 v181, v232, v233
 v_mfma_f32_16x16x16_bf16 v[200:203], v[186:187], v[190:191], v[200:203]
 s_add_u32 s25, s61, s55
 s_add_u32 s27, s61, s56
 v_mfma_f32_16x16x16_bf16 v[192:195], v[178:179], v[190:191], v[192:195]
 s_add_u32 s28, s27, 4096
 v_mfma_f32_16x16x16_bf16 v[196:199], v[180:181], v[190:191], v[196:199]
 s_mov_b32 s41, 0
 s_nop 0
 v_rcp_f32 v127, v200
 s_nop 1
 v_mul_f32 v192, v192, v127
 v_mul_f32 v193, v193, v127
 v_mul_f32 v194, v194, v127
 v_mul_f32 v195, v195, v127
 v_cvt_pk_bf16_f32 v204, v192, v193
 v_cvt_pk_bf16_f32 v205, v194, v195
 v_mul_f32 v196, v196, v127
 v_mul_f32 v197, v197, v127
 v_mul_f32 v198, v198, v127
 v_mul_f32 v199, v199, v127
 v_cvt_pk_bf16_f32 v206, v196, v197
 v_cvt_pk_bf16_f32 v207, v198, v199
 buffer_store_dwordx4 v[204:207], v2, s[4:7], s25 offen sc1
 ds_write_b64 v118, v[178:179] offset:512
 ds_write_b64 v118, v[180:181] offset:2560
 ds_read_b128 v[142:145], v115 offset:0
 ds_read_b128 v[146:149], v115 offset:1024
 ds_read_b128 v[150:153], v115 offset:2048
 ds_read_b128 v[154:157], v115 offset:3072
 ds_read_b128 v[234:237], v115 offset:4096
 ds_read_b128 v[238:241], v115 offset:5120
 ds_read_b128 v[242:245], v115 offset:6144
 ds_read_b128 v[246:249], v115 offset:7168
 ds_read_b128 v[250:253], v115 offset:8192
 s_sleep 2
 buffer_load_dwordx4 v[190:193], v2, s[4:7], s27 offen offset:0 sc1
 buffer_load_dwordx4 v[194:197], v2, s[4:7], s27 offen offset:1024 sc1
 buffer_load_dwordx4 v[198:201], v2, s[4:7], s27 offen offset:2048 sc1
 buffer_load_dwordx4 v[202:205], v2, s[4:7], s27 offen offset:3072 sc1
 buffer_load_dwordx4 v[206:209], v2, s[4:7], s28 offen offset:0 sc1
 buffer_load_dwordx4 v[210:213], v2, s[4:7], s28 offen offset:1024 sc1
 s_waitcnt lgkmcnt(0)
Lo_223:
 s_waitcnt vmcnt(5)
 v_max3_u32 v1, v190, v191, v192
 v_max_u32 v1, v1, v193
 v_cmp_eq_u32 vcc, -1, v1
 s_cbranch_vccnz Los_224
 v_mfma_f32_16x16x32_bf16 v[214:217], v[142:145], v[190:193], 0
 ds_read_b128 v[142:145], v115 offset:9216
 v_mfma_f32_16x16x32_bf16 v[218:221], v[146:149], v[190:193], 0
 ds_read_b128 v[146:149], v115 offset:10240
 s_waitcnt vmcnt(4)
 v_max3_u32 v1, v194, v195, v196
 v_mfma_f32_16x16x32_bf16 v[222:225], v[150:153], v[190:193], 0
 ds_read_b128 v[150:153], v115 offset:11264
 v_max_u32 v1, v1, v197
 v_mfma_f32_16x16x32_bf16 v[226:229], v[154:157], v[190:193], 0
 ds_read_b128 v[154:157], v115 offset:12288
 v_cmp_eq_u32 vcc, -1, v1
 v_mfma_f32_16x16x32_bf16 v[230:233], v[234:237], v[190:193], 0
 ds_read_b128 v[234:237], v115 offset:13312
Lo_225:
 s_cbranch_vccnz Los_226
 v_mfma_f32_16x16x32_bf16 v[214:217], v[238:241], v[194:197], v[214:217]
 ds_read_b128 v[238:241], v115 offset:14336
 v_mfma_f32_16x16x32_bf16 v[218:221], v[242:245], v[194:197], v[218:221]
 ds_read_b128 v[242:245], v116 offset:0
 s_waitcnt vmcnt(3)
 v_max3_u32 v1, v198, v199, v200
 v_mfma_f32_16x16x32_bf16 v[222:225], v[246:249], v[194:197], v[222:225]
 ds_read_b128 v[246:249], v116 offset:1024
 v_max_u32 v1, v1, v201
 v_mfma_f32_16x16x32_bf16 v[226:229], v[250:253], v[194:197], v[226:229]
 ds_read_b128 v[250:253], v116 offset:2048
 v_cmp_eq_u32 vcc, -1, v1
 s_waitcnt lgkmcnt(7)
 v_mfma_f32_16x16x32_bf16 v[230:233], v[142:145], v[194:197], v[230:233]
 ds_read_b128 v[142:145], v116 offset:3072
Lo_227:
 s_cbranch_vccnz Los_228
 v_mfma_f32_16x16x32_bf16 v[214:217], v[146:149], v[198:201], v[214:217]
 ds_read_b128 v[146:149], v116 offset:4096
 s_waitcnt lgkmcnt(7)
 v_mfma_f32_16x16x32_bf16 v[218:221], v[150:153], v[198:201], v[218:221]
 ds_read_b128 v[150:153], v116 offset:5120
 s_waitcnt vmcnt(2)
 v_max3_u32 v1, v202, v203, v204
 v_mfma_f32_16x16x32_bf16 v[222:225], v[154:157], v[198:201], v[222:225]
 ds_read_b128 v[154:157], v116 offset:6144
 v_max_u32 v1, v1, v205
 s_waitcnt lgkmcnt(7)
 v_mfma_f32_16x16x32_bf16 v[226:229], v[234:237], v[198:201], v[226:229]
 ds_read_b128 v[234:237], v116 offset:7168
 v_cmp_eq_u32 vcc, -1, v1
 v_mfma_f32_16x16x32_bf16 v[230:233], v[238:241], v[198:201], v[230:233]
 ds_read_b128 v[238:241], v116 offset:8192
Lo_229:
 s_cbranch_vccnz Los_230
 s_waitcnt lgkmcnt(7)
 v_mfma_f32_16x16x32_bf16 v[214:217], v[242:245], v[202:205], v[214:217]
 ds_read_b128 v[242:245], v116 offset:9216
 v_mfma_f32_16x16x32_bf16 v[218:221], v[246:249], v[202:205], v[218:221]
 ds_read_b128 v[246:249], v116 offset:10240
 s_waitcnt vmcnt(1)
 v_max3_u32 v1, v206, v207, v208
 s_waitcnt lgkmcnt(7)
 v_mfma_f32_16x16x32_bf16 v[222:225], v[250:253], v[202:205], v[222:225]
 ds_read_b128 v[250:253], v116 offset:11264
 v_max_u32 v1, v1, v209
 v_mfma_f32_16x16x32_bf16 v[226:229], v[142:145], v[202:205], v[226:229]
 ds_read_b128 v[142:145], v116 offset:12288
 v_cmp_eq_u32 vcc, -1, v1
 s_waitcnt lgkmcnt(7)
 v_mfma_f32_16x16x32_bf16 v[230:233], v[146:149], v[202:205], v[230:233]
 ds_read_b128 v[146:149], v116 offset:13312
Lo_231:
 s_cbranch_vccnz Los_232
 v_mfma_f32_16x16x32_bf16 v[214:217], v[150:153], v[206:209], v[214:217]
 ds_read_b128 v[150:153], v116 offset:14336
 s_waitcnt lgkmcnt(7)
 v_mfma_f32_16x16x32_bf16 v[218:221], v[154:157], v[206:209], v[218:221]
 s_waitcnt vmcnt(0)
 v_max3_u32 v1, v210, v211, v212
 v_mfma_f32_16x16x32_bf16 v[222:225], v[234:237], v[206:209], v[222:225]
 v_max_u32 v1, v1, v213
 s_waitcnt lgkmcnt(5)
 v_mfma_f32_16x16x32_bf16 v[226:229], v[238:241], v[206:209], v[226:229]
 v_cmp_eq_u32 vcc, -1, v1
 v_mfma_f32_16x16x32_bf16 v[230:233], v[242:245], v[206:209], v[230:233]
Lo_233:
 s_cbranch_vccnz Los_234
 s_waitcnt lgkmcnt(3)
 v_mfma_f32_16x16x32_bf16 v[214:217], v[246:249], v[210:213], v[214:217]
 buffer_load_dwordx4 v[130:133], v2, s[4:7], s67 offen sc1
 v_mfma_f32_16x16x32_bf16 v[218:221], v[250:253], v[210:213], v[218:221]
 buffer_load_dwordx4 v[134:137], v2, s[4:7], s67 offen offset:2048 sc1
 s_waitcnt lgkmcnt(1)
 v_mfma_f32_16x16x32_bf16 v[222:225], v[142:145], v[210:213], v[222:225]
 s_add_u32 s25, s67, 4096
 buffer_load_dwordx4 v[138:141], v2, s[4:7], s25 offen sc1
 v_mfma_f32_16x16x32_bf16 v[226:229], v[146:149], v[210:213], v[226:229]
 s_waitcnt lgkmcnt(0)
 v_mfma_f32_16x16x32_bf16 v[230:233], v[150:153], v[210:213], v[230:233]
 v_cvt_pk_bf16_f32 v190, v214, v215
 v_cvt_pk_bf16_f32 v191, v216, v217
 v_cvt_pk_bf16_f32 v192, v218, v219
 v_cvt_pk_bf16_f32 v193, v220, v221
 ds_write_b128 v119, v[190:193]
 v_cvt_pk_bf16_f32 v194, v222, v223
 v_cvt_pk_bf16_f32 v195, v224, v225
 v_cvt_pk_bf16_f32 v196, v226, v227
 v_cvt_pk_bf16_f32 v197, v228, v229
 ds_write_b128 v119, v[194:197] offset:4096
 v_cvt_pk_bf16_f32 v198, v230, v231
 v_cvt_pk_bf16_f32 v199, v232, v233
 ds_write_b64 v120, v[198:199] offset:8192
 s_add_u32 s25, s63, s46
 s_add_u32 s26, s63, s47
 s_add_u32 s27, s25, 655360
 s_add_u32 s28, s26, 655360
 s_waitcnt lgkmcnt(0)
 s_barrier
 ds_read_b128 v[190:193], v121 offset:0
 ds_read_b128 v[194:197], v121 offset:1024
 s_waitcnt lgkmcnt(1)
 v_mfma_f32_16x16x32_bf16 v[206:209], v[170:173], v[190:193], 0
 s_waitcnt lgkmcnt(0)
 v_mfma_f32_16x16x32_bf16 v[206:209], v[174:177], v[194:197], v[206:209]
 s_nop 7
 v_cvt_pk_bf16_f32 v214, v206, v207
 v_cvt_pk_bf16_f32 v215, v208, v209
 buffer_store_dwordx2 v[214:215], v122, s[4:7], s25 offen sc1
 buffer_store_dwordx2 v[214:215], v122, s[4:7], s27 offen sc1
 s_add_u32 s27, s63, s48
 s_add_u32 s28, s63, s49
 s_add_u32 s70, s31, 1
 s_and_b32 s25, s70, 3
 s_mul_i32 s26, s25, 20480
 s_add_u32 s57, s26, s42
 s_add_u32 s58, s57, 4096
 s_add_u32 s59, s26, s43
 s_mul_i32 s63, s25, 163840
 s_xor_b32 s26, s25, 2
 s_mul_i32 s64, s26, 163840
 s_add_u32 s25, s25, 3
 s_and_b32 s25, s25, 3
 s_mul_i32 s26, s25, 20480
 s_add_u32 s60, s26, s43
 s_and_b32 s25, s70, 1
 s_mul_i32 s61, s25, 196608
 s_xor_b32 s25, s25, 1
 s_mul_i32 s62, s25, 196608
 s_mul_i32 s70, s70, 196608
 s_sleep 6
 s_mov_b32 s41, 0
 buffer_load_dwordx4 v[190:193], v2, s[4:7], s27 offen sc1
 buffer_load_dwordx4 v[194:197], v2, s[4:7], s28 offen sc1
Lj_236:
 s_waitcnt vmcnt(1)
 v_mfma_f32_16x16x32_bf16 v[198:201], v[170:173], v[190:193], 0
 s_waitcnt vmcnt(0)
 v_mfma_f32_16x16x32_bf16 v[198:201], v[170:173], v[194:197], v[198:201]
 v_max3_u32 v202, v190, v191, v192
 v_max3_u32 v202, v202, v193, v194
 v_max3_u32 v202, v202, v195, v196
 v_max_u32 v202, v202, v197
 v_cmp_eq_u32 vcc, -1, v202
 s_cbranch_vccnz Ljs_237
 s_nop 1
 v_cvt_pk_bf16_f32 v202, v198, v199
 v_cvt_pk_bf16_f32 v203, v200, v201
 s_mov_b64 exec, 0xffffffff
 s_cmp_eq_u32 s31, 7
 s_cbranch_scc1 Lov_238
Lnov_239:
 buffer_store_dwordx2 v[202:203], v123, s[4:7], s59 offen sc1
 buffer_store_dwordx2 v[182:183], v123, s[4:7], s60 offen sc1
 s_mov_b64 exec, -1
Lnr_235:
 s_add_u32 s31, s31, 1
 s_cmp_lt_u32 s31, 72
 s_barrier
 s_cbranch_scc1 L_rec_top_1r
 s_waitcnt vmcnt(0)
 s_barrier
 s_endpgm
Lzs_209:
 buffer_load_dwordx4 v[190:193], v2, s[4:7], s57 offen offset:0 sc1
 buffer_load_dwordx4 v[194:197], v2, s[4:7], s57 offen offset:1024 sc1
 buffer_load_dwordx4 v[198:201], v2, s[4:7], s57 offen offset:2048 sc1
 buffer_load_dwordx4 v[202:205], v2, s[4:7], s57 offen offset:3072 sc1
 buffer_load_dwordx4 v[206:209], v2, s[4:7], s58 offen offset:0 sc1
 s_add_u32 s41, s41, 1
 s_cmp_gt_u32 s41, 200000
 s_cbranch_scc1 L_fail
 s_branch Lz_208
Lzs_211:
 buffer_load_dwordx4 v[194:197], v2, s[4:7], s57 offen offset:1024 sc1
 buffer_load_dwordx4 v[198:201], v2, s[4:7], s57 offen offset:2048 sc1
 buffer_load_dwordx4 v[202:205], v2, s[4:7], s57 offen offset:3072 sc1
 buffer_load_dwordx4 v[206:209], v2, s[4:7], s58 offen offset:0 sc1
 s_add_u32 s41, s41, 1
 s_cmp_gt_u32 s41, 200000
 s_cbranch_scc1 L_fail
 s_branch Lz_210
Lzs_213:
 buffer_load_dwordx4 v[198:201], v2, s[4:7], s57 offen offset:2048 sc1
 buffer_load_dwordx4 v[202:205], v2, s[4:7], s57 offen offset:3072 sc1
 buffer_load_dwordx4 v[206:209], v2, s[4:7], s58 offen offset:0 sc1
 s_add_u32 s41, s41, 1
 s_cmp_gt_u32 s41, 200000
 s_cbranch_scc1 L_fail
 s_branch Lz_212
Lzs_215:
 buffer_load_dwordx4 v[202:205], v2, s[4:7], s57 offen offset:3072 sc1
 buffer_load_dwordx4 v[206:209], v2, s[4:7], s58 offen offset:0 sc1
 s_add_u32 s41, s41, 1
 s_cmp_gt_u32 s41, 200000
 s_cbranch_scc1 L_fail
 s_branch Lz_214
Lzs_217:
 buffer_load_dwordx4 v[206:209], v2, s[4:7], s58 offen offset:0 sc1
 s_add_u32 s41, s41, 1
 s_cmp_gt_u32 s41, 200000
 s_cbranch_scc1 L_fail
 s_branch Lz_216
Lfs_221:
 v_max3_u32 v222, v194, v195, v196
 v_max3_u32 v222, v222, v197, v198
 v_max3_u32 v222, v222, v199, v200
 v_max3_u32 v222, v222, v201, v202
 v_max3_u32 v222, v222, v203, v204
 v_max_u32 v222, v222, v205
 v_cmp_eq_u32 vcc, -1, v222
 s_cbranch_vccz Lfok_222
 buffer_load_dwordx4 v[194:197], v2, s[4:7], s27 offen offset:0 sc1
 buffer_load_dwordx4 v[198:201], v2, s[4:7], s27 offen offset:1024 sc1
 buffer_load_dwordx4 v[202:205], v2, s[4:7], s27 offen offset:2048 sc1
 s_add_u32 s41, s41, 1
 s_cmp_gt_u32 s41, 200000
 s_cbranch_scc1 L_fail
 s_branch Lf_220
Los_224:
 buffer_load_dwordx4 v[190:193], v2, s[4:7], s27 offen offset:0 sc1
 buffer_load_dwordx4 v[194:197], v2, s[4:7], s27 offen offset:1024 sc1
 buffer_load_dwordx4 v[198:201], v2, s[4:7], s27 offen offset:2048 sc1
 buffer_load_dwordx4 v[202:205], v2, s[4:7], s27 offen offset:3072 sc1
 buffer_load_dwordx4 v[206:209], v2, s[4:7], s28 offen offset:0 sc1
 buffer_load_dwordx4 v[210:213], v2, s[4:7], s28 offen offset:1024 sc1
 s_add_u32 s41, s41, 1
 s_cmp_gt_u32 s41, 200000
 s_cbranch_scc1 L_fail
 s_branch Lo_223
Los_226:
 buffer_load_dwordx4 v[194:197], v2, s[4:7], s27 offen offset:1024 sc1
 buffer_load_dwordx4 v[198:201], v2, s[4:7], s27 offen offset:2048 sc1
 buffer_load_dwordx4 v[202:205], v2, s[4:7], s27 offen offset:3072 sc1
 buffer_load_dwordx4 v[206:209], v2, s[4:7], s28 offen offset:0 sc1
 buffer_load_dwordx4 v[210:213], v2, s[4:7], s28 offen offset:1024 sc1
 s_waitcnt vmcnt(4)
 v_max3_u32 v1, v194, v195, v196
 v_max_u32 v1, v1, v197
 v_cmp_eq_u32 vcc, -1, v1
 s_add_u32 s41, s41, 1
 s_cmp_gt_u32 s41, 200000
 s_cbranch_scc1 L_fail
 s_branch Lo_225
Los_228:
 buffer_load_dwordx4 v[198:201], v2, s[4:7], s27 offen offset:2048 sc1
 buffer_load_dwordx4 v[202:205], v2, s[4:7], s27 offen offset:3072 sc1
 buffer_load_dwordx4 v[206:209], v2, s[4:7], s28 offen offset:0 sc1
 buffer_load_dwordx4 v[210:213], v2, s[4:7], s28 offen offset:1024 sc1
 s_waitcnt vmcnt(3)
 v_max3_u32 v1, v198, v199, v200
 v_max_u32 v1, v1, v201
 v_cmp_eq_u32 vcc, -1, v1
 s_add_u32 s41, s41, 1
 s_cmp_gt_u32 s41, 200000
 s_cbranch_scc1 L_fail
 s_branch Lo_227
Los_230:
 buffer_load_dwordx4 v[202:205], v2, s[4:7], s27 offen offset:3072 sc1
 buffer_load_dwordx4 v[206:209], v2, s[4:7], s28 offen offset:0 sc1
 buffer_load_dwordx4 v[210:213], v2, s[4:7], s28 offen offset:1024 sc1
 s_waitcnt vmcnt(2)
 v_max3_u32 v1, v202, v203, v204
 v_max_u32 v1, v1, v205
 v_cmp_eq_u32 vcc, -1, v1
 s_add_u32 s41, s41, 1
 s_cmp_gt_u32 s41, 200000
 s_cbranch_scc1 L_fail
 s_branch Lo_229
Los_232:
 buffer_load_dwordx4 v[206:209], v2, s[4:7], s28 offen offset:0 sc1
 buffer_load_dwordx4 v[210:213], v2, s[4:7], s28 offen offset:1024 sc1
 s_waitcnt vmcnt(1)
 v_max3_u32 v1, v206, v207, v208
 v_max_u32 v1, v1, v209
 v_cmp_eq_u32 vcc, -1, v1
 s_add_u32 s41, s41, 1
 s_cmp_gt_u32 s41, 200000
 s_cbranch_scc1 L_fail
 s_branch Lo_231
Los_234:
 buffer_load_dwordx4 v[210:213], v2, s[4:7], s28 offen offset:1024 sc1
 s_waitcnt vmcnt(0)
 v_max3_u32 v1, v210, v211, v212
 v_max_u32 v1, v1, v213
 v_cmp_eq_u32 vcc, -1, v1
 s_add_u32 s41, s41, 1
 s_cmp_gt_u32 s41, 200000
 s_cbranch_scc1 L_fail
 s_branch Lo_233
Ljs_237:
 buffer_load_dwordx4 v[190:193], v2, s[4:7], s27 offen sc1
 buffer_load_dwordx4 v[194:197], v2, s[4:7], s28 offen sc1
 s_add_u32 s41, s41, 1
 s_cmp_gt_u32 s41, 200000
 s_cbranch_scc1 L_fail
 s_branch Lj_236
Lov_238:
 s_mov_b32 exec_lo, 0xff00ff00
 v_mov_b32 v202, v128
 v_mov_b32 v203, v129
 s_mov_b32 exec_lo, -1
 s_add_u32 s41, s41, 1
 s_cmp_gt_u32 s41, 200000
 s_cbranch_scc1 L_fail
 s_branch Lnov_239
Lpwn_206:
 s_cmp_eq_u32 s3, 2
 s_cbranch_scc0 Lpwn_241
 s_waitcnt vmcnt(0)
 s_cmp_eq_u32 s40, 0
 s_cbranch_scc1 Lz0_242
 s_mov_b64 exec, 0xffffffff
 buffer_store_dwordx2 v[128:129], v123, s[4:7], s43 offen sc1
 s_mov_b64 exec, -1
Lz0_242:
 s_barrier
L_rec_top_2r:
 s_sleep 2
 buffer_load_dwordx4 v[190:193], v2, s[4:7], s57 offen offset:0 sc1
 buffer_load_dwordx4 v[194:197], v2, s[4:7], s57 offen offset:1024 sc1
 buffer_load_dwordx4 v[198:201], v2, s[4:7], s57 offen offset:2048 sc1
 buffer_load_dwordx4 v[202:205], v2, s[4:7], s57 offen offset:3072 sc1
 buffer_load_dwordx4 v[206:209], v2, s[4:7], s58 offen offset:0 sc1
 s_mov_b32 s41, 0
Lz_243:
 s_waitcnt vmcnt(4)
 ds_write_b128 v109, v[190:193] offset:0
 v_mfma_f32_16x16x32_bf16 v[226:229], a[0:3], v[190:193], 0
 v_max3_u32 v1, v190, v191, v192
 v_max_u32 v1, v1, v193
 v_mfma_f32_16x16x32_bf16 v[230:233], a[80:83], v[190:193], 0
 v_cmp_eq_u32 vcc, -1, v1
 v_mfma_f32_16x16x32_bf16 v[234:237], a[160:163], v[190:193], 0
 s_cbranch_vccnz Lzs_244
Lz_245:
 s_waitcnt vmcnt(3)
 ds_write_b128 v109, v[194:197] offset:1024
 v_max3_u32 v1, v194, v195, v196
 v_max_u32 v1, v1, v197
 v_cmp_eq_u32 vcc, -1, v1
 s_cbranch_vccnz Lzs_246
 v_mfma_f32_16x16x32_bf16 v[226:229], a[4:7], v[194:197], v[226:229]
 v_mfma_f32_16x16x32_bf16 v[230:233], a[84:87], v[194:197], v[230:233]
 v_mfma_f32_16x16x32_bf16 v[234:237], a[164:167], v[194:197], v[234:237]
Lz_247:
 s_waitcnt vmcnt(2)
 ds_write_b128 v109, v[198:201] offset:2048
 v_max3_u32 v1, v198, v199, v200
 v_max_u32 v1, v1, v201
 v_cmp_eq_u32 vcc, -1, v1
 s_cbranch_vccnz Lzs_248
 v_mfma_f32_16x16x32_bf16 v[226:229], a[8:11], v[198:201], v[226:229]
 v_mfma_f32_16x16x32_bf16 v[230:233], a[88:91], v[198:201], v[230:233]
 v_mfma_f32_16x16x32_bf16 v[234:237], a[168:171], v[198:201], v[234:237]
Lz_249:
 s_waitcnt vmcnt(1)
 ds_write_b128 v109, v[202:205] offset:3072
 v_max3_u32 v1, v202, v203, v204
 v_max_u32 v1, v1, v205
 v_cmp_eq_u32 vcc, -1, v1
 s_cbranch_vccnz Lzs_250
Lz_251:
 s_waitcnt vmcnt(0)
 ds_write_b128 v109, v[206:209] offset:4096
 v_max3_u32 v1, v206, v207, v208
 v_max_u32 v1, v1, v209
 v_cmp_eq_u32 vcc, -1, v1
 s_cbranch_vccnz Lzs_252
 s_waitcnt lgkmcnt(0)
 s_barrier
 ds_read_b128 v[214:217], v110 offset:0
 ds_read_b128 v[218:221], v110 offset:1024
 ds_read_b128 v[222:225], v110 offset:2048
 v_mfma_f32_16x16x32_bf16 v[226:229], a[12:15], v[202:205], v[226:229]
 s_add_u32 s25, s68, s51
 v_mfma_f32_16x16x32_bf16 v[230:233], a[92:95], v[202:205], v[230:233]
 buffer_load_dwordx4 v[142:145], v2, s[4:7], s25 offen sc1
 v_mfma_f32_16x16x32_bf16 v[234:237], a[172:175], v[202:205], v[234:237]
 v_mfma_f32_16x16x32_bf16 v[226:229], a[16:19], v[206:209], v[226:229]
 s_add_u32 s25, s69, s51
 v_mfma_f32_16x16x32_bf16 v[230:233], a[96:99], v[206:209], v[230:233]
 buffer_load_dwordx4 v[150:153], v2, s[4:7], s25 offen sc1
 v_mfma_f32_16x16x32_bf16 v[234:237], a[176:179], v[206:209], v[234:237]
 ds_read_b128 v[210:213], v110 offset:3072
 s_waitcnt lgkmcnt(3)
 v_mfma_f32_16x16x32_bf16 v[226:229], a[20:23], v[214:217], v[226:229]
 s_add_u32 s25, s44, s62
 v_mfma_f32_16x16x32_bf16 v[230:233], a[100:103], v[214:217], v[230:233]
 buffer_store_dwordx4 v[182:185], v2, s[4:7], s25 offen offset:1024 sc1
 v_mfma_f32_16x16x32_bf16 v[234:237], a[180:183], v[214:217], v[234:237]
 ds_read_b128 v[214:217], v110 offset:4096
 s_waitcnt lgkmcnt(3)
 v_mfma_f32_16x16x32_bf16 v[226:229], a[24:27], v[218:221], v[226:229]
 s_add_u32 s25, s44, s62
 v_mfma_f32_16x16x32_bf16 v[230:233], a[104:107], v[218:221], v[230:233]
 s_add_u32 s25, s25, 1867776
 v_mfma_f32_16x16x32_bf16 v[234:237], a[184:187], v[218:221], v[234:237]
 buffer_store_dwordx4 v[182:185], v2, s[4:7], s25 offen offset:1024 sc1
 ds_read_b128 v[218:221], v111 offset:0
 s_waitcnt lgkmcnt(3)
 v_mfma_f32_16x16x32_bf16 v[226:229], a[28:31], v[222:225], v[226:229]
 s_add_u32 s25, s46, s64
 v_mfma_f32_16x16x32_bf16 v[230:233], a[108:111], v[222:225], v[230:233]
 buffer_store_dwordx2 v[182:183], v122, s[4:7], s25 offen sc1
 v_mfma_f32_16x16x32_bf16 v[234:237], a[188:191], v[222:225], v[234:237]
 ds_read_b128 v[222:225], v111 offset:1024
 s_waitcnt lgkmcnt(3)
 v_mfma_f32_16x16x32_bf16 v[226:229], a[32:35], v[210:213], v[226:229]
 s_add_u32 s25, s25, 655360
 v_mfma_f32_16x16x32_bf16 v[230:233], a[112:115], v[210:213], v[230:233]
 buffer_store_dwordx2 v[182:183], v122, s[4:7], s25 offen sc1
 v_mfma_f32_16x16x32_bf16 v[234:237], a[192:195], v[210:213], v[234:237]
 ds_read_b128 v[210:213], v111 offset:2048
 s_waitcnt lgkmcnt(3)
 v_mfma_f32_16x16x32_bf16 v[226:229], a[36:39], v[214:217], v[226:229]
 s_add_u32 s25, s31, 1
 s_mul_i32 s68, s25, 393216
 v_mfma_f32_16x16x32_bf16 v[230:233], a[116:119], v[214:217], v[230:233]
 s_add_u32 s68, s68, 84066304
 s_cmp_lt_u32 s25, 64
 v_mfma_f32_16x16x32_bf16 v[234:237], a[196:199], v[214:217], v[234:237]
 s_cselect_b32 s68, s68, 2146435072
 ds_read_b128 v[214:217], v111 offset:3072
 s_waitcnt lgkmcnt(3)
 v_mfma_f32_16x16x32_bf16 v[226:229], a[40:43], v[218:221], v[226:229]
 s_sub_u32 s26, s25, 8
 s_mul_i32 s69, s26, 393216
 v_mfma_f32_16x16x32_bf16 v[230:233], a[120:123], v[218:221], v[230:233]
 s_add_u32 s69, s69, 134397952
 s_cmp_lt_u32 s26, 64
 v_mfma_f32_16x16x32_bf16 v[234:237], a[200:203], v[218:221], v[234:237]
 s_cselect_b32 s69, s69, 2146435072
 ds_read_b128 v[218:221], v111 offset:4096
 s_waitcnt lgkmcnt(3)
 v_mfma_f32_16x16x32_bf16 v[226:229], a[44:47], v[222:225], v[226:229]
 s_add_u32 s25, s68, 4269801472
 s_add_u32 s26, s69, 4269801472
 v_mfma_f32_16x16x32_bf16 v[230:233], a[124:127], v[222:225], v[230:233]
 s_cmp_lt_u32 s3, 2
 s_cselect_b32 s67, s25, s26
 v_mfma_f32_16x16x32_bf16 v[234:237], a[204:207], v[222:225], v[234:237]
 s_add_u32 s67, s67, s50
 ds_read_b128 v[222:225], v112 offset:0
 s_waitcnt lgkmcnt(3)
 v_mfma_f32_16x16x32_bf16 v[226:229], a[48:51], v[210:213], v[226:229]
 v_mfma_f32_16x16x32_bf16 v[230:233], a[128:131], v[210:213], v[230:233]
 v_mfma_f32_16x16x32_bf16 v[234:237], a[208:211], v[210:213], v[234:237]
 ds_read_b128 v[210:213], v112 offset:1024
 s_waitcnt lgkmcnt(3)
 v_mfma_f32_16x16x32_bf16 v[226:229], a[52:55], v[214:217], v[226:229]
 v_mfma_f32_16x16x32_bf16 v[230:233], a[132:135], v[214:217], v[230:233]
 v_mfma_f32_16x16x32_bf16 v[234:237], a[212:215], v[214:217], v[234:237]
 ds_read_b128 v[214:217], v112 offset:2048
 s_waitcnt lgkmcnt(3)
 v_mfma_f32_16x16x32_bf16 v[226:229], a[56:59], v[218:221], v[226:229]
 v_mfma_f32_16x16x32_bf16 v[230:233], a[136:139], v[218:221], v[230:233]
 v_mfma_f32_16x16x32_bf16 v[234:237], a[216:219], v[218:221], v[234:237]
 ds_read_b128 v[218:221], v112 offset:3072
 s_waitcnt lgkmcnt(3)
 v_mfma_f32_16x16x32_bf16 v[226:229], a[60:63], v[222:225], v[226:229]
 v_mfma_f32_16x16x32_bf16 v[230:233], a[140:143], v[222:225], v[230:233]
 v_mfma_f32_16x16x32_bf16 v[234:237], a[220:223], v[222:225], v[234:237]
 ds_read_b128 v[222:225], v112 offset:4096
 s_waitcnt lgkmcnt(3)
 v_mfma_f32_16x16x32_bf16 v[226:229], a[64:67], v[210:213], v[226:229]
 v_mfma_f32_16x16x32_bf16 v[230:233], a[144:147], v[210:213], v[230:233]
 v_mfma_f32_16x16x32_bf16 v[234:237], a[224:227], v[210:213], v[234:237]
 s_waitcnt lgkmcnt(2)
 v_mfma_f32_16x16x32_bf16 v[226:229], a[68:71], v[214:217], v[226:229]
 v_mfma_f32_16x16x32_bf16 v[230:233], a[148:151], v[214:217], v[230:233]
 v_mfma_f32_16x16x32_bf16 v[234:237], a[228:231], v[214:217], v[234:237]
 s_waitcnt lgkmcnt(1)
 v_mfma_f32_16x16x32_bf16 v[226:229], a[72:75], v[218:221], v[226:229]
 v_mfma_f32_16x16x32_bf16 v[230:233], a[152:155], v[218:221], v[230:233]
 v_mfma_f32_16x16x32_bf16 v[234:237], a[232:235], v[218:221], v[234:237]
 s_waitcnt lgkmcnt(0)
 v_mfma_f32_16x16x32_bf16 v[226:229], a[76:79], v[222:225], v[226:229]
 v_mfma_f32_16x16x32_bf16 v[230:233], a[156:159], v[222:225], v[230:233]
 v_mfma_f32_16x16x32_bf16 v[234:237], a[236:239], v[222:225], v[234:237]
 s_nop 1
 v_cvt_pk_bf16_f32 v190, v226, v227
 v_cvt_pk_bf16_f32 v191, v228, v229
 ds_write_b64 v113, v[190:191] offset:0
 v_cvt_pk_bf16_f32 v192, v230, v231
 v_cvt_pk_bf16_f32 v193, v232, v233
 ds_write_b64 v114, v[192:193] offset:0
 v_cvt_pk_bf16_f32 v194, v234, v235
 v_cvt_pk_bf16_f32 v195, v236, v237
 ds_write_b64 v113, v[194:195] offset:1024
 s_add_u32 s26, s61, s44
 s_add_u32 s27, s61, s45
 s_waitcnt lgkmcnt(0)
 s_barrier
 ds_read_b128 v[198:201], v3 offset:20480
 ds_read_b128 v[202:205], v3 offset:21504
 ds_read_b128 v[206:209], v3 offset:22528
 ds_read_b128 v[226:229], v3 offset:23552
 ds_read_b128 v[230:233], v3 offset:24576
 ds_read_b128 v[234:237], v3 offset:25600
 ds_read_b128 v[210:213], v109 offset:0
 ds_read_b128 v[214:217], v109 offset:1024
 ds_read_b128 v[218:221], v109 offset:2048
 s_waitcnt lgkmcnt(8)
 v_mfma_f32_16x16x32_bf16 v[194:197], v[130:133], v[198:201], 0
 s_waitcnt lgkmcnt(7)
 v_mfma_f32_16x16x32_bf16 v[194:197], v[134:137], v[202:205], v[194:197]
 s_waitcnt lgkmcnt(6)
 v_mfma_f32_16x16x32_bf16 v[194:197], v[138:141], v[206:209], v[194:197]
 s_waitcnt lgkmcnt(5)
 v_mfma_f32_16x16x32_bf16 v[190:193], v[226:229], v[198:201], v[158:161]
 s_waitcnt lgkmcnt(4)
 v_mfma_f32_16x16x32_bf16 v[190:193], v[230:233], v[202:205], v[190:193]
 s_mov_b32 exec_lo, 0xff00ff00
 s_mov_b32 exec_hi, 0xff00ff00
 s_waitcnt lgkmcnt(3)
 v_mfma_f32_16x16x32_bf16 v[190:193], v[234:237], v[206:209], v[190:193]
 buffer_store_dwordx4 v[194:197], v2, s[4:7], s26 offen offset:0 sc1
 ds_write_b128 v117, v[194:197] offset:26624
 s_mov_b64 exec, -1
 ds_read_b128 v[222:225], v109 offset:3072
 s_waitcnt lgkmcnt(4)
 v_mfma_f32_16x16x32_bf16 v[226:229], v[210:213], a[240:243], 0
 v_mfma_f32_16x16x32_bf16 v[230:233], v[210:213], v[68:71], 0
 ds_read_b128 v[210:213], v109 offset:4096
 s_waitcnt lgkmcnt(4)
 v_mfma_f32_16x16x32_bf16 v[226:229], v[214:217], a[244:247], v[226:229]
 v_mfma_f32_16x16x32_bf16 v[230:233], v[214:217], v[72:75], v[230:233]
 ds_read_b128 v[214:217], v110 offset:0
 s_waitcnt lgkmcnt(4)
 v_mfma_f32_16x16x32_bf16 v[226:229], v[218:221], a[248:251], v[226:229]
 v_mfma_f32_16x16x32_bf16 v[230:233], v[218:221], v[76:79], v[230:233]
 buffer_load_dword v126, v124, s[4:7], 0 offen sc1
 ds_read_b128 v[218:221], v110 offset:1024
 s_waitcnt lgkmcnt(3)
 v_mfma_f32_16x16x32_bf16 v[226:229], v[222:225], a[252:255], v[226:229]
 v_mfma_f32_16x16x32_bf16 v[230:233], v[222:225], v[80:83], v[230:233]
 ds_read_b128 v[222:225], v110 offset:2048
 s_waitcnt lgkmcnt(3)
 v_mfma_f32_16x16x32_bf16 v[226:229], v[210:213], v[4:7], v[226:229]
 v_mfma_f32_16x16x32_bf16 v[230:233], v[210:213], v[84:87], v[230:233]
 s_barrier
 ds_read_b128 v[234:237], v3 offset:26624
 ds_read_b128 v[238:241], v3 offset:27648
 ds_read_b128 v[210:213], v110 offset:3072
 s_waitcnt lgkmcnt(5)
 v_mfma_f32_16x16x32_bf16 v[226:229], v[214:217], v[8:11], v[226:229]
 v_mfma_f32_16x16x32_bf16 v[230:233], v[214:217], v[88:91], v[230:233]
 ds_read_b128 v[214:217], v110 offset:4096
 s_waitcnt lgkmcnt(5)
 v_mfma_f32_16x16x32_bf16 v[226:229], v[218:221], v[12:15], v[226:229]
 v_mfma_f32_16x16x32_bf16 v[230:233], v[218:221], v[92:95], v[230:233]
 ds_read_b128 v[218:221], v111 offset:0
 s_waitcnt lgkmcnt(5)
 v_mfma_f32_16x16x32_bf16 v[226:229], v[222:225], v[16:19], v[226:229]
 v_mfma_f32_16x16x32_bf16 v[230:233], v[222:225], v[96:99], v[230:233]
 ds_read_b128 v[222:225], v111 offset:1024
 s_waitcnt lgkmcnt(3)
 v_mfma_f32_16x16x32_bf16 v[226:229], v[210:213], v[20:23], v[226:229]
 v_mfma_f32_16x16x32_bf16 v[230:233], v[210:213], v[100:103], v[230:233]
 buffer_load_dwordx4 v[194:197], v2, s[4:7], s27 offen offset:0 sc1
 ds_read_b128 v[210:213], v111 offset:2048
 s_waitcnt lgkmcnt(3)
 v_mfma_f32_16x16x32_bf16 v[226:229], v[214:217], v[24:27], v[226:229]
 v_mfma_f32_16x16x32_bf16 v[230:233], v[214:217], v[104:107], v[230:233]
 ds_read_b128 v[214:217], v111 offset:3072
 s_waitcnt lgkmcnt(3)
 v_mfma_f32_16x16x32_bf16 v[226:229], v[218:221], v[28:31], v[226:229]
 ds_read_b128 v[218:221], v111 offset:4096
 s_waitcnt lgkmcnt(3)
 v_mfma_f32_16x16x32_bf16 v[226:229], v[222:225], v[32:35], v[226:229]
 buffer_load_dwordx4 v[198:201], v2, s[4:7], s27 offen offset:1024 sc1
 ds_read_b128 v[222:225], v112 offset:0
 s_waitcnt lgkmcnt(3)
 v_mfma_f32_16x16x32_bf16 v[226:229], v[210:213], v[36:39], v[226:229]
 ds_write_b128 v117, v[230:233] offset:28672
 ds_read_b128 v[210:213], v112 offset:1024
 s_waitcnt lgkmcnt(4)
 v_mfma_f32_16x16x32_bf16 v[226:229], v[214:217], v[40:43], v[226:229]
 ds_read_b128 v[214:217], v112 offset:2048
 s_waitcnt lgkmcnt(4)
 v_mfma_f32_16x16x32_bf16 v[226:229], v[218:221], v[44:47], v[226:229]
 buffer_load_dwordx4 v[202:205], v2, s[4:7], s27 offen offset:2048 sc1
 ds_read_b128 v[218:221], v112 offset:3072
 s_waitcnt lgkmcnt(4)
 v_mfma_f32_16x16x32_bf16 v[226:229], v[222:225], v[48:51], v[226:229]
 ds_read_b128 v[222:225], v112 offset:4096
 s_waitcnt lgkmcnt(3)
 v_mfma_f32_16x16x32_bf16 v[226:229], v[210:213], v[52:55], v[226:229]
 s_waitcnt lgkmcnt(2)
 v_mfma_f32_16x16x32_bf16 v[226:229], v[214:217], v[56:59], v[226:229]
 s_barrier
 s_waitcnt lgkmcnt(1)
 v_mfma_f32_16x16x32_bf16 v[226:229], v[218:221], v[60:63], v[226:229]
 s_waitcnt vmcnt(3)
 s_mov_b32 s41, 0
 v_min_i32 v1, 64, v125
 v_cmp_ge_i32 vcc, v126, v1
 s_nop 0
 s_cmp_eq_u64 vcc, -1
 s_cbranch_scc1 Lflok_254
Lfl_253:
 s_add_u32 s41, s41, 1
 s_cmp_gt_u32 s41, 200000
 s_cbranch_scc1 L_fail
 buffer_load_dword v126, v124, s[4:7], 0 offen sc1
 s_waitcnt vmcnt(0)
 v_cmp_ge_i32 vcc, v126, v1
 s_nop 0
 s_cmp_eq_u64 vcc, -1
 s_cbranch_scc0 Lfl_253
 buffer_load_dwordx4 v[194:197], v2, s[4:7], s27 offen offset:0 sc1
 buffer_load_dwordx4 v[198:201], v2, s[4:7], s27 offen offset:1024 sc1
 buffer_load_dwordx4 v[202:205], v2, s[4:7], s27 offen offset:2048 sc1
Lflok_254:
 v_add_u32 v125, 1, v125
 s_waitcnt lgkmcnt(0)
 v_mfma_f32_16x16x32_bf16 v[226:229], v[222:225], v[64:67], v[226:229]
 s_mov_b32 s41, 0
Lf_255:
 s_waitcnt vmcnt(2)
 v_add_f32 v210, v234, v194
 v_add_f32 v211, v235, v195
 v_add_f32 v212, v236, v196
 v_add_f32 v213, v237, v197
 s_waitcnt vmcnt(1)
 v_add_f32 v214, v238, v198
 v_add_f32 v215, v239, v199
 v_add_f32 v216, v240, v200
 v_add_f32 v217, v241, v201
 v_maximum3_f32 v1, v210, v211, v212
 v_maximum3_f32 v127, v213, v214, v215
 v_maximum3_f32 v1, v1, v216, v217
 s_waitcnt vmcnt(0)
 v_add_f32 v218, v190, v202
 v_add_f32 v219, v191, v203
 v_add_f32 v220, v192, v204
 v_add_f32 v221, v193, v205
 v_maximum3_f32 v127, v127, v218, v219
 v_maximum3_f32 v1, v1, v220, v221
 v_maximum3_f32 v1, v1, v127, v127
 v_cmp_u_f32 vcc, v1, v1
 v_mov_b32 v127, v1
 s_cbranch_vccnz Lfs_256
Lfok_257:
 s_nop 0
 v_permlane32_swap_b32 v1, v127
 v_max_f32 v1, v1, v127
 v_mov_b32 v127, v1
 v_cvt_pk_bf16_f32 v178, v226, v227
 v_cvt_pk_bf16_f32 v179, v228, v229
 v_permlane16_swap_b32 v1, v127
 v_max_f32 v1, v1, v127
 v_mul_f32 v1, s71, v1
 v_fma_f32 v210, v210, s71, -v1
 v_fma_f32 v211, v211, s71, -v1
 v_fma_f32 v212, v212, s71, -v1
 v_fma_f32 v213, v213, s71, -v1
 v_fma_f32 v214, v214, s71, -v1
 v_fma_f32 v215, v215, s71, -v1
 v_fma_f32 v216, v216, s71, -v1
 v_fma_f32 v217, v217, s71, -v1
 v_fma_f32 v218, v218, s71, -v1
 v_fma_f32 v219, v219, s71, -v1
 v_fma_f32 v220, v220, s71, -v1
 v_fma_f32 v221, v221, s71, -v1
 v_exp_f32 v210, v210
 v_exp_f32 v211, v211
 v_exp_f32 v212, v212
 v_exp_f32 v213, v213
 v_exp_f32 v214, v214
 v_exp_f32 v215, v215
 v_exp_f32 v216, v216
 v_exp_f32 v217, v217
 s_mov_b32 exec_lo, 0x00ff00ff
 s_mov_b32 exec_hi, 0x00ff00ff
 v_cvt_pk_bf16_f32 v162, v210, v211
 v_cvt_pk_bf16_f32 v163, v212, v213
 v_cvt_pk_bf16_f32 v164, v214, v215
 v_cvt_pk_bf16_f32 v165, v216, v217
 s_not_b64 exec, exec
 v_cvt_pk_bf16_f32 v166, v210, v211
 v_cvt_pk_bf16_f32 v167, v212, v213
 v_cvt_pk_bf16_f32 v168, v214, v215
 v_cvt_pk_bf16_f32 v169, v216, v217
 s_mov_b64 exec, -1
 v_mfma_f32_16x16x32_bf16 v[200:203], v[186:189], v[162:165], 0
 v_exp_f32 v218, v218
 v_exp_f32 v219, v219
 v_mfma_f32_16x16x32_bf16 v[192:195], v[142:145], v[162:165], 0
 v_exp_f32 v220, v220
 v_exp_f32 v221, v221
 v_mfma_f32_16x16x32_bf16 v[200:203], v[186:189], v[166:169], v[200:203]
 v_cvt_pk_bf16_f32 v190, v218, v219
 v_mfma_f32_16x16x32_bf16 v[192:195], v[150:153], v[166:169], v[192:195]
 v_cvt_pk_bf16_f32 v191, v220, v221
 s_nop 1
 v_mfma_f32_16x16x16_bf16 v[200:203], v[186:187], v[190:191], v[200:203]
 s_add_u32 s25, s61, s55
 s_add_u32 s27, s61, s56
 v_mfma_f32_16x16x16_bf16 v[192:195], v[178:179], v[190:191], v[192:195]
 s_add_u32 s28, s27, 4096
 s_mov_b32 s41, 0
 s_nop 2
 v_rcp_f32 v127, v200
 s_nop 1
 v_mul_f32 v192, v192, v127
 v_mul_f32 v193, v193, v127
 v_mul_f32 v194, v194, v127
 v_mul_f32 v195, v195, v127
 v_cvt_pk_bf16_f32 v204, v192, v193
 v_cvt_pk_bf16_f32 v205, v194, v195
 buffer_store_dwordx2 v[204:205], v2, s[4:7], s25 offen sc1
 ds_write_b64 v118, v[178:179] offset:1024
 ds_read_b128 v[142:145], v115 offset:0
 ds_read_b128 v[146:149], v115 offset:1024
 ds_read_b128 v[150:153], v115 offset:2048
 ds_read_b128 v[154:157], v115 offset:3072
 ds_read_b128 v[234:237], v115 offset:4096
 ds_read_b128 v[238:241], v115 offset:5120
 ds_read_b128 v[242:245], v115 offset:6144
 ds_read_b128 v[246:249], v115 offset:7168
 ds_read_b128 v[250:253], v115 offset:8192
 s_sleep 2
 buffer_load_dwordx4 v[190:193], v2, s[4:7], s27 offen offset:0 sc1
 buffer_load_dwordx4 v[194:197], v2, s[4:7], s27 offen offset:1024 sc1
 buffer_load_dwordx4 v[198:201], v2, s[4:7], s27 offen offset:2048 sc1
 buffer_load_dwordx4 v[202:205], v2, s[4:7], s27 offen offset:3072 sc1
 buffer_load_dwordx4 v[206:209], v2, s[4:7], s28 offen offset:0 sc1
 buffer_load_dwordx4 v[210:213], v2, s[4:7], s28 offen offset:1024 sc1
 s_waitcnt lgkmcnt(0)
Lo_258:
 s_waitcnt vmcnt(5)
 v_max3_u32 v1, v190, v191, v192
 v_max_u32 v1, v1, v193
 v_cmp_eq_u32 vcc, -1, v1
 s_cbranch_vccnz Los_259
 v_mfma_f32_16x16x32_bf16 v[214:217], v[142:145], v[190:193], 0
 ds_read_b128 v[142:145], v115 offset:9216
 v_mfma_f32_16x16x32_bf16 v[218:221], v[146:149], v[190:193], 0
 ds_read_b128 v[146:149], v115 offset:10240
 s_waitcnt vmcnt(4)
 v_max3_u32 v1, v194, v195, v196
 v_mfma_f32_16x16x32_bf16 v[222:225], v[150:153], v[190:193], 0
 ds_read_b128 v[150:153], v115 offset:11264
 v_max_u32 v1, v1, v197
 v_mfma_f32_16x16x32_bf16 v[226:229], v[154:157], v[190:193], 0
 ds_read_b128 v[154:157], v115 offset:12288
 v_cmp_eq_u32 vcc, -1, v1
 v_mfma_f32_16x16x32_bf16 v[230:233], v[234:237], v[190:193], 0
 ds_read_b128 v[234:237], v115 offset:13312
Lo_260:
 s_cbranch_vccnz Los_261
 v_mfma_f32_16x16x32_bf16 v[214:217], v[238:241], v[194:197], v[214:217]
 ds_read_b128 v[238:241], v115 offset:14336
 v_mfma_f32_16x16x32_bf16 v[218:221], v[242:245], v[194:197], v[218:221]
 ds_read_b128 v[242:245], v116 offset:0
 s_waitcnt vmcnt(3)
 v_max3_u32 v1, v198, v199, v200
 v_mfma_f32_16x16x32_bf16 v[222:225], v[246:249], v[194:197], v[222:225]
 ds_read_b128 v[246:249], v116 offset:1024
 v_max_u32 v1, v1, v201
 v_mfma_f32_16x16x32_bf16 v[226:229], v[250:253], v[194:197], v[226:229]
 ds_read_b128 v[250:253], v116 offset:2048
 v_cmp_eq_u32 vcc, -1, v1
 s_waitcnt lgkmcnt(7)
 v_mfma_f32_16x16x32_bf16 v[230:233], v[142:145], v[194:197], v[230:233]
 ds_read_b128 v[142:145], v116 offset:3072
Lo_262:
 s_cbranch_vccnz Los_263
 v_mfma_f32_16x16x32_bf16 v[214:217], v[146:149], v[198:201], v[214:217]
 ds_read_b128 v[146:149], v116 offset:4096
 s_waitcnt lgkmcnt(7)
 v_mfma_f32_16x16x32_bf16 v[218:221], v[150:153], v[198:201], v[218:221]
 ds_read_b128 v[150:153], v116 offset:5120
 s_waitcnt vmcnt(2)
 v_max3_u32 v1, v202, v203, v204
 v_mfma_f32_16x16x32_bf16 v[222:225], v[154:157], v[198:201], v[222:225]
 ds_read_b128 v[154:157], v116 offset:6144
 v_max_u32 v1, v1, v205
 s_waitcnt lgkmcnt(7)
 v_mfma_f32_16x16x32_bf16 v[226:229], v[234:237], v[198:201], v[226:229]
 ds_read_b128 v[234:237], v116 offset:7168
 v_cmp_eq_u32 vcc, -1, v1
 v_mfma_f32_16x16x32_bf16 v[230:233], v[238:241], v[198:201], v[230:233]
 ds_read_b128 v[238:241], v116 offset:8192
Lo_264:
 s_cbranch_vccnz Los_265
 s_waitcnt lgkmcnt(7)
 v_mfma_f32_16x16x32_bf16 v[214:217], v[242:245], v[202:205], v[214:217]
 ds_read_b128 v[242:245], v116 offset:9216
 v_mfma_f32_16x16x32_bf16 v[218:221], v[246:249], v[202:205], v[218:221]
 ds_read_b128 v[246:249], v116 offset:10240
 s_waitcnt vmcnt(1)
 v_max3_u32 v1, v206, v207, v208
 s_waitcnt lgkmcnt(7)
 v_mfma_f32_16x16x32_bf16 v[222:225], v[250:253], v[202:205], v[222:225]
 ds_read_b128 v[250:253], v116 offset:11264
 v_max_u32 v1, v1, v209
 v_mfma_f32_16x16x32_bf16 v[226:229], v[142:145], v[202:205], v[226:229]
 ds_read_b128 v[142:145], v116 offset:12288
 v_cmp_eq_u32 vcc, -1, v1
 s_waitcnt lgkmcnt(7)
 v_mfma_f32_16x16x32_bf16 v[230:233], v[146:149], v[202:205], v[230:233]
 ds_read_b128 v[146:149], v116 offset:13312
Lo_266:
 s_cbranch_vccnz Los_267
 v_mfma_f32_16x16x32_bf16 v[214:217], v[150:153], v[206:209], v[214:217]
 ds_read_b128 v[150:153], v116 offset:14336
 s_waitcnt lgkmcnt(7)
 v_mfma_f32_16x16x32_bf16 v[218:221], v[154:157], v[206:209], v[218:221]
 s_waitcnt vmcnt(0)
 v_max3_u32 v1, v210, v211, v212
 v_mfma_f32_16x16x32_bf16 v[222:225], v[234:237], v[206:209], v[222:225]
 v_max_u32 v1, v1, v213
 s_waitcnt lgkmcnt(5)
 v_mfma_f32_16x16x32_bf16 v[226:229], v[238:241], v[206:209], v[226:229]
 v_cmp_eq_u32 vcc, -1, v1
 v_mfma_f32_16x16x32_bf16 v[230:233], v[242:245], v[206:209], v[230:233]
Lo_268:
 s_cbranch_vccnz Los_269
 s_waitcnt lgkmcnt(3)
 v_mfma_f32_16x16x32_bf16 v[214:217], v[246:249], v[210:213], v[214:217]
 buffer_load_dwordx4 v[130:133], v2, s[4:7], s67 offen sc1
 v_mfma_f32_16x16x32_bf16 v[218:221], v[250:253], v[210:213], v[218:221]
 buffer_load_dwordx4 v[134:137], v2, s[4:7], s67 offen offset:2048 sc1
 s_waitcnt lgkmcnt(1)
 v_mfma_f32_16x16x32_bf16 v[222:225], v[142:145], v[210:213], v[222:225]
 s_add_u32 s25, s67, 4096
 buffer_load_dwordx4 v[138:141], v2, s[4:7], s25 offen sc1
 v_mfma_f32_16x16x32_bf16 v[226:229], v[146:149], v[210:213], v[226:229]
 s_waitcnt lgkmcnt(0)
 v_mfma_f32_16x16x32_bf16 v[230:233], v[150:153], v[210:213], v[230:233]
 v_cvt_pk_bf16_f32 v190, v214, v215
 v_cvt_pk_bf16_f32 v191, v216, v217
 v_cvt_pk_bf16_f32 v192, v218, v219
 v_cvt_pk_bf16_f32 v193, v220, v221
 ds_write_b128 v119, v[190:193]
 v_cvt_pk_bf16_f32 v194, v222, v223
 v_cvt_pk_bf16_f32 v195, v224, v225
 v_cvt_pk_bf16_f32 v196, v226, v227
 v_cvt_pk_bf16_f32 v197, v228, v229
 ds_write_b128 v119, v[194:197] offset:4096
 v_cvt_pk_bf16_f32 v198, v230, v231
 v_cvt_pk_bf16_f32 v199, v232, v233
 ds_write_b64 v120, v[198:199] offset:8192
 s_add_u32 s25, s63, s46
 s_add_u32 s26, s63, s47
 s_add_u32 s27, s25, 655360
 s_add_u32 s28, s26, 655360
 s_waitcnt lgkmcnt(0)
 s_barrier
 ds_read_b128 v[190:193], v121 offset:0
 ds_read_b128 v[194:197], v121 offset:1024
 s_waitcnt lgkmcnt(1)
 v_mfma_f32_16x16x32_bf16 v[206:209], v[170:173], v[190:193], 0
 s_waitcnt lgkmcnt(0)
 v_mfma_f32_16x16x32_bf16 v[206:209], v[174:177], v[194:197], v[206:209]
 s_nop 7
 v_cvt_pk_bf16_f32 v214, v206, v207
 v_cvt_pk_bf16_f32 v215, v208, v209
 buffer_store_dwordx2 v[214:215], v122, s[4:7], s25 offen sc1
 buffer_store_dwordx2 v[214:215], v122, s[4:7], s27 offen sc1
 s_add_u32 s27, s63, s48
 s_add_u32 s28, s63, s49
 s_add_u32 s70, s31, 1
 s_and_b32 s25, s70, 3
 s_mul_i32 s26, s25, 20480
 s_add_u32 s57, s26, s42
 s_add_u32 s58, s57, 4096
 s_add_u32 s59, s26, s43
 s_mul_i32 s63, s25, 163840
 s_xor_b32 s26, s25, 2
 s_mul_i32 s64, s26, 163840
 s_add_u32 s25, s25, 3
 s_and_b32 s25, s25, 3
 s_mul_i32 s26, s25, 20480
 s_add_u32 s60, s26, s43
 s_and_b32 s25, s70, 1
 s_mul_i32 s61, s25, 196608
 s_xor_b32 s25, s25, 1
 s_mul_i32 s62, s25, 196608
 s_mul_i32 s70, s70, 196608
 s_cmp_eq_u32 s40, 0
 s_cbranch_scc1 Lnr_270
 s_sleep 6
 s_mov_b32 s41, 0
 buffer_load_dwordx4 v[190:193], v2, s[4:7], s27 offen sc1
 buffer_load_dwordx4 v[194:197], v2, s[4:7], s28 offen sc1
Lj_271:
 s_waitcnt vmcnt(1)
 v_mfma_f32_16x16x32_bf16 v[198:201], v[170:173], v[190:193], 0
 s_waitcnt vmcnt(0)
 v_mfma_f32_16x16x32_bf16 v[198:201], v[170:173], v[194:197], v[198:201]
 v_max3_u32 v202, v190, v191, v192
 v_max3_u32 v202, v202, v193, v194
 v_max3_u32 v202, v202, v195, v196
 v_max_u32 v202, v202, v197
 v_cmp_eq_u32 vcc, -1, v202
 s_cbranch_vccnz Ljs_272
 s_nop 1
 v_cvt_pk_bf16_f32 v202, v198, v199
 v_cvt_pk_bf16_f32 v203, v200, v201
 s_mov_b64 exec, 0xffffffff
 s_cmp_eq_u32 s31, 7
 s_cbranch_scc1 Lov_273
Lnov_274:
 buffer_store_dwordx2 v[202:203], v123, s[4:7], s59 offen sc1
 buffer_store_dwordx2 v[182:183], v123, s[4:7], s60 offen sc1
 s_mov_b64 exec, -1
Lnr_270:
 s_add_u32 s31, s31, 1
 s_cmp_lt_u32 s31, 72
 s_barrier
 s_cbranch_scc1 L_rec_top_2r
 s_waitcnt vmcnt(0)
 s_barrier
 s_endpgm
Lzs_244:
 buffer_load_dwordx4 v[190:193], v2, s[4:7], s57 offen offset:0 sc1
 buffer_load_dwordx4 v[194:197], v2, s[4:7], s57 offen offset:1024 sc1
 buffer_load_dwordx4 v[198:201], v2, s[4:7], s57 offen offset:2048 sc1
 buffer_load_dwordx4 v[202:205], v2, s[4:7], s57 offen offset:3072 sc1
 buffer_load_dwordx4 v[206:209], v2, s[4:7], s58 offen offset:0 sc1
 s_add_u32 s41, s41, 1
 s_cmp_gt_u32 s41, 200000
 s_cbranch_scc1 L_fail
 s_branch Lz_243
Lzs_246:
 buffer_load_dwordx4 v[194:197], v2, s[4:7], s57 offen offset:1024 sc1
 buffer_load_dwordx4 v[198:201], v2, s[4:7], s57 offen offset:2048 sc1
 buffer_load_dwordx4 v[202:205], v2, s[4:7], s57 offen offset:3072 sc1
 buffer_load_dwordx4 v[206:209], v2, s[4:7], s58 offen offset:0 sc1
 s_add_u32 s41, s41, 1
 s_cmp_gt_u32 s41, 200000
 s_cbranch_scc1 L_fail
 s_branch Lz_245
Lzs_248:
 buffer_load_dwordx4 v[198:201], v2, s[4:7], s57 offen offset:2048 sc1
 buffer_load_dwordx4 v[202:205], v2, s[4:7], s57 offen offset:3072 sc1
 buffer_load_dwordx4 v[206:209], v2, s[4:7], s58 offen offset:0 sc1
 s_add_u32 s41, s41, 1
 s_cmp_gt_u32 s41, 200000
 s_cbranch_scc1 L_fail
 s_branch Lz_247
Lzs_250:
 buffer_load_dwordx4 v[202:205], v2, s[4:7], s57 offen offset:3072 sc1
 buffer_load_dwordx4 v[206:209], v2, s[4:7], s58 offen offset:0 sc1
 s_add_u32 s41, s41, 1
 s_cmp_gt_u32 s41, 200000
 s_cbranch_scc1 L_fail
 s_branch Lz_249
Lzs_252:
 buffer_load_dwordx4 v[206:209], v2, s[4:7], s58 offen offset:0 sc1
 s_add_u32 s41, s41, 1
 s_cmp_gt_u32 s41, 200000
 s_cbranch_scc1 L_fail
 s_branch Lz_251
Lfs_256:
 v_max3_u32 v222, v194, v195, v196
 v_max3_u32 v222, v222, v197, v198
 v_max3_u32 v222, v222, v199, v200
 v_max3_u32 v222, v222, v201, v202
 v_max3_u32 v222, v222, v203, v204
 v_max_u32 v222, v222, v205
 v_cmp_eq_u32 vcc, -1, v222
 s_cbranch_vccz Lfok_257
 buffer_load_dwordx4 v[194:197], v2, s[4:7], s27 offen offset:0 sc1
 buffer_load_dwordx4 v[198:201], v2, s[4:7], s27 offen offset:1024 sc1
 buffer_load_dwordx4 v[202:205], v2, s[4:7], s27 offen offset:2048 sc1
 s_add_u32 s41, s41, 1
 s_cmp_gt_u32 s41, 200000
 s_cbranch_scc1 L_fail
 s_branch Lf_255
Los_259:
 buffer_load_dwordx4 v[190:193], v2, s[4:7], s27 offen offset:0 sc1
 buffer_load_dwordx4 v[194:197], v2, s[4:7], s27 offen offset:1024 sc1
 buffer_load_dwordx4 v[198:201], v2, s[4:7], s27 offen offset:2048 sc1
 buffer_load_dwordx4 v[202:205], v2, s[4:7], s27 offen offset:3072 sc1
 buffer_load_dwordx4 v[206:209], v2, s[4:7], s28 offen offset:0 sc1
 buffer_load_dwordx4 v[210:213], v2, s[4:7], s28 offen offset:1024 sc1
 s_add_u32 s41, s41, 1
 s_cmp_gt_u32 s41, 200000
 s_cbranch_scc1 L_fail
 s_branch Lo_258
Los_261:
 buffer_load_dwordx4 v[194:197], v2, s[4:7], s27 offen offset:1024 sc1
 buffer_load_dwordx4 v[198:201], v2, s[4:7], s27 offen offset:2048 sc1
 buffer_load_dwordx4 v[202:205], v2, s[4:7], s27 offen offset:3072 sc1
 buffer_load_dwordx4 v[206:209], v2, s[4:7], s28 offen offset:0 sc1
 buffer_load_dwordx4 v[210:213], v2, s[4:7], s28 offen offset:1024 sc1
 s_waitcnt vmcnt(4)
 v_max3_u32 v1, v194, v195, v196
 v_max_u32 v1, v1, v197
 v_cmp_eq_u32 vcc, -1, v1
 s_add_u32 s41, s41, 1
 s_cmp_gt_u32 s41, 200000
 s_cbranch_scc1 L_fail
 s_branch Lo_260
Los_263:
 buffer_load_dwordx4 v[198:201], v2, s[4:7], s27 offen offset:2048 sc1
 buffer_load_dwordx4 v[202:205], v2, s[4:7], s27 offen offset:3072 sc1
 buffer_load_dwordx4 v[206:209], v2, s[4:7], s28 offen offset:0 sc1
 buffer_load_dwordx4 v[210:213], v2, s[4:7], s28 offen offset:1024 sc1
 s_waitcnt vmcnt(3)
 v_max3_u32 v1, v198, v199, v200
 v_max_u32 v1, v1, v201
 v_cmp_eq_u32 vcc, -1, v1
 s_add_u32 s41, s41, 1
 s_cmp_gt_u32 s41, 200000
 s_cbranch_scc1 L_fail
 s_branch Lo_262
Los_265:
 buffer_load_dwordx4 v[202:205], v2, s[4:7], s27 offen offset:3072 sc1
 buffer_load_dwordx4 v[206:209], v2, s[4:7], s28 offen offset:0 sc1
 buffer_load_dwordx4 v[210:213], v2, s[4:7], s28 offen offset:1024 sc1
 s_waitcnt vmcnt(2)
 v_max3_u32 v1, v202, v203, v204
 v_max_u32 v1, v1, v205
 v_cmp_eq_u32 vcc, -1, v1
 s_add_u32 s41, s41, 1
 s_cmp_gt_u32 s41, 200000
 s_cbranch_scc1 L_fail
 s_branch Lo_264
Los_267:
 buffer_load_dwordx4 v[206:209], v2, s[4:7], s28 offen offset:0 sc1
 buffer_load_dwordx4 v[210:213], v2, s[4:7], s28 offen offset:1024 sc1
 s_waitcnt vmcnt(1)
 v_max3_u32 v1, v206, v207, v208
 v_max_u32 v1, v1, v209
 v_cmp_eq_u32 vcc, -1, v1
 s_add_u32 s41, s41, 1
 s_cmp_gt_u32 s41, 200000
 s_cbranch_scc1 L_fail
 s_branch Lo_266
Los_269:
 buffer_load_dwordx4 v[210:213], v2, s[4:7], s28 offen offset:1024 sc1
 s_waitcnt vmcnt(0)
 v_max3_u32 v1, v210, v211, v212
 v_max_u32 v1, v1, v213
 v_cmp_eq_u32 vcc, -1, v1
 s_add_u32 s41, s41, 1
 s_cmp_gt_u32 s41, 200000
 s_cbranch_scc1 L_fail
 s_branch Lo_268
Ljs_272:
 buffer_load_dwordx4 v[190:193], v2, s[4:7], s27 offen sc1
 buffer_load_dwordx4 v[194:197], v2, s[4:7], s28 offen sc1
 s_add_u32 s41, s41, 1
 s_cmp_gt_u32 s41, 200000
 s_cbranch_scc1 L_fail
 s_branch Lj_271
Lov_273:
 s_mov_b32 exec_lo, 0xff00ff00
 v_mov_b32 v202, v128
 v_mov_b32 v203, v129
 s_mov_b32 exec_lo, -1
 s_add_u32 s41, s41, 1
 s_cmp_gt_u32 s41, 200000
 s_cbranch_scc1 L_fail
 s_branch Lnov_274
Lpwn_241:
 s_waitcnt vmcnt(0)
 s_barrier
L_rec_top_3r:
 s_sleep 2
 buffer_load_dwordx4 v[190:193], v2, s[4:7], s57 offen offset:0 sc1
 buffer_load_dwordx4 v[194:197], v2, s[4:7], s57 offen offset:1024 sc1
 buffer_load_dwordx4 v[198:201], v2, s[4:7], s57 offen offset:2048 sc1
 buffer_load_dwordx4 v[202:205], v2, s[4:7], s57 offen offset:3072 sc1
 buffer_load_dwordx4 v[206:209], v2, s[4:7], s58 offen offset:0 sc1
 s_mov_b32 s41, 0
Lz_277:
 s_waitcnt vmcnt(4)
 ds_write_b128 v109, v[190:193] offset:0
 v_mfma_f32_16x16x32_bf16 v[226:229], a[0:3], v[190:193], 0
 v_max3_u32 v1, v190, v191, v192
 v_max_u32 v1, v1, v193
 v_mfma_f32_16x16x32_bf16 v[230:233], a[80:83], v[190:193], 0
 v_cmp_eq_u32 vcc, -1, v1
 v_mfma_f32_16x16x32_bf16 v[234:237], a[160:163], v[190:193], 0
 s_cbranch_vccnz Lzs_278
Lz_279:
 s_waitcnt vmcnt(3)
 ds_write_b128 v109, v[194:197] offset:1024
 v_max3_u32 v1, v194, v195, v196
 v_max_u32 v1, v1, v197
 v_cmp_eq_u32 vcc, -1, v1
 s_cbranch_vccnz Lzs_280
 v_mfma_f32_16x16x32_bf16 v[226:229], a[4:7], v[194:197], v[226:229]
 v_mfma_f32_16x16x32_bf16 v[230:233], a[84:87], v[194:197], v[230:233]
 v_mfma_f32_16x16x32_bf16 v[234:237], a[164:167], v[194:197], v[234:237]
Lz_281:
 s_waitcnt vmcnt(2)
 ds_write_b128 v109, v[198:201] offset:2048
 v_max3_u32 v1, v198, v199, v200
 v_max_u32 v1, v1, v201
 v_cmp_eq_u32 vcc, -1, v1
 s_cbranch_vccnz Lzs_282
 v_mfma_f32_16x16x32_bf16 v[226:229], a[8:11], v[198:201], v[226:229]
 v_mfma_f32_16x16x32_bf16 v[230:233], a[88:91], v[198:201], v[230:233]
 v_mfma_f32_16x16x32_bf16 v[234:237], a[168:171], v[198:201], v[234:237]
Lz_283:
 s_waitcnt vmcnt(1)
 ds_write_b128 v109, v[202:205] offset:3072
 v_max3_u32 v1, v202, v203, v204
 v_max_u32 v1, v1, v205
 v_cmp_eq_u32 vcc, -1, v1
 s_cbranch_vccnz Lzs_284
Lz_285:
 s_waitcnt vmcnt(0)
 ds_write_b128 v109, v[206:209] offset:4096
 v_max3_u32 v1, v206, v207, v208
 v_max_u32 v1, v1, v209
 v_cmp_eq_u32 vcc, -1, v1
 s_cbranch_vccnz Lzs_286
 s_waitcnt lgkmcnt(0)
 s_barrier
 ds_read_b128 v[214:217], v110 offset:0
 ds_read_b128 v[218:221], v110 offset:1024
 ds_read_b128 v[222:225], v110 offset:2048
 v_mfma_f32_16x16x32_bf16 v[226:229], a[12:15], v[202:205], v[226:229]
 s_add_u32 s25, s68, s51
 v_mfma_f32_16x16x32_bf16 v[230:233], a[92:95], v[202:205], v[230:233]
 buffer_load_dwordx4 v[142:145], v2, s[4:7], s25 offen sc1
 v_mfma_f32_16x16x32_bf16 v[234:237], a[172:175], v[202:205], v[234:237]
 v_mfma_f32_16x16x32_bf16 v[226:229], a[16:19], v[206:209], v[226:229]
 s_add_u32 s25, s69, s51
 v_mfma_f32_16x16x32_bf16 v[230:233], a[96:99], v[206:209], v[230:233]
 buffer_load_dwordx4 v[150:153], v2, s[4:7], s25 offen sc1
 v_mfma_f32_16x16x32_bf16 v[234:237], a[176:179], v[206:209], v[234:237]
 ds_read_b128 v[210:213], v110 offset:3072
 s_waitcnt lgkmcnt(3)
 v_mfma_f32_16x16x32_bf16 v[226:229], a[20:23], v[214:217], v[226:229]
 s_add_u32 s25, s44, s62
 v_mfma_f32_16x16x32_bf16 v[230:233], a[100:103], v[214:217], v[230:233]
 buffer_store_dwordx4 v[182:185], v2, s[4:7], s25 offen offset:2048 sc1
 v_mfma_f32_16x16x32_bf16 v[234:237], a[180:183], v[214:217], v[234:237]
 ds_read_b128 v[214:217], v110 offset:4096
 s_waitcnt lgkmcnt(3)
 v_mfma_f32_16x16x32_bf16 v[226:229], a[24:27], v[218:221], v[226:229]
 s_add_u32 s25, s44, s62
 v_mfma_f32_16x16x32_bf16 v[230:233], a[104:107], v[218:221], v[230:233]
 s_add_u32 s25, s25, 1867776
 v_mfma_f32_16x16x32_bf16 v[234:237], a[184:187], v[218:221], v[234:237]
 buffer_store_dwordx4 v[182:185], v2, s[4:7], s25 offen offset:2048 sc1
 ds_read_b128 v[218:221], v111 offset:0
 s_waitcnt lgkmcnt(3)
 v_mfma_f32_16x16x32_bf16 v[226:229], a[28:31], v[222:225], v[226:229]
 s_add_u32 s25, s46, s64
 v_mfma_f32_16x16x32_bf16 v[230:233], a[108:111], v[222:225], v[230:233]
 buffer_store_dwordx2 v[182:183], v122, s[4:7], s25 offen sc1
 v_mfma_f32_16x16x32_bf16 v[234:237], a[188:191], v[222:225], v[234:237]
 ds_read_b128 v[222:225], v111 offset:1024
 s_waitcnt lgkmcnt(3)
 v_mfma_f32_16x16x32_bf16 v[226:229], a[32:35], v[210:213], v[226:229]
 s_add_u32 s25, s25, 655360
 v_mfma_f32_16x16x32_bf16 v[230:233], a[112:115], v[210:213], v[230:233]
 buffer_store_dwordx2 v[182:183], v122, s[4:7], s25 offen sc1
 v_mfma_f32_16x16x32_bf16 v[234:237], a[192:195], v[210:213], v[234:237]
 ds_read_b128 v[210:213], v111 offset:2048
 s_waitcnt lgkmcnt(3)
 v_mfma_f32_16x16x32_bf16 v[226:229], a[36:39], v[214:217], v[226:229]
 s_add_u32 s25, s47, s64
 v_mfma_f32_16x16x32_bf16 v[230:233], a[116:119], v[214:217], v[230:233]
 buffer_store_dwordx2 v[182:183], v122, s[4:7], s25 offen sc1
 v_mfma_f32_16x16x32_bf16 v[234:237], a[196:199], v[214:217], v[234:237]
 ds_read_b128 v[214:217], v111 offset:3072
 s_waitcnt lgkmcnt(3)
 v_mfma_f32_16x16x32_bf16 v[226:229], a[40:43], v[218:221], v[226:229]
 s_add_u32 s25, s25, 655360
 v_mfma_f32_16x16x32_bf16 v[230:233], a[120:123], v[218:221], v[230:233]
 buffer_store_dwordx2 v[182:183], v122, s[4:7], s25 offen sc1
 v_mfma_f32_16x16x32_bf16 v[234:237], a[200:203], v[218:221], v[234:237]
 ds_read_b128 v[218:221], v111 offset:4096
 s_waitcnt lgkmcnt(3)
 v_mfma_f32_16x16x32_bf16 v[226:229], a[44:47], v[222:225], v[226:229]
 s_add_u32 s25, s31, 1
 s_mul_i32 s68, s25, 393216
 v_mfma_f32_16x16x32_bf16 v[230:233], a[124:127], v[222:225], v[230:233]
 s_add_u32 s68, s68, 84066304
 s_cmp_lt_u32 s25, 64
 v_mfma_f32_16x16x32_bf16 v[234:237], a[204:207], v[222:225], v[234:237]
 s_cselect_b32 s68, s68, 2146435072
 ds_read_b128 v[222:225], v112 offset:0
 s_waitcnt lgkmcnt(3)
 v_mfma_f32_16x16x32_bf16 v[226:229], a[48:51], v[210:213], v[226:229]
 s_sub_u32 s26, s25, 8
 s_mul_i32 s69, s26, 393216
 v_mfma_f32_16x16x32_bf16 v[230:233], a[128:131], v[210:213], v[230:233]
 s_add_u32 s69, s69, 134397952
 s_cmp_lt_u32 s26, 64
 v_mfma_f32_16x16x32_bf16 v[234:237], a[208:211], v[210:213], v[234:237]
 s_cselect_b32 s69, s69, 2146435072
 ds_read_b128 v[210:213], v112 offset:1024
 s_waitcnt lgkmcnt(3)
 v_mfma_f32_16x16x32_bf16 v[226:229], a[52:55], v[214:217], v[226:229]
 s_add_u32 s25, s68, 4269801472
 s_add_u32 s26, s69, 4269801472
 v_mfma_f32_16x16x32_bf16 v[230:233], a[132:135], v[214:217], v[230:233]
 s_cmp_lt_u32 s3, 2
 s_cselect_b32 s67, s25, s26
 v_mfma_f32_16x16x32_bf16 v[234:237], a[212:215], v[214:217], v[234:237]
 s_add_u32 s67, s67, s50
 ds_read_b128 v[214:217], v112 offset:2048
 s_waitcnt lgkmcnt(3)
 v_mfma_f32_16x16x32_bf16 v[226:229], a[56:59], v[218:221], v[226:229]
 v_mfma_f32_16x16x32_bf16 v[230:233], a[136:139], v[218:221], v[230:233]
 v_mfma_f32_16x16x32_bf16 v[234:237], a[216:219], v[218:221], v[234:237]
 ds_read_b128 v[218:221], v112 offset:3072
 s_waitcnt lgkmcnt(3)
 v_mfma_f32_16x16x32_bf16 v[226:229], a[60:63], v[222:225], v[226:229]
 v_mfma_f32_16x16x32_bf16 v[230:233], a[140:143], v[222:225], v[230:233]
 v_mfma_f32_16x16x32_bf16 v[234:237], a[220:223], v[222:225], v[234:237]
 ds_read_b128 v[222:225], v112 offset:4096
 s_waitcnt lgkmcnt(3)
 v_mfma_f32_16x16x32_bf16 v[226:229], a[64:67], v[210:213], v[226:229]
 v_mfma_f32_16x16x32_bf16 v[230:233], a[144:147], v[210:213], v[230:233]
 v_mfma_f32_16x16x32_bf16 v[234:237], a[224:227], v[210:213], v[234:237]
 s_waitcnt lgkmcnt(2)
 v_mfma_f32_16x16x32_bf16 v[226:229], a[68:71], v[214:217], v[226:229]
 v_mfma_f32_16x16x32_bf16 v[230:233], a[148:151], v[214:217], v[230:233]
 v_mfma_f32_16x16x32_bf16 v[234:237], a[228:231], v[214:217], v[234:237]
 s_waitcnt lgkmcnt(1)
 v_mfma_f32_16x16x32_bf16 v[226:229], a[72:75], v[218:221], v[226:229]
 v_mfma_f32_16x16x32_bf16 v[230:233], a[152:155], v[218:221], v[230:233]
 v_mfma_f32_16x16x32_bf16 v[234:237], a[232:235], v[218:221], v[234:237]
 s_waitcnt lgkmcnt(0)
 v_mfma_f32_16x16x32_bf16 v[226:229], a[76:79], v[222:225], v[226:229]
 v_mfma_f32_16x16x32_bf16 v[230:233], a[156:159], v[222:225], v[230:233]
 v_mfma_f32_16x16x32_bf16 v[234:237], a[236:239], v[222:225], v[234:237]
 s_nop 1
 v_cvt_pk_bf16_f32 v190, v226, v227
 v_cvt_pk_bf16_f32 v191, v228, v229
 ds_write_b64 v113, v[190:191] offset:0
 v_cvt_pk_bf16_f32 v192, v230, v231
 v_cvt_pk_bf16_f32 v193, v232, v233
 ds_write_b64 v114, v[192:193] offset:0
 v_cvt_pk_bf16_f32 v194, v234, v235
 v_cvt_pk_bf16_f32 v195, v236, v237
 ds_write_b64 v113, v[194:195] offset:1024
 s_add_u32 s26, s61, s44
 s_add_u32 s27, s61, s45
 s_waitcnt lgkmcnt(0)
 s_barrier
 ds_read_b128 v[198:201], v3 offset:20480
 ds_read_b128 v[202:205], v3 offset:21504
 ds_read_b128 v[206:209], v3 offset:22528
 ds_read_b128 v[226:229], v3 offset:23552
 ds_read_b128 v[230:233], v3 offset:24576
 ds_read_b128 v[234:237], v3 offset:25600
 ds_read_b128 v[210:213], v109 offset:0
 ds_read_b128 v[214:217], v109 offset:1024
 ds_read_b128 v[218:221], v109 offset:2048
 s_waitcnt lgkmcnt(8)
 v_mfma_f32_16x16x32_bf16 v[194:197], v[130:133], v[198:201], 0
 s_waitcnt lgkmcnt(7)
 v_mfma_f32_16x16x32_bf16 v[194:197], v[134:137], v[202:205], v[194:197]
 s_waitcnt lgkmcnt(6)
 v_mfma_f32_16x16x32_bf16 v[194:197], v[138:141], v[206:209], v[194:197]
 s_waitcnt lgkmcnt(5)
 v_mfma_f32_16x16x32_bf16 v[190:193], v[226:229], v[198:201], v[158:161]
 s_waitcnt lgkmcnt(4)
 v_mfma_f32_16x16x32_bf16 v[190:193], v[230:233], v[202:205], v[190:193]
 s_mov_b32 exec_lo, 0xff00ff00
 s_mov_b32 exec_hi, 0xff00ff00
 s_waitcnt lgkmcnt(3)
 v_mfma_f32_16x16x32_bf16 v[190:193], v[234:237], v[206:209], v[190:193]
 buffer_store_dwordx4 v[194:197], v2, s[4:7], s26 offen offset:1024 sc1
 ds_write_b128 v117, v[194:197] offset:26624
 s_mov_b64 exec, -1
 ds_read_b128 v[222:225], v109 offset:3072
 s_waitcnt lgkmcnt(4)
 v_mfma_f32_16x16x32_bf16 v[226:229], v[210:213], a[240:243], 0
 v_mfma_f32_16x16x32_bf16 v[230:233], v[210:213], v[68:71], 0
 s_nop 0
 buffer_store_dwordx4 v[190:193], v2, s[4:7], s26 offen offset:2048 sc1
 ds_read_b128 v[210:213], v109 offset:4096
 s_waitcnt lgkmcnt(4)
 v_mfma_f32_16x16x32_bf16 v[226:229], v[214:217], a[244:247], v[226:229]
 v_mfma_f32_16x16x32_bf16 v[230:233], v[214:217], v[72:75], v[230:233]
 ds_read_b128 v[214:217], v110 offset:0
 s_waitcnt lgkmcnt(4)
 v_mfma_f32_16x16x32_bf16 v[226:229], v[218:221], a[248:251], v[226:229]
 v_mfma_f32_16x16x32_bf16 v[230:233], v[218:221], v[76:79], v[230:233]
 buffer_load_dword v126, v124, s[4:7], 0 offen sc1
 ds_read_b128 v[218:221], v110 offset:1024
 s_waitcnt lgkmcnt(3)
 v_mfma_f32_16x16x32_bf16 v[226:229], v[222:225], a[252:255], v[226:229]
 v_mfma_f32_16x16x32_bf16 v[230:233], v[222:225], v[80:83], v[230:233]
 ds_read_b128 v[222:225], v110 offset:2048
 s_waitcnt lgkmcnt(3)
 v_mfma_f32_16x16x32_bf16 v[226:229], v[210:213], v[4:7], v[226:229]
 v_mfma_f32_16x16x32_bf16 v[230:233], v[210:213], v[84:87], v[230:233]
 s_barrier
 ds_read_b128 v[234:237], v3 offset:26624
 ds_read_b128 v[238:241], v3 offset:27648
 ds_read_b128 v[210:213], v110 offset:3072
 s_waitcnt lgkmcnt(5)
 v_mfma_f32_16x16x32_bf16 v[226:229], v[214:217], v[8:11], v[226:229]
 v_mfma_f32_16x16x32_bf16 v[230:233], v[214:217], v[88:91], v[230:233]
 ds_read_b128 v[214:217], v110 offset:4096
 s_waitcnt lgkmcnt(5)
 v_mfma_f32_16x16x32_bf16 v[226:229], v[218:221], v[12:15], v[226:229]
 v_mfma_f32_16x16x32_bf16 v[230:233], v[218:221], v[92:95], v[230:233]
 ds_read_b128 v[218:221], v111 offset:0
 s_waitcnt lgkmcnt(5)
 v_mfma_f32_16x16x32_bf16 v[226:229], v[222:225], v[16:19], v[226:229]
 v_mfma_f32_16x16x32_bf16 v[230:233], v[222:225], v[96:99], v[230:233]
 ds_read_b128 v[222:225], v111 offset:1024
 s_waitcnt lgkmcnt(3)
 v_mfma_f32_16x16x32_bf16 v[226:229], v[210:213], v[20:23], v[226:229]
 v_mfma_f32_16x16x32_bf16 v[230:233], v[210:213], v[100:103], v[230:233]
 buffer_load_dwordx4 v[194:197], v2, s[4:7], s27 offen offset:0 sc1
 ds_read_b128 v[210:213], v111 offset:2048
 s_waitcnt lgkmcnt(3)
 v_mfma_f32_16x16x32_bf16 v[226:229], v[214:217], v[24:27], v[226:229]
 v_mfma_f32_16x16x32_bf16 v[230:233], v[214:217], v[104:107], v[230:233]
 ds_read_b128 v[214:217], v111 offset:3072
 s_waitcnt lgkmcnt(3)
 v_mfma_f32_16x16x32_bf16 v[226:229], v[218:221], v[28:31], v[226:229]
 ds_read_b128 v[218:221], v111 offset:4096
 s_waitcnt lgkmcnt(3)
 v_mfma_f32_16x16x32_bf16 v[226:229], v[222:225], v[32:35], v[226:229]
 buffer_load_dwordx4 v[198:201], v2, s[4:7], s27 offen offset:1024 sc1
 ds_read_b128 v[222:225], v112 offset:0
 s_waitcnt lgkmcnt(3)
 v_mfma_f32_16x16x32_bf16 v[226:229], v[210:213], v[36:39], v[226:229]
 ds_write_b128 v117, v[230:233] offset:28672
 ds_read_b128 v[210:213], v112 offset:1024
 s_waitcnt lgkmcnt(4)
 v_mfma_f32_16x16x32_bf16 v[226:229], v[214:217], v[40:43], v[226:229]
 ds_read_b128 v[214:217], v112 offset:2048
 s_waitcnt lgkmcnt(4)
 v_mfma_f32_16x16x32_bf16 v[226:229], v[218:221], v[44:47], v[226:229]
 buffer_load_dwordx4 v[202:205], v2, s[4:7], s27 offen offset:2048 sc1
 ds_read_b128 v[218:221], v112 offset:3072
 s_waitcnt lgkmcnt(4)
 v_mfma_f32_16x16x32_bf16 v[226:229], v[222:225], v[48:51], v[226:229]
 ds_read_b128 v[222:225], v112 offset:4096
 s_waitcnt lgkmcnt(3)
 v_mfma_f32_16x16x32_bf16 v[226:229], v[210:213], v[52:55], v[226:229]
 s_waitcnt lgkmcnt(2)
 v_mfma_f32_16x16x32_bf16 v[226:229], v[214:217], v[56:59], v[226:229]
 s_barrier
 s_waitcnt lgkmcnt(1)
 v_mfma_f32_16x16x32_bf16 v[226:229], v[218:221], v[60:63], v[226:229]
 s_waitcnt vmcnt(3)
 s_mov_b32 s41, 0
 v_min_i32 v1, 64, v125
 v_cmp_ge_i32 vcc, v126, v1
 s_nop 0
 s_cmp_eq_u64 vcc, -1
 s_cbranch_scc1 Lflok_288
Lfl_287:
 s_add_u32 s41, s41, 1
 s_cmp_gt_u32 s41, 200000
 s_cbranch_scc1 L_fail
 buffer_load_dword v126, v124, s[4:7], 0 offen sc1
 s_waitcnt vmcnt(0)
 v_cmp_ge_i32 vcc, v126, v1
 s_nop 0
 s_cmp_eq_u64 vcc, -1
 s_cbranch_scc0 Lfl_287
 buffer_load_dwordx4 v[194:197], v2, s[4:7], s27 offen offset:0 sc1
 buffer_load_dwordx4 v[198:201], v2, s[4:7], s27 offen offset:1024 sc1
 buffer_load_dwordx4 v[202:205], v2, s[4:7], s27 offen offset:2048 sc1
Lflok_288:
 v_add_u32 v125, 1, v125
 s_waitcnt lgkmcnt(0)
 v_mfma_f32_16x16x32_bf16 v[226:229], v[222:225], v[64:67], v[226:229]
 s_mov_b32 s41, 0
Lf_289:
 s_waitcnt vmcnt(2)
 v_add_f32 v210, v234, v194
 v_add_f32 v211, v235, v195
 v_add_f32 v212, v236, v196
 v_add_f32 v213, v237, v197
 s_waitcnt vmcnt(1)
 v_add_f32 v214, v238, v198
 v_add_f32 v215, v239, v199
 v_add_f32 v216, v240, v200
 v_add_f32 v217, v241, v201
 v_maximum3_f32 v1, v210, v211, v212
 v_maximum3_f32 v127, v213, v214, v215
 v_maximum3_f32 v1, v1, v216, v217
 s_waitcnt vmcnt(0)
 v_add_f32 v218, v190, v202
 v_add_f32 v219, v191, v203
 v_add_f32 v220, v192, v204
 v_add_f32 v221, v193, v205
 v_maximum3_f32 v127, v127, v218, v219
 v_maximum3_f32 v1, v1, v220, v221
 v_maximum3_f32 v1, v1, v127, v127
 v_cmp_u_f32 vcc, v1, v1
 v_mov_b32 v127, v1
 s_cbranch_vccnz Lfs_290
Lfok_291:
 s_nop 0
 v_permlane32_swap_b32 v1, v127
 v_max_f32 v1, v1, v127
 v_mov_b32 v127, v1
 v_cvt_pk_bf16_f32 v178, v226, v227
 v_cvt_pk_bf16_f32 v179, v228, v229
 v_permlane16_swap_b32 v1, v127
 v_max_f32 v1, v1, v127
 v_mul_f32 v1, s71, v1
 v_fma_f32 v210, v210, s71, -v1
 v_fma_f32 v211, v211, s71, -v1
 v_fma_f32 v212, v212, s71, -v1
 v_fma_f32 v213, v213, s71, -v1
 v_fma_f32 v214, v214, s71, -v1
 v_fma_f32 v215, v215, s71, -v1
 v_fma_f32 v216, v216, s71, -v1
 v_fma_f32 v217, v217, s71, -v1
 v_fma_f32 v218, v218, s71, -v1
 v_fma_f32 v219, v219, s71, -v1
 v_fma_f32 v220, v220, s71, -v1
 v_fma_f32 v221, v221, s71, -v1
 v_exp_f32 v210, v210
 v_exp_f32 v211, v211
 v_exp_f32 v212, v212
 v_exp_f32 v213, v213
 v_exp_f32 v214, v214
 v_exp_f32 v215, v215
 v_exp_f32 v216, v216
 v_exp_f32 v217, v217
 s_mov_b32 exec_lo, 0x00ff00ff
 s_mov_b32 exec_hi, 0x00ff00ff
 v_cvt_pk_bf16_f32 v162, v210, v211
 v_cvt_pk_bf16_f32 v163, v212, v213
 v_cvt_pk_bf16_f32 v164, v214, v215
 v_cvt_pk_bf16_f32 v165, v216, v217
 s_not_b64 exec, exec
 v_cvt_pk_bf16_f32 v166, v210, v211
 v_cvt_pk_bf16_f32 v167, v212, v213
 v_cvt_pk_bf16_f32 v168, v214, v215
 v_cvt_pk_bf16_f32 v169, v216, v217
 s_mov_b64 exec, -1
 v_mfma_f32_16x16x32_bf16 v[200:203], v[186:189], v[162:165], 0
 v_exp_f32 v218, v218
 v_exp_f32 v219, v219
 v_mfma_f32_16x16x32_bf16 v[192:195], v[142:145], v[162:165], 0
 v_exp_f32 v220, v220
 v_exp_f32 v221, v221
 v_mfma_f32_16x16x32_bf16 v[200:203], v[186:189], v[166:169], v[200:203]
 v_cvt_pk_bf16_f32 v190, v218, v219
 v_mfma_f32_16x16x32_bf16 v[192:195], v[150:153], v[166:169], v[192:195]
 v_cvt_pk_bf16_f32 v191, v220, v221
 s_nop 1
 v_mfma_f32_16x16x16_bf16 v[200:203], v[186:187], v[190:191], v[200:203]
 s_add_u32 s25, s61, s55
 s_add_u32 s27, s61, s56
 v_mfma_f32_16x16x16_bf16 v[192:195], v[178:179], v[190:191], v[192:195]
 s_add_u32 s28, s27, 4096
 s_mov_b32 s41, 0
 s_nop 2
 v_rcp_f32 v127, v200
 s_nop 1
 v_mul_f32 v192, v192, v127
 v_mul_f32 v193, v193, v127
 v_mul_f32 v194, v194, v127
 v_mul_f32 v195, v195, v127
 v_cvt_pk_bf16_f32 v204, v192, v193
 v_cvt_pk_bf16_f32 v205, v194, v195
 buffer_store_dwordx2 v[204:205], v2, s[4:7], s25 offen sc1
 ds_read_b128 v[142:145], v115 offset:0
 ds_read_b128 v[146:149], v115 offset:1024
 ds_read_b128 v[150:153], v115 offset:2048
 ds_read_b128 v[154:157], v115 offset:3072
 ds_read_b128 v[234:237], v115 offset:4096
 ds_read_b128 v[238:241], v115 offset:5120
 ds_read_b128 v[242:245], v115 offset:6144
 ds_read_b128 v[246:249], v115 offset:7168
 ds_read_b128 v[250:253], v115 offset:8192
 s_sleep 2
 buffer_load_dwordx4 v[190:193], v2, s[4:7], s27 offen offset:0 sc1
 buffer_load_dwordx4 v[194:197], v2, s[4:7], s27 offen offset:1024 sc1
 buffer_load_dwordx4 v[198:201], v2, s[4:7], s27 offen offset:2048 sc1
 buffer_load_dwordx4 v[202:205], v2, s[4:7], s27 offen offset:3072 sc1
 buffer_load_dwordx4 v[206:209], v2, s[4:7], s28 offen offset:0 sc1
 buffer_load_dwordx4 v[210:213], v2, s[4:7], s28 offen offset:1024 sc1
 s_waitcnt lgkmcnt(0)
Lo_292:
 s_waitcnt vmcnt(5)
 v_max3_u32 v1, v190, v191, v192
 v_max_u32 v1, v1, v193
 v_cmp_eq_u32 vcc, -1, v1
 s_cbranch_vccnz Los_293
 v_mfma_f32_16x16x32_bf16 v[214:217], v[142:145], v[190:193], 0
 ds_read_b128 v[142:145], v115 offset:9216
 v_mfma_f32_16x16x32_bf16 v[218:221], v[146:149], v[190:193], 0
 ds_read_b128 v[146:149], v115 offset:10240
 s_waitcnt vmcnt(4)
 v_max3_u32 v1, v194, v195, v196
 v_mfma_f32_16x16x32_bf16 v[222:225], v[150:153], v[190:193], 0
 ds_read_b128 v[150:153], v115 offset:11264
 v_max_u32 v1, v1, v197
 v_mfma_f32_16x16x32_bf16 v[226:229], v[154:157], v[190:193], 0
 ds_read_b128 v[154:157], v115 offset:12288
 v_cmp_eq_u32 vcc, -1, v1
 v_mfma_f32_16x16x32_bf16 v[230:233], v[234:237], v[190:193], 0
 ds_read_b128 v[234:237], v115 offset:13312
Lo_294:
 s_cbranch_vccnz Los_295
 v_mfma_f32_16x16x32_bf16 v[214:217], v[238:241], v[194:197], v[214:217]
 ds_read_b128 v[238:241], v115 offset:14336
 v_mfma_f32_16x16x32_bf16 v[218:221], v[242:245], v[194:197], v[218:221]
 ds_read_b128 v[242:245], v116 offset:0
 s_waitcnt vmcnt(3)
 v_max3_u32 v1, v198, v199, v200
 v_mfma_f32_16x16x32_bf16 v[222:225], v[246:249], v[194:197], v[222:225]
 ds_read_b128 v[246:249], v116 offset:1024
 v_max_u32 v1, v1, v201
 v_mfma_f32_16x16x32_bf16 v[226:229], v[250:253], v[194:197], v[226:229]
 ds_read_b128 v[250:253], v116 offset:2048
 v_cmp_eq_u32 vcc, -1, v1
 s_waitcnt lgkmcnt(7)
 v_mfma_f32_16x16x32_bf16 v[230:233], v[142:145], v[194:197], v[230:233]
 ds_read_b128 v[142:145], v116 offset:3072
Lo_296:
 s_cbranch_vccnz Los_297
 v_mfma_f32_16x16x32_bf16 v[214:217], v[146:149], v[198:201], v[214:217]
 ds_read_b128 v[146:149], v116 offset:4096
 s_waitcnt lgkmcnt(7)
 v_mfma_f32_16x16x32_bf16 v[218:221], v[150:153], v[198:201], v[218:221]
 ds_read_b128 v[150:153], v116 offset:5120
 s_waitcnt vmcnt(2)
 v_max3_u32 v1, v202, v203, v204
 v_mfma_f32_16x16x32_bf16 v[222:225], v[154:157], v[198:201], v[222:225]
 ds_read_b128 v[154:157], v116 offset:6144
 v_max_u32 v1, v1, v205
 s_waitcnt lgkmcnt(7)
 v_mfma_f32_16x16x32_bf16 v[226:229], v[234:237], v[198:201], v[226:229]
 ds_read_b128 v[234:237], v116 offset:7168
 v_cmp_eq_u32 vcc, -1, v1
 v_mfma_f32_16x16x32_bf16 v[230:233], v[238:241], v[198:201], v[230:233]
 ds_read_b128 v[238:241], v116 offset:8192
Lo_298:
 s_cbranch_vccnz Los_299
 s_waitcnt lgkmcnt(7)
 v_mfma_f32_16x16x32_bf16 v[214:217], v[242:245], v[202:205], v[214:217]
 ds_read_b128 v[242:245], v116 offset:9216
 v_mfma_f32_16x16x32_bf16 v[218:221], v[246:249], v[202:205], v[218:221]
 ds_read_b128 v[246:249], v116 offset:10240
 s_waitcnt vmcnt(1)
 v_max3_u32 v1, v206, v207, v208
 s_waitcnt lgkmcnt(7)
 v_mfma_f32_16x16x32_bf16 v[222:225], v[250:253], v[202:205], v[222:225]
 ds_read_b128 v[250:253], v116 offset:11264
 v_max_u32 v1, v1, v209
 v_mfma_f32_16x16x32_bf16 v[226:229], v[142:145], v[202:205], v[226:229]
 ds_read_b128 v[142:145], v116 offset:12288
 v_cmp_eq_u32 vcc, -1, v1
 s_waitcnt lgkmcnt(7)
 v_mfma_f32_16x16x32_bf16 v[230:233], v[146:149], v[202:205], v[230:233]
 ds_read_b128 v[146:149], v116 offset:13312
Lo_300:
 s_cbranch_vccnz Los_301
 v_mfma_f32_16x16x32_bf16 v[214:217], v[150:153], v[206:209], v[214:217]
 ds_read_b128 v[150:153], v116 offset:14336
 s_waitcnt lgkmcnt(7)
 v_mfma_f32_16x16x32_bf16 v[218:221], v[154:157], v[206:209], v[218:221]
 s_waitcnt vmcnt(0)
 v_max3_u32 v1, v210, v211, v212
 v_mfma_f32_16x16x32_bf16 v[222:225], v[234:237], v[206:209], v[222:225]
 v_max_u32 v1, v1, v213
 s_waitcnt lgkmcnt(5)
 v_mfma_f32_16x16x32_bf16 v[226:229], v[238:241], v[206:209], v[226:229]
 v_cmp_eq_u32 vcc, -1, v1
 v_mfma_f32_16x16x32_bf16 v[230:233], v[242:245], v[206:209], v[230:233]
Lo_302:
 s_cbranch_vccnz Los_303
 s_waitcnt lgkmcnt(3)
 v_mfma_f32_16x16x32_bf16 v[214:217], v[246:249], v[210:213], v[214:217]
 buffer_load_dwordx4 v[130:133], v2, s[4:7], s67 offen sc1
 v_mfma_f32_16x16x32_bf16 v[218:221], v[250:253], v[210:213], v[218:221]
 buffer_load_dwordx4 v[134:137], v2, s[4:7], s67 offen offset:2048 sc1
 s_waitcnt lgkmcnt(1)
 v_mfma_f32_16x16x32_bf16 v[222:225], v[142:145], v[210:213], v[222:225]
 s_add_u32 s25, s67, 4096
 buffer_load_dwordx4 v[138:141], v2, s[4:7], s25 offen sc1
 v_mfma_f32_16x16x32_bf16 v[226:229], v[146:149], v[210:213], v[226:229]
 s_waitcnt lgkmcnt(0)
 v_mfma_f32_16x16x32_bf16 v[230:233], v[150:153], v[210:213], v[230:233]
 v_cvt_pk_bf16_f32 v190, v214, v215
 v_cvt_pk_bf16_f32 v191, v216, v217
 v_cvt_pk_bf16_f32 v192, v218, v219
 v_cvt_pk_bf16_f32 v193, v220, v221
 ds_write_b128 v119, v[190:193]
 v_cvt_pk_bf16_f32 v194, v222, v223
 v_cvt_pk_bf16_f32 v195, v224, v225
 v_cvt_pk_bf16_f32 v196, v226, v227
 v_cvt_pk_bf16_f32 v197, v228, v229
 ds_write_b128 v119, v[194:197] offset:4096
 v_cvt_pk_bf16_f32 v198, v230, v231
 v_cvt_pk_bf16_f32 v199, v232, v233
 ds_write_b64 v120, v[198:199] offset:8192
 s_add_u32 s25, s63, s46
 s_add_u32 s26, s63, s47
 s_add_u32 s27, s25, 655360
 s_add_u32 s28, s26, 655360
 s_waitcnt lgkmcnt(0)
 s_barrier
 ds_read_b128 v[190:193], v121 offset:0
 ds_read_b128 v[194:197], v121 offset:1024
 ds_read_b128 v[198:201], v3 offset:8192
 ds_read_b128 v[202:205], v3 offset:9216
 s_waitcnt lgkmcnt(3)
 v_mfma_f32_16x16x32_bf16 v[206:209], v[170:173], v[190:193], 0
 s_waitcnt lgkmcnt(2)
 v_mfma_f32_16x16x32_bf16 v[206:209], v[174:177], v[194:197], v[206:209]
 s_waitcnt lgkmcnt(1)
 v_mfma_f32_16x16x32_bf16 v[210:213], v[170:173], v[198:201], 0
 s_waitcnt lgkmcnt(0)
 v_mfma_f32_16x16x32_bf16 v[210:213], v[174:177], v[202:205], v[210:213]
 s_nop 1
 v_cvt_pk_bf16_f32 v214, v206, v207
 v_cvt_pk_bf16_f32 v215, v208, v209
 buffer_store_dwordx2 v[214:215], v122, s[4:7], s25 offen sc1
 s_nop 2
 v_cvt_pk_bf16_f32 v216, v210, v211
 v_cvt_pk_bf16_f32 v217, v212, v213
 buffer_store_dwordx2 v[216:217], v122, s[4:7], s26 offen sc1
 buffer_store_dwordx2 v[216:217], v122, s[4:7], s28 offen sc1
 buffer_store_dwordx2 v[214:215], v122, s[4:7], s27 offen sc1
 ds_read_b128 v[190:193], v3 offset:23552
 ds_read_b128 v[194:197], v3 offset:24576
 ds_read_b128 v[198:201], v3 offset:25600
 ds_read_b64 v[202:203], v118 offset:0
 ds_read_b64 v[204:205], v118 offset:512
 ds_read_b64 v[206:207], v118 offset:1024
 ds_read_b64 v[210:211], v118 offset:2048
 ds_read_b64 v[212:213], v118 offset:2560
 s_add_u32 s25, s70, s53
 s_add_u32 s26, s25, 15728640
 s_waitcnt lgkmcnt(0)
 buffer_store_dwordx4 v[190:193], v2, s[4:7], s25 offen offset:0 sc1
 buffer_store_dwordx4 v[194:197], v2, s[4:7], s25 offen offset:1024 sc1
 buffer_store_dwordx4 v[198:201], v2, s[4:7], s25 offen offset:2048 sc1
 buffer_store_dwordx2 v[202:203], v108, s[4:7], s26 offen offset:0 sc1
 buffer_store_dwordx2 v[204:205], v108, s[4:7], s26 offen offset:512 sc1
 buffer_store_dwordx2 v[206:207], v108, s[4:7], s26 offen offset:1024 sc1
 buffer_store_dwordx2 v[178:179], v108, s[4:7], s26 offen offset:1536 sc1
 buffer_store_dwordx2 v[210:211], v108, s[4:7], s26 offen offset:2048 sc1
 buffer_store_dwordx2 v[212:213], v108, s[4:7], s26 offen offset:2560 sc1
 s_add_u32 s27, s63, s48
 s_add_u32 s28, s63, s49
 s_add_u32 s70, s31, 1
 s_and_b32 s25, s70, 3
 s_mul_i32 s26, s25, 20480
 s_add_u32 s57, s26, s42
 s_add_u32 s58, s57, 4096
 s_add_u32 s59, s26, s43
 s_mul_i32 s63, s25, 163840
 s_xor_b32 s26, s25, 2
 s_mul_i32 s64, s26, 163840
 s_add_u32 s25, s25, 3
 s_and_b32 s25, s25, 3
 s_mul_i32 s26, s25, 20480
 s_add_u32 s60, s26, s43
 s_and_b32 s25, s70, 1
 s_mul_i32 s61, s25, 196608
 s_xor_b32 s25, s25, 1
 s_mul_i32 s62, s25, 196608
 s_mul_i32 s70, s70, 196608
 s_add_u32 s31, s31, 1
 s_cmp_lt_u32 s31, 72
 s_barrier
 s_cbranch_scc1 L_rec_top_3r
 s_waitcnt vmcnt(0)
 s_barrier
 s_endpgm
Lzs_278:
 buffer_load_dwordx4 v[190:193], v2, s[4:7], s57 offen offset:0 sc1
 buffer_load_dwordx4 v[194:197], v2, s[4:7], s57 offen offset:1024 sc1
 buffer_load_dwordx4 v[198:201], v2, s[4:7], s57 offen offset:2048 sc1
 buffer_load_dwordx4 v[202:205], v2, s[4:7], s57 offen offset:3072 sc1
 buffer_load_dwordx4 v[206:209], v2, s[4:7], s58 offen offset:0 sc1
 s_add_u32 s41, s41, 1
 s_cmp_gt_u32 s41, 200000
 s_cbranch_scc1 L_fail
 s_branch Lz_277
Lzs_280:
 buffer_load_dwordx4 v[194:197], v2, s[4:7], s57 offen offset:1024 sc1
 buffer_load_dwordx4 v[198:201], v2, s[4:7], s57 offen offset:2048 sc1
 buffer_load_dwordx4 v[202:205], v2, s[4:7], s57 offen offset:3072 sc1
 buffer_load_dwordx4 v[206:209], v2, s[4:7], s58 offen offset:0 sc1
 s_add_u32 s41, s41, 1
 s_cmp_gt_u32 s41, 200000
 s_cbranch_scc1 L_fail
 s_branch Lz_279
Lzs_282:
 buffer_load_dwordx4 v[198:201], v2, s[4:7], s57 offen offset:2048 sc1
 buffer_load_dwordx4 v[202:205], v2, s[4:7], s57 offen offset:3072 sc1
 buffer_load_dwordx4 v[206:209], v2, s[4:7], s58 offen offset:0 sc1
 s_add_u32 s41, s41, 1
 s_cmp_gt_u32 s41, 200000
 s_cbranch_scc1 L_fail
 s_branch Lz_281
Lzs_284:
 buffer_load_dwordx4 v[202:205], v2, s[4:7], s57 offen offset:3072 sc1
 buffer_load_dwordx4 v[206:209], v2, s[4:7], s58 offen offset:0 sc1
 s_add_u32 s41, s41, 1
 s_cmp_gt_u32 s41, 200000
 s_cbranch_scc1 L_fail
 s_branch Lz_283
Lzs_286:
 buffer_load_dwordx4 v[206:209], v2, s[4:7], s58 offen offset:0 sc1
 s_add_u32 s41, s41, 1
 s_cmp_gt_u32 s41, 200000
 s_cbranch_scc1 L_fail
 s_branch Lz_285
Lfs_290:
 v_max3_u32 v222, v194, v195, v196
 v_max3_u32 v222, v222, v197, v198
 v_max3_u32 v222, v222, v199, v200
 v_max3_u32 v222, v222, v201, v202
 v_max3_u32 v222, v222, v203, v204
 v_max_u32 v222, v222, v205
 v_cmp_eq_u32 vcc, -1, v222
 s_cbranch_vccz Lfok_291
 buffer_load_dwordx4 v[194:197], v2, s[4:7], s27 offen offset:0 sc1
 buffer_load_dwordx4 v[198:201], v2, s[4:7], s27 offen offset:1024 sc1
 buffer_load_dwordx4 v[202:205], v2, s[4:7], s27 offen offset:2048 sc1
 s_add_u32 s41, s41, 1
 s_cmp_gt_u32 s41, 200000
 s_cbranch_scc1 L_fail
 s_branch Lf_289
Los_293:
 buffer_load_dwordx4 v[190:193], v2, s[4:7], s27 offen offset:0 sc1
 buffer_load_dwordx4 v[194:197], v2, s[4:7], s27 offen offset:1024 sc1
 buffer_load_dwordx4 v[198:201], v2, s[4:7], s27 offen offset:2048 sc1
 buffer_load_dwordx4 v[202:205], v2, s[4:7], s27 offen offset:3072 sc1
 buffer_load_dwordx4 v[206:209], v2, s[4:7], s28 offen offset:0 sc1
 buffer_load_dwordx4 v[210:213], v2, s[4:7], s28 offen offset:1024 sc1
 s_add_u32 s41, s41, 1
 s_cmp_gt_u32 s41, 200000
 s_cbranch_scc1 L_fail
 s_branch Lo_292
Los_295:
 buffer_load_dwordx4 v[194:197], v2, s[4:7], s27 offen offset:1024 sc1
 buffer_load_dwordx4 v[198:201], v2, s[4:7], s27 offen offset:2048 sc1
 buffer_load_dwordx4 v[202:205], v2, s[4:7], s27 offen offset:3072 sc1
 buffer_load_dwordx4 v[206:209], v2, s[4:7], s28 offen offset:0 sc1
 buffer_load_dwordx4 v[210:213], v2, s[4:7], s28 offen offset:1024 sc1
 s_waitcnt vmcnt(4)
 v_max3_u32 v1, v194, v195, v196
 v_max_u32 v1, v1, v197
 v_cmp_eq_u32 vcc, -1, v1
 s_add_u32 s41, s41, 1
 s_cmp_gt_u32 s41, 200000
 s_cbranch_scc1 L_fail
 s_branch Lo_294
Los_297:
 buffer_load_dwordx4 v[198:201], v2, s[4:7], s27 offen offset:2048 sc1
 buffer_load_dwordx4 v[202:205], v2, s[4:7], s27 offen offset:3072 sc1
 buffer_load_dwordx4 v[206:209], v2, s[4:7], s28 offen offset:0 sc1
 buffer_load_dwordx4 v[210:213], v2, s[4:7], s28 offen offset:1024 sc1
 s_waitcnt vmcnt(3)
 v_max3_u32 v1, v198, v199, v200
 v_max_u32 v1, v1, v201
 v_cmp_eq_u32 vcc, -1, v1
 s_add_u32 s41, s41, 1
 s_cmp_gt_u32 s41, 200000
 s_cbranch_scc1 L_fail
 s_branch Lo_296
Los_299:
 buffer_load_dwordx4 v[202:205], v2, s[4:7], s27 offen offset:3072 sc1
 buffer_load_dwordx4 v[206:209], v2, s[4:7], s28 offen offset:0 sc1
 buffer_load_dwordx4 v[210:213], v2, s[4:7], s28 offen offset:1024 sc1
 s_waitcnt vmcnt(2)
 v_max3_u32 v1, v202, v203, v204
 v_max_u32 v1, v1, v205
 v_cmp_eq_u32 vcc, -1, v1
 s_add_u32 s41, s41, 1
 s_cmp_gt_u32 s41, 200000
 s_cbranch_scc1 L_fail
 s_branch Lo_298
Los_301:
 buffer_load_dwordx4 v[206:209], v2, s[4:7], s28 offen offset:0 sc1
 buffer_load_dwordx4 v[210:213], v2, s[4:7], s28 offen offset:1024 sc1
 s_waitcnt vmcnt(1)
 v_max3_u32 v1, v206, v207, v208
 v_max_u32 v1, v1, v209
 v_cmp_eq_u32 vcc, -1, v1
 s_add_u32 s41, s41, 1
 s_cmp_gt_u32 s41, 200000
 s_cbranch_scc1 L_fail
 s_branch Lo_300
Los_303:
 buffer_load_dwordx4 v[210:213], v2, s[4:7], s28 offen offset:1024 sc1
 s_waitcnt vmcnt(0)
 v_max3_u32 v1, v210, v211, v212
 v_max_u32 v1, v1, v213
 v_cmp_eq_u32 vcc, -1, v1
 s_add_u32 s41, s41, 1
 s_cmp_gt_u32 s41, 200000
 s_cbranch_scc1 L_fail
 s_branch Lo_302
L_role_qkv:
 s_sub_u32 s12, s12, 64
 v_and_b32 v1, 63, v0
 v_lshlrev_b32 v2, 4, v1
 s_load_dwordx4 s[32:35], s[0:1], 16
 s_load_dwordx2 s[36:37], s[0:1], 32
 s_cmp_ge_u32 s12, 24
 s_cselect_b32 s25, 1, 0
 s_cmp_ge_u32 s12, 48
 s_cselect_b32 s25, 2, s25
 s_mul_i32 s19, s25, 24
 s_sub_u32 s26, s12, s19
 s_lshl_b32 s26, s26, 2
 s_add_u32 s26, s26, s3
 s_waitcnt lgkmcnt(0)
 s_cmp_eq_u32 s25, 1
 s_cselect_b32 s32, s34, s32
 s_cselect_b32 s33, s35, s33
 s_cmp_eq_u32 s25, 2
 s_cselect_b32 s32, s36, s32
 s_cselect_b32 s33, s37, s33
 s_lshl_b32 s23, s26, 7
 s_mov_b32 s28, s32
 s_mov_b32 s29, s33
 s_mov_b32 s30, 7864320
 s_mov_b32 s31, 0x20000
 v_lshrrev_b32 v68, 3, v1
 v_mul_u32_u24 v68, 12288, v68
 v_and_b32 v3, 7, v1
 v_lshl_add_u32 v68, v3, 4, v68
 v_lshrrev_b32 v69, 4, v1
 v_lshlrev_b32 v69, 3, v69
 v_bfe_u32 v3, v1, 2, 2
 v_add_u32 v69, v69, v3
 v_mul_u32_u24 v69, 128, v69
 v_and_b32 v3, 3, v1
 v_lshl_add_u32 v69, v3, 3, v69
 s_mul_i32 s19, s3, 40960
 s_add_u32 s19, s19, 0
 v_add_u32 v69, s19, v69
 s_mul_i32 s19, s3, 40960
 s_add_u32 m0, s19, 0
 s_add_u32 s20, s23, 0
 buffer_load_dwordx4 v68, s[28:31], s20 offen lds
 s_add_u32 m0, s19, 1024
 s_add_u32 s20, s23, 98304
 buffer_load_dwordx4 v68, s[28:31], s20 offen lds
 s_add_u32 m0, s19, 2048
 s_add_u32 s20, s23, 196608
 buffer_load_dwordx4 v68, s[28:31], s20 offen lds
 s_add_u32 m0, s19, 3072
 s_add_u32 s20, s23, 294912
 buffer_load_dwordx4 v68, s[28:31], s20 offen lds
 s_add_u32 m0, s19, 4096
 s_add_u32 s20, s23, 393216
 buffer_load_dwordx4 v68, s[28:31], s20 offen lds
 s_add_u32 m0, s19, 5120
 s_add_u32 s20, s23, 491520
 buffer_load_dwordx4 v68, s[28:31], s20 offen lds
 s_add_u32 m0, s19, 6144
 s_add_u32 s20, s23, 589824
 buffer_load_dwordx4 v68, s[28:31], s20 offen lds
 s_add_u32 m0, s19, 7168
 s_add_u32 s20, s23, 688128
 buffer_load_dwordx4 v68, s[28:31], s20 offen lds
 s_add_u32 m0, s19, 8192
 s_add_u32 s20, s23, 786432
 buffer_load_dwordx4 v68, s[28:31], s20 offen lds
 s_add_u32 m0, s19, 9216
 s_add_u32 s20, s23, 884736
 buffer_load_dwordx4 v68, s[28:31], s20 offen lds
 s_add_u32 m0, s19, 10240
 s_add_u32 s20, s23, 983040
 buffer_load_dwordx4 v68, s[28:31], s20 offen lds
 s_add_u32 m0, s19, 11264
 s_add_u32 s20, s23, 1081344
 buffer_load_dwordx4 v68, s[28:31], s20 offen lds
 s_add_u32 m0, s19, 12288
 s_add_u32 s20, s23, 1179648
 buffer_load_dwordx4 v68, s[28:31], s20 offen lds
 s_add_u32 m0, s19, 13312
 s_add_u32 s20, s23, 1277952
 buffer_load_dwordx4 v68, s[28:31], s20 offen lds
 s_add_u32 m0, s19, 14336
 s_add_u32 s20, s23, 1376256
 buffer_load_dwordx4 v68, s[28:31], s20 offen lds
 s_add_u32 m0, s19, 15360
 s_add_u32 s20, s23, 1474560
 buffer_load_dwordx4 v68, s[28:31], s20 offen lds
 s_add_u32 m0, s19, 16384
 s_add_u32 s20, s23, 1572864
 buffer_load_dwordx4 v68, s[28:31], s20 offen lds
 s_add_u32 m0, s19, 17408
 s_add_u32 s20, s23, 1671168
 buffer_load_dwordx4 v68, s[28:31], s20 offen lds
 s_add_u32 m0, s19, 18432
 s_add_u32 s20, s23, 1769472
 buffer_load_dwordx4 v68, s[28:31], s20 offen lds
 s_add_u32 m0, s19, 19456
 s_add_u32 s20, s23, 1867776
 buffer_load_dwordx4 v68, s[28:31], s20 offen lds
 s_mul_i32 s19, s3, 40960
 s_add_u32 m0, s19, 20480
 s_add_u32 s20, s23, 1966080
 buffer_load_dwordx4 v68, s[28:31], s20 offen lds
 s_add_u32 m0, s19, 21504
 s_add_u32 s20, s23, 2064384
 buffer_load_dwordx4 v68, s[28:31], s20 offen lds
 s_add_u32 m0, s19, 22528
 s_add_u32 s20, s23, 2162688
 buffer_load_dwordx4 v68, s[28:31], s20 offen lds
 s_add_u32 m0, s19, 23552
 s_add_u32 s20, s23, 2260992
 buffer_load_dwordx4 v68, s[28:31], s20 offen lds
 s_add_u32 m0, s19, 24576
 s_add_u32 s20, s23, 2359296
 buffer_load_dwordx4 v68, s[28:31], s20 offen lds
 s_add_u32 m0, s19, 25600
 s_add_u32 s20, s23, 2457600
 buffer_load_dwordx4 v68, s[28:31], s20 offen lds
 s_add_u32 m0, s19, 26624
 s_add_u32 s20, s23, 2555904
 buffer_load_dwordx4 v68, s[28:31], s20 offen lds
 s_add_u32 m0, s19, 27648
 s_add_u32 s20, s23, 2654208
 buffer_load_dwordx4 v68, s[28:31], s20 offen lds
 s_add_u32 m0, s19, 28672
 s_add_u32 s20, s23, 2752512
 buffer_load_dwordx4 v68, s[28:31], s20 offen lds
 s_add_u32 m0, s19, 29696
 s_add_u32 s20, s23, 2850816
 buffer_load_dwordx4 v68, s[28:31], s20 offen lds
 s_add_u32 m0, s19, 30720
 s_add_u32 s20, s23, 2949120
 buffer_load_dwordx4 v68, s[28:31], s20 offen lds
 s_add_u32 m0, s19, 31744
 s_add_u32 s20, s23, 3047424
 buffer_load_dwordx4 v68, s[28:31], s20 offen lds
 s_add_u32 m0, s19, 32768
 s_add_u32 s20, s23, 3145728
 buffer_load_dwordx4 v68, s[28:31], s20 offen lds
 s_add_u32 m0, s19, 33792
 s_add_u32 s20, s23, 3244032
 buffer_load_dwordx4 v68, s[28:31], s20 offen lds
 s_add_u32 m0, s19, 34816
 s_add_u32 s20, s23, 3342336
 buffer_load_dwordx4 v68, s[28:31], s20 offen lds
 s_add_u32 m0, s19, 35840
 s_add_u32 s20, s23, 3440640
 buffer_load_dwordx4 v68, s[28:31], s20 offen lds
 s_add_u32 m0, s19, 36864
 s_add_u32 s20, s23, 3538944
 buffer_load_dwordx4 v68, s[28:31], s20 offen lds
 s_add_u32 m0, s19, 37888
 s_add_u32 s20, s23, 3637248
 buffer_load_dwordx4 v68, s[28:31], s20 offen lds
 s_add_u32 m0, s19, 38912
 s_add_u32 s20, s23, 3735552
 buffer_load_dwordx4 v68, s[28:31], s20 offen lds
 s_add_u32 m0, s19, 39936
 s_add_u32 s20, s23, 3833856
 buffer_load_dwordx4 v68, s[28:31], s20 offen lds
 s_waitcnt vmcnt(20)
 ds_read_b64_tr_b16 a[0:1], v69 offset:0
 ds_read_b64_tr_b16 a[2:3], v69 offset:512
 ds_read_b64_tr_b16 a[80:81], v69 offset:32
 ds_read_b64_tr_b16 a[82:83], v69 offset:544
 ds_read_b64_tr_b16 a[160:161], v69 offset:64
 ds_read_b64_tr_b16 a[162:163], v69 offset:576
 ds_read_b64_tr_b16 a[240:241], v69 offset:96
 ds_read_b64_tr_b16 a[242:243], v69 offset:608
 ds_read_b64_tr_b16 a[4:5], v69 offset:4096
 ds_read_b64_tr_b16 a[6:7], v69 offset:4608
 ds_read_b64_tr_b16 a[84:85], v69 offset:4128
 ds_read_b64_tr_b16 a[86:87], v69 offset:4640
 ds_read_b64_tr_b16 a[164:165], v69 offset:4160
 ds_read_b64_tr_b16 a[166:167], v69 offset:4672
 ds_read_b64_tr_b16 a[244:245], v69 offset:4192
 ds_read_b64_tr_b16 a[246:247], v69 offset:4704
 ds_read_b64_tr_b16 a[8:9], v69 offset:8192
 ds_read_b64_tr_b16 a[10:11], v69 offset:8704
 ds_read_b64_tr_b16 a[88:89], v69 offset:8224
 ds_read_b64_tr_b16 a[90:91], v69 offset:8736
 ds_read_b64_tr_b16 a[168:169], v69 offset:8256
 ds_read_b64_tr_b16 a[170:171], v69 offset:8768
 ds_read_b64_tr_b16 a[248:249], v69 offset:8288
 ds_read_b64_tr_b16 a[250:251], v69 offset:8800
 ds_read_b64_tr_b16 a[12:13], v69 offset:12288
 ds_read_b64_tr_b16 a[14:15], v69 offset:12800
 ds_read_b64_tr_b16 a[92:93], v69 offset:12320
 ds_read_b64_tr_b16 a[94:95], v69 offset:12832
 ds_read_b64_tr_b16 a[172:173], v69 offset:12352
 ds_read_b64_tr_b16 a[174:175], v69 offset:12864
 ds_read_b64_tr_b16 a[252:253], v69 offset:12384
 ds_read_b64_tr_b16 a[254:255], v69 offset:12896
 ds_read_b64_tr_b16 a[16:17], v69 offset:16384
 ds_read_b64_tr_b16 a[18:19], v69 offset:16896
 ds_read_b64_tr_b16 a[96:97], v69 offset:16416
 ds_read_b64_tr_b16 a[98:99], v69 offset:16928
 ds_read_b64_tr_b16 a[176:177], v69 offset:16448
 ds_read_b64_tr_b16 a[178:179], v69 offset:16960
 ds_read_b64_tr_b16 v[4:5], v69 offset:16480
 ds_read_b64_tr_b16 v[6:7], v69 offset:16992
 s_waitcnt lgkmcnt(0)
 s_mul_i32 s19, s3, 40960
 s_add_u32 m0, s19, 0
 s_add_u32 s20, s23, 3932160
 buffer_load_dwordx4 v68, s[28:31], s20 offen lds
 s_add_u32 m0, s19, 1024
 s_add_u32 s20, s23, 4030464
 buffer_load_dwordx4 v68, s[28:31], s20 offen lds
 s_add_u32 m0, s19, 2048
 s_add_u32 s20, s23, 4128768
 buffer_load_dwordx4 v68, s[28:31], s20 offen lds
 s_add_u32 m0, s19, 3072
 s_add_u32 s20, s23, 4227072
 buffer_load_dwordx4 v68, s[28:31], s20 offen lds
 s_add_u32 m0, s19, 4096
 s_add_u32 s20, s23, 4325376
 buffer_load_dwordx4 v68, s[28:31], s20 offen lds
 s_add_u32 m0, s19, 5120
 s_add_u32 s20, s23, 4423680
 buffer_load_dwordx4 v68, s[28:31], s20 offen lds
 s_add_u32 m0, s19, 6144
 s_add_u32 s20, s23, 4521984
 buffer_load_dwordx4 v68, s[28:31], s20 offen lds
 s_add_u32 m0, s19, 7168
 s_add_u32 s20, s23, 4620288
 buffer_load_dwordx4 v68, s[28:31], s20 offen lds
 s_add_u32 m0, s19, 8192
 s_add_u32 s20, s23, 4718592
 buffer_load_dwordx4 v68, s[28:31], s20 offen lds
 s_add_u32 m0, s19, 9216
 s_add_u32 s20, s23, 4816896
 buffer_load_dwordx4 v68, s[28:31], s20 offen lds
 s_add_u32 m0, s19, 10240
 s_add_u32 s20, s23, 4915200
 buffer_load_dwordx4 v68, s[28:31], s20 offen lds
 s_add_u32 m0, s19, 11264
 s_add_u32 s20, s23, 5013504
 buffer_load_dwordx4 v68, s[28:31], s20 offen lds
 s_add_u32 m0, s19, 12288
 s_add_u32 s20, s23, 5111808
 buffer_load_dwordx4 v68, s[28:31], s20 offen lds
 s_add_u32 m0, s19, 13312
 s_add_u32 s20, s23, 5210112
 buffer_load_dwordx4 v68, s[28:31], s20 offen lds
 s_add_u32 m0, s19, 14336
 s_add_u32 s20, s23, 5308416
 buffer_load_dwordx4 v68, s[28:31], s20 offen lds
 s_add_u32 m0, s19, 15360
 s_add_u32 s20, s23, 5406720
 buffer_load_dwordx4 v68, s[28:31], s20 offen lds
 s_add_u32 m0, s19, 16384
 s_add_u32 s20, s23, 5505024
 buffer_load_dwordx4 v68, s[28:31], s20 offen lds
 s_add_u32 m0, s19, 17408
 s_add_u32 s20, s23, 5603328
 buffer_load_dwordx4 v68, s[28:31], s20 offen lds
 s_add_u32 m0, s19, 18432
 s_add_u32 s20, s23, 5701632
 buffer_load_dwordx4 v68, s[28:31], s20 offen lds
 s_add_u32 m0, s19, 19456
 s_add_u32 s20, s23, 5799936
 buffer_load_dwordx4 v68, s[28:31], s20 offen lds
 s_waitcnt vmcnt(20)
 ds_read_b64_tr_b16 a[20:21], v69 offset:20480
 ds_read_b64_tr_b16 a[22:23], v69 offset:20992
 ds_read_b64_tr_b16 a[100:101], v69 offset:20512
 ds_read_b64_tr_b16 a[102:103], v69 offset:21024
 ds_read_b64_tr_b16 a[180:181], v69 offset:20544
 ds_read_b64_tr_b16 a[182:183], v69 offset:21056
 ds_read_b64_tr_b16 v[8:9], v69 offset:20576
 ds_read_b64_tr_b16 v[10:11], v69 offset:21088
 ds_read_b64_tr_b16 a[24:25], v69 offset:24576
 ds_read_b64_tr_b16 a[26:27], v69 offset:25088
 ds_read_b64_tr_b16 a[104:105], v69 offset:24608
 ds_read_b64_tr_b16 a[106:107], v69 offset:25120
 ds_read_b64_tr_b16 a[184:185], v69 offset:24640
 ds_read_b64_tr_b16 a[186:187], v69 offset:25152
 ds_read_b64_tr_b16 v[12:13], v69 offset:24672
 ds_read_b64_tr_b16 v[14:15], v69 offset:25184
 ds_read_b64_tr_b16 a[28:29], v69 offset:28672
 ds_read_b64_tr_b16 a[30:31], v69 offset:29184
 ds_read_b64_tr_b16 a[108:109], v69 offset:28704
 ds_read_b64_tr_b16 a[110:111], v69 offset:29216
 ds_read_b64_tr_b16 a[188:189], v69 offset:28736
 ds_read_b64_tr_b16 a[190:191], v69 offset:29248
 ds_read_b64_tr_b16 v[16:17], v69 offset:28768
 ds_read_b64_tr_b16 v[18:19], v69 offset:29280
 ds_read_b64_tr_b16 a[32:33], v69 offset:32768
 ds_read_b64_tr_b16 a[34:35], v69 offset:33280
 ds_read_b64_tr_b16 a[112:113], v69 offset:32800
 ds_read_b64_tr_b16 a[114:115], v69 offset:33312
 ds_read_b64_tr_b16 a[192:193], v69 offset:32832
 ds_read_b64_tr_b16 a[194:195], v69 offset:33344
 ds_read_b64_tr_b16 v[20:21], v69 offset:32864
 ds_read_b64_tr_b16 v[22:23], v69 offset:33376
 ds_read_b64_tr_b16 a[36:37], v69 offset:36864
 ds_read_b64_tr_b16 a[38:39], v69 offset:37376
 ds_read_b64_tr_b16 a[116:117], v69 offset:36896
 ds_read_b64_tr_b16 a[118:119], v69 offset:37408
 ds_read_b64_tr_b16 a[196:197], v69 offset:36928
 ds_read_b64_tr_b16 a[198:199], v69 offset:37440
 ds_read_b64_tr_b16 v[24:25], v69 offset:36960
 ds_read_b64_tr_b16 v[26:27], v69 offset:37472
 s_waitcnt lgkmcnt(0)
 s_mul_i32 s19, s3, 40960
 s_add_u32 m0, s19, 20480
 s_add_u32 s20, s23, 5898240
 buffer_load_dwordx4 v68, s[28:31], s20 offen lds
 s_add_u32 m0, s19, 21504
 s_add_u32 s20, s23, 5996544
 buffer_load_dwordx4 v68, s[28:31], s20 offen lds
 s_add_u32 m0, s19, 22528
 s_add_u32 s20, s23, 6094848
 buffer_load_dwordx4 v68, s[28:31], s20 offen lds
 s_add_u32 m0, s19, 23552
 s_add_u32 s20, s23, 6193152
 buffer_load_dwordx4 v68, s[28:31], s20 offen lds
 s_add_u32 m0, s19, 24576
 s_add_u32 s20, s23, 6291456
 buffer_load_dwordx4 v68, s[28:31], s20 offen lds
 s_add_u32 m0, s19, 25600
 s_add_u32 s20, s23, 6389760
 buffer_load_dwordx4 v68, s[28:31], s20 offen lds
 s_add_u32 m0, s19, 26624
 s_add_u32 s20, s23, 6488064
 buffer_load_dwordx4 v68, s[28:31], s20 offen lds
 s_add_u32 m0, s19, 27648
 s_add_u32 s20, s23, 6586368
 buffer_load_dwordx4 v68, s[28:31], s20 offen lds
 s_add_u32 m0, s19, 28672
 s_add_u32 s20, s23, 6684672
 buffer_load_dwordx4 v68, s[28:31], s20 offen lds
 s_add_u32 m0, s19, 29696
 s_add_u32 s20, s23, 6782976
 buffer_load_dwordx4 v68, s[28:31], s20 offen lds
 s_add_u32 m0, s19, 30720
 s_add_u32 s20, s23, 6881280
 buffer_load_dwordx4 v68, s[28:31], s20 offen lds
 s_add_u32 m0, s19, 31744
 s_add_u32 s20, s23, 6979584
 buffer_load_dwordx4 v68, s[28:31], s20 offen lds
 s_add_u32 m0, s19, 32768
 s_add_u32 s20, s23, 7077888
 buffer_load_dwordx4 v68, s[28:31], s20 offen lds
 s_add_u32 m0, s19, 33792
 s_add_u32 s20, s23, 7176192
 buffer_load_dwordx4 v68, s[28:31], s20 offen lds
 s_add_u32 m0, s19, 34816
 s_add_u32 s20, s23, 7274496
 buffer_load_dwordx4 v68, s[28:31], s20 offen lds
 s_add_u32 m0, s19, 35840
 s_add_u32 s20, s23, 7372800
 buffer_load_dwordx4 v68, s[28:31], s20 offen lds
 s_add_u32 m0, s19, 36864
 s_add_u32 s20, s23, 7471104
 buffer_load_dwordx4 v68, s[28:31], s20 offen lds
 s_add_u32 m0, s19, 37888
 s_add_u32 s20, s23, 7569408
 buffer_load_dwordx4 v68, s[28:31], s20 offen lds
 s_add_u32 m0, s19, 38912
 s_add_u32 s20, s23, 7667712
 buffer_load_dwordx4 v68, s[28:31], s20 offen lds
 s_add_u32 m0, s19, 39936
 s_add_u32 s20, s23, 7766016
 buffer_load_dwordx4 v68, s[28:31], s20 offen lds
 s_waitcnt vmcnt(20)
 ds_read_b64_tr_b16 a[40:41], v69 offset:0
 ds_read_b64_tr_b16 a[42:43], v69 offset:512
 ds_read_b64_tr_b16 a[120:121], v69 offset:32
 ds_read_b64_tr_b16 a[122:123], v69 offset:544
 ds_read_b64_tr_b16 a[200:201], v69 offset:64
 ds_read_b64_tr_b16 a[202:203], v69 offset:576
 ds_read_b64_tr_b16 v[28:29], v69 offset:96
 ds_read_b64_tr_b16 v[30:31], v69 offset:608
 ds_read_b64_tr_b16 a[44:45], v69 offset:4096
 ds_read_b64_tr_b16 a[46:47], v69 offset:4608
 ds_read_b64_tr_b16 a[124:125], v69 offset:4128
 ds_read_b64_tr_b16 a[126:127], v69 offset:4640
 ds_read_b64_tr_b16 a[204:205], v69 offset:4160
 ds_read_b64_tr_b16 a[206:207], v69 offset:4672
 ds_read_b64_tr_b16 v[32:33], v69 offset:4192
 ds_read_b64_tr_b16 v[34:35], v69 offset:4704
 ds_read_b64_tr_b16 a[48:49], v69 offset:8192
 ds_read_b64_tr_b16 a[50:51], v69 offset:8704
 ds_read_b64_tr_b16 a[128:129], v69 offset:8224
 ds_read_b64_tr_b16 a[130:131], v69 offset:8736
 ds_read_b64_tr_b16 a[208:209], v69 offset:8256
 ds_read_b64_tr_b16 a[210:211], v69 offset:8768
 ds_read_b64_tr_b16 v[36:37], v69 offset:8288
 ds_read_b64_tr_b16 v[38:39], v69 offset:8800
 ds_read_b64_tr_b16 a[52:53], v69 offset:12288
 ds_read_b64_tr_b16 a[54:55], v69 offset:12800
 ds_read_b64_tr_b16 a[132:133], v69 offset:12320
 ds_read_b64_tr_b16 a[134:135], v69 offset:12832
 ds_read_b64_tr_b16 a[212:213], v69 offset:12352
 ds_read_b64_tr_b16 a[214:215], v69 offset:12864
 ds_read_b64_tr_b16 v[40:41], v69 offset:12384
 ds_read_b64_tr_b16 v[42:43], v69 offset:12896
 ds_read_b64_tr_b16 a[56:57], v69 offset:16384
 ds_read_b64_tr_b16 a[58:59], v69 offset:16896
 ds_read_b64_tr_b16 a[136:137], v69 offset:16416
 ds_read_b64_tr_b16 a[138:139], v69 offset:16928
 ds_read_b64_tr_b16 a[216:217], v69 offset:16448
 ds_read_b64_tr_b16 a[218:219], v69 offset:16960
 ds_read_b64_tr_b16 v[44:45], v69 offset:16480
 ds_read_b64_tr_b16 v[46:47], v69 offset:16992
 s_waitcnt lgkmcnt(0)
 s_waitcnt vmcnt(0)
 ds_read_b64_tr_b16 a[60:61], v69 offset:20480
 ds_read_b64_tr_b16 a[62:63], v69 offset:20992
 ds_read_b64_tr_b16 a[140:141], v69 offset:20512
 ds_read_b64_tr_b16 a[142:143], v69 offset:21024
 ds_read_b64_tr_b16 a[220:221], v69 offset:20544
 ds_read_b64_tr_b16 a[222:223], v69 offset:21056
 ds_read_b64_tr_b16 v[48:49], v69 offset:20576
 ds_read_b64_tr_b16 v[50:51], v69 offset:21088
 ds_read_b64_tr_b16 a[64:65], v69 offset:24576
 ds_read_b64_tr_b16 a[66:67], v69 offset:25088
 ds_read_b64_tr_b16 a[144:145], v69 offset:24608
 ds_read_b64_tr_b16 a[146:147], v69 offset:25120
 ds_read_b64_tr_b16 a[224:225], v69 offset:24640
 ds_read_b64_tr_b16 a[226:227], v69 offset:25152
 ds_read_b64_tr_b16 v[52:53], v69 offset:24672
 ds_read_b64_tr_b16 v[54:55], v69 offset:25184
 ds_read_b64_tr_b16 a[68:69], v69 offset:28672
 ds_read_b64_tr_b16 a[70:71], v69 offset:29184
 ds_read_b64_tr_b16 a[148:149], v69 offset:28704
 ds_read_b64_tr_b16 a[150:151], v69 offset:29216
 ds_read_b64_tr_b16 a[228:229], v69 offset:28736
 ds_read_b64_tr_b16 a[230:231], v69 offset:29248
 ds_read_b64_tr_b16 v[56:57], v69 offset:28768
 ds_read_b64_tr_b16 v[58:59], v69 offset:29280
 ds_read_b64_tr_b16 a[72:73], v69 offset:32768
 ds_read_b64_tr_b16 a[74:75], v69 offset:33280
 ds_read_b64_tr_b16 a[152:153], v69 offset:32800
 ds_read_b64_tr_b16 a[154:155], v69 offset:33312
 ds_read_b64_tr_b16 a[232:233], v69 offset:32832
 ds_read_b64_tr_b16 a[234:235], v69 offset:33344
 ds_read_b64_tr_b16 v[60:61], v69 offset:32864
 ds_read_b64_tr_b16 v[62:63], v69 offset:33376
 ds_read_b64_tr_b16 a[76:77], v69 offset:36864
 ds_read_b64_tr_b16 a[78:79], v69 offset:37376
 ds_read_b64_tr_b16 a[156:157], v69 offset:36896
 ds_read_b64_tr_b16 a[158:159], v69 offset:37408
 ds_read_b64_tr_b16 a[236:237], v69 offset:36928
 ds_read_b64_tr_b16 a[238:239], v69 offset:37440
 ds_read_b64_tr_b16 v[64:65], v69 offset:36960
 ds_read_b64_tr_b16 v[66:67], v69 offset:37472
 s_waitcnt lgkmcnt(0)
 s_barrier
 s_cmp_eq_u32 s13, 1
 s_cbranch_scc1 Lverok_306
 s_mov_b32 s18, 0
Lver_305:
 s_add_u32 s18, s18, 1
 s_cmp_gt_u32 s18, 200000
 s_cbranch_scc1 L_fail
 v_and_b32 v254, 7, v0
 v_lshlrev_b32 v254, 2, v254
 buffer_load_dword v255, v254, s[8:11], 0 offen sc1
 s_waitcnt vmcnt(0)
 v_cmp_eq_u32 vcc, 32, v255
 s_nop 0
 s_cmp_eq_u64 vcc, -1
 s_cbranch_scc1 Lverok_306
 s_mov_b32 s17, 0
 v_readlane_b32 s14, v255, 0
 s_nop 0
 s_add_u32 s17, s17, s14
 v_readlane_b32 s14, v255, 1
 s_nop 0
 s_add_u32 s17, s17, s14
 v_readlane_b32 s14, v255, 2
 s_nop 0
 s_add_u32 s17, s17, s14
 v_readlane_b32 s14, v255, 3
 s_nop 0
 s_add_u32 s17, s17, s14
 v_readlane_b32 s14, v255, 4
 s_nop 0
 s_add_u32 s17, s17, s14
 v_readlane_b32 s14, v255, 5
 s_nop 0
 s_add_u32 s17, s17, s14
 v_readlane_b32 s14, v255, 6
 s_nop 0
 s_add_u32 s17, s17, s14
 v_readlane_b32 s14, v255, 7
 s_nop 0
 s_add_u32 s17, s17, s14
 s_cmp_eq_u32 s17, 256
 s_cbranch_scc1 L_fallback
 s_branch Lver_305
Lverok_306:
 v_lshrrev_b32 v70, 3, v1
 s_lshl_b32 s19, s3, 3
 v_add_u32 v70, s19, v70
 v_bfe_u32 v71, v70, 1, 3
 v_mul_u32_u24 v70, 1280, v70
 v_and_b32 v3, 7, v1
 v_xor_b32 v3, v3, v71
 v_lshl_add_u32 v3, v3, 4, v70
 v_and_b32 v70, 15, v1
 v_bfe_u32 v71, v1, 1, 3
 v_lshrrev_b32 v68, 4, v1
 v_add_u32 v69, 4, v68
 v_xor_b32 v68, v68, v71
 v_xor_b32 v69, v69, v71
 v_lshlrev_b32 v70, 7, v70
 v_lshl_add_u32 v68, v68, 4, v70
 v_lshl_add_u32 v69, v69, 4, v70
 v_and_b32 v73, 15, v1
 v_lshlrev_b32 v73, 2, v73
 v_add_u32 v73, 10240, v73
 s_lshl_b32 s19, s26, 12
 s_mov_b32 s20, 33734656
 s_cmp_eq_u32 s25, 1
 s_cselect_b32 s46, 58900480, s20
 s_cselect_b32 s47, 109232128, s20
 s_cmp_eq_u32 s25, 2
 s_cselect_b32 s46, 84066304, s46
 s_cselect_b32 s47, 134397952, s47
 s_add_u32 s46, s46, s19
 s_add_u32 s47, s47, s19
 s_lshl_b32 s48, s12, 2
 s_add_u32 s48, s48, s3
 s_lshl_b32 s48, s48, 2
 s_add_u32 s48, s48, 0
 s_mov_b32 s27, 0
 s_mov_b32 s44, 0
 s_mov_b32 s45, 0
 s_mov_b32 s42, 0
 s_mov_b32 s43, 0
 s_mov_b32 s52, 0
 s_mov_b32 s51, 4092
 s_cmp_eq_u32 s25, 2
 s_cbranch_scc1 L_qkv_v
Lqt_307:
 s_mov_b32 s40, s42
 s_mov_b32 s41, s43
 s_cmp_eq_u32 s44, 1
 s_cbranch_scc1 Lqa_308
 s_waitcnt vmcnt(0)
 s_mov_b64 exec, 1
 v_mov_b32 v74, s52
 buffer_store_dword v74, off, s[4:7], s51 sc1
 s_mov_b64 exec, -1
 s_cmp_eq_u32 s40, 0
 s_cbranch_scc1 Lqs_312
 s_add_u32 s22, s41, 1
 s_mov_b32 s24, 0
Lw_313:
 s_add_u32 s24, s24, 1
 s_cmp_gt_u32 s24, 200000
 s_cbranch_scc1 L_fail
 buffer_load_dword v72, v73, s[4:7], 0 offen sc1
 s_waitcnt vmcnt(0)
 v_cmp_le_u32 vcc, s22, v72
 s_nop 0
 s_cmp_eq_u64 vcc, -1
 s_cbranch_scc0 Lw_313
Lqs_312:
 s_mul_i32 s49, s41, 40960
 s_cmp_eq_u32 s40, 0
 s_cselect_b32 s19, 0, 2621440
 s_add_u32 s49, s49, s19
 s_add_u32 s49, s49, 184729600
 s_lshl_b32 s50, s3, 10
 s_add_u32 s50, s50, s45
 s_add_u32 m0, s50, 0
 s_nop 0
 buffer_load_dwordx4 v3, s[4:7], s49 offen offset:0 sc1 lds
 s_add_u32 m0, s50, 3968
 s_nop 0
 buffer_load_dwordx4 v3, s[4:7], s49 offen offset:128 sc1 lds
 s_add_u32 m0, s50, 7936
 s_nop 0
 buffer_load_dwordx4 v3, s[4:7], s49 offen offset:256 sc1 lds
 s_add_u32 m0, s50, 11904
 s_nop 0
 buffer_load_dwordx4 v3, s[4:7], s49 offen offset:384 sc1 lds
 s_add_u32 m0, s50, 15872
 s_nop 0
 buffer_load_dwordx4 v3, s[4:7], s49 offen offset:512 sc1 lds
 s_add_u32 m0, s50, 19840
 s_nop 0
 buffer_load_dwordx4 v3, s[4:7], s49 offen offset:640 sc1 lds
 s_add_u32 m0, s50, 23808
 s_nop 0
 buffer_load_dwordx4 v3, s[4:7], s49 offen offset:768 sc1 lds
 s_add_u32 m0, s50, 27776
 s_nop 0
 buffer_load_dwordx4 v3, s[4:7], s49 offen offset:896 sc1 lds
 s_add_u32 m0, s50, 31744
 s_nop 0
 buffer_load_dwordx4 v3, s[4:7], s49 offen offset:1024 sc1 lds
 s_add_u32 m0, s50, 35712
 s_nop 0
 buffer_load_dwordx4 v3, s[4:7], s49 offen offset:1152 sc1 lds
Lqa_308:
 buffer_load_dword v72, v73, s[4:7], 0 offen sc1
 v_add_u32 v70, s45, v68
 v_add_u32 v71, s45, v69
 s_add_u32 s27, s27, 1
 s_sub_u32 s19, s27, 12
 s_lshr_b32 s20, s19, 1
 s_add_u32 s21, s20, 12
 s_bitcmp1_b32 s19, 0
 s_cselect_b32 s43, s21, s20
 s_cselect_b32 s42, 0, 1
 s_cmp_lt_u32 s27, 12
 s_cselect_b32 s43, s27, s43
 s_cselect_b32 s42, 0, s42
 s_sub_u32 s19, s27, 64
 s_cmp_ge_u32 s27, 116
 s_cselect_b32 s43, s19, s43
 s_cselect_b32 s42, 1, s42
 s_waitcnt vmcnt(9)
 s_barrier
 ds_read_b128 v[108:111], v70 offset:0
 ds_read_b128 v[112:115], v70 offset:2048
 ds_read_b128 v[116:119], v71 offset:0
 ds_read_b128 v[120:123], v71 offset:2048
 ds_read_b128 v[124:127], v70 offset:4096
 ds_read_b128 v[128:131], v70 offset:6144
 s_waitcnt lgkmcnt(5)
 v_mfma_f32_16x16x32_bf16 v[76:79], a[0:3], v[108:111], 0
 v_mfma_f32_16x16x32_bf16 v[84:87], a[80:83], v[108:111], 0
 v_mfma_f32_16x16x32_bf16 v[92:95], a[160:163], v[108:111], 0
 v_mfma_f32_16x16x32_bf16 v[100:103], a[240:243], v[108:111], 0
 s_waitcnt lgkmcnt(4)
 v_mfma_f32_16x16x32_bf16 v[80:83], a[0:3], v[112:115], 0
 v_mfma_f32_16x16x32_bf16 v[88:91], a[80:83], v[112:115], 0
 v_mfma_f32_16x16x32_bf16 v[96:99], a[160:163], v[112:115], 0
 v_mfma_f32_16x16x32_bf16 v[104:107], a[240:243], v[112:115], 0
 ds_read_b128 v[108:111], v71 offset:4096
 ds_read_b128 v[112:115], v71 offset:6144
 s_waitcnt lgkmcnt(4)
 v_mfma_f32_16x16x32_bf16 v[76:79], a[4:7], v[116:119], v[76:79]
 v_mfma_f32_16x16x32_bf16 v[84:87], a[84:87], v[116:119], v[84:87]
 v_mfma_f32_16x16x32_bf16 v[92:95], a[164:167], v[116:119], v[92:95]
 v_mfma_f32_16x16x32_bf16 v[100:103], a[244:247], v[116:119], v[100:103]
 v_mfma_f32_16x16x32_bf16 v[80:83], a[4:7], v[120:123], v[80:83]
 v_mfma_f32_16x16x32_bf16 v[88:91], a[84:87], v[120:123], v[88:91]
 v_mfma_f32_16x16x32_bf16 v[96:99], a[164:167], v[120:123], v[96:99]
 v_mfma_f32_16x16x32_bf16 v[104:107], a[244:247], v[120:123], v[104:107]
 s_waitcnt vmcnt(7)
 s_barrier
 ds_read_b128 v[116:119], v70 offset:8192
 ds_read_b128 v[120:123], v70 offset:10240
 s_waitcnt lgkmcnt(4)
 v_mfma_f32_16x16x32_bf16 v[76:79], a[8:11], v[124:127], v[76:79]
 v_mfma_f32_16x16x32_bf16 v[84:87], a[88:91], v[124:127], v[84:87]
 v_mfma_f32_16x16x32_bf16 v[92:95], a[168:171], v[124:127], v[92:95]
 v_mfma_f32_16x16x32_bf16 v[100:103], a[248:251], v[124:127], v[100:103]
 v_mfma_f32_16x16x32_bf16 v[80:83], a[8:11], v[128:131], v[80:83]
 v_mfma_f32_16x16x32_bf16 v[88:91], a[88:91], v[128:131], v[88:91]
 v_mfma_f32_16x16x32_bf16 v[96:99], a[168:171], v[128:131], v[96:99]
 v_mfma_f32_16x16x32_bf16 v[104:107], a[248:251], v[128:131], v[104:107]
 ds_read_b128 v[124:127], v71 offset:8192
 ds_read_b128 v[128:131], v71 offset:10240
 s_waitcnt lgkmcnt(4)
 v_mfma_f32_16x16x32_bf16 v[76:79], a[12:15], v[108:111], v[76:79]
 v_mfma_f32_16x16x32_bf16 v[84:87], a[92:95], v[108:111], v[84:87]
 v_mfma_f32_16x16x32_bf16 v[92:95], a[172:175], v[108:111], v[92:95]
 v_mfma_f32_16x16x32_bf16 v[100:103], a[252:255], v[108:111], v[100:103]
 v_mfma_f32_16x16x32_bf16 v[80:83], a[12:15], v[112:115], v[80:83]
 v_mfma_f32_16x16x32_bf16 v[88:91], a[92:95], v[112:115], v[88:91]
 v_mfma_f32_16x16x32_bf16 v[96:99], a[172:175], v[112:115], v[96:99]
 v_mfma_f32_16x16x32_bf16 v[104:107], a[252:255], v[112:115], v[104:107]
 ds_read_b128 v[108:111], v70 offset:12288
 ds_read_b128 v[112:115], v70 offset:14336
 s_waitcnt lgkmcnt(4)
 v_mfma_f32_16x16x32_bf16 v[76:79], a[16:19], v[116:119], v[76:79]
 v_mfma_f32_16x16x32_bf16 v[84:87], a[96:99], v[116:119], v[84:87]
 v_mfma_f32_16x16x32_bf16 v[92:95], a[176:179], v[116:119], v[92:95]
 v_mfma_f32_16x16x32_bf16 v[100:103], v[4:7], v[116:119], v[100:103]
 v_mfma_f32_16x16x32_bf16 v[80:83], a[16:19], v[120:123], v[80:83]
 v_mfma_f32_16x16x32_bf16 v[88:91], a[96:99], v[120:123], v[88:91]
 v_mfma_f32_16x16x32_bf16 v[96:99], a[176:179], v[120:123], v[96:99]
 v_mfma_f32_16x16x32_bf16 v[104:107], v[4:7], v[120:123], v[104:107]
 ds_read_b128 v[116:119], v71 offset:12288
 ds_read_b128 v[120:123], v71 offset:14336
 s_waitcnt lgkmcnt(4)
 v_mfma_f32_16x16x32_bf16 v[76:79], a[20:23], v[124:127], v[76:79]
 v_mfma_f32_16x16x32_bf16 v[84:87], a[100:103], v[124:127], v[84:87]
 v_mfma_f32_16x16x32_bf16 v[92:95], a[180:183], v[124:127], v[92:95]
 v_mfma_f32_16x16x32_bf16 v[100:103], v[8:11], v[124:127], v[100:103]
 v_mfma_f32_16x16x32_bf16 v[80:83], a[20:23], v[128:131], v[80:83]
 v_mfma_f32_16x16x32_bf16 v[88:91], a[100:103], v[128:131], v[88:91]
 v_mfma_f32_16x16x32_bf16 v[96:99], a[180:183], v[128:131], v[96:99]
 v_mfma_f32_16x16x32_bf16 v[104:107], v[8:11], v[128:131], v[104:107]
 s_cmp_eq_u32 s44, 1
 s_cbranch_scc0 Lqn_309
 s_waitcnt vmcnt(1)
 s_mov_b64 exec, 1
 v_mov_b32 v74, s52
 buffer_store_dword v74, off, s[4:7], s51 sc1
 s_mov_b64 exec, -1
Lqn_309:
 s_waitcnt vmcnt(5)
 s_barrier
 ds_read_b128 v[124:127], v70 offset:16384
 ds_read_b128 v[128:131], v70 offset:18432
 s_waitcnt lgkmcnt(4)
 v_mfma_f32_16x16x32_bf16 v[76:79], a[24:27], v[108:111], v[76:79]
 v_mfma_f32_16x16x32_bf16 v[84:87], a[104:107], v[108:111], v[84:87]
 v_mfma_f32_16x16x32_bf16 v[92:95], a[184:187], v[108:111], v[92:95]
 v_mfma_f32_16x16x32_bf16 v[100:103], v[12:15], v[108:111], v[100:103]
 v_mfma_f32_16x16x32_bf16 v[80:83], a[24:27], v[112:115], v[80:83]
 v_mfma_f32_16x16x32_bf16 v[88:91], a[104:107], v[112:115], v[88:91]
 v_mfma_f32_16x16x32_bf16 v[96:99], a[184:187], v[112:115], v[96:99]
 v_mfma_f32_16x16x32_bf16 v[104:107], v[12:15], v[112:115], v[104:107]
 ds_read_b128 v[108:111], v71 offset:16384
 ds_read_b128 v[112:115], v71 offset:18432
 s_waitcnt lgkmcnt(4)
 v_mfma_f32_16x16x32_bf16 v[76:79], a[28:31], v[116:119], v[76:79]
 v_mfma_f32_16x16x32_bf16 v[84:87], a[108:111], v[116:119], v[84:87]
 v_mfma_f32_16x16x32_bf16 v[92:95], a[188:191], v[116:119], v[92:95]
 v_mfma_f32_16x16x32_bf16 v[100:103], v[16:19], v[116:119], v[100:103]
 v_mfma_f32_16x16x32_bf16 v[80:83], a[28:31], v[120:123], v[80:83]
 v_mfma_f32_16x16x32_bf16 v[88:91], a[108:111], v[120:123], v[88:91]
 v_mfma_f32_16x16x32_bf16 v[96:99], a[188:191], v[120:123], v[96:99]
 v_mfma_f32_16x16x32_bf16 v[104:107], v[16:19], v[120:123], v[104:107]
 ds_read_b128 v[116:119], v70 offset:20480
 ds_read_b128 v[120:123], v70 offset:22528
 s_waitcnt lgkmcnt(4)
 v_mfma_f32_16x16x32_bf16 v[76:79], a[32:35], v[124:127], v[76:79]
 v_mfma_f32_16x16x32_bf16 v[84:87], a[112:115], v[124:127], v[84:87]
 v_mfma_f32_16x16x32_bf16 v[92:95], a[192:195], v[124:127], v[92:95]
 v_mfma_f32_16x16x32_bf16 v[100:103], v[20:23], v[124:127], v[100:103]
 v_mfma_f32_16x16x32_bf16 v[80:83], a[32:35], v[128:131], v[80:83]
 v_mfma_f32_16x16x32_bf16 v[88:91], a[112:115], v[128:131], v[88:91]
 v_mfma_f32_16x16x32_bf16 v[96:99], a[192:195], v[128:131], v[96:99]
 v_mfma_f32_16x16x32_bf16 v[104:107], v[20:23], v[128:131], v[104:107]
 ds_read_b128 v[124:127], v71 offset:20480
 ds_read_b128 v[128:131], v71 offset:22528
 s_waitcnt lgkmcnt(4)
 v_mfma_f32_16x16x32_bf16 v[76:79], a[36:39], v[108:111], v[76:79]
 v_mfma_f32_16x16x32_bf16 v[84:87], a[116:119], v[108:111], v[84:87]
 v_mfma_f32_16x16x32_bf16 v[92:95], a[196:199], v[108:111], v[92:95]
 v_mfma_f32_16x16x32_bf16 v[100:103], v[24:27], v[108:111], v[100:103]
 v_mfma_f32_16x16x32_bf16 v[80:83], a[36:39], v[112:115], v[80:83]
 v_mfma_f32_16x16x32_bf16 v[88:91], a[116:119], v[112:115], v[88:91]
 v_mfma_f32_16x16x32_bf16 v[96:99], a[196:199], v[112:115], v[96:99]
 v_mfma_f32_16x16x32_bf16 v[104:107], v[24:27], v[112:115], v[104:107]
 s_waitcnt vmcnt(3)
 s_barrier
 ds_read_b128 v[108:111], v70 offset:24576
 ds_read_b128 v[112:115], v70 offset:26624
 s_waitcnt lgkmcnt(4)
 v_mfma_f32_16x16x32_bf16 v[76:79], a[40:43], v[116:119], v[76:79]
 v_mfma_f32_16x16x32_bf16 v[84:87], a[120:123], v[116:119], v[84:87]
 v_mfma_f32_16x16x32_bf16 v[92:95], a[200:203], v[116:119], v[92:95]
 v_mfma_f32_16x16x32_bf16 v[100:103], v[28:31], v[116:119], v[100:103]
 v_mfma_f32_16x16x32_bf16 v[80:83], a[40:43], v[120:123], v[80:83]
 v_mfma_f32_16x16x32_bf16 v[88:91], a[120:123], v[120:123], v[88:91]
 v_mfma_f32_16x16x32_bf16 v[96:99], a[200:203], v[120:123], v[96:99]
 v_mfma_f32_16x16x32_bf16 v[104:107], v[28:31], v[120:123], v[104:107]
 ds_read_b128 v[116:119], v71 offset:24576
 ds_read_b128 v[120:123], v71 offset:26624
 s_waitcnt lgkmcnt(4)
 v_mfma_f32_16x16x32_bf16 v[76:79], a[44:47], v[124:127], v[76:79]
 v_mfma_f32_16x16x32_bf16 v[84:87], a[124:127], v[124:127], v[84:87]
 v_mfma_f32_16x16x32_bf16 v[92:95], a[204:207], v[124:127], v[92:95]
 v_mfma_f32_16x16x32_bf16 v[100:103], v[32:35], v[124:127], v[100:103]
 v_mfma_f32_16x16x32_bf16 v[80:83], a[44:47], v[128:131], v[80:83]
 v_mfma_f32_16x16x32_bf16 v[88:91], a[124:127], v[128:131], v[88:91]
 v_mfma_f32_16x16x32_bf16 v[96:99], a[204:207], v[128:131], v[96:99]
 v_mfma_f32_16x16x32_bf16 v[104:107], v[32:35], v[128:131], v[104:107]
 ds_read_b128 v[124:127], v70 offset:28672
 ds_read_b128 v[128:131], v70 offset:30720
 s_waitcnt lgkmcnt(4)
 v_mfma_f32_16x16x32_bf16 v[76:79], a[48:51], v[108:111], v[76:79]
 v_mfma_f32_16x16x32_bf16 v[84:87], a[128:131], v[108:111], v[84:87]
 v_mfma_f32_16x16x32_bf16 v[92:95], a[208:211], v[108:111], v[92:95]
 v_mfma_f32_16x16x32_bf16 v[100:103], v[36:39], v[108:111], v[100:103]
 v_mfma_f32_16x16x32_bf16 v[80:83], a[48:51], v[112:115], v[80:83]
 v_mfma_f32_16x16x32_bf16 v[88:91], a[128:131], v[112:115], v[88:91]
 v_mfma_f32_16x16x32_bf16 v[96:99], a[208:211], v[112:115], v[96:99]
 v_mfma_f32_16x16x32_bf16 v[104:107], v[36:39], v[112:115], v[104:107]
 ds_read_b128 v[108:111], v71 offset:28672
 ds_read_b128 v[112:115], v71 offset:30720
 s_waitcnt lgkmcnt(4)
 v_mfma_f32_16x16x32_bf16 v[76:79], a[52:55], v[116:119], v[76:79]
 v_mfma_f32_16x16x32_bf16 v[84:87], a[132:135], v[116:119], v[84:87]
 v_mfma_f32_16x16x32_bf16 v[92:95], a[212:215], v[116:119], v[92:95]
 v_mfma_f32_16x16x32_bf16 v[100:103], v[40:43], v[116:119], v[100:103]
 v_mfma_f32_16x16x32_bf16 v[80:83], a[52:55], v[120:123], v[80:83]
 v_mfma_f32_16x16x32_bf16 v[88:91], a[132:135], v[120:123], v[88:91]
 v_mfma_f32_16x16x32_bf16 v[96:99], a[212:215], v[120:123], v[96:99]
 v_mfma_f32_16x16x32_bf16 v[104:107], v[40:43], v[120:123], v[104:107]
 s_waitcnt vmcnt(1)
 s_barrier
 ds_read_b128 v[116:119], v70 offset:32768
 ds_read_b128 v[120:123], v70 offset:34816
 s_waitcnt lgkmcnt(4)
 v_mfma_f32_16x16x32_bf16 v[76:79], a[56:59], v[124:127], v[76:79]
 v_mfma_f32_16x16x32_bf16 v[84:87], a[136:139], v[124:127], v[84:87]
 v_mfma_f32_16x16x32_bf16 v[92:95], a[216:219], v[124:127], v[92:95]
 v_mfma_f32_16x16x32_bf16 v[100:103], v[44:47], v[124:127], v[100:103]
 v_mfma_f32_16x16x32_bf16 v[80:83], a[56:59], v[128:131], v[80:83]
 v_mfma_f32_16x16x32_bf16 v[88:91], a[136:139], v[128:131], v[88:91]
 v_mfma_f32_16x16x32_bf16 v[96:99], a[216:219], v[128:131], v[96:99]
 v_mfma_f32_16x16x32_bf16 v[104:107], v[44:47], v[128:131], v[104:107]
 ds_read_b128 v[124:127], v71 offset:32768
 ds_read_b128 v[128:131], v71 offset:34816
 s_waitcnt lgkmcnt(4)
 v_mfma_f32_16x16x32_bf16 v[76:79], a[60:63], v[108:111], v[76:79]
 v_mfma_f32_16x16x32_bf16 v[84:87], a[140:143], v[108:111], v[84:87]
 v_mfma_f32_16x16x32_bf16 v[92:95], a[220:223], v[108:111], v[92:95]
 v_mfma_f32_16x16x32_bf16 v[100:103], v[48:51], v[108:111], v[100:103]
 v_mfma_f32_16x16x32_bf16 v[80:83], a[60:63], v[112:115], v[80:83]
 v_mfma_f32_16x16x32_bf16 v[88:91], a[140:143], v[112:115], v[88:91]
 v_mfma_f32_16x16x32_bf16 v[96:99], a[220:223], v[112:115], v[96:99]
 v_mfma_f32_16x16x32_bf16 v[104:107], v[48:51], v[112:115], v[104:107]
 s_mov_b32 s44, 0
 s_cmp_ge_u32 s27, 128
 s_cbranch_scc1 Lqp_310
 s_cmp_eq_u32 s42, 0
 s_cbranch_scc1 Lqo_314
 s_waitcnt vmcnt(0)
 v_cmp_lt_u32 vcc, s43, v72
 s_nop 0
 s_cmp_eq_u64 vcc, -1
 s_cbranch_scc0 Lqp_310
Lqo_314:
 s_mov_b32 s44, 1
 s_xor_b32 s22, s45, 40960
 s_mul_i32 s49, s43, 40960
 s_cmp_eq_u32 s42, 0
 s_cselect_b32 s19, 0, 2621440
 s_add_u32 s49, s49, s19
 s_add_u32 s49, s49, 184729600
 s_lshl_b32 s50, s3, 10
 s_add_u32 s50, s50, s22
 s_add_u32 m0, s50, 0
 s_nop 0
 buffer_load_dwordx4 v3, s[4:7], s49 offen offset:0 sc1 lds
 s_add_u32 m0, s50, 3968
 s_nop 0
 buffer_load_dwordx4 v3, s[4:7], s49 offen offset:128 sc1 lds
 s_add_u32 m0, s50, 7936
 s_nop 0
 buffer_load_dwordx4 v3, s[4:7], s49 offen offset:256 sc1 lds
 s_add_u32 m0, s50, 11904
 s_nop 0
 buffer_load_dwordx4 v3, s[4:7], s49 offen offset:384 sc1 lds
 s_add_u32 m0, s50, 15872
 s_nop 0
 buffer_load_dwordx4 v3, s[4:7], s49 offen offset:512 sc1 lds
 s_add_u32 m0, s50, 19840
 s_nop 0
 buffer_load_dwordx4 v3, s[4:7], s49 offen offset:640 sc1 lds
 s_add_u32 m0, s50, 23808
 s_nop 0
 buffer_load_dwordx4 v3, s[4:7], s49 offen offset:768 sc1 lds
 s_add_u32 m0, s50, 27776
 s_nop 0
 buffer_load_dwordx4 v3, s[4:7], s49 offen offset:896 sc1 lds
 s_add_u32 m0, s50, 31744
 s_nop 0
 buffer_load_dwordx4 v3, s[4:7], s49 offen offset:1024 sc1 lds
 s_add_u32 m0, s50, 35712
 s_nop 0
 buffer_load_dwordx4 v3, s[4:7], s49 offen offset:1152 sc1 lds
Lqp_310:
 ds_read_b128 v[108:111], v70 offset:36864
 ds_read_b128 v[112:115], v70 offset:38912
 s_waitcnt lgkmcnt(4)
 v_mfma_f32_16x16x32_bf16 v[76:79], a[64:67], v[116:119], v[76:79]
 v_mfma_f32_16x16x32_bf16 v[84:87], a[144:147], v[116:119], v[84:87]
 v_mfma_f32_16x16x32_bf16 v[92:95], a[224:227], v[116:119], v[92:95]
 v_mfma_f32_16x16x32_bf16 v[100:103], v[52:55], v[116:119], v[100:103]
 v_mfma_f32_16x16x32_bf16 v[80:83], a[64:67], v[120:123], v[80:83]
 v_mfma_f32_16x16x32_bf16 v[88:91], a[144:147], v[120:123], v[88:91]
 v_mfma_f32_16x16x32_bf16 v[96:99], a[224:227], v[120:123], v[96:99]
 v_mfma_f32_16x16x32_bf16 v[104:107], v[52:55], v[120:123], v[104:107]
 ds_read_b128 v[116:119], v71 offset:36864
 ds_read_b128 v[120:123], v71 offset:38912
 s_waitcnt lgkmcnt(4)
 v_mfma_f32_16x16x32_bf16 v[76:79], a[68:71], v[124:127], v[76:79]
 v_mfma_f32_16x16x32_bf16 v[84:87], a[148:151], v[124:127], v[84:87]
 v_mfma_f32_16x16x32_bf16 v[92:95], a[228:231], v[124:127], v[92:95]
 v_mfma_f32_16x16x32_bf16 v[100:103], v[56:59], v[124:127], v[100:103]
 v_mfma_f32_16x16x32_bf16 v[80:83], a[68:71], v[128:131], v[80:83]
 v_mfma_f32_16x16x32_bf16 v[88:91], a[148:151], v[128:131], v[88:91]
 v_mfma_f32_16x16x32_bf16 v[96:99], a[228:231], v[128:131], v[96:99]
 v_mfma_f32_16x16x32_bf16 v[104:107], v[56:59], v[128:131], v[104:107]
 s_waitcnt lgkmcnt(3)
 v_mfma_f32_16x16x32_bf16 v[76:79], a[72:75], v[108:111], v[76:79]
 v_mfma_f32_16x16x32_bf16 v[84:87], a[152:155], v[108:111], v[84:87]
 v_mfma_f32_16x16x32_bf16 v[92:95], a[232:235], v[108:111], v[92:95]
 v_mfma_f32_16x16x32_bf16 v[100:103], v[60:63], v[108:111], v[100:103]
 s_waitcnt lgkmcnt(2)
 v_mfma_f32_16x16x32_bf16 v[80:83], a[72:75], v[112:115], v[80:83]
 v_mfma_f32_16x16x32_bf16 v[88:91], a[152:155], v[112:115], v[88:91]
 v_mfma_f32_16x16x32_bf16 v[96:99], a[232:235], v[112:115], v[96:99]
 v_mfma_f32_16x16x32_bf16 v[104:107], v[60:63], v[112:115], v[104:107]
 s_waitcnt lgkmcnt(1)
 v_mfma_f32_16x16x32_bf16 v[76:79], a[76:79], v[116:119], v[76:79]
 v_mfma_f32_16x16x32_bf16 v[84:87], a[156:159], v[116:119], v[84:87]
 v_mfma_f32_16x16x32_bf16 v[92:95], a[236:239], v[116:119], v[92:95]
 v_mfma_f32_16x16x32_bf16 v[100:103], v[64:67], v[116:119], v[100:103]
 s_waitcnt lgkmcnt(0)
 v_mfma_f32_16x16x32_bf16 v[80:83], a[76:79], v[120:123], v[80:83]
 v_mfma_f32_16x16x32_bf16 v[88:91], a[156:159], v[120:123], v[88:91]
 v_mfma_f32_16x16x32_bf16 v[96:99], a[236:239], v[120:123], v[96:99]
 v_mfma_f32_16x16x32_bf16 v[104:107], v[64:67], v[120:123], v[104:107]
 s_mul_i32 s19, s41, 393216
 s_cmp_eq_u32 s40, 0
 s_cselect_b32 s20, s46, s47
 s_add_u32 s19, s19, s20
 s_lshl_b32 s51, s40, 11
 s_add_u32 s51, s51, s48
 s_add_u32 s52, s41, 1
 s_xor_b32 s45, s45, 40960
 v_cvt_pk_bf16_f32 v132, v76, v77
 v_cvt_pk_bf16_f32 v133, v78, v79
 v_cvt_pk_bf16_f32 v134, v84, v85
 v_cvt_pk_bf16_f32 v135, v86, v87
 buffer_store_dwordx4 v[132:135], v2, s[4:7], s19 offen offset:0 sc1
 v_cvt_pk_bf16_f32 v136, v80, v81
 v_cvt_pk_bf16_f32 v137, v82, v83
 v_cvt_pk_bf16_f32 v138, v88, v89
 v_cvt_pk_bf16_f32 v139, v90, v91
 buffer_store_dwordx4 v[136:139], v2, s[4:7], s19 offen offset:1024 sc1
 v_cvt_pk_bf16_f32 v140, v92, v93
 v_cvt_pk_bf16_f32 v141, v94, v95
 v_cvt_pk_bf16_f32 v142, v100, v101
 v_cvt_pk_bf16_f32 v143, v102, v103
 buffer_store_dwordx4 v[140:143], v2, s[4:7], s19 offen offset:2048 sc1
 v_cvt_pk_bf16_f32 v144, v96, v97
 v_cvt_pk_bf16_f32 v145, v98, v99
 v_cvt_pk_bf16_f32 v146, v104, v105
 v_cvt_pk_bf16_f32 v147, v106, v107
 buffer_store_dwordx4 v[144:147], v2, s[4:7], s19 offen offset:3072 sc1
 s_cmp_lt_u32 s27, 128
 s_cbranch_scc1 Lqt_307
 s_waitcnt vmcnt(0)
 s_mov_b64 exec, 1
 v_mov_b32 v74, s52
 buffer_store_dword v74, off, s[4:7], s51 sc1
 s_mov_b64 exec, -1
 s_endpgm
L_qkv_v:
Lqt_315:
 s_mov_b32 s40, s42
 s_mov_b32 s41, s43
 s_cmp_eq_u32 s44, 1
 s_cbranch_scc1 Lqa_316
 s_waitcnt vmcnt(0)
 s_mov_b64 exec, 1
 v_mov_b32 v74, s52
 buffer_store_dword v74, off, s[4:7], s51 sc1
 s_mov_b64 exec, -1
 s_cmp_eq_u32 s40, 0
 s_cbranch_scc1 Lqs_320
 s_add_u32 s22, s41, 1
 s_mov_b32 s24, 0
Lw_321:
 s_add_u32 s24, s24, 1
 s_cmp_gt_u32 s24, 200000
 s_cbranch_scc1 L_fail
 buffer_load_dword v72, v73, s[4:7], 0 offen sc1
 s_waitcnt vmcnt(0)
 v_cmp_le_u32 vcc, s22, v72
 s_nop 0
 s_cmp_eq_u64 vcc, -1
 s_cbranch_scc0 Lw_321
Lqs_320:
 s_mul_i32 s49, s41, 40960
 s_cmp_eq_u32 s40, 0
 s_cselect_b32 s19, 0, 2621440
 s_add_u32 s49, s49, s19
 s_add_u32 s49, s49, 184729600
 s_lshl_b32 s50, s3, 10
 s_add_u32 s50, s50, s45
 s_add_u32 m0, s50, 0
 s_nop 0
 buffer_load_dwordx4 v3, s[4:7], s49 offen offset:0 sc1 lds
 s_add_u32 m0, s50, 3968
 s_nop 0
 buffer_load_dwordx4 v3, s[4:7], s49 offen offset:128 sc1 lds
 s_add_u32 m0, s50, 7936
 s_nop 0
 buffer_load_dwordx4 v3, s[4:7], s49 offen offset:256 sc1 lds
 s_add_u32 m0, s50, 11904
 s_nop 0
 buffer_load_dwordx4 v3, s[4:7], s49 offen offset:384 sc1 lds
 s_add_u32 m0, s50, 15872
 s_nop 0
 buffer_load_dwordx4 v3, s[4:7], s49 offen offset:512 sc1 lds
 s_add_u32 m0, s50, 19840
 s_nop 0
 buffer_load_dwordx4 v3, s[4:7], s49 offen offset:640 sc1 lds
 s_add_u32 m0, s50, 23808
 s_nop 0
 buffer_load_dwordx4 v3, s[4:7], s49 offen offset:768 sc1 lds
 s_add_u32 m0, s50, 27776
 s_nop 0
 buffer_load_dwordx4 v3, s[4:7], s49 offen offset:896 sc1 lds
 s_add_u32 m0, s50, 31744
 s_nop 0
 buffer_load_dwordx4 v3, s[4:7], s49 offen offset:1024 sc1 lds
 s_add_u32 m0, s50, 35712
 s_nop 0
 buffer_load_dwordx4 v3, s[4:7], s49 offen offset:1152 sc1 lds
Lqa_316:
 buffer_load_dword v72, v73, s[4:7], 0 offen sc1
 v_add_u32 v70, s45, v68
 v_add_u32 v71, s45, v69
 s_add_u32 s27, s27, 1
 s_sub_u32 s19, s27, 12
 s_lshr_b32 s20, s19, 1
 s_add_u32 s21, s20, 12
 s_bitcmp1_b32 s19, 0
 s_cselect_b32 s43, s21, s20
 s_cselect_b32 s42, 0, 1
 s_cmp_lt_u32 s27, 12
 s_cselect_b32 s43, s27, s43
 s_cselect_b32 s42, 0, s42
 s_sub_u32 s19, s27, 64
 s_cmp_ge_u32 s27, 116
 s_cselect_b32 s43, s19, s43
 s_cselect_b32 s42, 1, s42
 s_waitcnt vmcnt(9)
 s_barrier
 ds_read_b128 v[108:111], v70 offset:0
 ds_read_b128 v[112:115], v70 offset:2048
 ds_read_b128 v[116:119], v71 offset:0
 ds_read_b128 v[120:123], v71 offset:2048
 ds_read_b128 v[124:127], v70 offset:4096
 ds_read_b128 v[128:131], v70 offset:6144
 s_waitcnt lgkmcnt(5)
 v_mfma_f32_16x16x32_bf16 v[76:79], v[108:111], a[0:3], 0
 v_mfma_f32_16x16x32_bf16 v[84:87], v[108:111], a[80:83], 0
 v_mfma_f32_16x16x32_bf16 v[92:95], v[108:111], a[160:163], 0
 v_mfma_f32_16x16x32_bf16 v[100:103], v[108:111], a[240:243], 0
 s_waitcnt lgkmcnt(4)
 v_mfma_f32_16x16x32_bf16 v[80:83], v[112:115], a[0:3], 0
 v_mfma_f32_16x16x32_bf16 v[88:91], v[112:115], a[80:83], 0
 v_mfma_f32_16x16x32_bf16 v[96:99], v[112:115], a[160:163], 0
 v_mfma_f32_16x16x32_bf16 v[104:107], v[112:115], a[240:243], 0
 ds_read_b128 v[108:111], v71 offset:4096
 ds_read_b128 v[112:115], v71 offset:6144
 s_waitcnt lgkmcnt(4)
 v_mfma_f32_16x16x32_bf16 v[76:79], v[116:119], a[4:7], v[76:79]
 v_mfma_f32_16x16x32_bf16 v[84:87], v[116:119], a[84:87], v[84:87]
 v_mfma_f32_16x16x32_bf16 v[92:95], v[116:119], a[164:167], v[92:95]
 v_mfma_f32_16x16x32_bf16 v[100:103], v[116:119], a[244:247], v[100:103]
 v_mfma_f32_16x16x32_bf16 v[80:83], v[120:123], a[4:7], v[80:83]
 v_mfma_f32_16x16x32_bf16 v[88:91], v[120:123], a[84:87], v[88:91]
 v_mfma_f32_16x16x32_bf16 v[96:99], v[120:123], a[164:167], v[96:99]
 v_mfma_f32_16x16x32_bf16 v[104:107], v[120:123], a[244:247], v[104:107]
 s_waitcnt vmcnt(7)
 s_barrier
 ds_read_b128 v[116:119], v70 offset:8192
 ds_read_b128 v[120:123], v70 offset:10240
 s_waitcnt lgkmcnt(4)
 v_mfma_f32_16x16x32_bf16 v[76:79], v[124:127], a[8:11], v[76:79]
 v_mfma_f32_16x16x32_bf16 v[84:87], v[124:127], a[88:91], v[84:87]
 v_mfma_f32_16x16x32_bf16 v[92:95], v[124:127], a[168:171], v[92:95]
 v_mfma_f32_16x16x32_bf16 v[100:103], v[124:127], a[248:251], v[100:103]
 v_mfma_f32_16x16x32_bf16 v[80:83], v[128:131], a[8:11], v[80:83]
 v_mfma_f32_16x16x32_bf16 v[88:91], v[128:131], a[88:91], v[88:91]
 v_mfma_f32_16x16x32_bf16 v[96:99], v[128:131], a[168:171], v[96:99]
 v_mfma_f32_16x16x32_bf16 v[104:107], v[128:131], a[248:251], v[104:107]
 ds_read_b128 v[124:127], v71 offset:8192
 ds_read_b128 v[128:131], v71 offset:10240
 s_waitcnt lgkmcnt(4)
 v_mfma_f32_16x16x32_bf16 v[76:79], v[108:111], a[12:15], v[76:79]
 v_mfma_f32_16x16x32_bf16 v[84:87], v[108:111], a[92:95], v[84:87]
 v_mfma_f32_16x16x32_bf16 v[92:95], v[108:111], a[172:175], v[92:95]
 v_mfma_f32_16x16x32_bf16 v[100:103], v[108:111], a[252:255], v[100:103]
 v_mfma_f32_16x16x32_bf16 v[80:83], v[112:115], a[12:15], v[80:83]
 v_mfma_f32_16x16x32_bf16 v[88:91], v[112:115], a[92:95], v[88:91]
 v_mfma_f32_16x16x32_bf16 v[96:99], v[112:115], a[172:175], v[96:99]
 v_mfma_f32_16x16x32_bf16 v[104:107], v[112:115], a[252:255], v[104:107]
 ds_read_b128 v[108:111], v70 offset:12288
 ds_read_b128 v[112:115], v70 offset:14336
 s_waitcnt lgkmcnt(4)
 v_mfma_f32_16x16x32_bf16 v[76:79], v[116:119], a[16:19], v[76:79]
 v_mfma_f32_16x16x32_bf16 v[84:87], v[116:119], a[96:99], v[84:87]
 v_mfma_f32_16x16x32_bf16 v[92:95], v[116:119], a[176:179], v[92:95]
 v_mfma_f32_16x16x32_bf16 v[100:103], v[116:119], v[4:7], v[100:103]
 v_mfma_f32_16x16x32_bf16 v[80:83], v[120:123], a[16:19], v[80:83]
 v_mfma_f32_16x16x32_bf16 v[88:91], v[120:123], a[96:99], v[88:91]
 v_mfma_f32_16x16x32_bf16 v[96:99], v[120:123], a[176:179], v[96:99]
 v_mfma_f32_16x16x32_bf16 v[104:107], v[120:123], v[4:7], v[104:107]
 ds_read_b128 v[116:119], v71 offset:12288
 ds_read_b128 v[120:123], v71 offset:14336
 s_waitcnt lgkmcnt(4)
 v_mfma_f32_16x16x32_bf16 v[76:79], v[124:127], a[20:23], v[76:79]
 v_mfma_f32_16x16x32_bf16 v[84:87], v[124:127], a[100:103], v[84:87]
 v_mfma_f32_16x16x32_bf16 v[92:95], v[124:127], a[180:183], v[92:95]
 v_mfma_f32_16x16x32_bf16 v[100:103], v[124:127], v[8:11], v[100:103]
 v_mfma_f32_16x16x32_bf16 v[80:83], v[128:131], a[20:23], v[80:83]
 v_mfma_f32_16x16x32_bf16 v[88:91], v[128:131], a[100:103], v[88:91]
 v_mfma_f32_16x16x32_bf16 v[96:99], v[128:131], a[180:183], v[96:99]
 v_mfma_f32_16x16x32_bf16 v[104:107], v[128:131], v[8:11], v[104:107]
 s_cmp_eq_u32 s44, 1
 s_cbranch_scc0 Lqn_317
 s_waitcnt vmcnt(1)
 s_mov_b64 exec, 1
 v_mov_b32 v74, s52
 buffer_store_dword v74, off, s[4:7], s51 sc1
 s_mov_b64 exec, -1
Lqn_317:
 s_waitcnt vmcnt(5)
 s_barrier
 ds_read_b128 v[124:127], v70 offset:16384
 ds_read_b128 v[128:131], v70 offset:18432
 s_waitcnt lgkmcnt(4)
 v_mfma_f32_16x16x32_bf16 v[76:79], v[108:111], a[24:27], v[76:79]
 v_mfma_f32_16x16x32_bf16 v[84:87], v[108:111], a[104:107], v[84:87]
 v_mfma_f32_16x16x32_bf16 v[92:95], v[108:111], a[184:187], v[92:95]
 v_mfma_f32_16x16x32_bf16 v[100:103], v[108:111], v[12:15], v[100:103]
 v_mfma_f32_16x16x32_bf16 v[80:83], v[112:115], a[24:27], v[80:83]
 v_mfma_f32_16x16x32_bf16 v[88:91], v[112:115], a[104:107], v[88:91]
 v_mfma_f32_16x16x32_bf16 v[96:99], v[112:115], a[184:187], v[96:99]
 v_mfma_f32_16x16x32_bf16 v[104:107], v[112:115], v[12:15], v[104:107]
 ds_read_b128 v[108:111], v71 offset:16384
 ds_read_b128 v[112:115], v71 offset:18432
 s_waitcnt lgkmcnt(4)
 v_mfma_f32_16x16x32_bf16 v[76:79], v[116:119], a[28:31], v[76:79]
 v_mfma_f32_16x16x32_bf16 v[84:87], v[116:119], a[108:111], v[84:87]
 v_mfma_f32_16x16x32_bf16 v[92:95], v[116:119], a[188:191], v[92:95]
 v_mfma_f32_16x16x32_bf16 v[100:103], v[116:119], v[16:19], v[100:103]
 v_mfma_f32_16x16x32_bf16 v[80:83], v[120:123], a[28:31], v[80:83]
 v_mfma_f32_16x16x32_bf16 v[88:91], v[120:123], a[108:111], v[88:91]
 v_mfma_f32_16x16x32_bf16 v[96:99], v[120:123], a[188:191], v[96:99]
 v_mfma_f32_16x16x32_bf16 v[104:107], v[120:123], v[16:19], v[104:107]
 ds_read_b128 v[116:119], v70 offset:20480
 ds_read_b128 v[120:123], v70 offset:22528
 s_waitcnt lgkmcnt(4)
 v_mfma_f32_16x16x32_bf16 v[76:79], v[124:127], a[32:35], v[76:79]
 v_mfma_f32_16x16x32_bf16 v[84:87], v[124:127], a[112:115], v[84:87]
 v_mfma_f32_16x16x32_bf16 v[92:95], v[124:127], a[192:195], v[92:95]
 v_mfma_f32_16x16x32_bf16 v[100:103], v[124:127], v[20:23], v[100:103]
 v_mfma_f32_16x16x32_bf16 v[80:83], v[128:131], a[32:35], v[80:83]
 v_mfma_f32_16x16x32_bf16 v[88:91], v[128:131], a[112:115], v[88:91]
 v_mfma_f32_16x16x32_bf16 v[96:99], v[128:131], a[192:195], v[96:99]
 v_mfma_f32_16x16x32_bf16 v[104:107], v[128:131], v[20:23], v[104:107]
 ds_read_b128 v[124:127], v71 offset:20480
 ds_read_b128 v[128:131], v71 offset:22528
 s_waitcnt lgkmcnt(4)
 v_mfma_f32_16x16x32_bf16 v[76:79], v[108:111], a[36:39], v[76:79]
 v_mfma_f32_16x16x32_bf16 v[84:87], v[108:111], a[116:119], v[84:87]
 v_mfma_f32_16x16x32_bf16 v[92:95], v[108:111], a[196:199], v[92:95]
 v_mfma_f32_16x16x32_bf16 v[100:103], v[108:111], v[24:27], v[100:103]
 v_mfma_f32_16x16x32_bf16 v[80:83], v[112:115], a[36:39], v[80:83]
 v_mfma_f32_16x16x32_bf16 v[88:91], v[112:115], a[116:119], v[88:91]
 v_mfma_f32_16x16x32_bf16 v[96:99], v[112:115], a[196:199], v[96:99]
 v_mfma_f32_16x16x32_bf16 v[104:107], v[112:115], v[24:27], v[104:107]
 s_waitcnt vmcnt(3)
 s_barrier
 ds_read_b128 v[108:111], v70 offset:24576
 ds_read_b128 v[112:115], v70 offset:26624
 s_waitcnt lgkmcnt(4)
 v_mfma_f32_16x16x32_bf16 v[76:79], v[116:119], a[40:43], v[76:79]
 v_mfma_f32_16x16x32_bf16 v[84:87], v[116:119], a[120:123], v[84:87]
 v_mfma_f32_16x16x32_bf16 v[92:95], v[116:119], a[200:203], v[92:95]
 v_mfma_f32_16x16x32_bf16 v[100:103], v[116:119], v[28:31], v[100:103]
 v_mfma_f32_16x16x32_bf16 v[80:83], v[120:123], a[40:43], v[80:83]
 v_mfma_f32_16x16x32_bf16 v[88:91], v[120:123], a[120:123], v[88:91]
 v_mfma_f32_16x16x32_bf16 v[96:99], v[120:123], a[200:203], v[96:99]
 v_mfma_f32_16x16x32_bf16 v[104:107], v[120:123], v[28:31], v[104:107]
 ds_read_b128 v[116:119], v71 offset:24576
 ds_read_b128 v[120:123], v71 offset:26624
 s_waitcnt lgkmcnt(4)
 v_mfma_f32_16x16x32_bf16 v[76:79], v[124:127], a[44:47], v[76:79]
 v_mfma_f32_16x16x32_bf16 v[84:87], v[124:127], a[124:127], v[84:87]
 v_mfma_f32_16x16x32_bf16 v[92:95], v[124:127], a[204:207], v[92:95]
 v_mfma_f32_16x16x32_bf16 v[100:103], v[124:127], v[32:35], v[100:103]
 v_mfma_f32_16x16x32_bf16 v[80:83], v[128:131], a[44:47], v[80:83]
 v_mfma_f32_16x16x32_bf16 v[88:91], v[128:131], a[124:127], v[88:91]
 v_mfma_f32_16x16x32_bf16 v[96:99], v[128:131], a[204:207], v[96:99]
 v_mfma_f32_16x16x32_bf16 v[104:107], v[128:131], v[32:35], v[104:107]
 ds_read_b128 v[124:127], v70 offset:28672
 ds_read_b128 v[128:131], v70 offset:30720
 s_waitcnt lgkmcnt(4)
 v_mfma_f32_16x16x32_bf16 v[76:79], v[108:111], a[48:51], v[76:79]
 v_mfma_f32_16x16x32_bf16 v[84:87], v[108:111], a[128:131], v[84:87]
 v_mfma_f32_16x16x32_bf16 v[92:95], v[108:111], a[208:211], v[92:95]
 v_mfma_f32_16x16x32_bf16 v[100:103], v[108:111], v[36:39], v[100:103]
 v_mfma_f32_16x16x32_bf16 v[80:83], v[112:115], a[48:51], v[80:83]
 v_mfma_f32_16x16x32_bf16 v[88:91], v[112:115], a[128:131], v[88:91]
 v_mfma_f32_16x16x32_bf16 v[96:99], v[112:115], a[208:211], v[96:99]
 v_mfma_f32_16x16x32_bf16 v[104:107], v[112:115], v[36:39], v[104:107]
 ds_read_b128 v[108:111], v71 offset:28672
 ds_read_b128 v[112:115], v71 offset:30720
 s_waitcnt lgkmcnt(4)
 v_mfma_f32_16x16x32_bf16 v[76:79], v[116:119], a[52:55], v[76:79]
 v_mfma_f32_16x16x32_bf16 v[84:87], v[116:119], a[132:135], v[84:87]
 v_mfma_f32_16x16x32_bf16 v[92:95], v[116:119], a[212:215], v[92:95]
 v_mfma_f32_16x16x32_bf16 v[100:103], v[116:119], v[40:43], v[100:103]
 v_mfma_f32_16x16x32_bf16 v[80:83], v[120:123], a[52:55], v[80:83]
 v_mfma_f32_16x16x32_bf16 v[88:91], v[120:123], a[132:135], v[88:91]
 v_mfma_f32_16x16x32_bf16 v[96:99], v[120:123], a[212:215], v[96:99]
 v_mfma_f32_16x16x32_bf16 v[104:107], v[120:123], v[40:43], v[104:107]
 s_waitcnt vmcnt(1)
 s_barrier
 ds_read_b128 v[116:119], v70 offset:32768
 ds_read_b128 v[120:123], v70 offset:34816
 s_waitcnt lgkmcnt(4)
 v_mfma_f32_16x16x32_bf16 v[76:79], v[124:127], a[56:59], v[76:79]
 v_mfma_f32_16x16x32_bf16 v[84:87], v[124:127], a[136:139], v[84:87]
 v_mfma_f32_16x16x32_bf16 v[92:95], v[124:127], a[216:219], v[92:95]
 v_mfma_f32_16x16x32_bf16 v[100:103], v[124:127], v[44:47], v[100:103]
 v_mfma_f32_16x16x32_bf16 v[80:83], v[128:131], a[56:59], v[80:83]
 v_mfma_f32_16x16x32_bf16 v[88:91], v[128:131], a[136:139], v[88:91]
 v_mfma_f32_16x16x32_bf16 v[96:99], v[128:131], a[216:219], v[96:99]
 v_mfma_f32_16x16x32_bf16 v[104:107], v[128:131], v[44:47], v[104:107]
 ds_read_b128 v[124:127], v71 offset:32768
 ds_read_b128 v[128:131], v71 offset:34816
 s_waitcnt lgkmcnt(4)
 v_mfma_f32_16x16x32_bf16 v[76:79], v[108:111], a[60:63], v[76:79]
 v_mfma_f32_16x16x32_bf16 v[84:87], v[108:111], a[140:143], v[84:87]
 v_mfma_f32_16x16x32_bf16 v[92:95], v[108:111], a[220:223], v[92:95]
 v_mfma_f32_16x16x32_bf16 v[100:103], v[108:111], v[48:51], v[100:103]
 v_mfma_f32_16x16x32_bf16 v[80:83], v[112:115], a[60:63], v[80:83]
 v_mfma_f32_16x16x32_bf16 v[88:91], v[112:115], a[140:143], v[88:91]
 v_mfma_f32_16x16x32_bf16 v[96:99], v[112:115], a[220:223], v[96:99]
 v_mfma_f32_16x16x32_bf16 v[104:107], v[112:115], v[48:51], v[104:107]
 s_mov_b32 s44, 0
 s_cmp_ge_u32 s27, 128
 s_cbranch_scc1 Lqp_318
 s_cmp_eq_u32 s42, 0
 s_cbranch_scc1 Lqo_322
 s_waitcnt vmcnt(0)
 v_cmp_lt_u32 vcc, s43, v72
 s_nop 0
 s_cmp_eq_u64 vcc, -1
 s_cbranch_scc0 Lqp_318
Lqo_322:
 s_mov_b32 s44, 1
 s_xor_b32 s22, s45, 40960
 s_mul_i32 s49, s43, 40960
 s_cmp_eq_u32 s42, 0
 s_cselect_b32 s19, 0, 2621440
 s_add_u32 s49, s49, s19
 s_add_u32 s49, s49, 184729600
 s_lshl_b32 s50, s3, 10
 s_add_u32 s50, s50, s22
 s_add_u32 m0, s50, 0
 s_nop 0
 buffer_load_dwordx4 v3, s[4:7], s49 offen offset:0 sc1 lds
 s_add_u32 m0, s50, 3968
 s_nop 0
 buffer_load_dwordx4 v3, s[4:7], s49 offen offset:128 sc1 lds
 s_add_u32 m0, s50, 7936
 s_nop 0
 buffer_load_dwordx4 v3, s[4:7], s49 offen offset:256 sc1 lds
 s_add_u32 m0, s50, 11904
 s_nop 0
 buffer_load_dwordx4 v3, s[4:7], s49 offen offset:384 sc1 lds
 s_add_u32 m0, s50, 15872
 s_nop 0
 buffer_load_dwordx4 v3, s[4:7], s49 offen offset:512 sc1 lds
 s_add_u32 m0, s50, 19840
 s_nop 0
 buffer_load_dwordx4 v3, s[4:7], s49 offen offset:640 sc1 lds
 s_add_u32 m0, s50, 23808
 s_nop 0
 buffer_load_dwordx4 v3, s[4:7], s49 offen offset:768 sc1 lds
 s_add_u32 m0, s50, 27776
 s_nop 0
 buffer_load_dwordx4 v3, s[4:7], s49 offen offset:896 sc1 lds
 s_add_u32 m0, s50, 31744
 s_nop 0
 buffer_load_dwordx4 v3, s[4:7], s49 offen offset:1024 sc1 lds
 s_add_u32 m0, s50, 35712
 s_nop 0
 buffer_load_dwordx4 v3, s[4:7], s49 offen offset:1152 sc1 lds
Lqp_318:
 ds_read_b128 v[108:111], v70 offset:36864
 ds_read_b128 v[112:115], v70 offset:38912
 s_waitcnt lgkmcnt(4)
 v_mfma_f32_16x16x32_bf16 v[76:79], v[116:119], a[64:67], v[76:79]
 v_mfma_f32_16x16x32_bf16 v[84:87], v[116:119], a[144:147], v[84:87]
 v_mfma_f32_16x16x32_bf16 v[92:95], v[116:119], a[224:227], v[92:95]
 v_mfma_f32_16x16x32_bf16 v[100:103], v[116:119], v[52:55], v[100:103]
 v_mfma_f32_16x16x32_bf16 v[80:83], v[120:123], a[64:67], v[80:83]
 v_mfma_f32_16x16x32_bf16 v[88:91], v[120:123], a[144:147], v[88:91]
 v_mfma_f32_16x16x32_bf16 v[96:99], v[120:123], a[224:227], v[96:99]
 v_mfma_f32_16x16x32_bf16 v[104:107], v[120:123], v[52:55], v[104:107]
 ds_read_b128 v[116:119], v71 offset:36864
 ds_read_b128 v[120:123], v71 offset:38912
 s_waitcnt lgkmcnt(4)
 v_mfma_f32_16x16x32_bf16 v[76:79], v[124:127], a[68:71], v[76:79]
 v_mfma_f32_16x16x32_bf16 v[84:87], v[124:127], a[148:151], v[84:87]
 v_mfma_f32_16x16x32_bf16 v[92:95], v[124:127], a[228:231], v[92:95]
 v_mfma_f32_16x16x32_bf16 v[100:103], v[124:127], v[56:59], v[100:103]
 v_mfma_f32_16x16x32_bf16 v[80:83], v[128:131], a[68:71], v[80:83]
 v_mfma_f32_16x16x32_bf16 v[88:91], v[128:131], a[148:151], v[88:91]
 v_mfma_f32_16x16x32_bf16 v[96:99], v[128:131], a[228:231], v[96:99]
 v_mfma_f32_16x16x32_bf16 v[104:107], v[128:131], v[56:59], v[104:107]
 s_waitcnt lgkmcnt(3)
 v_mfma_f32_16x16x32_bf16 v[76:79], v[108:111], a[72:75], v[76:79]
 v_mfma_f32_16x16x32_bf16 v[84:87], v[108:111], a[152:155], v[84:87]
 v_mfma_f32_16x16x32_bf16 v[92:95], v[108:111], a[232:235], v[92:95]
 v_mfma_f32_16x16x32_bf16 v[100:103], v[108:111], v[60:63], v[100:103]
 s_waitcnt lgkmcnt(2)
 v_mfma_f32_16x16x32_bf16 v[80:83], v[112:115], a[72:75], v[80:83]
 v_mfma_f32_16x16x32_bf16 v[88:91], v[112:115], a[152:155], v[88:91]
 v_mfma_f32_16x16x32_bf16 v[96:99], v[112:115], a[232:235], v[96:99]
 v_mfma_f32_16x16x32_bf16 v[104:107], v[112:115], v[60:63], v[104:107]
 s_waitcnt lgkmcnt(1)
 v_mfma_f32_16x16x32_bf16 v[76:79], v[116:119], a[76:79], v[76:79]
 v_mfma_f32_16x16x32_bf16 v[84:87], v[116:119], a[156:159], v[84:87]
 v_mfma_f32_16x16x32_bf16 v[92:95], v[116:119], a[236:239], v[92:95]
 v_mfma_f32_16x16x32_bf16 v[100:103], v[116:119], v[64:67], v[100:103]
 s_waitcnt lgkmcnt(0)
 v_mfma_f32_16x16x32_bf16 v[80:83], v[120:123], a[76:79], v[80:83]
 v_mfma_f32_16x16x32_bf16 v[88:91], v[120:123], a[156:159], v[88:91]
 v_mfma_f32_16x16x32_bf16 v[96:99], v[120:123], a[236:239], v[96:99]
 v_mfma_f32_16x16x32_bf16 v[104:107], v[120:123], v[64:67], v[104:107]
 s_mul_i32 s19, s41, 393216
 s_cmp_eq_u32 s40, 0
 s_cselect_b32 s20, s46, s47
 s_add_u32 s19, s19, s20
 s_lshl_b32 s51, s40, 11
 s_add_u32 s51, s51, s48
 s_add_u32 s52, s41, 1
 s_xor_b32 s45, s45, 40960
 v_cvt_pk_bf16_f32 v132, v76, v77
 v_cvt_pk_bf16_f32 v133, v78, v79
 v_cvt_pk_bf16_f32 v134, v80, v81
 v_cvt_pk_bf16_f32 v135, v82, v83
 buffer_store_dwordx4 v[132:135], v2, s[4:7], s19 offen offset:0 sc1
 v_cvt_pk_bf16_f32 v136, v84, v85
 v_cvt_pk_bf16_f32 v137, v86, v87
 v_cvt_pk_bf16_f32 v138, v88, v89
 v_cvt_pk_bf16_f32 v139, v90, v91
 buffer_store_dwordx4 v[136:139], v2, s[4:7], s19 offen offset:1024 sc1
 v_cvt_pk_bf16_f32 v140, v92, v93
 v_cvt_pk_bf16_f32 v141, v94, v95
 v_cvt_pk_bf16_f32 v142, v96, v97
 v_cvt_pk_bf16_f32 v143, v98, v99
 buffer_store_dwordx4 v[140:143], v2, s[4:7], s19 offen offset:2048 sc1
 v_cvt_pk_bf16_f32 v144, v100, v101
 v_cvt_pk_bf16_f32 v145, v102, v103
 v_cvt_pk_bf16_f32 v146, v104, v105
 v_cvt_pk_bf16_f32 v147, v106, v107
 buffer_store_dwordx4 v[144:147], v2, s[4:7], s19 offen offset:3072 sc1
 s_cmp_lt_u32 s27, 128
 s_cbranch_scc1 Lqt_315
 s_waitcnt vmcnt(0)
 s_mov_b64 exec, 1
 v_mov_b32 v74, s52
 buffer_store_dword v74, off, s[4:7], s51 sc1
 s_mov_b64 exec, -1
 s_endpgm
L_role_o:
 s_sub_u32 s12, s12, 136
 v_and_b32 v1, 63, v0
 v_lshlrev_b32 v2, 4, v1
 s_load_dwordx2 s[26:27], s[0:1], 40
 s_cmp_ge_u32 s12, 20
 s_cselect_b32 s25, 1, 0
 s_mul_i32 s19, s25, 20
 s_sub_u32 s19, s12, s19
 s_lshl_b32 s34, s25, 6
 s_add_u32 s34, s34, s19
 s_lshl_b32 s34, s34, 2
 s_add_u32 s34, s34, 6144
 s_mul_i32 s32, s19, 0x3334
 s_lshr_b32 s32, s32, 16
 s_mul_i32 s20, s32, 5
 s_sub_u32 s33, s19, s20
 s_lshl_b32 s19, s33, 8
 s_lshl_b32 s20, s3, 6
 s_add_u32 s19, s19, s20
 s_lshl_b32 s37, s19, 1
 s_mul_i32 s23, s32, 1966080
 s_add_u32 s23, s23, s19
 s_mul_i32 s20, s32, 81920
 s_add_u32 s37, s37, s20
 s_add_u32 s37, s37, 213565440
 s_waitcnt lgkmcnt(0)
 s_mov_b32 s28, s26
 s_mov_b32 s29, s27
 s_mov_b32 s30, 7864320
 s_mov_b32 s31, 0x20000
 v_lshrrev_b32 v132, 2, v1
 v_mul_u32_u24 v132, 1280, v132
 v_and_b32 v3, 3, v1
 v_lshl_add_u32 v132, v3, 4, v132
 v_lshrrev_b32 v133, 4, v1
 v_lshlrev_b32 v133, 2, v133
 v_bfe_u32 v3, v1, 2, 2
 v_add_u32 v133, v133, v3
 v_mul_u32_u24 v133, 64, v133
 v_and_b32 v3, 3, v1
 v_lshl_add_u32 v133, v3, 3, v133
 s_mul_i32 s19, s3, 40960
 s_add_u32 s19, s19, 0
 v_add_u32 v133, s19, v133
 s_mul_i32 s19, s3, 40960
 s_add_u32 m0, s19, 0
 s_add_u32 s20, s23, 0
 buffer_load_dwordx4 v132, s[28:31], s20 offen lds
 s_add_u32 m0, s19, 1024
 s_add_u32 s20, s23, 20480
 buffer_load_dwordx4 v132, s[28:31], s20 offen lds
 s_add_u32 m0, s19, 2048
 s_add_u32 s20, s23, 40960
 buffer_load_dwordx4 v132, s[28:31], s20 offen lds
 s_add_u32 m0, s19, 3072
 s_add_u32 s20, s23, 61440
 buffer_load_dwordx4 v132, s[28:31], s20 offen lds
 s_add_u32 m0, s19, 4096
 s_add_u32 s20, s23, 81920
 buffer_load_dwordx4 v132, s[28:31], s20 offen lds
 s_add_u32 m0, s19, 5120
 s_add_u32 s20, s23, 102400
 buffer_load_dwordx4 v132, s[28:31], s20 offen lds
 s_add_u32 m0, s19, 6144
 s_add_u32 s20, s23, 122880
 buffer_load_dwordx4 v132, s[28:31], s20 offen lds
 s_add_u32 m0, s19, 7168
 s_add_u32 s20, s23, 143360
 buffer_load_dwordx4 v132, s[28:31], s20 offen lds
 s_add_u32 m0, s19, 8192
 s_add_u32 s20, s23, 163840
 buffer_load_dwordx4 v132, s[28:31], s20 offen lds
 s_add_u32 m0, s19, 9216
 s_add_u32 s20, s23, 184320
 buffer_load_dwordx4 v132, s[28:31], s20 offen lds
 s_add_u32 m0, s19, 10240
 s_add_u32 s20, s23, 204800
 buffer_load_dwordx4 v132, s[28:31], s20 offen lds
 s_add_u32 m0, s19, 11264
 s_add_u32 s20, s23, 225280
 buffer_load_dwordx4 v132, s[28:31], s20 offen lds
 s_add_u32 m0, s19, 12288
 s_add_u32 s20, s23, 245760
 buffer_load_dwordx4 v132, s[28:31], s20 offen lds
 s_add_u32 m0, s19, 13312
 s_add_u32 s20, s23, 266240
 buffer_load_dwordx4 v132, s[28:31], s20 offen lds
 s_add_u32 m0, s19, 14336
 s_add_u32 s20, s23, 286720
 buffer_load_dwordx4 v132, s[28:31], s20 offen lds
 s_add_u32 m0, s19, 15360
 s_add_u32 s20, s23, 307200
 buffer_load_dwordx4 v132, s[28:31], s20 offen lds
 s_add_u32 m0, s19, 16384
 s_add_u32 s20, s23, 327680
 buffer_load_dwordx4 v132, s[28:31], s20 offen lds
 s_add_u32 m0, s19, 17408
 s_add_u32 s20, s23, 348160
 buffer_load_dwordx4 v132, s[28:31], s20 offen lds
 s_add_u32 m0, s19, 18432
 s_add_u32 s20, s23, 368640
 buffer_load_dwordx4 v132, s[28:31], s20 offen lds
 s_add_u32 m0, s19, 19456
 s_add_u32 s20, s23, 389120
 buffer_load_dwordx4 v132, s[28:31], s20 offen lds
 s_mul_i32 s19, s3, 40960
 s_add_u32 m0, s19, 20480
 s_add_u32 s20, s23, 409600
 buffer_load_dwordx4 v132, s[28:31], s20 offen lds
 s_add_u32 m0, s19, 21504
 s_add_u32 s20, s23, 430080
 buffer_load_dwordx4 v132, s[28:31], s20 offen lds
 s_add_u32 m0, s19, 22528
 s_add_u32 s20, s23, 450560
 buffer_load_dwordx4 v132, s[28:31], s20 offen lds
 s_add_u32 m0, s19, 23552
 s_add_u32 s20, s23, 471040
 buffer_load_dwordx4 v132, s[28:31], s20 offen lds
 s_add_u32 m0, s19, 24576
 s_add_u32 s20, s23, 491520
 buffer_load_dwordx4 v132, s[28:31], s20 offen lds
 s_add_u32 m0, s19, 25600
 s_add_u32 s20, s23, 512000
 buffer_load_dwordx4 v132, s[28:31], s20 offen lds
 s_add_u32 m0, s19, 26624
 s_add_u32 s20, s23, 532480
 buffer_load_dwordx4 v132, s[28:31], s20 offen lds
 s_add_u32 m0, s19, 27648
 s_add_u32 s20, s23, 552960
 buffer_load_dwordx4 v132, s[28:31], s20 offen lds
 s_add_u32 m0, s19, 28672
 s_add_u32 s20, s23, 573440
 buffer_load_dwordx4 v132, s[28:31], s20 offen lds
 s_add_u32 m0, s19, 29696
 s_add_u32 s20, s23, 593920
 buffer_load_dwordx4 v132, s[28:31], s20 offen lds
 s_add_u32 m0, s19, 30720
 s_add_u32 s20, s23, 614400
 buffer_load_dwordx4 v132, s[28:31], s20 offen lds
 s_add_u32 m0, s19, 31744
 s_add_u32 s20, s23, 634880
 buffer_load_dwordx4 v132, s[28:31], s20 offen lds
 s_add_u32 m0, s19, 32768
 s_add_u32 s20, s23, 655360
 buffer_load_dwordx4 v132, s[28:31], s20 offen lds
 s_add_u32 m0, s19, 33792
 s_add_u32 s20, s23, 675840
 buffer_load_dwordx4 v132, s[28:31], s20 offen lds
 s_add_u32 m0, s19, 34816
 s_add_u32 s20, s23, 696320
 buffer_load_dwordx4 v132, s[28:31], s20 offen lds
 s_add_u32 m0, s19, 35840
 s_add_u32 s20, s23, 716800
 buffer_load_dwordx4 v132, s[28:31], s20 offen lds
 s_add_u32 m0, s19, 36864
 s_add_u32 s20, s23, 737280
 buffer_load_dwordx4 v132, s[28:31], s20 offen lds
 s_add_u32 m0, s19, 37888
 s_add_u32 s20, s23, 757760
 buffer_load_dwordx4 v132, s[28:31], s20 offen lds
 s_add_u32 m0, s19, 38912
 s_add_u32 s20, s23, 778240
 buffer_load_dwordx4 v132, s[28:31], s20 offen lds
 s_add_u32 m0, s19, 39936
 s_add_u32 s20, s23, 798720
 buffer_load_dwordx4 v132, s[28:31], s20 offen lds
 s_waitcnt vmcnt(20)
 ds_read_b64_tr_b16 a[0:1], v133 offset:0
 ds_read_b64_tr_b16 a[2:3], v133 offset:1024
 ds_read_b64_tr_b16 a[192:193], v133 offset:32
 ds_read_b64_tr_b16 a[194:195], v133 offset:1056
 ds_read_b64_tr_b16 a[4:5], v133 offset:2048
 ds_read_b64_tr_b16 a[6:7], v133 offset:3072
 ds_read_b64_tr_b16 a[196:197], v133 offset:2080
 ds_read_b64_tr_b16 a[198:199], v133 offset:3104
 ds_read_b64_tr_b16 a[8:9], v133 offset:4096
 ds_read_b64_tr_b16 a[10:11], v133 offset:5120
 ds_read_b64_tr_b16 a[200:201], v133 offset:4128
 ds_read_b64_tr_b16 a[202:203], v133 offset:5152
 ds_read_b64_tr_b16 a[12:13], v133 offset:6144
 ds_read_b64_tr_b16 a[14:15], v133 offset:7168
 ds_read_b64_tr_b16 a[204:205], v133 offset:6176
 ds_read_b64_tr_b16 a[206:207], v133 offset:7200
 ds_read_b64_tr_b16 a[16:17], v133 offset:8192
 ds_read_b64_tr_b16 a[18:19], v133 offset:9216
 ds_read_b64_tr_b16 a[208:209], v133 offset:8224
 ds_read_b64_tr_b16 a[210:211], v133 offset:9248
 ds_read_b64_tr_b16 a[20:21], v133 offset:10240
 ds_read_b64_tr_b16 a[22:23], v133 offset:11264
 ds_read_b64_tr_b16 a[212:213], v133 offset:10272
 ds_read_b64_tr_b16 a[214:215], v133 offset:11296
 ds_read_b64_tr_b16 a[24:25], v133 offset:12288
 ds_read_b64_tr_b16 a[26:27], v133 offset:13312
 ds_read_b64_tr_b16 a[216:217], v133 offset:12320
 ds_read_b64_tr_b16 a[218:219], v133 offset:13344
 ds_read_b64_tr_b16 a[28:29], v133 offset:14336
 ds_read_b64_tr_b16 a[30:31], v133 offset:15360
 ds_read_b64_tr_b16 a[220:221], v133 offset:14368
 ds_read_b64_tr_b16 a[222:223], v133 offset:15392
 ds_read_b64_tr_b16 a[32:33], v133 offset:16384
 ds_read_b64_tr_b16 a[34:35], v133 offset:17408
 ds_read_b64_tr_b16 a[224:225], v133 offset:16416
 ds_read_b64_tr_b16 a[226:227], v133 offset:17440
 ds_read_b64_tr_b16 a[36:37], v133 offset:18432
 ds_read_b64_tr_b16 a[38:39], v133 offset:19456
 ds_read_b64_tr_b16 a[228:229], v133 offset:18464
 ds_read_b64_tr_b16 a[230:231], v133 offset:19488
 s_waitcnt lgkmcnt(0)
 s_mul_i32 s19, s3, 40960
 s_add_u32 m0, s19, 0
 s_add_u32 s20, s23, 819200
 buffer_load_dwordx4 v132, s[28:31], s20 offen lds
 s_add_u32 m0, s19, 1024
 s_add_u32 s20, s23, 839680
 buffer_load_dwordx4 v132, s[28:31], s20 offen lds
 s_add_u32 m0, s19, 2048
 s_add_u32 s20, s23, 860160
 buffer_load_dwordx4 v132, s[28:31], s20 offen lds
 s_add_u32 m0, s19, 3072
 s_add_u32 s20, s23, 880640
 buffer_load_dwordx4 v132, s[28:31], s20 offen lds
 s_add_u32 m0, s19, 4096
 s_add_u32 s20, s23, 901120
 buffer_load_dwordx4 v132, s[28:31], s20 offen lds
 s_add_u32 m0, s19, 5120
 s_add_u32 s20, s23, 921600
 buffer_load_dwordx4 v132, s[28:31], s20 offen lds
 s_add_u32 m0, s19, 6144
 s_add_u32 s20, s23, 942080
 buffer_load_dwordx4 v132, s[28:31], s20 offen lds
 s_add_u32 m0, s19, 7168
 s_add_u32 s20, s23, 962560
 buffer_load_dwordx4 v132, s[28:31], s20 offen lds
 s_add_u32 m0, s19, 8192
 s_add_u32 s20, s23, 983040
 buffer_load_dwordx4 v132, s[28:31], s20 offen lds
 s_add_u32 m0, s19, 9216
 s_add_u32 s20, s23, 1003520
 buffer_load_dwordx4 v132, s[28:31], s20 offen lds
 s_add_u32 m0, s19, 10240
 s_add_u32 s20, s23, 1024000
 buffer_load_dwordx4 v132, s[28:31], s20 offen lds
 s_add_u32 m0, s19, 11264
 s_add_u32 s20, s23, 1044480
 buffer_load_dwordx4 v132, s[28:31], s20 offen lds
 s_add_u32 m0, s19, 12288
 s_add_u32 s20, s23, 1064960
 buffer_load_dwordx4 v132, s[28:31], s20 offen lds
 s_add_u32 m0, s19, 13312
 s_add_u32 s20, s23, 1085440
 buffer_load_dwordx4 v132, s[28:31], s20 offen lds
 s_add_u32 m0, s19, 14336
 s_add_u32 s20, s23, 1105920
 buffer_load_dwordx4 v132, s[28:31], s20 offen lds
 s_add_u32 m0, s19, 15360
 s_add_u32 s20, s23, 1126400
 buffer_load_dwordx4 v132, s[28:31], s20 offen lds
 s_add_u32 m0, s19, 16384
 s_add_u32 s20, s23, 1146880
 buffer_load_dwordx4 v132, s[28:31], s20 offen lds
 s_add_u32 m0, s19, 17408
 s_add_u32 s20, s23, 1167360
 buffer_load_dwordx4 v132, s[28:31], s20 offen lds
 s_add_u32 m0, s19, 18432
 s_add_u32 s20, s23, 1187840
 buffer_load_dwordx4 v132, s[28:31], s20 offen lds
 s_add_u32 m0, s19, 19456
 s_add_u32 s20, s23, 1208320
 buffer_load_dwordx4 v132, s[28:31], s20 offen lds
 s_waitcnt vmcnt(20)
 ds_read_b64_tr_b16 a[40:41], v133 offset:20480
 ds_read_b64_tr_b16 a[42:43], v133 offset:21504
 ds_read_b64_tr_b16 a[232:233], v133 offset:20512
 ds_read_b64_tr_b16 a[234:235], v133 offset:21536
 ds_read_b64_tr_b16 a[44:45], v133 offset:22528
 ds_read_b64_tr_b16 a[46:47], v133 offset:23552
 ds_read_b64_tr_b16 a[236:237], v133 offset:22560
 ds_read_b64_tr_b16 a[238:239], v133 offset:23584
 ds_read_b64_tr_b16 a[48:49], v133 offset:24576
 ds_read_b64_tr_b16 a[50:51], v133 offset:25600
 ds_read_b64_tr_b16 a[240:241], v133 offset:24608
 ds_read_b64_tr_b16 a[242:243], v133 offset:25632
 ds_read_b64_tr_b16 a[52:53], v133 offset:26624
 ds_read_b64_tr_b16 a[54:55], v133 offset:27648
 ds_read_b64_tr_b16 a[244:245], v133 offset:26656
 ds_read_b64_tr_b16 a[246:247], v133 offset:27680
 ds_read_b64_tr_b16 a[56:57], v133 offset:28672
 ds_read_b64_tr_b16 a[58:59], v133 offset:29696
 ds_read_b64_tr_b16 a[248:249], v133 offset:28704
 ds_read_b64_tr_b16 a[250:251], v133 offset:29728
 ds_read_b64_tr_b16 a[60:61], v133 offset:30720
 ds_read_b64_tr_b16 a[62:63], v133 offset:31744
 ds_read_b64_tr_b16 a[252:253], v133 offset:30752
 ds_read_b64_tr_b16 a[254:255], v133 offset:31776
 ds_read_b64_tr_b16 a[64:65], v133 offset:32768
 ds_read_b64_tr_b16 a[66:67], v133 offset:33792
 ds_read_b64_tr_b16 v[4:5], v133 offset:32800
 ds_read_b64_tr_b16 v[6:7], v133 offset:33824
 ds_read_b64_tr_b16 a[68:69], v133 offset:34816
 ds_read_b64_tr_b16 a[70:71], v133 offset:35840
 ds_read_b64_tr_b16 v[8:9], v133 offset:34848
 ds_read_b64_tr_b16 v[10:11], v133 offset:35872
 ds_read_b64_tr_b16 a[72:73], v133 offset:36864
 ds_read_b64_tr_b16 a[74:75], v133 offset:37888
 ds_read_b64_tr_b16 v[12:13], v133 offset:36896
 ds_read_b64_tr_b16 v[14:15], v133 offset:37920
 ds_read_b64_tr_b16 a[76:77], v133 offset:38912
 ds_read_b64_tr_b16 a[78:79], v133 offset:39936
 ds_read_b64_tr_b16 v[16:17], v133 offset:38944
 ds_read_b64_tr_b16 v[18:19], v133 offset:39968
 s_waitcnt lgkmcnt(0)
 s_mul_i32 s19, s3, 40960
 s_add_u32 m0, s19, 20480
 s_add_u32 s20, s23, 1228800
 buffer_load_dwordx4 v132, s[28:31], s20 offen lds
 s_add_u32 m0, s19, 21504
 s_add_u32 s20, s23, 1249280
 buffer_load_dwordx4 v132, s[28:31], s20 offen lds
 s_add_u32 m0, s19, 22528
 s_add_u32 s20, s23, 1269760
 buffer_load_dwordx4 v132, s[28:31], s20 offen lds
 s_add_u32 m0, s19, 23552
 s_add_u32 s20, s23, 1290240
 buffer_load_dwordx4 v132, s[28:31], s20 offen lds
 s_add_u32 m0, s19, 24576
 s_add_u32 s20, s23, 1310720
 buffer_load_dwordx4 v132, s[28:31], s20 offen lds
 s_add_u32 m0, s19, 25600
 s_add_u32 s20, s23, 1331200
 buffer_load_dwordx4 v132, s[28:31], s20 offen lds
 s_add_u32 m0, s19, 26624
 s_add_u32 s20, s23, 1351680
 buffer_load_dwordx4 v132, s[28:31], s20 offen lds
 s_add_u32 m0, s19, 27648
 s_add_u32 s20, s23, 1372160
 buffer_load_dwordx4 v132, s[28:31], s20 offen lds
 s_add_u32 m0, s19, 28672
 s_add_u32 s20, s23, 1392640
 buffer_load_dwordx4 v132, s[28:31], s20 offen lds
 s_add_u32 m0, s19, 29696
 s_add_u32 s20, s23, 1413120
 buffer_load_dwordx4 v132, s[28:31], s20 offen lds
 s_add_u32 m0, s19, 30720
 s_add_u32 s20, s23, 1433600
 buffer_load_dwordx4 v132, s[28:31], s20 offen lds
 s_add_u32 m0, s19, 31744
 s_add_u32 s20, s23, 1454080
 buffer_load_dwordx4 v132, s[28:31], s20 offen lds
 s_add_u32 m0, s19, 32768
 s_add_u32 s20, s23, 1474560
 buffer_load_dwordx4 v132, s[28:31], s20 offen lds
 s_add_u32 m0, s19, 33792
 s_add_u32 s20, s23, 1495040
 buffer_load_dwordx4 v132, s[28:31], s20 offen lds
 s_add_u32 m0, s19, 34816
 s_add_u32 s20, s23, 1515520
 buffer_load_dwordx4 v132, s[28:31], s20 offen lds
 s_add_u32 m0, s19, 35840
 s_add_u32 s20, s23, 1536000
 buffer_load_dwordx4 v132, s[28:31], s20 offen lds
 s_add_u32 m0, s19, 36864
 s_add_u32 s20, s23, 1556480
 buffer_load_dwordx4 v132, s[28:31], s20 offen lds
 s_add_u32 m0, s19, 37888
 s_add_u32 s20, s23, 1576960
 buffer_load_dwordx4 v132, s[28:31], s20 offen lds
 s_add_u32 m0, s19, 38912
 s_add_u32 s20, s23, 1597440
 buffer_load_dwordx4 v132, s[28:31], s20 offen lds
 s_add_u32 m0, s19, 39936
 s_add_u32 s20, s23, 1617920
 buffer_load_dwordx4 v132, s[28:31], s20 offen lds
 s_waitcnt vmcnt(20)
 ds_read_b64_tr_b16 a[80:81], v133 offset:0
 ds_read_b64_tr_b16 a[82:83], v133 offset:1024
 ds_read_b64_tr_b16 v[20:21], v133 offset:32
 ds_read_b64_tr_b16 v[22:23], v133 offset:1056
 ds_read_b64_tr_b16 a[84:85], v133 offset:2048
 ds_read_b64_tr_b16 a[86:87], v133 offset:3072
 ds_read_b64_tr_b16 v[24:25], v133 offset:2080
 ds_read_b64_tr_b16 v[26:27], v133 offset:3104
 ds_read_b64_tr_b16 a[88:89], v133 offset:4096
 ds_read_b64_tr_b16 a[90:91], v133 offset:5120
 ds_read_b64_tr_b16 v[28:29], v133 offset:4128
 ds_read_b64_tr_b16 v[30:31], v133 offset:5152
 ds_read_b64_tr_b16 a[92:93], v133 offset:6144
 ds_read_b64_tr_b16 a[94:95], v133 offset:7168
 ds_read_b64_tr_b16 v[32:33], v133 offset:6176
 ds_read_b64_tr_b16 v[34:35], v133 offset:7200
 ds_read_b64_tr_b16 a[96:97], v133 offset:8192
 ds_read_b64_tr_b16 a[98:99], v133 offset:9216
 ds_read_b64_tr_b16 v[36:37], v133 offset:8224
 ds_read_b64_tr_b16 v[38:39], v133 offset:9248
 ds_read_b64_tr_b16 a[100:101], v133 offset:10240
 ds_read_b64_tr_b16 a[102:103], v133 offset:11264
 ds_read_b64_tr_b16 v[40:41], v133 offset:10272
 ds_read_b64_tr_b16 v[42:43], v133 offset:11296
 ds_read_b64_tr_b16 a[104:105], v133 offset:12288
 ds_read_b64_tr_b16 a[106:107], v133 offset:13312
 ds_read_b64_tr_b16 v[44:45], v133 offset:12320
 ds_read_b64_tr_b16 v[46:47], v133 offset:13344
 ds_read_b64_tr_b16 a[108:109], v133 offset:14336
 ds_read_b64_tr_b16 a[110:111], v133 offset:15360
 ds_read_b64_tr_b16 v[48:49], v133 offset:14368
 ds_read_b64_tr_b16 v[50:51], v133 offset:15392
 ds_read_b64_tr_b16 a[112:113], v133 offset:16384
 ds_read_b64_tr_b16 a[114:115], v133 offset:17408
 ds_read_b64_tr_b16 v[52:53], v133 offset:16416
 ds_read_b64_tr_b16 v[54:55], v133 offset:17440
 ds_read_b64_tr_b16 a[116:117], v133 offset:18432
 ds_read_b64_tr_b16 a[118:119], v133 offset:19456
 ds_read_b64_tr_b16 v[56:57], v133 offset:18464
 ds_read_b64_tr_b16 v[58:59], v133 offset:19488
 s_waitcnt lgkmcnt(0)
 s_mul_i32 s19, s3, 40960
 s_add_u32 m0, s19, 0
 s_add_u32 s20, s23, 1638400
 buffer_load_dwordx4 v132, s[28:31], s20 offen lds
 s_add_u32 m0, s19, 1024
 s_add_u32 s20, s23, 1658880
 buffer_load_dwordx4 v132, s[28:31], s20 offen lds
 s_add_u32 m0, s19, 2048
 s_add_u32 s20, s23, 1679360
 buffer_load_dwordx4 v132, s[28:31], s20 offen lds
 s_add_u32 m0, s19, 3072
 s_add_u32 s20, s23, 1699840
 buffer_load_dwordx4 v132, s[28:31], s20 offen lds
 s_add_u32 m0, s19, 4096
 s_add_u32 s20, s23, 1720320
 buffer_load_dwordx4 v132, s[28:31], s20 offen lds
 s_add_u32 m0, s19, 5120
 s_add_u32 s20, s23, 1740800
 buffer_load_dwordx4 v132, s[28:31], s20 offen lds
 s_add_u32 m0, s19, 6144
 s_add_u32 s20, s23, 1761280
 buffer_load_dwordx4 v132, s[28:31], s20 offen lds
 s_add_u32 m0, s19, 7168
 s_add_u32 s20, s23, 1781760
 buffer_load_dwordx4 v132, s[28:31], s20 offen lds
 s_add_u32 m0, s19, 8192
 s_add_u32 s20, s23, 1802240
 buffer_load_dwordx4 v132, s[28:31], s20 offen lds
 s_add_u32 m0, s19, 9216
 s_add_u32 s20, s23, 1822720
 buffer_load_dwordx4 v132, s[28:31], s20 offen lds
 s_add_u32 m0, s19, 10240
 s_add_u32 s20, s23, 1843200
 buffer_load_dwordx4 v132, s[28:31], s20 offen lds
 s_add_u32 m0, s19, 11264
 s_add_u32 s20, s23, 1863680
 buffer_load_dwordx4 v132, s[28:31], s20 offen lds
 s_add_u32 m0, s19, 12288
 s_add_u32 s20, s23, 1884160
 buffer_load_dwordx4 v132, s[28:31], s20 offen lds
 s_add_u32 m0, s19, 13312
 s_add_u32 s20, s23, 1904640
 buffer_load_dwordx4 v132, s[28:31], s20 offen lds
 s_add_u32 m0, s19, 14336
 s_add_u32 s20, s23, 1925120
 buffer_load_dwordx4 v132, s[28:31], s20 offen lds
 s_add_u32 m0, s19, 15360
 s_add_u32 s20, s23, 1945600
 buffer_load_dwordx4 v132, s[28:31], s20 offen lds
 s_waitcnt vmcnt(16)
 ds_read_b64_tr_b16 a[120:121], v133 offset:20480
 ds_read_b64_tr_b16 a[122:123], v133 offset:21504
 ds_read_b64_tr_b16 v[60:61], v133 offset:20512
 ds_read_b64_tr_b16 v[62:63], v133 offset:21536
 ds_read_b64_tr_b16 a[124:125], v133 offset:22528
 ds_read_b64_tr_b16 a[126:127], v133 offset:23552
 ds_read_b64_tr_b16 v[64:65], v133 offset:22560
 ds_read_b64_tr_b16 v[66:67], v133 offset:23584
 ds_read_b64_tr_b16 a[128:129], v133 offset:24576
 ds_read_b64_tr_b16 a[130:131], v133 offset:25600
 ds_read_b64_tr_b16 v[68:69], v133 offset:24608
 ds_read_b64_tr_b16 v[70:71], v133 offset:25632
 ds_read_b64_tr_b16 a[132:133], v133 offset:26624
 ds_read_b64_tr_b16 a[134:135], v133 offset:27648
 ds_read_b64_tr_b16 v[72:73], v133 offset:26656
 ds_read_b64_tr_b16 v[74:75], v133 offset:27680
 ds_read_b64_tr_b16 a[136:137], v133 offset:28672
 ds_read_b64_tr_b16 a[138:139], v133 offset:29696
 ds_read_b64_tr_b16 v[76:77], v133 offset:28704
 ds_read_b64_tr_b16 v[78:79], v133 offset:29728
 ds_read_b64_tr_b16 a[140:141], v133 offset:30720
 ds_read_b64_tr_b16 a[142:143], v133 offset:31744
 ds_read_b64_tr_b16 v[80:81], v133 offset:30752
 ds_read_b64_tr_b16 v[82:83], v133 offset:31776
 ds_read_b64_tr_b16 a[144:145], v133 offset:32768
 ds_read_b64_tr_b16 a[146:147], v133 offset:33792
 ds_read_b64_tr_b16 v[84:85], v133 offset:32800
 ds_read_b64_tr_b16 v[86:87], v133 offset:33824
 ds_read_b64_tr_b16 a[148:149], v133 offset:34816
 ds_read_b64_tr_b16 a[150:151], v133 offset:35840
 ds_read_b64_tr_b16 v[88:89], v133 offset:34848
 ds_read_b64_tr_b16 v[90:91], v133 offset:35872
 ds_read_b64_tr_b16 a[152:153], v133 offset:36864
 ds_read_b64_tr_b16 a[154:155], v133 offset:37888
 ds_read_b64_tr_b16 v[92:93], v133 offset:36896
 ds_read_b64_tr_b16 v[94:95], v133 offset:37920
 ds_read_b64_tr_b16 a[156:157], v133 offset:38912
 ds_read_b64_tr_b16 a[158:159], v133 offset:39936
 ds_read_b64_tr_b16 v[96:97], v133 offset:38944
 ds_read_b64_tr_b16 v[98:99], v133 offset:39968
 s_waitcnt lgkmcnt(0)
 s_waitcnt vmcnt(0)
 ds_read_b64_tr_b16 a[160:161], v133 offset:0
 ds_read_b64_tr_b16 a[162:163], v133 offset:1024
 ds_read_b64_tr_b16 v[100:101], v133 offset:32
 ds_read_b64_tr_b16 v[102:103], v133 offset:1056
 ds_read_b64_tr_b16 a[164:165], v133 offset:2048
 ds_read_b64_tr_b16 a[166:167], v133 offset:3072
 ds_read_b64_tr_b16 v[104:105], v133 offset:2080
 ds_read_b64_tr_b16 v[106:107], v133 offset:3104
 ds_read_b64_tr_b16 a[168:169], v133 offset:4096
 ds_read_b64_tr_b16 a[170:171], v133 offset:5120
 ds_read_b64_tr_b16 v[108:109], v133 offset:4128
 ds_read_b64_tr_b16 v[110:111], v133 offset:5152
 ds_read_b64_tr_b16 a[172:173], v133 offset:6144
 ds_read_b64_tr_b16 a[174:175], v133 offset:7168
 ds_read_b64_tr_b16 v[112:113], v133 offset:6176
 ds_read_b64_tr_b16 v[114:115], v133 offset:7200
 ds_read_b64_tr_b16 a[176:177], v133 offset:8192
 ds_read_b64_tr_b16 a[178:179], v133 offset:9216
 ds_read_b64_tr_b16 v[116:117], v133 offset:8224
 ds_read_b64_tr_b16 v[118:119], v133 offset:9248
 ds_read_b64_tr_b16 a[180:181], v133 offset:10240
 ds_read_b64_tr_b16 a[182:183], v133 offset:11264
 ds_read_b64_tr_b16 v[120:121], v133 offset:10272
 ds_read_b64_tr_b16 v[122:123], v133 offset:11296
 ds_read_b64_tr_b16 a[184:185], v133 offset:12288
 ds_read_b64_tr_b16 a[186:187], v133 offset:13312
 ds_read_b64_tr_b16 v[124:125], v133 offset:12320
 ds_read_b64_tr_b16 v[126:127], v133 offset:13344
 ds_read_b64_tr_b16 a[188:189], v133 offset:14336
 ds_read_b64_tr_b16 a[190:191], v133 offset:15360
 ds_read_b64_tr_b16 v[128:129], v133 offset:14368
 ds_read_b64_tr_b16 v[130:131], v133 offset:15392
 s_waitcnt lgkmcnt(0)
 s_barrier
 s_cmp_eq_u32 s13, 1
 s_cbranch_scc1 Lverok_324
 s_mov_b32 s18, 0
Lver_323:
 s_add_u32 s18, s18, 1
 s_cmp_gt_u32 s18, 200000
 s_cbranch_scc1 L_fail
 v_and_b32 v254, 7, v0
 v_lshlrev_b32 v254, 2, v254
 buffer_load_dword v255, v254, s[8:11], 0 offen sc1
 s_waitcnt vmcnt(0)
 v_cmp_eq_u32 vcc, 32, v255
 s_nop 0
 s_cmp_eq_u64 vcc, -1
 s_cbranch_scc1 Lverok_324
 s_mov_b32 s17, 0
 v_readlane_b32 s14, v255, 0
 s_nop 0
 s_add_u32 s17, s17, s14
 v_readlane_b32 s14, v255, 1
 s_nop 0
 s_add_u32 s17, s17, s14
 v_readlane_b32 s14, v255, 2
 s_nop 0
 s_add_u32 s17, s17, s14
 v_readlane_b32 s14, v255, 3
 s_nop 0
 s_add_u32 s17, s17, s14
 v_readlane_b32 s14, v255, 4
 s_nop 0
 s_add_u32 s17, s17, s14
 v_readlane_b32 s14, v255, 5
 s_nop 0
 s_add_u32 s17, s17, s14
 v_readlane_b32 s14, v255, 6
 s_nop 0
 s_add_u32 s17, s17, s14
 v_readlane_b32 s14, v255, 7
 s_nop 0
 s_add_u32 s17, s17, s14
 s_cmp_eq_u32 s17, 256
 s_cbranch_scc1 L_fallback
 s_branch Lver_323
Lverok_324:
 v_and_b32 v132, 15, v1
 s_lshl_b32 s19, s32, 4
 v_add_u32 v132, s19, v132
 v_lshlrev_b32 v132, 2, v132
 s_lshl_b32 s19, s25, 8
 s_add_u32 s19, s19, 5120
 v_add_u32 v132, s19, v132
 v_and_b32 v133, 15, v1
 v_mul_u32_u24 v133, 2560, v133
 v_lshrrev_b32 v135, 4, v1
 v_lshl_add_u32 v133, v135, 4, v133
 v_add_u32 v134, 49152, v2
 s_lshl_b32 s36, s3, 10
 s_mov_b32 s38, 0
Lo_325:
 s_add_u32 s39, s38, 1
 s_mov_b32 s24, 0
Lw_326:
 s_add_u32 s24, s24, 1
 s_cmp_gt_u32 s24, 200000
 s_cbranch_scc1 L_fail
 buffer_load_dword v3, v132, s[4:7], 0 offen sc1
 s_waitcnt vmcnt(0)
 v_cmp_le_u32 vcc, s39, v3
 s_nop 0
 s_cmp_eq_u64 vcc, -1
 s_cbranch_scc0 Lw_326
 s_mul_i32 s35, s38, 393216
 s_mul_i32 s19, s32, 98304
 s_add_u32 s35, s35, s19
 s_add_u32 s35, s35, 159563776
 s_add_u32 s35, s35, s36
 s_add_u32 m0, s36, 0
 s_add_u32 s19, s35, 0
 buffer_load_dwordx4 v2, s[4:7], s19 offen sc1 lds
 s_add_u32 m0, s36, 4096
 s_add_u32 s19, s35, 4096
 buffer_load_dwordx4 v2, s[4:7], s19 offen sc1 lds
 s_add_u32 m0, s36, 8192
 s_add_u32 s19, s35, 8192
 buffer_load_dwordx4 v2, s[4:7], s19 offen sc1 lds
 s_add_u32 m0, s36, 12288
 s_add_u32 s19, s35, 12288
 buffer_load_dwordx4 v2, s[4:7], s19 offen sc1 lds
 s_add_u32 m0, s36, 16384
 s_add_u32 s19, s35, 16384
 buffer_load_dwordx4 v2, s[4:7], s19 offen sc1 lds
 s_add_u32 m0, s36, 20480
 s_add_u32 s19, s35, 20480
 buffer_load_dwordx4 v2, s[4:7], s19 offen sc1 lds
 s_add_u32 m0, s36, 24576
 s_add_u32 s19, s35, 24576
 buffer_load_dwordx4 v2, s[4:7], s19 offen sc1 lds
 s_add_u32 m0, s36, 28672
 s_add_u32 s19, s35, 28672
 buffer_load_dwordx4 v2, s[4:7], s19 offen sc1 lds
 s_add_u32 m0, s36, 32768
 s_add_u32 s19, s35, 32768
 buffer_load_dwordx4 v2, s[4:7], s19 offen sc1 lds
 s_add_u32 m0, s36, 36864
 s_add_u32 s19, s35, 36864
 buffer_load_dwordx4 v2, s[4:7], s19 offen sc1 lds
 s_add_u32 m0, s36, 40960
 s_add_u32 s19, s35, 40960
 buffer_load_dwordx4 v2, s[4:7], s19 offen sc1 lds
 s_add_u32 m0, s36, 45056
 s_add_u32 s19, s35, 45056
 buffer_load_dwordx4 v2, s[4:7], s19 offen sc1 lds
 s_add_u32 m0, s36, 49152
 s_add_u32 s19, s35, 49152
 buffer_load_dwordx4 v2, s[4:7], s19 offen sc1 lds
 s_add_u32 m0, s36, 53248
 s_add_u32 s19, s35, 53248
 buffer_load_dwordx4 v2, s[4:7], s19 offen sc1 lds
 s_add_u32 m0, s36, 57344
 s_add_u32 s19, s35, 57344
 buffer_load_dwordx4 v2, s[4:7], s19 offen sc1 lds
 s_add_u32 m0, s36, 61440
 s_add_u32 s19, s35, 61440
 buffer_load_dwordx4 v2, s[4:7], s19 offen sc1 lds
 s_add_u32 m0, s36, 65536
 s_add_u32 s19, s35, 65536
 buffer_load_dwordx4 v2, s[4:7], s19 offen sc1 lds
 s_add_u32 m0, s36, 69632
 s_add_u32 s19, s35, 69632
 buffer_load_dwordx4 v2, s[4:7], s19 offen sc1 lds
 s_add_u32 m0, s36, 73728
 s_add_u32 s19, s35, 73728
 buffer_load_dwordx4 v2, s[4:7], s19 offen sc1 lds
 s_add_u32 m0, s36, 77824
 s_add_u32 s19, s35, 77824
 buffer_load_dwordx4 v2, s[4:7], s19 offen sc1 lds
 s_add_u32 m0, s36, 81920
 s_add_u32 s19, s35, 81920
 buffer_load_dwordx4 v2, s[4:7], s19 offen sc1 lds
 s_add_u32 m0, s36, 86016
 s_add_u32 s19, s35, 86016
 buffer_load_dwordx4 v2, s[4:7], s19 offen sc1 lds
 s_add_u32 m0, s36, 90112
 s_add_u32 s19, s35, 90112
 buffer_load_dwordx4 v2, s[4:7], s19 offen sc1 lds
 s_add_u32 m0, s36, 94208
 s_add_u32 s19, s35, 94208
 buffer_load_dwordx4 v2, s[4:7], s19 offen sc1 lds
 s_waitcnt vmcnt(20)
 s_barrier
 ds_read_b128 v[152:155], v2 offset:0
 ds_read_b128 v[156:159], v2 offset:1024
 ds_read_b128 v[160:163], v2 offset:2048
 ds_read_b128 v[164:167], v2 offset:3072
 ds_read_b128 v[168:171], v2 offset:4096
 ds_read_b128 v[172:175], v2 offset:5120
 s_waitcnt lgkmcnt(5)
 v_mfma_f32_16x16x32_bf16 v[136:139], a[0:3], v[152:155], 0
 v_mfma_f32_16x16x32_bf16 v[144:147], a[192:195], v[152:155], 0
 s_waitcnt lgkmcnt(4)
 v_mfma_f32_16x16x32_bf16 v[140:143], a[0:3], v[156:159], 0
 v_mfma_f32_16x16x32_bf16 v[148:151], a[192:195], v[156:159], 0
 ds_read_b128 v[152:155], v2 offset:6144
 ds_read_b128 v[156:159], v2 offset:7168
 s_waitcnt lgkmcnt(4)
 v_mfma_f32_16x16x32_bf16 v[136:139], a[4:7], v[160:163], v[136:139]
 v_mfma_f32_16x16x32_bf16 v[144:147], a[196:199], v[160:163], v[144:147]
 v_mfma_f32_16x16x32_bf16 v[140:143], a[4:7], v[164:167], v[140:143]
 v_mfma_f32_16x16x32_bf16 v[148:151], a[196:199], v[164:167], v[148:151]
 ds_read_b128 v[160:163], v2 offset:8192
 ds_read_b128 v[164:167], v2 offset:9216
 s_waitcnt lgkmcnt(4)
 v_mfma_f32_16x16x32_bf16 v[136:139], a[8:11], v[168:171], v[136:139]
 v_mfma_f32_16x16x32_bf16 v[144:147], a[200:203], v[168:171], v[144:147]
 v_mfma_f32_16x16x32_bf16 v[140:143], a[8:11], v[172:175], v[140:143]
 v_mfma_f32_16x16x32_bf16 v[148:151], a[200:203], v[172:175], v[148:151]
 ds_read_b128 v[168:171], v2 offset:10240
 ds_read_b128 v[172:175], v2 offset:11264
 s_waitcnt lgkmcnt(4)
 v_mfma_f32_16x16x32_bf16 v[136:139], a[12:15], v[152:155], v[136:139]
 v_mfma_f32_16x16x32_bf16 v[144:147], a[204:207], v[152:155], v[144:147]
 v_mfma_f32_16x16x32_bf16 v[140:143], a[12:15], v[156:159], v[140:143]
 v_mfma_f32_16x16x32_bf16 v[148:151], a[204:207], v[156:159], v[148:151]
 ds_read_b128 v[152:155], v2 offset:12288
 ds_read_b128 v[156:159], v2 offset:13312
 s_waitcnt lgkmcnt(4)
 v_mfma_f32_16x16x32_bf16 v[136:139], a[16:19], v[160:163], v[136:139]
 v_mfma_f32_16x16x32_bf16 v[144:147], a[208:211], v[160:163], v[144:147]
 v_mfma_f32_16x16x32_bf16 v[140:143], a[16:19], v[164:167], v[140:143]
 v_mfma_f32_16x16x32_bf16 v[148:151], a[208:211], v[164:167], v[148:151]
 ds_read_b128 v[160:163], v2 offset:14336
 ds_read_b128 v[164:167], v2 offset:15360
 s_waitcnt lgkmcnt(4)
 v_mfma_f32_16x16x32_bf16 v[136:139], a[20:23], v[168:171], v[136:139]
 v_mfma_f32_16x16x32_bf16 v[144:147], a[212:215], v[168:171], v[144:147]
 v_mfma_f32_16x16x32_bf16 v[140:143], a[20:23], v[172:175], v[140:143]
 v_mfma_f32_16x16x32_bf16 v[148:151], a[212:215], v[172:175], v[148:151]
 s_waitcnt vmcnt(16)
 s_barrier
 ds_read_b128 v[168:171], v2 offset:16384
 ds_read_b128 v[172:175], v2 offset:17408
 s_waitcnt lgkmcnt(4)
 v_mfma_f32_16x16x32_bf16 v[136:139], a[24:27], v[152:155], v[136:139]
 v_mfma_f32_16x16x32_bf16 v[144:147], a[216:219], v[152:155], v[144:147]
 v_mfma_f32_16x16x32_bf16 v[140:143], a[24:27], v[156:159], v[140:143]
 v_mfma_f32_16x16x32_bf16 v[148:151], a[216:219], v[156:159], v[148:151]
 ds_read_b128 v[152:155], v2 offset:18432
 ds_read_b128 v[156:159], v2 offset:19456
 s_waitcnt lgkmcnt(4)
 v_mfma_f32_16x16x32_bf16 v[136:139], a[28:31], v[160:163], v[136:139]
 v_mfma_f32_16x16x32_bf16 v[144:147], a[220:223], v[160:163], v[144:147]
 v_mfma_f32_16x16x32_bf16 v[140:143], a[28:31], v[164:167], v[140:143]
 v_mfma_f32_16x16x32_bf16 v[148:151], a[220:223], v[164:167], v[148:151]
 ds_read_b128 v[160:163], v2 offset:20480
 ds_read_b128 v[164:167], v2 offset:21504
 s_waitcnt lgkmcnt(4)
 v_mfma_f32_16x16x32_bf16 v[136:139], a[32:35], v[168:171], v[136:139]
 v_mfma_f32_16x16x32_bf16 v[144:147], a[224:227], v[168:171], v[144:147]
 v_mfma_f32_16x16x32_bf16 v[140:143], a[32:35], v[172:175], v[140:143]
 v_mfma_f32_16x16x32_bf16 v[148:151], a[224:227], v[172:175], v[148:151]
 ds_read_b128 v[168:171], v2 offset:22528
 ds_read_b128 v[172:175], v2 offset:23552
 s_waitcnt lgkmcnt(4)
 v_mfma_f32_16x16x32_bf16 v[136:139], a[36:39], v[152:155], v[136:139]
 v_mfma_f32_16x16x32_bf16 v[144:147], a[228:231], v[152:155], v[144:147]
 v_mfma_f32_16x16x32_bf16 v[140:143], a[36:39], v[156:159], v[140:143]
 v_mfma_f32_16x16x32_bf16 v[148:151], a[228:231], v[156:159], v[148:151]
 ds_read_b128 v[152:155], v2 offset:24576
 ds_read_b128 v[156:159], v2 offset:25600
 s_waitcnt lgkmcnt(4)
 v_mfma_f32_16x16x32_bf16 v[136:139], a[40:43], v[160:163], v[136:139]
 v_mfma_f32_16x16x32_bf16 v[144:147], a[232:235], v[160:163], v[144:147]
 v_mfma_f32_16x16x32_bf16 v[140:143], a[40:43], v[164:167], v[140:143]
 v_mfma_f32_16x16x32_bf16 v[148:151], a[232:235], v[164:167], v[148:151]
 ds_read_b128 v[160:163], v2 offset:26624
 ds_read_b128 v[164:167], v2 offset:27648
 s_waitcnt lgkmcnt(4)
 v_mfma_f32_16x16x32_bf16 v[136:139], a[44:47], v[168:171], v[136:139]
 v_mfma_f32_16x16x32_bf16 v[144:147], a[236:239], v[168:171], v[144:147]
 v_mfma_f32_16x16x32_bf16 v[140:143], a[44:47], v[172:175], v[140:143]
 v_mfma_f32_16x16x32_bf16 v[148:151], a[236:239], v[172:175], v[148:151]
 ds_read_b128 v[168:171], v2 offset:28672
 ds_read_b128 v[172:175], v2 offset:29696
 s_waitcnt lgkmcnt(4)
 v_mfma_f32_16x16x32_bf16 v[136:139], a[48:51], v[152:155], v[136:139]
 v_mfma_f32_16x16x32_bf16 v[144:147], a[240:243], v[152:155], v[144:147]
 v_mfma_f32_16x16x32_bf16 v[140:143], a[48:51], v[156:159], v[140:143]
 v_mfma_f32_16x16x32_bf16 v[148:151], a[240:243], v[156:159], v[148:151]
 ds_read_b128 v[152:155], v2 offset:30720
 ds_read_b128 v[156:159], v2 offset:31744
 s_waitcnt lgkmcnt(4)
 v_mfma_f32_16x16x32_bf16 v[136:139], a[52:55], v[160:163], v[136:139]
 v_mfma_f32_16x16x32_bf16 v[144:147], a[244:247], v[160:163], v[144:147]
 v_mfma_f32_16x16x32_bf16 v[140:143], a[52:55], v[164:167], v[140:143]
 v_mfma_f32_16x16x32_bf16 v[148:151], a[244:247], v[164:167], v[148:151]
 s_waitcnt vmcnt(12)
 s_barrier
 ds_read_b128 v[160:163], v2 offset:32768
 ds_read_b128 v[164:167], v2 offset:33792
 s_waitcnt lgkmcnt(4)
 v_mfma_f32_16x16x32_bf16 v[136:139], a[56:59], v[168:171], v[136:139]
 v_mfma_f32_16x16x32_bf16 v[144:147], a[248:251], v[168:171], v[144:147]
 v_mfma_f32_16x16x32_bf16 v[140:143], a[56:59], v[172:175], v[140:143]
 v_mfma_f32_16x16x32_bf16 v[148:151], a[248:251], v[172:175], v[148:151]
 ds_read_b128 v[168:171], v2 offset:34816
 ds_read_b128 v[172:175], v2 offset:35840
 s_waitcnt lgkmcnt(4)
 v_mfma_f32_16x16x32_bf16 v[136:139], a[60:63], v[152:155], v[136:139]
 v_mfma_f32_16x16x32_bf16 v[144:147], a[252:255], v[152:155], v[144:147]
 v_mfma_f32_16x16x32_bf16 v[140:143], a[60:63], v[156:159], v[140:143]
 v_mfma_f32_16x16x32_bf16 v[148:151], a[252:255], v[156:159], v[148:151]
 ds_read_b128 v[152:155], v2 offset:36864
 ds_read_b128 v[156:159], v2 offset:37888
 s_waitcnt lgkmcnt(4)
 v_mfma_f32_16x16x32_bf16 v[136:139], a[64:67], v[160:163], v[136:139]
 v_mfma_f32_16x16x32_bf16 v[144:147], v[4:7], v[160:163], v[144:147]
 v_mfma_f32_16x16x32_bf16 v[140:143], a[64:67], v[164:167], v[140:143]
 v_mfma_f32_16x16x32_bf16 v[148:151], v[4:7], v[164:167], v[148:151]
 ds_read_b128 v[160:163], v2 offset:38912
 ds_read_b128 v[164:167], v2 offset:39936
 s_waitcnt lgkmcnt(4)
 v_mfma_f32_16x16x32_bf16 v[136:139], a[68:71], v[168:171], v[136:139]
 v_mfma_f32_16x16x32_bf16 v[144:147], v[8:11], v[168:171], v[144:147]
 v_mfma_f32_16x16x32_bf16 v[140:143], a[68:71], v[172:175], v[140:143]
 v_mfma_f32_16x16x32_bf16 v[148:151], v[8:11], v[172:175], v[148:151]
 ds_read_b128 v[168:171], v2 offset:40960
 ds_read_b128 v[172:175], v2 offset:41984
 s_waitcnt lgkmcnt(4)
 v_mfma_f32_16x16x32_bf16 v[136:139], a[72:75], v[152:155], v[136:139]
 v_mfma_f32_16x16x32_bf16 v[144:147], v[12:15], v[152:155], v[144:147]
 v_mfma_f32_16x16x32_bf16 v[140:143], a[72:75], v[156:159], v[140:143]
 v_mfma_f32_16x16x32_bf16 v[148:151], v[12:15], v[156:159], v[148:151]
 ds_read_b128 v[152:155], v2 offset:43008
 ds_read_b128 v[156:159], v2 offset:44032
 s_waitcnt lgkmcnt(4)
 v_mfma_f32_16x16x32_bf16 v[136:139], a[76:79], v[160:163], v[136:139]
 v_mfma_f32_16x16x32_bf16 v[144:147], v[16:19], v[160:163], v[144:147]
 v_mfma_f32_16x16x32_bf16 v[140:143], a[76:79], v[164:167], v[140:143]
 v_mfma_f32_16x16x32_bf16 v[148:151], v[16:19], v[164:167], v[148:151]
 ds_read_b128 v[160:163], v2 offset:45056
 ds_read_b128 v[164:167], v2 offset:46080
 s_waitcnt lgkmcnt(4)
 v_mfma_f32_16x16x32_bf16 v[136:139], a[80:83], v[168:171], v[136:139]
 v_mfma_f32_16x16x32_bf16 v[144:147], v[20:23], v[168:171], v[144:147]
 v_mfma_f32_16x16x32_bf16 v[140:143], a[80:83], v[172:175], v[140:143]
 v_mfma_f32_16x16x32_bf16 v[148:151], v[20:23], v[172:175], v[148:151]
 ds_read_b128 v[168:171], v2 offset:47104
 ds_read_b128 v[172:175], v2 offset:48128
 s_waitcnt lgkmcnt(4)
 v_mfma_f32_16x16x32_bf16 v[136:139], a[84:87], v[152:155], v[136:139]
 v_mfma_f32_16x16x32_bf16 v[144:147], v[24:27], v[152:155], v[144:147]
 v_mfma_f32_16x16x32_bf16 v[140:143], a[84:87], v[156:159], v[140:143]
 v_mfma_f32_16x16x32_bf16 v[148:151], v[24:27], v[156:159], v[148:151]
 s_waitcnt vmcnt(8)
 s_barrier
 ds_read_b128 v[152:155], v134 offset:0
 ds_read_b128 v[156:159], v134 offset:1024
 s_waitcnt lgkmcnt(4)
 v_mfma_f32_16x16x32_bf16 v[136:139], a[88:91], v[160:163], v[136:139]
 v_mfma_f32_16x16x32_bf16 v[144:147], v[28:31], v[160:163], v[144:147]
 v_mfma_f32_16x16x32_bf16 v[140:143], a[88:91], v[164:167], v[140:143]
 v_mfma_f32_16x16x32_bf16 v[148:151], v[28:31], v[164:167], v[148:151]
 ds_read_b128 v[160:163], v134 offset:2048
 ds_read_b128 v[164:167], v134 offset:3072
 s_waitcnt lgkmcnt(4)
 v_mfma_f32_16x16x32_bf16 v[136:139], a[92:95], v[168:171], v[136:139]
 v_mfma_f32_16x16x32_bf16 v[144:147], v[32:35], v[168:171], v[144:147]
 v_mfma_f32_16x16x32_bf16 v[140:143], a[92:95], v[172:175], v[140:143]
 v_mfma_f32_16x16x32_bf16 v[148:151], v[32:35], v[172:175], v[148:151]
 ds_read_b128 v[168:171], v134 offset:4096
 ds_read_b128 v[172:175], v134 offset:5120
 s_waitcnt lgkmcnt(4)
 v_mfma_f32_16x16x32_bf16 v[136:139], a[96:99], v[152:155], v[136:139]
 v_mfma_f32_16x16x32_bf16 v[144:147], v[36:39], v[152:155], v[144:147]
 v_mfma_f32_16x16x32_bf16 v[140:143], a[96:99], v[156:159], v[140:143]
 v_mfma_f32_16x16x32_bf16 v[148:151], v[36:39], v[156:159], v[148:151]
 ds_read_b128 v[152:155], v134 offset:6144
 ds_read_b128 v[156:159], v134 offset:7168
 s_waitcnt lgkmcnt(4)
 v_mfma_f32_16x16x32_bf16 v[136:139], a[100:103], v[160:163], v[136:139]
 v_mfma_f32_16x16x32_bf16 v[144:147], v[40:43], v[160:163], v[144:147]
 v_mfma_f32_16x16x32_bf16 v[140:143], a[100:103], v[164:167], v[140:143]
 v_mfma_f32_16x16x32_bf16 v[148:151], v[40:43], v[164:167], v[148:151]
 ds_read_b128 v[160:163], v134 offset:8192
 ds_read_b128 v[164:167], v134 offset:9216
 s_waitcnt lgkmcnt(4)
 v_mfma_f32_16x16x32_bf16 v[136:139], a[104:107], v[168:171], v[136:139]
 v_mfma_f32_16x16x32_bf16 v[144:147], v[44:47], v[168:171], v[144:147]
 v_mfma_f32_16x16x32_bf16 v[140:143], a[104:107], v[172:175], v[140:143]
 v_mfma_f32_16x16x32_bf16 v[148:151], v[44:47], v[172:175], v[148:151]
 ds_read_b128 v[168:171], v134 offset:10240
 ds_read_b128 v[172:175], v134 offset:11264
 s_waitcnt lgkmcnt(4)
 v_mfma_f32_16x16x32_bf16 v[136:139], a[108:111], v[152:155], v[136:139]
 v_mfma_f32_16x16x32_bf16 v[144:147], v[48:51], v[152:155], v[144:147]
 v_mfma_f32_16x16x32_bf16 v[140:143], a[108:111], v[156:159], v[140:143]
 v_mfma_f32_16x16x32_bf16 v[148:151], v[48:51], v[156:159], v[148:151]
 ds_read_b128 v[152:155], v134 offset:12288
 ds_read_b128 v[156:159], v134 offset:13312
 s_waitcnt lgkmcnt(4)
 v_mfma_f32_16x16x32_bf16 v[136:139], a[112:115], v[160:163], v[136:139]
 v_mfma_f32_16x16x32_bf16 v[144:147], v[52:55], v[160:163], v[144:147]
 v_mfma_f32_16x16x32_bf16 v[140:143], a[112:115], v[164:167], v[140:143]
 v_mfma_f32_16x16x32_bf16 v[148:151], v[52:55], v[164:167], v[148:151]
 ds_read_b128 v[160:163], v134 offset:14336
 ds_read_b128 v[164:167], v134 offset:15360
 s_waitcnt lgkmcnt(4)
 v_mfma_f32_16x16x32_bf16 v[136:139], a[116:119], v[168:171], v[136:139]
 v_mfma_f32_16x16x32_bf16 v[144:147], v[56:59], v[168:171], v[144:147]
 v_mfma_f32_16x16x32_bf16 v[140:143], a[116:119], v[172:175], v[140:143]
 v_mfma_f32_16x16x32_bf16 v[148:151], v[56:59], v[172:175], v[148:151]
 s_waitcnt vmcnt(4)
 s_barrier
 ds_read_b128 v[168:171], v134 offset:16384
 ds_read_b128 v[172:175], v134 offset:17408
 s_waitcnt lgkmcnt(4)
 v_mfma_f32_16x16x32_bf16 v[136:139], a[120:123], v[152:155], v[136:139]
 v_mfma_f32_16x16x32_bf16 v[144:147], v[60:63], v[152:155], v[144:147]
 v_mfma_f32_16x16x32_bf16 v[140:143], a[120:123], v[156:159], v[140:143]
 v_mfma_f32_16x16x32_bf16 v[148:151], v[60:63], v[156:159], v[148:151]
 ds_read_b128 v[152:155], v134 offset:18432
 ds_read_b128 v[156:159], v134 offset:19456
 s_waitcnt lgkmcnt(4)
 v_mfma_f32_16x16x32_bf16 v[136:139], a[124:127], v[160:163], v[136:139]
 v_mfma_f32_16x16x32_bf16 v[144:147], v[64:67], v[160:163], v[144:147]
 v_mfma_f32_16x16x32_bf16 v[140:143], a[124:127], v[164:167], v[140:143]
 v_mfma_f32_16x16x32_bf16 v[148:151], v[64:67], v[164:167], v[148:151]
 ds_read_b128 v[160:163], v134 offset:20480
 ds_read_b128 v[164:167], v134 offset:21504
 s_waitcnt lgkmcnt(4)
 v_mfma_f32_16x16x32_bf16 v[136:139], a[128:131], v[168:171], v[136:139]
 v_mfma_f32_16x16x32_bf16 v[144:147], v[68:71], v[168:171], v[144:147]
 v_mfma_f32_16x16x32_bf16 v[140:143], a[128:131], v[172:175], v[140:143]
 v_mfma_f32_16x16x32_bf16 v[148:151], v[68:71], v[172:175], v[148:151]
 ds_read_b128 v[168:171], v134 offset:22528
 ds_read_b128 v[172:175], v134 offset:23552
 s_waitcnt lgkmcnt(4)
 v_mfma_f32_16x16x32_bf16 v[136:139], a[132:135], v[152:155], v[136:139]
 v_mfma_f32_16x16x32_bf16 v[144:147], v[72:75], v[152:155], v[144:147]
 v_mfma_f32_16x16x32_bf16 v[140:143], a[132:135], v[156:159], v[140:143]
 v_mfma_f32_16x16x32_bf16 v[148:151], v[72:75], v[156:159], v[148:151]
 ds_read_b128 v[152:155], v134 offset:24576
 ds_read_b128 v[156:159], v134 offset:25600
 s_waitcnt lgkmcnt(4)
 v_mfma_f32_16x16x32_bf16 v[136:139], a[136:139], v[160:163], v[136:139]
 v_mfma_f32_16x16x32_bf16 v[144:147], v[76:79], v[160:163], v[144:147]
 v_mfma_f32_16x16x32_bf16 v[140:143], a[136:139], v[164:167], v[140:143]
 v_mfma_f32_16x16x32_bf16 v[148:151], v[76:79], v[164:167], v[148:151]
 ds_read_b128 v[160:163], v134 offset:26624
 ds_read_b128 v[164:167], v134 offset:27648
 s_waitcnt lgkmcnt(4)
 v_mfma_f32_16x16x32_bf16 v[136:139], a[140:143], v[168:171], v[136:139]
 v_mfma_f32_16x16x32_bf16 v[144:147], v[80:83], v[168:171], v[144:147]
 v_mfma_f32_16x16x32_bf16 v[140:143], a[140:143], v[172:175], v[140:143]
 v_mfma_f32_16x16x32_bf16 v[148:151], v[80:83], v[172:175], v[148:151]
 ds_read_b128 v[168:171], v134 offset:28672
 ds_read_b128 v[172:175], v134 offset:29696
 s_waitcnt lgkmcnt(4)
 v_mfma_f32_16x16x32_bf16 v[136:139], a[144:147], v[152:155], v[136:139]
 v_mfma_f32_16x16x32_bf16 v[144:147], v[84:87], v[152:155], v[144:147]
 v_mfma_f32_16x16x32_bf16 v[140:143], a[144:147], v[156:159], v[140:143]
 v_mfma_f32_16x16x32_bf16 v[148:151], v[84:87], v[156:159], v[148:151]
 ds_read_b128 v[152:155], v134 offset:30720
 ds_read_b128 v[156:159], v134 offset:31744
 s_waitcnt lgkmcnt(4)
 v_mfma_f32_16x16x32_bf16 v[136:139], a[148:151], v[160:163], v[136:139]
 v_mfma_f32_16x16x32_bf16 v[144:147], v[88:91], v[160:163], v[144:147]
 v_mfma_f32_16x16x32_bf16 v[140:143], a[148:151], v[164:167], v[140:143]
 v_mfma_f32_16x16x32_bf16 v[148:151], v[88:91], v[164:167], v[148:151]
 s_waitcnt vmcnt(0)
 s_barrier
 ds_read_b128 v[160:163], v134 offset:32768
 ds_read_b128 v[164:167], v134 offset:33792
 s_waitcnt lgkmcnt(4)
 v_mfma_f32_16x16x32_bf16 v[136:139], a[152:155], v[168:171], v[136:139]
 v_mfma_f32_16x16x32_bf16 v[144:147], v[92:95], v[168:171], v[144:147]
 v_mfma_f32_16x16x32_bf16 v[140:143], a[152:155], v[172:175], v[140:143]
 v_mfma_f32_16x16x32_bf16 v[148:151], v[92:95], v[172:175], v[148:151]
 ds_read_b128 v[168:171], v134 offset:34816
 ds_read_b128 v[172:175], v134 offset:35840
 s_waitcnt lgkmcnt(4)
 v_mfma_f32_16x16x32_bf16 v[136:139], a[156:159], v[152:155], v[136:139]
 v_mfma_f32_16x16x32_bf16 v[144:147], v[96:99], v[152:155], v[144:147]
 v_mfma_f32_16x16x32_bf16 v[140:143], a[156:159], v[156:159], v[140:143]
 v_mfma_f32_16x16x32_bf16 v[148:151], v[96:99], v[156:159], v[148:151]
 ds_read_b128 v[152:155], v134 offset:36864
 ds_read_b128 v[156:159], v134 offset:37888
 s_waitcnt lgkmcnt(4)
 v_mfma_f32_16x16x32_bf16 v[136:139], a[160:163], v[160:163], v[136:139]
 v_mfma_f32_16x16x32_bf16 v[144:147], v[100:103], v[160:163], v[144:147]
 v_mfma_f32_16x16x32_bf16 v[140:143], a[160:163], v[164:167], v[140:143]
 v_mfma_f32_16x16x32_bf16 v[148:151], v[100:103], v[164:167], v[148:151]
 ds_read_b128 v[160:163], v134 offset:38912
 ds_read_b128 v[164:167], v134 offset:39936
 s_waitcnt lgkmcnt(4)
 v_mfma_f32_16x16x32_bf16 v[136:139], a[164:167], v[168:171], v[136:139]
 v_mfma_f32_16x16x32_bf16 v[144:147], v[104:107], v[168:171], v[144:147]
 v_mfma_f32_16x16x32_bf16 v[140:143], a[164:167], v[172:175], v[140:143]
 v_mfma_f32_16x16x32_bf16 v[148:151], v[104:107], v[172:175], v[148:151]
 ds_read_b128 v[168:171], v134 offset:40960
 ds_read_b128 v[172:175], v134 offset:41984
 s_waitcnt lgkmcnt(4)
 v_mfma_f32_16x16x32_bf16 v[136:139], a[168:171], v[152:155], v[136:139]
 v_mfma_f32_16x16x32_bf16 v[144:147], v[108:111], v[152:155], v[144:147]
 v_mfma_f32_16x16x32_bf16 v[140:143], a[168:171], v[156:159], v[140:143]
 v_mfma_f32_16x16x32_bf16 v[148:151], v[108:111], v[156:159], v[148:151]
 ds_read_b128 v[152:155], v134 offset:43008
 ds_read_b128 v[156:159], v134 offset:44032
 s_waitcnt lgkmcnt(4)
 v_mfma_f32_16x16x32_bf16 v[136:139], a[172:175], v[160:163], v[136:139]
 v_mfma_f32_16x16x32_bf16 v[144:147], v[112:115], v[160:163], v[144:147]
 v_mfma_f32_16x16x32_bf16 v[140:143], a[172:175], v[164:167], v[140:143]
 v_mfma_f32_16x16x32_bf16 v[148:151], v[112:115], v[164:167], v[148:151]
 ds_read_b128 v[160:163], v134 offset:45056
 ds_read_b128 v[164:167], v134 offset:46080
 s_waitcnt lgkmcnt(4)
 v_mfma_f32_16x16x32_bf16 v[136:139], a[176:179], v[168:171], v[136:139]
 v_mfma_f32_16x16x32_bf16 v[144:147], v[116:119], v[168:171], v[144:147]
 v_mfma_f32_16x16x32_bf16 v[140:143], a[176:179], v[172:175], v[140:143]
 v_mfma_f32_16x16x32_bf16 v[148:151], v[116:119], v[172:175], v[148:151]
 ds_read_b128 v[168:171], v134 offset:47104
 ds_read_b128 v[172:175], v134 offset:48128
 s_waitcnt lgkmcnt(4)
 v_mfma_f32_16x16x32_bf16 v[136:139], a[180:183], v[152:155], v[136:139]
 v_mfma_f32_16x16x32_bf16 v[144:147], v[120:123], v[152:155], v[144:147]
 v_mfma_f32_16x16x32_bf16 v[140:143], a[180:183], v[156:159], v[140:143]
 v_mfma_f32_16x16x32_bf16 v[148:151], v[120:123], v[156:159], v[148:151]
 s_waitcnt lgkmcnt(3)
 v_mfma_f32_16x16x32_bf16 v[136:139], a[184:187], v[160:163], v[136:139]
 v_mfma_f32_16x16x32_bf16 v[144:147], v[124:127], v[160:163], v[144:147]
 s_waitcnt lgkmcnt(2)
 v_mfma_f32_16x16x32_bf16 v[140:143], a[184:187], v[164:167], v[140:143]
 v_mfma_f32_16x16x32_bf16 v[148:151], v[124:127], v[164:167], v[148:151]
 s_waitcnt lgkmcnt(1)
 v_mfma_f32_16x16x32_bf16 v[136:139], a[188:191], v[168:171], v[136:139]
 v_mfma_f32_16x16x32_bf16 v[144:147], v[128:131], v[168:171], v[144:147]
 s_waitcnt lgkmcnt(0)
 v_mfma_f32_16x16x32_bf16 v[140:143], a[188:191], v[172:175], v[140:143]
 v_mfma_f32_16x16x32_bf16 v[148:151], v[128:131], v[172:175], v[148:151]
 s_mul_i32 s19, s38, 327680
 s_add_u32 s19, s19, s37
 s_add_u32 s20, s19, 40960
 buffer_store_dwordx4 v[136:139], v133, s[4:7], s19 offen offset:0 sc1
 buffer_store_dwordx4 v[144:147], v133, s[4:7], s19 offen offset:64 sc1
 buffer_store_dwordx4 v[140:143], v133, s[4:7], s20 offen offset:0 sc1
 s_nop 1
 buffer_store_dwordx4 v[148:151], v133, s[4:7], s20 offen offset:64 sc1
 s_waitcnt vmcnt(0)
 s_barrier
 s_cmp_eq_u32 s3, 0
 s_cbranch_scc0 Lnp_327
 s_mov_b64 exec, 1
 v_mov_b32 v3, s39
 buffer_store_dword v3, off, s[4:7], s34 sc1
 s_mov_b64 exec, -1
Lnp_327:
 s_mov_b32 s38, s39
 s_cmp_lt_u32 s38, 64
 s_cbranch_scc1 Lo_325
 s_endpgm
L_role_at:
 s_sub_u32 s12, s12, 176
 s_cmp_eq_u32 s13, 1
 s_cbranch_scc1 Lverok_329
 s_mov_b32 s18, 0
Lver_328:
 s_add_u32 s18, s18, 1
 s_cmp_gt_u32 s18, 200000
 s_cbranch_scc1 L_fail
 v_and_b32 v254, 7, v0
 v_lshlrev_b32 v254, 2, v254
 buffer_load_dword v255, v254, s[8:11], 0 offen sc1
 s_waitcnt vmcnt(0)
 v_cmp_eq_u32 vcc, 32, v255
 s_nop 0
 s_cmp_eq_u64 vcc, -1
 s_cbranch_scc1 Lverok_329
 s_mov_b32 s17, 0
 v_readlane_b32 s14, v255, 0
 s_nop 0
 s_add_u32 s17, s17, s14
 v_readlane_b32 s14, v255, 1
 s_nop 0
 s_add_u32 s17, s17, s14
 v_readlane_b32 s14, v255, 2
 s_nop 0
 s_add_u32 s17, s17, s14
 v_readlane_b32 s14, v255, 3
 s_nop 0
 s_add_u32 s17, s17, s14
 v_readlane_b32 s14, v255, 4
 s_nop 0
 s_add_u32 s17, s17, s14
 v_readlane_b32 s14, v255, 5
 s_nop 0
 s_add_u32 s17, s17, s14
 v_readlane_b32 s14, v255, 6
 s_nop 0
 s_add_u32 s17, s17, s14
 v_readlane_b32 s14, v255, 7
 s_nop 0
 s_add_u32 s17, s17, s14
 s_cmp_eq_u32 s17, 256
 s_cbranch_scc1 L_fallback
 s_branch Lver_328
Lverok_329:
 v_and_b32 v1, 63, v0
 v_lshlrev_b32 v2, 4, v1
 v_lshlrev_b32 v3, 3, v1
 s_mov_b32 s30, 0x3dd53b95
 s_lshr_b32 s25, s3, 1
 s_and_b32 s19, s3, 1
 s_mul_i32 s20, s12, 12288
 s_lshl_b32 s21, s19, 10
 s_add_u32 s21, s21, s20
 s_add_u32 s31, s21, 33734656
 s_add_u32 s34, s21, 159563776
 s_mul_i32 s22, s25, 50331648
 s_add_u32 s22, s22, s20
 s_add_u32 s32, s22, 58900480
 s_add_u32 s33, s22, 84066304
 s_mul_i32 s35, s12, 6144
 s_mul_i32 s22, s25, 1572864
 s_add_u32 s35, s35, s22
 s_add_u32 s35, s35, 2277376
 s_lshl_b32 s29, s25, 6
 s_lshl_b32 s22, s12, 1
 s_add_u32 s29, s29, s22
 s_add_u32 s29, s29, s19
 s_lshl_b32 s29, s29, 2
 s_add_u32 s29, s29, 5120
 v_and_b32 v5, 3, v1
 v_min_u32 v5, 2, v5
 v_bfe_u32 v7, v1, 2, 2
 v_min_u32 v7, 2, v7
 v_mul_u32_u24 v7, 96, v7
 v_add_u32 v5, v5, v7
 s_mul_i32 s22, s12, 3
 s_lshl_b32 s23, s25, 9
 s_add_u32 s22, s22, s23
 v_add_u32 v5, s22, v5
 v_lshlrev_b32 v5, 2, v5
 v_add_u32 v5, 0, v5
 v_and_b32 v6, 1, v1
 s_lshl_b32 s22, s12, 1
 v_add_u32 v6, s22, v6
 v_lshlrev_b32 v6, 2, v6
 v_add_u32 v6, 4096, v6
 v_mov_b32 v8, 0xf149f2ca
 v_lshrrev_b32 v7, 5, v1
 v_cmp_eq_u32 vcc, s25, v7
 s_nop 1
 v_cndmask_b32 v14, v8, 0, vcc
 v_mov_b32 v18, 0x3f803f80
 v_lshrrev_b32 v7, 4, v1
 v_lshlrev_b32 v7, 2, v7
 v_add_u32 v7, 0, v7
 v_and_b32 v4, 15, v1
 v_cmp_le_u32 vcc, v7, v4
 s_nop 1
 v_cndmask_b32 v10, v8, 0, vcc
 v_mov_b32 v15, v14
 v_mov_b32 v19, 0x3f803f80
 v_lshrrev_b32 v7, 4, v1
 v_lshlrev_b32 v7, 2, v7
 v_add_u32 v7, 1, v7
 v_and_b32 v4, 15, v1
 v_cmp_le_u32 vcc, v7, v4
 s_nop 1
 v_cndmask_b32 v11, v8, 0, vcc
 v_mov_b32 v16, v14
 v_mov_b32 v20, 0x3f803f80
 v_lshrrev_b32 v7, 4, v1
 v_lshlrev_b32 v7, 2, v7
 v_add_u32 v7, 2, v7
 v_and_b32 v4, 15, v1
 v_cmp_le_u32 vcc, v7, v4
 s_nop 1
 v_cndmask_b32 v12, v8, 0, vcc
 v_mov_b32 v17, v14
 v_mov_b32 v21, 0x3f803f80
 v_lshrrev_b32 v7, 4, v1
 v_lshlrev_b32 v7, 2, v7
 v_add_u32 v7, 3, v7
 v_and_b32 v4, 15, v1
 v_cmp_le_u32 vcc, v7, v4
 s_nop 1
 v_cndmask_b32 v13, v8, 0, vcc
 v_mov_b32 v204, 0
 v_mov_b32 v205, 0
 s_mov_b32 s26, 0
 s_bitcmp1_b32 s3, 0
 s_cbranch_scc1 L_at_1
Lat_330:
 s_add_u32 s27, s26, 1
 s_mul_i32 s28, s25, 8
 s_add_u32 s28, s28, s27
 s_mov_b32 s24, 0
Lw_331:
 s_add_u32 s24, s24, 1
 s_cmp_gt_u32 s24, 200000
 s_cbranch_scc1 L_fail
 buffer_load_dword v4, v5, s[4:7], 0 offen sc1
 s_waitcnt vmcnt(0)
 v_cmp_le_u32 vcc, s27, v4
 s_nop 0
 s_cmp_eq_u64 vcc, -1
 s_cbranch_scc0 Lw_331
 s_mul_i32 s19, s26, 393216
 s_add_u32 s20, s19, s31
 s_add_u32 s21, s19, s32
 s_add_u32 s22, s19, s33
 s_add_u32 s23, s20, 0
 buffer_load_dwordx4 v[22:25], v2, s[4:7], s23 offen offset:0 sc1
 buffer_load_dwordx4 v[26:29], v2, s[4:7], s23 offen offset:2048 sc1
 s_add_u32 s23, s20, 4096
 buffer_load_dwordx4 v[30:33], v2, s[4:7], s23 offen offset:0 sc1
 buffer_load_dwordx4 v[34:37], v2, s[4:7], s23 offen offset:2048 sc1
 s_add_u32 s23, s20, 8192
 buffer_load_dwordx4 v[38:41], v2, s[4:7], s23 offen offset:0 sc1
 buffer_load_dwordx4 v[42:45], v2, s[4:7], s23 offen offset:2048 sc1
 s_add_u32 s23, s21, 0
 buffer_load_dwordx4 v[46:49], v2, s[4:7], s23 offen offset:0 sc1
 buffer_load_dwordx4 v[50:53], v2, s[4:7], s23 offen offset:2048 sc1
 s_add_u32 s23, s21, 4096
 buffer_load_dwordx4 v[54:57], v2, s[4:7], s23 offen offset:0 sc1
 buffer_load_dwordx4 v[58:61], v2, s[4:7], s23 offen offset:2048 sc1
 s_add_u32 s23, s21, 8192
 buffer_load_dwordx4 v[62:65], v2, s[4:7], s23 offen offset:0 sc1
 buffer_load_dwordx4 v[66:69], v2, s[4:7], s23 offen offset:2048 sc1
 s_add_u32 s23, s22, 0
 buffer_load_dwordx4 v[94:97], v2, s[4:7], s23 offen offset:0 sc1
 buffer_load_dwordx4 v[98:101], v2, s[4:7], s23 offen offset:1024 sc1
 buffer_load_dwordx4 v[102:105], v2, s[4:7], s23 offen offset:2048 sc1
 buffer_load_dwordx4 v[106:109], v2, s[4:7], s23 offen offset:3072 sc1
 s_add_u32 s23, s22, 4096
 buffer_load_dwordx4 v[110:113], v2, s[4:7], s23 offen offset:0 sc1
 buffer_load_dwordx4 v[114:117], v2, s[4:7], s23 offen offset:1024 sc1
 buffer_load_dwordx4 v[118:121], v2, s[4:7], s23 offen offset:2048 sc1
 buffer_load_dwordx4 v[122:125], v2, s[4:7], s23 offen offset:3072 sc1
 s_add_u32 s23, s22, 8192
 buffer_load_dwordx4 v[126:129], v2, s[4:7], s23 offen offset:0 sc1
 buffer_load_dwordx4 v[130:133], v2, s[4:7], s23 offen offset:1024 sc1
 buffer_load_dwordx4 v[134:137], v2, s[4:7], s23 offen offset:2048 sc1
 buffer_load_dwordx4 v[138:141], v2, s[4:7], s23 offen offset:3072 sc1
 s_waitcnt vmcnt(12)
 v_mfma_f32_16x16x32_bf16 v[190:193], v[46:49], v[22:25], v[10:13]
 v_mfma_f32_16x16x32_bf16 v[190:193], v[50:53], v[26:29], v[190:193]
 v_mfma_f32_16x16x32_bf16 v[190:193], v[54:57], v[30:33], v[190:193]
 v_mfma_f32_16x16x32_bf16 v[190:193], v[58:61], v[34:37], v[190:193]
 v_mfma_f32_16x16x32_bf16 v[190:193], v[62:65], v[38:41], v[190:193]
 v_mfma_f32_16x16x32_bf16 v[190:193], v[66:69], v[42:45], v[190:193]
 s_mov_b32 s24, 0
Lw_332:
 s_add_u32 s24, s24, 1
 s_cmp_gt_u32 s24, 200000
 s_cbranch_scc1 L_fail
 buffer_load_dword v4, v6, s[4:7], 0 offen sc1
 s_waitcnt vmcnt(0)
 v_cmp_le_u32 vcc, s28, v4
 s_nop 0
 s_cmp_eq_u64 vcc, -1
 s_cbranch_scc0 Lw_332
 s_mul_i32 s20, s26, 196608
 s_add_u32 s20, s20, s35
 s_add_u32 s21, s20, 15728640
 s_add_u32 s23, s20, 0
 buffer_load_dwordx4 v[142:145], v2, s[4:7], s23 offen offset:0 sc1
 buffer_load_dwordx4 v[146:149], v2, s[4:7], s23 offen offset:1024 sc1
 buffer_load_dwordx4 v[150:153], v2, s[4:7], s23 offen offset:2048 sc1
 buffer_load_dwordx4 v[154:157], v2, s[4:7], s23 offen offset:3072 sc1
 s_add_u32 s23, s20, 4096
 buffer_load_dwordx4 v[158:161], v2, s[4:7], s23 offen offset:0 sc1
 buffer_load_dwordx4 v[162:165], v2, s[4:7], s23 offen offset:1024 sc1
 s_add_u32 s23, s21, 0
 buffer_load_dwordx2 v[166:167], v3, s[4:7], s23 offen offset:0 sc1
 buffer_load_dwordx2 v[168:169], v3, s[4:7], s23 offen offset:512 sc1
 buffer_load_dwordx2 v[170:171], v3, s[4:7], s23 offen offset:1024 sc1
 buffer_load_dwordx2 v[172:173], v3, s[4:7], s23 offen offset:1536 sc1
 buffer_load_dwordx2 v[174:175], v3, s[4:7], s23 offen offset:2048 sc1
 buffer_load_dwordx2 v[176:177], v3, s[4:7], s23 offen offset:2560 sc1
 buffer_load_dwordx2 v[178:179], v3, s[4:7], s23 offen offset:3072 sc1
 buffer_load_dwordx2 v[180:181], v3, s[4:7], s23 offen offset:3584 sc1
 s_add_u32 s23, s21, 4096
 buffer_load_dwordx2 v[182:183], v3, s[4:7], s23 offen offset:0 sc1
 buffer_load_dwordx2 v[184:185], v3, s[4:7], s23 offen offset:512 sc1
 buffer_load_dwordx2 v[186:187], v3, s[4:7], s23 offen offset:1024 sc1
 buffer_load_dwordx2 v[188:189], v3, s[4:7], s23 offen offset:1536 sc1
 s_waitcnt vmcnt(17)
 v_mfma_f32_16x16x32_bf16 v[198:201], v[142:145], v[22:25], v[14:17]
 s_waitcnt vmcnt(16)
 v_mfma_f32_16x16x32_bf16 v[198:201], v[146:149], v[26:29], v[198:201]
 s_waitcnt vmcnt(15)
 v_mfma_f32_16x16x32_bf16 v[198:201], v[150:153], v[30:33], v[198:201]
 s_waitcnt vmcnt(14)
 v_mfma_f32_16x16x32_bf16 v[198:201], v[154:157], v[34:37], v[198:201]
 s_waitcnt vmcnt(13)
 v_mfma_f32_16x16x32_bf16 v[198:201], v[158:161], v[38:41], v[198:201]
 s_waitcnt vmcnt(12)
 v_mfma_f32_16x16x32_bf16 v[198:201], v[162:165], v[42:45], v[198:201]
 v_max3_f32 v1, v190, v191, v192
 s_nop 6
 v_max3_f32 v7, v193, v198, v199
 v_max3_f32 v1, v1, v200, v201
 v_max_f32 v1, v1, v7
 v_mov_b32 v7, v1
 s_nop 1
 v_permlane32_swap_b32 v1, v7
 v_max_f32 v1, v1, v7
 v_mov_b32 v7, v1
 s_nop 1
 v_permlane16_swap_b32 v1, v7
 v_max_f32 v1, v1, v7
 v_mul_f32 v1, s30, v1
 v_fma_f32 v190, v190, s30, -v1
 v_fma_f32 v191, v191, s30, -v1
 v_fma_f32 v192, v192, s30, -v1
 v_fma_f32 v193, v193, s30, -v1
 v_fma_f32 v198, v198, s30, -v1
 v_fma_f32 v199, v199, s30, -v1
 v_fma_f32 v200, v200, s30, -v1
 v_fma_f32 v201, v201, s30, -v1
 v_exp_f32 v190, v190
 v_exp_f32 v191, v191
 v_exp_f32 v192, v192
 v_exp_f32 v193, v193
 v_exp_f32 v198, v198
 v_exp_f32 v199, v199
 v_exp_f32 v200, v200
 v_exp_f32 v201, v201
 v_cvt_pk_bf16_f32 v202, v190, v191
 v_cvt_pk_bf16_f32 v203, v192, v193
 v_cvt_pk_bf16_f32 v8, v198, v199
 v_cvt_pk_bf16_f32 v9, v200, v201
 v_mfma_f32_16x16x32_bf16 v[206:209], v[18:21], v[202:205], 0
 v_mfma_f32_16x16x32_bf16 v[46:49], v[94:97], v[202:205], 0
 v_mfma_f32_16x16x32_bf16 v[50:53], v[98:101], v[202:205], 0
 v_mfma_f32_16x16x16_bf16 v[206:209], v[18:19], v[8:9], v[206:209]
 v_mfma_f32_16x16x32_bf16 v[54:57], v[102:105], v[202:205], 0
 v_mfma_f32_16x16x32_bf16 v[58:61], v[106:109], v[202:205], 0
 v_mfma_f32_16x16x32_bf16 v[62:65], v[110:113], v[202:205], 0
 v_mfma_f32_16x16x32_bf16 v[66:69], v[114:117], v[202:205], 0
 v_rcp_f32 v7, v206
 s_add_u32 s20, s19, s34
 s_waitcnt vmcnt(0)
 v_mfma_f32_16x16x32_bf16 v[70:73], v[118:121], v[202:205], 0
 v_mfma_f32_16x16x32_bf16 v[74:77], v[122:125], v[202:205], 0
 v_mfma_f32_16x16x32_bf16 v[78:81], v[126:129], v[202:205], 0
 v_mfma_f32_16x16x32_bf16 v[82:85], v[130:133], v[202:205], 0
 v_mfma_f32_16x16x32_bf16 v[86:89], v[134:137], v[202:205], 0
 v_mfma_f32_16x16x32_bf16 v[90:93], v[138:141], v[202:205], 0
 v_mfma_f32_16x16x16_bf16 v[46:49], v[166:167], v[8:9], v[46:49]
 v_mfma_f32_16x16x16_bf16 v[50:53], v[168:169], v[8:9], v[50:53]
 v_mfma_f32_16x16x16_bf16 v[54:57], v[170:171], v[8:9], v[54:57]
 v_mfma_f32_16x16x16_bf16 v[58:61], v[172:173], v[8:9], v[58:61]
 v_mfma_f32_16x16x16_bf16 v[62:65], v[174:175], v[8:9], v[62:65]
 v_mfma_f32_16x16x16_bf16 v[66:69], v[176:177], v[8:9], v[66:69]
 v_mul_f32 v46, v46, v7
 v_mul_f32 v47, v47, v7
 v_mul_f32 v48, v48, v7
 v_mul_f32 v49, v49, v7
 v_mul_f32 v50, v50, v7
 v_mul_f32 v51, v51, v7
 v_mul_f32 v52, v52, v7
 v_mul_f32 v53, v53, v7
 v_cvt_pk_bf16_f32 v22, v46, v47
 v_cvt_pk_bf16_f32 v23, v48, v49
 v_cvt_pk_bf16_f32 v24, v50, v51
 v_cvt_pk_bf16_f32 v25, v52, v53
 s_add_u32 s23, s20, 0
 buffer_store_dwordx4 v[22:25], v2, s[4:7], s23 offen offset:0 sc1
 v_mfma_f32_16x16x16_bf16 v[70:73], v[178:179], v[8:9], v[70:73]
 v_mfma_f32_16x16x16_bf16 v[74:77], v[180:181], v[8:9], v[74:77]
 v_mul_f32 v54, v54, v7
 v_mul_f32 v55, v55, v7
 v_mul_f32 v56, v56, v7
 v_mul_f32 v57, v57, v7
 v_mul_f32 v58, v58, v7
 v_mul_f32 v59, v59, v7
 v_mul_f32 v60, v60, v7
 v_mul_f32 v61, v61, v7
 v_cvt_pk_bf16_f32 v26, v54, v55
 v_cvt_pk_bf16_f32 v27, v56, v57
 v_cvt_pk_bf16_f32 v28, v58, v59
 v_cvt_pk_bf16_f32 v29, v60, v61
 buffer_store_dwordx4 v[26:29], v2, s[4:7], s23 offen offset:2048 sc1
 v_mfma_f32_16x16x16_bf16 v[78:81], v[182:183], v[8:9], v[78:81]
 v_mfma_f32_16x16x16_bf16 v[82:85], v[184:185], v[8:9], v[82:85]
 v_mul_f32 v62, v62, v7
 v_mul_f32 v63, v63, v7
 v_mul_f32 v64, v64, v7
 v_mul_f32 v65, v65, v7
 v_mul_f32 v66, v66, v7
 v_mul_f32 v67, v67, v7
 v_mul_f32 v68, v68, v7
 v_mul_f32 v69, v69, v7
 v_cvt_pk_bf16_f32 v30, v62, v63
 v_cvt_pk_bf16_f32 v31, v64, v65
 v_cvt_pk_bf16_f32 v32, v66, v67
 v_cvt_pk_bf16_f32 v33, v68, v69
 s_add_u32 s23, s20, 4096
 buffer_store_dwordx4 v[30:33], v2, s[4:7], s23 offen offset:0 sc1
 v_mfma_f32_16x16x16_bf16 v[86:89], v[186:187], v[8:9], v[86:89]
 v_mfma_f32_16x16x16_bf16 v[90:93], v[188:189], v[8:9], v[90:93]
 v_mul_f32 v70, v70, v7
 v_mul_f32 v71, v71, v7
 v_mul_f32 v72, v72, v7
 v_mul_f32 v73, v73, v7
 v_mul_f32 v74, v74, v7
 v_mul_f32 v75, v75, v7
 v_mul_f32 v76, v76, v7
 v_mul_f32 v77, v77, v7
 v_cvt_pk_bf16_f32 v34, v70, v71
 v_cvt_pk_bf16_f32 v35, v72, v73
 v_cvt_pk_bf16_f32 v36, v74, v75
 v_cvt_pk_bf16_f32 v37, v76, v77
 buffer_store_dwordx4 v[34:37], v2, s[4:7], s23 offen offset:2048 sc1
 v_mul_f32 v78, v78, v7
 v_mul_f32 v79, v79, v7
 v_mul_f32 v80, v80, v7
 v_mul_f32 v81, v81, v7
 v_mul_f32 v82, v82, v7
 v_mul_f32 v83, v83, v7
 v_mul_f32 v84, v84, v7
 v_mul_f32 v85, v85, v7
 v_cvt_pk_bf16_f32 v38, v78, v79
 v_cvt_pk_bf16_f32 v39, v80, v81
 v_cvt_pk_bf16_f32 v40, v82, v83
 v_cvt_pk_bf16_f32 v41, v84, v85
 s_add_u32 s23, s20, 8192
 buffer_store_dwordx4 v[38:41], v2, s[4:7], s23 offen offset:0 sc1
 v_mul_f32 v86, v86, v7
 v_mul_f32 v87, v87, v7
 v_mul_f32 v88, v88, v7
 v_mul_f32 v89, v89, v7
 v_mul_f32 v90, v90, v7
 v_mul_f32 v91, v91, v7
 v_mul_f32 v92, v92, v7
 v_mul_f32 v93, v93, v7
 v_cvt_pk_bf16_f32 v42, v86, v87
 v_cvt_pk_bf16_f32 v43, v88, v89
 v_cvt_pk_bf16_f32 v44, v90, v91
 v_cvt_pk_bf16_f32 v45, v92, v93
 buffer_store_dwordx4 v[42:45], v2, s[4:7], s23 offen offset:2048 sc1
 s_waitcnt vmcnt(0)
 s_mov_b64 exec, 1
 v_mov_b32 v4, s27
 buffer_store_dword v4, off, s[4:7], s29 sc1
 s_mov_b64 exec, -1
 s_mov_b32 s26, s27
 s_cmp_lt_u32 s26, 64
 s_cbranch_scc1 Lat_330
 s_endpgm
L_at_1:
Lat_333:
 s_add_u32 s27, s26, 1
 s_mul_i32 s28, s25, 8
 s_add_u32 s28, s28, s27
 s_mov_b32 s24, 0
Lw_334:
 s_add_u32 s24, s24, 1
 s_cmp_gt_u32 s24, 200000
 s_cbranch_scc1 L_fail
 buffer_load_dword v4, v5, s[4:7], 0 offen sc1
 s_waitcnt vmcnt(0)
 v_cmp_le_u32 vcc, s27, v4
 s_nop 0
 s_cmp_eq_u64 vcc, -1
 s_cbranch_scc0 Lw_334
 s_mul_i32 s19, s26, 393216
 s_add_u32 s20, s19, s31
 s_add_u32 s21, s19, s32
 s_add_u32 s22, s19, s33
 s_add_u32 s23, s20, 0
 buffer_load_dwordx4 v[22:25], v2, s[4:7], s23 offen offset:0 sc1
 buffer_load_dwordx4 v[26:29], v2, s[4:7], s23 offen offset:2048 sc1
 s_add_u32 s23, s20, 4096
 buffer_load_dwordx4 v[30:33], v2, s[4:7], s23 offen offset:0 sc1
 buffer_load_dwordx4 v[34:37], v2, s[4:7], s23 offen offset:2048 sc1
 s_add_u32 s23, s20, 8192
 buffer_load_dwordx4 v[38:41], v2, s[4:7], s23 offen offset:0 sc1
 buffer_load_dwordx4 v[42:45], v2, s[4:7], s23 offen offset:2048 sc1
 s_add_u32 s23, s21, 0
 buffer_load_dwordx4 v[46:49], v2, s[4:7], s23 offen offset:0 sc1
 buffer_load_dwordx4 v[50:53], v2, s[4:7], s23 offen offset:1024 sc1
 buffer_load_dwordx4 v[54:57], v2, s[4:7], s23 offen offset:2048 sc1
 buffer_load_dwordx4 v[58:61], v2, s[4:7], s23 offen offset:3072 sc1
 s_add_u32 s23, s21, 4096
 buffer_load_dwordx4 v[62:65], v2, s[4:7], s23 offen offset:0 sc1
 buffer_load_dwordx4 v[66:69], v2, s[4:7], s23 offen offset:1024 sc1
 buffer_load_dwordx4 v[70:73], v2, s[4:7], s23 offen offset:2048 sc1
 buffer_load_dwordx4 v[74:77], v2, s[4:7], s23 offen offset:3072 sc1
 s_add_u32 s23, s21, 8192
 buffer_load_dwordx4 v[78:81], v2, s[4:7], s23 offen offset:0 sc1
 buffer_load_dwordx4 v[82:85], v2, s[4:7], s23 offen offset:1024 sc1
 buffer_load_dwordx4 v[86:89], v2, s[4:7], s23 offen offset:2048 sc1
 buffer_load_dwordx4 v[90:93], v2, s[4:7], s23 offen offset:3072 sc1
 s_add_u32 s23, s22, 0
 buffer_load_dwordx4 v[94:97], v2, s[4:7], s23 offen offset:0 sc1
 buffer_load_dwordx4 v[98:101], v2, s[4:7], s23 offen offset:1024 sc1
 buffer_load_dwordx4 v[102:105], v2, s[4:7], s23 offen offset:2048 sc1
 buffer_load_dwordx4 v[106:109], v2, s[4:7], s23 offen offset:3072 sc1
 s_add_u32 s23, s22, 4096
 buffer_load_dwordx4 v[110:113], v2, s[4:7], s23 offen offset:0 sc1
 buffer_load_dwordx4 v[114:117], v2, s[4:7], s23 offen offset:1024 sc1
 buffer_load_dwordx4 v[118:121], v2, s[4:7], s23 offen offset:2048 sc1
 buffer_load_dwordx4 v[122:125], v2, s[4:7], s23 offen offset:3072 sc1
 s_add_u32 s23, s22, 8192
 buffer_load_dwordx4 v[126:129], v2, s[4:7], s23 offen offset:0 sc1
 buffer_load_dwordx4 v[130:133], v2, s[4:7], s23 offen offset:1024 sc1
 buffer_load_dwordx4 v[134:137], v2, s[4:7], s23 offen offset:2048 sc1
 buffer_load_dwordx4 v[138:141], v2, s[4:7], s23 offen offset:3072 sc1
 s_waitcnt vmcnt(12)
 v_mfma_f32_16x16x32_bf16 v[190:193], v[46:49], v[22:25], 0
 v_mfma_f32_16x16x32_bf16 v[194:197], v[50:53], v[22:25], v[10:13]
 v_mfma_f32_16x16x32_bf16 v[190:193], v[54:57], v[26:29], v[190:193]
 v_mfma_f32_16x16x32_bf16 v[194:197], v[58:61], v[26:29], v[194:197]
 v_mfma_f32_16x16x32_bf16 v[190:193], v[62:65], v[30:33], v[190:193]
 v_mfma_f32_16x16x32_bf16 v[194:197], v[66:69], v[30:33], v[194:197]
 v_mfma_f32_16x16x32_bf16 v[190:193], v[70:73], v[34:37], v[190:193]
 v_mfma_f32_16x16x32_bf16 v[194:197], v[74:77], v[34:37], v[194:197]
 v_mfma_f32_16x16x32_bf16 v[190:193], v[78:81], v[38:41], v[190:193]
 v_mfma_f32_16x16x32_bf16 v[194:197], v[82:85], v[38:41], v[194:197]
 v_mfma_f32_16x16x32_bf16 v[190:193], v[86:89], v[42:45], v[190:193]
 v_mfma_f32_16x16x32_bf16 v[194:197], v[90:93], v[42:45], v[194:197]
 s_mov_b32 s24, 0
Lw_335:
 s_add_u32 s24, s24, 1
 s_cmp_gt_u32 s24, 200000
 s_cbranch_scc1 L_fail
 buffer_load_dword v4, v6, s[4:7], 0 offen sc1
 s_waitcnt vmcnt(0)
 v_cmp_le_u32 vcc, s28, v4
 s_nop 0
 s_cmp_eq_u64 vcc, -1
 s_cbranch_scc0 Lw_335
 s_mul_i32 s20, s26, 196608
 s_add_u32 s20, s20, s35
 s_add_u32 s21, s20, 15728640
 s_add_u32 s23, s20, 0
 buffer_load_dwordx4 v[142:145], v2, s[4:7], s23 offen offset:0 sc1
 buffer_load_dwordx4 v[146:149], v2, s[4:7], s23 offen offset:1024 sc1
 buffer_load_dwordx4 v[150:153], v2, s[4:7], s23 offen offset:2048 sc1
 buffer_load_dwordx4 v[154:157], v2, s[4:7], s23 offen offset:3072 sc1
 s_add_u32 s23, s20, 4096
 buffer_load_dwordx4 v[158:161], v2, s[4:7], s23 offen offset:0 sc1
 buffer_load_dwordx4 v[162:165], v2, s[4:7], s23 offen offset:1024 sc1
 s_add_u32 s23, s21, 0
 buffer_load_dwordx2 v[166:167], v3, s[4:7], s23 offen offset:0 sc1
 buffer_load_dwordx2 v[168:169], v3, s[4:7], s23 offen offset:512 sc1
 buffer_load_dwordx2 v[170:171], v3, s[4:7], s23 offen offset:1024 sc1
 buffer_load_dwordx2 v[172:173], v3, s[4:7], s23 offen offset:1536 sc1
 buffer_load_dwordx2 v[174:175], v3, s[4:7], s23 offen offset:2048 sc1
 buffer_load_dwordx2 v[176:177], v3, s[4:7], s23 offen offset:2560 sc1
 buffer_load_dwordx2 v[178:179], v3, s[4:7], s23 offen offset:3072 sc1
 buffer_load_dwordx2 v[180:181], v3, s[4:7], s23 offen offset:3584 sc1
 s_add_u32 s23, s21, 4096
 buffer_load_dwordx2 v[182:183], v3, s[4:7], s23 offen offset:0 sc1
 buffer_load_dwordx2 v[184:185], v3, s[4:7], s23 offen offset:512 sc1
 buffer_load_dwordx2 v[186:187], v3, s[4:7], s23 offen offset:1024 sc1
 buffer_load_dwordx2 v[188:189], v3, s[4:7], s23 offen offset:1536 sc1
 s_waitcnt vmcnt(17)
 v_mfma_f32_16x16x32_bf16 v[198:201], v[142:145], v[22:25], v[14:17]
 s_waitcnt vmcnt(16)
 v_mfma_f32_16x16x32_bf16 v[198:201], v[146:149], v[26:29], v[198:201]
 s_waitcnt vmcnt(15)
 v_mfma_f32_16x16x32_bf16 v[198:201], v[150:153], v[30:33], v[198:201]
 s_waitcnt vmcnt(14)
 v_mfma_f32_16x16x32_bf16 v[198:201], v[154:157], v[34:37], v[198:201]
 s_waitcnt vmcnt(13)
 v_mfma_f32_16x16x32_bf16 v[198:201], v[158:161], v[38:41], v[198:201]
 s_waitcnt vmcnt(12)
 v_mfma_f32_16x16x32_bf16 v[198:201], v[162:165], v[42:45], v[198:201]
 v_max3_f32 v1, v190, v191, v192
 v_max3_f32 v1, v1, v194, v195
 v_max3_f32 v1, v1, v196, v197
 s_nop 4
 v_max3_f32 v7, v193, v198, v199
 v_max3_f32 v1, v1, v200, v201
 v_max_f32 v1, v1, v7
 v_mov_b32 v7, v1
 s_nop 1
 v_permlane32_swap_b32 v1, v7
 v_max_f32 v1, v1, v7
 v_mov_b32 v7, v1
 s_nop 1
 v_permlane16_swap_b32 v1, v7
 v_max_f32 v1, v1, v7
 v_mul_f32 v1, s30, v1
 v_fma_f32 v190, v190, s30, -v1
 v_fma_f32 v191, v191, s30, -v1
 v_fma_f32 v192, v192, s30, -v1
 v_fma_f32 v193, v193, s30, -v1
 v_fma_f32 v194, v194, s30, -v1
 v_fma_f32 v195, v195, s30, -v1
 v_fma_f32 v196, v196, s30, -v1
 v_fma_f32 v197, v197, s30, -v1
 v_fma_f32 v198, v198, s30, -v1
 v_fma_f32 v199, v199, s30, -v1
 v_fma_f32 v200, v200, s30, -v1
 v_fma_f32 v201, v201, s30, -v1
 v_exp_f32 v190, v190
 v_exp_f32 v191, v191
 v_exp_f32 v192, v192
 v_exp_f32 v193, v193
 v_exp_f32 v194, v194
 v_exp_f32 v195, v195
 v_exp_f32 v196, v196
 v_exp_f32 v197, v197
 v_exp_f32 v198, v198
 v_exp_f32 v199, v199
 v_exp_f32 v200, v200
 v_exp_f32 v201, v201
 v_cvt_pk_bf16_f32 v202, v190, v191
 v_cvt_pk_bf16_f32 v203, v192, v193
 v_cvt_pk_bf16_f32 v204, v194, v195
 v_cvt_pk_bf16_f32 v205, v196, v197
 v_cvt_pk_bf16_f32 v8, v198, v199
 v_cvt_pk_bf16_f32 v9, v200, v201
 v_mfma_f32_16x16x32_bf16 v[206:209], v[18:21], v[202:205], 0
 v_mfma_f32_16x16x32_bf16 v[46:49], v[94:97], v[202:205], 0
 v_mfma_f32_16x16x32_bf16 v[50:53], v[98:101], v[202:205], 0
 v_mfma_f32_16x16x16_bf16 v[206:209], v[18:19], v[8:9], v[206:209]
 v_mfma_f32_16x16x32_bf16 v[54:57], v[102:105], v[202:205], 0
 v_mfma_f32_16x16x32_bf16 v[58:61], v[106:109], v[202:205], 0
 v_mfma_f32_16x16x32_bf16 v[62:65], v[110:113], v[202:205], 0
 v_mfma_f32_16x16x32_bf16 v[66:69], v[114:117], v[202:205], 0
 v_rcp_f32 v7, v206
 s_add_u32 s20, s19, s34
 s_waitcnt vmcnt(0)
 v_mfma_f32_16x16x32_bf16 v[70:73], v[118:121], v[202:205], 0
 v_mfma_f32_16x16x32_bf16 v[74:77], v[122:125], v[202:205], 0
 v_mfma_f32_16x16x32_bf16 v[78:81], v[126:129], v[202:205], 0
 v_mfma_f32_16x16x32_bf16 v[82:85], v[130:133], v[202:205], 0
 v_mfma_f32_16x16x32_bf16 v[86:89], v[134:137], v[202:205], 0
 v_mfma_f32_16x16x32_bf16 v[90:93], v[138:141], v[202:205], 0
 v_mfma_f32_16x16x16_bf16 v[46:49], v[166:167], v[8:9], v[46:49]
 v_mfma_f32_16x16x16_bf16 v[50:53], v[168:169], v[8:9], v[50:53]
 v_mfma_f32_16x16x16_bf16 v[54:57], v[170:171], v[8:9], v[54:57]
 v_mfma_f32_16x16x16_bf16 v[58:61], v[172:173], v[8:9], v[58:61]
 v_mfma_f32_16x16x16_bf16 v[62:65], v[174:175], v[8:9], v[62:65]
 v_mfma_f32_16x16x16_bf16 v[66:69], v[176:177], v[8:9], v[66:69]
 v_mul_f32 v46, v46, v7
 v_mul_f32 v47, v47, v7
 v_mul_f32 v48, v48, v7
 v_mul_f32 v49, v49, v7
 v_mul_f32 v50, v50, v7
 v_mul_f32 v51, v51, v7
 v_mul_f32 v52, v52, v7
 v_mul_f32 v53, v53, v7
 v_cvt_pk_bf16_f32 v22, v46, v47
 v_cvt_pk_bf16_f32 v23, v48, v49
 v_cvt_pk_bf16_f32 v24, v50, v51
 v_cvt_pk_bf16_f32 v25, v52, v53
 s_add_u32 s23, s20, 0
 buffer_store_dwordx4 v[22:25], v2, s[4:7], s23 offen offset:0 sc1
 v_mfma_f32_16x16x16_bf16 v[70:73], v[178:179], v[8:9], v[70:73]
 v_mfma_f32_16x16x16_bf16 v[74:77], v[180:181], v[8:9], v[74:77]
 v_mul_f32 v54, v54, v7
 v_mul_f32 v55, v55, v7
 v_mul_f32 v56, v56, v7
 v_mul_f32 v57, v57, v7
 v_mul_f32 v58, v58, v7
 v_mul_f32 v59, v59, v7
 v_mul_f32 v60, v60, v7
 v_mul_f32 v61, v61, v7
 v_cvt_pk_bf16_f32 v26, v54, v55
 v_cvt_pk_bf16_f32 v27, v56, v57
 v_cvt_pk_bf16_f32 v28, v58, v59
 v_cvt_pk_bf16_f32 v29, v60, v61
 buffer_store_dwordx4 v[26:29], v2, s[4:7], s23 offen offset:2048 sc1
 v_mfma_f32_16x16x16_bf16 v[78:81], v[182:183], v[8:9], v[78:81]
 v_mfma_f32_16x16x16_bf16 v[82:85], v[184:185], v[8:9], v[82:85]
 v_mul_f32 v62, v62, v7
 v_mul_f32 v63, v63, v7
 v_mul_f32 v64, v64, v7
 v_mul_f32 v65, v65, v7
 v_mul_f32 v66, v66, v7
 v_mul_f32 v67, v67, v7
 v_mul_f32 v68, v68, v7
 v_mul_f32 v69, v69, v7
 v_cvt_pk_bf16_f32 v30, v62, v63
 v_cvt_pk_bf16_f32 v31, v64, v65
 v_cvt_pk_bf16_f32 v32, v66, v67
 v_cvt_pk_bf16_f32 v33, v68, v69
 s_add_u32 s23, s20, 4096
 buffer_store_dwordx4 v[30:33], v2, s[4:7], s23 offen offset:0 sc1
 v_mfma_f32_16x16x16_bf16 v[86:89], v[186:187], v[8:9], v[86:89]
 v_mfma_f32_16x16x16_bf16 v[90:93], v[188:189], v[8:9], v[90:93]
 v_mul_f32 v70, v70, v7
 v_mul_f32 v71, v71, v7
 v_mul_f32 v72, v72, v7
 v_mul_f32 v73, v73, v7
 v_mul_f32 v74, v74, v7
 v_mul_f32 v75, v75, v7
 v_mul_f32 v76, v76, v7
 v_mul_f32 v77, v77, v7
 v_cvt_pk_bf16_f32 v34, v70, v71
 v_cvt_pk_bf16_f32 v35, v72, v73
 v_cvt_pk_bf16_f32 v36, v74, v75
 v_cvt_pk_bf16_f32 v37, v76, v77
 buffer_store_dwordx4 v[34:37], v2, s[4:7], s23 offen offset:2048 sc1
 v_mul_f32 v78, v78, v7
 v_mul_f32 v79, v79, v7
 v_mul_f32 v80, v80, v7
 v_mul_f32 v81, v81, v7
 v_mul_f32 v82, v82, v7
 v_mul_f32 v83, v83, v7
 v_mul_f32 v84, v84, v7
 v_mul_f32 v85, v85, v7
 v_cvt_pk_bf16_f32 v38, v78, v79
 v_cvt_pk_bf16_f32 v39, v80, v81
 v_cvt_pk_bf16_f32 v40, v82, v83
 v_cvt_pk_bf16_f32 v41, v84, v85
 s_add_u32 s23, s20, 8192
 buffer_store_dwordx4 v[38:41], v2, s[4:7], s23 offen offset:0 sc1
 v_mul_f32 v86, v86, v7
 v_mul_f32 v87, v87, v7
 v_mul_f32 v88, v88, v7
 v_mul_f32 v89, v89, v7
 v_mul_f32 v90, v90, v7
 v_mul_f32 v91, v91, v7
 v_mul_f32 v92, v92, v7
 v_mul_f32 v93, v93, v7
 v_cvt_pk_bf16_f32 v42, v86, v87
 v_cvt_pk_bf16_f32 v43, v88, v89
 v_cvt_pk_bf16_f32 v44, v90, v91
 v_cvt_pk_bf16_f32 v45, v92, v93
 buffer_store_dwordx4 v[42:45], v2, s[4:7], s23 offen offset:2048 sc1
 s_waitcnt vmcnt(0)
 s_mov_b64 exec, 1
 v_mov_b32 v4, s27
 buffer_store_dword v4, off, s[4:7], s29 sc1
 s_mov_b64 exec, -1
 s_mov_b32 s26, s27
 s_cmp_lt_u32 s26, 64
 s_cbranch_scc1 Lat_333
 s_endpgm
L_role_gu:
 s_sub_u32 s12, s12, 208
 v_and_b32 v1, 63, v0
 v_lshlrev_b32 v2, 4, v1
 s_load_dwordx4 s[36:39], s[0:1], 64
 s_cmp_ge_u32 s12, 12
 s_cselect_b32 s25, 1, 0
 s_mul_i32 s19, s25, 12
 s_sub_u32 s19, s12, s19
 s_lshl_b32 s27, s25, 6
 s_add_u32 s27, s27, s19
 s_lshl_b32 s27, s27, 2
 s_add_u32 s27, s27, 8192
 s_lshl_b32 s26, s19, 2
 s_add_u32 s26, s26, s3
 s_lshl_b32 s23, s26, 6
 s_waitcnt lgkmcnt(0)
 s_mov_b32 s28, s36
 s_mov_b32 s29, s37
 s_mov_b32 s30, 1966080
 s_mov_b32 s31, 0x20000
 s_mov_b32 s32, s38
 s_mov_b32 s33, s39
 s_mov_b32 s34, 1966080
 s_mov_b32 s35, 0x20000
 v_lshrrev_b32 v68, 2, v1
 v_mul_u32_u24 v68, 3072, v68
 v_and_b32 v3, 3, v1
 v_lshl_add_u32 v68, v3, 4, v68
 v_lshrrev_b32 v69, 4, v1
 v_lshlrev_b32 v69, 3, v69
 v_bfe_u32 v3, v1, 2, 2
 v_add_u32 v69, v69, v3
 v_mul_u32_u24 v69, 64, v69
 v_and_b32 v3, 3, v1
 v_lshl_add_u32 v69, v3, 3, v69
 s_mul_i32 s19, s3, 40960
 s_add_u32 s19, s19, 0
 v_add_u32 v69, s19, v69
 v_lshrrev_b32 v70, 2, v1
 v_mul_u32_u24 v70, 3072, v70
 v_and_b32 v3, 3, v1
 v_lshl_add_u32 v70, v3, 4, v70
 v_lshrrev_b32 v71, 4, v1
 v_lshlrev_b32 v71, 3, v71
 v_bfe_u32 v3, v1, 2, 2
 v_add_u32 v71, v71, v3
 v_mul_u32_u24 v71, 64, v71
 v_and_b32 v3, 3, v1
 v_lshl_add_u32 v71, v3, 3, v71
 s_mul_i32 s19, s3, 40960
 s_add_u32 s19, s19, 10240
 v_add_u32 v71, s19, v71
 s_mul_i32 s19, s3, 40960
 s_add_u32 m0, s19, 0
 s_add_u32 s20, s23, 0
 buffer_load_dwordx4 v68, s[28:31], s20 offen lds
 s_add_u32 m0, s19, 1024
 s_add_u32 s20, s23, 49152
 buffer_load_dwordx4 v68, s[28:31], s20 offen lds
 s_add_u32 m0, s19, 2048
 s_add_u32 s20, s23, 98304
 buffer_load_dwordx4 v68, s[28:31], s20 offen lds
 s_add_u32 m0, s19, 3072
 s_add_u32 s20, s23, 147456
 buffer_load_dwordx4 v68, s[28:31], s20 offen lds
 s_add_u32 m0, s19, 4096
 s_add_u32 s20, s23, 196608
 buffer_load_dwordx4 v68, s[28:31], s20 offen lds
 s_add_u32 m0, s19, 5120
 s_add_u32 s20, s23, 245760
 buffer_load_dwordx4 v68, s[28:31], s20 offen lds
 s_add_u32 m0, s19, 6144
 s_add_u32 s20, s23, 294912
 buffer_load_dwordx4 v68, s[28:31], s20 offen lds
 s_add_u32 m0, s19, 7168
 s_add_u32 s20, s23, 344064
 buffer_load_dwordx4 v68, s[28:31], s20 offen lds
 s_add_u32 m0, s19, 8192
 s_add_u32 s20, s23, 393216
 buffer_load_dwordx4 v68, s[28:31], s20 offen lds
 s_add_u32 m0, s19, 9216
 s_add_u32 s20, s23, 442368
 buffer_load_dwordx4 v68, s[28:31], s20 offen lds
 s_add_u32 m0, s19, 10240
 s_add_u32 s20, s23, 0
 buffer_load_dwordx4 v70, s[32:35], s20 offen lds
 s_add_u32 m0, s19, 11264
 s_add_u32 s20, s23, 49152
 buffer_load_dwordx4 v70, s[32:35], s20 offen lds
 s_add_u32 m0, s19, 12288
 s_add_u32 s20, s23, 98304
 buffer_load_dwordx4 v70, s[32:35], s20 offen lds
 s_add_u32 m0, s19, 13312
 s_add_u32 s20, s23, 147456
 buffer_load_dwordx4 v70, s[32:35], s20 offen lds
 s_add_u32 m0, s19, 14336
 s_add_u32 s20, s23, 196608
 buffer_load_dwordx4 v70, s[32:35], s20 offen lds
 s_add_u32 m0, s19, 15360
 s_add_u32 s20, s23, 245760
 buffer_load_dwordx4 v70, s[32:35], s20 offen lds
 s_add_u32 m0, s19, 16384
 s_add_u32 s20, s23, 294912
 buffer_load_dwordx4 v70, s[32:35], s20 offen lds
 s_add_u32 m0, s19, 17408
 s_add_u32 s20, s23, 344064
 buffer_load_dwordx4 v70, s[32:35], s20 offen lds
 s_add_u32 m0, s19, 18432
 s_add_u32 s20, s23, 393216
 buffer_load_dwordx4 v70, s[32:35], s20 offen lds
 s_add_u32 m0, s19, 19456
 s_add_u32 s20, s23, 442368
 buffer_load_dwordx4 v70, s[32:35], s20 offen lds
 s_mul_i32 s19, s3, 40960
 s_add_u32 m0, s19, 20480
 s_add_u32 s20, s23, 491520
 buffer_load_dwordx4 v68, s[28:31], s20 offen lds
 s_add_u32 m0, s19, 21504
 s_add_u32 s20, s23, 540672
 buffer_load_dwordx4 v68, s[28:31], s20 offen lds
 s_add_u32 m0, s19, 22528
 s_add_u32 s20, s23, 589824
 buffer_load_dwordx4 v68, s[28:31], s20 offen lds
 s_add_u32 m0, s19, 23552
 s_add_u32 s20, s23, 638976
 buffer_load_dwordx4 v68, s[28:31], s20 offen lds
 s_add_u32 m0, s19, 24576
 s_add_u32 s20, s23, 688128
 buffer_load_dwordx4 v68, s[28:31], s20 offen lds
 s_add_u32 m0, s19, 25600
 s_add_u32 s20, s23, 737280
 buffer_load_dwordx4 v68, s[28:31], s20 offen lds
 s_add_u32 m0, s19, 26624
 s_add_u32 s20, s23, 786432
 buffer_load_dwordx4 v68, s[28:31], s20 offen lds
 s_add_u32 m0, s19, 27648
 s_add_u32 s20, s23, 835584
 buffer_load_dwordx4 v68, s[28:31], s20 offen lds
 s_add_u32 m0, s19, 28672
 s_add_u32 s20, s23, 884736
 buffer_load_dwordx4 v68, s[28:31], s20 offen lds
 s_add_u32 m0, s19, 29696
 s_add_u32 s20, s23, 933888
 buffer_load_dwordx4 v68, s[28:31], s20 offen lds
 s_add_u32 m0, s19, 30720
 s_add_u32 s20, s23, 491520
 buffer_load_dwordx4 v70, s[32:35], s20 offen lds
 s_add_u32 m0, s19, 31744
 s_add_u32 s20, s23, 540672
 buffer_load_dwordx4 v70, s[32:35], s20 offen lds
 s_add_u32 m0, s19, 32768
 s_add_u32 s20, s23, 589824
 buffer_load_dwordx4 v70, s[32:35], s20 offen lds
 s_add_u32 m0, s19, 33792
 s_add_u32 s20, s23, 638976
 buffer_load_dwordx4 v70, s[32:35], s20 offen lds
 s_add_u32 m0, s19, 34816
 s_add_u32 s20, s23, 688128
 buffer_load_dwordx4 v70, s[32:35], s20 offen lds
 s_add_u32 m0, s19, 35840
 s_add_u32 s20, s23, 737280
 buffer_load_dwordx4 v70, s[32:35], s20 offen lds
 s_add_u32 m0, s19, 36864
 s_add_u32 s20, s23, 786432
 buffer_load_dwordx4 v70, s[32:35], s20 offen lds
 s_add_u32 m0, s19, 37888
 s_add_u32 s20, s23, 835584
 buffer_load_dwordx4 v70, s[32:35], s20 offen lds
 s_add_u32 m0, s19, 38912
 s_add_u32 s20, s23, 884736
 buffer_load_dwordx4 v70, s[32:35], s20 offen lds
 s_add_u32 m0, s19, 39936
 s_add_u32 s20, s23, 933888
 buffer_load_dwordx4 v70, s[32:35], s20 offen lds
 s_waitcnt vmcnt(20)
 ds_read_b64_tr_b16 a[0:1], v69 offset:0
 ds_read_b64_tr_b16 a[2:3], v69 offset:256
 ds_read_b64_tr_b16 a[80:81], v69 offset:32
 ds_read_b64_tr_b16 a[82:83], v69 offset:288
 ds_read_b64_tr_b16 a[160:161], v71 offset:0
 ds_read_b64_tr_b16 a[162:163], v71 offset:256
 ds_read_b64_tr_b16 a[240:241], v71 offset:32
 ds_read_b64_tr_b16 a[242:243], v71 offset:288
 ds_read_b64_tr_b16 a[4:5], v69 offset:2048
 ds_read_b64_tr_b16 a[6:7], v69 offset:2304
 ds_read_b64_tr_b16 a[84:85], v69 offset:2080
 ds_read_b64_tr_b16 a[86:87], v69 offset:2336
 ds_read_b64_tr_b16 a[164:165], v71 offset:2048
 ds_read_b64_tr_b16 a[166:167], v71 offset:2304
 ds_read_b64_tr_b16 a[244:245], v71 offset:2080
 ds_read_b64_tr_b16 a[246:247], v71 offset:2336
 ds_read_b64_tr_b16 a[8:9], v69 offset:4096
 ds_read_b64_tr_b16 a[10:11], v69 offset:4352
 ds_read_b64_tr_b16 a[88:89], v69 offset:4128
 ds_read_b64_tr_b16 a[90:91], v69 offset:4384
 ds_read_b64_tr_b16 a[168:169], v71 offset:4096
 ds_read_b64_tr_b16 a[170:171], v71 offset:4352
 ds_read_b64_tr_b16 a[248:249], v71 offset:4128
 ds_read_b64_tr_b16 a[250:251], v71 offset:4384
 ds_read_b64_tr_b16 a[12:13], v69 offset:6144
 ds_read_b64_tr_b16 a[14:15], v69 offset:6400
 ds_read_b64_tr_b16 a[92:93], v69 offset:6176
 ds_read_b64_tr_b16 a[94:95], v69 offset:6432
 ds_read_b64_tr_b16 a[172:173], v71 offset:6144
 ds_read_b64_tr_b16 a[174:175], v71 offset:6400
 ds_read_b64_tr_b16 a[252:253], v71 offset:6176
 ds_read_b64_tr_b16 a[254:255], v71 offset:6432
 ds_read_b64_tr_b16 a[16:17], v69 offset:8192
 ds_read_b64_tr_b16 a[18:19], v69 offset:8448
 ds_read_b64_tr_b16 a[96:97], v69 offset:8224
 ds_read_b64_tr_b16 a[98:99], v69 offset:8480
 ds_read_b64_tr_b16 a[176:177], v71 offset:8192
 ds_read_b64_tr_b16 a[178:179], v71 offset:8448
 ds_read_b64_tr_b16 v[4:5], v71 offset:8224
 ds_read_b64_tr_b16 v[6:7], v71 offset:8480
 s_waitcnt lgkmcnt(0)
 s_mul_i32 s19, s3, 40960
 s_add_u32 m0, s19, 0
 s_add_u32 s20, s23, 983040
 buffer_load_dwordx4 v68, s[28:31], s20 offen lds
 s_add_u32 m0, s19, 1024
 s_add_u32 s20, s23, 1032192
 buffer_load_dwordx4 v68, s[28:31], s20 offen lds
 s_add_u32 m0, s19, 2048
 s_add_u32 s20, s23, 1081344
 buffer_load_dwordx4 v68, s[28:31], s20 offen lds
 s_add_u32 m0, s19, 3072
 s_add_u32 s20, s23, 1130496
 buffer_load_dwordx4 v68, s[28:31], s20 offen lds
 s_add_u32 m0, s19, 4096
 s_add_u32 s20, s23, 1179648
 buffer_load_dwordx4 v68, s[28:31], s20 offen lds
 s_add_u32 m0, s19, 5120
 s_add_u32 s20, s23, 1228800
 buffer_load_dwordx4 v68, s[28:31], s20 offen lds
 s_add_u32 m0, s19, 6144
 s_add_u32 s20, s23, 1277952
 buffer_load_dwordx4 v68, s[28:31], s20 offen lds
 s_add_u32 m0, s19, 7168
 s_add_u32 s20, s23, 1327104
 buffer_load_dwordx4 v68, s[28:31], s20 offen lds
 s_add_u32 m0, s19, 8192
 s_add_u32 s20, s23, 1376256
 buffer_load_dwordx4 v68, s[28:31], s20 offen lds
 s_add_u32 m0, s19, 9216
 s_add_u32 s20, s23, 1425408
 buffer_load_dwordx4 v68, s[28:31], s20 offen lds
 s_add_u32 m0, s19, 10240
 s_add_u32 s20, s23, 983040
 buffer_load_dwordx4 v70, s[32:35], s20 offen lds
 s_add_u32 m0, s19, 11264
 s_add_u32 s20, s23, 1032192
 buffer_load_dwordx4 v70, s[32:35], s20 offen lds
 s_add_u32 m0, s19, 12288
 s_add_u32 s20, s23, 1081344
 buffer_load_dwordx4 v70, s[32:35], s20 offen lds
 s_add_u32 m0, s19, 13312
 s_add_u32 s20, s23, 1130496
 buffer_load_dwordx4 v70, s[32:35], s20 offen lds
 s_add_u32 m0, s19, 14336
 s_add_u32 s20, s23, 1179648
 buffer_load_dwordx4 v70, s[32:35], s20 offen lds
 s_add_u32 m0, s19, 15360
 s_add_u32 s20, s23, 1228800
 buffer_load_dwordx4 v70, s[32:35], s20 offen lds
 s_add_u32 m0, s19, 16384
 s_add_u32 s20, s23, 1277952
 buffer_load_dwordx4 v70, s[32:35], s20 offen lds
 s_add_u32 m0, s19, 17408
 s_add_u32 s20, s23, 1327104
 buffer_load_dwordx4 v70, s[32:35], s20 offen lds
 s_add_u32 m0, s19, 18432
 s_add_u32 s20, s23, 1376256
 buffer_load_dwordx4 v70, s[32:35], s20 offen lds
 s_add_u32 m0, s19, 19456
 s_add_u32 s20, s23, 1425408
 buffer_load_dwordx4 v70, s[32:35], s20 offen lds
 s_waitcnt vmcnt(20)
 ds_read_b64_tr_b16 a[20:21], v69 offset:20480
 ds_read_b64_tr_b16 a[22:23], v69 offset:20736
 ds_read_b64_tr_b16 a[100:101], v69 offset:20512
 ds_read_b64_tr_b16 a[102:103], v69 offset:20768
 ds_read_b64_tr_b16 a[180:181], v71 offset:20480
 ds_read_b64_tr_b16 a[182:183], v71 offset:20736
 ds_read_b64_tr_b16 v[8:9], v71 offset:20512
 ds_read_b64_tr_b16 v[10:11], v71 offset:20768
 ds_read_b64_tr_b16 a[24:25], v69 offset:22528
 ds_read_b64_tr_b16 a[26:27], v69 offset:22784
 ds_read_b64_tr_b16 a[104:105], v69 offset:22560
 ds_read_b64_tr_b16 a[106:107], v69 offset:22816
 ds_read_b64_tr_b16 a[184:185], v71 offset:22528
 ds_read_b64_tr_b16 a[186:187], v71 offset:22784
 ds_read_b64_tr_b16 v[12:13], v71 offset:22560
 ds_read_b64_tr_b16 v[14:15], v71 offset:22816
 ds_read_b64_tr_b16 a[28:29], v69 offset:24576
 ds_read_b64_tr_b16 a[30:31], v69 offset:24832
 ds_read_b64_tr_b16 a[108:109], v69 offset:24608
 ds_read_b64_tr_b16 a[110:111], v69 offset:24864
 ds_read_b64_tr_b16 a[188:189], v71 offset:24576
 ds_read_b64_tr_b16 a[190:191], v71 offset:24832
 ds_read_b64_tr_b16 v[16:17], v71 offset:24608
 ds_read_b64_tr_b16 v[18:19], v71 offset:24864
 ds_read_b64_tr_b16 a[32:33], v69 offset:26624
 ds_read_b64_tr_b16 a[34:35], v69 offset:26880
 ds_read_b64_tr_b16 a[112:113], v69 offset:26656
 ds_read_b64_tr_b16 a[114:115], v69 offset:26912
 ds_read_b64_tr_b16 a[192:193], v71 offset:26624
 ds_read_b64_tr_b16 a[194:195], v71 offset:26880
 ds_read_b64_tr_b16 v[20:21], v71 offset:26656
 ds_read_b64_tr_b16 v[22:23], v71 offset:26912
 ds_read_b64_tr_b16 a[36:37], v69 offset:28672
 ds_read_b64_tr_b16 a[38:39], v69 offset:28928
 ds_read_b64_tr_b16 a[116:117], v69 offset:28704
 ds_read_b64_tr_b16 a[118:119], v69 offset:28960
 ds_read_b64_tr_b16 a[196:197], v71 offset:28672
 ds_read_b64_tr_b16 a[198:199], v71 offset:28928
 ds_read_b64_tr_b16 v[24:25], v71 offset:28704
 ds_read_b64_tr_b16 v[26:27], v71 offset:28960
 s_waitcnt lgkmcnt(0)
 s_mul_i32 s19, s3, 40960
 s_add_u32 m0, s19, 20480
 s_add_u32 s20, s23, 1474560
 buffer_load_dwordx4 v68, s[28:31], s20 offen lds
 s_add_u32 m0, s19, 21504
 s_add_u32 s20, s23, 1523712
 buffer_load_dwordx4 v68, s[28:31], s20 offen lds
 s_add_u32 m0, s19, 22528
 s_add_u32 s20, s23, 1572864
 buffer_load_dwordx4 v68, s[28:31], s20 offen lds
 s_add_u32 m0, s19, 23552
 s_add_u32 s20, s23, 1622016
 buffer_load_dwordx4 v68, s[28:31], s20 offen lds
 s_add_u32 m0, s19, 24576
 s_add_u32 s20, s23, 1671168
 buffer_load_dwordx4 v68, s[28:31], s20 offen lds
 s_add_u32 m0, s19, 25600
 s_add_u32 s20, s23, 1720320
 buffer_load_dwordx4 v68, s[28:31], s20 offen lds
 s_add_u32 m0, s19, 26624
 s_add_u32 s20, s23, 1769472
 buffer_load_dwordx4 v68, s[28:31], s20 offen lds
 s_add_u32 m0, s19, 27648
 s_add_u32 s20, s23, 1818624
 buffer_load_dwordx4 v68, s[28:31], s20 offen lds
 s_add_u32 m0, s19, 28672
 s_add_u32 s20, s23, 1867776
 buffer_load_dwordx4 v68, s[28:31], s20 offen lds
 s_add_u32 m0, s19, 29696
 s_add_u32 s20, s23, 1916928
 buffer_load_dwordx4 v68, s[28:31], s20 offen lds
 s_add_u32 m0, s19, 30720
 s_add_u32 s20, s23, 1474560
 buffer_load_dwordx4 v70, s[32:35], s20 offen lds
 s_add_u32 m0, s19, 31744
 s_add_u32 s20, s23, 1523712
 buffer_load_dwordx4 v70, s[32:35], s20 offen lds
 s_add_u32 m0, s19, 32768
 s_add_u32 s20, s23, 1572864
 buffer_load_dwordx4 v70, s[32:35], s20 offen lds
 s_add_u32 m0, s19, 33792
 s_add_u32 s20, s23, 1622016
 buffer_load_dwordx4 v70, s[32:35], s20 offen lds
 s_add_u32 m0, s19, 34816
 s_add_u32 s20, s23, 1671168
 buffer_load_dwordx4 v70, s[32:35], s20 offen lds
 s_add_u32 m0, s19, 35840
 s_add_u32 s20, s23, 1720320
 buffer_load_dwordx4 v70, s[32:35], s20 offen lds
 s_add_u32 m0, s19, 36864
 s_add_u32 s20, s23, 1769472
 buffer_load_dwordx4 v70, s[32:35], s20 offen lds
 s_add_u32 m0, s19, 37888
 s_add_u32 s20, s23, 1818624
 buffer_load_dwordx4 v70, s[32:35], s20 offen lds
 s_add_u32 m0, s19, 38912
 s_add_u32 s20, s23, 1867776
 buffer_load_dwordx4 v70, s[32:35], s20 offen lds
 s_add_u32 m0, s19, 39936
 s_add_u32 s20, s23, 1916928
 buffer_load_dwordx4 v70, s[32:35], s20 offen lds
 s_waitcnt vmcnt(20)
 ds_read_b64_tr_b16 a[40:41], v69 offset:0
 ds_read_b64_tr_b16 a[42:43], v69 offset:256
 ds_read_b64_tr_b16 a[120:121], v69 offset:32
 ds_read_b64_tr_b16 a[122:123], v69 offset:288
 ds_read_b64_tr_b16 a[200:201], v71 offset:0
 ds_read_b64_tr_b16 a[202:203], v71 offset:256
 ds_read_b64_tr_b16 v[28:29], v71 offset:32
 ds_read_b64_tr_b16 v[30:31], v71 offset:288
 ds_read_b64_tr_b16 a[44:45], v69 offset:2048
 ds_read_b64_tr_b16 a[46:47], v69 offset:2304
 ds_read_b64_tr_b16 a[124:125], v69 offset:2080
 ds_read_b64_tr_b16 a[126:127], v69 offset:2336
 ds_read_b64_tr_b16 a[204:205], v71 offset:2048
 ds_read_b64_tr_b16 a[206:207], v71 offset:2304
 ds_read_b64_tr_b16 v[32:33], v71 offset:2080
 ds_read_b64_tr_b16 v[34:35], v71 offset:2336
 ds_read_b64_tr_b16 a[48:49], v69 offset:4096
 ds_read_b64_tr_b16 a[50:51], v69 offset:4352
 ds_read_b64_tr_b16 a[128:129], v69 offset:4128
 ds_read_b64_tr_b16 a[130:131], v69 offset:4384
 ds_read_b64_tr_b16 a[208:209], v71 offset:4096
 ds_read_b64_tr_b16 a[210:211], v71 offset:4352
 ds_read_b64_tr_b16 v[36:37], v71 offset:4128
 ds_read_b64_tr_b16 v[38:39], v71 offset:4384
 ds_read_b64_tr_b16 a[52:53], v69 offset:6144
 ds_read_b64_tr_b16 a[54:55], v69 offset:6400
 ds_read_b64_tr_b16 a[132:133], v69 offset:6176
 ds_read_b64_tr_b16 a[134:135], v69 offset:6432
 ds_read_b64_tr_b16 a[212:213], v71 offset:6144
 ds_read_b64_tr_b16 a[214:215], v71 offset:6400
 ds_read_b64_tr_b16 v[40:41], v71 offset:6176
 ds_read_b64_tr_b16 v[42:43], v71 offset:6432
 ds_read_b64_tr_b16 a[56:57], v69 offset:8192
 ds_read_b64_tr_b16 a[58:59], v69 offset:8448
 ds_read_b64_tr_b16 a[136:137], v69 offset:8224
 ds_read_b64_tr_b16 a[138:139], v69 offset:8480
 ds_read_b64_tr_b16 a[216:217], v71 offset:8192
 ds_read_b64_tr_b16 a[218:219], v71 offset:8448
 ds_read_b64_tr_b16 v[44:45], v71 offset:8224
 ds_read_b64_tr_b16 v[46:47], v71 offset:8480
 s_waitcnt lgkmcnt(0)
 s_waitcnt vmcnt(0)
 ds_read_b64_tr_b16 a[60:61], v69 offset:20480
 ds_read_b64_tr_b16 a[62:63], v69 offset:20736
 ds_read_b64_tr_b16 a[140:141], v69 offset:20512
 ds_read_b64_tr_b16 a[142:143], v69 offset:20768
 ds_read_b64_tr_b16 a[220:221], v71 offset:20480
 ds_read_b64_tr_b16 a[222:223], v71 offset:20736
 ds_read_b64_tr_b16 v[48:49], v71 offset:20512
 ds_read_b64_tr_b16 v[50:51], v71 offset:20768
 ds_read_b64_tr_b16 a[64:65], v69 offset:22528
 ds_read_b64_tr_b16 a[66:67], v69 offset:22784
 ds_read_b64_tr_b16 a[144:145], v69 offset:22560
 ds_read_b64_tr_b16 a[146:147], v69 offset:22816
 ds_read_b64_tr_b16 a[224:225], v71 offset:22528
 ds_read_b64_tr_b16 a[226:227], v71 offset:22784
 ds_read_b64_tr_b16 v[52:53], v71 offset:22560
 ds_read_b64_tr_b16 v[54:55], v71 offset:22816
 ds_read_b64_tr_b16 a[68:69], v69 offset:24576
 ds_read_b64_tr_b16 a[70:71], v69 offset:24832
 ds_read_b64_tr_b16 a[148:149], v69 offset:24608
 ds_read_b64_tr_b16 a[150:151], v69 offset:24864
 ds_read_b64_tr_b16 a[228:229], v71 offset:24576
 ds_read_b64_tr_b16 a[230:231], v71 offset:24832
 ds_read_b64_tr_b16 v[56:57], v71 offset:24608
 ds_read_b64_tr_b16 v[58:59], v71 offset:24864
 ds_read_b64_tr_b16 a[72:73], v69 offset:26624
 ds_read_b64_tr_b16 a[74:75], v69 offset:26880
 ds_read_b64_tr_b16 a[152:153], v69 offset:26656
 ds_read_b64_tr_b16 a[154:155], v69 offset:26912
 ds_read_b64_tr_b16 a[232:233], v71 offset:26624
 ds_read_b64_tr_b16 a[234:235], v71 offset:26880
 ds_read_b64_tr_b16 v[60:61], v71 offset:26656
 ds_read_b64_tr_b16 v[62:63], v71 offset:26912
 ds_read_b64_tr_b16 a[76:77], v69 offset:28672
 ds_read_b64_tr_b16 a[78:79], v69 offset:28928
 ds_read_b64_tr_b16 a[156:157], v69 offset:28704
 ds_read_b64_tr_b16 a[158:159], v69 offset:28960
 ds_read_b64_tr_b16 a[236:237], v71 offset:28672
 ds_read_b64_tr_b16 a[238:239], v71 offset:28928
 ds_read_b64_tr_b16 v[64:65], v71 offset:28704
 ds_read_b64_tr_b16 v[66:67], v71 offset:28960
 s_waitcnt lgkmcnt(0)
 s_barrier
 s_cmp_eq_u32 s13, 1
 s_cbranch_scc1 Lverok_337
 s_mov_b32 s18, 0
Lver_336:
 s_add_u32 s18, s18, 1
 s_cmp_gt_u32 s18, 200000
 s_cbranch_scc1 L_fail
 v_and_b32 v254, 7, v0
 v_lshlrev_b32 v254, 2, v254
 buffer_load_dword v255, v254, s[8:11], 0 offen sc1
 s_waitcnt vmcnt(0)
 v_cmp_eq_u32 vcc, 32, v255
 s_nop 0
 s_cmp_eq_u64 vcc, -1
 s_cbranch_scc1 Lverok_337
 s_mov_b32 s17, 0
 v_readlane_b32 s14, v255, 0
 s_nop 0
 s_add_u32 s17, s17, s14
 v_readlane_b32 s14, v255, 1
 s_nop 0
 s_add_u32 s17, s17, s14
 v_readlane_b32 s14, v255, 2
 s_nop 0
 s_add_u32 s17, s17, s14
 v_readlane_b32 s14, v255, 3
 s_nop 0
 s_add_u32 s17, s17, s14
 v_readlane_b32 s14, v255, 4
 s_nop 0
 s_add_u32 s17, s17, s14
 v_readlane_b32 s14, v255, 5
 s_nop 0
 s_add_u32 s17, s17, s14
 v_readlane_b32 s14, v255, 6
 s_nop 0
 s_add_u32 s17, s17, s14
 v_readlane_b32 s14, v255, 7
 s_nop 0
 s_add_u32 s17, s17, s14
 s_cmp_eq_u32 s17, 256
 s_cbranch_scc1 L_fallback
 s_branch Lver_336
Lverok_337:
 v_lshrrev_b32 v70, 3, v1
 s_lshl_b32 s19, s3, 3
 v_add_u32 v70, s19, v70
 v_bfe_u32 v71, v70, 1, 3
 v_mul_u32_u24 v70, 1280, v70
 v_and_b32 v3, 7, v1
 v_xor_b32 v3, v3, v71
 v_lshl_add_u32 v3, v3, 4, v70
 v_and_b32 v70, 15, v1
 v_bfe_u32 v71, v1, 1, 3
 v_lshrrev_b32 v68, 4, v1
 v_add_u32 v69, 4, v68
 v_xor_b32 v68, v68, v71
 v_xor_b32 v69, v69, v71
 v_lshlrev_b32 v70, 7, v70
 v_lshl_add_u32 v68, v68, 4, v70
 v_lshl_add_u32 v69, v69, 4, v70
 v_and_b32 v71, 31, v1
 v_lshlrev_b32 v71, 2, v71
 s_lshl_b32 s19, s25, 8
 s_add_u32 s19, s19, 7168
 v_add_u32 v71, s19, v71
 s_lshl_b32 s41, s3, 10
 s_mov_b32 s42, 0xbfb8aa3b
 s_mov_b32 s43, 0
Lgu_338:
 s_add_u32 s44, s43, 1
 s_mov_b32 s24, 0
Lw_339:
 s_add_u32 s24, s24, 1
 s_cmp_gt_u32 s24, 200000
 s_cbranch_scc1 L_fail
 buffer_load_dword v70, v71, s[4:7], 0 offen sc1
 s_waitcnt vmcnt(0)
 v_cmp_le_u32 vcc, s44, v70
 s_nop 0
 s_cmp_eq_u64 vcc, -1
 s_cbranch_scc0 Lw_339
 s_mul_i32 s40, s43, 40960
 s_add_u32 s40, s40, 189972480
 s_add_u32 m0, s41, 0
 s_nop 0
 buffer_load_dwordx4 v3, s[4:7], s40 offen offset:0 sc1 lds
 s_add_u32 m0, s41, 3968
 s_nop 0
 buffer_load_dwordx4 v3, s[4:7], s40 offen offset:128 sc1 lds
 s_add_u32 m0, s41, 7936
 s_nop 0
 buffer_load_dwordx4 v3, s[4:7], s40 offen offset:256 sc1 lds
 s_add_u32 m0, s41, 11904
 s_nop 0
 buffer_load_dwordx4 v3, s[4:7], s40 offen offset:384 sc1 lds
 s_add_u32 m0, s41, 15872
 s_nop 0
 buffer_load_dwordx4 v3, s[4:7], s40 offen offset:512 sc1 lds
 s_add_u32 m0, s41, 19840
 s_nop 0
 buffer_load_dwordx4 v3, s[4:7], s40 offen offset:640 sc1 lds
 s_add_u32 m0, s41, 23808
 s_nop 0
 buffer_load_dwordx4 v3, s[4:7], s40 offen offset:768 sc1 lds
 s_add_u32 m0, s41, 27776
 s_nop 0
 buffer_load_dwordx4 v3, s[4:7], s40 offen offset:896 sc1 lds
 s_add_u32 m0, s41, 31744
 s_nop 0
 buffer_load_dwordx4 v3, s[4:7], s40 offen offset:1024 sc1 lds
 s_add_u32 m0, s41, 35712
 s_nop 0
 buffer_load_dwordx4 v3, s[4:7], s40 offen offset:1152 sc1 lds
 s_waitcnt vmcnt(8)
 s_barrier
 ds_read_b128 v[104:107], v68 offset:0
 ds_read_b128 v[108:111], v68 offset:2048
 ds_read_b128 v[112:115], v69 offset:0
 ds_read_b128 v[116:119], v69 offset:2048
 ds_read_b128 v[120:123], v68 offset:4096
 ds_read_b128 v[124:127], v68 offset:6144
 s_waitcnt lgkmcnt(5)
 v_mfma_f32_16x16x32_bf16 v[72:75], a[0:3], v[104:107], 0
 v_mfma_f32_16x16x32_bf16 v[80:83], a[80:83], v[104:107], 0
 v_mfma_f32_16x16x32_bf16 v[88:91], a[160:163], v[104:107], 0
 v_mfma_f32_16x16x32_bf16 v[96:99], a[240:243], v[104:107], 0
 s_waitcnt lgkmcnt(4)
 v_mfma_f32_16x16x32_bf16 v[76:79], a[0:3], v[108:111], 0
 v_mfma_f32_16x16x32_bf16 v[84:87], a[80:83], v[108:111], 0
 v_mfma_f32_16x16x32_bf16 v[92:95], a[160:163], v[108:111], 0
 v_mfma_f32_16x16x32_bf16 v[100:103], a[240:243], v[108:111], 0
 ds_read_b128 v[104:107], v69 offset:4096
 ds_read_b128 v[108:111], v69 offset:6144
 s_waitcnt lgkmcnt(4)
 v_mfma_f32_16x16x32_bf16 v[72:75], a[4:7], v[112:115], v[72:75]
 v_mfma_f32_16x16x32_bf16 v[80:83], a[84:87], v[112:115], v[80:83]
 v_mfma_f32_16x16x32_bf16 v[88:91], a[164:167], v[112:115], v[88:91]
 v_mfma_f32_16x16x32_bf16 v[96:99], a[244:247], v[112:115], v[96:99]
 v_mfma_f32_16x16x32_bf16 v[76:79], a[4:7], v[116:119], v[76:79]
 v_mfma_f32_16x16x32_bf16 v[84:87], a[84:87], v[116:119], v[84:87]
 v_mfma_f32_16x16x32_bf16 v[92:95], a[164:167], v[116:119], v[92:95]
 v_mfma_f32_16x16x32_bf16 v[100:103], a[244:247], v[116:119], v[100:103]
 s_waitcnt vmcnt(6)
 s_barrier
 ds_read_b128 v[112:115], v68 offset:8192
 ds_read_b128 v[116:119], v68 offset:10240
 s_waitcnt lgkmcnt(4)
 v_mfma_f32_16x16x32_bf16 v[72:75], a[8:11], v[120:123], v[72:75]
 v_mfma_f32_16x16x32_bf16 v[80:83], a[88:91], v[120:123], v[80:83]
 v_mfma_f32_16x16x32_bf16 v[88:91], a[168:171], v[120:123], v[88:91]
 v_mfma_f32_16x16x32_bf16 v[96:99], a[248:251], v[120:123], v[96:99]
 v_mfma_f32_16x16x32_bf16 v[76:79], a[8:11], v[124:127], v[76:79]
 v_mfma_f32_16x16x32_bf16 v[84:87], a[88:91], v[124:127], v[84:87]
 v_mfma_f32_16x16x32_bf16 v[92:95], a[168:171], v[124:127], v[92:95]
 v_mfma_f32_16x16x32_bf16 v[100:103], a[248:251], v[124:127], v[100:103]
 ds_read_b128 v[120:123], v69 offset:8192
 ds_read_b128 v[124:127], v69 offset:10240
 s_waitcnt lgkmcnt(4)
 v_mfma_f32_16x16x32_bf16 v[72:75], a[12:15], v[104:107], v[72:75]
 v_mfma_f32_16x16x32_bf16 v[80:83], a[92:95], v[104:107], v[80:83]
 v_mfma_f32_16x16x32_bf16 v[88:91], a[172:175], v[104:107], v[88:91]
 v_mfma_f32_16x16x32_bf16 v[96:99], a[252:255], v[104:107], v[96:99]
 v_mfma_f32_16x16x32_bf16 v[76:79], a[12:15], v[108:111], v[76:79]
 v_mfma_f32_16x16x32_bf16 v[84:87], a[92:95], v[108:111], v[84:87]
 v_mfma_f32_16x16x32_bf16 v[92:95], a[172:175], v[108:111], v[92:95]
 v_mfma_f32_16x16x32_bf16 v[100:103], a[252:255], v[108:111], v[100:103]
 ds_read_b128 v[104:107], v68 offset:12288
 ds_read_b128 v[108:111], v68 offset:14336
 s_waitcnt lgkmcnt(4)
 v_mfma_f32_16x16x32_bf16 v[72:75], a[16:19], v[112:115], v[72:75]
 v_mfma_f32_16x16x32_bf16 v[80:83], a[96:99], v[112:115], v[80:83]
 v_mfma_f32_16x16x32_bf16 v[88:91], a[176:179], v[112:115], v[88:91]
 v_mfma_f32_16x16x32_bf16 v[96:99], v[4:7], v[112:115], v[96:99]
 v_mfma_f32_16x16x32_bf16 v[76:79], a[16:19], v[116:119], v[76:79]
 v_mfma_f32_16x16x32_bf16 v[84:87], a[96:99], v[116:119], v[84:87]
 v_mfma_f32_16x16x32_bf16 v[92:95], a[176:179], v[116:119], v[92:95]
 v_mfma_f32_16x16x32_bf16 v[100:103], v[4:7], v[116:119], v[100:103]
 ds_read_b128 v[112:115], v69 offset:12288
 ds_read_b128 v[116:119], v69 offset:14336
 s_waitcnt lgkmcnt(4)
 v_mfma_f32_16x16x32_bf16 v[72:75], a[20:23], v[120:123], v[72:75]
 v_mfma_f32_16x16x32_bf16 v[80:83], a[100:103], v[120:123], v[80:83]
 v_mfma_f32_16x16x32_bf16 v[88:91], a[180:183], v[120:123], v[88:91]
 v_mfma_f32_16x16x32_bf16 v[96:99], v[8:11], v[120:123], v[96:99]
 v_mfma_f32_16x16x32_bf16 v[76:79], a[20:23], v[124:127], v[76:79]
 v_mfma_f32_16x16x32_bf16 v[84:87], a[100:103], v[124:127], v[84:87]
 v_mfma_f32_16x16x32_bf16 v[92:95], a[180:183], v[124:127], v[92:95]
 v_mfma_f32_16x16x32_bf16 v[100:103], v[8:11], v[124:127], v[100:103]
 s_waitcnt vmcnt(4)
 s_barrier
 ds_read_b128 v[120:123], v68 offset:16384
 ds_read_b128 v[124:127], v68 offset:18432
 s_waitcnt lgkmcnt(4)
 v_mfma_f32_16x16x32_bf16 v[72:75], a[24:27], v[104:107], v[72:75]
 v_mfma_f32_16x16x32_bf16 v[80:83], a[104:107], v[104:107], v[80:83]
 v_mfma_f32_16x16x32_bf16 v[88:91], a[184:187], v[104:107], v[88:91]
 v_mfma_f32_16x16x32_bf16 v[96:99], v[12:15], v[104:107], v[96:99]
 v_mfma_f32_16x16x32_bf16 v[76:79], a[24:27], v[108:111], v[76:79]
 v_mfma_f32_16x16x32_bf16 v[84:87], a[104:107], v[108:111], v[84:87]
 v_mfma_f32_16x16x32_bf16 v[92:95], a[184:187], v[108:111], v[92:95]
 v_mfma_f32_16x16x32_bf16 v[100:103], v[12:15], v[108:111], v[100:103]
 ds_read_b128 v[104:107], v69 offset:16384
 ds_read_b128 v[108:111], v69 offset:18432
 s_waitcnt lgkmcnt(4)
 v_mfma_f32_16x16x32_bf16 v[72:75], a[28:31], v[112:115], v[72:75]
 v_mfma_f32_16x16x32_bf16 v[80:83], a[108:111], v[112:115], v[80:83]
 v_mfma_f32_16x16x32_bf16 v[88:91], a[188:191], v[112:115], v[88:91]
 v_mfma_f32_16x16x32_bf16 v[96:99], v[16:19], v[112:115], v[96:99]
 v_mfma_f32_16x16x32_bf16 v[76:79], a[28:31], v[116:119], v[76:79]
 v_mfma_f32_16x16x32_bf16 v[84:87], a[108:111], v[116:119], v[84:87]
 v_mfma_f32_16x16x32_bf16 v[92:95], a[188:191], v[116:119], v[92:95]
 v_mfma_f32_16x16x32_bf16 v[100:103], v[16:19], v[116:119], v[100:103]
 ds_read_b128 v[112:115], v68 offset:20480
 ds_read_b128 v[116:119], v68 offset:22528
 s_waitcnt lgkmcnt(4)
 v_mfma_f32_16x16x32_bf16 v[72:75], a[32:35], v[120:123], v[72:75]
 v_mfma_f32_16x16x32_bf16 v[80:83], a[112:115], v[120:123], v[80:83]
 v_mfma_f32_16x16x32_bf16 v[88:91], a[192:195], v[120:123], v[88:91]
 v_mfma_f32_16x16x32_bf16 v[96:99], v[20:23], v[120:123], v[96:99]
 v_mfma_f32_16x16x32_bf16 v[76:79], a[32:35], v[124:127], v[76:79]
 v_mfma_f32_16x16x32_bf16 v[84:87], a[112:115], v[124:127], v[84:87]
 v_mfma_f32_16x16x32_bf16 v[92:95], a[192:195], v[124:127], v[92:95]
 v_mfma_f32_16x16x32_bf16 v[100:103], v[20:23], v[124:127], v[100:103]
 ds_read_b128 v[120:123], v69 offset:20480
 ds_read_b128 v[124:127], v69 offset:22528
 s_waitcnt lgkmcnt(4)
 v_mfma_f32_16x16x32_bf16 v[72:75], a[36:39], v[104:107], v[72:75]
 v_mfma_f32_16x16x32_bf16 v[80:83], a[116:119], v[104:107], v[80:83]
 v_mfma_f32_16x16x32_bf16 v[88:91], a[196:199], v[104:107], v[88:91]
 v_mfma_f32_16x16x32_bf16 v[96:99], v[24:27], v[104:107], v[96:99]
 v_mfma_f32_16x16x32_bf16 v[76:79], a[36:39], v[108:111], v[76:79]
 v_mfma_f32_16x16x32_bf16 v[84:87], a[116:119], v[108:111], v[84:87]
 v_mfma_f32_16x16x32_bf16 v[92:95], a[196:199], v[108:111], v[92:95]
 v_mfma_f32_16x16x32_bf16 v[100:103], v[24:27], v[108:111], v[100:103]
 s_waitcnt vmcnt(2)
 s_barrier
 ds_read_b128 v[104:107], v68 offset:24576
 ds_read_b128 v[108:111], v68 offset:26624
 s_waitcnt lgkmcnt(4)
 v_mfma_f32_16x16x32_bf16 v[72:75], a[40:43], v[112:115], v[72:75]
 v_mfma_f32_16x16x32_bf16 v[80:83], a[120:123], v[112:115], v[80:83]
 v_mfma_f32_16x16x32_bf16 v[88:91], a[200:203], v[112:115], v[88:91]
 v_mfma_f32_16x16x32_bf16 v[96:99], v[28:31], v[112:115], v[96:99]
 v_mfma_f32_16x16x32_bf16 v[76:79], a[40:43], v[116:119], v[76:79]
 v_mfma_f32_16x16x32_bf16 v[84:87], a[120:123], v[116:119], v[84:87]
 v_mfma_f32_16x16x32_bf16 v[92:95], a[200:203], v[116:119], v[92:95]
 v_mfma_f32_16x16x32_bf16 v[100:103], v[28:31], v[116:119], v[100:103]
 ds_read_b128 v[112:115], v69 offset:24576
 ds_read_b128 v[116:119], v69 offset:26624
 s_waitcnt lgkmcnt(4)
 v_mfma_f32_16x16x32_bf16 v[72:75], a[44:47], v[120:123], v[72:75]
 v_mfma_f32_16x16x32_bf16 v[80:83], a[124:127], v[120:123], v[80:83]
 v_mfma_f32_16x16x32_bf16 v[88:91], a[204:207], v[120:123], v[88:91]
 v_mfma_f32_16x16x32_bf16 v[96:99], v[32:35], v[120:123], v[96:99]
 v_mfma_f32_16x16x32_bf16 v[76:79], a[44:47], v[124:127], v[76:79]
 v_mfma_f32_16x16x32_bf16 v[84:87], a[124:127], v[124:127], v[84:87]
 v_mfma_f32_16x16x32_bf16 v[92:95], a[204:207], v[124:127], v[92:95]
 v_mfma_f32_16x16x32_bf16 v[100:103], v[32:35], v[124:127], v[100:103]
 ds_read_b128 v[120:123], v68 offset:28672
 ds_read_b128 v[124:127], v68 offset:30720
 s_waitcnt lgkmcnt(4)
 v_mfma_f32_16x16x32_bf16 v[72:75], a[48:51], v[104:107], v[72:75]
 v_mfma_f32_16x16x32_bf16 v[80:83], a[128:131], v[104:107], v[80:83]
 v_mfma_f32_16x16x32_bf16 v[88:91], a[208:211], v[104:107], v[88:91]
 v_mfma_f32_16x16x32_bf16 v[96:99], v[36:39], v[104:107], v[96:99]
 v_mfma_f32_16x16x32_bf16 v[76:79], a[48:51], v[108:111], v[76:79]
 v_mfma_f32_16x16x32_bf16 v[84:87], a[128:131], v[108:111], v[84:87]
 v_mfma_f32_16x16x32_bf16 v[92:95], a[208:211], v[108:111], v[92:95]
 v_mfma_f32_16x16x32_bf16 v[100:103], v[36:39], v[108:111], v[100:103]
 ds_read_b128 v[104:107], v69 offset:28672
 ds_read_b128 v[108:111], v69 offset:30720
 s_waitcnt lgkmcnt(4)
 v_mfma_f32_16x16x32_bf16 v[72:75], a[52:55], v[112:115], v[72:75]
 v_mfma_f32_16x16x32_bf16 v[80:83], a[132:135], v[112:115], v[80:83]
 v_mfma_f32_16x16x32_bf16 v[88:91], a[212:215], v[112:115], v[88:91]
 v_mfma_f32_16x16x32_bf16 v[96:99], v[40:43], v[112:115], v[96:99]
 v_mfma_f32_16x16x32_bf16 v[76:79], a[52:55], v[116:119], v[76:79]
 v_mfma_f32_16x16x32_bf16 v[84:87], a[132:135], v[116:119], v[84:87]
 v_mfma_f32_16x16x32_bf16 v[92:95], a[212:215], v[116:119], v[92:95]
 v_mfma_f32_16x16x32_bf16 v[100:103], v[40:43], v[116:119], v[100:103]
 s_waitcnt vmcnt(0)
 s_barrier
 ds_read_b128 v[112:115], v68 offset:32768
 ds_read_b128 v[116:119], v68 offset:34816
 s_waitcnt lgkmcnt(4)
 v_mfma_f32_16x16x32_bf16 v[72:75], a[56:59], v[120:123], v[72:75]
 v_mfma_f32_16x16x32_bf16 v[80:83], a[136:139], v[120:123], v[80:83]
 v_mfma_f32_16x16x32_bf16 v[88:91], a[216:219], v[120:123], v[88:91]
 v_mfma_f32_16x16x32_bf16 v[96:99], v[44:47], v[120:123], v[96:99]
 v_mfma_f32_16x16x32_bf16 v[76:79], a[56:59], v[124:127], v[76:79]
 v_mfma_f32_16x16x32_bf16 v[84:87], a[136:139], v[124:127], v[84:87]
 v_mfma_f32_16x16x32_bf16 v[92:95], a[216:219], v[124:127], v[92:95]
 v_mfma_f32_16x16x32_bf16 v[100:103], v[44:47], v[124:127], v[100:103]
 ds_read_b128 v[120:123], v69 offset:32768
 ds_read_b128 v[124:127], v69 offset:34816
 s_waitcnt lgkmcnt(4)
 v_mfma_f32_16x16x32_bf16 v[72:75], a[60:63], v[104:107], v[72:75]
 v_mfma_f32_16x16x32_bf16 v[80:83], a[140:143], v[104:107], v[80:83]
 v_mfma_f32_16x16x32_bf16 v[88:91], a[220:223], v[104:107], v[88:91]
 v_mfma_f32_16x16x32_bf16 v[96:99], v[48:51], v[104:107], v[96:99]
 v_mfma_f32_16x16x32_bf16 v[76:79], a[60:63], v[108:111], v[76:79]
 v_mfma_f32_16x16x32_bf16 v[84:87], a[140:143], v[108:111], v[84:87]
 v_mfma_f32_16x16x32_bf16 v[92:95], a[220:223], v[108:111], v[92:95]
 v_mfma_f32_16x16x32_bf16 v[100:103], v[48:51], v[108:111], v[100:103]
 ds_read_b128 v[104:107], v68 offset:36864
 ds_read_b128 v[108:111], v68 offset:38912
 s_waitcnt lgkmcnt(4)
 v_mfma_f32_16x16x32_bf16 v[72:75], a[64:67], v[112:115], v[72:75]
 v_mfma_f32_16x16x32_bf16 v[80:83], a[144:147], v[112:115], v[80:83]
 v_mfma_f32_16x16x32_bf16 v[88:91], a[224:227], v[112:115], v[88:91]
 v_mfma_f32_16x16x32_bf16 v[96:99], v[52:55], v[112:115], v[96:99]
 v_mfma_f32_16x16x32_bf16 v[76:79], a[64:67], v[116:119], v[76:79]
 v_mfma_f32_16x16x32_bf16 v[84:87], a[144:147], v[116:119], v[84:87]
 v_mfma_f32_16x16x32_bf16 v[92:95], a[224:227], v[116:119], v[92:95]
 v_mfma_f32_16x16x32_bf16 v[100:103], v[52:55], v[116:119], v[100:103]
 ds_read_b128 v[112:115], v69 offset:36864
 ds_read_b128 v[116:119], v69 offset:38912
 s_waitcnt lgkmcnt(4)
 v_mfma_f32_16x16x32_bf16 v[72:75], a[68:71], v[120:123], v[72:75]
 v_mfma_f32_16x16x32_bf16 v[80:83], a[148:151], v[120:123], v[80:83]
 v_mfma_f32_16x16x32_bf16 v[88:91], a[228:231], v[120:123], v[88:91]
 v_mfma_f32_16x16x32_bf16 v[96:99], v[56:59], v[120:123], v[96:99]
 v_mfma_f32_16x16x32_bf16 v[76:79], a[68:71], v[124:127], v[76:79]
 v_mfma_f32_16x16x32_bf16 v[84:87], a[148:151], v[124:127], v[84:87]
 v_mfma_f32_16x16x32_bf16 v[92:95], a[228:231], v[124:127], v[92:95]
 v_mfma_f32_16x16x32_bf16 v[100:103], v[56:59], v[124:127], v[100:103]
 s_waitcnt lgkmcnt(3)
 v_mfma_f32_16x16x32_bf16 v[72:75], a[72:75], v[104:107], v[72:75]
 v_mfma_f32_16x16x32_bf16 v[80:83], a[152:155], v[104:107], v[80:83]
 v_mfma_f32_16x16x32_bf16 v[88:91], a[232:235], v[104:107], v[88:91]
 v_mfma_f32_16x16x32_bf16 v[96:99], v[60:63], v[104:107], v[96:99]
 s_waitcnt lgkmcnt(2)
 v_mfma_f32_16x16x32_bf16 v[76:79], a[72:75], v[108:111], v[76:79]
 v_mfma_f32_16x16x32_bf16 v[84:87], a[152:155], v[108:111], v[84:87]
 v_mfma_f32_16x16x32_bf16 v[92:95], a[232:235], v[108:111], v[92:95]
 v_mfma_f32_16x16x32_bf16 v[100:103], v[60:63], v[108:111], v[100:103]
 s_waitcnt lgkmcnt(1)
 v_mfma_f32_16x16x32_bf16 v[72:75], a[76:79], v[112:115], v[72:75]
 v_mfma_f32_16x16x32_bf16 v[80:83], a[156:159], v[112:115], v[80:83]
 v_mfma_f32_16x16x32_bf16 v[88:91], a[236:239], v[112:115], v[88:91]
 v_mfma_f32_16x16x32_bf16 v[96:99], v[64:67], v[112:115], v[96:99]
 s_waitcnt lgkmcnt(0)
 v_mfma_f32_16x16x32_bf16 v[76:79], a[76:79], v[116:119], v[76:79]
 v_mfma_f32_16x16x32_bf16 v[84:87], a[156:159], v[116:119], v[84:87]
 v_mfma_f32_16x16x32_bf16 v[92:95], a[236:239], v[116:119], v[92:95]
 v_mfma_f32_16x16x32_bf16 v[100:103], v[64:67], v[116:119], v[100:103]
 s_mul_i32 s19, s43, 98304
 s_lshl_b32 s20, s26, 11
 s_add_u32 s19, s19, s20
 s_add_u32 s19, s19, 234536960
 v_mul_f32 v72, s42, v72
 v_mul_f32 v73, s42, v73
 v_mul_f32 v74, s42, v74
 v_mul_f32 v75, s42, v75
 v_mul_f32 v80, s42, v80
 v_mul_f32 v81, s42, v81
 v_mul_f32 v82, s42, v82
 v_mul_f32 v83, s42, v83
 v_exp_f32 v72, v72
 v_exp_f32 v73, v73
 v_exp_f32 v74, v74
 v_exp_f32 v75, v75
 v_exp_f32 v80, v80
 v_exp_f32 v81, v81
 v_exp_f32 v82, v82
 v_exp_f32 v83, v83
 v_add_f32 v72, 1.0, v72
 v_add_f32 v73, 1.0, v73
 v_add_f32 v74, 1.0, v74
 v_add_f32 v75, 1.0, v75
 v_add_f32 v80, 1.0, v80
 v_add_f32 v81, 1.0, v81
 v_add_f32 v82, 1.0, v82
 v_add_f32 v83, 1.0, v83
 v_rcp_f32 v72, v72
 v_rcp_f32 v73, v73
 v_rcp_f32 v74, v74
 v_rcp_f32 v75, v75
 v_rcp_f32 v80, v80
 v_rcp_f32 v81, v81
 v_rcp_f32 v82, v82
 v_rcp_f32 v83, v83
 v_mul_f32 v72, v72, v88
 v_mul_f32 v73, v73, v89
 v_mul_f32 v74, v74, v90
 v_mul_f32 v75, v75, v91
 v_mul_f32 v80, v80, v96
 v_mul_f32 v81, v81, v97
 v_mul_f32 v82, v82, v98
 v_mul_f32 v83, v83, v99
 v_cvt_pk_bf16_f32 v128, v72, v73
 v_cvt_pk_bf16_f32 v129, v74, v75
 v_cvt_pk_bf16_f32 v130, v80, v81
 v_cvt_pk_bf16_f32 v131, v82, v83
 buffer_store_dwordx4 v[128:131], v2, s[4:7], s19 offen offset:0 sc1
 v_mul_f32 v76, s42, v76
 v_mul_f32 v77, s42, v77
 v_mul_f32 v78, s42, v78
 v_mul_f32 v79, s42, v79
 v_mul_f32 v84, s42, v84
 v_mul_f32 v85, s42, v85
 v_mul_f32 v86, s42, v86
 v_mul_f32 v87, s42, v87
 v_exp_f32 v76, v76
 v_exp_f32 v77, v77
 v_exp_f32 v78, v78
 v_exp_f32 v79, v79
 v_exp_f32 v84, v84
 v_exp_f32 v85, v85
 v_exp_f32 v86, v86
 v_exp_f32 v87, v87
 v_add_f32 v76, 1.0, v76
 v_add_f32 v77, 1.0, v77
 v_add_f32 v78, 1.0, v78
 v_add_f32 v79, 1.0, v79
 v_add_f32 v84, 1.0, v84
 v_add_f32 v85, 1.0, v85
 v_add_f32 v86, 1.0, v86
 v_add_f32 v87, 1.0, v87
 v_rcp_f32 v76, v76
 v_rcp_f32 v77, v77
 v_rcp_f32 v78, v78
 v_rcp_f32 v79, v79
 v_rcp_f32 v84, v84
 v_rcp_f32 v85, v85
 v_rcp_f32 v86, v86
 v_rcp_f32 v87, v87
 v_mul_f32 v76, v76, v92
 v_mul_f32 v77, v77, v93
 v_mul_f32 v78, v78, v94
 v_mul_f32 v79, v79, v95
 v_mul_f32 v84, v84, v100
 v_mul_f32 v85, v85, v101
 v_mul_f32 v86, v86, v102
 v_mul_f32 v87, v87, v103
 v_cvt_pk_bf16_f32 v132, v76, v77
 v_cvt_pk_bf16_f32 v133, v78, v79
 v_cvt_pk_bf16_f32 v134, v84, v85
 v_cvt_pk_bf16_f32 v135, v86, v87
 buffer_store_dwordx4 v[132:135], v2, s[4:7], s19 offen offset:1024 sc1
 s_waitcnt vmcnt(0)
 s_barrier
 s_cmp_eq_u32 s3, 0
 s_cbranch_scc0 Lnp_340
 s_mov_b64 exec, 1
 v_mov_b32 v70, s44
 buffer_store_dword v70, off, s[4:7], s27 sc1
 s_mov_b64 exec, -1
Lnp_340:
 s_mov_b32 s43, s44
 s_cmp_lt_u32 s43, 64
 s_cbranch_scc1 Lgu_338
 s_endpgm
L_role_d:
 s_sub_u32 s12, s12, 232
 v_and_b32 v1, 63, v0
 v_lshlrev_b32 v2, 4, v1
 s_load_dwordx2 s[26:27], s[0:1], 80
 s_cmp_ge_u32 s12, 5
 s_cselect_b32 s25, 1, 0
 s_mul_i32 s19, s25, 5
 s_sub_u32 s19, s12, s19
 s_lshl_b32 s34, s25, 6
 s_add_u32 s34, s34, s19
 s_lshl_b32 s34, s34, 2
 s_add_u32 s34, s34, 9216
 s_mul_i32 s32, s19, 0x3334
 s_lshr_b32 s32, s32, 16
 s_mul_i32 s20, s32, 5
 s_sub_u32 s33, s19, s20
 s_lshl_b32 s19, s33, 8
 s_lshl_b32 s20, s3, 6
 s_add_u32 s19, s19, s20
 s_lshl_b32 s37, s19, 1
 s_mul_i32 s23, s32, 1966080
 s_add_u32 s23, s23, s19
 s_mul_i32 s20, s32, 81920
 s_add_u32 s37, s37, s20
 s_add_u32 s37, s37, 208322560
 s_waitcnt lgkmcnt(0)
 s_mov_b32 s28, s26
 s_mov_b32 s29, s27
 s_mov_b32 s30, 1966080
 s_mov_b32 s31, 0x20000
 v_lshrrev_b32 v132, 2, v1
 v_mul_u32_u24 v132, 1280, v132
 v_and_b32 v3, 3, v1
 v_lshl_add_u32 v132, v3, 4, v132
 v_lshrrev_b32 v133, 4, v1
 v_lshlrev_b32 v133, 2, v133
 v_bfe_u32 v3, v1, 2, 2
 v_add_u32 v133, v133, v3
 v_mul_u32_u24 v133, 64, v133
 v_and_b32 v3, 3, v1
 v_lshl_add_u32 v133, v3, 3, v133
 s_mul_i32 s19, s3, 40960
 s_add_u32 s19, s19, 0
 v_add_u32 v133, s19, v133
 s_mul_i32 s19, s3, 40960
 s_add_u32 m0, s19, 0
 s_add_u32 s20, s23, 0
 buffer_load_dwordx4 v132, s[28:31], s20 offen lds
 s_add_u32 m0, s19, 1024
 s_add_u32 s20, s23, 20480
 buffer_load_dwordx4 v132, s[28:31], s20 offen lds
 s_add_u32 m0, s19, 2048
 s_add_u32 s20, s23, 40960
 buffer_load_dwordx4 v132, s[28:31], s20 offen lds
 s_add_u32 m0, s19, 3072
 s_add_u32 s20, s23, 61440
 buffer_load_dwordx4 v132, s[28:31], s20 offen lds
 s_add_u32 m0, s19, 4096
 s_add_u32 s20, s23, 81920
 buffer_load_dwordx4 v132, s[28:31], s20 offen lds
 s_add_u32 m0, s19, 5120
 s_add_u32 s20, s23, 102400
 buffer_load_dwordx4 v132, s[28:31], s20 offen lds
 s_add_u32 m0, s19, 6144
 s_add_u32 s20, s23, 122880
 buffer_load_dwordx4 v132, s[28:31], s20 offen lds
 s_add_u32 m0, s19, 7168
 s_add_u32 s20, s23, 143360
 buffer_load_dwordx4 v132, s[28:31], s20 offen lds
 s_add_u32 m0, s19, 8192
 s_add_u32 s20, s23, 163840
 buffer_load_dwordx4 v132, s[28:31], s20 offen lds
 s_add_u32 m0, s19, 9216
 s_add_u32 s20, s23, 184320
 buffer_load_dwordx4 v132, s[28:31], s20 offen lds
 s_add_u32 m0, s19, 10240
 s_add_u32 s20, s23, 204800
 buffer_load_dwordx4 v132, s[28:31], s20 offen lds
 s_add_u32 m0, s19, 11264
 s_add_u32 s20, s23, 225280
 buffer_load_dwordx4 v132, s[28:31], s20 offen lds
 s_add_u32 m0, s19, 12288
 s_add_u32 s20, s23, 245760
 buffer_load_dwordx4 v132, s[28:31], s20 offen lds
 s_add_u32 m0, s19, 13312
 s_add_u32 s20, s23, 266240
 buffer_load_dwordx4 v132, s[28:31], s20 offen lds
 s_add_u32 m0, s19, 14336
 s_add_u32 s20, s23, 286720
 buffer_load_dwordx4 v132, s[28:31], s20 offen lds
 s_add_u32 m0, s19, 15360
 s_add_u32 s20, s23, 307200
 buffer_load_dwordx4 v132, s[28:31], s20 offen lds
 s_add_u32 m0, s19, 16384
 s_add_u32 s20, s23, 327680
 buffer_load_dwordx4 v132, s[28:31], s20 offen lds
 s_add_u32 m0, s19, 17408
 s_add_u32 s20, s23, 348160
 buffer_load_dwordx4 v132, s[28:31], s20 offen lds
 s_add_u32 m0, s19, 18432
 s_add_u32 s20, s23, 368640
 buffer_load_dwordx4 v132, s[28:31], s20 offen lds
 s_add_u32 m0, s19, 19456
 s_add_u32 s20, s23, 389120
 buffer_load_dwordx4 v132, s[28:31], s20 offen lds
 s_mul_i32 s19, s3, 40960
 s_add_u32 m0, s19, 20480
 s_add_u32 s20, s23, 409600
 buffer_load_dwordx4 v132, s[28:31], s20 offen lds
 s_add_u32 m0, s19, 21504
 s_add_u32 s20, s23, 430080
 buffer_load_dwordx4 v132, s[28:31], s20 offen lds
 s_add_u32 m0, s19, 22528
 s_add_u32 s20, s23, 450560
 buffer_load_dwordx4 v132, s[28:31], s20 offen lds
 s_add_u32 m0, s19, 23552
 s_add_u32 s20, s23, 471040
 buffer_load_dwordx4 v132, s[28:31], s20 offen lds
 s_add_u32 m0, s19, 24576
 s_add_u32 s20, s23, 491520
 buffer_load_dwordx4 v132, s[28:31], s20 offen lds
 s_add_u32 m0, s19, 25600
 s_add_u32 s20, s23, 512000
 buffer_load_dwordx4 v132, s[28:31], s20 offen lds
 s_add_u32 m0, s19, 26624
 s_add_u32 s20, s23, 532480
 buffer_load_dwordx4 v132, s[28:31], s20 offen lds
 s_add_u32 m0, s19, 27648
 s_add_u32 s20, s23, 552960
 buffer_load_dwordx4 v132, s[28:31], s20 offen lds
 s_add_u32 m0, s19, 28672
 s_add_u32 s20, s23, 573440
 buffer_load_dwordx4 v132, s[28:31], s20 offen lds
 s_add_u32 m0, s19, 29696
 s_add_u32 s20, s23, 593920
 buffer_load_dwordx4 v132, s[28:31], s20 offen lds
 s_add_u32 m0, s19, 30720
 s_add_u32 s20, s23, 614400
 buffer_load_dwordx4 v132, s[28:31], s20 offen lds
 s_add_u32 m0, s19, 31744
 s_add_u32 s20, s23, 634880
 buffer_load_dwordx4 v132, s[28:31], s20 offen lds
 s_add_u32 m0, s19, 32768
 s_add_u32 s20, s23, 655360
 buffer_load_dwordx4 v132, s[28:31], s20 offen lds
 s_add_u32 m0, s19, 33792
 s_add_u32 s20, s23, 675840
 buffer_load_dwordx4 v132, s[28:31], s20 offen lds
 s_add_u32 m0, s19, 34816
 s_add_u32 s20, s23, 696320
 buffer_load_dwordx4 v132, s[28:31], s20 offen lds
 s_add_u32 m0, s19, 35840
 s_add_u32 s20, s23, 716800
 buffer_load_dwordx4 v132, s[28:31], s20 offen lds
 s_add_u32 m0, s19, 36864
 s_add_u32 s20, s23, 737280
 buffer_load_dwordx4 v132, s[28:31], s20 offen lds
 s_add_u32 m0, s19, 37888
 s_add_u32 s20, s23, 757760
 buffer_load_dwordx4 v132, s[28:31], s20 offen lds
 s_add_u32 m0, s19, 38912
 s_add_u32 s20, s23, 778240
 buffer_load_dwordx4 v132, s[28:31], s20 offen lds
 s_add_u32 m0, s19, 39936
 s_add_u32 s20, s23, 798720
 buffer_load_dwordx4 v132, s[28:31], s20 offen lds
 s_waitcnt vmcnt(20)
 ds_read_b64_tr_b16 a[0:1], v133 offset:0
 ds_read_b64_tr_b16 a[2:3], v133 offset:1024
 ds_read_b64_tr_b16 a[192:193], v133 offset:32
 ds_read_b64_tr_b16 a[194:195], v133 offset:1056
 ds_read_b64_tr_b16 a[4:5], v133 offset:2048
 ds_read_b64_tr_b16 a[6:7], v133 offset:3072
 ds_read_b64_tr_b16 a[196:197], v133 offset:2080
 ds_read_b64_tr_b16 a[198:199], v133 offset:3104
 ds_read_b64_tr_b16 a[8:9], v133 offset:4096
 ds_read_b64_tr_b16 a[10:11], v133 offset:5120
 ds_read_b64_tr_b16 a[200:201], v133 offset:4128
 ds_read_b64_tr_b16 a[202:203], v133 offset:5152
 ds_read_b64_tr_b16 a[12:13], v133 offset:6144
 ds_read_b64_tr_b16 a[14:15], v133 offset:7168
 ds_read_b64_tr_b16 a[204:205], v133 offset:6176
 ds_read_b64_tr_b16 a[206:207], v133 offset:7200
 ds_read_b64_tr_b16 a[16:17], v133 offset:8192
 ds_read_b64_tr_b16 a[18:19], v133 offset:9216
 ds_read_b64_tr_b16 a[208:209], v133 offset:8224
 ds_read_b64_tr_b16 a[210:211], v133 offset:9248
 ds_read_b64_tr_b16 a[20:21], v133 offset:10240
 ds_read_b64_tr_b16 a[22:23], v133 offset:11264
 ds_read_b64_tr_b16 a[212:213], v133 offset:10272
 ds_read_b64_tr_b16 a[214:215], v133 offset:11296
 ds_read_b64_tr_b16 a[24:25], v133 offset:12288
 ds_read_b64_tr_b16 a[26:27], v133 offset:13312
 ds_read_b64_tr_b16 a[216:217], v133 offset:12320
 ds_read_b64_tr_b16 a[218:219], v133 offset:13344
 ds_read_b64_tr_b16 a[28:29], v133 offset:14336
 ds_read_b64_tr_b16 a[30:31], v133 offset:15360
 ds_read_b64_tr_b16 a[220:221], v133 offset:14368
 ds_read_b64_tr_b16 a[222:223], v133 offset:15392
 ds_read_b64_tr_b16 a[32:33], v133 offset:16384
 ds_read_b64_tr_b16 a[34:35], v133 offset:17408
 ds_read_b64_tr_b16 a[224:225], v133 offset:16416
 ds_read_b64_tr_b16 a[226:227], v133 offset:17440
 ds_read_b64_tr_b16 a[36:37], v133 offset:18432
 ds_read_b64_tr_b16 a[38:39], v133 offset:19456
 ds_read_b64_tr_b16 a[228:229], v133 offset:18464
 ds_read_b64_tr_b16 a[230:231], v133 offset:19488
 s_waitcnt lgkmcnt(0)
 s_mul_i32 s19, s3, 40960
 s_add_u32 m0, s19, 0
 s_add_u32 s20, s23, 819200
 buffer_load_dwordx4 v132, s[28:31], s20 offen lds
 s_add_u32 m0, s19, 1024
 s_add_u32 s20, s23, 839680
 buffer_load_dwordx4 v132, s[28:31], s20 offen lds
 s_add_u32 m0, s19, 2048
 s_add_u32 s20, s23, 860160
 buffer_load_dwordx4 v132, s[28:31], s20 offen lds
 s_add_u32 m0, s19, 3072
 s_add_u32 s20, s23, 880640
 buffer_load_dwordx4 v132, s[28:31], s20 offen lds
 s_add_u32 m0, s19, 4096
 s_add_u32 s20, s23, 901120
 buffer_load_dwordx4 v132, s[28:31], s20 offen lds
 s_add_u32 m0, s19, 5120
 s_add_u32 s20, s23, 921600
 buffer_load_dwordx4 v132, s[28:31], s20 offen lds
 s_add_u32 m0, s19, 6144
 s_add_u32 s20, s23, 942080
 buffer_load_dwordx4 v132, s[28:31], s20 offen lds
 s_add_u32 m0, s19, 7168
 s_add_u32 s20, s23, 962560
 buffer_load_dwordx4 v132, s[28:31], s20 offen lds
 s_add_u32 m0, s19, 8192
 s_add_u32 s20, s23, 983040
 buffer_load_dwordx4 v132, s[28:31], s20 offen lds
 s_add_u32 m0, s19, 9216
 s_add_u32 s20, s23, 1003520
 buffer_load_dwordx4 v132, s[28:31], s20 offen lds
 s_add_u32 m0, s19, 10240
 s_add_u32 s20, s23, 1024000
 buffer_load_dwordx4 v132, s[28:31], s20 offen lds
 s_add_u32 m0, s19, 11264
 s_add_u32 s20, s23, 1044480
 buffer_load_dwordx4 v132, s[28:31], s20 offen lds
 s_add_u32 m0, s19, 12288
 s_add_u32 s20, s23, 1064960
 buffer_load_dwordx4 v132, s[28:31], s20 offen lds
 s_add_u32 m0, s19, 13312
 s_add_u32 s20, s23, 1085440
 buffer_load_dwordx4 v132, s[28:31], s20 offen lds
 s_add_u32 m0, s19, 14336
 s_add_u32 s20, s23, 1105920
 buffer_load_dwordx4 v132, s[28:31], s20 offen lds
 s_add_u32 m0, s19, 15360
 s_add_u32 s20, s23, 1126400
 buffer_load_dwordx4 v132, s[28:31], s20 offen lds
 s_add_u32 m0, s19, 16384
 s_add_u32 s20, s23, 1146880
 buffer_load_dwordx4 v132, s[28:31], s20 offen lds
 s_add_u32 m0, s19, 17408
 s_add_u32 s20, s23, 1167360
 buffer_load_dwordx4 v132, s[28:31], s20 offen lds
 s_add_u32 m0, s19, 18432
 s_add_u32 s20, s23, 1187840
 buffer_load_dwordx4 v132, s[28:31], s20 offen lds
 s_add_u32 m0, s19, 19456
 s_add_u32 s20, s23, 1208320
 buffer_load_dwordx4 v132, s[28:31], s20 offen lds
 s_waitcnt vmcnt(20)
 ds_read_b64_tr_b16 a[40:41], v133 offset:20480
 ds_read_b64_tr_b16 a[42:43], v133 offset:21504
 ds_read_b64_tr_b16 a[232:233], v133 offset:20512
 ds_read_b64_tr_b16 a[234:235], v133 offset:21536
 ds_read_b64_tr_b16 a[44:45], v133 offset:22528
 ds_read_b64_tr_b16 a[46:47], v133 offset:23552
 ds_read_b64_tr_b16 a[236:237], v133 offset:22560
 ds_read_b64_tr_b16 a[238:239], v133 offset:23584
 ds_read_b64_tr_b16 a[48:49], v133 offset:24576
 ds_read_b64_tr_b16 a[50:51], v133 offset:25600
 ds_read_b64_tr_b16 a[240:241], v133 offset:24608
 ds_read_b64_tr_b16 a[242:243], v133 offset:25632
 ds_read_b64_tr_b16 a[52:53], v133 offset:26624
 ds_read_b64_tr_b16 a[54:55], v133 offset:27648
 ds_read_b64_tr_b16 a[244:245], v133 offset:26656
 ds_read_b64_tr_b16 a[246:247], v133 offset:27680
 ds_read_b64_tr_b16 a[56:57], v133 offset:28672
 ds_read_b64_tr_b16 a[58:59], v133 offset:29696
 ds_read_b64_tr_b16 a[248:249], v133 offset:28704
 ds_read_b64_tr_b16 a[250:251], v133 offset:29728
 ds_read_b64_tr_b16 a[60:61], v133 offset:30720
 ds_read_b64_tr_b16 a[62:63], v133 offset:31744
 ds_read_b64_tr_b16 a[252:253], v133 offset:30752
 ds_read_b64_tr_b16 a[254:255], v133 offset:31776
 ds_read_b64_tr_b16 a[64:65], v133 offset:32768
 ds_read_b64_tr_b16 a[66:67], v133 offset:33792
 ds_read_b64_tr_b16 v[4:5], v133 offset:32800
 ds_read_b64_tr_b16 v[6:7], v133 offset:33824
 ds_read_b64_tr_b16 a[68:69], v133 offset:34816
 ds_read_b64_tr_b16 a[70:71], v133 offset:35840
 ds_read_b64_tr_b16 v[8:9], v133 offset:34848
 ds_read_b64_tr_b16 v[10:11], v133 offset:35872
 ds_read_b64_tr_b16 a[72:73], v133 offset:36864
 ds_read_b64_tr_b16 a[74:75], v133 offset:37888
 ds_read_b64_tr_b16 v[12:13], v133 offset:36896
 ds_read_b64_tr_b16 v[14:15], v133 offset:37920
 ds_read_b64_tr_b16 a[76:77], v133 offset:38912
 ds_read_b64_tr_b16 a[78:79], v133 offset:39936
 ds_read_b64_tr_b16 v[16:17], v133 offset:38944
 ds_read_b64_tr_b16 v[18:19], v133 offset:39968
 s_waitcnt lgkmcnt(0)
 s_mul_i32 s19, s3, 40960
 s_add_u32 m0, s19, 20480
 s_add_u32 s20, s23, 1228800
 buffer_load_dwordx4 v132, s[28:31], s20 offen lds
 s_add_u32 m0, s19, 21504
 s_add_u32 s20, s23, 1249280
 buffer_load_dwordx4 v132, s[28:31], s20 offen lds
 s_add_u32 m0, s19, 22528
 s_add_u32 s20, s23, 1269760
 buffer_load_dwordx4 v132, s[28:31], s20 offen lds
 s_add_u32 m0, s19, 23552
 s_add_u32 s20, s23, 1290240
 buffer_load_dwordx4 v132, s[28:31], s20 offen lds
 s_add_u32 m0, s19, 24576
 s_add_u32 s20, s23, 1310720
 buffer_load_dwordx4 v132, s[28:31], s20 offen lds
 s_add_u32 m0, s19, 25600
 s_add_u32 s20, s23, 1331200
 buffer_load_dwordx4 v132, s[28:31], s20 offen lds
 s_add_u32 m0, s19, 26624
 s_add_u32 s20, s23, 1351680
 buffer_load_dwordx4 v132, s[28:31], s20 offen lds
 s_add_u32 m0, s19, 27648
 s_add_u32 s20, s23, 1372160
 buffer_load_dwordx4 v132, s[28:31], s20 offen lds
 s_add_u32 m0, s19, 28672
 s_add_u32 s20, s23, 1392640
 buffer_load_dwordx4 v132, s[28:31], s20 offen lds
 s_add_u32 m0, s19, 29696
 s_add_u32 s20, s23, 1413120
 buffer_load_dwordx4 v132, s[28:31], s20 offen lds
 s_add_u32 m0, s19, 30720
 s_add_u32 s20, s23, 1433600
 buffer_load_dwordx4 v132, s[28:31], s20 offen lds
 s_add_u32 m0, s19, 31744
 s_add_u32 s20, s23, 1454080
 buffer_load_dwordx4 v132, s[28:31], s20 offen lds
 s_add_u32 m0, s19, 32768
 s_add_u32 s20, s23, 1474560
 buffer_load_dwordx4 v132, s[28:31], s20 offen lds
 s_add_u32 m0, s19, 33792
 s_add_u32 s20, s23, 1495040
 buffer_load_dwordx4 v132, s[28:31], s20 offen lds
 s_add_u32 m0, s19, 34816
 s_add_u32 s20, s23, 1515520
 buffer_load_dwordx4 v132, s[28:31], s20 offen lds
 s_add_u32 m0, s19, 35840
 s_add_u32 s20, s23, 1536000
 buffer_load_dwordx4 v132, s[28:31], s20 offen lds
 s_add_u32 m0, s19, 36864
 s_add_u32 s20, s23, 1556480
 buffer_load_dwordx4 v132, s[28:31], s20 offen lds
 s_add_u32 m0, s19, 37888
 s_add_u32 s20, s23, 1576960
 buffer_load_dwordx4 v132, s[28:31], s20 offen lds
 s_add_u32 m0, s19, 38912
 s_add_u32 s20, s23, 1597440
 buffer_load_dwordx4 v132, s[28:31], s20 offen lds
 s_add_u32 m0, s19, 39936
 s_add_u32 s20, s23, 1617920
 buffer_load_dwordx4 v132, s[28:31], s20 offen lds
 s_waitcnt vmcnt(20)
 ds_read_b64_tr_b16 a[80:81], v133 offset:0
 ds_read_b64_tr_b16 a[82:83], v133 offset:1024
 ds_read_b64_tr_b16 v[20:21], v133 offset:32
 ds_read_b64_tr_b16 v[22:23], v133 offset:1056
 ds_read_b64_tr_b16 a[84:85], v133 offset:2048
 ds_read_b64_tr_b16 a[86:87], v133 offset:3072
 ds_read_b64_tr_b16 v[24:25], v133 offset:2080
 ds_read_b64_tr_b16 v[26:27], v133 offset:3104
 ds_read_b64_tr_b16 a[88:89], v133 offset:4096
 ds_read_b64_tr_b16 a[90:91], v133 offset:5120
 ds_read_b64_tr_b16 v[28:29], v133 offset:4128
 ds_read_b64_tr_b16 v[30:31], v133 offset:5152
 ds_read_b64_tr_b16 a[92:93], v133 offset:6144
 ds_read_b64_tr_b16 a[94:95], v133 offset:7168
 ds_read_b64_tr_b16 v[32:33], v133 offset:6176
 ds_read_b64_tr_b16 v[34:35], v133 offset:7200
 ds_read_b64_tr_b16 a[96:97], v133 offset:8192
 ds_read_b64_tr_b16 a[98:99], v133 offset:9216
 ds_read_b64_tr_b16 v[36:37], v133 offset:8224
 ds_read_b64_tr_b16 v[38:39], v133 offset:9248
 ds_read_b64_tr_b16 a[100:101], v133 offset:10240
 ds_read_b64_tr_b16 a[102:103], v133 offset:11264
 ds_read_b64_tr_b16 v[40:41], v133 offset:10272
 ds_read_b64_tr_b16 v[42:43], v133 offset:11296
 ds_read_b64_tr_b16 a[104:105], v133 offset:12288
 ds_read_b64_tr_b16 a[106:107], v133 offset:13312
 ds_read_b64_tr_b16 v[44:45], v133 offset:12320
 ds_read_b64_tr_b16 v[46:47], v133 offset:13344
 ds_read_b64_tr_b16 a[108:109], v133 offset:14336
 ds_read_b64_tr_b16 a[110:111], v133 offset:15360
 ds_read_b64_tr_b16 v[48:49], v133 offset:14368
 ds_read_b64_tr_b16 v[50:51], v133 offset:15392
 ds_read_b64_tr_b16 a[112:113], v133 offset:16384
 ds_read_b64_tr_b16 a[114:115], v133 offset:17408
 ds_read_b64_tr_b16 v[52:53], v133 offset:16416
 ds_read_b64_tr_b16 v[54:55], v133 offset:17440
 ds_read_b64_tr_b16 a[116:117], v133 offset:18432
 ds_read_b64_tr_b16 a[118:119], v133 offset:19456
 ds_read_b64_tr_b16 v[56:57], v133 offset:18464
 ds_read_b64_tr_b16 v[58:59], v133 offset:19488
 s_waitcnt lgkmcnt(0)
 s_mul_i32 s19, s3, 40960
 s_add_u32 m0, s19, 0
 s_add_u32 s20, s23, 1638400
 buffer_load_dwordx4 v132, s[28:31], s20 offen lds
 s_add_u32 m0, s19, 1024
 s_add_u32 s20, s23, 1658880
 buffer_load_dwordx4 v132, s[28:31], s20 offen lds
 s_add_u32 m0, s19, 2048
 s_add_u32 s20, s23, 1679360
 buffer_load_dwordx4 v132, s[28:31], s20 offen lds
 s_add_u32 m0, s19, 3072
 s_add_u32 s20, s23, 1699840
 buffer_load_dwordx4 v132, s[28:31], s20 offen lds
 s_add_u32 m0, s19, 4096
 s_add_u32 s20, s23, 1720320
 buffer_load_dwordx4 v132, s[28:31], s20 offen lds
 s_add_u32 m0, s19, 5120
 s_add_u32 s20, s23, 1740800
 buffer_load_dwordx4 v132, s[28:31], s20 offen lds
 s_add_u32 m0, s19, 6144
 s_add_u32 s20, s23, 1761280
 buffer_load_dwordx4 v132, s[28:31], s20 offen lds
 s_add_u32 m0, s19, 7168
 s_add_u32 s20, s23, 1781760
 buffer_load_dwordx4 v132, s[28:31], s20 offen lds
 s_add_u32 m0, s19, 8192
 s_add_u32 s20, s23, 1802240
 buffer_load_dwordx4 v132, s[28:31], s20 offen lds
 s_add_u32 m0, s19, 9216
 s_add_u32 s20, s23, 1822720
 buffer_load_dwordx4 v132, s[28:31], s20 offen lds
 s_add_u32 m0, s19, 10240
 s_add_u32 s20, s23, 1843200
 buffer_load_dwordx4 v132, s[28:31], s20 offen lds
 s_add_u32 m0, s19, 11264
 s_add_u32 s20, s23, 1863680
 buffer_load_dwordx4 v132, s[28:31], s20 offen lds
 s_add_u32 m0, s19, 12288
 s_add_u32 s20, s23, 1884160
 buffer_load_dwordx4 v132, s[28:31], s20 offen lds
 s_add_u32 m0, s19, 13312
 s_add_u32 s20, s23, 1904640
 buffer_load_dwordx4 v132, s[28:31], s20 offen lds
 s_add_u32 m0, s19, 14336
 s_add_u32 s20, s23, 1925120
 buffer_load_dwordx4 v132, s[28:31], s20 offen lds
 s_add_u32 m0, s19, 15360
 s_add_u32 s20, s23, 1945600
 buffer_load_dwordx4 v132, s[28:31], s20 offen lds
 s_waitcnt vmcnt(16)
 ds_read_b64_tr_b16 a[120:121], v133 offset:20480
 ds_read_b64_tr_b16 a[122:123], v133 offset:21504
 ds_read_b64_tr_b16 v[60:61], v133 offset:20512
 ds_read_b64_tr_b16 v[62:63], v133 offset:21536
 ds_read_b64_tr_b16 a[124:125], v133 offset:22528
 ds_read_b64_tr_b16 a[126:127], v133 offset:23552
 ds_read_b64_tr_b16 v[64:65], v133 offset:22560
 ds_read_b64_tr_b16 v[66:67], v133 offset:23584
 ds_read_b64_tr_b16 a[128:129], v133 offset:24576
 ds_read_b64_tr_b16 a[130:131], v133 offset:25600
 ds_read_b64_tr_b16 v[68:69], v133 offset:24608
 ds_read_b64_tr_b16 v[70:71], v133 offset:25632
 ds_read_b64_tr_b16 a[132:133], v133 offset:26624
 ds_read_b64_tr_b16 a[134:135], v133 offset:27648
 ds_read_b64_tr_b16 v[72:73], v133 offset:26656
 ds_read_b64_tr_b16 v[74:75], v133 offset:27680
 ds_read_b64_tr_b16 a[136:137], v133 offset:28672
 ds_read_b64_tr_b16 a[138:139], v133 offset:29696
 ds_read_b64_tr_b16 v[76:77], v133 offset:28704
 ds_read_b64_tr_b16 v[78:79], v133 offset:29728
 ds_read_b64_tr_b16 a[140:141], v133 offset:30720
 ds_read_b64_tr_b16 a[142:143], v133 offset:31744
 ds_read_b64_tr_b16 v[80:81], v133 offset:30752
 ds_read_b64_tr_b16 v[82:83], v133 offset:31776
 ds_read_b64_tr_b16 a[144:145], v133 offset:32768
 ds_read_b64_tr_b16 a[146:147], v133 offset:33792
 ds_read_b64_tr_b16 v[84:85], v133 offset:32800
 ds_read_b64_tr_b16 v[86:87], v133 offset:33824
 ds_read_b64_tr_b16 a[148:149], v133 offset:34816
 ds_read_b64_tr_b16 a[150:151], v133 offset:35840
 ds_read_b64_tr_b16 v[88:89], v133 offset:34848
 ds_read_b64_tr_b16 v[90:91], v133 offset:35872
 ds_read_b64_tr_b16 a[152:153], v133 offset:36864
 ds_read_b64_tr_b16 a[154:155], v133 offset:37888
 ds_read_b64_tr_b16 v[92:93], v133 offset:36896
 ds_read_b64_tr_b16 v[94:95], v133 offset:37920
 ds_read_b64_tr_b16 a[156:157], v133 offset:38912
 ds_read_b64_tr_b16 a[158:159], v133 offset:39936
 ds_read_b64_tr_b16 v[96:97], v133 offset:38944
 ds_read_b64_tr_b16 v[98:99], v133 offset:39968
 s_waitcnt lgkmcnt(0)
 s_waitcnt vmcnt(0)
 ds_read_b64_tr_b16 a[160:161], v133 offset:0
 ds_read_b64_tr_b16 a[162:163], v133 offset:1024
 ds_read_b64_tr_b16 v[100:101], v133 offset:32
 ds_read_b64_tr_b16 v[102:103], v133 offset:1056
 ds_read_b64_tr_b16 a[164:165], v133 offset:2048
 ds_read_b64_tr_b16 a[166:167], v133 offset:3072
 ds_read_b64_tr_b16 v[104:105], v133 offset:2080
 ds_read_b64_tr_b16 v[106:107], v133 offset:3104
 ds_read_b64_tr_b16 a[168:169], v133 offset:4096
 ds_read_b64_tr_b16 a[170:171], v133 offset:5120
 ds_read_b64_tr_b16 v[108:109], v133 offset:4128
 ds_read_b64_tr_b16 v[110:111], v133 offset:5152
 ds_read_b64_tr_b16 a[172:173], v133 offset:6144
 ds_read_b64_tr_b16 a[174:175], v133 offset:7168
 ds_read_b64_tr_b16 v[112:113], v133 offset:6176
 ds_read_b64_tr_b16 v[114:115], v133 offset:7200
 ds_read_b64_tr_b16 a[176:177], v133 offset:8192
 ds_read_b64_tr_b16 a[178:179], v133 offset:9216
 ds_read_b64_tr_b16 v[116:117], v133 offset:8224
 ds_read_b64_tr_b16 v[118:119], v133 offset:9248
 ds_read_b64_tr_b16 a[180:181], v133 offset:10240
 ds_read_b64_tr_b16 a[182:183], v133 offset:11264
 ds_read_b64_tr_b16 v[120:121], v133 offset:10272
 ds_read_b64_tr_b16 v[122:123], v133 offset:11296
 ds_read_b64_tr_b16 a[184:185], v133 offset:12288
 ds_read_b64_tr_b16 a[186:187], v133 offset:13312
 ds_read_b64_tr_b16 v[124:125], v133 offset:12320
 ds_read_b64_tr_b16 v[126:127], v133 offset:13344
 ds_read_b64_tr_b16 a[188:189], v133 offset:14336
 ds_read_b64_tr_b16 a[190:191], v133 offset:15360
 ds_read_b64_tr_b16 v[128:129], v133 offset:14368
 ds_read_b64_tr_b16 v[130:131], v133 offset:15392
 s_waitcnt lgkmcnt(0)
 s_barrier
 s_cmp_eq_u32 s13, 1
 s_cbranch_scc1 Lverok_342
 s_mov_b32 s18, 0
Lver_341:
 s_add_u32 s18, s18, 1
 s_cmp_gt_u32 s18, 200000
 s_cbranch_scc1 L_fail
 v_and_b32 v254, 7, v0
 v_lshlrev_b32 v254, 2, v254
 buffer_load_dword v255, v254, s[8:11], 0 offen sc1
 s_waitcnt vmcnt(0)
 v_cmp_eq_u32 vcc, 32, v255
 s_nop 0
 s_cmp_eq_u64 vcc, -1
 s_cbranch_scc1 Lverok_342
 s_mov_b32 s17, 0
 v_readlane_b32 s14, v255, 0
 s_nop 0
 s_add_u32 s17, s17, s14
 v_readlane_b32 s14, v255, 1
 s_nop 0
 s_add_u32 s17, s17, s14
 v_readlane_b32 s14, v255, 2
 s_nop 0
 s_add_u32 s17, s17, s14
 v_readlane_b32 s14, v255, 3
 s_nop 0
 s_add_u32 s17, s17, s14
 v_readlane_b32 s14, v255, 4
 s_nop 0
 s_add_u32 s17, s17, s14
 v_readlane_b32 s14, v255, 5
 s_nop 0
 s_add_u32 s17, s17, s14
 v_readlane_b32 s14, v255, 6
 s_nop 0
 s_add_u32 s17, s17, s14
 v_readlane_b32 s14, v255, 7
 s_nop 0
 s_add_u32 s17, s17, s14
 s_cmp_eq_u32 s17, 256
 s_cbranch_scc1 L_fallback
 s_branch Lver_341
Lverok_342:
 v_and_b32 v132, 15, v1
 v_min_u32 v132, 11, v132
 v_lshlrev_b32 v132, 2, v132
 s_lshl_b32 s19, s25, 8
 s_add_u32 s19, s19, 8192
 v_add_u32 v132, s19, v132
 v_and_b32 v133, 15, v1
 v_mul_u32_u24 v133, 2560, v133
 v_lshrrev_b32 v135, 4, v1
 v_lshl_add_u32 v133, v135, 4, v133
 v_add_u32 v134, 49152, v2
 s_lshl_b32 s36, s3, 10
 s_mov_b32 s38, 0
Ld_343:
 s_add_u32 s39, s38, 1
 s_mov_b32 s24, 0
Lw_344:
 s_add_u32 s24, s24, 1
 s_cmp_gt_u32 s24, 200000
 s_cbranch_scc1 L_fail
 buffer_load_dword v3, v132, s[4:7], 0 offen sc1
 s_waitcnt vmcnt(0)
 v_cmp_le_u32 vcc, s39, v3
 s_nop 0
 s_cmp_eq_u64 vcc, -1
 s_cbranch_scc0 Lw_344
 s_mul_i32 s35, s38, 98304
 s_add_u32 s35, s35, 234536960
 s_add_u32 s35, s35, s36
 s_add_u32 m0, s36, 0
 s_add_u32 s19, s35, 0
 buffer_load_dwordx4 v2, s[4:7], s19 offen sc1 lds
 s_add_u32 m0, s36, 4096
 s_add_u32 s19, s35, 4096
 buffer_load_dwordx4 v2, s[4:7], s19 offen sc1 lds
 s_add_u32 m0, s36, 8192
 s_add_u32 s19, s35, 8192
 buffer_load_dwordx4 v2, s[4:7], s19 offen sc1 lds
 s_add_u32 m0, s36, 12288
 s_add_u32 s19, s35, 12288
 buffer_load_dwordx4 v2, s[4:7], s19 offen sc1 lds
 s_add_u32 m0, s36, 16384
 s_add_u32 s19, s35, 16384
 buffer_load_dwordx4 v2, s[4:7], s19 offen sc1 lds
 s_add_u32 m0, s36, 20480
 s_add_u32 s19, s35, 20480
 buffer_load_dwordx4 v2, s[4:7], s19 offen sc1 lds
 s_add_u32 m0, s36, 24576
 s_add_u32 s19, s35, 24576
 buffer_load_dwordx4 v2, s[4:7], s19 offen sc1 lds
 s_add_u32 m0, s36, 28672
 s_add_u32 s19, s35, 28672
 buffer_load_dwordx4 v2, s[4:7], s19 offen sc1 lds
 s_add_u32 m0, s36, 32768
 s_add_u32 s19, s35, 32768
 buffer_load_dwordx4 v2, s[4:7], s19 offen sc1 lds
 s_add_u32 m0, s36, 36864
 s_add_u32 s19, s35, 36864
 buffer_load_dwordx4 v2, s[4:7], s19 offen sc1 lds
 s_add_u32 m0, s36, 40960
 s_add_u32 s19, s35, 40960
 buffer_load_dwordx4 v2, s[4:7], s19 offen sc1 lds
 s_add_u32 m0, s36, 45056
 s_add_u32 s19, s35, 45056
 buffer_load_dwordx4 v2, s[4:7], s19 offen sc1 lds
 s_add_u32 m0, s36, 49152
 s_add_u32 s19, s35, 49152
 buffer_load_dwordx4 v2, s[4:7], s19 offen sc1 lds
 s_add_u32 m0, s36, 53248
 s_add_u32 s19, s35, 53248
 buffer_load_dwordx4 v2, s[4:7], s19 offen sc1 lds
 s_add_u32 m0, s36, 57344
 s_add_u32 s19, s35, 57344
 buffer_load_dwordx4 v2, s[4:7], s19 offen sc1 lds
 s_add_u32 m0, s36, 61440
 s_add_u32 s19, s35, 61440
 buffer_load_dwordx4 v2, s[4:7], s19 offen sc1 lds
 s_add_u32 m0, s36, 65536
 s_add_u32 s19, s35, 65536
 buffer_load_dwordx4 v2, s[4:7], s19 offen sc1 lds
 s_add_u32 m0, s36, 69632
 s_add_u32 s19, s35, 69632
 buffer_load_dwordx4 v2, s[4:7], s19 offen sc1 lds
 s_add_u32 m0, s36, 73728
 s_add_u32 s19, s35, 73728
 buffer_load_dwordx4 v2, s[4:7], s19 offen sc1 lds
 s_add_u32 m0, s36, 77824
 s_add_u32 s19, s35, 77824
 buffer_load_dwordx4 v2, s[4:7], s19 offen sc1 lds
 s_add_u32 m0, s36, 81920
 s_add_u32 s19, s35, 81920
 buffer_load_dwordx4 v2, s[4:7], s19 offen sc1 lds
 s_add_u32 m0, s36, 86016
 s_add_u32 s19, s35, 86016
 buffer_load_dwordx4 v2, s[4:7], s19 offen sc1 lds
 s_add_u32 m0, s36, 90112
 s_add_u32 s19, s35, 90112
 buffer_load_dwordx4 v2, s[4:7], s19 offen sc1 lds
 s_add_u32 m0, s36, 94208
 s_add_u32 s19, s35, 94208
 buffer_load_dwordx4 v2, s[4:7], s19 offen sc1 lds
 s_waitcnt vmcnt(20)
 s_barrier
 ds_read_b128 v[152:155], v2 offset:0
 ds_read_b128 v[156:159], v2 offset:1024
 ds_read_b128 v[160:163], v2 offset:2048
 ds_read_b128 v[164:167], v2 offset:3072
 ds_read_b128 v[168:171], v2 offset:4096
 ds_read_b128 v[172:175], v2 offset:5120
 s_waitcnt lgkmcnt(5)
 v_mfma_f32_16x16x32_bf16 v[136:139], a[0:3], v[152:155], 0
 v_mfma_f32_16x16x32_bf16 v[144:147], a[192:195], v[152:155], 0
 s_waitcnt lgkmcnt(4)
 v_mfma_f32_16x16x32_bf16 v[140:143], a[0:3], v[156:159], 0
 v_mfma_f32_16x16x32_bf16 v[148:151], a[192:195], v[156:159], 0
 ds_read_b128 v[152:155], v2 offset:6144
 ds_read_b128 v[156:159], v2 offset:7168
 s_waitcnt lgkmcnt(4)
 v_mfma_f32_16x16x32_bf16 v[136:139], a[4:7], v[160:163], v[136:139]
 v_mfma_f32_16x16x32_bf16 v[144:147], a[196:199], v[160:163], v[144:147]
 v_mfma_f32_16x16x32_bf16 v[140:143], a[4:7], v[164:167], v[140:143]
 v_mfma_f32_16x16x32_bf16 v[148:151], a[196:199], v[164:167], v[148:151]
 ds_read_b128 v[160:163], v2 offset:8192
 ds_read_b128 v[164:167], v2 offset:9216
 s_waitcnt lgkmcnt(4)
 v_mfma_f32_16x16x32_bf16 v[136:139], a[8:11], v[168:171], v[136:139]
 v_mfma_f32_16x16x32_bf16 v[144:147], a[200:203], v[168:171], v[144:147]
 v_mfma_f32_16x16x32_bf16 v[140:143], a[8:11], v[172:175], v[140:143]
 v_mfma_f32_16x16x32_bf16 v[148:151], a[200:203], v[172:175], v[148:151]
 ds_read_b128 v[168:171], v2 offset:10240
 ds_read_b128 v[172:175], v2 offset:11264
 s_waitcnt lgkmcnt(4)
 v_mfma_f32_16x16x32_bf16 v[136:139], a[12:15], v[152:155], v[136:139]
 v_mfma_f32_16x16x32_bf16 v[144:147], a[204:207], v[152:155], v[144:147]
 v_mfma_f32_16x16x32_bf16 v[140:143], a[12:15], v[156:159], v[140:143]
 v_mfma_f32_16x16x32_bf16 v[148:151], a[204:207], v[156:159], v[148:151]
 ds_read_b128 v[152:155], v2 offset:12288
 ds_read_b128 v[156:159], v2 offset:13312
 s_waitcnt lgkmcnt(4)
 v_mfma_f32_16x16x32_bf16 v[136:139], a[16:19], v[160:163], v[136:139]
 v_mfma_f32_16x16x32_bf16 v[144:147], a[208:211], v[160:163], v[144:147]
 v_mfma_f32_16x16x32_bf16 v[140:143], a[16:19], v[164:167], v[140:143]
 v_mfma_f32_16x16x32_bf16 v[148:151], a[208:211], v[164:167], v[148:151]
 ds_read_b128 v[160:163], v2 offset:14336
 ds_read_b128 v[164:167], v2 offset:15360
 s_waitcnt lgkmcnt(4)
 v_mfma_f32_16x16x32_bf16 v[136:139], a[20:23], v[168:171], v[136:139]
 v_mfma_f32_16x16x32_bf16 v[144:147], a[212:215], v[168:171], v[144:147]
 v_mfma_f32_16x16x32_bf16 v[140:143], a[20:23], v[172:175], v[140:143]
 v_mfma_f32_16x16x32_bf16 v[148:151], a[212:215], v[172:175], v[148:151]
 s_waitcnt vmcnt(16)
 s_barrier
 ds_read_b128 v[168:171], v2 offset:16384
 ds_read_b128 v[172:175], v2 offset:17408
 s_waitcnt lgkmcnt(4)
 v_mfma_f32_16x16x32_bf16 v[136:139], a[24:27], v[152:155], v[136:139]
 v_mfma_f32_16x16x32_bf16 v[144:147], a[216:219], v[152:155], v[144:147]
 v_mfma_f32_16x16x32_bf16 v[140:143], a[24:27], v[156:159], v[140:143]
 v_mfma_f32_16x16x32_bf16 v[148:151], a[216:219], v[156:159], v[148:151]
 ds_read_b128 v[152:155], v2 offset:18432
 ds_read_b128 v[156:159], v2 offset:19456
 s_waitcnt lgkmcnt(4)
 v_mfma_f32_16x16x32_bf16 v[136:139], a[28:31], v[160:163], v[136:139]
 v_mfma_f32_16x16x32_bf16 v[144:147], a[220:223], v[160:163], v[144:147]
 v_mfma_f32_16x16x32_bf16 v[140:143], a[28:31], v[164:167], v[140:143]
 v_mfma_f32_16x16x32_bf16 v[148:151], a[220:223], v[164:167], v[148:151]
 ds_read_b128 v[160:163], v2 offset:20480
 ds_read_b128 v[164:167], v2 offset:21504
 s_waitcnt lgkmcnt(4)
 v_mfma_f32_16x16x32_bf16 v[136:139], a[32:35], v[168:171], v[136:139]
 v_mfma_f32_16x16x32_bf16 v[144:147], a[224:227], v[168:171], v[144:147]
 v_mfma_f32_16x16x32_bf16 v[140:143], a[32:35], v[172:175], v[140:143]
 v_mfma_f32_16x16x32_bf16 v[148:151], a[224:227], v[172:175], v[148:151]
 ds_read_b128 v[168:171], v2 offset:22528
 ds_read_b128 v[172:175], v2 offset:23552
 s_waitcnt lgkmcnt(4)
 v_mfma_f32_16x16x32_bf16 v[136:139], a[36:39], v[152:155], v[136:139]
 v_mfma_f32_16x16x32_bf16 v[144:147], a[228:231], v[152:155], v[144:147]
 v_mfma_f32_16x16x32_bf16 v[140:143], a[36:39], v[156:159], v[140:143]
 v_mfma_f32_16x16x32_bf16 v[148:151], a[228:231], v[156:159], v[148:151]
 ds_read_b128 v[152:155], v2 offset:24576
 ds_read_b128 v[156:159], v2 offset:25600
 s_waitcnt lgkmcnt(4)
 v_mfma_f32_16x16x32_bf16 v[136:139], a[40:43], v[160:163], v[136:139]
 v_mfma_f32_16x16x32_bf16 v[144:147], a[232:235], v[160:163], v[144:147]
 v_mfma_f32_16x16x32_bf16 v[140:143], a[40:43], v[164:167], v[140:143]
 v_mfma_f32_16x16x32_bf16 v[148:151], a[232:235], v[164:167], v[148:151]
 ds_read_b128 v[160:163], v2 offset:26624
 ds_read_b128 v[164:167], v2 offset:27648
 s_waitcnt lgkmcnt(4)
 v_mfma_f32_16x16x32_bf16 v[136:139], a[44:47], v[168:171], v[136:139]
 v_mfma_f32_16x16x32_bf16 v[144:147], a[236:239], v[168:171], v[144:147]
 v_mfma_f32_16x16x32_bf16 v[140:143], a[44:47], v[172:175], v[140:143]
 v_mfma_f32_16x16x32_bf16 v[148:151], a[236:239], v[172:175], v[148:151]
 ds_read_b128 v[168:171], v2 offset:28672
 ds_read_b128 v[172:175], v2 offset:29696
 s_waitcnt lgkmcnt(4)
 v_mfma_f32_16x16x32_bf16 v[136:139], a[48:51], v[152:155], v[136:139]
 v_mfma_f32_16x16x32_bf16 v[144:147], a[240:243], v[152:155], v[144:147]
 v_mfma_f32_16x16x32_bf16 v[140:143], a[48:51], v[156:159], v[140:143]
 v_mfma_f32_16x16x32_bf16 v[148:151], a[240:243], v[156:159], v[148:151]
 ds_read_b128 v[152:155], v2 offset:30720
 ds_read_b128 v[156:159], v2 offset:31744
 s_waitcnt lgkmcnt(4)
 v_mfma_f32_16x16x32_bf16 v[136:139], a[52:55], v[160:163], v[136:139]
 v_mfma_f32_16x16x32_bf16 v[144:147], a[244:247], v[160:163], v[144:147]
 v_mfma_f32_16x16x32_bf16 v[140:143], a[52:55], v[164:167], v[140:143]
 v_mfma_f32_16x16x32_bf16 v[148:151], a[244:247], v[164:167], v[148:151]
 s_waitcnt vmcnt(12)
 s_barrier
 ds_read_b128 v[160:163], v2 offset:32768
 ds_read_b128 v[164:167], v2 offset:33792
 s_waitcnt lgkmcnt(4)
 v_mfma_f32_16x16x32_bf16 v[136:139], a[56:59], v[168:171], v[136:139]
 v_mfma_f32_16x16x32_bf16 v[144:147], a[248:251], v[168:171], v[144:147]
 v_mfma_f32_16x16x32_bf16 v[140:143], a[56:59], v[172:175], v[140:143]
 v_mfma_f32_16x16x32_bf16 v[148:151], a[248:251], v[172:175], v[148:151]
 ds_read_b128 v[168:171], v2 offset:34816
 ds_read_b128 v[172:175], v2 offset:35840
 s_waitcnt lgkmcnt(4)
 v_mfma_f32_16x16x32_bf16 v[136:139], a[60:63], v[152:155], v[136:139]
 v_mfma_f32_16x16x32_bf16 v[144:147], a[252:255], v[152:155], v[144:147]
 v_mfma_f32_16x16x32_bf16 v[140:143], a[60:63], v[156:159], v[140:143]
 v_mfma_f32_16x16x32_bf16 v[148:151], a[252:255], v[156:159], v[148:151]
 ds_read_b128 v[152:155], v2 offset:36864
 ds_read_b128 v[156:159], v2 offset:37888
 s_waitcnt lgkmcnt(4)
 v_mfma_f32_16x16x32_bf16 v[136:139], a[64:67], v[160:163], v[136:139]
 v_mfma_f32_16x16x32_bf16 v[144:147], v[4:7], v[160:163], v[144:147]
 v_mfma_f32_16x16x32_bf16 v[140:143], a[64:67], v[164:167], v[140:143]
 v_mfma_f32_16x16x32_bf16 v[148:151], v[4:7], v[164:167], v[148:151]
 ds_read_b128 v[160:163], v2 offset:38912
 ds_read_b128 v[164:167], v2 offset:39936
 s_waitcnt lgkmcnt(4)
 v_mfma_f32_16x16x32_bf16 v[136:139], a[68:71], v[168:171], v[136:139]
 v_mfma_f32_16x16x32_bf16 v[144:147], v[8:11], v[168:171], v[144:147]
 v_mfma_f32_16x16x32_bf16 v[140:143], a[68:71], v[172:175], v[140:143]
 v_mfma_f32_16x16x32_bf16 v[148:151], v[8:11], v[172:175], v[148:151]
 ds_read_b128 v[168:171], v2 offset:40960
 ds_read_b128 v[172:175], v2 offset:41984
 s_waitcnt lgkmcnt(4)
 v_mfma_f32_16x16x32_bf16 v[136:139], a[72:75], v[152:155], v[136:139]
 v_mfma_f32_16x16x32_bf16 v[144:147], v[12:15], v[152:155], v[144:147]
 v_mfma_f32_16x16x32_bf16 v[140:143], a[72:75], v[156:159], v[140:143]
 v_mfma_f32_16x16x32_bf16 v[148:151], v[12:15], v[156:159], v[148:151]
 ds_read_b128 v[152:155], v2 offset:43008
 ds_read_b128 v[156:159], v2 offset:44032
 s_waitcnt lgkmcnt(4)
 v_mfma_f32_16x16x32_bf16 v[136:139], a[76:79], v[160:163], v[136:139]
 v_mfma_f32_16x16x32_bf16 v[144:147], v[16:19], v[160:163], v[144:147]
 v_mfma_f32_16x16x32_bf16 v[140:143], a[76:79], v[164:167], v[140:143]
 v_mfma_f32_16x16x32_bf16 v[148:151], v[16:19], v[164:167], v[148:151]
 ds_read_b128 v[160:163], v2 offset:45056
 ds_read_b128 v[164:167], v2 offset:46080
 s_waitcnt lgkmcnt(4)
 v_mfma_f32_16x16x32_bf16 v[136:139], a[80:83], v[168:171], v[136:139]
 v_mfma_f32_16x16x32_bf16 v[144:147], v[20:23], v[168:171], v[144:147]
 v_mfma_f32_16x16x32_bf16 v[140:143], a[80:83], v[172:175], v[140:143]
 v_mfma_f32_16x16x32_bf16 v[148:151], v[20:23], v[172:175], v[148:151]
 ds_read_b128 v[168:171], v2 offset:47104
 ds_read_b128 v[172:175], v2 offset:48128
 s_waitcnt lgkmcnt(4)
 v_mfma_f32_16x16x32_bf16 v[136:139], a[84:87], v[152:155], v[136:139]
 v_mfma_f32_16x16x32_bf16 v[144:147], v[24:27], v[152:155], v[144:147]
 v_mfma_f32_16x16x32_bf16 v[140:143], a[84:87], v[156:159], v[140:143]
 v_mfma_f32_16x16x32_bf16 v[148:151], v[24:27], v[156:159], v[148:151]
 s_waitcnt vmcnt(8)
 s_barrier
 ds_read_b128 v[152:155], v134 offset:0
 ds_read_b128 v[156:159], v134 offset:1024
 s_waitcnt lgkmcnt(4)
 v_mfma_f32_16x16x32_bf16 v[136:139], a[88:91], v[160:163], v[136:139]
 v_mfma_f32_16x16x32_bf16 v[144:147], v[28:31], v[160:163], v[144:147]
 v_mfma_f32_16x16x32_bf16 v[140:143], a[88:91], v[164:167], v[140:143]
 v_mfma_f32_16x16x32_bf16 v[148:151], v[28:31], v[164:167], v[148:151]
 ds_read_b128 v[160:163], v134 offset:2048
 ds_read_b128 v[164:167], v134 offset:3072
 s_waitcnt lgkmcnt(4)
 v_mfma_f32_16x16x32_bf16 v[136:139], a[92:95], v[168:171], v[136:139]
 v_mfma_f32_16x16x32_bf16 v[144:147], v[32:35], v[168:171], v[144:147]
 v_mfma_f32_16x16x32_bf16 v[140:143], a[92:95], v[172:175], v[140:143]
 v_mfma_f32_16x16x32_bf16 v[148:151], v[32:35], v[172:175], v[148:151]
 ds_read_b128 v[168:171], v134 offset:4096
 ds_read_b128 v[172:175], v134 offset:5120
 s_waitcnt lgkmcnt(4)
 v_mfma_f32_16x16x32_bf16 v[136:139], a[96:99], v[152:155], v[136:139]
 v_mfma_f32_16x16x32_bf16 v[144:147], v[36:39], v[152:155], v[144:147]
 v_mfma_f32_16x16x32_bf16 v[140:143], a[96:99], v[156:159], v[140:143]
 v_mfma_f32_16x16x32_bf16 v[148:151], v[36:39], v[156:159], v[148:151]
 ds_read_b128 v[152:155], v134 offset:6144
 ds_read_b128 v[156:159], v134 offset:7168
 s_waitcnt lgkmcnt(4)
 v_mfma_f32_16x16x32_bf16 v[136:139], a[100:103], v[160:163], v[136:139]
 v_mfma_f32_16x16x32_bf16 v[144:147], v[40:43], v[160:163], v[144:147]
 v_mfma_f32_16x16x32_bf16 v[140:143], a[100:103], v[164:167], v[140:143]
 v_mfma_f32_16x16x32_bf16 v[148:151], v[40:43], v[164:167], v[148:151]
 ds_read_b128 v[160:163], v134 offset:8192
 ds_read_b128 v[164:167], v134 offset:9216
 s_waitcnt lgkmcnt(4)
 v_mfma_f32_16x16x32_bf16 v[136:139], a[104:107], v[168:171], v[136:139]
 v_mfma_f32_16x16x32_bf16 v[144:147], v[44:47], v[168:171], v[144:147]
 v_mfma_f32_16x16x32_bf16 v[140:143], a[104:107], v[172:175], v[140:143]
 v_mfma_f32_16x16x32_bf16 v[148:151], v[44:47], v[172:175], v[148:151]
 ds_read_b128 v[168:171], v134 offset:10240
 ds_read_b128 v[172:175], v134 offset:11264
 s_waitcnt lgkmcnt(4)
 v_mfma_f32_16x16x32_bf16 v[136:139], a[108:111], v[152:155], v[136:139]
 v_mfma_f32_16x16x32_bf16 v[144:147], v[48:51], v[152:155], v[144:147]
 v_mfma_f32_16x16x32_bf16 v[140:143], a[108:111], v[156:159], v[140:143]
 v_mfma_f32_16x16x32_bf16 v[148:151], v[48:51], v[156:159], v[148:151]
 ds_read_b128 v[152:155], v134 offset:12288
 ds_read_b128 v[156:159], v134 offset:13312
 s_waitcnt lgkmcnt(4)
 v_mfma_f32_16x16x32_bf16 v[136:139], a[112:115], v[160:163], v[136:139]
 v_mfma_f32_16x16x32_bf16 v[144:147], v[52:55], v[160:163], v[144:147]
 v_mfma_f32_16x16x32_bf16 v[140:143], a[112:115], v[164:167], v[140:143]
 v_mfma_f32_16x16x32_bf16 v[148:151], v[52:55], v[164:167], v[148:151]
 ds_read_b128 v[160:163], v134 offset:14336
 ds_read_b128 v[164:167], v134 offset:15360
 s_waitcnt lgkmcnt(4)
 v_mfma_f32_16x16x32_bf16 v[136:139], a[116:119], v[168:171], v[136:139]
 v_mfma_f32_16x16x32_bf16 v[144:147], v[56:59], v[168:171], v[144:147]
 v_mfma_f32_16x16x32_bf16 v[140:143], a[116:119], v[172:175], v[140:143]
 v_mfma_f32_16x16x32_bf16 v[148:151], v[56:59], v[172:175], v[148:151]
 s_waitcnt vmcnt(4)
 s_barrier
 ds_read_b128 v[168:171], v134 offset:16384
 ds_read_b128 v[172:175], v134 offset:17408
 s_waitcnt lgkmcnt(4)
 v_mfma_f32_16x16x32_bf16 v[136:139], a[120:123], v[152:155], v[136:139]
 v_mfma_f32_16x16x32_bf16 v[144:147], v[60:63], v[152:155], v[144:147]
 v_mfma_f32_16x16x32_bf16 v[140:143], a[120:123], v[156:159], v[140:143]
 v_mfma_f32_16x16x32_bf16 v[148:151], v[60:63], v[156:159], v[148:151]
 ds_read_b128 v[152:155], v134 offset:18432
 ds_read_b128 v[156:159], v134 offset:19456
 s_waitcnt lgkmcnt(4)
 v_mfma_f32_16x16x32_bf16 v[136:139], a[124:127], v[160:163], v[136:139]
 v_mfma_f32_16x16x32_bf16 v[144:147], v[64:67], v[160:163], v[144:147]
 v_mfma_f32_16x16x32_bf16 v[140:143], a[124:127], v[164:167], v[140:143]
 v_mfma_f32_16x16x32_bf16 v[148:151], v[64:67], v[164:167], v[148:151]
 ds_read_b128 v[160:163], v134 offset:20480
 ds_read_b128 v[164:167], v134 offset:21504
 s_waitcnt lgkmcnt(4)
 v_mfma_f32_16x16x32_bf16 v[136:139], a[128:131], v[168:171], v[136:139]
 v_mfma_f32_16x16x32_bf16 v[144:147], v[68:71], v[168:171], v[144:147]
 v_mfma_f32_16x16x32_bf16 v[140:143], a[128:131], v[172:175], v[140:143]
 v_mfma_f32_16x16x32_bf16 v[148:151], v[68:71], v[172:175], v[148:151]
 ds_read_b128 v[168:171], v134 offset:22528
 ds_read_b128 v[172:175], v134 offset:23552
 s_waitcnt lgkmcnt(4)
 v_mfma_f32_16x16x32_bf16 v[136:139], a[132:135], v[152:155], v[136:139]
 v_mfma_f32_16x16x32_bf16 v[144:147], v[72:75], v[152:155], v[144:147]
 v_mfma_f32_16x16x32_bf16 v[140:143], a[132:135], v[156:159], v[140:143]
 v_mfma_f32_16x16x32_bf16 v[148:151], v[72:75], v[156:159], v[148:151]
 ds_read_b128 v[152:155], v134 offset:24576
 ds_read_b128 v[156:159], v134 offset:25600
 s_waitcnt lgkmcnt(4)
 v_mfma_f32_16x16x32_bf16 v[136:139], a[136:139], v[160:163], v[136:139]
 v_mfma_f32_16x16x32_bf16 v[144:147], v[76:79], v[160:163], v[144:147]
 v_mfma_f32_16x16x32_bf16 v[140:143], a[136:139], v[164:167], v[140:143]
 v_mfma_f32_16x16x32_bf16 v[148:151], v[76:79], v[164:167], v[148:151]
 ds_read_b128 v[160:163], v134 offset:26624
 ds_read_b128 v[164:167], v134 offset:27648
 s_waitcnt lgkmcnt(4)
 v_mfma_f32_16x16x32_bf16 v[136:139], a[140:143], v[168:171], v[136:139]
 v_mfma_f32_16x16x32_bf16 v[144:147], v[80:83], v[168:171], v[144:147]
 v_mfma_f32_16x16x32_bf16 v[140:143], a[140:143], v[172:175], v[140:143]
 v_mfma_f32_16x16x32_bf16 v[148:151], v[80:83], v[172:175], v[148:151]
 ds_read_b128 v[168:171], v134 offset:28672
 ds_read_b128 v[172:175], v134 offset:29696
 s_waitcnt lgkmcnt(4)
 v_mfma_f32_16x16x32_bf16 v[136:139], a[144:147], v[152:155], v[136:139]
 v_mfma_f32_16x16x32_bf16 v[144:147], v[84:87], v[152:155], v[144:147]
 v_mfma_f32_16x16x32_bf16 v[140:143], a[144:147], v[156:159], v[140:143]
 v_mfma_f32_16x16x32_bf16 v[148:151], v[84:87], v[156:159], v[148:151]
 ds_read_b128 v[152:155], v134 offset:30720
 ds_read_b128 v[156:159], v134 offset:31744
 s_waitcnt lgkmcnt(4)
 v_mfma_f32_16x16x32_bf16 v[136:139], a[148:151], v[160:163], v[136:139]
 v_mfma_f32_16x16x32_bf16 v[144:147], v[88:91], v[160:163], v[144:147]
 v_mfma_f32_16x16x32_bf16 v[140:143], a[148:151], v[164:167], v[140:143]
 v_mfma_f32_16x16x32_bf16 v[148:151], v[88:91], v[164:167], v[148:151]
 s_waitcnt vmcnt(0)
 s_barrier
 ds_read_b128 v[160:163], v134 offset:32768
 ds_read_b128 v[164:167], v134 offset:33792
 s_waitcnt lgkmcnt(4)
 v_mfma_f32_16x16x32_bf16 v[136:139], a[152:155], v[168:171], v[136:139]
 v_mfma_f32_16x16x32_bf16 v[144:147], v[92:95], v[168:171], v[144:147]
 v_mfma_f32_16x16x32_bf16 v[140:143], a[152:155], v[172:175], v[140:143]
 v_mfma_f32_16x16x32_bf16 v[148:151], v[92:95], v[172:175], v[148:151]
 ds_read_b128 v[168:171], v134 offset:34816
 ds_read_b128 v[172:175], v134 offset:35840
 s_waitcnt lgkmcnt(4)
 v_mfma_f32_16x16x32_bf16 v[136:139], a[156:159], v[152:155], v[136:139]
 v_mfma_f32_16x16x32_bf16 v[144:147], v[96:99], v[152:155], v[144:147]
 v_mfma_f32_16x16x32_bf16 v[140:143], a[156:159], v[156:159], v[140:143]
 v_mfma_f32_16x16x32_bf16 v[148:151], v[96:99], v[156:159], v[148:151]
 ds_read_b128 v[152:155], v134 offset:36864
 ds_read_b128 v[156:159], v134 offset:37888
 s_waitcnt lgkmcnt(4)
 v_mfma_f32_16x16x32_bf16 v[136:139], a[160:163], v[160:163], v[136:139]
 v_mfma_f32_16x16x32_bf16 v[144:147], v[100:103], v[160:163], v[144:147]
 v_mfma_f32_16x16x32_bf16 v[140:143], a[160:163], v[164:167], v[140:143]
 v_mfma_f32_16x16x32_bf16 v[148:151], v[100:103], v[164:167], v[148:151]
 ds_read_b128 v[160:163], v134 offset:38912
 ds_read_b128 v[164:167], v134 offset:39936
 s_waitcnt lgkmcnt(4)
 v_mfma_f32_16x16x32_bf16 v[136:139], a[164:167], v[168:171], v[136:139]
 v_mfma_f32_16x16x32_bf16 v[144:147], v[104:107], v[168:171], v[144:147]
 v_mfma_f32_16x16x32_bf16 v[140:143], a[164:167], v[172:175], v[140:143]
 v_mfma_f32_16x16x32_bf16 v[148:151], v[104:107], v[172:175], v[148:151]
 ds_read_b128 v[168:171], v134 offset:40960
 ds_read_b128 v[172:175], v134 offset:41984
 s_waitcnt lgkmcnt(4)
 v_mfma_f32_16x16x32_bf16 v[136:139], a[168:171], v[152:155], v[136:139]
 v_mfma_f32_16x16x32_bf16 v[144:147], v[108:111], v[152:155], v[144:147]
 v_mfma_f32_16x16x32_bf16 v[140:143], a[168:171], v[156:159], v[140:143]
 v_mfma_f32_16x16x32_bf16 v[148:151], v[108:111], v[156:159], v[148:151]
 ds_read_b128 v[152:155], v134 offset:43008
 ds_read_b128 v[156:159], v134 offset:44032
 s_waitcnt lgkmcnt(4)
 v_mfma_f32_16x16x32_bf16 v[136:139], a[172:175], v[160:163], v[136:139]
 v_mfma_f32_16x16x32_bf16 v[144:147], v[112:115], v[160:163], v[144:147]
 v_mfma_f32_16x16x32_bf16 v[140:143], a[172:175], v[164:167], v[140:143]
 v_mfma_f32_16x16x32_bf16 v[148:151], v[112:115], v[164:167], v[148:151]
 ds_read_b128 v[160:163], v134 offset:45056
 ds_read_b128 v[164:167], v134 offset:46080
 s_waitcnt lgkmcnt(4)
 v_mfma_f32_16x16x32_bf16 v[136:139], a[176:179], v[168:171], v[136:139]
 v_mfma_f32_16x16x32_bf16 v[144:147], v[116:119], v[168:171], v[144:147]
 v_mfma_f32_16x16x32_bf16 v[140:143], a[176:179], v[172:175], v[140:143]
 v_mfma_f32_16x16x32_bf16 v[148:151], v[116:119], v[172:175], v[148:151]
 ds_read_b128 v[168:171], v134 offset:47104
 ds_read_b128 v[172:175], v134 offset:48128
 s_waitcnt lgkmcnt(4)
 v_mfma_f32_16x16x32_bf16 v[136:139], a[180:183], v[152:155], v[136:139]
 v_mfma_f32_16x16x32_bf16 v[144:147], v[120:123], v[152:155], v[144:147]
 v_mfma_f32_16x16x32_bf16 v[140:143], a[180:183], v[156:159], v[140:143]
 v_mfma_f32_16x16x32_bf16 v[148:151], v[120:123], v[156:159], v[148:151]
 s_waitcnt lgkmcnt(3)
 v_mfma_f32_16x16x32_bf16 v[136:139], a[184:187], v[160:163], v[136:139]
 v_mfma_f32_16x16x32_bf16 v[144:147], v[124:127], v[160:163], v[144:147]
 s_waitcnt lgkmcnt(2)
 v_mfma_f32_16x16x32_bf16 v[140:143], a[184:187], v[164:167], v[140:143]
 v_mfma_f32_16x16x32_bf16 v[148:151], v[124:127], v[164:167], v[148:151]
 s_waitcnt lgkmcnt(1)
 v_mfma_f32_16x16x32_bf16 v[136:139], a[188:191], v[168:171], v[136:139]
 v_mfma_f32_16x16x32_bf16 v[144:147], v[128:131], v[168:171], v[144:147]
 s_waitcnt lgkmcnt(0)
 v_mfma_f32_16x16x32_bf16 v[140:143], a[188:191], v[172:175], v[140:143]
 v_mfma_f32_16x16x32_bf16 v[148:151], v[128:131], v[172:175], v[148:151]
 s_mul_i32 s19, s38, 81920
 s_add_u32 s19, s19, s37
 s_add_u32 s20, s19, 40960
 buffer_store_dwordx4 v[136:139], v133, s[4:7], s19 offen offset:0 sc1
 buffer_store_dwordx4 v[144:147], v133, s[4:7], s19 offen offset:64 sc1
 buffer_store_dwordx4 v[140:143], v133, s[4:7], s20 offen offset:0 sc1
 s_nop 1
 buffer_store_dwordx4 v[148:151], v133, s[4:7], s20 offen offset:64 sc1
 s_waitcnt vmcnt(0)
 s_barrier
 s_cmp_eq_u32 s3, 0
 s_cbranch_scc0 Lnp_345
 s_mov_b64 exec, 1
 v_mov_b32 v3, s39
 buffer_store_dword v3, off, s[4:7], s34 sc1
 s_mov_b64 exec, -1
Lnp_345:
 s_mov_b32 s38, s39
 s_cmp_lt_u32 s38, 64
 s_cbranch_scc1 Ld_343
 s_endpgm
L_role_r1:
 s_sub_u32 s12, s12, 242
 s_cmp_eq_u32 s13, 1
 s_cbranch_scc1 Lverok_347
 s_mov_b32 s18, 0
Lver_346:
 s_add_u32 s18, s18, 1
 s_cmp_gt_u32 s18, 200000
 s_cbranch_scc1 L_fail
 v_and_b32 v254, 7, v0
 v_lshlrev_b32 v254, 2, v254
 buffer_load_dword v255, v254, s[8:11], 0 offen sc1
 s_waitcnt vmcnt(0)
 v_cmp_eq_u32 vcc, 32, v255
 s_nop 0
 s_cmp_eq_u64 vcc, -1
 s_cbranch_scc1 Lverok_347
 s_mov_b32 s17, 0
 v_readlane_b32 s14, v255, 0
 s_nop 0
 s_add_u32 s17, s17, s14
 v_readlane_b32 s14, v255, 1
 s_nop 0
 s_add_u32 s17, s17, s14
 v_readlane_b32 s14, v255, 2
 s_nop 0
 s_add_u32 s17, s17, s14
 v_readlane_b32 s14, v255, 3
 s_nop 0
 s_add_u32 s17, s17, s14
 v_readlane_b32 s14, v255, 4
 s_nop 0
 s_add_u32 s17, s17, s14
 v_readlane_b32 s14, v255, 5
 s_nop 0
 s_add_u32 s17, s17, s14
 v_readlane_b32 s14, v255, 6
 s_nop 0
 s_add_u32 s17, s17, s14
 v_readlane_b32 s14, v255, 7
 s_nop 0
 s_add_u32 s17, s17, s14
 s_cmp_eq_u32 s17, 256
 s_cbranch_scc1 L_fallback
 s_branch Lver_346
Lverok_347:
 s_load_dwordx2 s[36:37], s[0:1], 88
 v_and_b32 v1, 63, v0
 s_lshl_b32 s29, s12, 2
 s_add_u32 s29, s29, s3
 s_mov_b32 s30, 0x3acccccd
 v_lshrrev_b32 v8, 5, v1
 v_and_b32 v9, 31, v1
 v_min_u32 v6, 19, v9
 v_lshl_add_u32 v6, v8, 6, v6
 v_lshlrev_b32 v6, 2, v6
 v_add_u32 v6, 6144, v6
 s_mul_i32 s19, s29, 2560
 v_lshl_add_u32 v2, v9, 4, s19
 v_mul_u32_u24 v4, 163840, v8
 v_add_u32 v4, v4, v2
 v_lshrrev_b32 v3, 1, v2
 s_mov_b32 s25, 0
 s_mov_b32 s26, 0
 s_waitcnt lgkmcnt(0)
 s_mov_b32 s32, s36
 s_mov_b32 s33, s37
 s_mov_b32 s34, 2621440
 s_mov_b32 s35, 0x20000
Lr_348:
 s_add_u32 s19, s25, s26
 s_cmp_ge_u32 s19, 128
 s_cbranch_scc1 L_exit
 v_mov_b32 v7, s25
 s_mov_b32 exec_lo, 0
 v_mov_b32 v7, s26
 s_mov_b32 exec_lo, -1
 s_mov_b32 s24, 0
Lrs_349:
 s_add_u32 s24, s24, 1
 s_cmp_gt_u32 s24, 200000
 s_cbranch_scc1 L_fail
 buffer_load_dword v5, v6, s[4:7], 0 offen sc1
 s_waitcnt vmcnt(0)
 v_cmp_lt_u32 vcc, v7, v5
 s_nop 0
 s_cmp_eq_u32 vcc_lo, -1
 s_cbranch_scc0 Lr1_351
 s_mov_b32 s27, 0
 s_mov_b32 s28, s25
 s_add_u32 s25, s25, 1
 s_branch Lrg_350
Lr1_351:
 s_cmp_eq_u32 vcc_hi, -1
 s_cbranch_scc0 Lrs_349
 s_mov_b32 s27, 1
 s_mov_b32 s28, s26
 s_add_u32 s26, s26, 1
Lrg_350:
 s_mul_i32 s19, s28, 81920
 s_mul_i32 s20, s28, 327680
 s_add_u32 s20, s20, 213565440
 s_add_u32 s21, s20, 81920
 s_mul_i32 s22, s27, 5242880
 s_add_u32 s22, s22, s19
 s_add_u32 s22, s22, 197836800
 buffer_load_dwordx4 v[30:33], v4, s[4:7], s20 offen offset:0 sc1
 buffer_load_dwordx4 v[34:37], v4, s[4:7], s20 offen offset:512 sc1
 buffer_load_dwordx4 v[38:41], v4, s[4:7], s20 offen offset:1024 sc1
 buffer_load_dwordx4 v[42:45], v4, s[4:7], s20 offen offset:1536 sc1
 buffer_load_dwordx4 v[46:49], v4, s[4:7], s20 offen offset:2048 sc1
 buffer_load_dwordx4 v[50:53], v4, s[4:7], s21 offen offset:0 sc1
 buffer_load_dwordx4 v[54:57], v4, s[4:7], s21 offen offset:512 sc1
 buffer_load_dwordx4 v[58:61], v4, s[4:7], s21 offen offset:1024 sc1
 buffer_load_dwordx4 v[62:65], v4, s[4:7], s21 offen offset:1536 sc1
 buffer_load_dwordx4 v[66:69], v4, s[4:7], s21 offen offset:2048 sc1
 buffer_load_dwordx4 v[10:13], v2, s[4:7], s22 offen offset:0 sc1
 buffer_load_dwordx4 v[14:17], v2, s[4:7], s22 offen offset:512 sc1
 buffer_load_dwordx4 v[18:21], v2, s[4:7], s22 offen offset:1024 sc1
 buffer_load_dwordx4 v[22:25], v2, s[4:7], s22 offen offset:1536 sc1
 buffer_load_dwordx4 v[26:29], v2, s[4:7], s22 offen offset:2048 sc1
 s_waitcnt vmcnt(5)
 v_add_f32 v30, v30, v50
 v_add_f32 v31, v31, v51
 v_add_f32 v32, v32, v52
 v_add_f32 v33, v33, v53
 v_add_f32 v34, v34, v54
 v_add_f32 v35, v35, v55
 v_add_f32 v36, v36, v56
 v_add_f32 v37, v37, v57
 v_add_f32 v38, v38, v58
 v_add_f32 v39, v39, v59
 v_add_f32 v40, v40, v60
 v_add_f32 v41, v41, v61
 v_add_f32 v42, v42, v62
 v_add_f32 v43, v43, v63
 v_add_f32 v44, v44, v64
 v_add_f32 v45, v45, v65
 v_add_f32 v46, v46, v66
 v_add_f32 v47, v47, v67
 v_add_f32 v48, v48, v68
 v_add_f32 v49, v49, v69
 v_mov_b32 v50, v30
 v_mov_b32 v51, v31
 v_mov_b32 v52, v32
 v_mov_b32 v53, v33
 v_mov_b32 v54, v34
 v_mov_b32 v55, v35
 v_mov_b32 v56, v36
 v_mov_b32 v57, v37
 v_mov_b32 v58, v38
 v_mov_b32 v59, v39
 v_mov_b32 v60, v40
 v_mov_b32 v61, v41
 v_mov_b32 v62, v42
 v_mov_b32 v63, v43
 v_mov_b32 v64, v44
 v_mov_b32 v65, v45
 v_mov_b32 v66, v46
 v_mov_b32 v67, v47
 v_mov_b32 v68, v48
 v_mov_b32 v69, v49
 v_permlane32_swap_b32 v30, v50
 v_permlane32_swap_b32 v31, v51
 v_permlane32_swap_b32 v32, v52
 v_permlane32_swap_b32 v33, v53
 v_permlane32_swap_b32 v34, v54
 v_permlane32_swap_b32 v35, v55
 v_permlane32_swap_b32 v36, v56
 v_permlane32_swap_b32 v37, v57
 v_permlane32_swap_b32 v38, v58
 v_permlane32_swap_b32 v39, v59
 v_permlane32_swap_b32 v40, v60
 v_permlane32_swap_b32 v41, v61
 v_permlane32_swap_b32 v42, v62
 v_permlane32_swap_b32 v43, v63
 v_permlane32_swap_b32 v44, v64
 v_permlane32_swap_b32 v45, v65
 v_permlane32_swap_b32 v46, v66
 v_permlane32_swap_b32 v47, v67
 v_permlane32_swap_b32 v48, v68
 v_permlane32_swap_b32 v49, v69
 s_waitcnt vmcnt(0)
 v_add_f32 v30, v30, v50
 v_add_f32 v31, v31, v51
 v_add_f32 v32, v32, v52
 v_add_f32 v33, v33, v53
 v_add_f32 v34, v34, v54
 v_add_f32 v35, v35, v55
 v_add_f32 v36, v36, v56
 v_add_f32 v37, v37, v57
 v_add_f32 v38, v38, v58
 v_add_f32 v39, v39, v59
 v_add_f32 v40, v40, v60
 v_add_f32 v41, v41, v61
 v_add_f32 v42, v42, v62
 v_add_f32 v43, v43, v63
 v_add_f32 v44, v44, v64
 v_add_f32 v45, v45, v65
 v_add_f32 v46, v46, v66
 v_add_f32 v47, v47, v67
 v_add_f32 v48, v48, v68
 v_add_f32 v49, v49, v69
 v_add_f32 v10, v10, v30
 v_add_f32 v11, v11, v31
 v_add_f32 v12, v12, v32
 v_add_f32 v13, v13, v33
 v_add_f32 v14, v14, v34
 v_add_f32 v15, v15, v35
 v_add_f32 v16, v16, v36
 v_add_f32 v17, v17, v37
 v_add_f32 v18, v18, v38
 v_add_f32 v19, v19, v39
 v_add_f32 v20, v20, v40
 v_add_f32 v21, v21, v41
 v_add_f32 v22, v22, v42
 v_add_f32 v23, v23, v43
 v_add_f32 v24, v24, v44
 v_add_f32 v25, v25, v45
 v_add_f32 v26, v26, v46
 v_add_f32 v27, v27, v47
 v_add_f32 v28, v28, v48
 v_add_f32 v29, v29, v49
 v_add_f32 v8, v10, v11
 v_add_f32 v9, v12, v13
 v_add_f32 v8, v8, v14
 v_add_f32 v9, v9, v15
 v_add_f32 v8, v8, v16
 v_add_f32 v9, v9, v17
 v_add_f32 v8, v8, v18
 v_add_f32 v9, v9, v19
 v_add_f32 v8, v8, v20
 v_add_f32 v9, v9, v21
 v_add_f32 v8, v8, v22
 v_add_f32 v9, v9, v23
 v_add_f32 v8, v8, v24
 v_add_f32 v9, v9, v25
 v_add_f32 v8, v8, v26
 v_add_f32 v9, v9, v27
 v_add_f32 v8, v8, v28
 v_add_f32 v9, v9, v29
 v_add_f32 v8, v8, v9
 s_nop 1
 v_add_f32_dpp v8, v8, v8 row_ror:8 row_mask:0xf bank_mask:0xf
 s_nop 1
 v_add_f32_dpp v8, v8, v8 row_ror:4 row_mask:0xf bank_mask:0xf
 s_nop 1
 v_add_f32_dpp v8, v8, v8 row_ror:2 row_mask:0xf bank_mask:0xf
 s_nop 1
 v_add_f32_dpp v8, v8, v8 row_ror:1 row_mask:0xf bank_mask:0xf
 v_mov_b32 v9, v8
 s_nop 1
 v_permlane16_swap_b32 v8, v9
 v_add_f32 v8, v8, v9
 v_mul_f32 v8, s30, v8
 v_sub_f32 v30, v10, v8
 v_sub_f32 v31, v11, v8
 v_sub_f32 v32, v12, v8
 v_sub_f32 v33, v13, v8
 v_sub_f32 v34, v14, v8
 v_sub_f32 v35, v15, v8
 v_sub_f32 v36, v16, v8
 v_sub_f32 v37, v17, v8
 v_sub_f32 v38, v18, v8
 v_sub_f32 v39, v19, v8
 v_sub_f32 v40, v20, v8
 v_sub_f32 v41, v21, v8
 v_sub_f32 v42, v22, v8
 v_sub_f32 v43, v23, v8
 v_sub_f32 v44, v24, v8
 v_sub_f32 v45, v25, v8
 v_sub_f32 v46, v26, v8
 v_sub_f32 v47, v27, v8
 v_sub_f32 v48, v28, v8
 v_sub_f32 v49, v29, v8
 v_mul_f32 v8, v30, v30
 v_mul_f32 v9, v31, v31
 v_fmac_f32 v8, v32, v32
 v_fmac_f32 v9, v33, v33
 v_fmac_f32 v8, v34, v34
 v_fmac_f32 v9, v35, v35
 v_fmac_f32 v8, v36, v36
 v_fmac_f32 v9, v37, v37
 v_fmac_f32 v8, v38, v38
 v_fmac_f32 v9, v39, v39
 v_fmac_f32 v8, v40, v40
 v_fmac_f32 v9, v41, v41
 v_fmac_f32 v8, v42, v42
 v_fmac_f32 v9, v43, v43
 v_fmac_f32 v8, v44, v44
 v_fmac_f32 v9, v45, v45
 v_fmac_f32 v8, v46, v46
 v_fmac_f32 v9, v47, v47
 v_fmac_f32 v8, v48, v48
 v_fmac_f32 v9, v49, v49
 v_add_f32 v8, v8, v9
 s_nop 1
 v_add_f32_dpp v8, v8, v8 row_ror:8 row_mask:0xf bank_mask:0xf
 s_nop 1
 v_add_f32_dpp v8, v8, v8 row_ror:4 row_mask:0xf bank_mask:0xf
 s_nop 1
 v_add_f32_dpp v8, v8, v8 row_ror:2 row_mask:0xf bank_mask:0xf
 s_nop 1
 v_add_f32_dpp v8, v8, v8 row_ror:1 row_mask:0xf bank_mask:0xf
 v_mov_b32 v9, v8
 s_nop 1
 v_permlane16_swap_b32 v8, v9
 v_add_f32 v8, v8, v9
 v_mov_b32 v9, 0x3727c5ac
 v_fma_f32 v8, v8, s30, v9
 v_rsq_f32 v8, v8
 s_nop 0
 v_mul_f32 v30, v30, v8
 v_mul_f32 v31, v31, v8
 v_mul_f32 v32, v32, v8
 v_mul_f32 v33, v33, v8
 v_mul_f32 v34, v34, v8
 v_mul_f32 v35, v35, v8
 v_mul_f32 v36, v36, v8
 v_mul_f32 v37, v37, v8
 v_mul_f32 v38, v38, v8
 v_mul_f32 v39, v39, v8
 v_mul_f32 v40, v40, v8
 v_mul_f32 v41, v41, v8
 v_mul_f32 v42, v42, v8
 v_mul_f32 v43, v43, v8
 v_mul_f32 v44, v44, v8
 v_mul_f32 v45, v45, v8
 v_mul_f32 v46, v46, v8
 v_mul_f32 v47, v47, v8
 v_mul_f32 v48, v48, v8
 v_mul_f32 v49, v49, v8
 v_cvt_pk_bf16_f32 v70, v30, v31
 v_cvt_pk_bf16_f32 v71, v32, v33
 v_cvt_pk_bf16_f32 v72, v34, v35
 v_cvt_pk_bf16_f32 v73, v36, v37
 v_cvt_pk_bf16_f32 v74, v38, v39
 v_cvt_pk_bf16_f32 v75, v40, v41
 v_cvt_pk_bf16_f32 v76, v42, v43
 v_cvt_pk_bf16_f32 v77, v44, v45
 v_cvt_pk_bf16_f32 v78, v46, v47
 v_cvt_pk_bf16_f32 v79, v48, v49
 s_lshr_b32 s20, s19, 1
 s_add_u32 s20, s20, 189972480
 s_add_u32 s21, s19, 192593920
 s_mov_b32 exec_hi, 0
 buffer_store_dwordx2 v[70:71], v3, s[4:7], s20 offen offset:0 sc1
 buffer_store_dwordx2 v[72:73], v3, s[4:7], s20 offen offset:256 sc1
 buffer_store_dwordx2 v[74:75], v3, s[4:7], s20 offen offset:512 sc1
 buffer_store_dwordx2 v[76:77], v3, s[4:7], s20 offen offset:768 sc1
 buffer_store_dwordx2 v[78:79], v3, s[4:7], s20 offen offset:1024 sc1
 buffer_store_dwordx4 v[10:13], v2, s[4:7], s21 offen offset:0 sc1
 buffer_store_dwordx4 v[14:17], v2, s[4:7], s21 offen offset:512 sc1
 buffer_store_dwordx4 v[18:21], v2, s[4:7], s21 offen offset:1024 sc1
 buffer_store_dwordx4 v[22:25], v2, s[4:7], s21 offen offset:1536 sc1
 buffer_store_dwordx4 v[26:29], v2, s[4:7], s21 offen offset:2048 sc1
 s_mov_b32 exec_hi, -1
 s_lshl_b32 s19, s27, 6
 s_add_u32 s19, s19, s29
 s_lshl_b32 s19, s19, 2
 s_add_u32 s19, s19, 7168
 s_add_u32 s20, s28, 1
 s_waitcnt vmcnt(0)
 s_mov_b64 exec, 1
 v_mov_b32 v5, s20
 buffer_store_dword v5, off, s[4:7], s19 sc1
 s_mov_b64 exec, -1
 s_branch Lr_348
L_role_r2:
 s_sub_u32 s12, s12, 250
 s_cmp_eq_u32 s13, 1
 s_cbranch_scc1 Lverok_353
 s_mov_b32 s18, 0
Lver_352:
 s_add_u32 s18, s18, 1
 s_cmp_gt_u32 s18, 200000
 s_cbranch_scc1 L_fail
 v_and_b32 v254, 7, v0
 v_lshlrev_b32 v254, 2, v254
 buffer_load_dword v255, v254, s[8:11], 0 offen sc1
 s_waitcnt vmcnt(0)
 v_cmp_eq_u32 vcc, 32, v255
 s_nop 0
 s_cmp_eq_u64 vcc, -1
 s_cbranch_scc1 Lverok_353
 s_mov_b32 s17, 0
 v_readlane_b32 s14, v255, 0
 s_nop 0
 s_add_u32 s17, s17, s14
 v_readlane_b32 s14, v255, 1
 s_nop 0
 s_add_u32 s17, s17, s14
 v_readlane_b32 s14, v255, 2
 s_nop 0
 s_add_u32 s17, s17, s14
 v_readlane_b32 s14, v255, 3
 s_nop 0
 s_add_u32 s17, s17, s14
 v_readlane_b32 s14, v255, 4
 s_nop 0
 s_add_u32 s17, s17, s14
 v_readlane_b32 s14, v255, 5
 s_nop 0
 s_add_u32 s17, s17, s14
 v_readlane_b32 s14, v255, 6
 s_nop 0
 s_add_u32 s17, s17, s14
 v_readlane_b32 s14, v255, 7
 s_nop 0
 s_add_u32 s17, s17, s14
 s_cmp_eq_u32 s17, 256
 s_cbranch_scc1 L_fallback
 s_branch Lver_352
Lverok_353:
 s_load_dwordx2 s[36:37], s[0:1], 88
 v_and_b32 v1, 63, v0
 s_lshl_b32 s29, s12, 2
 s_add_u32 s29, s29, s3
 s_mov_b32 s30, 0x3acccccd
 v_lshrrev_b32 v8, 5, v1
 v_and_b32 v9, 31, v1
 v_min_u32 v6, 4, v9
 v_lshl_add_u32 v6, v8, 6, v6
 v_lshlrev_b32 v6, 2, v6
 v_add_u32 v6, 9216, v6
 s_mul_i32 s19, s29, 5120
 v_mul_u32_u24 v2, 2560, v8
 v_lshl_add_u32 v2, v9, 4, v2
 v_add_u32 v2, s19, v2
 v_lshrrev_b32 v3, 1, v2
 s_mov_b32 s25, 0
 s_mov_b32 s26, 0
 s_waitcnt lgkmcnt(0)
 s_mov_b32 s32, s36
 s_mov_b32 s33, s37
 s_mov_b32 s34, 2621440
 s_mov_b32 s35, 0x20000
Lr_354:
 s_add_u32 s19, s25, s26
 s_cmp_ge_u32 s19, 128
 s_cbranch_scc1 L_exit
 v_mov_b32 v7, s25
 s_mov_b32 exec_lo, 0
 v_mov_b32 v7, s26
 s_mov_b32 exec_lo, -1
 s_mov_b32 s24, 0
Lrs_355:
 s_add_u32 s24, s24, 1
 s_cmp_gt_u32 s24, 200000
 s_cbranch_scc1 L_fail
 buffer_load_dword v5, v6, s[4:7], 0 offen sc1
 s_waitcnt vmcnt(0)
 v_cmp_lt_u32 vcc, v7, v5
 s_nop 0
 s_cmp_eq_u32 vcc_lo, -1
 s_cbranch_scc0 Lr1_357
 s_mov_b32 s27, 0
 s_mov_b32 s28, s25
 s_add_u32 s25, s25, 1
 s_branch Lrg_356
Lr1_357:
 s_cmp_eq_u32 vcc_hi, -1
 s_cbranch_scc0 Lrs_355
 s_mov_b32 s27, 1
 s_mov_b32 s28, s26
 s_add_u32 s26, s26, 1
Lrg_356:
 s_mul_i32 s19, s28, 81920
 s_add_u32 s20, s19, 208322560
 s_add_u32 s21, s19, 192593920
 buffer_load_dwordx4 v[30:33], v2, s[4:7], s20 offen offset:0 sc1
 buffer_load_dwordx4 v[34:37], v2, s[4:7], s20 offen offset:512 sc1
 buffer_load_dwordx4 v[38:41], v2, s[4:7], s20 offen offset:1024 sc1
 buffer_load_dwordx4 v[42:45], v2, s[4:7], s20 offen offset:1536 sc1
 buffer_load_dwordx4 v[46:49], v2, s[4:7], s20 offen offset:2048 sc1
 buffer_load_dwordx4 v[10:13], v2, s[4:7], s21 offen offset:0 sc1
 buffer_load_dwordx4 v[14:17], v2, s[4:7], s21 offen offset:512 sc1
 buffer_load_dwordx4 v[18:21], v2, s[4:7], s21 offen offset:1024 sc1
 buffer_load_dwordx4 v[22:25], v2, s[4:7], s21 offen offset:1536 sc1
 buffer_load_dwordx4 v[26:29], v2, s[4:7], s21 offen offset:2048 sc1
 s_waitcnt vmcnt(0)
 v_add_f32 v10, v10, v30
 v_add_f32 v11, v11, v31
 v_add_f32 v12, v12, v32
 v_add_f32 v13, v13, v33
 v_add_f32 v14, v14, v34
 v_add_f32 v15, v15, v35
 v_add_f32 v16, v16, v36
 v_add_f32 v17, v17, v37
 v_add_f32 v18, v18, v38
 v_add_f32 v19, v19, v39
 v_add_f32 v20, v20, v40
 v_add_f32 v21, v21, v41
 v_add_f32 v22, v22, v42
 v_add_f32 v23, v23, v43
 v_add_f32 v24, v24, v44
 v_add_f32 v25, v25, v45
 v_add_f32 v26, v26, v46
 v_add_f32 v27, v27, v47
 v_add_f32 v28, v28, v48
 v_add_f32 v29, v29, v49
 s_lshr_b32 s20, s19, 1
 s_cmp_eq_u32 s27, 1
 s_cbranch_scc1 Lrl_358
 v_add_f32 v8, v10, v11
 v_add_f32 v9, v12, v13
 v_add_f32 v8, v8, v14
 v_add_f32 v9, v9, v15
 v_add_f32 v8, v8, v16
 v_add_f32 v9, v9, v17
 v_add_f32 v8, v8, v18
 v_add_f32 v9, v9, v19
 v_add_f32 v8, v8, v20
 v_add_f32 v9, v9, v21
 v_add_f32 v8, v8, v22
 v_add_f32 v9, v9, v23
 v_add_f32 v8, v8, v24
 v_add_f32 v9, v9, v25
 v_add_f32 v8, v8, v26
 v_add_f32 v9, v9, v27
 v_add_f32 v8, v8, v28
 v_add_f32 v9, v9, v29
 v_add_f32 v8, v8, v9
 s_nop 1
 v_add_f32_dpp v8, v8, v8 row_ror:8 row_mask:0xf bank_mask:0xf
 s_nop 1
 v_add_f32_dpp v8, v8, v8 row_ror:4 row_mask:0xf bank_mask:0xf
 s_nop 1
 v_add_f32_dpp v8, v8, v8 row_ror:2 row_mask:0xf bank_mask:0xf
 s_nop 1
 v_add_f32_dpp v8, v8, v8 row_ror:1 row_mask:0xf bank_mask:0xf
 v_mov_b32 v9, v8
 s_nop 1
 v_permlane16_swap_b32 v8, v9
 v_add_f32 v8, v8, v9
 v_mul_f32 v8, s30, v8
 v_sub_f32 v30, v10, v8
 v_sub_f32 v31, v11, v8
 v_sub_f32 v32, v12, v8
 v_sub_f32 v33, v13, v8
 v_sub_f32 v34, v14, v8
 v_sub_f32 v35, v15, v8
 v_sub_f32 v36, v16, v8
 v_sub_f32 v37, v17, v8
 v_sub_f32 v38, v18, v8
 v_sub_f32 v39, v19, v8
 v_sub_f32 v40, v20, v8
 v_sub_f32 v41, v21, v8
 v_sub_f32 v42, v22, v8
 v_sub_f32 v43, v23, v8
 v_sub_f32 v44, v24, v8
 v_sub_f32 v45, v25, v8
 v_sub_f32 v46, v26, v8
 v_sub_f32 v47, v27, v8
 v_sub_f32 v48, v28, v8
 v_sub_f32 v49, v29, v8
 v_mul_f32 v8, v30, v30
 v_mul_f32 v9, v31, v31
 v_fmac_f32 v8, v32, v32
 v_fmac_f32 v9, v33, v33
 v_fmac_f32 v8, v34, v34
 v_fmac_f32 v9, v35, v35
 v_fmac_f32 v8, v36, v36
 v_fmac_f32 v9, v37, v37
 v_fmac_f32 v8, v38, v38
 v_fmac_f32 v9, v39, v39
 v_fmac_f32 v8, v40, v40
 v_fmac_f32 v9, v41, v41
 v_fmac_f32 v8, v42, v42
 v_fmac_f32 v9, v43, v43
 v_fmac_f32 v8, v44, v44
 v_fmac_f32 v9, v45, v45
 v_fmac_f32 v8, v46, v46
 v_fmac_f32 v9, v47, v47
 v_fmac_f32 v8, v48, v48
 v_fmac_f32 v9, v49, v49
 v_add_f32 v8, v8, v9
 s_nop 1
 v_add_f32_dpp v8, v8, v8 row_ror:8 row_mask:0xf bank_mask:0xf
 s_nop 1
 v_add_f32_dpp v8, v8, v8 row_ror:4 row_mask:0xf bank_mask:0xf
 s_nop 1
 v_add_f32_dpp v8, v8, v8 row_ror:2 row_mask:0xf bank_mask:0xf
 s_nop 1
 v_add_f32_dpp v8, v8, v8 row_ror:1 row_mask:0xf bank_mask:0xf
 v_mov_b32 v9, v8
 s_nop 1
 v_permlane16_swap_b32 v8, v9
 v_add_f32 v8, v8, v9
 v_mov_b32 v9, 0x3727c5ac
 v_fma_f32 v8, v8, s30, v9
 v_rsq_f32 v8, v8
 s_nop 0
 v_mul_f32 v30, v30, v8
 v_mul_f32 v31, v31, v8
 v_mul_f32 v32, v32, v8
 v_mul_f32 v33, v33, v8
 v_mul_f32 v34, v34, v8
 v_mul_f32 v35, v35, v8
 v_mul_f32 v36, v36, v8
 v_mul_f32 v37, v37, v8
 v_mul_f32 v38, v38, v8
 v_mul_f32 v39, v39, v8
 v_mul_f32 v40, v40, v8
 v_mul_f32 v41, v41, v8
 v_mul_f32 v42, v42, v8
 v_mul_f32 v43, v43, v8
 v_mul_f32 v44, v44, v8
 v_mul_f32 v45, v45, v8
 v_mul_f32 v46, v46, v8
 v_mul_f32 v47, v47, v8
 v_mul_f32 v48, v48, v8
 v_mul_f32 v49, v49, v8
 v_cvt_pk_bf16_f32 v70, v30, v31
 v_cvt_pk_bf16_f32 v71, v32, v33
 v_cvt_pk_bf16_f32 v72, v34, v35
 v_cvt_pk_bf16_f32 v73, v36, v37
 v_cvt_pk_bf16_f32 v74, v38, v39
 v_cvt_pk_bf16_f32 v75, v40, v41
 v_cvt_pk_bf16_f32 v76, v42, v43
 v_cvt_pk_bf16_f32 v77, v44, v45
 v_cvt_pk_bf16_f32 v78, v46, v47
 v_cvt_pk_bf16_f32 v79, v48, v49
 s_add_u32 s20, s20, 187351040
 s_add_u32 s21, s19, 203079680
 buffer_store_dwordx2 v[70:71], v3, s[4:7], s20 offen offset:0 sc1
 buffer_store_dwordx2 v[72:73], v3, s[4:7], s20 offen offset:256 sc1
 buffer_store_dwordx2 v[74:75], v3, s[4:7], s20 offen offset:512 sc1
 buffer_store_dwordx2 v[76:77], v3, s[4:7], s20 offen offset:768 sc1
 buffer_store_dwordx2 v[78:79], v3, s[4:7], s20 offen offset:1024 sc1
 buffer_store_dwordx4 v[10:13], v2, s[4:7], s21 offen offset:0 sc1
 buffer_store_dwordx4 v[14:17], v2, s[4:7], s21 offen offset:512 sc1
 buffer_store_dwordx4 v[18:21], v2, s[4:7], s21 offen offset:1024 sc1
 buffer_store_dwordx4 v[22:25], v2, s[4:7], s21 offen offset:1536 sc1
 buffer_store_dwordx4 v[26:29], v2, s[4:7], s21 offen offset:2048 sc1
 s_branch Lrj_359
Lrl_358:
 v_cvt_pk_bf16_f32 v70, v10, v11
 v_cvt_pk_bf16_f32 v71, v12, v13
 v_cvt_pk_bf16_f32 v72, v14, v15
 v_cvt_pk_bf16_f32 v73, v16, v17
 v_cvt_pk_bf16_f32 v74, v18, v19
 v_cvt_pk_bf16_f32 v75, v20, v21
 v_cvt_pk_bf16_f32 v76, v22, v23
 v_cvt_pk_bf16_f32 v77, v24, v25
 v_cvt_pk_bf16_f32 v78, v26, v27
 v_cvt_pk_bf16_f32 v79, v28, v29
 buffer_store_dwordx2 v[70:71], v3, s[32:35], s20 offen offset:0
 buffer_store_dwordx2 v[72:73], v3, s[32:35], s20 offen offset:256
 buffer_store_dwordx2 v[74:75], v3, s[32:35], s20 offen offset:512
 buffer_store_dwordx2 v[76:77], v3, s[32:35], s20 offen offset:768
 buffer_store_dwordx2 v[78:79], v3, s[32:35], s20 offen offset:1024
Lrj_359:
 s_lshl_b32 s19, s27, 6
 s_add_u32 s19, s19, s29
 s_lshl_b32 s19, s19, 2
 s_add_u32 s19, s19, 10240
 s_add_u32 s20, s28, 1
 s_waitcnt vmcnt(0)
 s_mov_b64 exec, 1
 v_mov_b32 v5, s20
 buffer_store_dword v5, off, s[4:7], s19 sc1
 s_mov_b64 exec, -1
 s_branch Lr_354
.section .rodata,"a"
.p2align 6
.amdhsa_kernel pro_kernel
  .amdhsa_next_free_vgpr 64
  .amdhsa_next_free_sgpr 32
  .amdhsa_accum_offset 64
  .amdhsa_group_segment_fixed_size 0
  .amdhsa_kernarg_size 112
  .amdhsa_user_sgpr_count 2
  .amdhsa_user_sgpr_kernarg_segment_ptr 1
  .amdhsa_system_sgpr_workgroup_id_x 1
  .amdhsa_float_denorm_mode_32 3
.end_amdhsa_kernel
.p2align 6
.amdhsa_kernel main_kernel
  .amdhsa_next_free_vgpr 512
  .amdhsa_next_free_sgpr 102
  .amdhsa_accum_offset 256
  .amdhsa_group_segment_fixed_size 0
  .amdhsa_kernarg_size 112
  .amdhsa_user_sgpr_count 2
  .amdhsa_user_sgpr_kernarg_segment_ptr 1
  .amdhsa_system_sgpr_workgroup_id_x 1
  .amdhsa_float_denorm_mode_32 3
.end_amdhsa_kernel
```

```asm
; @launch kernel=pro_kernel grid=(256,1,1) block=(256,1,1) lds=0
; @launch kernel=main_kernel grid=(256,1,1) block=(256,1,1) lds=163840
.amdgcn_target "amdgcn-amd-amdhsa--gfx950"
.text
.globl pro_kernel
.p2align 8
.type pro_kernel,@function
pro_kernel:
 s_cmp_ge_u32 s2, 256
 s_cbranch_scc1 L_pro_exit
 s_load_dwordx2 s[4:5], s[0:1], 0
 s_load_dwordx2 s[8:9], s[0:1], 104
 v_lshrrev_b32 v3, 5, v0
 s_lshl_b32 s20, s2, 3
 v_add_u32 v3, s20, v3
 v_mul_u32_u24 v2, 1280, v3
 v_and_b32 v4, 31, v0
 v_lshl_add_u32 v2, v4, 3, v2
 v_lshlrev_b32 v1, 1, v2
 s_mov_b32 s21, 0x3acccccd
 s_waitcnt lgkmcnt(0)
 s_mov_b32 s6, 2621440
 s_mov_b32 s7, 0x20000
 s_mov_b32 s10, 0x10000000
 s_mov_b32 s11, 0x20000
 s_mov_b32 s12, s8
 s_mov_b32 s13, s9
 s_mov_b32 s14, 2523136
 s_mov_b32 s15, 0x20000
 buffer_load_dwordx2 v[46:47], v2, s[4:7], 0 offen offset:0
 buffer_load_dwordx2 v[48:49], v2, s[4:7], 0 offen offset:256
 buffer_load_dwordx2 v[50:51], v2, s[4:7], 0 offen offset:512
 buffer_load_dwordx2 v[52:53], v2, s[4:7], 0 offen offset:768
 buffer_load_dwordx2 v[54:55], v2, s[4:7], 0 offen offset:1024
 v_mov_b32 v56, -1
 v_mov_b32 v57, -1
 v_mov_b32 v58, -1
 v_mov_b32 v59, -1
 v_lshlrev_b32 v3, 4, v0
 s_mul_i32 s20, s2, 12288
 s_add_u32 s20, s20, 262144
 buffer_store_dwordx4 v[56:59], v3, s[12:15], s20 offen
 s_add_u32 s20, s20, 4096
 buffer_store_dwordx4 v[56:59], v3, s[12:15], s20 offen
 s_add_u32 s20, s20, 4096
 buffer_store_dwordx4 v[56:59], v3, s[12:15], s20 offen
 s_add_u32 s20, s20, 4096
 s_cmp_ge_u32 s2, 64
 s_cbranch_scc1 L_pro_nf
 v_mov_b32 v26, 0
 v_mov_b32 v27, 0
 v_mov_b32 v28, 0
 v_mov_b32 v29, 0
 s_lshl_b32 s20, s2, 12
 s_add_u32 s20, s20, 0
 buffer_store_dwordx4 v[26:29], v3, s[12:15], s20 offen
L_pro_nf:
 s_waitcnt vmcnt(0)
 v_lshlrev_b32 v6, 16, v46
 v_and_b32 v7, 0xffff0000, v46
 v_lshlrev_b32 v8, 16, v47
 v_and_b32 v9, 0xffff0000, v47
 v_lshlrev_b32 v10, 16, v48
 v_and_b32 v11, 0xffff0000, v48
 v_lshlrev_b32 v12, 16, v49
 v_and_b32 v13, 0xffff0000, v49
 v_lshlrev_b32 v14, 16, v50
 v_and_b32 v15, 0xffff0000, v50
 v_lshlrev_b32 v16, 16, v51
 v_and_b32 v17, 0xffff0000, v51
 v_lshlrev_b32 v18, 16, v52
 v_and_b32 v19, 0xffff0000, v52
 v_lshlrev_b32 v20, 16, v53
 v_and_b32 v21, 0xffff0000, v53
 v_lshlrev_b32 v22, 16, v54
 v_and_b32 v23, 0xffff0000, v54
 v_lshlrev_b32 v24, 16, v55
 v_and_b32 v25, 0xffff0000, v55
 s_mov_b32 s20, 198082560
 s_mov_b32 s22, 184975360
 buffer_store_dwordx4 v[6:9], v1, s[8:11], s20 offen offset:0
 buffer_store_dwordx4 v[10:13], v1, s[8:11], s20 offen offset:512
 buffer_store_dwordx4 v[14:17], v1, s[8:11], s20 offen offset:1024
 buffer_store_dwordx4 v[18:21], v1, s[8:11], s20 offen offset:1536
 buffer_store_dwordx4 v[22:25], v1, s[8:11], s20 offen offset:2048
 v_add_f32 v3, v6, v7
 v_add_f32 v4, v8, v9
 v_add_f32 v3, v3, v10
 v_add_f32 v4, v4, v11
 v_add_f32 v3, v3, v12
 v_add_f32 v4, v4, v13
 v_add_f32 v3, v3, v14
 v_add_f32 v4, v4, v15
 v_add_f32 v3, v3, v16
 v_add_f32 v4, v4, v17
 v_add_f32 v3, v3, v18
 v_add_f32 v4, v4, v19
 v_add_f32 v3, v3, v20
 v_add_f32 v4, v4, v21
 v_add_f32 v3, v3, v22
 v_add_f32 v4, v4, v23
 v_add_f32 v3, v3, v24
 v_add_f32 v4, v4, v25
 v_add_f32 v3, v3, v4
 s_nop 1
 v_add_f32_dpp v3, v3, v3 row_ror:8 row_mask:0xf bank_mask:0xf
 s_nop 1
 v_add_f32_dpp v3, v3, v3 row_ror:4 row_mask:0xf bank_mask:0xf
 s_nop 1
 v_add_f32_dpp v3, v3, v3 row_ror:2 row_mask:0xf bank_mask:0xf
 s_nop 1
 v_add_f32_dpp v3, v3, v3 row_ror:1 row_mask:0xf bank_mask:0xf
 v_mov_b32 v4, v3
 s_nop 1
 v_permlane16_swap_b32 v3, v4
 v_add_f32 v3, v3, v4
 v_mul_f32 v3, s21, v3
 v_sub_f32 v26, v6, v3
 v_sub_f32 v27, v7, v3
 v_sub_f32 v28, v8, v3
 v_sub_f32 v29, v9, v3
 v_sub_f32 v30, v10, v3
 v_sub_f32 v31, v11, v3
 v_sub_f32 v32, v12, v3
 v_sub_f32 v33, v13, v3
 v_sub_f32 v34, v14, v3
 v_sub_f32 v35, v15, v3
 v_sub_f32 v36, v16, v3
 v_sub_f32 v37, v17, v3
 v_sub_f32 v38, v18, v3
 v_sub_f32 v39, v19, v3
 v_sub_f32 v40, v20, v3
 v_sub_f32 v41, v21, v3
 v_sub_f32 v42, v22, v3
 v_sub_f32 v43, v23, v3
 v_sub_f32 v44, v24, v3
 v_sub_f32 v45, v25, v3
 v_mul_f32 v3, v26, v26
 v_mul_f32 v4, v27, v27
 v_fmac_f32 v3, v28, v28
 v_fmac_f32 v4, v29, v29
 v_fmac_f32 v3, v30, v30
 v_fmac_f32 v4, v31, v31
 v_fmac_f32 v3, v32, v32
 v_fmac_f32 v4, v33, v33
 v_fmac_f32 v3, v34, v34
 v_fmac_f32 v4, v35, v35
 v_fmac_f32 v3, v36, v36
 v_fmac_f32 v4, v37, v37
 v_fmac_f32 v3, v38, v38
 v_fmac_f32 v4, v39, v39
 v_fmac_f32 v3, v40, v40
 v_fmac_f32 v4, v41, v41
 v_fmac_f32 v3, v42, v42
 v_fmac_f32 v4, v43, v43
 v_fmac_f32 v3, v44, v44
 v_fmac_f32 v4, v45, v45
 v_add_f32 v3, v3, v4
 s_nop 1
 v_add_f32_dpp v3, v3, v3 row_ror:8 row_mask:0xf bank_mask:0xf
 s_nop 1
 v_add_f32_dpp v3, v3, v3 row_ror:4 row_mask:0xf bank_mask:0xf
 s_nop 1
 v_add_f32_dpp v3, v3, v3 row_ror:2 row_mask:0xf bank_mask:0xf
 s_nop 1
 v_add_f32_dpp v3, v3, v3 row_ror:1 row_mask:0xf bank_mask:0xf
 v_mov_b32 v4, v3
 s_nop 1
 v_permlane16_swap_b32 v3, v4
 v_add_f32 v3, v3, v4
 v_mov_b32 v4, 0x3727c5ac
 v_fma_f32 v3, v3, s21, v4
 v_rsq_f32 v3, v3
 s_nop 0
 v_mul_f32 v26, v26, v3
 v_mul_f32 v27, v27, v3
 v_mul_f32 v28, v28, v3
 v_mul_f32 v29, v29, v3
 v_mul_f32 v30, v30, v3
 v_mul_f32 v31, v31, v3
 v_mul_f32 v32, v32, v3
 v_mul_f32 v33, v33, v3
 v_mul_f32 v34, v34, v3
 v_mul_f32 v35, v35, v3
 v_mul_f32 v36, v36, v3
 v_mul_f32 v37, v37, v3
 v_mul_f32 v38, v38, v3
 v_mul_f32 v39, v39, v3
 v_mul_f32 v40, v40, v3
 v_mul_f32 v41, v41, v3
 v_mul_f32 v42, v42, v3
 v_mul_f32 v43, v43, v3
 v_mul_f32 v44, v44, v3
 v_mul_f32 v45, v45, v3
 v_cvt_pk_bf16_f32 v46, v26, v27
 v_cvt_pk_bf16_f32 v47, v28, v29
 v_cvt_pk_bf16_f32 v48, v30, v31
 v_cvt_pk_bf16_f32 v49, v32, v33
 v_cvt_pk_bf16_f32 v50, v34, v35
 v_cvt_pk_bf16_f32 v51, v36, v37
 v_cvt_pk_bf16_f32 v52, v38, v39
 v_cvt_pk_bf16_f32 v53, v40, v41
 v_cvt_pk_bf16_f32 v54, v42, v43
 v_cvt_pk_bf16_f32 v55, v44, v45
 buffer_store_dwordx2 v[46:47], v2, s[8:11], s22 offen offset:0
 buffer_store_dwordx2 v[48:49], v2, s[8:11], s22 offen offset:256
 buffer_store_dwordx2 v[50:51], v2, s[8:11], s22 offen offset:512
 buffer_store_dwordx2 v[52:53], v2, s[8:11], s22 offen offset:768
 buffer_store_dwordx2 v[54:55], v2, s[8:11], s22 offen offset:1024
L_pro_exit:
 s_endpgm
.globl main_kernel
.p2align 8
.type main_kernel,@function
main_kernel:
 s_cmp_ge_u32 s2, 256
 s_cbranch_scc1 L_exit
 s_load_dwordx2 s[8:9], s[0:1], 96
 s_load_dwordx2 s[4:5], s[0:1], 104
 s_getreg_b32 s14, hwreg(HW_REG_XCC_ID, 0, 4)
 s_and_b32 s14, s14, 7
 v_lshrrev_b32 v1, 6, v0
 s_nop 0
 v_readfirstlane_b32 s3, v1
 s_waitcnt lgkmcnt(0)
 s_mov_b32 s10, 256
 s_mov_b32 s11, 0x20000
 s_mov_b32 s6, 0x10000000
 s_mov_b32 s7, 0x20000
 v_mov_b32 v3, 0
 s_cmp_eq_u32 s3, 0
 s_cbranch_scc0 L_noticket
 s_lshl_b32 s17, s14, 2
 v_mov_b32 v1, s17
 v_mov_b32 v2, 32
 v_cmp_eq_u32 vcc, 0, v0
 s_nop 1
 v_cndmask_b32 v1, v2, v1, vcc
 v_mov_b32 v2, 1
 s_mov_b64 exec, 3
 buffer_atomic_add v2, v1, s[8:11], 0 offen sc0
 v_lshlrev_b32 v1, 2, v0
 s_waitcnt vmcnt(0)
 ds_write_b32 v1, v2
 s_mov_b64 exec, -1
 s_waitcnt lgkmcnt(0)
L_noticket:
 s_barrier
 ds_read_b64 v[4:5], v3
 s_waitcnt lgkmcnt(0)
 v_readfirstlane_b32 s15, v4
 v_readfirstlane_b32 s16, v5
 s_barrier
 s_mov_b32 s13, 0
 s_lshl_b32 s17, s14, 5
 s_add_u32 s17, s17, s15
 s_mov_b32 s12, 0
 s_cmp_ge_u32 s17, 0
 s_cselect_b32 s12, 64, s12
 s_cmp_ge_u32 s17, 12
 s_cselect_b32 s12, 124, s12
 s_cmp_ge_u32 s17, 22
 s_cselect_b32 s12, 186, s12
 s_cmp_ge_u32 s17, 25
 s_cselect_b32 s12, 151, s12
 s_cmp_ge_u32 s17, 30
 s_cselect_b32 s12, 212, s12
 s_cmp_ge_u32 s17, 32
 s_cselect_b32 s12, 44, s12
 s_cmp_ge_u32 s17, 44
 s_cselect_b32 s12, 102, s12
 s_cmp_ge_u32 s17, 54
 s_cselect_b32 s12, 157, s12
 s_cmp_ge_u32 s17, 57
 s_cselect_b32 s12, 124, s12
 s_cmp_ge_u32 s17, 62
 s_cselect_b32 s12, 182, s12
 s_cmp_ge_u32 s17, 64
 s_cselect_b32 s12, 24, s12
 s_cmp_ge_u32 s17, 76
 s_cselect_b32 s12, 80, s12
 s_cmp_ge_u32 s17, 81
 s_cselect_b32 s12, 151, s12
 s_cmp_ge_u32 s17, 86
 s_cselect_b32 s12, 128, s12
 s_cmp_ge_u32 s17, 89
 s_cselect_b32 s12, 97, s12
 s_cmp_ge_u32 s17, 94
 s_cselect_b32 s12, 152, s12
 s_cmp_ge_u32 s17, 96
 s_cselect_b32 s12, 4294967200, s12
 s_cmp_ge_u32 s17, 128
 s_cselect_b32 s12, 4294967200, s12
 s_cmp_ge_u32 s17, 160
 s_cselect_b32 s12, 4294967236, s12
 s_cmp_ge_u32 s17, 172
 s_cselect_b32 s12, 4294967285, s12
 s_cmp_ge_u32 s17, 177
 s_cselect_b32 s12, 60, s12
 s_cmp_ge_u32 s17, 182
 s_cselect_b32 s12, 35, s12
 s_cmp_ge_u32 s17, 185
 s_cselect_b32 s12, 6, s12
 s_cmp_ge_u32 s17, 190
 s_cselect_b32 s12, 58, s12
 s_cmp_ge_u32 s17, 192
 s_cselect_b32 s12, 4294967216, s12
 s_cmp_ge_u32 s17, 204
 s_cselect_b32 s12, 4294967258, s12
 s_cmp_ge_u32 s17, 209
 s_cselect_b32 s12, 11, s12
 s_cmp_ge_u32 s17, 215
 s_cselect_b32 s12, 4294967277, s12
 s_cmp_ge_u32 s17, 221
 s_cselect_b32 s12, 29, s12
 s_cmp_ge_u32 s17, 224
 s_cselect_b32 s12, 4294967196, s12
 s_cmp_ge_u32 s17, 236
 s_cselect_b32 s12, 4294967231, s12
 s_cmp_ge_u32 s17, 241
 s_cselect_b32 s12, 4294967281, s12
 s_cmp_ge_u32 s17, 247
 s_cselect_b32 s12, 4294967251, s12
 s_cmp_ge_u32 s17, 253
 s_cselect_b32 s12, 0, s12
 s_add_u32 s12, s12, s17
 s_cmp_lt_u32 s15, 32
 s_cbranch_scc1 L_dispatch
L_fallback:
 s_mov_b32 s12, s16
 s_mov_b32 s13, 1
 s_waitcnt vmcnt(0) lgkmcnt(0)
 s_barrier
L_dispatch:
 s_cmp_lt_u32 s12, 64
 s_cbranch_scc1 L_role_rec
 s_cmp_lt_u32 s12, 136
 s_cbranch_scc1 L_role_qkv
 s_cmp_lt_u32 s12, 176
 s_cbranch_scc1 L_role_o
 s_cmp_lt_u32 s12, 208
 s_cbranch_scc1 L_role_at
 s_cmp_lt_u32 s12, 232
 s_cbranch_scc1 L_role_gu
 s_cmp_lt_u32 s12, 242
 s_cbranch_scc1 L_role_d
 s_cmp_lt_u32 s12, 250
 s_cbranch_scc1 L_role_r1
 s_cmp_lt_u32 s12, 254
 s_cbranch_scc1 L_role_r2
 s_branch L_exit
L_fail:
 s_waitcnt vmcnt(0) lgkmcnt(0)
 s_mov_b64 exec, 1
 v_mov_b32 v1, 0xdead
 buffer_store_dword v1, off, s[8:11], 0 offset:64 sc1
L_exit:
 s_endpgm
L_role_rec:
 s_and_b32 s19, s12, 31
 s_lshr_b32 s24, s12, 5
 v_and_b32 v1, 63, v0
 v_lshlrev_b32 v2, 4, v1
 s_load_dwordx8 s[32:39], s[0:1], 16
 v_add_u32 v115, 0, v1
 v_mul_u32_u24 v3, 0x1556, v115
 v_lshrrev_b32 v3, 16, v3
 v_mul_u32_u24 v116, 12, v3
 v_sub_u32 v115, v115, v116
 v_mul_u32_u24 v3, 12288, v3
 v_lshl_add_u32 v3, v115, 4, v3
 v_add_u32 v115, 64, v1
 v_mul_u32_u24 v108, 0x1556, v115
 v_lshrrev_b32 v108, 16, v108
 v_mul_u32_u24 v116, 12, v108
 v_sub_u32 v115, v115, v116
 v_mul_u32_u24 v108, 12288, v108
 v_lshl_add_u32 v108, v115, 4, v108
 v_add_u32 v115, 128, v1
 v_mul_u32_u24 v109, 0x1556, v115
 v_lshrrev_b32 v109, 16, v109
 v_mul_u32_u24 v116, 12, v109
 v_sub_u32 v115, v115, v116
 v_mul_u32_u24 v109, 12288, v109
 v_lshl_add_u32 v109, v115, 4, v109
 v_add_u32 v115, 0, v1
 v_mul_u32_u24 v110, 0x199a, v115
 v_lshrrev_b32 v110, 16, v110
 v_mul_u32_u24 v116, 10, v110
 v_sub_u32 v115, v115, v116
 v_mul_u32_u24 v110, 1280, v110
 v_lshl_add_u32 v110, v115, 4, v110
 v_add_u32 v115, 64, v1
 v_mul_u32_u24 v111, 0x199a, v115
 v_lshrrev_b32 v111, 16, v111
 v_mul_u32_u24 v116, 10, v111
 v_sub_u32 v115, v115, v116
 v_mul_u32_u24 v111, 1280, v111
 v_lshl_add_u32 v111, v115, 4, v111
 v_add_u32 v115, 128, v1
 v_mul_u32_u24 v112, 0x199a, v115
 v_lshrrev_b32 v112, 16, v112
 v_mul_u32_u24 v116, 10, v112
 v_sub_u32 v115, v115, v116
 v_mul_u32_u24 v112, 1280, v112
 v_lshl_add_u32 v112, v115, 4, v112
 v_add_u32 v115, 192, v1
 v_mul_u32_u24 v113, 0x199a, v115
 v_lshrrev_b32 v113, 16, v113
 v_mul_u32_u24 v116, 10, v113
 v_sub_u32 v115, v115, v116
 v_mul_u32_u24 v113, 1280, v113
 v_lshl_add_u32 v113, v115, 4, v113
 v_add_u32 v115, 256, v1
 v_mul_u32_u24 v114, 0x199a, v115
 v_lshrrev_b32 v114, 16, v114
 v_mul_u32_u24 v116, 10, v114
 v_sub_u32 v115, v115, v116
 v_mul_u32_u24 v114, 1280, v114
 v_lshl_add_u32 v114, v115, 4, v114
 v_lshrrev_b32 v115, 4, v1
 v_bfe_u32 v116, v1, 2, 2
 v_lshl_add_u32 v117, v115, 3, v116
 v_lshl_add_u32 v121, v115, 2, v116
 v_mul_u32_u24 v117, 192, v117
 v_mul_u32_u24 v121, 160, v121
 v_and_b32 v115, 3, v1
 v_lshl_add_u32 v117, v115, 3, v117
 s_mul_i32 s27, s3, 15360
 v_add_u32 v121, s27, v121
 v_add_u32 v123, s27, v2
 v_lshl_add_u32 v122, v115, 3, v121
 v_lshl_add_u32 v121, v115, 4, v121
 s_lshl_b32 s27, s3, 5
 v_add_u32 v119, s27, v117
 s_and_b32 s26, s3, 1
 s_lshl_b32 s27, s26, 5
 s_add_u32 s27, s27, 128
 v_add_u32 v120, s27, v117
 s_lshr_b32 s25, s3, 1
 s_mul_i32 s27, s25, 30720
 s_mul_i32 s28, s26, 96
 s_add_u32 s27, s27, s28
 v_add_u32 v117, s27, v117
 v_add_u32 v118, 61440, v117
 s_waitcnt lgkmcnt(0)
 s_mul_i32 s29, s12, 192
 s_lshr_b32 s25, s12, 3
 s_lshl_b32 s25, s25, 2
 s_add_u32 s25, s25, s3
 s_mul_i32 s30, s25, 245760
 s_and_b32 s25, s12, 7
 s_mul_i32 s25, s25, 160
 s_add_u32 s30, s30, s25
 s_cmp_lt_u32 s3, 2
 s_cselect_b32 s20, s32, s34
 s_cselect_b32 s21, s33, s35
 s_mov_b32 s22, 7864320
 s_mov_b32 s23, 0x20000
 s_mul_i32 s25, s3, 15360
 s_add_u32 s25, s25, 0
 s_and_b32 s26, s3, 1
 s_mul_i32 s26, s26, 983040
 s_add_u32 s26, s26, 0
 s_add_u32 s26, s26, s29
 s_add_u32 m0, s25, 0
 s_add_u32 s27, s26, 0
 buffer_load_dwordx4 v3, s[20:23], s27 offen lds
 s_add_u32 m0, s25, 1024
 s_add_u32 s27, s26, 0
 buffer_load_dwordx4 v108, s[20:23], s27 offen lds
 s_add_u32 m0, s25, 2048
 s_add_u32 s27, s26, 0
 buffer_load_dwordx4 v109, s[20:23], s27 offen lds
 s_add_u32 m0, s25, 3072
 s_add_u32 s27, s26, 196608
 buffer_load_dwordx4 v3, s[20:23], s27 offen lds
 s_add_u32 m0, s25, 4096
 s_add_u32 s27, s26, 196608
 buffer_load_dwordx4 v108, s[20:23], s27 offen lds
 s_add_u32 m0, s25, 5120
 s_add_u32 s27, s26, 196608
 buffer_load_dwordx4 v109, s[20:23], s27 offen lds
 s_add_u32 m0, s25, 6144
 s_add_u32 s27, s26, 393216
 buffer_load_dwordx4 v3, s[20:23], s27 offen lds
 s_add_u32 m0, s25, 7168
 s_add_u32 s27, s26, 393216
 buffer_load_dwordx4 v108, s[20:23], s27 offen lds
 s_add_u32 m0, s25, 8192
 s_add_u32 s27, s26, 393216
 buffer_load_dwordx4 v109, s[20:23], s27 offen lds
 s_add_u32 m0, s25, 9216
 s_add_u32 s27, s26, 589824
 buffer_load_dwordx4 v3, s[20:23], s27 offen lds
 s_add_u32 m0, s25, 10240
 s_add_u32 s27, s26, 589824
 buffer_load_dwordx4 v108, s[20:23], s27 offen lds
 s_add_u32 m0, s25, 11264
 s_add_u32 s27, s26, 589824
 buffer_load_dwordx4 v109, s[20:23], s27 offen lds
 s_add_u32 m0, s25, 12288
 s_add_u32 s27, s26, 786432
 buffer_load_dwordx4 v3, s[20:23], s27 offen lds
 s_add_u32 m0, s25, 13312
 s_add_u32 s27, s26, 786432
 buffer_load_dwordx4 v108, s[20:23], s27 offen lds
 s_add_u32 m0, s25, 14336
 s_add_u32 s27, s26, 786432
 buffer_load_dwordx4 v109, s[20:23], s27 offen lds
 s_cmp_lt_u32 s3, 2
 s_cselect_b32 s20, s32, s34
 s_cselect_b32 s21, s33, s35
 s_mov_b32 s22, 7864320
 s_mov_b32 s23, 0x20000
 s_mul_i32 s25, s3, 15360
 s_add_u32 s25, s25, 61440
 s_and_b32 s26, s3, 1
 s_mul_i32 s26, s26, 983040
 s_add_u32 s26, s26, 1966080
 s_add_u32 s26, s26, s29
 s_add_u32 m0, s25, 0
 s_add_u32 s27, s26, 0
 buffer_load_dwordx4 v3, s[20:23], s27 offen lds
 s_add_u32 m0, s25, 1024
 s_add_u32 s27, s26, 0
 buffer_load_dwordx4 v108, s[20:23], s27 offen lds
 s_add_u32 m0, s25, 2048
 s_add_u32 s27, s26, 0
 buffer_load_dwordx4 v109, s[20:23], s27 offen lds
 s_add_u32 m0, s25, 3072
 s_add_u32 s27, s26, 196608
 buffer_load_dwordx4 v3, s[20:23], s27 offen lds
 s_add_u32 m0, s25, 4096
 s_add_u32 s27, s26, 196608
 buffer_load_dwordx4 v108, s[20:23], s27 offen lds
 s_add_u32 m0, s25, 5120
 s_add_u32 s27, s26, 196608
 buffer_load_dwordx4 v109, s[20:23], s27 offen lds
 s_add_u32 m0, s25, 6144
 s_add_u32 s27, s26, 393216
 buffer_load_dwordx4 v3, s[20:23], s27 offen lds
 s_add_u32 m0, s25, 7168
 s_add_u32 s27, s26, 393216
 buffer_load_dwordx4 v108, s[20:23], s27 offen lds
 s_add_u32 m0, s25, 8192
 s_add_u32 s27, s26, 393216
 buffer_load_dwordx4 v109, s[20:23], s27 offen lds
 s_add_u32 m0, s25, 9216
 s_add_u32 s27, s26, 589824
 buffer_load_dwordx4 v3, s[20:23], s27 offen lds
 s_add_u32 m0, s25, 10240
 s_add_u32 s27, s26, 589824
 buffer_load_dwordx4 v108, s[20:23], s27 offen lds
 s_add_u32 m0, s25, 11264
 s_add_u32 s27, s26, 589824
 buffer_load_dwordx4 v109, s[20:23], s27 offen lds
 s_add_u32 m0, s25, 12288
 s_add_u32 s27, s26, 786432
 buffer_load_dwordx4 v3, s[20:23], s27 offen lds
 s_add_u32 m0, s25, 13312
 s_add_u32 s27, s26, 786432
 buffer_load_dwordx4 v108, s[20:23], s27 offen lds
 s_add_u32 m0, s25, 14336
 s_add_u32 s27, s26, 786432
 buffer_load_dwordx4 v109, s[20:23], s27 offen lds
 s_waitcnt vmcnt(15)
 s_barrier
 s_cmp_eq_u32 s3, 0
 s_cbranch_scc0 Lpwn_2
 ds_read_b64_tr_b16 a[0:1], v117 offset:0
 ds_read_b64_tr_b16 a[2:3], v117 offset:768
 ds_read_b64_tr_b16 a[80:81], v117 offset:32
 ds_read_b64_tr_b16 a[82:83], v117 offset:800
 ds_read_b64_tr_b16 a[160:161], v117 offset:64
 ds_read_b64_tr_b16 a[162:163], v117 offset:832
 ds_read_b64_tr_b16 a[4:5], v117 offset:6144
 ds_read_b64_tr_b16 a[6:7], v117 offset:6912
 ds_read_b64_tr_b16 a[84:85], v117 offset:6176
 ds_read_b64_tr_b16 a[86:87], v117 offset:6944
 ds_read_b64_tr_b16 a[164:165], v117 offset:6208
 ds_read_b64_tr_b16 a[166:167], v117 offset:6976
 ds_read_b64_tr_b16 a[8:9], v117 offset:12288
 ds_read_b64_tr_b16 a[10:11], v117 offset:13056
 ds_read_b64_tr_b16 a[88:89], v117 offset:12320
 ds_read_b64_tr_b16 a[90:91], v117 offset:13088
 ds_read_b64_tr_b16 a[168:169], v117 offset:12352
 ds_read_b64_tr_b16 a[170:171], v117 offset:13120
 ds_read_b64_tr_b16 a[12:13], v117 offset:18432
 ds_read_b64_tr_b16 a[14:15], v117 offset:19200
 ds_read_b64_tr_b16 a[92:93], v117 offset:18464
 ds_read_b64_tr_b16 a[94:95], v117 offset:19232
 ds_read_b64_tr_b16 a[172:173], v117 offset:18496
 ds_read_b64_tr_b16 a[174:175], v117 offset:19264
 ds_read_b64_tr_b16 a[16:17], v117 offset:24576
 ds_read_b64_tr_b16 a[18:19], v117 offset:25344
 ds_read_b64_tr_b16 a[96:97], v117 offset:24608
 ds_read_b64_tr_b16 a[98:99], v117 offset:25376
 ds_read_b64_tr_b16 a[176:177], v117 offset:24640
 ds_read_b64_tr_b16 a[178:179], v117 offset:25408
 s_branch Lpw_1
Lpwn_2:
 s_cmp_eq_u32 s3, 1
 s_cbranch_scc0 Lpwn_3
 ds_read_b64_tr_b16 a[60:61], v117 offset:0
 ds_read_b64_tr_b16 a[62:63], v117 offset:768
 ds_read_b64_tr_b16 a[140:141], v117 offset:32
 ds_read_b64_tr_b16 a[142:143], v117 offset:800
 ds_read_b64_tr_b16 a[220:221], v117 offset:64
 ds_read_b64_tr_b16 a[222:223], v117 offset:832
 ds_read_b64_tr_b16 a[64:65], v117 offset:6144
 ds_read_b64_tr_b16 a[66:67], v117 offset:6912
 ds_read_b64_tr_b16 a[144:145], v117 offset:6176
 ds_read_b64_tr_b16 a[146:147], v117 offset:6944
 ds_read_b64_tr_b16 a[224:225], v117 offset:6208
 ds_read_b64_tr_b16 a[226:227], v117 offset:6976
 ds_read_b64_tr_b16 a[68:69], v117 offset:12288
 ds_read_b64_tr_b16 a[70:71], v117 offset:13056
 ds_read_b64_tr_b16 a[148:149], v117 offset:12320
 ds_read_b64_tr_b16 a[150:151], v117 offset:13088
 ds_read_b64_tr_b16 a[228:229], v117 offset:12352
 ds_read_b64_tr_b16 a[230:231], v117 offset:13120
 ds_read_b64_tr_b16 a[72:73], v117 offset:18432
 ds_read_b64_tr_b16 a[74:75], v117 offset:19200
 ds_read_b64_tr_b16 a[152:153], v117 offset:18464
 ds_read_b64_tr_b16 a[154:155], v117 offset:19232
 ds_read_b64_tr_b16 a[232:233], v117 offset:18496
 ds_read_b64_tr_b16 a[234:235], v117 offset:19264
 ds_read_b64_tr_b16 a[76:77], v117 offset:24576
 ds_read_b64_tr_b16 a[78:79], v117 offset:25344
 ds_read_b64_tr_b16 a[156:157], v117 offset:24608
 ds_read_b64_tr_b16 a[158:159], v117 offset:25376
 ds_read_b64_tr_b16 a[236:237], v117 offset:24640
 ds_read_b64_tr_b16 a[238:239], v117 offset:25408
 s_branch Lpw_1
Lpwn_3:
 s_cmp_eq_u32 s3, 2
 s_cbranch_scc0 Lpwn_4
 ds_read_b64_tr_b16 a[40:41], v117 offset:0
 ds_read_b64_tr_b16 a[42:43], v117 offset:768
 ds_read_b64_tr_b16 a[120:121], v117 offset:32
 ds_read_b64_tr_b16 a[122:123], v117 offset:800
 ds_read_b64_tr_b16 a[200:201], v117 offset:64
 ds_read_b64_tr_b16 a[202:203], v117 offset:832
 ds_read_b64_tr_b16 a[44:45], v117 offset:6144
 ds_read_b64_tr_b16 a[46:47], v117 offset:6912
 ds_read_b64_tr_b16 a[124:125], v117 offset:6176
 ds_read_b64_tr_b16 a[126:127], v117 offset:6944
 ds_read_b64_tr_b16 a[204:205], v117 offset:6208
 ds_read_b64_tr_b16 a[206:207], v117 offset:6976
 ds_read_b64_tr_b16 a[48:49], v117 offset:12288
 ds_read_b64_tr_b16 a[50:51], v117 offset:13056
 ds_read_b64_tr_b16 a[128:129], v117 offset:12320
 ds_read_b64_tr_b16 a[130:131], v117 offset:13088
 ds_read_b64_tr_b16 a[208:209], v117 offset:12352
 ds_read_b64_tr_b16 a[210:211], v117 offset:13120
 ds_read_b64_tr_b16 a[52:53], v117 offset:18432
 ds_read_b64_tr_b16 a[54:55], v117 offset:19200
 ds_read_b64_tr_b16 a[132:133], v117 offset:18464
 ds_read_b64_tr_b16 a[134:135], v117 offset:19232
 ds_read_b64_tr_b16 a[212:213], v117 offset:18496
 ds_read_b64_tr_b16 a[214:215], v117 offset:19264
 ds_read_b64_tr_b16 a[56:57], v117 offset:24576
 ds_read_b64_tr_b16 a[58:59], v117 offset:25344
 ds_read_b64_tr_b16 a[136:137], v117 offset:24608
 ds_read_b64_tr_b16 a[138:139], v117 offset:25376
 ds_read_b64_tr_b16 a[216:217], v117 offset:24640
 ds_read_b64_tr_b16 a[218:219], v117 offset:25408
 s_branch Lpw_1
Lpwn_4:
 ds_read_b64_tr_b16 a[20:21], v117 offset:0
 ds_read_b64_tr_b16 a[22:23], v117 offset:768
 ds_read_b64_tr_b16 a[100:101], v117 offset:32
 ds_read_b64_tr_b16 a[102:103], v117 offset:800
 ds_read_b64_tr_b16 a[180:181], v117 offset:64
 ds_read_b64_tr_b16 a[182:183], v117 offset:832
 ds_read_b64_tr_b16 a[24:25], v117 offset:6144
 ds_read_b64_tr_b16 a[26:27], v117 offset:6912
 ds_read_b64_tr_b16 a[104:105], v117 offset:6176
 ds_read_b64_tr_b16 a[106:107], v117 offset:6944
 ds_read_b64_tr_b16 a[184:185], v117 offset:6208
 ds_read_b64_tr_b16 a[186:187], v117 offset:6976
 ds_read_b64_tr_b16 a[28:29], v117 offset:12288
 ds_read_b64_tr_b16 a[30:31], v117 offset:13056
 ds_read_b64_tr_b16 a[108:109], v117 offset:12320
 ds_read_b64_tr_b16 a[110:111], v117 offset:13088
 ds_read_b64_tr_b16 a[188:189], v117 offset:12352
 ds_read_b64_tr_b16 a[190:191], v117 offset:13120
 ds_read_b64_tr_b16 a[32:33], v117 offset:18432
 ds_read_b64_tr_b16 a[34:35], v117 offset:19200
 ds_read_b64_tr_b16 a[112:113], v117 offset:18464
 ds_read_b64_tr_b16 a[114:115], v117 offset:19232
 ds_read_b64_tr_b16 a[192:193], v117 offset:18496
 ds_read_b64_tr_b16 a[194:195], v117 offset:19264
 ds_read_b64_tr_b16 a[36:37], v117 offset:24576
 ds_read_b64_tr_b16 a[38:39], v117 offset:25344
 ds_read_b64_tr_b16 a[116:117], v117 offset:24608
 ds_read_b64_tr_b16 a[118:119], v117 offset:25376
 ds_read_b64_tr_b16 a[196:197], v117 offset:24640
 ds_read_b64_tr_b16 a[198:199], v117 offset:25408
Lpw_1:
 s_waitcnt lgkmcnt(0)
 s_barrier
 s_cmp_lt_u32 s3, 2
 s_cselect_b32 s20, s32, s34
 s_cselect_b32 s21, s33, s35
 s_mov_b32 s22, 7864320
 s_mov_b32 s23, 0x20000
 s_mul_i32 s25, s3, 15360
 s_add_u32 s25, s25, 0
 s_and_b32 s26, s3, 1
 s_mul_i32 s26, s26, 983040
 s_add_u32 s26, s26, 3932160
 s_add_u32 s26, s26, s29
 s_add_u32 m0, s25, 0
 s_add_u32 s27, s26, 0
 buffer_load_dwordx4 v3, s[20:23], s27 offen lds
 s_add_u32 m0, s25, 1024
 s_add_u32 s27, s26, 0
 buffer_load_dwordx4 v108, s[20:23], s27 offen lds
 s_add_u32 m0, s25, 2048
 s_add_u32 s27, s26, 0
 buffer_load_dwordx4 v109, s[20:23], s27 offen lds
 s_add_u32 m0, s25, 3072
 s_add_u32 s27, s26, 196608
 buffer_load_dwordx4 v3, s[20:23], s27 offen lds
 s_add_u32 m0, s25, 4096
 s_add_u32 s27, s26, 196608
 buffer_load_dwordx4 v108, s[20:23], s27 offen lds
 s_add_u32 m0, s25, 5120
 s_add_u32 s27, s26, 196608
 buffer_load_dwordx4 v109, s[20:23], s27 offen lds
 s_add_u32 m0, s25, 6144
 s_add_u32 s27, s26, 393216
 buffer_load_dwordx4 v3, s[20:23], s27 offen lds
 s_add_u32 m0, s25, 7168
 s_add_u32 s27, s26, 393216
 buffer_load_dwordx4 v108, s[20:23], s27 offen lds
 s_add_u32 m0, s25, 8192
 s_add_u32 s27, s26, 393216
 buffer_load_dwordx4 v109, s[20:23], s27 offen lds
 s_add_u32 m0, s25, 9216
 s_add_u32 s27, s26, 589824
 buffer_load_dwordx4 v3, s[20:23], s27 offen lds
 s_add_u32 m0, s25, 10240
 s_add_u32 s27, s26, 589824
 buffer_load_dwordx4 v108, s[20:23], s27 offen lds
 s_add_u32 m0, s25, 11264
 s_add_u32 s27, s26, 589824
 buffer_load_dwordx4 v109, s[20:23], s27 offen lds
 s_add_u32 m0, s25, 12288
 s_add_u32 s27, s26, 786432
 buffer_load_dwordx4 v3, s[20:23], s27 offen lds
 s_add_u32 m0, s25, 13312
 s_add_u32 s27, s26, 786432
 buffer_load_dwordx4 v108, s[20:23], s27 offen lds
 s_add_u32 m0, s25, 14336
 s_add_u32 s27, s26, 786432
 buffer_load_dwordx4 v109, s[20:23], s27 offen lds
 s_waitcnt vmcnt(15)
 s_barrier
 s_cmp_eq_u32 s3, 0
 s_cbranch_scc0 Lpwn_7
 ds_read_b64_tr_b16 a[20:21], v118 offset:0
 ds_read_b64_tr_b16 a[22:23], v118 offset:768
 ds_read_b64_tr_b16 a[100:101], v118 offset:32
 ds_read_b64_tr_b16 a[102:103], v118 offset:800
 ds_read_b64_tr_b16 a[180:181], v118 offset:64
 ds_read_b64_tr_b16 a[182:183], v118 offset:832
 ds_read_b64_tr_b16 a[24:25], v118 offset:6144
 ds_read_b64_tr_b16 a[26:27], v118 offset:6912
 ds_read_b64_tr_b16 a[104:105], v118 offset:6176
 ds_read_b64_tr_b16 a[106:107], v118 offset:6944
 ds_read_b64_tr_b16 a[184:185], v118 offset:6208
 ds_read_b64_tr_b16 a[186:187], v118 offset:6976
 ds_read_b64_tr_b16 a[28:29], v118 offset:12288
 ds_read_b64_tr_b16 a[30:31], v118 offset:13056
 ds_read_b64_tr_b16 a[108:109], v118 offset:12320
 ds_read_b64_tr_b16 a[110:111], v118 offset:13088
 ds_read_b64_tr_b16 a[188:189], v118 offset:12352
 ds_read_b64_tr_b16 a[190:191], v118 offset:13120
 ds_read_b64_tr_b16 a[32:33], v118 offset:18432
 ds_read_b64_tr_b16 a[34:35], v118 offset:19200
 ds_read_b64_tr_b16 a[112:113], v118 offset:18464
 ds_read_b64_tr_b16 a[114:115], v118 offset:19232
 ds_read_b64_tr_b16 a[192:193], v118 offset:18496
 ds_read_b64_tr_b16 a[194:195], v118 offset:19264
 ds_read_b64_tr_b16 a[36:37], v118 offset:24576
 ds_read_b64_tr_b16 a[38:39], v118 offset:25344
 ds_read_b64_tr_b16 a[116:117], v118 offset:24608
 ds_read_b64_tr_b16 a[118:119], v118 offset:25376
 ds_read_b64_tr_b16 a[196:197], v118 offset:24640
 ds_read_b64_tr_b16 a[198:199], v118 offset:25408
 s_branch Lpw_6
Lpwn_7:
 s_cmp_eq_u32 s3, 1
 s_cbranch_scc0 Lpwn_8
 ds_read_b64_tr_b16 a[0:1], v118 offset:0
 ds_read_b64_tr_b16 a[2:3], v118 offset:768
 ds_read_b64_tr_b16 a[80:81], v118 offset:32
 ds_read_b64_tr_b16 a[82:83], v118 offset:800
 ds_read_b64_tr_b16 a[160:161], v118 offset:64
 ds_read_b64_tr_b16 a[162:163], v118 offset:832
 ds_read_b64_tr_b16 a[4:5], v118 offset:6144
 ds_read_b64_tr_b16 a[6:7], v118 offset:6912
 ds_read_b64_tr_b16 a[84:85], v118 offset:6176
 ds_read_b64_tr_b16 a[86:87], v118 offset:6944
 ds_read_b64_tr_b16 a[164:165], v118 offset:6208
 ds_read_b64_tr_b16 a[166:167], v118 offset:6976
 ds_read_b64_tr_b16 a[8:9], v118 offset:12288
 ds_read_b64_tr_b16 a[10:11], v118 offset:13056
 ds_read_b64_tr_b16 a[88:89], v118 offset:12320
 ds_read_b64_tr_b16 a[90:91], v118 offset:13088
 ds_read_b64_tr_b16 a[168:169], v118 offset:12352
 ds_read_b64_tr_b16 a[170:171], v118 offset:13120
 ds_read_b64_tr_b16 a[12:13], v118 offset:18432
 ds_read_b64_tr_b16 a[14:15], v118 offset:19200
 ds_read_b64_tr_b16 a[92:93], v118 offset:18464
 ds_read_b64_tr_b16 a[94:95], v118 offset:19232
 ds_read_b64_tr_b16 a[172:173], v118 offset:18496
 ds_read_b64_tr_b16 a[174:175], v118 offset:19264
 ds_read_b64_tr_b16 a[16:17], v118 offset:24576
 ds_read_b64_tr_b16 a[18:19], v118 offset:25344
 ds_read_b64_tr_b16 a[96:97], v118 offset:24608
 ds_read_b64_tr_b16 a[98:99], v118 offset:25376
 ds_read_b64_tr_b16 a[176:177], v118 offset:24640
 ds_read_b64_tr_b16 a[178:179], v118 offset:25408
 s_branch Lpw_6
Lpwn_8:
 s_cmp_eq_u32 s3, 2
 s_cbranch_scc0 Lpwn_9
 ds_read_b64_tr_b16 a[60:61], v118 offset:0
 ds_read_b64_tr_b16 a[62:63], v118 offset:768
 ds_read_b64_tr_b16 a[140:141], v118 offset:32
 ds_read_b64_tr_b16 a[142:143], v118 offset:800
 ds_read_b64_tr_b16 a[220:221], v118 offset:64
 ds_read_b64_tr_b16 a[222:223], v118 offset:832
 ds_read_b64_tr_b16 a[64:65], v118 offset:6144
 ds_read_b64_tr_b16 a[66:67], v118 offset:6912
 ds_read_b64_tr_b16 a[144:145], v118 offset:6176
 ds_read_b64_tr_b16 a[146:147], v118 offset:6944
 ds_read_b64_tr_b16 a[224:225], v118 offset:6208
 ds_read_b64_tr_b16 a[226:227], v118 offset:6976
 ds_read_b64_tr_b16 a[68:69], v118 offset:12288
 ds_read_b64_tr_b16 a[70:71], v118 offset:13056
 ds_read_b64_tr_b16 a[148:149], v118 offset:12320
 ds_read_b64_tr_b16 a[150:151], v118 offset:13088
 ds_read_b64_tr_b16 a[228:229], v118 offset:12352
 ds_read_b64_tr_b16 a[230:231], v118 offset:13120
 ds_read_b64_tr_b16 a[72:73], v118 offset:18432
 ds_read_b64_tr_b16 a[74:75], v118 offset:19200
 ds_read_b64_tr_b16 a[152:153], v118 offset:18464
 ds_read_b64_tr_b16 a[154:155], v118 offset:19232
 ds_read_b64_tr_b16 a[232:233], v118 offset:18496
 ds_read_b64_tr_b16 a[234:235], v118 offset:19264
 ds_read_b64_tr_b16 a[76:77], v118 offset:24576
 ds_read_b64_tr_b16 a[78:79], v118 offset:25344
 ds_read_b64_tr_b16 a[156:157], v118 offset:24608
 ds_read_b64_tr_b16 a[158:159], v118 offset:25376
 ds_read_b64_tr_b16 a[236:237], v118 offset:24640
 ds_read_b64_tr_b16 a[238:239], v118 offset:25408
 s_branch Lpw_6
Lpwn_9:
 ds_read_b64_tr_b16 a[40:41], v118 offset:0
 ds_read_b64_tr_b16 a[42:43], v118 offset:768
 ds_read_b64_tr_b16 a[120:121], v118 offset:32
 ds_read_b64_tr_b16 a[122:123], v118 offset:800
 ds_read_b64_tr_b16 a[200:201], v118 offset:64
 ds_read_b64_tr_b16 a[202:203], v118 offset:832
 ds_read_b64_tr_b16 a[44:45], v118 offset:6144
 ds_read_b64_tr_b16 a[46:47], v118 offset:6912
 ds_read_b64_tr_b16 a[124:125], v118 offset:6176
 ds_read_b64_tr_b16 a[126:127], v118 offset:6944
 ds_read_b64_tr_b16 a[204:205], v118 offset:6208
 ds_read_b64_tr_b16 a[206:207], v118 offset:6976
 ds_read_b64_tr_b16 a[48:49], v118 offset:12288
 ds_read_b64_tr_b16 a[50:51], v118 offset:13056
 ds_read_b64_tr_b16 a[128:129], v118 offset:12320
 ds_read_b64_tr_b16 a[130:131], v118 offset:13088
 ds_read_b64_tr_b16 a[208:209], v118 offset:12352
 ds_read_b64_tr_b16 a[210:211], v118 offset:13120
 ds_read_b64_tr_b16 a[52:53], v118 offset:18432
 ds_read_b64_tr_b16 a[54:55], v118 offset:19200
 ds_read_b64_tr_b16 a[132:133], v118 offset:18464
 ds_read_b64_tr_b16 a[134:135], v118 offset:19232
 ds_read_b64_tr_b16 a[212:213], v118 offset:18496
 ds_read_b64_tr_b16 a[214:215], v118 offset:19264
 ds_read_b64_tr_b16 a[56:57], v118 offset:24576
 ds_read_b64_tr_b16 a[58:59], v118 offset:25344
 ds_read_b64_tr_b16 a[136:137], v118 offset:24608
 ds_read_b64_tr_b16 a[138:139], v118 offset:25376
 ds_read_b64_tr_b16 a[216:217], v118 offset:24640
 ds_read_b64_tr_b16 a[218:219], v118 offset:25408
Lpw_6:
 s_waitcnt lgkmcnt(0)
 s_barrier
 s_cmp_lt_u32 s3, 2
 s_cselect_b32 s20, s32, s34
 s_cselect_b32 s21, s33, s35
 s_mov_b32 s22, 7864320
 s_mov_b32 s23, 0x20000
 s_mul_i32 s25, s3, 15360
 s_add_u32 s25, s25, 61440
 s_and_b32 s26, s3, 1
 s_mul_i32 s26, s26, 983040
 s_add_u32 s26, s26, 5898240
 s_add_u32 s26, s26, s29
 s_add_u32 m0, s25, 0
 s_add_u32 s27, s26, 0
 buffer_load_dwordx4 v3, s[20:23], s27 offen lds
 s_add_u32 m0, s25, 1024
 s_add_u32 s27, s26, 0
 buffer_load_dwordx4 v108, s[20:23], s27 offen lds
 s_add_u32 m0, s25, 2048
 s_add_u32 s27, s26, 0
 buffer_load_dwordx4 v109, s[20:23], s27 offen lds
 s_add_u32 m0, s25, 3072
 s_add_u32 s27, s26, 196608
 buffer_load_dwordx4 v3, s[20:23], s27 offen lds
 s_add_u32 m0, s25, 4096
 s_add_u32 s27, s26, 196608
 buffer_load_dwordx4 v108, s[20:23], s27 offen lds
 s_add_u32 m0, s25, 5120
 s_add_u32 s27, s26, 196608
 buffer_load_dwordx4 v109, s[20:23], s27 offen lds
 s_add_u32 m0, s25, 6144
 s_add_u32 s27, s26, 393216
 buffer_load_dwordx4 v3, s[20:23], s27 offen lds
 s_add_u32 m0, s25, 7168
 s_add_u32 s27, s26, 393216
 buffer_load_dwordx4 v108, s[20:23], s27 offen lds
 s_add_u32 m0, s25, 8192
 s_add_u32 s27, s26, 393216
 buffer_load_dwordx4 v109, s[20:23], s27 offen lds
 s_add_u32 m0, s25, 9216
 s_add_u32 s27, s26, 589824
 buffer_load_dwordx4 v3, s[20:23], s27 offen lds
 s_add_u32 m0, s25, 10240
 s_add_u32 s27, s26, 589824
 buffer_load_dwordx4 v108, s[20:23], s27 offen lds
 s_add_u32 m0, s25, 11264
 s_add_u32 s27, s26, 589824
 buffer_load_dwordx4 v109, s[20:23], s27 offen lds
 s_add_u32 m0, s25, 12288
 s_add_u32 s27, s26, 786432
 buffer_load_dwordx4 v3, s[20:23], s27 offen lds
 s_add_u32 m0, s25, 13312
 s_add_u32 s27, s26, 786432
 buffer_load_dwordx4 v108, s[20:23], s27 offen lds
 s_add_u32 m0, s25, 14336
 s_add_u32 s27, s26, 786432
 buffer_load_dwordx4 v109, s[20:23], s27 offen lds
 s_waitcnt vmcnt(15)
 s_barrier
 s_cmp_eq_u32 s3, 0
 s_cbranch_scc0 Lpwn_12
 ds_read_b64_tr_b16 a[40:41], v117 offset:0
 ds_read_b64_tr_b16 a[42:43], v117 offset:768
 ds_read_b64_tr_b16 a[120:121], v117 offset:32
 ds_read_b64_tr_b16 a[122:123], v117 offset:800
 ds_read_b64_tr_b16 a[200:201], v117 offset:64
 ds_read_b64_tr_b16 a[202:203], v117 offset:832
 ds_read_b64_tr_b16 a[44:45], v117 offset:6144
 ds_read_b64_tr_b16 a[46:47], v117 offset:6912
 ds_read_b64_tr_b16 a[124:125], v117 offset:6176
 ds_read_b64_tr_b16 a[126:127], v117 offset:6944
 ds_read_b64_tr_b16 a[204:205], v117 offset:6208
 ds_read_b64_tr_b16 a[206:207], v117 offset:6976
 ds_read_b64_tr_b16 a[48:49], v117 offset:12288
 ds_read_b64_tr_b16 a[50:51], v117 offset:13056
 ds_read_b64_tr_b16 a[128:129], v117 offset:12320
 ds_read_b64_tr_b16 a[130:131], v117 offset:13088
 ds_read_b64_tr_b16 a[208:209], v117 offset:12352
 ds_read_b64_tr_b16 a[210:211], v117 offset:13120
 ds_read_b64_tr_b16 a[52:53], v117 offset:18432
 ds_read_b64_tr_b16 a[54:55], v117 offset:19200
 ds_read_b64_tr_b16 a[132:133], v117 offset:18464
 ds_read_b64_tr_b16 a[134:135], v117 offset:19232
 ds_read_b64_tr_b16 a[212:213], v117 offset:18496
 ds_read_b64_tr_b16 a[214:215], v117 offset:19264
 ds_read_b64_tr_b16 a[56:57], v117 offset:24576
 ds_read_b64_tr_b16 a[58:59], v117 offset:25344
 ds_read_b64_tr_b16 a[136:137], v117 offset:24608
 ds_read_b64_tr_b16 a[138:139], v117 offset:25376
 ds_read_b64_tr_b16 a[216:217], v117 offset:24640
 ds_read_b64_tr_b16 a[218:219], v117 offset:25408
 s_branch Lpw_11
Lpwn_12:
 s_cmp_eq_u32 s3, 1
 s_cbranch_scc0 Lpwn_13
 ds_read_b64_tr_b16 a[20:21], v117 offset:0
 ds_read_b64_tr_b16 a[22:23], v117 offset:768
 ds_read_b64_tr_b16 a[100:101], v117 offset:32
 ds_read_b64_tr_b16 a[102:103], v117 offset:800
 ds_read_b64_tr_b16 a[180:181], v117 offset:64
 ds_read_b64_tr_b16 a[182:183], v117 offset:832
 ds_read_b64_tr_b16 a[24:25], v117 offset:6144
 ds_read_b64_tr_b16 a[26:27], v117 offset:6912
 ds_read_b64_tr_b16 a[104:105], v117 offset:6176
 ds_read_b64_tr_b16 a[106:107], v117 offset:6944
 ds_read_b64_tr_b16 a[184:185], v117 offset:6208
 ds_read_b64_tr_b16 a[186:187], v117 offset:6976
 ds_read_b64_tr_b16 a[28:29], v117 offset:12288
 ds_read_b64_tr_b16 a[30:31], v117 offset:13056
 ds_read_b64_tr_b16 a[108:109], v117 offset:12320
 ds_read_b64_tr_b16 a[110:111], v117 offset:13088
 ds_read_b64_tr_b16 a[188:189], v117 offset:12352
 ds_read_b64_tr_b16 a[190:191], v117 offset:13120
 ds_read_b64_tr_b16 a[32:33], v117 offset:18432
 ds_read_b64_tr_b16 a[34:35], v117 offset:19200
 ds_read_b64_tr_b16 a[112:113], v117 offset:18464
 ds_read_b64_tr_b16 a[114:115], v117 offset:19232
 ds_read_b64_tr_b16 a[192:193], v117 offset:18496
 ds_read_b64_tr_b16 a[194:195], v117 offset:19264
 ds_read_b64_tr_b16 a[36:37], v117 offset:24576
 ds_read_b64_tr_b16 a[38:39], v117 offset:25344
 ds_read_b64_tr_b16 a[116:117], v117 offset:24608
 ds_read_b64_tr_b16 a[118:119], v117 offset:25376
 ds_read_b64_tr_b16 a[196:197], v117 offset:24640
 ds_read_b64_tr_b16 a[198:199], v117 offset:25408
 s_branch Lpw_11
Lpwn_13:
 s_cmp_eq_u32 s3, 2
 s_cbranch_scc0 Lpwn_14
 ds_read_b64_tr_b16 a[0:1], v117 offset:0
 ds_read_b64_tr_b16 a[2:3], v117 offset:768
 ds_read_b64_tr_b16 a[80:81], v117 offset:32
 ds_read_b64_tr_b16 a[82:83], v117 offset:800
 ds_read_b64_tr_b16 a[160:161], v117 offset:64
 ds_read_b64_tr_b16 a[162:163], v117 offset:832
 ds_read_b64_tr_b16 a[4:5], v117 offset:6144
 ds_read_b64_tr_b16 a[6:7], v117 offset:6912
 ds_read_b64_tr_b16 a[84:85], v117 offset:6176
 ds_read_b64_tr_b16 a[86:87], v117 offset:6944
 ds_read_b64_tr_b16 a[164:165], v117 offset:6208
 ds_read_b64_tr_b16 a[166:167], v117 offset:6976
 ds_read_b64_tr_b16 a[8:9], v117 offset:12288
 ds_read_b64_tr_b16 a[10:11], v117 offset:13056
 ds_read_b64_tr_b16 a[88:89], v117 offset:12320
 ds_read_b64_tr_b16 a[90:91], v117 offset:13088
 ds_read_b64_tr_b16 a[168:169], v117 offset:12352
 ds_read_b64_tr_b16 a[170:171], v117 offset:13120
 ds_read_b64_tr_b16 a[12:13], v117 offset:18432
 ds_read_b64_tr_b16 a[14:15], v117 offset:19200
 ds_read_b64_tr_b16 a[92:93], v117 offset:18464
 ds_read_b64_tr_b16 a[94:95], v117 offset:19232
 ds_read_b64_tr_b16 a[172:173], v117 offset:18496
 ds_read_b64_tr_b16 a[174:175], v117 offset:19264
 ds_read_b64_tr_b16 a[16:17], v117 offset:24576
 ds_read_b64_tr_b16 a[18:19], v117 offset:25344
 ds_read_b64_tr_b16 a[96:97], v117 offset:24608
 ds_read_b64_tr_b16 a[98:99], v117 offset:25376
 ds_read_b64_tr_b16 a[176:177], v117 offset:24640
 ds_read_b64_tr_b16 a[178:179], v117 offset:25408
 s_branch Lpw_11
Lpwn_14:
 ds_read_b64_tr_b16 a[60:61], v117 offset:0
 ds_read_b64_tr_b16 a[62:63], v117 offset:768
 ds_read_b64_tr_b16 a[140:141], v117 offset:32
 ds_read_b64_tr_b16 a[142:143], v117 offset:800
 ds_read_b64_tr_b16 a[220:221], v117 offset:64
 ds_read_b64_tr_b16 a[222:223], v117 offset:832
 ds_read_b64_tr_b16 a[64:65], v117 offset:6144
 ds_read_b64_tr_b16 a[66:67], v117 offset:6912
 ds_read_b64_tr_b16 a[144:145], v117 offset:6176
 ds_read_b64_tr_b16 a[146:147], v117 offset:6944
 ds_read_b64_tr_b16 a[224:225], v117 offset:6208
 ds_read_b64_tr_b16 a[226:227], v117 offset:6976
 ds_read_b64_tr_b16 a[68:69], v117 offset:12288
 ds_read_b64_tr_b16 a[70:71], v117 offset:13056
 ds_read_b64_tr_b16 a[148:149], v117 offset:12320
 ds_read_b64_tr_b16 a[150:151], v117 offset:13088
 ds_read_b64_tr_b16 a[228:229], v117 offset:12352
 ds_read_b64_tr_b16 a[230:231], v117 offset:13120
 ds_read_b64_tr_b16 a[72:73], v117 offset:18432
 ds_read_b64_tr_b16 a[74:75], v117 offset:19200
 ds_read_b64_tr_b16 a[152:153], v117 offset:18464
 ds_read_b64_tr_b16 a[154:155], v117 offset:19232
 ds_read_b64_tr_b16 a[232:233], v117 offset:18496
 ds_read_b64_tr_b16 a[234:235], v117 offset:19264
 ds_read_b64_tr_b16 a[76:77], v117 offset:24576
 ds_read_b64_tr_b16 a[78:79], v117 offset:25344
 ds_read_b64_tr_b16 a[156:157], v117 offset:24608
 ds_read_b64_tr_b16 a[158:159], v117 offset:25376
 ds_read_b64_tr_b16 a[236:237], v117 offset:24640
 ds_read_b64_tr_b16 a[238:239], v117 offset:25408
Lpw_11:
 s_waitcnt lgkmcnt(0)
 s_barrier
 s_mov_b32 s20, s36
 s_mov_b32 s21, s37
 s_mov_b32 s22, 7864320
 s_mov_b32 s23, 0x20000
 s_mul_i32 s25, s3, 15360
 s_add_u32 s25, s25, 0
 s_mul_i32 s26, s3, 983040
 s_add_u32 s26, s26, 0
 s_add_u32 s26, s26, s29
 s_add_u32 m0, s25, 0
 s_add_u32 s27, s26, 0
 buffer_load_dwordx4 v3, s[20:23], s27 offen lds
 s_add_u32 m0, s25, 1024
 s_add_u32 s27, s26, 0
 buffer_load_dwordx4 v108, s[20:23], s27 offen lds
 s_add_u32 m0, s25, 2048
 s_add_u32 s27, s26, 0
 buffer_load_dwordx4 v109, s[20:23], s27 offen lds
 s_add_u32 m0, s25, 3072
 s_add_u32 s27, s26, 196608
 buffer_load_dwordx4 v3, s[20:23], s27 offen lds
 s_add_u32 m0, s25, 4096
 s_add_u32 s27, s26, 196608
 buffer_load_dwordx4 v108, s[20:23], s27 offen lds
 s_add_u32 m0, s25, 5120
 s_add_u32 s27, s26, 196608
 buffer_load_dwordx4 v109, s[20:23], s27 offen lds
 s_add_u32 m0, s25, 6144
 s_add_u32 s27, s26, 393216
 buffer_load_dwordx4 v3, s[20:23], s27 offen lds
 s_add_u32 m0, s25, 7168
 s_add_u32 s27, s26, 393216
 buffer_load_dwordx4 v108, s[20:23], s27 offen lds
 s_add_u32 m0, s25, 8192
 s_add_u32 s27, s26, 393216
 buffer_load_dwordx4 v109, s[20:23], s27 offen lds
 s_add_u32 m0, s25, 9216
 s_add_u32 s27, s26, 589824
 buffer_load_dwordx4 v3, s[20:23], s27 offen lds
 s_add_u32 m0, s25, 10240
 s_add_u32 s27, s26, 589824
 buffer_load_dwordx4 v108, s[20:23], s27 offen lds
 s_add_u32 m0, s25, 11264
 s_add_u32 s27, s26, 589824
 buffer_load_dwordx4 v109, s[20:23], s27 offen lds
 s_add_u32 m0, s25, 12288
 s_add_u32 s27, s26, 786432
 buffer_load_dwordx4 v3, s[20:23], s27 offen lds
 s_add_u32 m0, s25, 13312
 s_add_u32 s27, s26, 786432
 buffer_load_dwordx4 v108, s[20:23], s27 offen lds
 s_add_u32 m0, s25, 14336
 s_add_u32 s27, s26, 786432
 buffer_load_dwordx4 v109, s[20:23], s27 offen lds
 s_waitcnt vmcnt(15)
 s_barrier
 s_cmp_eq_u32 s3, 0
 s_cbranch_scc0 Lpwn_17
 ds_read_b64_tr_b16 a[60:61], v118 offset:0
 ds_read_b64_tr_b16 a[62:63], v118 offset:768
 ds_read_b64_tr_b16 a[140:141], v118 offset:32
 ds_read_b64_tr_b16 a[142:143], v118 offset:800
 ds_read_b64_tr_b16 a[220:221], v118 offset:64
 ds_read_b64_tr_b16 a[222:223], v118 offset:832
 ds_read_b64_tr_b16 a[64:65], v118 offset:6144
 ds_read_b64_tr_b16 a[66:67], v118 offset:6912
 ds_read_b64_tr_b16 a[144:145], v118 offset:6176
 ds_read_b64_tr_b16 a[146:147], v118 offset:6944
 ds_read_b64_tr_b16 a[224:225], v118 offset:6208
 ds_read_b64_tr_b16 a[226:227], v118 offset:6976
 ds_read_b64_tr_b16 a[68:69], v118 offset:12288
 ds_read_b64_tr_b16 a[70:71], v118 offset:13056
 ds_read_b64_tr_b16 a[148:149], v118 offset:12320
 ds_read_b64_tr_b16 a[150:151], v118 offset:13088
 ds_read_b64_tr_b16 a[228:229], v118 offset:12352
 ds_read_b64_tr_b16 a[230:231], v118 offset:13120
 ds_read_b64_tr_b16 a[72:73], v118 offset:18432
 ds_read_b64_tr_b16 a[74:75], v118 offset:19200
 ds_read_b64_tr_b16 a[152:153], v118 offset:18464
 ds_read_b64_tr_b16 a[154:155], v118 offset:19232
 ds_read_b64_tr_b16 a[232:233], v118 offset:18496
 ds_read_b64_tr_b16 a[234:235], v118 offset:19264
 ds_read_b64_tr_b16 a[76:77], v118 offset:24576
 ds_read_b64_tr_b16 a[78:79], v118 offset:25344
 ds_read_b64_tr_b16 a[156:157], v118 offset:24608
 ds_read_b64_tr_b16 a[158:159], v118 offset:25376
 ds_read_b64_tr_b16 a[236:237], v118 offset:24640
 ds_read_b64_tr_b16 a[238:239], v118 offset:25408
 s_branch Lpw_16
Lpwn_17:
 s_cmp_eq_u32 s3, 1
 s_cbranch_scc0 Lpwn_18
 ds_read_b64_tr_b16 a[40:41], v118 offset:0
 ds_read_b64_tr_b16 a[42:43], v118 offset:768
 ds_read_b64_tr_b16 a[120:121], v118 offset:32
 ds_read_b64_tr_b16 a[122:123], v118 offset:800
 ds_read_b64_tr_b16 a[200:201], v118 offset:64
 ds_read_b64_tr_b16 a[202:203], v118 offset:832
 ds_read_b64_tr_b16 a[44:45], v118 offset:6144
 ds_read_b64_tr_b16 a[46:47], v118 offset:6912
 ds_read_b64_tr_b16 a[124:125], v118 offset:6176
 ds_read_b64_tr_b16 a[126:127], v118 offset:6944
 ds_read_b64_tr_b16 a[204:205], v118 offset:6208
 ds_read_b64_tr_b16 a[206:207], v118 offset:6976
 ds_read_b64_tr_b16 a[48:49], v118 offset:12288
 ds_read_b64_tr_b16 a[50:51], v118 offset:13056
 ds_read_b64_tr_b16 a[128:129], v118 offset:12320
 ds_read_b64_tr_b16 a[130:131], v118 offset:13088
 ds_read_b64_tr_b16 a[208:209], v118 offset:12352
 ds_read_b64_tr_b16 a[210:211], v118 offset:13120
 ds_read_b64_tr_b16 a[52:53], v118 offset:18432
 ds_read_b64_tr_b16 a[54:55], v118 offset:19200
 ds_read_b64_tr_b16 a[132:133], v118 offset:18464
 ds_read_b64_tr_b16 a[134:135], v118 offset:19232
 ds_read_b64_tr_b16 a[212:213], v118 offset:18496
 ds_read_b64_tr_b16 a[214:215], v118 offset:19264
 ds_read_b64_tr_b16 a[56:57], v118 offset:24576
 ds_read_b64_tr_b16 a[58:59], v118 offset:25344
 ds_read_b64_tr_b16 a[136:137], v118 offset:24608
 ds_read_b64_tr_b16 a[138:139], v118 offset:25376
 ds_read_b64_tr_b16 a[216:217], v118 offset:24640
 ds_read_b64_tr_b16 a[218:219], v118 offset:25408
 s_branch Lpw_16
Lpwn_18:
 s_cmp_eq_u32 s3, 2
 s_cbranch_scc0 Lpwn_19
 ds_read_b64_tr_b16 a[20:21], v118 offset:0
 ds_read_b64_tr_b16 a[22:23], v118 offset:768
 ds_read_b64_tr_b16 a[100:101], v118 offset:32
 ds_read_b64_tr_b16 a[102:103], v118 offset:800
 ds_read_b64_tr_b16 a[180:181], v118 offset:64
 ds_read_b64_tr_b16 a[182:183], v118 offset:832
 ds_read_b64_tr_b16 a[24:25], v118 offset:6144
 ds_read_b64_tr_b16 a[26:27], v118 offset:6912
 ds_read_b64_tr_b16 a[104:105], v118 offset:6176
 ds_read_b64_tr_b16 a[106:107], v118 offset:6944
 ds_read_b64_tr_b16 a[184:185], v118 offset:6208
 ds_read_b64_tr_b16 a[186:187], v118 offset:6976
 ds_read_b64_tr_b16 a[28:29], v118 offset:12288
 ds_read_b64_tr_b16 a[30:31], v118 offset:13056
 ds_read_b64_tr_b16 a[108:109], v118 offset:12320
 ds_read_b64_tr_b16 a[110:111], v118 offset:13088
 ds_read_b64_tr_b16 a[188:189], v118 offset:12352
 ds_read_b64_tr_b16 a[190:191], v118 offset:13120
 ds_read_b64_tr_b16 a[32:33], v118 offset:18432
 ds_read_b64_tr_b16 a[34:35], v118 offset:19200
 ds_read_b64_tr_b16 a[112:113], v118 offset:18464
 ds_read_b64_tr_b16 a[114:115], v118 offset:19232
 ds_read_b64_tr_b16 a[192:193], v118 offset:18496
 ds_read_b64_tr_b16 a[194:195], v118 offset:19264
 ds_read_b64_tr_b16 a[36:37], v118 offset:24576
 ds_read_b64_tr_b16 a[38:39], v118 offset:25344
 ds_read_b64_tr_b16 a[116:117], v118 offset:24608
 ds_read_b64_tr_b16 a[118:119], v118 offset:25376
 ds_read_b64_tr_b16 a[196:197], v118 offset:24640
 ds_read_b64_tr_b16 a[198:199], v118 offset:25408
 s_branch Lpw_16
Lpwn_19:
 ds_read_b64_tr_b16 a[0:1], v118 offset:0
 ds_read_b64_tr_b16 a[2:3], v118 offset:768
 ds_read_b64_tr_b16 a[80:81], v118 offset:32
 ds_read_b64_tr_b16 a[82:83], v118 offset:800
 ds_read_b64_tr_b16 a[160:161], v118 offset:64
 ds_read_b64_tr_b16 a[162:163], v118 offset:832
 ds_read_b64_tr_b16 a[4:5], v118 offset:6144
 ds_read_b64_tr_b16 a[6:7], v118 offset:6912
 ds_read_b64_tr_b16 a[84:85], v118 offset:6176
 ds_read_b64_tr_b16 a[86:87], v118 offset:6944
 ds_read_b64_tr_b16 a[164:165], v118 offset:6208
 ds_read_b64_tr_b16 a[166:167], v118 offset:6976
 ds_read_b64_tr_b16 a[8:9], v118 offset:12288
 ds_read_b64_tr_b16 a[10:11], v118 offset:13056
 ds_read_b64_tr_b16 a[88:89], v118 offset:12320
 ds_read_b64_tr_b16 a[90:91], v118 offset:13088
 ds_read_b64_tr_b16 a[168:169], v118 offset:12352
 ds_read_b64_tr_b16 a[170:171], v118 offset:13120
 ds_read_b64_tr_b16 a[12:13], v118 offset:18432
 ds_read_b64_tr_b16 a[14:15], v118 offset:19200
 ds_read_b64_tr_b16 a[92:93], v118 offset:18464
 ds_read_b64_tr_b16 a[94:95], v118 offset:19232
 ds_read_b64_tr_b16 a[172:173], v118 offset:18496
 ds_read_b64_tr_b16 a[174:175], v118 offset:19264
 ds_read_b64_tr_b16 a[16:17], v118 offset:24576
 ds_read_b64_tr_b16 a[18:19], v118 offset:25344
 ds_read_b64_tr_b16 a[96:97], v118 offset:24608
 ds_read_b64_tr_b16 a[98:99], v118 offset:25376
 ds_read_b64_tr_b16 a[176:177], v118 offset:24640
 ds_read_b64_tr_b16 a[178:179], v118 offset:25408
Lpw_16:
 s_waitcnt lgkmcnt(0)
 s_barrier
 s_mov_b32 s20, s36
 s_mov_b32 s21, s37
 s_mov_b32 s22, 7864320
 s_mov_b32 s23, 0x20000
 s_mul_i32 s25, s3, 15360
 s_add_u32 s25, s25, 61440
 s_mul_i32 s26, s3, 983040
 s_add_u32 s26, s26, 3932160
 s_add_u32 s26, s26, s29
 s_add_u32 m0, s25, 0
 s_add_u32 s27, s26, 0
 buffer_load_dwordx4 v3, s[20:23], s27 offen lds
 s_add_u32 m0, s25, 1024
 s_add_u32 s27, s26, 0
 buffer_load_dwordx4 v108, s[20:23], s27 offen lds
 s_add_u32 m0, s25, 2048
 s_add_u32 s27, s26, 0
 buffer_load_dwordx4 v109, s[20:23], s27 offen lds
 s_add_u32 m0, s25, 3072
 s_add_u32 s27, s26, 196608
 buffer_load_dwordx4 v3, s[20:23], s27 offen lds
 s_add_u32 m0, s25, 4096
 s_add_u32 s27, s26, 196608
 buffer_load_dwordx4 v108, s[20:23], s27 offen lds
 s_add_u32 m0, s25, 5120
 s_add_u32 s27, s26, 196608
 buffer_load_dwordx4 v109, s[20:23], s27 offen lds
 s_add_u32 m0, s25, 6144
 s_add_u32 s27, s26, 393216
 buffer_load_dwordx4 v3, s[20:23], s27 offen lds
 s_add_u32 m0, s25, 7168
 s_add_u32 s27, s26, 393216
 buffer_load_dwordx4 v108, s[20:23], s27 offen lds
 s_add_u32 m0, s25, 8192
 s_add_u32 s27, s26, 393216
 buffer_load_dwordx4 v109, s[20:23], s27 offen lds
 s_add_u32 m0, s25, 9216
 s_add_u32 s27, s26, 589824
 buffer_load_dwordx4 v3, s[20:23], s27 offen lds
 s_add_u32 m0, s25, 10240
 s_add_u32 s27, s26, 589824
 buffer_load_dwordx4 v108, s[20:23], s27 offen lds
 s_add_u32 m0, s25, 11264
 s_add_u32 s27, s26, 589824
 buffer_load_dwordx4 v109, s[20:23], s27 offen lds
 s_add_u32 m0, s25, 12288
 s_add_u32 s27, s26, 786432
 buffer_load_dwordx4 v3, s[20:23], s27 offen lds
 s_add_u32 m0, s25, 13312
 s_add_u32 s27, s26, 786432
 buffer_load_dwordx4 v108, s[20:23], s27 offen lds
 s_add_u32 m0, s25, 14336
 s_add_u32 s27, s26, 786432
 buffer_load_dwordx4 v109, s[20:23], s27 offen lds
 s_waitcnt vmcnt(15)
 s_barrier
 s_cmp_eq_u32 s3, 0
 s_cbranch_scc0 Lpwn_22
 ds_read_b64_tr_b16 a[240:241], v119 offset:0
 ds_read_b64_tr_b16 v[68:69], v120 offset:0
 ds_read_b64_tr_b16 a[242:243], v119 offset:768
 ds_read_b64_tr_b16 v[70:71], v120 offset:768
 ds_read_b64_tr_b16 a[244:245], v119 offset:6144
 ds_read_b64_tr_b16 v[72:73], v120 offset:6144
 ds_read_b64_tr_b16 a[246:247], v119 offset:6912
 ds_read_b64_tr_b16 v[74:75], v120 offset:6912
 ds_read_b64_tr_b16 a[248:249], v119 offset:12288
 ds_read_b64_tr_b16 v[76:77], v120 offset:12288
 ds_read_b64_tr_b16 a[250:251], v119 offset:13056
 ds_read_b64_tr_b16 v[78:79], v120 offset:13056
 ds_read_b64_tr_b16 a[252:253], v119 offset:18432
 ds_read_b64_tr_b16 v[80:81], v120 offset:18432
 ds_read_b64_tr_b16 a[254:255], v119 offset:19200
 ds_read_b64_tr_b16 v[82:83], v120 offset:19200
 ds_read_b64_tr_b16 v[4:5], v119 offset:24576
 ds_read_b64_tr_b16 v[84:85], v120 offset:24576
 ds_read_b64_tr_b16 v[6:7], v119 offset:25344
 ds_read_b64_tr_b16 v[86:87], v120 offset:25344
 ds_read_b64_tr_b16 v[8:9], v119 offset:30720
 ds_read_b64_tr_b16 v[88:89], v120 offset:30720
 ds_read_b64_tr_b16 v[10:11], v119 offset:31488
 ds_read_b64_tr_b16 v[90:91], v120 offset:31488
 ds_read_b64_tr_b16 v[12:13], v119 offset:36864
 ds_read_b64_tr_b16 v[92:93], v120 offset:36864
 ds_read_b64_tr_b16 v[14:15], v119 offset:37632
 ds_read_b64_tr_b16 v[94:95], v120 offset:37632
 ds_read_b64_tr_b16 v[16:17], v119 offset:43008
 ds_read_b64_tr_b16 v[96:97], v120 offset:43008
 ds_read_b64_tr_b16 v[18:19], v119 offset:43776
 ds_read_b64_tr_b16 v[98:99], v120 offset:43776
 ds_read_b64_tr_b16 v[20:21], v119 offset:49152
 ds_read_b64_tr_b16 v[100:101], v120 offset:49152
 ds_read_b64_tr_b16 v[22:23], v119 offset:49920
 ds_read_b64_tr_b16 v[102:103], v120 offset:49920
 ds_read_b64_tr_b16 v[24:25], v119 offset:55296
 ds_read_b64_tr_b16 v[104:105], v120 offset:55296
 ds_read_b64_tr_b16 v[26:27], v119 offset:56064
 ds_read_b64_tr_b16 v[106:107], v120 offset:56064
 s_branch Lpw_21
Lpwn_22:
 s_cmp_eq_u32 s3, 1
 s_cbranch_scc0 Lpwn_23
 ds_read_b64_tr_b16 v[48:49], v119 offset:0
 ds_read_b64_tr_b16 v[50:51], v119 offset:768
 ds_read_b64_tr_b16 v[52:53], v119 offset:6144
 ds_read_b64_tr_b16 v[54:55], v119 offset:6912
 ds_read_b64_tr_b16 v[56:57], v119 offset:12288
 ds_read_b64_tr_b16 v[58:59], v119 offset:13056
 ds_read_b64_tr_b16 v[60:61], v119 offset:18432
 ds_read_b64_tr_b16 v[62:63], v119 offset:19200
 ds_read_b64_tr_b16 v[64:65], v119 offset:24576
 ds_read_b64_tr_b16 v[66:67], v119 offset:25344
 ds_read_b64_tr_b16 a[240:241], v119 offset:30720
 ds_read_b64_tr_b16 v[68:69], v120 offset:30720
 ds_read_b64_tr_b16 a[242:243], v119 offset:31488
 ds_read_b64_tr_b16 v[70:71], v120 offset:31488
 ds_read_b64_tr_b16 a[244:245], v119 offset:36864
 ds_read_b64_tr_b16 v[72:73], v120 offset:36864
 ds_read_b64_tr_b16 a[246:247], v119 offset:37632
 ds_read_b64_tr_b16 v[74:75], v120 offset:37632
 ds_read_b64_tr_b16 a[248:249], v119 offset:43008
 ds_read_b64_tr_b16 v[76:77], v120 offset:43008
 ds_read_b64_tr_b16 a[250:251], v119 offset:43776
 ds_read_b64_tr_b16 v[78:79], v120 offset:43776
 ds_read_b64_tr_b16 a[252:253], v119 offset:49152
 ds_read_b64_tr_b16 v[80:81], v120 offset:49152
 ds_read_b64_tr_b16 a[254:255], v119 offset:49920
 ds_read_b64_tr_b16 v[82:83], v120 offset:49920
 ds_read_b64_tr_b16 v[4:5], v119 offset:55296
 ds_read_b64_tr_b16 v[84:85], v120 offset:55296
 ds_read_b64_tr_b16 v[6:7], v119 offset:56064
 ds_read_b64_tr_b16 v[86:87], v120 offset:56064
 s_branch Lpw_21
Lpwn_23:
 s_cmp_eq_u32 s3, 2
 s_cbranch_scc0 Lpwn_24
 ds_read_b64_tr_b16 v[28:29], v119 offset:0
 ds_read_b64_tr_b16 v[30:31], v119 offset:768
 ds_read_b64_tr_b16 v[32:33], v119 offset:6144
 ds_read_b64_tr_b16 v[34:35], v119 offset:6912
 ds_read_b64_tr_b16 v[36:37], v119 offset:12288
 ds_read_b64_tr_b16 v[38:39], v119 offset:13056
 ds_read_b64_tr_b16 v[40:41], v119 offset:18432
 ds_read_b64_tr_b16 v[42:43], v119 offset:19200
 ds_read_b64_tr_b16 v[44:45], v119 offset:24576
 ds_read_b64_tr_b16 v[46:47], v119 offset:25344
 ds_read_b64_tr_b16 v[48:49], v119 offset:30720
 ds_read_b64_tr_b16 v[50:51], v119 offset:31488
 ds_read_b64_tr_b16 v[52:53], v119 offset:36864
 ds_read_b64_tr_b16 v[54:55], v119 offset:37632
 ds_read_b64_tr_b16 v[56:57], v119 offset:43008
 ds_read_b64_tr_b16 v[58:59], v119 offset:43776
 ds_read_b64_tr_b16 v[60:61], v119 offset:49152
 ds_read_b64_tr_b16 v[62:63], v119 offset:49920
 ds_read_b64_tr_b16 v[64:65], v119 offset:55296
 ds_read_b64_tr_b16 v[66:67], v119 offset:56064
 s_branch Lpw_21
Lpwn_24:
 ds_read_b64_tr_b16 v[8:9], v119 offset:0
 ds_read_b64_tr_b16 v[88:89], v120 offset:0
 ds_read_b64_tr_b16 v[10:11], v119 offset:768
 ds_read_b64_tr_b16 v[90:91], v120 offset:768
 ds_read_b64_tr_b16 v[12:13], v119 offset:6144
 ds_read_b64_tr_b16 v[92:93], v120 offset:6144
 ds_read_b64_tr_b16 v[14:15], v119 offset:6912
 ds_read_b64_tr_b16 v[94:95], v120 offset:6912
 ds_read_b64_tr_b16 v[16:17], v119 offset:12288
 ds_read_b64_tr_b16 v[96:97], v120 offset:12288
 ds_read_b64_tr_b16 v[18:19], v119 offset:13056
 ds_read_b64_tr_b16 v[98:99], v120 offset:13056
 ds_read_b64_tr_b16 v[20:21], v119 offset:18432
 ds_read_b64_tr_b16 v[100:101], v120 offset:18432
 ds_read_b64_tr_b16 v[22:23], v119 offset:19200
 ds_read_b64_tr_b16 v[102:103], v120 offset:19200
 ds_read_b64_tr_b16 v[24:25], v119 offset:24576
 ds_read_b64_tr_b16 v[104:105], v120 offset:24576
 ds_read_b64_tr_b16 v[26:27], v119 offset:25344
 ds_read_b64_tr_b16 v[106:107], v120 offset:25344
 ds_read_b64_tr_b16 v[28:29], v119 offset:30720
 ds_read_b64_tr_b16 v[30:31], v119 offset:31488
 ds_read_b64_tr_b16 v[32:33], v119 offset:36864
 ds_read_b64_tr_b16 v[34:35], v119 offset:37632
 ds_read_b64_tr_b16 v[36:37], v119 offset:43008
 ds_read_b64_tr_b16 v[38:39], v119 offset:43776
 ds_read_b64_tr_b16 v[40:41], v119 offset:49152
 ds_read_b64_tr_b16 v[42:43], v119 offset:49920
 ds_read_b64_tr_b16 v[44:45], v119 offset:55296
 ds_read_b64_tr_b16 v[46:47], v119 offset:56064
Lpw_21:
 s_waitcnt lgkmcnt(0)
 s_barrier
 s_mov_b32 s20, s38
 s_mov_b32 s21, s39
 s_mov_b32 s22, 7864320
 s_mov_b32 s23, 0x20000
 s_mul_i32 s25, s3, 15360
 s_add_u32 s25, s25, 0
 s_add_u32 s26, s30, 0
 s_add_u32 m0, s25, 0
 s_add_u32 s27, s26, 0
 buffer_load_dwordx4 v110, s[20:23], s27 offen lds
 s_add_u32 m0, s25, 1024
 s_add_u32 s27, s26, 0
 buffer_load_dwordx4 v111, s[20:23], s27 offen lds
 s_add_u32 m0, s25, 2048
 s_add_u32 s27, s26, 0
 buffer_load_dwordx4 v112, s[20:23], s27 offen lds
 s_add_u32 m0, s25, 3072
 s_add_u32 s27, s26, 0
 buffer_load_dwordx4 v113, s[20:23], s27 offen lds
 s_add_u32 m0, s25, 4096
 s_add_u32 s27, s26, 0
 buffer_load_dwordx4 v114, s[20:23], s27 offen lds
 s_add_u32 m0, s25, 5120
 s_add_u32 s27, s26, 40960
 buffer_load_dwordx4 v110, s[20:23], s27 offen lds
 s_add_u32 m0, s25, 6144
 s_add_u32 s27, s26, 40960
 buffer_load_dwordx4 v111, s[20:23], s27 offen lds
 s_add_u32 m0, s25, 7168
 s_add_u32 s27, s26, 40960
 buffer_load_dwordx4 v112, s[20:23], s27 offen lds
 s_add_u32 m0, s25, 8192
 s_add_u32 s27, s26, 40960
 buffer_load_dwordx4 v113, s[20:23], s27 offen lds
 s_add_u32 m0, s25, 9216
 s_add_u32 s27, s26, 40960
 buffer_load_dwordx4 v114, s[20:23], s27 offen lds
 s_add_u32 m0, s25, 10240
 s_add_u32 s27, s26, 81920
 buffer_load_dwordx4 v110, s[20:23], s27 offen lds
 s_add_u32 m0, s25, 11264
 s_add_u32 s27, s26, 81920
 buffer_load_dwordx4 v111, s[20:23], s27 offen lds
 s_add_u32 m0, s25, 12288
 s_add_u32 s27, s26, 81920
 buffer_load_dwordx4 v112, s[20:23], s27 offen lds
 s_add_u32 m0, s25, 13312
 s_add_u32 s27, s26, 81920
 buffer_load_dwordx4 v113, s[20:23], s27 offen lds
 s_add_u32 m0, s25, 14336
 s_add_u32 s27, s26, 81920
 buffer_load_dwordx4 v114, s[20:23], s27 offen lds
 s_waitcnt vmcnt(15)
 s_barrier
 v_add_u32 v119, 61440, v119
 v_add_u32 v120, 61440, v120
 s_cmp_eq_u32 s3, 0
 s_cbranch_scc0 Lpwn_27
 ds_read_b64_tr_b16 v[28:29], v119 offset:0
 ds_read_b64_tr_b16 v[30:31], v119 offset:768
 ds_read_b64_tr_b16 v[32:33], v119 offset:6144
 ds_read_b64_tr_b16 v[34:35], v119 offset:6912
 ds_read_b64_tr_b16 v[36:37], v119 offset:12288
 ds_read_b64_tr_b16 v[38:39], v119 offset:13056
 ds_read_b64_tr_b16 v[40:41], v119 offset:18432
 ds_read_b64_tr_b16 v[42:43], v119 offset:19200
 ds_read_b64_tr_b16 v[44:45], v119 offset:24576
 ds_read_b64_tr_b16 v[46:47], v119 offset:25344
 ds_read_b64_tr_b16 v[48:49], v119 offset:30720
 ds_read_b64_tr_b16 v[50:51], v119 offset:31488
 ds_read_b64_tr_b16 v[52:53], v119 offset:36864
 ds_read_b64_tr_b16 v[54:55], v119 offset:37632
 ds_read_b64_tr_b16 v[56:57], v119 offset:43008
 ds_read_b64_tr_b16 v[58:59], v119 offset:43776
 ds_read_b64_tr_b16 v[60:61], v119 offset:49152
 ds_read_b64_tr_b16 v[62:63], v119 offset:49920
 ds_read_b64_tr_b16 v[64:65], v119 offset:55296
 ds_read_b64_tr_b16 v[66:67], v119 offset:56064
 s_branch Lpw_26
Lpwn_27:
 s_cmp_eq_u32 s3, 1
 s_cbranch_scc0 Lpwn_28
 ds_read_b64_tr_b16 v[8:9], v119 offset:0
 ds_read_b64_tr_b16 v[88:89], v120 offset:0
 ds_read_b64_tr_b16 v[10:11], v119 offset:768
 ds_read_b64_tr_b16 v[90:91], v120 offset:768
 ds_read_b64_tr_b16 v[12:13], v119 offset:6144
 ds_read_b64_tr_b16 v[92:93], v120 offset:6144
 ds_read_b64_tr_b16 v[14:15], v119 offset:6912
 ds_read_b64_tr_b16 v[94:95], v120 offset:6912
 ds_read_b64_tr_b16 v[16:17], v119 offset:12288
 ds_read_b64_tr_b16 v[96:97], v120 offset:12288
 ds_read_b64_tr_b16 v[18:19], v119 offset:13056
 ds_read_b64_tr_b16 v[98:99], v120 offset:13056
 ds_read_b64_tr_b16 v[20:21], v119 offset:18432
 ds_read_b64_tr_b16 v[100:101], v120 offset:18432
 ds_read_b64_tr_b16 v[22:23], v119 offset:19200
 ds_read_b64_tr_b16 v[102:103], v120 offset:19200
 ds_read_b64_tr_b16 v[24:25], v119 offset:24576
 ds_read_b64_tr_b16 v[104:105], v120 offset:24576
 ds_read_b64_tr_b16 v[26:27], v119 offset:25344
 ds_read_b64_tr_b16 v[106:107], v120 offset:25344
 ds_read_b64_tr_b16 v[28:29], v119 offset:30720
 ds_read_b64_tr_b16 v[30:31], v119 offset:31488
 ds_read_b64_tr_b16 v[32:33], v119 offset:36864
 ds_read_b64_tr_b16 v[34:35], v119 offset:37632
 ds_read_b64_tr_b16 v[36:37], v119 offset:43008
 ds_read_b64_tr_b16 v[38:39], v119 offset:43776
 ds_read_b64_tr_b16 v[40:41], v119 offset:49152
 ds_read_b64_tr_b16 v[42:43], v119 offset:49920
 ds_read_b64_tr_b16 v[44:45], v119 offset:55296
 ds_read_b64_tr_b16 v[46:47], v119 offset:56064
 s_branch Lpw_26
Lpwn_28:
 s_cmp_eq_u32 s3, 2
 s_cbranch_scc0 Lpwn_29
 ds_read_b64_tr_b16 a[240:241], v119 offset:0
 ds_read_b64_tr_b16 v[68:69], v120 offset:0
 ds_read_b64_tr_b16 a[242:243], v119 offset:768
 ds_read_b64_tr_b16 v[70:71], v120 offset:768
 ds_read_b64_tr_b16 a[244:245], v119 offset:6144
 ds_read_b64_tr_b16 v[72:73], v120 offset:6144
 ds_read_b64_tr_b16 a[246:247], v119 offset:6912
 ds_read_b64_tr_b16 v[74:75], v120 offset:6912
 ds_read_b64_tr_b16 a[248:249], v119 offset:12288
 ds_read_b64_tr_b16 v[76:77], v120 offset:12288
 ds_read_b64_tr_b16 a[250:251], v119 offset:13056
 ds_read_b64_tr_b16 v[78:79], v120 offset:13056
 ds_read_b64_tr_b16 a[252:253], v119 offset:18432
 ds_read_b64_tr_b16 v[80:81], v120 offset:18432
 ds_read_b64_tr_b16 a[254:255], v119 offset:19200
 ds_read_b64_tr_b16 v[82:83], v120 offset:19200
 ds_read_b64_tr_b16 v[4:5], v119 offset:24576
 ds_read_b64_tr_b16 v[84:85], v120 offset:24576
 ds_read_b64_tr_b16 v[6:7], v119 offset:25344
 ds_read_b64_tr_b16 v[86:87], v120 offset:25344
 ds_read_b64_tr_b16 v[8:9], v119 offset:30720
 ds_read_b64_tr_b16 v[88:89], v120 offset:30720
 ds_read_b64_tr_b16 v[10:11], v119 offset:31488
 ds_read_b64_tr_b16 v[90:91], v120 offset:31488
 ds_read_b64_tr_b16 v[12:13], v119 offset:36864
 ds_read_b64_tr_b16 v[92:93], v120 offset:36864
 ds_read_b64_tr_b16 v[14:15], v119 offset:37632
 ds_read_b64_tr_b16 v[94:95], v120 offset:37632
 ds_read_b64_tr_b16 v[16:17], v119 offset:43008
 ds_read_b64_tr_b16 v[96:97], v120 offset:43008
 ds_read_b64_tr_b16 v[18:19], v119 offset:43776
 ds_read_b64_tr_b16 v[98:99], v120 offset:43776
 ds_read_b64_tr_b16 v[20:21], v119 offset:49152
 ds_read_b64_tr_b16 v[100:101], v120 offset:49152
 ds_read_b64_tr_b16 v[22:23], v119 offset:49920
 ds_read_b64_tr_b16 v[102:103], v120 offset:49920
 ds_read_b64_tr_b16 v[24:25], v119 offset:55296
 ds_read_b64_tr_b16 v[104:105], v120 offset:55296
 ds_read_b64_tr_b16 v[26:27], v119 offset:56064
 ds_read_b64_tr_b16 v[106:107], v120 offset:56064
 s_branch Lpw_26
Lpwn_29:
 ds_read_b64_tr_b16 v[48:49], v119 offset:0
 ds_read_b64_tr_b16 v[50:51], v119 offset:768
 ds_read_b64_tr_b16 v[52:53], v119 offset:6144
 ds_read_b64_tr_b16 v[54:55], v119 offset:6912
 ds_read_b64_tr_b16 v[56:57], v119 offset:12288
 ds_read_b64_tr_b16 v[58:59], v119 offset:13056
 ds_read_b64_tr_b16 v[60:61], v119 offset:18432
 ds_read_b64_tr_b16 v[62:63], v119 offset:19200
 ds_read_b64_tr_b16 v[64:65], v119 offset:24576
 ds_read_b64_tr_b16 v[66:67], v119 offset:25344
 ds_read_b64_tr_b16 a[240:241], v119 offset:30720
 ds_read_b64_tr_b16 v[68:69], v120 offset:30720
 ds_read_b64_tr_b16 a[242:243], v119 offset:31488
 ds_read_b64_tr_b16 v[70:71], v120 offset:31488
 ds_read_b64_tr_b16 a[244:245], v119 offset:36864
 ds_read_b64_tr_b16 v[72:73], v120 offset:36864
 ds_read_b64_tr_b16 a[246:247], v119 offset:37632
 ds_read_b64_tr_b16 v[74:75], v120 offset:37632
 ds_read_b64_tr_b16 a[248:249], v119 offset:43008
 ds_read_b64_tr_b16 v[76:77], v120 offset:43008
 ds_read_b64_tr_b16 a[250:251], v119 offset:43776
 ds_read_b64_tr_b16 v[78:79], v120 offset:43776
 ds_read_b64_tr_b16 a[252:253], v119 offset:49152
 ds_read_b64_tr_b16 v[80:81], v120 offset:49152
 ds_read_b64_tr_b16 a[254:255], v119 offset:49920
 ds_read_b64_tr_b16 v[82:83], v120 offset:49920
 ds_read_b64_tr_b16 v[4:5], v119 offset:55296
 ds_read_b64_tr_b16 v[84:85], v120 offset:55296
 ds_read_b64_tr_b16 v[6:7], v119 offset:56064
 ds_read_b64_tr_b16 v[86:87], v120 offset:56064
Lpw_26:
 s_waitcnt lgkmcnt(0)
 s_barrier
 s_mov_b32 s20, s38
 s_mov_b32 s21, s39
 s_mov_b32 s22, 7864320
 s_mov_b32 s23, 0x20000
 s_mul_i32 s25, s3, 15360
 s_add_u32 s25, s25, 61440
 s_add_u32 s26, s30, 122880
 s_add_u32 m0, s25, 0
 s_add_u32 s27, s26, 0
 buffer_load_dwordx4 v110, s[20:23], s27 offen lds
 s_add_u32 m0, s25, 1024
 s_add_u32 s27, s26, 0
 buffer_load_dwordx4 v111, s[20:23], s27 offen lds
 s_add_u32 m0, s25, 2048
 s_add_u32 s27, s26, 0
 buffer_load_dwordx4 v112, s[20:23], s27 offen lds
 s_add_u32 m0, s25, 3072
 s_add_u32 s27, s26, 0
 buffer_load_dwordx4 v113, s[20:23], s27 offen lds
 s_add_u32 m0, s25, 4096
 s_add_u32 s27, s26, 0
 buffer_load_dwordx4 v114, s[20:23], s27 offen lds
 s_add_u32 m0, s25, 5120
 s_add_u32 s27, s26, 40960
 buffer_load_dwordx4 v110, s[20:23], s27 offen lds
 s_add_u32 m0, s25, 6144
 s_add_u32 s27, s26, 40960
 buffer_load_dwordx4 v111, s[20:23], s27 offen lds
 s_add_u32 m0, s25, 7168
 s_add_u32 s27, s26, 40960
 buffer_load_dwordx4 v112, s[20:23], s27 offen lds
 s_add_u32 m0, s25, 8192
 s_add_u32 s27, s26, 40960
 buffer_load_dwordx4 v113, s[20:23], s27 offen lds
 s_add_u32 m0, s25, 9216
 s_add_u32 s27, s26, 40960
 buffer_load_dwordx4 v114, s[20:23], s27 offen lds
 s_add_u32 m0, s25, 10240
 s_add_u32 s27, s26, 81920
 buffer_load_dwordx4 v110, s[20:23], s27 offen lds
 s_add_u32 m0, s25, 11264
 s_add_u32 s27, s26, 81920
 buffer_load_dwordx4 v111, s[20:23], s27 offen lds
 s_add_u32 m0, s25, 12288
 s_add_u32 s27, s26, 81920
 buffer_load_dwordx4 v112, s[20:23], s27 offen lds
 s_add_u32 m0, s25, 13312
 s_add_u32 s27, s26, 81920
 buffer_load_dwordx4 v113, s[20:23], s27 offen lds
 s_add_u32 m0, s25, 14336
 s_add_u32 s27, s26, 81920
 buffer_load_dwordx4 v114, s[20:23], s27 offen lds
 s_waitcnt vmcnt(15)
 s_barrier
 ds_read_b64_tr_b16 v[124:125], v121 offset:0
 ds_read_b64_tr_b16 v[126:127], v121 offset:10240
 ds_read_b64_tr_b16 v[128:129], v121 offset:8
 ds_read_b64_tr_b16 v[130:131], v121 offset:10248
 ds_read_b64_tr_b16 v[132:133], v121 offset:64
 ds_read_b64_tr_b16 v[134:135], v121 offset:10304
 ds_read_b64_tr_b16 v[136:137], v121 offset:72
 ds_read_b64_tr_b16 v[138:139], v121 offset:10312
 ds_read_b64_tr_b16 v[140:141], v122 offset:128
 ds_read_b64_tr_b16 v[142:143], v122 offset:10368
 ds_read_b64_tr_b16 v[144:145], v121 offset:2560
 ds_read_b64_tr_b16 v[146:147], v121 offset:12800
 ds_read_b64_tr_b16 v[148:149], v121 offset:2568
 ds_read_b64_tr_b16 v[150:151], v121 offset:12808
 ds_read_b64_tr_b16 v[152:153], v121 offset:2624
 ds_read_b64_tr_b16 v[154:155], v121 offset:12864
 ds_read_b64_tr_b16 v[156:157], v121 offset:2632
 ds_read_b64_tr_b16 v[158:159], v121 offset:12872
 ds_read_b64_tr_b16 v[160:161], v122 offset:2688
 ds_read_b64_tr_b16 v[162:163], v122 offset:12928
 ds_read_b64_tr_b16 v[164:165], v121 offset:5120
 ds_read_b64_tr_b16 v[166:167], v121 offset:7680
 ds_read_b64_tr_b16 v[168:169], v121 offset:5128
 ds_read_b64_tr_b16 v[170:171], v121 offset:7688
 ds_read_b64_tr_b16 v[172:173], v121 offset:5184
 ds_read_b64_tr_b16 v[174:175], v121 offset:7744
 ds_read_b64_tr_b16 v[176:177], v121 offset:5192
 ds_read_b64_tr_b16 v[178:179], v121 offset:7752
 ds_read_b64_tr_b16 v[180:181], v122 offset:5248
 ds_read_b64_tr_b16 v[182:183], v122 offset:7808
 s_waitcnt lgkmcnt(0)
 s_barrier
 ds_write_b128 v123, v[124:127] offset:0
 ds_write_b128 v123, v[128:131] offset:1024
 ds_write_b128 v123, v[132:135] offset:2048
 ds_write_b128 v123, v[136:139] offset:3072
 ds_write_b128 v123, v[140:143] offset:4096
 ds_write_b128 v123, v[144:147] offset:5120
 ds_write_b128 v123, v[148:151] offset:6144
 ds_write_b128 v123, v[152:155] offset:7168
 ds_write_b128 v123, v[156:159] offset:8192
 ds_write_b128 v123, v[160:163] offset:9216
 ds_write_b128 v123, v[164:167] offset:10240
 ds_write_b128 v123, v[168:171] offset:11264
 ds_write_b128 v123, v[172:175] offset:12288
 ds_write_b128 v123, v[176:179] offset:13312
 ds_write_b128 v123, v[180:183] offset:14336
 s_waitcnt vmcnt(0)
 s_barrier
 v_add_u32 v121, 61440, v121
 v_add_u32 v122, 61440, v122
 v_add_u32 v123, 61440, v123
 ds_read_b64_tr_b16 v[124:125], v121 offset:0
 ds_read_b64_tr_b16 v[126:127], v121 offset:10240
 ds_read_b64_tr_b16 v[128:129], v121 offset:8
 ds_read_b64_tr_b16 v[130:131], v121 offset:10248
 ds_read_b64_tr_b16 v[132:133], v121 offset:64
 ds_read_b64_tr_b16 v[134:135], v121 offset:10304
 ds_read_b64_tr_b16 v[136:137], v121 offset:72
 ds_read_b64_tr_b16 v[138:139], v121 offset:10312
 ds_read_b64_tr_b16 v[140:141], v122 offset:128
 ds_read_b64_tr_b16 v[142:143], v122 offset:10368
 ds_read_b64_tr_b16 v[144:145], v121 offset:2560
 ds_read_b64_tr_b16 v[146:147], v121 offset:12800
 ds_read_b64_tr_b16 v[148:149], v121 offset:2568
 ds_read_b64_tr_b16 v[150:151], v121 offset:12808
 ds_read_b64_tr_b16 v[152:153], v121 offset:2624
 ds_read_b64_tr_b16 v[154:155], v121 offset:12864
 ds_read_b64_tr_b16 v[156:157], v121 offset:2632
 ds_read_b64_tr_b16 v[158:159], v121 offset:12872
 ds_read_b64_tr_b16 v[160:161], v122 offset:2688
 ds_read_b64_tr_b16 v[162:163], v122 offset:12928
 ds_read_b64_tr_b16 v[164:165], v121 offset:5120
 ds_read_b64_tr_b16 v[166:167], v121 offset:7680
 ds_read_b64_tr_b16 v[168:169], v121 offset:5128
 ds_read_b64_tr_b16 v[170:171], v121 offset:7688
 ds_read_b64_tr_b16 v[172:173], v121 offset:5184
 ds_read_b64_tr_b16 v[174:175], v121 offset:7744
 ds_read_b64_tr_b16 v[176:177], v121 offset:5192
 ds_read_b64_tr_b16 v[178:179], v121 offset:7752
 ds_read_b64_tr_b16 v[180:181], v122 offset:5248
 ds_read_b64_tr_b16 v[182:183], v122 offset:7808
 s_waitcnt lgkmcnt(0)
 s_barrier
 ds_write_b128 v123, v[124:127] offset:0
 ds_write_b128 v123, v[128:131] offset:1024
 ds_write_b128 v123, v[132:135] offset:2048
 ds_write_b128 v123, v[136:139] offset:3072
 ds_write_b128 v123, v[140:143] offset:4096
 ds_write_b128 v123, v[144:147] offset:5120
 ds_write_b128 v123, v[148:151] offset:6144
 ds_write_b128 v123, v[152:155] offset:7168
 ds_write_b128 v123, v[156:159] offset:8192
 ds_write_b128 v123, v[160:163] offset:9216
 ds_write_b128 v123, v[164:167] offset:10240
 ds_write_b128 v123, v[168:171] offset:11264
 ds_write_b128 v123, v[172:175] offset:12288
 ds_write_b128 v123, v[176:179] offset:13312
 ds_write_b128 v123, v[180:183] offset:14336
 s_waitcnt lgkmcnt(0)
 s_cmp_eq_u32 s13, 1
 s_cbranch_scc1 Lverok_32
 s_mov_b32 s18, 0
Lver_31:
 s_add_u32 s18, s18, 1
 s_cmp_gt_u32 s18, 200000
 s_cbranch_scc1 L_fail
 v_and_b32 v254, 7, v0
 v_lshlrev_b32 v254, 2, v254
 buffer_load_dword v255, v254, s[8:11], 0 offen sc1
 s_waitcnt vmcnt(0)
 v_cmp_eq_u32 vcc, 32, v255
 s_nop 0
 s_cmp_eq_u64 vcc, -1
 s_cbranch_scc1 Lverok_32
 s_mov_b32 s17, 0
 v_readlane_b32 s14, v255, 0
 s_nop 0
 s_add_u32 s17, s17, s14
 v_readlane_b32 s14, v255, 1
 s_nop 0
 s_add_u32 s17, s17, s14
 v_readlane_b32 s14, v255, 2
 s_nop 0
 s_add_u32 s17, s17, s14
 v_readlane_b32 s14, v255, 3
 s_nop 0
 s_add_u32 s17, s17, s14
 v_readlane_b32 s14, v255, 4
 s_nop 0
 s_add_u32 s17, s17, s14
 v_readlane_b32 s14, v255, 5
 s_nop 0
 s_add_u32 s17, s17, s14
 v_readlane_b32 s14, v255, 6
 s_nop 0
 s_add_u32 s17, s17, s14
 v_readlane_b32 s14, v255, 7
 s_nop 0
 s_add_u32 s17, s17, s14
 s_cmp_eq_u32 s17, 256
 s_cbranch_scc1 L_fallback
 s_branch Lver_31
Lverok_32:
 s_mov_b32 s71, 0x3dd53b95
 v_add_u32 v3, 122880, v2
 v_lshlrev_b32 v117, 3, v1
 v_add_u32 v117, 153600, v117
 s_mul_i32 s25, s3, 5120
 s_mul_i32 s26, s24, 81920
 s_add_u32 s26, s26, 655360
 s_add_u32 s42, s25, s26
 s_add_u32 s25, s3, 0
 s_and_b32 s25, s25, 3
 s_mul_i32 s25, s25, 5120
 v_add_u32 v108, s25, v3
 s_add_u32 s25, s3, 1
 s_and_b32 s25, s25, 3
 s_mul_i32 s25, s25, 5120
 v_add_u32 v109, s25, v3
 s_add_u32 s25, s3, 2
 s_and_b32 s25, s25, 3
 s_mul_i32 s25, s25, 5120
 v_add_u32 v110, s25, v3
 s_add_u32 s25, s3, 3
 s_and_b32 s25, s25, 3
 s_mul_i32 s25, s25, 5120
 v_add_u32 v111, s25, v3
 s_bitcmp1_b32 s3, 0
 s_mov_b32 s26, 20480
 s_cselect_b32 s25, 21512, s26
 s_lshr_b32 s26, s3, 1
 s_mul_i32 s26, s26, 3072
 s_add_u32 s25, s25, s26
 v_add_u32 v112, s25, v3
 s_bitcmp1_b32 s3, 0
 s_mov_b32 s26, 20488
 s_cselect_b32 s25, 22528, s26
 s_lshr_b32 s26, s3, 1
 s_mul_i32 s26, s26, 3072
 s_add_u32 s25, s25, s26
 v_add_u32 v113, s25, v3
 s_and_b32 s28, s3, 1
 s_lshl_b32 s26, s28, 10
 v_add_u32 v116, s26, v3
 s_mul_i32 s25, s12, 3072
 s_add_u32 s44, s25, 262144
 s_xor_b32 s26, s12, 1
 s_mul_i32 s26, s26, 3072
 s_add_u32 s45, s26, 262144
 s_min_u32 s26, s3, 2
 s_lshl_b32 s26, s26, 10
 s_add_u32 s26, s26, s25
 s_cmp_eq_u32 s3, 3
 s_cselect_b32 s27, 8, 0
 s_add_u32 s26, s26, s27
 s_add_u32 s54, s26, 2129920
 s_lshr_b32 s26, s12, 3
 s_lshl_b32 s26, s26, 2
 s_add_u32 s26, s26, s3
 s_mul_i32 s26, s26, 6144
 s_add_u32 s55, s26, 2129920
 s_mul_i32 s26, s3, 15360
 v_add_u32 v114, s26, v2
 v_add_u32 v115, 61440, v114
 v_lshrrev_b32 v127, 4, v1
 v_and_b32 v190, 15, v1
 s_lshl_b32 s26, s3, 8
 s_add_u32 s26, s26, 122880
 v_lshl_add_u32 v119, v190, 4, s26
 v_lshl_add_u32 v118, v127, 10, v119
 v_lshrrev_b32 v191, 5, v1
 v_lshl_add_u32 v119, v191, 10, v119
 v_bfe_u32 v126, v1, 4, 1
 v_lshl_add_u32 v119, v126, 3, v119
 v_lshlrev_b32 v120, 10, v191
 v_lshl_add_u32 v120, v190, 4, v120
 v_lshl_add_u32 v120, v126, 11, v120
 s_and_b32 s26, s12, 7
 s_mul_i32 s26, s26, 10240
 s_bfe_u32 s27, s12, 0x20003
 s_lshl_b32 s27, s27, 8
 s_add_u32 s26, s26, s27
 s_mul_i32 s27, s24, 81920
 s_add_u32 s26, s26, s27
 s_add_u32 s26, s26, 819200
 s_and_b32 s27, s3, 1
 s_lshl_b32 s27, s27, 12
 s_add_u32 s46, s26, s27
 s_lshl_b32 s25, s3, 5
 s_add_u32 s25, s25, s19
 s_lshl_b32 s25, s25, 1
 s_cmp_lt_u32 s25, 80
 s_cselect_b32 s40, 1, 0
 s_cselect_b32 s25, s25, 0
 s_lshl_b32 s26, s25, 10
 s_mul_i32 s27, s24, 81920
 s_add_u32 s47, s26, s27
 s_add_u32 s47, s47, 1474560
 s_sub_u32 s48, s26, s27
 s_add_u32 s48, s48, 901120
 s_lshl_b32 s26, s25, 8
 s_mul_i32 s27, s24, 81920
 s_add_u32 s26, s26, s27
 s_add_u32 s43, s26, 655360
 v_lshlrev_b32 v121, 4, v190
 v_lshl_add_u32 v121, v126, 3, v121
 v_lshl_add_u32 v121, v191, 8, v121
 s_load_dwordx2 s[32:33], s[0:1], 8
 v_and_b32 v191, 7, v1
 v_mul_u32_u24 v191, 1280, v191
 v_lshl_add_u32 v191, v127, 3, v191
 s_lshl_b32 s26, s25, 4
 v_add_u32 v191, s26, v191
 s_waitcnt lgkmcnt(0)
 s_mov_b32 s20, s32
 s_mov_b32 s21, s33
 s_mov_b32 s22, 10240
 s_mov_b32 s23, 0x20000
 buffer_load_dwordx2 v[128:129], v191, s[20:23], 0 offen
 s_mul_i32 s25, s12, 6144
 s_lshl_b32 s27, s28, 10
 s_add_u32 s49, s27, s25
 s_lshl_b32 s27, s3, 10
 s_add_u32 s50, s27, s25
 s_add_u32 s27, s28, 4
 s_lshl_b32 s27, s27, 10
 s_add_u32 s51, s27, s25
 s_mul_i32 s25, s12, 3072
 s_add_u32 s52, s25, 2523136
 s_lshl_b32 s53, s12, 7
 s_add_u32 s53, s53, 131072
 s_mul_i32 s25, s12, 96
 v_and_b32 v124, 3, v1
 v_mul_u32_u24 v124, 48, v124
 v_min_u32 v124, 95, v124
 v_add_u32 v124, s25, v124
 v_lshrrev_b32 v124, 6, v124
 v_bfe_u32 v126, v1, 2, 1
 v_add_u32 v126, 1, v126
 v_mul_u32_u24 v126, 96, v126
 v_add_u32 v124, v126, v124
 v_bfe_u32 v126, v1, 3, 1
 v_lshl_add_u32 v124, v126, 9, v124
 v_lshlrev_b32 v124, 7, v124
 v_add_u32 v124, 0, v124
 v_mul_u32_u24 v125, 9, v126
 v_sub_u32 v125, 1, v125
 v_min_u32 v122, 9, v1
 v_lshlrev_b32 v122, 9, v122
 v_and_b32 v123, 3, v1
 v_min_u32 v191, 2, v123
 v_sub_u32 v123, v123, v191
 v_lshlrev_b32 v123, 3, v123
 v_lshl_add_u32 v123, v191, 10, v123
 v_bfe_u32 v191, v1, 2, 1
 v_mul_u32_u24 v191, 3072, v191
 v_add_u32 v123, v123, v191
 v_lshrrev_b32 v191, 5, v1
 v_bfe_u32 v126, v1, 3, 1
 v_cmp_eq_u32 vcc, v191, v126
 v_mov_b32 v191, 0xf149f2ca
 s_nop 0
 v_cndmask_b32 v158, v191, 0, vcc
 v_mov_b32 v159, v158
 v_mov_b32 v160, v158
 v_mov_b32 v161, v158
 v_mov_b32 v162, 0
 v_mov_b32 v166, 0
 v_mov_b32 v182, -1
 v_mov_b32 v186, 0x3f803f80
 v_mov_b32 v178, 0
 v_mov_b32 v170, 0
 v_mov_b32 v191, 0x3f80
 v_cmp_eq_u32 vcc, 0, v190
 s_nop 1
 v_cndmask_b32 v170, v170, v191, vcc
 v_mov_b32 v191, 0x3f800000
 v_cmp_eq_u32 vcc, 1, v190
 s_nop 1
 v_cndmask_b32 v170, v170, v191, vcc
 v_mov_b32 v174, 0
 v_mov_b32 v191, 0x3f80
 v_cmp_eq_u32 vcc, 8, v190
 s_nop 1
 v_cndmask_b32 v174, v174, v191, vcc
 v_mov_b32 v191, 0x3f800000
 v_cmp_eq_u32 vcc, 9, v190
 s_nop 1
 v_cndmask_b32 v174, v174, v191, vcc
 v_mov_b32 v163, 0
 v_mov_b32 v167, 0
 v_mov_b32 v183, -1
 v_mov_b32 v187, 0x3f803f80
 v_mov_b32 v179, 0
 v_mov_b32 v171, 0
 v_mov_b32 v191, 0x3f80
 v_cmp_eq_u32 vcc, 2, v190
 s_nop 1
 v_cndmask_b32 v171, v171, v191, vcc
 v_mov_b32 v191, 0x3f800000
 v_cmp_eq_u32 vcc, 3, v190
 s_nop 1
 v_cndmask_b32 v171, v171, v191, vcc
 v_mov_b32 v175, 0
 v_mov_b32 v191, 0x3f80
 v_cmp_eq_u32 vcc, 10, v190
 s_nop 1
 v_cndmask_b32 v175, v175, v191, vcc
 v_mov_b32 v191, 0x3f800000
 v_cmp_eq_u32 vcc, 11, v190
 s_nop 1
 v_cndmask_b32 v175, v175, v191, vcc
 v_mov_b32 v164, 0
 v_mov_b32 v168, 0
 v_mov_b32 v184, -1
 v_mov_b32 v188, 0x3f803f80
 v_mov_b32 v180, 0
 v_mov_b32 v172, 0
 v_mov_b32 v191, 0x3f80
 v_cmp_eq_u32 vcc, 4, v190
 s_nop 1
 v_cndmask_b32 v172, v172, v191, vcc
 v_mov_b32 v191, 0x3f800000
 v_cmp_eq_u32 vcc, 5, v190
 s_nop 1
 v_cndmask_b32 v172, v172, v191, vcc
 v_mov_b32 v176, 0
 v_mov_b32 v191, 0x3f80
 v_cmp_eq_u32 vcc, 12, v190
 s_nop 1
 v_cndmask_b32 v176, v176, v191, vcc
 v_mov_b32 v191, 0x3f800000
 v_cmp_eq_u32 vcc, 13, v190
 s_nop 1
 v_cndmask_b32 v176, v176, v191, vcc
 v_mov_b32 v165, 0
 v_mov_b32 v169, 0
 v_mov_b32 v185, -1
 v_mov_b32 v189, 0x3f803f80
 v_mov_b32 v181, 0
 v_mov_b32 v173, 0
 v_mov_b32 v191, 0x3f80
 v_cmp_eq_u32 vcc, 6, v190
 s_nop 1
 v_cndmask_b32 v173, v173, v191, vcc
 v_mov_b32 v191, 0x3f800000
 v_cmp_eq_u32 vcc, 7, v190
 s_nop 1
 v_cndmask_b32 v173, v173, v191, vcc
 v_mov_b32 v177, 0
 v_mov_b32 v191, 0x3f80
 v_cmp_eq_u32 vcc, 14, v190
 s_nop 1
 v_cndmask_b32 v177, v177, v191, vcc
 v_mov_b32 v191, 0x3f800000
 v_cmp_eq_u32 vcc, 15, v190
 s_nop 1
 v_cndmask_b32 v177, v177, v191, vcc
 s_mov_b32 s31, 0
 s_mov_b32 s41, 0
 v_min_i32 v1, 64, v125
Lfl_33:
 s_add_u32 s41, s41, 1
 s_cmp_gt_u32 s41, 200000
 s_cbranch_scc1 L_fail
 buffer_load_dword v126, v124, s[4:7], 0 offen sc1
 s_waitcnt vmcnt(0)
 v_cmp_ge_i32 vcc, v126, v1
 s_nop 0
 s_cmp_eq_u64 vcc, -1
 s_cbranch_scc0 Lfl_33
Lflok_34:
 v_add_u32 v125, 1, v125
 s_add_u32 s25, s31, 0
 s_mul_i32 s67, s25, 393216
 s_add_u32 s67, s67, 84312064
 s_cmp_lt_u32 s25, 64
 s_cselect_b32 s67, s67, 2146435072
 s_sub_u32 s26, s25, 9
 s_mul_i32 s68, s26, 393216
 s_add_u32 s68, s68, 134643712
 s_cmp_lt_u32 s26, 64
 s_cselect_b32 s68, s68, 2146435072
 s_add_u32 s25, s67, 4269801472
 s_add_u32 s26, s68, 4269801472
 s_cmp_lt_u32 s3, 2
 s_cselect_b32 s66, s25, s26
 s_add_u32 s66, s66, s49
 buffer_load_dwordx4 v[130:133], v2, s[4:7], s66 offen sc1
 buffer_load_dwordx4 v[134:137], v2, s[4:7], s66 offen offset:2048 sc1
 s_add_u32 s25, s66, 4096
 buffer_load_dwordx4 v[138:141], v2, s[4:7], s25 offen sc1
 s_add_u32 s69, s31, 0
 s_and_b32 s25, s69, 3
 s_mul_i32 s26, s25, 20480
 s_add_u32 s56, s26, s42
 s_add_u32 s57, s56, 4096
 s_add_u32 s58, s26, s43
 s_mul_i32 s62, s25, 163840
 s_xor_b32 s26, s25, 2
 s_mul_i32 s63, s26, 163840
 s_add_u32 s25, s25, 3
 s_and_b32 s25, s25, 3
 s_mul_i32 s26, s25, 20480
 s_add_u32 s59, s26, s43
 s_and_b32 s25, s69, 1
 s_mul_i32 s60, s25, 196608
 s_xor_b32 s25, s25, 1
 s_mul_i32 s61, s25, 196608
 s_mul_i32 s69, s69, 196608
 s_mov_b32 s70, 2146435072
 s_cmp_eq_u32 s13, 0
 s_cbranch_scc0 L_rec_remote
 s_cmp_eq_u32 s3, 0
 s_cbranch_scc0 Lpwn_36
 s_waitcnt vmcnt(0)
 s_cmp_eq_u32 s40, 0
 s_cbranch_scc1 Lz0_37
 buffer_store_dwordx2 v[128:129], v121, s[4:7], s43 offen
Lz0_37:
 s_barrier
L_rec_top_0l:
 s_mov_b32 s41, 0
 s_sleep 2
 buffer_load_dwordx4 v[190:193], v2, s[4:7], s56 offen offset:0 sc1
 s_nop 11
 buffer_load_dwordx4 v[194:197], v2, s[4:7], s56 offen offset:1024 sc1
 s_nop 11
 buffer_load_dwordx4 v[198:201], v2, s[4:7], s56 offen offset:2048 sc1
 s_nop 11
 buffer_load_dwordx4 v[202:205], v2, s[4:7], s56 offen offset:3072 sc1
 s_nop 11
 buffer_load_dwordx4 v[206:209], v2, s[4:7], s57 offen offset:0 sc1
Lz_38:
 s_waitcnt vmcnt(4)
 ds_write_b128 v108, v[190:193] offset:0
 v_mfma_f32_16x16x32_bf16 v[226:229], a[0:3], v[190:193], 0
 v_max3_u32 v1, v190, v191, v192
 v_max_u32 v1, v1, v193
 v_mfma_f32_16x16x32_bf16 v[230:233], a[80:83], v[190:193], 0
 v_cmp_eq_u32 vcc, -1, v1
 v_mfma_f32_16x16x32_bf16 v[234:237], a[160:163], v[190:193], 0
 s_cbranch_vccnz Lzs_39
Lz_40:
 s_waitcnt vmcnt(3)
 ds_write_b128 v108, v[194:197] offset:1024
 v_max3_u32 v1, v194, v195, v196
 v_max_u32 v1, v1, v197
 v_cmp_eq_u32 vcc, -1, v1
 s_cbranch_vccnz Lzs_41
 v_mfma_f32_16x16x32_bf16 v[226:229], a[4:7], v[194:197], v[226:229]
 v_mfma_f32_16x16x32_bf16 v[230:233], a[84:87], v[194:197], v[230:233]
 v_mfma_f32_16x16x32_bf16 v[234:237], a[164:167], v[194:197], v[234:237]
Lz_42:
 s_waitcnt vmcnt(2)
 ds_write_b128 v108, v[198:201] offset:2048
 v_max3_u32 v1, v198, v199, v200
 v_max_u32 v1, v1, v201
 v_cmp_eq_u32 vcc, -1, v1
 s_cbranch_vccnz Lzs_43
 v_mfma_f32_16x16x32_bf16 v[226:229], a[8:11], v[198:201], v[226:229]
 v_mfma_f32_16x16x32_bf16 v[230:233], a[88:91], v[198:201], v[230:233]
 v_mfma_f32_16x16x32_bf16 v[234:237], a[168:171], v[198:201], v[234:237]
Lz_44:
 s_waitcnt vmcnt(1)
 ds_write_b128 v108, v[202:205] offset:3072
 v_max3_u32 v1, v202, v203, v204
 v_max_u32 v1, v1, v205
 v_cmp_eq_u32 vcc, -1, v1
 s_cbranch_vccnz Lzs_45
Lz_46:
 s_waitcnt vmcnt(0)
 ds_write_b128 v108, v[206:209] offset:4096
 v_max3_u32 v1, v206, v207, v208
 v_max_u32 v1, v1, v209
 v_cmp_eq_u32 vcc, -1, v1
 s_cbranch_vccnz Lzs_47
 s_waitcnt lgkmcnt(0)
 s_barrier
 ds_read_b128 v[214:217], v109 offset:0
 ds_read_b128 v[218:221], v109 offset:1024
 ds_read_b128 v[222:225], v109 offset:2048
 v_mfma_f32_16x16x32_bf16 v[226:229], a[12:15], v[202:205], v[226:229]
 buffer_load_dword v126, v124, s[4:7], 0 offen sc1
 v_mfma_f32_16x16x32_bf16 v[230:233], a[92:95], v[202:205], v[230:233]
 v_mfma_f32_16x16x32_bf16 v[234:237], a[172:175], v[202:205], v[234:237]
 v_mfma_f32_16x16x32_bf16 v[226:229], a[16:19], v[206:209], v[226:229]
 s_add_u32 s25, s67, s50
 v_mfma_f32_16x16x32_bf16 v[230:233], a[96:99], v[206:209], v[230:233]
 buffer_load_dwordx4 v[142:145], v2, s[4:7], s25 offen sc1
 v_mfma_f32_16x16x32_bf16 v[234:237], a[176:179], v[206:209], v[234:237]
 ds_read_b128 v[210:213], v109 offset:3072
 s_waitcnt lgkmcnt(3)
 v_mfma_f32_16x16x32_bf16 v[226:229], a[20:23], v[214:217], v[226:229]
 s_add_u32 s25, s67, s51
 v_mfma_f32_16x16x32_bf16 v[230:233], a[100:103], v[214:217], v[230:233]
 buffer_load_dwordx4 v[146:149], v2, s[4:7], s25 offen sc1
 v_mfma_f32_16x16x32_bf16 v[234:237], a[180:183], v[214:217], v[234:237]
 ds_read_b128 v[214:217], v109 offset:4096
 s_waitcnt lgkmcnt(3)
 v_mfma_f32_16x16x32_bf16 v[226:229], a[24:27], v[218:221], v[226:229]
 s_add_u32 s25, s68, s50
 v_mfma_f32_16x16x32_bf16 v[230:233], a[104:107], v[218:221], v[230:233]
 buffer_load_dwordx4 v[150:153], v2, s[4:7], s25 offen sc1
 v_mfma_f32_16x16x32_bf16 v[234:237], a[184:187], v[218:221], v[234:237]
 ds_read_b128 v[218:221], v110 offset:0
 s_waitcnt lgkmcnt(3)
 v_mfma_f32_16x16x32_bf16 v[226:229], a[28:31], v[222:225], v[226:229]
 s_add_u32 s25, s68, s51
 v_mfma_f32_16x16x32_bf16 v[230:233], a[108:111], v[222:225], v[230:233]
 buffer_load_dwordx4 v[154:157], v2, s[4:7], s25 offen sc1
 v_mfma_f32_16x16x32_bf16 v[234:237], a[188:191], v[222:225], v[234:237]
 ds_read_b128 v[222:225], v110 offset:1024
 s_waitcnt lgkmcnt(3)
 v_mfma_f32_16x16x32_bf16 v[226:229], a[32:35], v[210:213], v[226:229]
 s_add_u32 s25, s44, s61
 v_mfma_f32_16x16x32_bf16 v[230:233], a[112:115], v[210:213], v[230:233]
 s_add_u32 s25, s25, 0
 v_mfma_f32_16x16x32_bf16 v[234:237], a[192:195], v[210:213], v[234:237]
 buffer_store_dwordx4 v[182:185], v2, s[4:7], s25 offen offset:0
 ds_read_b128 v[210:213], v110 offset:2048
 s_waitcnt lgkmcnt(3)
 v_mfma_f32_16x16x32_bf16 v[226:229], a[36:39], v[214:217], v[226:229]
 s_add_u32 s25, s44, s61
 v_mfma_f32_16x16x32_bf16 v[230:233], a[116:119], v[214:217], v[230:233]
 s_add_u32 s25, s25, 0
 v_mfma_f32_16x16x32_bf16 v[234:237], a[196:199], v[214:217], v[234:237]
 buffer_store_dwordx4 v[182:185], v2, s[4:7], s25 offen offset:1024
 ds_read_b128 v[214:217], v110 offset:3072
 s_waitcnt lgkmcnt(3)
 v_mfma_f32_16x16x32_bf16 v[226:229], a[40:43], v[218:221], v[226:229]
 s_add_u32 s25, s44, s61
 v_mfma_f32_16x16x32_bf16 v[230:233], a[120:123], v[218:221], v[230:233]
 s_add_u32 s25, s25, 0
 v_mfma_f32_16x16x32_bf16 v[234:237], a[200:203], v[218:221], v[234:237]
 buffer_store_dwordx4 v[182:185], v2, s[4:7], s25 offen offset:2048
 ds_read_b128 v[218:221], v110 offset:4096
 s_waitcnt lgkmcnt(3)
 v_mfma_f32_16x16x32_bf16 v[226:229], a[44:47], v[222:225], v[226:229]
 s_add_u32 s25, s31, 1
 s_mul_i32 s67, s25, 393216
 v_mfma_f32_16x16x32_bf16 v[230:233], a[124:127], v[222:225], v[230:233]
 s_add_u32 s67, s67, 84312064
 s_cmp_lt_u32 s25, 64
 v_mfma_f32_16x16x32_bf16 v[234:237], a[204:207], v[222:225], v[234:237]
 s_cselect_b32 s67, s67, 2146435072
 ds_read_b128 v[222:225], v111 offset:0
 s_waitcnt lgkmcnt(3)
 v_mfma_f32_16x16x32_bf16 v[226:229], a[48:51], v[210:213], v[226:229]
 s_sub_u32 s26, s25, 9
 s_mul_i32 s68, s26, 393216
 v_mfma_f32_16x16x32_bf16 v[230:233], a[128:131], v[210:213], v[230:233]
 s_add_u32 s68, s68, 134643712
 s_cmp_lt_u32 s26, 64
 v_mfma_f32_16x16x32_bf16 v[234:237], a[208:211], v[210:213], v[234:237]
 s_cselect_b32 s68, s68, 2146435072
 ds_read_b128 v[210:213], v111 offset:1024
 s_waitcnt lgkmcnt(3)
 v_mfma_f32_16x16x32_bf16 v[226:229], a[52:55], v[214:217], v[226:229]
 s_add_u32 s25, s67, 4269801472
 s_add_u32 s26, s68, 4269801472
 v_mfma_f32_16x16x32_bf16 v[230:233], a[132:135], v[214:217], v[230:233]
 s_cmp_lt_u32 s3, 2
 s_cselect_b32 s66, s25, s26
 v_mfma_f32_16x16x32_bf16 v[234:237], a[212:215], v[214:217], v[234:237]
 s_add_u32 s66, s66, s49
 ds_read_b128 v[214:217], v111 offset:2048
 s_waitcnt lgkmcnt(3)
 v_mfma_f32_16x16x32_bf16 v[226:229], a[56:59], v[218:221], v[226:229]
 v_mfma_f32_16x16x32_bf16 v[230:233], a[136:139], v[218:221], v[230:233]
 v_mfma_f32_16x16x32_bf16 v[234:237], a[216:219], v[218:221], v[234:237]
 ds_read_b128 v[218:221], v111 offset:3072
 s_waitcnt lgkmcnt(3)
 v_mfma_f32_16x16x32_bf16 v[226:229], a[60:63], v[222:225], v[226:229]
 v_mfma_f32_16x16x32_bf16 v[230:233], a[140:143], v[222:225], v[230:233]
 v_mfma_f32_16x16x32_bf16 v[234:237], a[220:223], v[222:225], v[234:237]
 ds_read_b128 v[222:225], v111 offset:4096
 s_waitcnt lgkmcnt(3)
 v_mfma_f32_16x16x32_bf16 v[226:229], a[64:67], v[210:213], v[226:229]
 v_mfma_f32_16x16x32_bf16 v[230:233], a[144:147], v[210:213], v[230:233]
 v_mfma_f32_16x16x32_bf16 v[234:237], a[224:227], v[210:213], v[234:237]
 s_waitcnt lgkmcnt(2)
 v_mfma_f32_16x16x32_bf16 v[226:229], a[68:71], v[214:217], v[226:229]
 v_mfma_f32_16x16x32_bf16 v[230:233], a[148:151], v[214:217], v[230:233]
 v_mfma_f32_16x16x32_bf16 v[234:237], a[228:231], v[214:217], v[234:237]
 s_waitcnt lgkmcnt(1)
 v_mfma_f32_16x16x32_bf16 v[226:229], a[72:75], v[218:221], v[226:229]
 v_mfma_f32_16x16x32_bf16 v[230:233], a[152:155], v[218:221], v[230:233]
 v_mfma_f32_16x16x32_bf16 v[234:237], a[232:235], v[218:221], v[234:237]
 s_waitcnt lgkmcnt(0)
 v_mfma_f32_16x16x32_bf16 v[226:229], a[76:79], v[222:225], v[226:229]
 v_mfma_f32_16x16x32_bf16 v[230:233], a[156:159], v[222:225], v[230:233]
 v_mfma_f32_16x16x32_bf16 v[234:237], a[236:239], v[222:225], v[234:237]
 s_nop 1
 v_cvt_pk_bf16_f32 v190, v226, v227
 v_cvt_pk_bf16_f32 v191, v228, v229
 ds_write_b64 v112, v[190:191] offset:0
 v_cvt_pk_bf16_f32 v192, v230, v231
 v_cvt_pk_bf16_f32 v193, v232, v233
 ds_write_b64 v113, v[192:193] offset:0
 v_cvt_pk_bf16_f32 v194, v234, v235
 v_cvt_pk_bf16_f32 v195, v236, v237
 ds_write_b64 v112, v[194:195] offset:1024
 s_add_u32 s26, s60, s44
 s_add_u32 s27, s60, s45
 s_waitcnt lgkmcnt(0)
 s_barrier
 ds_read_b128 v[198:201], v3 offset:20480
 ds_read_b128 v[202:205], v3 offset:21504
 ds_read_b128 v[206:209], v3 offset:22528
 ds_read_b128 v[226:229], v3 offset:23552
 ds_read_b128 v[230:233], v3 offset:24576
 ds_read_b128 v[234:237], v3 offset:25600
 ds_read_b128 v[210:213], v108 offset:0
 ds_read_b128 v[214:217], v108 offset:1024
 ds_read_b128 v[218:221], v108 offset:2048
 s_waitcnt lgkmcnt(8)
 v_mfma_f32_16x16x32_bf16 v[194:197], v[130:133], v[198:201], 0
 s_waitcnt lgkmcnt(7)
 v_mfma_f32_16x16x32_bf16 v[194:197], v[134:137], v[202:205], v[194:197]
 s_waitcnt lgkmcnt(6)
 v_mfma_f32_16x16x32_bf16 v[194:197], v[138:141], v[206:209], v[194:197]
 s_waitcnt lgkmcnt(5)
 v_mfma_f32_16x16x32_bf16 v[190:193], v[226:229], v[198:201], v[158:161]
 s_waitcnt lgkmcnt(4)
 v_mfma_f32_16x16x32_bf16 v[190:193], v[230:233], v[202:205], v[190:193]
 s_mov_b32 exec_lo, 0x00ff00ff
 s_mov_b32 exec_hi, 0x00ff00ff
 s_waitcnt lgkmcnt(3)
 v_mfma_f32_16x16x32_bf16 v[190:193], v[234:237], v[206:209], v[190:193]
 buffer_store_dwordx4 v[194:197], v2, s[4:7], s26 offen offset:0
 ds_write_b128 v116, v[194:197] offset:26624
 s_mov_b64 exec, -1
 ds_read_b128 v[222:225], v108 offset:3072
 s_waitcnt lgkmcnt(4)
 v_mfma_f32_16x16x32_bf16 v[226:229], v[210:213], a[240:243], 0
 v_mfma_f32_16x16x32_bf16 v[230:233], v[210:213], v[68:71], 0
 ds_read_b128 v[210:213], v108 offset:4096
 s_waitcnt lgkmcnt(4)
 v_mfma_f32_16x16x32_bf16 v[226:229], v[214:217], a[244:247], v[226:229]
 v_mfma_f32_16x16x32_bf16 v[230:233], v[214:217], v[72:75], v[230:233]
 ds_read_b128 v[214:217], v109 offset:0
 s_waitcnt lgkmcnt(4)
 v_mfma_f32_16x16x32_bf16 v[226:229], v[218:221], a[248:251], v[226:229]
 v_mfma_f32_16x16x32_bf16 v[230:233], v[218:221], v[76:79], v[230:233]
 ds_read_b128 v[218:221], v109 offset:1024
 s_waitcnt lgkmcnt(3)
 v_mfma_f32_16x16x32_bf16 v[226:229], v[222:225], a[252:255], v[226:229]
 v_mfma_f32_16x16x32_bf16 v[230:233], v[222:225], v[80:83], v[230:233]
 s_waitcnt vmcnt(8)
 s_mov_b32 s41, 0
 v_min_i32 v1, 64, v125
 v_cmp_ge_i32 vcc, v126, v1
 s_nop 0
 s_cmp_eq_u64 vcc, -1
 s_cbranch_scc1 Lflok_49
Lfl_48:
 s_add_u32 s41, s41, 1
 s_cmp_gt_u32 s41, 200000
 s_cbranch_scc1 L_fail
 buffer_load_dword v126, v124, s[4:7], 0 offen sc1
 s_waitcnt vmcnt(0)
 v_cmp_ge_i32 vcc, v126, v1
 s_nop 0
 s_cmp_eq_u64 vcc, -1
 s_cbranch_scc0 Lfl_48
Lflok_49:
 v_add_u32 v125, 1, v125
 ds_read_b128 v[222:225], v109 offset:2048
 s_waitcnt lgkmcnt(3)
 v_mfma_f32_16x16x32_bf16 v[226:229], v[210:213], v[4:7], v[226:229]
 v_mfma_f32_16x16x32_bf16 v[230:233], v[210:213], v[84:87], v[230:233]
 s_barrier
 ds_read_b128 v[234:237], v3 offset:26624
 ds_read_b128 v[238:241], v3 offset:27648
 ds_read_b128 v[210:213], v109 offset:3072
 s_waitcnt lgkmcnt(5)
 v_mfma_f32_16x16x32_bf16 v[226:229], v[214:217], v[8:11], v[226:229]
 v_mfma_f32_16x16x32_bf16 v[230:233], v[214:217], v[88:91], v[230:233]
 ds_read_b128 v[214:217], v109 offset:4096
 s_waitcnt lgkmcnt(5)
 v_mfma_f32_16x16x32_bf16 v[226:229], v[218:221], v[12:15], v[226:229]
 v_mfma_f32_16x16x32_bf16 v[230:233], v[218:221], v[92:95], v[230:233]
 ds_read_b128 v[218:221], v110 offset:0
 s_waitcnt lgkmcnt(5)
 v_mfma_f32_16x16x32_bf16 v[226:229], v[222:225], v[16:19], v[226:229]
 v_mfma_f32_16x16x32_bf16 v[230:233], v[222:225], v[96:99], v[230:233]
 ds_read_b128 v[222:225], v110 offset:1024
 s_waitcnt lgkmcnt(3)
 v_mfma_f32_16x16x32_bf16 v[226:229], v[210:213], v[20:23], v[226:229]
 v_mfma_f32_16x16x32_bf16 v[230:233], v[210:213], v[100:103], v[230:233]
 buffer_load_dwordx4 v[194:197], v2, s[4:7], s27 offen offset:0 sc1
 ds_read_b128 v[210:213], v110 offset:2048
 s_waitcnt lgkmcnt(3)
 v_mfma_f32_16x16x32_bf16 v[226:229], v[214:217], v[24:27], v[226:229]
 v_mfma_f32_16x16x32_bf16 v[230:233], v[214:217], v[104:107], v[230:233]
 ds_read_b128 v[214:217], v110 offset:3072
 s_waitcnt lgkmcnt(3)
 v_mfma_f32_16x16x32_bf16 v[226:229], v[218:221], v[28:31], v[226:229]
 ds_read_b128 v[218:221], v110 offset:4096
 s_waitcnt lgkmcnt(3)
 v_mfma_f32_16x16x32_bf16 v[226:229], v[222:225], v[32:35], v[226:229]
 buffer_load_dwordx4 v[198:201], v2, s[4:7], s27 offen offset:1024 sc1
 ds_read_b128 v[222:225], v111 offset:0
 s_waitcnt lgkmcnt(3)
 v_mfma_f32_16x16x32_bf16 v[226:229], v[210:213], v[36:39], v[226:229]
 ds_read_b128 v[210:213], v111 offset:1024
 s_waitcnt lgkmcnt(3)
 v_mfma_f32_16x16x32_bf16 v[226:229], v[214:217], v[40:43], v[226:229]
 ds_read_b128 v[214:217], v111 offset:2048
 s_waitcnt lgkmcnt(3)
 v_mfma_f32_16x16x32_bf16 v[226:229], v[218:221], v[44:47], v[226:229]
 buffer_load_dwordx4 v[202:205], v2, s[4:7], s27 offen offset:2048 sc1
 ds_read_b128 v[218:221], v111 offset:3072
 s_waitcnt lgkmcnt(3)
 v_mfma_f32_16x16x32_bf16 v[226:229], v[222:225], v[48:51], v[226:229]
 ds_read_b128 v[222:225], v111 offset:4096
 s_waitcnt lgkmcnt(3)
 v_mfma_f32_16x16x32_bf16 v[226:229], v[210:213], v[52:55], v[226:229]
 s_waitcnt lgkmcnt(2)
 v_mfma_f32_16x16x32_bf16 v[226:229], v[214:217], v[56:59], v[226:229]
 s_barrier
 ds_read_b128 v[206:209], v116 offset:28672
 s_waitcnt lgkmcnt(2)
 v_mfma_f32_16x16x32_bf16 v[226:229], v[218:221], v[60:63], v[226:229]
 s_waitcnt lgkmcnt(1)
 v_mfma_f32_16x16x32_bf16 v[226:229], v[222:225], v[64:67], v[226:229]
 s_cmp_eq_u32 s31, 72
 s_cbranch_scc1 Lfin_50
 s_mov_b32 s41, 0
Lf_51:
 s_waitcnt vmcnt(2)
 v_add_f32 v210, v234, v194
 v_add_f32 v211, v235, v195
 v_add_f32 v212, v236, v196
 v_add_f32 v213, v237, v197
 s_waitcnt vmcnt(1)
 v_add_f32 v214, v238, v198
 v_add_f32 v215, v239, v199
 v_add_f32 v216, v240, v200
 v_add_f32 v217, v241, v201
 v_maximum3_f32 v1, v210, v211, v212
 v_maximum3_f32 v127, v213, v214, v215
 v_maximum3_f32 v1, v1, v216, v217
 s_waitcnt vmcnt(0)
 v_add_f32 v218, v190, v202
 v_add_f32 v219, v191, v203
 v_add_f32 v220, v192, v204
 v_add_f32 v221, v193, v205
 v_maximum3_f32 v127, v127, v218, v219
 v_maximum3_f32 v1, v1, v220, v221
 v_maximum3_f32 v1, v1, v127, v127
 v_cmp_u_f32 vcc, v1, v1
 v_mov_b32 v127, v1
 s_cbranch_vccnz Lfs_52
Lfok_53:
 s_nop 0
 v_permlane32_swap_b32 v1, v127
 v_max_f32 v1, v1, v127
 v_mov_b32 v127, v1
 v_cvt_pk_bf16_f32 v178, v226, v227
 v_cvt_pk_bf16_f32 v179, v228, v229
 v_permlane16_swap_b32 v1, v127
 v_max_f32 v1, v1, v127
 v_mul_f32 v1, s71, v1
 v_fma_f32 v210, v210, s71, -v1
 v_fma_f32 v211, v211, s71, -v1
 v_fma_f32 v212, v212, s71, -v1
 v_fma_f32 v213, v213, s71, -v1
 v_fma_f32 v214, v214, s71, -v1
 v_fma_f32 v215, v215, s71, -v1
 v_fma_f32 v216, v216, s71, -v1
 v_fma_f32 v217, v217, s71, -v1
 v_fma_f32 v218, v218, s71, -v1
 v_fma_f32 v219, v219, s71, -v1
 v_fma_f32 v220, v220, s71, -v1
 v_fma_f32 v221, v221, s71, -v1
 v_exp_f32 v210, v210
 v_exp_f32 v211, v211
 v_exp_f32 v212, v212
 v_exp_f32 v213, v213
 v_exp_f32 v214, v214
 v_exp_f32 v215, v215
 v_exp_f32 v216, v216
 v_exp_f32 v217, v217
 s_mov_b32 exec_lo, 0x00ff00ff
 s_mov_b32 exec_hi, 0x00ff00ff
 v_cvt_pk_bf16_f32 v162, v210, v211
 v_cvt_pk_bf16_f32 v163, v212, v213
 v_cvt_pk_bf16_f32 v164, v214, v215
 v_cvt_pk_bf16_f32 v165, v216, v217
 s_not_b64 exec, exec
 v_cvt_pk_bf16_f32 v166, v210, v211
 v_cvt_pk_bf16_f32 v167, v212, v213
 v_cvt_pk_bf16_f32 v168, v214, v215
 v_cvt_pk_bf16_f32 v169, v216, v217
 s_mov_b64 exec, -1
 v_mfma_f32_16x16x32_bf16 v[200:203], v[186:189], v[162:165], 0
 v_exp_f32 v218, v218
 v_exp_f32 v219, v219
 v_mfma_f32_16x16x32_bf16 v[192:195], v[142:145], v[162:165], 0
 v_exp_f32 v220, v220
 v_mfma_f32_16x16x32_bf16 v[196:199], v[146:149], v[162:165], 0
 v_exp_f32 v221, v221
 v_mfma_f32_16x16x32_bf16 v[200:203], v[186:189], v[166:169], v[200:203]
 v_cvt_pk_bf16_f32 v190, v218, v219
 v_cvt_pk_bf16_f32 v191, v220, v221
 s_waitcnt lgkmcnt(0)
 v_mfma_f32_16x16x32_bf16 v[192:195], v[150:153], v[166:169], v[192:195]
 v_add_f32 v230, v230, v206
 v_add_f32 v231, v231, v207
 v_add_f32 v232, v232, v208
 v_mfma_f32_16x16x32_bf16 v[196:199], v[154:157], v[166:169], v[196:199]
 v_add_f32 v233, v233, v209
 v_cvt_pk_bf16_f32 v180, v230, v231
 v_cvt_pk_bf16_f32 v181, v232, v233
 v_mfma_f32_16x16x16_bf16 v[200:203], v[186:187], v[190:191], v[200:203]
 s_add_u32 s25, s60, s54
 s_add_u32 s27, s60, s55
 v_mfma_f32_16x16x16_bf16 v[192:195], v[178:179], v[190:191], v[192:195]
 s_add_u32 s28, s27, 4096
 v_mfma_f32_16x16x16_bf16 v[196:199], v[180:181], v[190:191], v[196:199]
 s_mov_b32 s41, 0
 s_nop 0
 v_rcp_f32 v127, v200
 s_nop 1
 v_mul_f32 v192, v192, v127
 v_mul_f32 v193, v193, v127
 v_mul_f32 v194, v194, v127
 v_mul_f32 v195, v195, v127
 v_cvt_pk_bf16_f32 v204, v192, v193
 v_cvt_pk_bf16_f32 v205, v194, v195
 v_mul_f32 v196, v196, v127
 v_mul_f32 v197, v197, v127
 v_mul_f32 v198, v198, v127
 v_mul_f32 v199, v199, v127
 v_cvt_pk_bf16_f32 v206, v196, v197
 v_cvt_pk_bf16_f32 v207, v198, v199
 buffer_store_dwordx4 v[204:207], v2, s[4:7], s25 offen
 ds_write_b64 v117, v[178:179] offset:0
 ds_write_b64 v117, v[180:181] offset:2048
 s_sleep 4
 buffer_load_dwordx4 v[190:193], v2, s[4:7], s27 offen offset:0 sc1
 ds_read_b128 v[142:145], v114 offset:0
 ds_read_b128 v[146:149], v114 offset:1024
 s_nop 7
 buffer_load_dwordx4 v[194:197], v2, s[4:7], s27 offen offset:1024 sc1
 ds_read_b128 v[150:153], v114 offset:2048
 ds_read_b128 v[154:157], v114 offset:3072
 s_nop 7
 buffer_load_dwordx4 v[198:201], v2, s[4:7], s27 offen offset:2048 sc1
 ds_read_b128 v[234:237], v114 offset:4096
 ds_read_b128 v[238:241], v114 offset:5120
 s_nop 7
 buffer_load_dwordx4 v[202:205], v2, s[4:7], s27 offen offset:3072 sc1
 ds_read_b128 v[242:245], v114 offset:6144
 ds_read_b128 v[246:249], v114 offset:7168
 s_nop 7
 buffer_load_dwordx4 v[206:209], v2, s[4:7], s28 offen offset:0 sc1
 s_nop 7
 buffer_load_dwordx4 v[210:213], v2, s[4:7], s28 offen offset:1024 sc1
 s_waitcnt lgkmcnt(0)
Lo_54:
 s_waitcnt vmcnt(5)
 v_max3_u32 v1, v190, v191, v192
 v_max_u32 v1, v1, v193
 v_cmp_eq_u32 vcc, -1, v1
 s_cbranch_vccnz Los_55
 v_mfma_f32_16x16x32_bf16 v[214:217], v[142:145], v[190:193], 0
 ds_read_b128 v[142:145], v114 offset:8192
 v_mfma_f32_16x16x32_bf16 v[218:221], v[146:149], v[190:193], 0
 ds_read_b128 v[146:149], v114 offset:9216
 s_waitcnt vmcnt(4)
 v_max3_u32 v1, v194, v195, v196
 v_mfma_f32_16x16x32_bf16 v[222:225], v[150:153], v[190:193], 0
 ds_read_b128 v[150:153], v114 offset:10240
 v_max_u32 v1, v1, v197
 v_mfma_f32_16x16x32_bf16 v[226:229], v[154:157], v[190:193], 0
 ds_read_b128 v[154:157], v114 offset:11264
 v_cmp_eq_u32 vcc, -1, v1
 v_mfma_f32_16x16x32_bf16 v[230:233], v[234:237], v[190:193], 0
 ds_read_b128 v[234:237], v114 offset:12288
Lo_56:
 s_cbranch_vccnz Los_57
 v_mfma_f32_16x16x32_bf16 v[214:217], v[238:241], v[194:197], v[214:217]
 ds_read_b128 v[238:241], v114 offset:13312
 v_mfma_f32_16x16x32_bf16 v[218:221], v[242:245], v[194:197], v[218:221]
 ds_read_b128 v[242:245], v114 offset:14336
 s_waitcnt vmcnt(3)
 v_max3_u32 v1, v198, v199, v200
 v_mfma_f32_16x16x32_bf16 v[222:225], v[246:249], v[194:197], v[222:225]
 ds_read_b128 v[246:249], v115 offset:0
 v_max_u32 v1, v1, v201
 s_waitcnt lgkmcnt(6)
 v_mfma_f32_16x16x32_bf16 v[226:229], v[142:145], v[194:197], v[226:229]
 ds_read_b128 v[142:145], v115 offset:1024
 v_cmp_eq_u32 vcc, -1, v1
 v_mfma_f32_16x16x32_bf16 v[230:233], v[146:149], v[194:197], v[230:233]
 ds_read_b128 v[146:149], v115 offset:2048
Lo_58:
 s_cbranch_vccnz Los_59
 s_waitcnt lgkmcnt(6)
 v_mfma_f32_16x16x32_bf16 v[214:217], v[150:153], v[198:201], v[214:217]
 ds_read_b128 v[150:153], v115 offset:3072
 v_mfma_f32_16x16x32_bf16 v[218:221], v[154:157], v[198:201], v[218:221]
 ds_read_b128 v[154:157], v115 offset:4096
 s_waitcnt vmcnt(2)
 v_max3_u32 v1, v202, v203, v204
 s_waitcnt lgkmcnt(6)
 v_mfma_f32_16x16x32_bf16 v[222:225], v[234:237], v[198:201], v[222:225]
 ds_read_b128 v[234:237], v115 offset:5120
 v_max_u32 v1, v1, v205
 v_mfma_f32_16x16x32_bf16 v[226:229], v[238:241], v[198:201], v[226:229]
 ds_read_b128 v[238:241], v115 offset:6144
 v_cmp_eq_u32 vcc, -1, v1
 s_waitcnt lgkmcnt(6)
 v_mfma_f32_16x16x32_bf16 v[230:233], v[242:245], v[198:201], v[230:233]
 ds_read_b128 v[242:245], v115 offset:7168
Lo_60:
 s_cbranch_vccnz Los_61
 v_mfma_f32_16x16x32_bf16 v[214:217], v[246:249], v[202:205], v[214:217]
 ds_read_b128 v[246:249], v115 offset:8192
 s_waitcnt lgkmcnt(6)
 v_mfma_f32_16x16x32_bf16 v[218:221], v[142:145], v[202:205], v[218:221]
 ds_read_b128 v[142:145], v115 offset:9216
 s_waitcnt vmcnt(1)
 v_max3_u32 v1, v206, v207, v208
 v_mfma_f32_16x16x32_bf16 v[222:225], v[146:149], v[202:205], v[222:225]
 ds_read_b128 v[146:149], v115 offset:10240
 v_max_u32 v1, v1, v209
 s_waitcnt lgkmcnt(6)
 v_mfma_f32_16x16x32_bf16 v[226:229], v[150:153], v[202:205], v[226:229]
 ds_read_b128 v[150:153], v115 offset:11264
 v_cmp_eq_u32 vcc, -1, v1
 v_mfma_f32_16x16x32_bf16 v[230:233], v[154:157], v[202:205], v[230:233]
 ds_read_b128 v[154:157], v115 offset:12288
Lo_62:
 s_cbranch_vccnz Los_63
 s_waitcnt lgkmcnt(6)
 v_mfma_f32_16x16x32_bf16 v[214:217], v[234:237], v[206:209], v[214:217]
 ds_read_b128 v[234:237], v115 offset:13312
 v_mfma_f32_16x16x32_bf16 v[218:221], v[238:241], v[206:209], v[218:221]
 ds_read_b128 v[238:241], v115 offset:14336
 s_waitcnt vmcnt(0)
 v_max3_u32 v1, v210, v211, v212
 s_waitcnt lgkmcnt(6)
 v_mfma_f32_16x16x32_bf16 v[222:225], v[242:245], v[206:209], v[222:225]
 v_max_u32 v1, v1, v213
 v_mfma_f32_16x16x32_bf16 v[226:229], v[246:249], v[206:209], v[226:229]
 v_cmp_eq_u32 vcc, -1, v1
 s_waitcnt lgkmcnt(4)
 v_mfma_f32_16x16x32_bf16 v[230:233], v[142:145], v[206:209], v[230:233]
Lo_64:
 s_cbranch_vccnz Los_65
 v_mfma_f32_16x16x32_bf16 v[214:217], v[146:149], v[210:213], v[214:217]
 buffer_load_dwordx4 v[130:133], v2, s[4:7], s66 offen sc1
 s_waitcnt lgkmcnt(2)
 v_mfma_f32_16x16x32_bf16 v[218:221], v[150:153], v[210:213], v[218:221]
 buffer_load_dwordx4 v[134:137], v2, s[4:7], s66 offen offset:2048 sc1
 v_mfma_f32_16x16x32_bf16 v[222:225], v[154:157], v[210:213], v[222:225]
 s_add_u32 s25, s66, 4096
 buffer_load_dwordx4 v[138:141], v2, s[4:7], s25 offen sc1
 s_waitcnt lgkmcnt(0)
 v_mfma_f32_16x16x32_bf16 v[226:229], v[234:237], v[210:213], v[226:229]
 v_mfma_f32_16x16x32_bf16 v[230:233], v[238:241], v[210:213], v[230:233]
 v_cvt_pk_bf16_f32 v190, v214, v215
 v_cvt_pk_bf16_f32 v191, v216, v217
 v_cvt_pk_bf16_f32 v192, v218, v219
 v_cvt_pk_bf16_f32 v193, v220, v221
 ds_write_b128 v118, v[190:193]
 v_cvt_pk_bf16_f32 v194, v222, v223
 v_cvt_pk_bf16_f32 v195, v224, v225
 v_cvt_pk_bf16_f32 v196, v226, v227
 v_cvt_pk_bf16_f32 v197, v228, v229
 ds_write_b128 v118, v[194:197] offset:4096
 v_cvt_pk_bf16_f32 v198, v230, v231
 v_cvt_pk_bf16_f32 v199, v232, v233
 ds_write_b64 v119, v[198:199] offset:8192
 s_add_u32 s25, s62, s46
 s_add_u32 s26, s25, 8192
 s_add_u32 s27, s25, 655360
 s_add_u32 s28, s26, 655360
 s_waitcnt lgkmcnt(0)
 s_barrier
 s_add_u32 s70, s69, s52
 s_add_u32 s27, s62, s47
 s_add_u32 s28, s62, s48
 s_add_u32 s69, s31, 1
 s_and_b32 s25, s69, 3
 s_mul_i32 s26, s25, 20480
 s_add_u32 s56, s26, s42
 s_add_u32 s57, s56, 4096
 s_add_u32 s58, s26, s43
 s_mul_i32 s62, s25, 163840
 s_xor_b32 s26, s25, 2
 s_mul_i32 s63, s26, 163840
 s_add_u32 s25, s25, 3
 s_and_b32 s25, s25, 3
 s_mul_i32 s26, s25, 20480
 s_add_u32 s59, s26, s43
 s_and_b32 s25, s69, 1
 s_mul_i32 s60, s25, 196608
 s_xor_b32 s25, s25, 1
 s_mul_i32 s61, s25, 196608
 s_mul_i32 s69, s69, 196608
 s_sleep 11
 s_mov_b32 s41, 0
 buffer_load_dwordx4 v[190:193], v2, s[4:7], s27 offen offset:0 sc1
 buffer_load_dwordx4 v[194:197], v2, s[4:7], s27 offen offset:1024 sc1
 buffer_load_dwordx4 v[198:201], v2, s[4:7], s28 offen offset:0 sc1
 buffer_load_dwordx4 v[202:205], v2, s[4:7], s28 offen offset:1024 sc1
 s_waitcnt vmcnt(2)
Lj_67:
 v_mfma_f32_16x16x32_bf16 v[210:213], v[170:173], v[190:193], 0
 v_max3_u32 v214, v190, v191, v192
 v_max3_u32 v215, v193, v194, v195
 v_mfma_f32_16x16x32_bf16 v[210:213], v[174:177], v[194:197], v[210:213]
 v_max3_u32 v214, v214, v196, v197
 v_max_u32 v214, v214, v215
 v_cmp_eq_u32 vcc, -1, v214
 s_cbranch_vccnz Ljs_68
Ly_70:
 s_waitcnt vmcnt(0)
 v_mfma_f32_16x16x32_bf16 v[206:209], v[170:173], v[198:201], v[210:213]
 v_max3_u32 v214, v198, v199, v200
 v_max3_u32 v215, v201, v202, v203
 v_mfma_f32_16x16x32_bf16 v[206:209], v[174:177], v[202:205], v[206:209]
 v_max3_u32 v214, v214, v204, v205
 v_max_u32 v214, v214, v215
 v_cmp_eq_u32 vcc, -1, v214
 s_cbranch_vccz Lyd_69
 buffer_load_dwordx4 v[198:201], v2, s[4:7], s28 offen offset:0 sc1
 buffer_load_dwordx4 v[202:205], v2, s[4:7], s28 offen offset:1024 sc1
 s_add_u32 s41, s41, 1
 s_cmp_gt_u32 s41, 200000
 s_cbranch_scc1 L_fail
 s_branch Ly_70
Lyd_69:
 s_nop 3
 v_cvt_pk_bf16_f32 v214, v206, v207
 v_cvt_pk_bf16_f32 v215, v208, v209
 s_cmp_eq_u32 s31, 8
 s_cbranch_scc1 Lov_71
Lnov_72:
 buffer_store_dwordx2 v[214:215], v121, s[4:7], s58 offen
 buffer_store_dwordx2 v[182:183], v121, s[4:7], s59 offen
Lnr_66:
 s_add_u32 s31, s31, 1
 s_barrier
 s_branch L_rec_top_0l
Lfin_50:
 s_waitcnt lgkmcnt(0)
 s_nop 4
 v_cvt_pk_bf16_f32 v178, v226, v227
 v_cvt_pk_bf16_f32 v179, v228, v229
 v_add_f32 v230, v230, v206
 v_add_f32 v231, v231, v207
 v_add_f32 v232, v232, v208
 v_add_f32 v233, v233, v209
 v_cvt_pk_bf16_f32 v180, v230, v231
 v_cvt_pk_bf16_f32 v181, v232, v233
 ds_write_b64 v117, v[178:179] offset:0
 ds_write_b64 v117, v[180:181] offset:2048
 s_waitcnt lgkmcnt(0)
 s_barrier
 s_endpgm
Lzs_39:
 buffer_load_dwordx4 v[190:193], v2, s[4:7], s56 offen offset:0 sc1
 buffer_load_dwordx4 v[194:197], v2, s[4:7], s56 offen offset:1024 sc1
 buffer_load_dwordx4 v[198:201], v2, s[4:7], s56 offen offset:2048 sc1
 buffer_load_dwordx4 v[202:205], v2, s[4:7], s56 offen offset:3072 sc1
 buffer_load_dwordx4 v[206:209], v2, s[4:7], s57 offen offset:0 sc1
 s_add_u32 s41, s41, 1
 s_cmp_gt_u32 s41, 200000
 s_cbranch_scc1 L_fail
 s_branch Lz_38
Lzs_41:
 buffer_load_dwordx4 v[194:197], v2, s[4:7], s56 offen offset:1024 sc1
 buffer_load_dwordx4 v[198:201], v2, s[4:7], s56 offen offset:2048 sc1
 buffer_load_dwordx4 v[202:205], v2, s[4:7], s56 offen offset:3072 sc1
 buffer_load_dwordx4 v[206:209], v2, s[4:7], s57 offen offset:0 sc1
 s_add_u32 s41, s41, 1
 s_cmp_gt_u32 s41, 200000
 s_cbranch_scc1 L_fail
 s_branch Lz_40
Lzs_43:
 buffer_load_dwordx4 v[198:201], v2, s[4:7], s56 offen offset:2048 sc1
 buffer_load_dwordx4 v[202:205], v2, s[4:7], s56 offen offset:3072 sc1
 buffer_load_dwordx4 v[206:209], v2, s[4:7], s57 offen offset:0 sc1
 s_add_u32 s41, s41, 1
 s_cmp_gt_u32 s41, 200000
 s_cbranch_scc1 L_fail
 s_branch Lz_42
Lzs_45:
 buffer_load_dwordx4 v[202:205], v2, s[4:7], s56 offen offset:3072 sc1
 buffer_load_dwordx4 v[206:209], v2, s[4:7], s57 offen offset:0 sc1
 s_add_u32 s41, s41, 1
 s_cmp_gt_u32 s41, 200000
 s_cbranch_scc1 L_fail
 s_branch Lz_44
Lzs_47:
 buffer_load_dwordx4 v[206:209], v2, s[4:7], s57 offen offset:0 sc1
 s_add_u32 s41, s41, 1
 s_cmp_gt_u32 s41, 200000
 s_cbranch_scc1 L_fail
 s_branch Lz_46
Lfs_52:
 v_max3_u32 v222, v194, v195, v196
 v_max3_u32 v222, v222, v197, v198
 v_max3_u32 v222, v222, v199, v200
 v_max3_u32 v222, v222, v201, v202
 v_max3_u32 v222, v222, v203, v204
 v_max_u32 v222, v222, v205
 v_cmp_eq_u32 vcc, -1, v222
 s_cbranch_vccz Lfok_53
 buffer_load_dwordx4 v[194:197], v2, s[4:7], s27 offen offset:0 sc1
 buffer_load_dwordx4 v[198:201], v2, s[4:7], s27 offen offset:1024 sc1
 buffer_load_dwordx4 v[202:205], v2, s[4:7], s27 offen offset:2048 sc1
 s_add_u32 s41, s41, 1
 s_cmp_gt_u32 s41, 200000
 s_cbranch_scc1 L_fail
 s_branch Lf_51
Los_55:
 buffer_load_dwordx4 v[190:193], v2, s[4:7], s27 offen offset:0 sc1
 buffer_load_dwordx4 v[194:197], v2, s[4:7], s27 offen offset:1024 sc1
 buffer_load_dwordx4 v[198:201], v2, s[4:7], s27 offen offset:2048 sc1
 buffer_load_dwordx4 v[202:205], v2, s[4:7], s27 offen offset:3072 sc1
 buffer_load_dwordx4 v[206:209], v2, s[4:7], s28 offen offset:0 sc1
 buffer_load_dwordx4 v[210:213], v2, s[4:7], s28 offen offset:1024 sc1
 s_add_u32 s41, s41, 1
 s_cmp_gt_u32 s41, 200000
 s_cbranch_scc1 L_fail
 s_branch Lo_54
Los_57:
 buffer_load_dwordx4 v[194:197], v2, s[4:7], s27 offen offset:1024 sc1
 buffer_load_dwordx4 v[198:201], v2, s[4:7], s27 offen offset:2048 sc1
 buffer_load_dwordx4 v[202:205], v2, s[4:7], s27 offen offset:3072 sc1
 buffer_load_dwordx4 v[206:209], v2, s[4:7], s28 offen offset:0 sc1
 buffer_load_dwordx4 v[210:213], v2, s[4:7], s28 offen offset:1024 sc1
 s_waitcnt vmcnt(4)
 v_max3_u32 v1, v194, v195, v196
 v_max_u32 v1, v1, v197
 v_cmp_eq_u32 vcc, -1, v1
 s_add_u32 s41, s41, 1
 s_cmp_gt_u32 s41, 200000
 s_cbranch_scc1 L_fail
 s_branch Lo_56
Los_59:
 buffer_load_dwordx4 v[198:201], v2, s[4:7], s27 offen offset:2048 sc1
 buffer_load_dwordx4 v[202:205], v2, s[4:7], s27 offen offset:3072 sc1
 buffer_load_dwordx4 v[206:209], v2, s[4:7], s28 offen offset:0 sc1
 buffer_load_dwordx4 v[210:213], v2, s[4:7], s28 offen offset:1024 sc1
 s_waitcnt vmcnt(3)
 v_max3_u32 v1, v198, v199, v200
 v_max_u32 v1, v1, v201
 v_cmp_eq_u32 vcc, -1, v1
 s_add_u32 s41, s41, 1
 s_cmp_gt_u32 s41, 200000
 s_cbranch_scc1 L_fail
 s_branch Lo_58
Los_61:
 buffer_load_dwordx4 v[202:205], v2, s[4:7], s27 offen offset:3072 sc1
 buffer_load_dwordx4 v[206:209], v2, s[4:7], s28 offen offset:0 sc1
 buffer_load_dwordx4 v[210:213], v2, s[4:7], s28 offen offset:1024 sc1
 s_waitcnt vmcnt(2)
 v_max3_u32 v1, v202, v203, v204
 v_max_u32 v1, v1, v205
 v_cmp_eq_u32 vcc, -1, v1
 s_add_u32 s41, s41, 1
 s_cmp_gt_u32 s41, 200000
 s_cbranch_scc1 L_fail
 s_branch Lo_60
Los_63:
 buffer_load_dwordx4 v[206:209], v2, s[4:7], s28 offen offset:0 sc1
 buffer_load_dwordx4 v[210:213], v2, s[4:7], s28 offen offset:1024 sc1
 s_waitcnt vmcnt(1)
 v_max3_u32 v1, v206, v207, v208
 v_max_u32 v1, v1, v209
 v_cmp_eq_u32 vcc, -1, v1
 s_add_u32 s41, s41, 1
 s_cmp_gt_u32 s41, 200000
 s_cbranch_scc1 L_fail
 s_branch Lo_62
Los_65:
 buffer_load_dwordx4 v[210:213], v2, s[4:7], s28 offen offset:1024 sc1
 s_waitcnt vmcnt(0)
 v_max3_u32 v1, v210, v211, v212
 v_max_u32 v1, v1, v213
 v_cmp_eq_u32 vcc, -1, v1
 s_add_u32 s41, s41, 1
 s_cmp_gt_u32 s41, 200000
 s_cbranch_scc1 L_fail
 s_branch Lo_64
Ljs_68:
 buffer_load_dwordx4 v[190:193], v2, s[4:7], s27 offen offset:0 sc1
 buffer_load_dwordx4 v[194:197], v2, s[4:7], s27 offen offset:1024 sc1
 s_waitcnt vmcnt(0)
 s_add_u32 s41, s41, 1
 s_cmp_gt_u32 s41, 200000
 s_cbranch_scc1 L_fail
 s_branch Lj_67
Lov_71:
 s_mov_b32 exec_lo, 0xff00ff00
 s_mov_b32 exec_hi, 0xff00ff00
 v_mov_b32 v214, v128
 v_mov_b32 v215, v129
 s_mov_b64 exec, -1
 s_add_u32 s41, s41, 1
 s_cmp_gt_u32 s41, 200000
 s_cbranch_scc1 L_fail
 s_branch Lnov_72
Lpwn_36:
 s_cmp_eq_u32 s3, 1
 s_cbranch_scc0 Lpwn_73
 s_waitcnt vmcnt(0)
 s_cmp_eq_u32 s40, 0
 s_cbranch_scc1 Lz0_74
 buffer_store_dwordx2 v[128:129], v121, s[4:7], s43 offen
Lz0_74:
 s_barrier
L_rec_top_1l:
 s_mov_b32 s41, 0
 s_sleep 2
 buffer_load_dwordx4 v[190:193], v2, s[4:7], s56 offen offset:0 sc1
 s_nop 11
 buffer_load_dwordx4 v[194:197], v2, s[4:7], s56 offen offset:1024 sc1
 s_nop 11
 buffer_load_dwordx4 v[198:201], v2, s[4:7], s56 offen offset:2048 sc1
 s_nop 11
 buffer_load_dwordx4 v[202:205], v2, s[4:7], s56 offen offset:3072 sc1
 s_nop 11
 buffer_load_dwordx4 v[206:209], v2, s[4:7], s57 offen offset:0 sc1
Lz_75:
 s_waitcnt vmcnt(4)
 ds_write_b128 v108, v[190:193] offset:0
 v_mfma_f32_16x16x32_bf16 v[226:229], a[0:3], v[190:193], 0
 v_max3_u32 v1, v190, v191, v192
 v_max_u32 v1, v1, v193
 v_mfma_f32_16x16x32_bf16 v[230:233], a[80:83], v[190:193], 0
 v_cmp_eq_u32 vcc, -1, v1
 v_mfma_f32_16x16x32_bf16 v[234:237], a[160:163], v[190:193], 0
 s_cbranch_vccnz Lzs_76
Lz_77:
 s_waitcnt vmcnt(3)
 ds_write_b128 v108, v[194:197] offset:1024
 v_max3_u32 v1, v194, v195, v196
 v_max_u32 v1, v1, v197
 v_cmp_eq_u32 vcc, -1, v1
 s_cbranch_vccnz Lzs_78
 v_mfma_f32_16x16x32_bf16 v[226:229], a[4:7], v[194:197], v[226:229]
 v_mfma_f32_16x16x32_bf16 v[230:233], a[84:87], v[194:197], v[230:233]
 v_mfma_f32_16x16x32_bf16 v[234:237], a[164:167], v[194:197], v[234:237]
Lz_79:
 s_waitcnt vmcnt(2)
 ds_write_b128 v108, v[198:201] offset:2048
 v_max3_u32 v1, v198, v199, v200
 v_max_u32 v1, v1, v201
 v_cmp_eq_u32 vcc, -1, v1
 s_cbranch_vccnz Lzs_80
 v_mfma_f32_16x16x32_bf16 v[226:229], a[8:11], v[198:201], v[226:229]
 v_mfma_f32_16x16x32_bf16 v[230:233], a[88:91], v[198:201], v[230:233]
 v_mfma_f32_16x16x32_bf16 v[234:237], a[168:171], v[198:201], v[234:237]
Lz_81:
 s_waitcnt vmcnt(1)
 ds_write_b128 v108, v[202:205] offset:3072
 v_max3_u32 v1, v202, v203, v204
 v_max_u32 v1, v1, v205
 v_cmp_eq_u32 vcc, -1, v1
 s_cbranch_vccnz Lzs_82
Lz_83:
 s_waitcnt vmcnt(0)
 ds_write_b128 v108, v[206:209] offset:4096
 v_max3_u32 v1, v206, v207, v208
 v_max_u32 v1, v1, v209
 v_cmp_eq_u32 vcc, -1, v1
 s_cbranch_vccnz Lzs_84
 s_waitcnt lgkmcnt(0)
 s_barrier
 ds_read_b128 v[214:217], v109 offset:0
 ds_read_b128 v[218:221], v109 offset:1024
 ds_read_b128 v[222:225], v109 offset:2048
 v_mfma_f32_16x16x32_bf16 v[226:229], a[12:15], v[202:205], v[226:229]
 buffer_load_dword v126, v124, s[4:7], 0 offen sc1
 v_mfma_f32_16x16x32_bf16 v[230:233], a[92:95], v[202:205], v[230:233]
 v_mfma_f32_16x16x32_bf16 v[234:237], a[172:175], v[202:205], v[234:237]
 v_mfma_f32_16x16x32_bf16 v[226:229], a[16:19], v[206:209], v[226:229]
 s_add_u32 s25, s67, s50
 v_mfma_f32_16x16x32_bf16 v[230:233], a[96:99], v[206:209], v[230:233]
 buffer_load_dwordx4 v[142:145], v2, s[4:7], s25 offen sc1
 v_mfma_f32_16x16x32_bf16 v[234:237], a[176:179], v[206:209], v[234:237]
 ds_read_b128 v[210:213], v109 offset:3072
 s_waitcnt lgkmcnt(3)
 v_mfma_f32_16x16x32_bf16 v[226:229], a[20:23], v[214:217], v[226:229]
 s_add_u32 s25, s67, s51
 v_mfma_f32_16x16x32_bf16 v[230:233], a[100:103], v[214:217], v[230:233]
 buffer_load_dwordx4 v[146:149], v2, s[4:7], s25 offen sc1
 v_mfma_f32_16x16x32_bf16 v[234:237], a[180:183], v[214:217], v[234:237]
 ds_read_b128 v[214:217], v109 offset:4096
 s_waitcnt lgkmcnt(3)
 v_mfma_f32_16x16x32_bf16 v[226:229], a[24:27], v[218:221], v[226:229]
 s_add_u32 s25, s68, s50
 v_mfma_f32_16x16x32_bf16 v[230:233], a[104:107], v[218:221], v[230:233]
 buffer_load_dwordx4 v[150:153], v2, s[4:7], s25 offen sc1
 v_mfma_f32_16x16x32_bf16 v[234:237], a[184:187], v[218:221], v[234:237]
 ds_read_b128 v[218:221], v110 offset:0
 s_waitcnt lgkmcnt(3)
 v_mfma_f32_16x16x32_bf16 v[226:229], a[28:31], v[222:225], v[226:229]
 s_add_u32 s25, s68, s51
 v_mfma_f32_16x16x32_bf16 v[230:233], a[108:111], v[222:225], v[230:233]
 buffer_load_dwordx4 v[154:157], v2, s[4:7], s25 offen sc1
 v_mfma_f32_16x16x32_bf16 v[234:237], a[188:191], v[222:225], v[234:237]
 ds_read_b128 v[222:225], v110 offset:1024
 s_waitcnt lgkmcnt(3)
 v_mfma_f32_16x16x32_bf16 v[226:229], a[32:35], v[210:213], v[226:229]
 s_add_u32 s25, s44, s61
 v_mfma_f32_16x16x32_bf16 v[230:233], a[112:115], v[210:213], v[230:233]
 s_add_u32 s25, s25, 1867776
 v_mfma_f32_16x16x32_bf16 v[234:237], a[192:195], v[210:213], v[234:237]
 buffer_store_dwordx4 v[182:185], v2, s[4:7], s25 offen offset:0
 ds_read_b128 v[210:213], v110 offset:2048
 s_waitcnt lgkmcnt(3)
 v_mfma_f32_16x16x32_bf16 v[226:229], a[36:39], v[214:217], v[226:229]
 s_add_u32 s25, s44, s61
 v_mfma_f32_16x16x32_bf16 v[230:233], a[116:119], v[214:217], v[230:233]
 s_add_u32 s25, s25, 1867776
 v_mfma_f32_16x16x32_bf16 v[234:237], a[196:199], v[214:217], v[234:237]
 buffer_store_dwordx4 v[182:185], v2, s[4:7], s25 offen offset:1024
 ds_read_b128 v[214:217], v110 offset:3072
 s_waitcnt lgkmcnt(3)
 v_mfma_f32_16x16x32_bf16 v[226:229], a[40:43], v[218:221], v[226:229]
 s_add_u32 s25, s44, s61
 v_mfma_f32_16x16x32_bf16 v[230:233], a[120:123], v[218:221], v[230:233]
 s_add_u32 s25, s25, 1867776
 v_mfma_f32_16x16x32_bf16 v[234:237], a[200:203], v[218:221], v[234:237]
 buffer_store_dwordx4 v[182:185], v2, s[4:7], s25 offen offset:2048
 ds_read_b128 v[218:221], v110 offset:4096
 s_waitcnt lgkmcnt(3)
 v_mfma_f32_16x16x32_bf16 v[226:229], a[44:47], v[222:225], v[226:229]
 s_add_u32 s25, s31, 1
 s_mul_i32 s67, s25, 393216
 v_mfma_f32_16x16x32_bf16 v[230:233], a[124:127], v[222:225], v[230:233]
 s_add_u32 s67, s67, 84312064
 s_cmp_lt_u32 s25, 64
 v_mfma_f32_16x16x32_bf16 v[234:237], a[204:207], v[222:225], v[234:237]
 s_cselect_b32 s67, s67, 2146435072
 ds_read_b128 v[222:225], v111 offset:0
 s_waitcnt lgkmcnt(3)
 v_mfma_f32_16x16x32_bf16 v[226:229], a[48:51], v[210:213], v[226:229]
 s_sub_u32 s26, s25, 9
 s_mul_i32 s68, s26, 393216
 v_mfma_f32_16x16x32_bf16 v[230:233], a[128:131], v[210:213], v[230:233]
 s_add_u32 s68, s68, 134643712
 s_cmp_lt_u32 s26, 64
 v_mfma_f32_16x16x32_bf16 v[234:237], a[208:211], v[210:213], v[234:237]
 s_cselect_b32 s68, s68, 2146435072
 ds_read_b128 v[210:213], v111 offset:1024
 s_waitcnt lgkmcnt(3)
 v_mfma_f32_16x16x32_bf16 v[226:229], a[52:55], v[214:217], v[226:229]
 s_add_u32 s25, s67, 4269801472
 s_add_u32 s26, s68, 4269801472
 v_mfma_f32_16x16x32_bf16 v[230:233], a[132:135], v[214:217], v[230:233]
 s_cmp_lt_u32 s3, 2
 s_cselect_b32 s66, s25, s26
 v_mfma_f32_16x16x32_bf16 v[234:237], a[212:215], v[214:217], v[234:237]
 s_add_u32 s66, s66, s49
 ds_read_b128 v[214:217], v111 offset:2048
 s_waitcnt lgkmcnt(3)
 v_mfma_f32_16x16x32_bf16 v[226:229], a[56:59], v[218:221], v[226:229]
 v_mfma_f32_16x16x32_bf16 v[230:233], a[136:139], v[218:221], v[230:233]
 v_mfma_f32_16x16x32_bf16 v[234:237], a[216:219], v[218:221], v[234:237]
 ds_read_b128 v[218:221], v111 offset:3072
 s_waitcnt lgkmcnt(3)
 v_mfma_f32_16x16x32_bf16 v[226:229], a[60:63], v[222:225], v[226:229]
 v_mfma_f32_16x16x32_bf16 v[230:233], a[140:143], v[222:225], v[230:233]
 v_mfma_f32_16x16x32_bf16 v[234:237], a[220:223], v[222:225], v[234:237]
 ds_read_b128 v[222:225], v111 offset:4096
 s_waitcnt lgkmcnt(3)
 v_mfma_f32_16x16x32_bf16 v[226:229], a[64:67], v[210:213], v[226:229]
 v_mfma_f32_16x16x32_bf16 v[230:233], a[144:147], v[210:213], v[230:233]
 v_mfma_f32_16x16x32_bf16 v[234:237], a[224:227], v[210:213], v[234:237]
 s_waitcnt lgkmcnt(2)
 v_mfma_f32_16x16x32_bf16 v[226:229], a[68:71], v[214:217], v[226:229]
 v_mfma_f32_16x16x32_bf16 v[230:233], a[148:151], v[214:217], v[230:233]
 v_mfma_f32_16x16x32_bf16 v[234:237], a[228:231], v[214:217], v[234:237]
 s_waitcnt lgkmcnt(1)
 v_mfma_f32_16x16x32_bf16 v[226:229], a[72:75], v[218:221], v[226:229]
 v_mfma_f32_16x16x32_bf16 v[230:233], a[152:155], v[218:221], v[230:233]
 v_mfma_f32_16x16x32_bf16 v[234:237], a[232:235], v[218:221], v[234:237]
 s_waitcnt lgkmcnt(0)
 v_mfma_f32_16x16x32_bf16 v[226:229], a[76:79], v[222:225], v[226:229]
 v_mfma_f32_16x16x32_bf16 v[230:233], a[156:159], v[222:225], v[230:233]
 v_mfma_f32_16x16x32_bf16 v[234:237], a[236:239], v[222:225], v[234:237]
 s_nop 1
 v_cvt_pk_bf16_f32 v190, v226, v227
 v_cvt_pk_bf16_f32 v191, v228, v229
 ds_write_b64 v112, v[190:191] offset:0
 v_cvt_pk_bf16_f32 v192, v230, v231
 v_cvt_pk_bf16_f32 v193, v232, v233
 ds_write_b64 v113, v[192:193] offset:0
 v_cvt_pk_bf16_f32 v194, v234, v235
 v_cvt_pk_bf16_f32 v195, v236, v237
 ds_write_b64 v112, v[194:195] offset:1024
 s_add_u32 s26, s60, s44
 s_add_u32 s27, s60, s45
 s_waitcnt lgkmcnt(0)
 s_barrier
 ds_read_b128 v[198:201], v3 offset:20480
 ds_read_b128 v[202:205], v3 offset:21504
 ds_read_b128 v[206:209], v3 offset:22528
 ds_read_b128 v[226:229], v3 offset:23552
 ds_read_b128 v[230:233], v3 offset:24576
 ds_read_b128 v[234:237], v3 offset:25600
 ds_read_b128 v[210:213], v108 offset:0
 ds_read_b128 v[214:217], v108 offset:1024
 ds_read_b128 v[218:221], v108 offset:2048
 s_waitcnt lgkmcnt(8)
 v_mfma_f32_16x16x32_bf16 v[194:197], v[130:133], v[198:201], 0
 s_waitcnt lgkmcnt(7)
 v_mfma_f32_16x16x32_bf16 v[194:197], v[134:137], v[202:205], v[194:197]
 s_waitcnt lgkmcnt(6)
 v_mfma_f32_16x16x32_bf16 v[194:197], v[138:141], v[206:209], v[194:197]
 s_waitcnt lgkmcnt(5)
 v_mfma_f32_16x16x32_bf16 v[190:193], v[226:229], v[198:201], v[158:161]
 s_waitcnt lgkmcnt(4)
 v_mfma_f32_16x16x32_bf16 v[190:193], v[230:233], v[202:205], v[190:193]
 s_mov_b32 exec_lo, 0x00ff00ff
 s_mov_b32 exec_hi, 0x00ff00ff
 s_waitcnt lgkmcnt(3)
 v_mfma_f32_16x16x32_bf16 v[190:193], v[234:237], v[206:209], v[190:193]
 buffer_store_dwordx4 v[194:197], v2, s[4:7], s26 offen offset:1024
 ds_write_b128 v116, v[194:197] offset:26624
 s_mov_b64 exec, -1
 ds_read_b128 v[222:225], v108 offset:3072
 s_waitcnt lgkmcnt(4)
 v_mfma_f32_16x16x32_bf16 v[226:229], v[210:213], a[240:243], 0
 v_mfma_f32_16x16x32_bf16 v[230:233], v[210:213], v[68:71], 0
 ds_read_b128 v[210:213], v108 offset:4096
 s_waitcnt lgkmcnt(4)
 v_mfma_f32_16x16x32_bf16 v[226:229], v[214:217], a[244:247], v[226:229]
 v_mfma_f32_16x16x32_bf16 v[230:233], v[214:217], v[72:75], v[230:233]
 ds_read_b128 v[214:217], v109 offset:0
 s_waitcnt lgkmcnt(4)
 v_mfma_f32_16x16x32_bf16 v[226:229], v[218:221], a[248:251], v[226:229]
 v_mfma_f32_16x16x32_bf16 v[230:233], v[218:221], v[76:79], v[230:233]
 ds_read_b128 v[218:221], v109 offset:1024
 s_waitcnt lgkmcnt(3)
 v_mfma_f32_16x16x32_bf16 v[226:229], v[222:225], a[252:255], v[226:229]
 v_mfma_f32_16x16x32_bf16 v[230:233], v[222:225], v[80:83], v[230:233]
 s_waitcnt vmcnt(8)
 s_mov_b32 s41, 0
 v_min_i32 v1, 64, v125
 v_cmp_ge_i32 vcc, v126, v1
 s_nop 0
 s_cmp_eq_u64 vcc, -1
 s_cbranch_scc1 Lflok_86
Lfl_85:
 s_add_u32 s41, s41, 1
 s_cmp_gt_u32 s41, 200000
 s_cbranch_scc1 L_fail
 buffer_load_dword v126, v124, s[4:7], 0 offen sc1
 s_waitcnt vmcnt(0)
 v_cmp_ge_i32 vcc, v126, v1
 s_nop 0
 s_cmp_eq_u64 vcc, -1
 s_cbranch_scc0 Lfl_85
Lflok_86:
 v_add_u32 v125, 1, v125
 ds_read_b128 v[222:225], v109 offset:2048
 s_waitcnt lgkmcnt(3)
 v_mfma_f32_16x16x32_bf16 v[226:229], v[210:213], v[4:7], v[226:229]
 v_mfma_f32_16x16x32_bf16 v[230:233], v[210:213], v[84:87], v[230:233]
 s_barrier
 ds_read_b128 v[234:237], v3 offset:26624
 ds_read_b128 v[238:241], v3 offset:27648
 ds_read_b128 v[210:213], v109 offset:3072
 s_waitcnt lgkmcnt(5)
 v_mfma_f32_16x16x32_bf16 v[226:229], v[214:217], v[8:11], v[226:229]
 v_mfma_f32_16x16x32_bf16 v[230:233], v[214:217], v[88:91], v[230:233]
 ds_read_b128 v[214:217], v109 offset:4096
 s_waitcnt lgkmcnt(5)
 v_mfma_f32_16x16x32_bf16 v[226:229], v[218:221], v[12:15], v[226:229]
 v_mfma_f32_16x16x32_bf16 v[230:233], v[218:221], v[92:95], v[230:233]
 ds_read_b128 v[218:221], v110 offset:0
 s_waitcnt lgkmcnt(5)
 v_mfma_f32_16x16x32_bf16 v[226:229], v[222:225], v[16:19], v[226:229]
 v_mfma_f32_16x16x32_bf16 v[230:233], v[222:225], v[96:99], v[230:233]
 ds_read_b128 v[222:225], v110 offset:1024
 s_waitcnt lgkmcnt(3)
 v_mfma_f32_16x16x32_bf16 v[226:229], v[210:213], v[20:23], v[226:229]
 v_mfma_f32_16x16x32_bf16 v[230:233], v[210:213], v[100:103], v[230:233]
 buffer_load_dwordx4 v[194:197], v2, s[4:7], s27 offen offset:0 sc1
 ds_read_b128 v[210:213], v110 offset:2048
 s_waitcnt lgkmcnt(3)
 v_mfma_f32_16x16x32_bf16 v[226:229], v[214:217], v[24:27], v[226:229]
 v_mfma_f32_16x16x32_bf16 v[230:233], v[214:217], v[104:107], v[230:233]
 ds_read_b128 v[214:217], v110 offset:3072
 s_waitcnt lgkmcnt(3)
 v_mfma_f32_16x16x32_bf16 v[226:229], v[218:221], v[28:31], v[226:229]
 ds_read_b128 v[218:221], v110 offset:4096
 s_waitcnt lgkmcnt(3)
 v_mfma_f32_16x16x32_bf16 v[226:229], v[222:225], v[32:35], v[226:229]
 buffer_load_dwordx4 v[198:201], v2, s[4:7], s27 offen offset:1024 sc1
 ds_read_b128 v[222:225], v111 offset:0
 s_waitcnt lgkmcnt(3)
 v_mfma_f32_16x16x32_bf16 v[226:229], v[210:213], v[36:39], v[226:229]
 ds_read_b128 v[210:213], v111 offset:1024
 s_waitcnt lgkmcnt(3)
 v_mfma_f32_16x16x32_bf16 v[226:229], v[214:217], v[40:43], v[226:229]
 ds_read_b128 v[214:217], v111 offset:2048
 s_waitcnt lgkmcnt(3)
 v_mfma_f32_16x16x32_bf16 v[226:229], v[218:221], v[44:47], v[226:229]
 buffer_load_dwordx4 v[202:205], v2, s[4:7], s27 offen offset:2048 sc1
 ds_read_b128 v[218:221], v111 offset:3072
 s_waitcnt lgkmcnt(3)
 v_mfma_f32_16x16x32_bf16 v[226:229], v[222:225], v[48:51], v[226:229]
 ds_read_b128 v[222:225], v111 offset:4096
 s_waitcnt lgkmcnt(3)
 v_mfma_f32_16x16x32_bf16 v[226:229], v[210:213], v[52:55], v[226:229]
 s_waitcnt lgkmcnt(2)
 v_mfma_f32_16x16x32_bf16 v[226:229], v[214:217], v[56:59], v[226:229]
 s_barrier
 ds_read_b128 v[206:209], v116 offset:28672
 s_waitcnt lgkmcnt(2)
 v_mfma_f32_16x16x32_bf16 v[226:229], v[218:221], v[60:63], v[226:229]
 s_waitcnt lgkmcnt(1)
 v_mfma_f32_16x16x32_bf16 v[226:229], v[222:225], v[64:67], v[226:229]
 s_cmp_eq_u32 s31, 72
 s_cbranch_scc1 Lfin_87
 s_mov_b32 s41, 0
Lf_88:
 s_waitcnt vmcnt(2)
 v_add_f32 v210, v234, v194
 v_add_f32 v211, v235, v195
 v_add_f32 v212, v236, v196
 v_add_f32 v213, v237, v197
 s_waitcnt vmcnt(1)
 v_add_f32 v214, v238, v198
 v_add_f32 v215, v239, v199
 v_add_f32 v216, v240, v200
 v_add_f32 v217, v241, v201
 v_maximum3_f32 v1, v210, v211, v212
 v_maximum3_f32 v127, v213, v214, v215
 v_maximum3_f32 v1, v1, v216, v217
 s_waitcnt vmcnt(0)
 v_add_f32 v218, v190, v202
 v_add_f32 v219, v191, v203
 v_add_f32 v220, v192, v204
 v_add_f32 v221, v193, v205
 v_maximum3_f32 v127, v127, v218, v219
 v_maximum3_f32 v1, v1, v220, v221
 v_maximum3_f32 v1, v1, v127, v127
 v_cmp_u_f32 vcc, v1, v1
 v_mov_b32 v127, v1
 s_cbranch_vccnz Lfs_89
Lfok_90:
 s_nop 0
 v_permlane32_swap_b32 v1, v127
 v_max_f32 v1, v1, v127
 v_mov_b32 v127, v1
 v_cvt_pk_bf16_f32 v178, v226, v227
 v_cvt_pk_bf16_f32 v179, v228, v229
 v_permlane16_swap_b32 v1, v127
 v_max_f32 v1, v1, v127
 v_mul_f32 v1, s71, v1
 v_fma_f32 v210, v210, s71, -v1
 v_fma_f32 v211, v211, s71, -v1
 v_fma_f32 v212, v212, s71, -v1
 v_fma_f32 v213, v213, s71, -v1
 v_fma_f32 v214, v214, s71, -v1
 v_fma_f32 v215, v215, s71, -v1
 v_fma_f32 v216, v216, s71, -v1
 v_fma_f32 v217, v217, s71, -v1
 v_fma_f32 v218, v218, s71, -v1
 v_fma_f32 v219, v219, s71, -v1
 v_fma_f32 v220, v220, s71, -v1
 v_fma_f32 v221, v221, s71, -v1
 v_exp_f32 v210, v210
 v_exp_f32 v211, v211
 v_exp_f32 v212, v212
 v_exp_f32 v213, v213
 v_exp_f32 v214, v214
 v_exp_f32 v215, v215
 v_exp_f32 v216, v216
 v_exp_f32 v217, v217
 s_mov_b32 exec_lo, 0x00ff00ff
 s_mov_b32 exec_hi, 0x00ff00ff
 v_cvt_pk_bf16_f32 v162, v210, v211
 v_cvt_pk_bf16_f32 v163, v212, v213
 v_cvt_pk_bf16_f32 v164, v214, v215
 v_cvt_pk_bf16_f32 v165, v216, v217
 s_not_b64 exec, exec
 v_cvt_pk_bf16_f32 v166, v210, v211
 v_cvt_pk_bf16_f32 v167, v212, v213
 v_cvt_pk_bf16_f32 v168, v214, v215
 v_cvt_pk_bf16_f32 v169, v216, v217
 s_mov_b64 exec, -1
 v_mfma_f32_16x16x32_bf16 v[200:203], v[186:189], v[162:165], 0
 v_exp_f32 v218, v218
 v_exp_f32 v219, v219
 v_mfma_f32_16x16x32_bf16 v[192:195], v[142:145], v[162:165], 0
 v_exp_f32 v220, v220
 v_mfma_f32_16x16x32_bf16 v[196:199], v[146:149], v[162:165], 0
 v_exp_f32 v221, v221
 v_mfma_f32_16x16x32_bf16 v[200:203], v[186:189], v[166:169], v[200:203]
 v_cvt_pk_bf16_f32 v190, v218, v219
 v_cvt_pk_bf16_f32 v191, v220, v221
 s_waitcnt lgkmcnt(0)
 v_mfma_f32_16x16x32_bf16 v[192:195], v[150:153], v[166:169], v[192:195]
 v_add_f32 v230, v230, v206
 v_add_f32 v231, v231, v207
 v_add_f32 v232, v232, v208
 v_mfma_f32_16x16x32_bf16 v[196:199], v[154:157], v[166:169], v[196:199]
 v_add_f32 v233, v233, v209
 v_cvt_pk_bf16_f32 v180, v230, v231
 v_cvt_pk_bf16_f32 v181, v232, v233
 v_mfma_f32_16x16x16_bf16 v[200:203], v[186:187], v[190:191], v[200:203]
 s_add_u32 s25, s60, s54
 s_add_u32 s27, s60, s55
 v_mfma_f32_16x16x16_bf16 v[192:195], v[178:179], v[190:191], v[192:195]
 s_add_u32 s28, s27, 4096
 v_mfma_f32_16x16x16_bf16 v[196:199], v[180:181], v[190:191], v[196:199]
 s_mov_b32 s41, 0
 s_nop 0
 v_rcp_f32 v127, v200
 s_nop 1
 v_mul_f32 v192, v192, v127
 v_mul_f32 v193, v193, v127
 v_mul_f32 v194, v194, v127
 v_mul_f32 v195, v195, v127
 v_cvt_pk_bf16_f32 v204, v192, v193
 v_cvt_pk_bf16_f32 v205, v194, v195
 v_mul_f32 v196, v196, v127
 v_mul_f32 v197, v197, v127
 v_mul_f32 v198, v198, v127
 v_mul_f32 v199, v199, v127
 v_cvt_pk_bf16_f32 v206, v196, v197
 v_cvt_pk_bf16_f32 v207, v198, v199
 buffer_store_dwordx4 v[204:207], v2, s[4:7], s25 offen
 ds_write_b64 v117, v[178:179] offset:512
 ds_write_b64 v117, v[180:181] offset:2560
 s_sleep 4
 buffer_load_dwordx4 v[190:193], v2, s[4:7], s27 offen offset:0 sc1
 ds_read_b128 v[142:145], v114 offset:0
 ds_read_b128 v[146:149], v114 offset:1024
 s_nop 7
 buffer_load_dwordx4 v[194:197], v2, s[4:7], s27 offen offset:1024 sc1
 ds_read_b128 v[150:153], v114 offset:2048
 ds_read_b128 v[154:157], v114 offset:3072
 s_nop 7
 buffer_load_dwordx4 v[198:201], v2, s[4:7], s27 offen offset:2048 sc1
 ds_read_b128 v[234:237], v114 offset:4096
 ds_read_b128 v[238:241], v114 offset:5120
 s_nop 7
 buffer_load_dwordx4 v[202:205], v2, s[4:7], s27 offen offset:3072 sc1
 ds_read_b128 v[242:245], v114 offset:6144
 ds_read_b128 v[246:249], v114 offset:7168
 s_nop 7
 buffer_load_dwordx4 v[206:209], v2, s[4:7], s28 offen offset:0 sc1
 s_nop 7
 buffer_load_dwordx4 v[210:213], v2, s[4:7], s28 offen offset:1024 sc1
 s_waitcnt lgkmcnt(0)
Lo_91:
 s_waitcnt vmcnt(5)
 v_max3_u32 v1, v190, v191, v192
 v_max_u32 v1, v1, v193
 v_cmp_eq_u32 vcc, -1, v1
 s_cbranch_vccnz Los_92
 v_mfma_f32_16x16x32_bf16 v[214:217], v[142:145], v[190:193], 0
 ds_read_b128 v[142:145], v114 offset:8192
 v_mfma_f32_16x16x32_bf16 v[218:221], v[146:149], v[190:193], 0
 ds_read_b128 v[146:149], v114 offset:9216
 s_waitcnt vmcnt(4)
 v_max3_u32 v1, v194, v195, v196
 v_mfma_f32_16x16x32_bf16 v[222:225], v[150:153], v[190:193], 0
 ds_read_b128 v[150:153], v114 offset:10240
 v_max_u32 v1, v1, v197
 v_mfma_f32_16x16x32_bf16 v[226:229], v[154:157], v[190:193], 0
 ds_read_b128 v[154:157], v114 offset:11264
 v_cmp_eq_u32 vcc, -1, v1
 v_mfma_f32_16x16x32_bf16 v[230:233], v[234:237], v[190:193], 0
 ds_read_b128 v[234:237], v114 offset:12288
Lo_93:
 s_cbranch_vccnz Los_94
 v_mfma_f32_16x16x32_bf16 v[214:217], v[238:241], v[194:197], v[214:217]
 ds_read_b128 v[238:241], v114 offset:13312
 v_mfma_f32_16x16x32_bf16 v[218:221], v[242:245], v[194:197], v[218:221]
 ds_read_b128 v[242:245], v114 offset:14336
 s_waitcnt vmcnt(3)
 v_max3_u32 v1, v198, v199, v200
 v_mfma_f32_16x16x32_bf16 v[222:225], v[246:249], v[194:197], v[222:225]
 ds_read_b128 v[246:249], v115 offset:0
 v_max_u32 v1, v1, v201
 s_waitcnt lgkmcnt(6)
 v_mfma_f32_16x16x32_bf16 v[226:229], v[142:145], v[194:197], v[226:229]
 ds_read_b128 v[142:145], v115 offset:1024
 v_cmp_eq_u32 vcc, -1, v1
 v_mfma_f32_16x16x32_bf16 v[230:233], v[146:149], v[194:197], v[230:233]
 ds_read_b128 v[146:149], v115 offset:2048
Lo_95:
 s_cbranch_vccnz Los_96
 s_waitcnt lgkmcnt(6)
 v_mfma_f32_16x16x32_bf16 v[214:217], v[150:153], v[198:201], v[214:217]
 ds_read_b128 v[150:153], v115 offset:3072
 v_mfma_f32_16x16x32_bf16 v[218:221], v[154:157], v[198:201], v[218:221]
 ds_read_b128 v[154:157], v115 offset:4096
 s_waitcnt vmcnt(2)
 v_max3_u32 v1, v202, v203, v204
 s_waitcnt lgkmcnt(6)
 v_mfma_f32_16x16x32_bf16 v[222:225], v[234:237], v[198:201], v[222:225]
 ds_read_b128 v[234:237], v115 offset:5120
 v_max_u32 v1, v1, v205
 v_mfma_f32_16x16x32_bf16 v[226:229], v[238:241], v[198:201], v[226:229]
 ds_read_b128 v[238:241], v115 offset:6144
 v_cmp_eq_u32 vcc, -1, v1
 s_waitcnt lgkmcnt(6)
 v_mfma_f32_16x16x32_bf16 v[230:233], v[242:245], v[198:201], v[230:233]
 ds_read_b128 v[242:245], v115 offset:7168
Lo_97:
 s_cbranch_vccnz Los_98
 v_mfma_f32_16x16x32_bf16 v[214:217], v[246:249], v[202:205], v[214:217]
 ds_read_b128 v[246:249], v115 offset:8192
 s_waitcnt lgkmcnt(6)
 v_mfma_f32_16x16x32_bf16 v[218:221], v[142:145], v[202:205], v[218:221]
 ds_read_b128 v[142:145], v115 offset:9216
 s_waitcnt vmcnt(1)
 v_max3_u32 v1, v206, v207, v208
 v_mfma_f32_16x16x32_bf16 v[222:225], v[146:149], v[202:205], v[222:225]
 ds_read_b128 v[146:149], v115 offset:10240
 v_max_u32 v1, v1, v209
 s_waitcnt lgkmcnt(6)
 v_mfma_f32_16x16x32_bf16 v[226:229], v[150:153], v[202:205], v[226:229]
 ds_read_b128 v[150:153], v115 offset:11264
 v_cmp_eq_u32 vcc, -1, v1
 v_mfma_f32_16x16x32_bf16 v[230:233], v[154:157], v[202:205], v[230:233]
 ds_read_b128 v[154:157], v115 offset:12288
Lo_99:
 s_cbranch_vccnz Los_100
 s_waitcnt lgkmcnt(6)
 v_mfma_f32_16x16x32_bf16 v[214:217], v[234:237], v[206:209], v[214:217]
 ds_read_b128 v[234:237], v115 offset:13312
 v_mfma_f32_16x16x32_bf16 v[218:221], v[238:241], v[206:209], v[218:221]
 ds_read_b128 v[238:241], v115 offset:14336
 s_waitcnt vmcnt(0)
 v_max3_u32 v1, v210, v211, v212
 s_waitcnt lgkmcnt(6)
 v_mfma_f32_16x16x32_bf16 v[222:225], v[242:245], v[206:209], v[222:225]
 v_max_u32 v1, v1, v213
 v_mfma_f32_16x16x32_bf16 v[226:229], v[246:249], v[206:209], v[226:229]
 v_cmp_eq_u32 vcc, -1, v1
 s_waitcnt lgkmcnt(4)
 v_mfma_f32_16x16x32_bf16 v[230:233], v[142:145], v[206:209], v[230:233]
Lo_101:
 s_cbranch_vccnz Los_102
 v_mfma_f32_16x16x32_bf16 v[214:217], v[146:149], v[210:213], v[214:217]
 buffer_load_dwordx4 v[130:133], v2, s[4:7], s66 offen sc1
 s_waitcnt lgkmcnt(2)
 v_mfma_f32_16x16x32_bf16 v[218:221], v[150:153], v[210:213], v[218:221]
 buffer_load_dwordx4 v[134:137], v2, s[4:7], s66 offen offset:2048 sc1
 v_mfma_f32_16x16x32_bf16 v[222:225], v[154:157], v[210:213], v[222:225]
 s_add_u32 s25, s66, 4096
 buffer_load_dwordx4 v[138:141], v2, s[4:7], s25 offen sc1
 s_waitcnt lgkmcnt(0)
 v_mfma_f32_16x16x32_bf16 v[226:229], v[234:237], v[210:213], v[226:229]
 v_mfma_f32_16x16x32_bf16 v[230:233], v[238:241], v[210:213], v[230:233]
 v_cvt_pk_bf16_f32 v190, v214, v215
 v_cvt_pk_bf16_f32 v191, v216, v217
 v_cvt_pk_bf16_f32 v192, v218, v219
 v_cvt_pk_bf16_f32 v193, v220, v221
 ds_write_b128 v118, v[190:193]
 v_cvt_pk_bf16_f32 v194, v222, v223
 v_cvt_pk_bf16_f32 v195, v224, v225
 v_cvt_pk_bf16_f32 v196, v226, v227
 v_cvt_pk_bf16_f32 v197, v228, v229
 ds_write_b128 v118, v[194:197] offset:4096
 v_cvt_pk_bf16_f32 v198, v230, v231
 v_cvt_pk_bf16_f32 v199, v232, v233
 ds_write_b64 v119, v[198:199] offset:8192
 s_add_u32 s25, s62, s46
 s_add_u32 s26, s25, 8192
 s_add_u32 s27, s25, 655360
 s_add_u32 s28, s26, 655360
 s_waitcnt lgkmcnt(0)
 s_barrier
 s_add_u32 s70, s69, s52
 s_add_u32 s27, s62, s47
 s_add_u32 s28, s62, s48
 s_add_u32 s69, s31, 1
 s_and_b32 s25, s69, 3
 s_mul_i32 s26, s25, 20480
 s_add_u32 s56, s26, s42
 s_add_u32 s57, s56, 4096
 s_add_u32 s58, s26, s43
 s_mul_i32 s62, s25, 163840
 s_xor_b32 s26, s25, 2
 s_mul_i32 s63, s26, 163840
 s_add_u32 s25, s25, 3
 s_and_b32 s25, s25, 3
 s_mul_i32 s26, s25, 20480
 s_add_u32 s59, s26, s43
 s_and_b32 s25, s69, 1
 s_mul_i32 s60, s25, 196608
 s_xor_b32 s25, s25, 1
 s_mul_i32 s61, s25, 196608
 s_mul_i32 s69, s69, 196608
 s_cmp_eq_u32 s40, 0
 s_cbranch_scc1 Lnr_103
 s_sleep 11
 s_mov_b32 s41, 0
 buffer_load_dwordx4 v[190:193], v2, s[4:7], s27 offen offset:0 sc1
 buffer_load_dwordx4 v[194:197], v2, s[4:7], s27 offen offset:1024 sc1
 buffer_load_dwordx4 v[198:201], v2, s[4:7], s28 offen offset:0 sc1
 buffer_load_dwordx4 v[202:205], v2, s[4:7], s28 offen offset:1024 sc1
 s_waitcnt vmcnt(2)
Lj_104:
 v_mfma_f32_16x16x32_bf16 v[210:213], v[170:173], v[190:193], 0
 v_max3_u32 v214, v190, v191, v192
 v_max3_u32 v215, v193, v194, v195
 v_mfma_f32_16x16x32_bf16 v[210:213], v[174:177], v[194:197], v[210:213]
 v_max3_u32 v214, v214, v196, v197
 v_max_u32 v214, v214, v215
 v_cmp_eq_u32 vcc, -1, v214
 s_cbranch_vccnz Ljs_105
Ly_107:
 s_waitcnt vmcnt(0)
 v_mfma_f32_16x16x32_bf16 v[206:209], v[170:173], v[198:201], v[210:213]
 v_max3_u32 v214, v198, v199, v200
 v_max3_u32 v215, v201, v202, v203
 v_mfma_f32_16x16x32_bf16 v[206:209], v[174:177], v[202:205], v[206:209]
 v_max3_u32 v214, v214, v204, v205
 v_max_u32 v214, v214, v215
 v_cmp_eq_u32 vcc, -1, v214
 s_cbranch_vccz Lyd_106
 buffer_load_dwordx4 v[198:201], v2, s[4:7], s28 offen offset:0 sc1
 buffer_load_dwordx4 v[202:205], v2, s[4:7], s28 offen offset:1024 sc1
 s_add_u32 s41, s41, 1
 s_cmp_gt_u32 s41, 200000
 s_cbranch_scc1 L_fail
 s_branch Ly_107
Lyd_106:
 s_nop 3
 v_cvt_pk_bf16_f32 v214, v206, v207
 v_cvt_pk_bf16_f32 v215, v208, v209
 s_cmp_eq_u32 s31, 8
 s_cbranch_scc1 Lov_108
Lnov_109:
 buffer_store_dwordx2 v[214:215], v121, s[4:7], s58 offen
 buffer_store_dwordx2 v[182:183], v121, s[4:7], s59 offen
Lnr_103:
 s_add_u32 s31, s31, 1
 s_barrier
 s_branch L_rec_top_1l
Lfin_87:
 s_waitcnt lgkmcnt(0)
 s_nop 4
 v_cvt_pk_bf16_f32 v178, v226, v227
 v_cvt_pk_bf16_f32 v179, v228, v229
 v_add_f32 v230, v230, v206
 v_add_f32 v231, v231, v207
 v_add_f32 v232, v232, v208
 v_add_f32 v233, v233, v209
 v_cvt_pk_bf16_f32 v180, v230, v231
 v_cvt_pk_bf16_f32 v181, v232, v233
 ds_write_b64 v117, v[178:179] offset:512
 ds_write_b64 v117, v[180:181] offset:2560
 s_waitcnt lgkmcnt(0)
 s_barrier
 s_endpgm
Lzs_76:
 buffer_load_dwordx4 v[190:193], v2, s[4:7], s56 offen offset:0 sc1
 buffer_load_dwordx4 v[194:197], v2, s[4:7], s56 offen offset:1024 sc1
 buffer_load_dwordx4 v[198:201], v2, s[4:7], s56 offen offset:2048 sc1
 buffer_load_dwordx4 v[202:205], v2, s[4:7], s56 offen offset:3072 sc1
 buffer_load_dwordx4 v[206:209], v2, s[4:7], s57 offen offset:0 sc1
 s_add_u32 s41, s41, 1
 s_cmp_gt_u32 s41, 200000
 s_cbranch_scc1 L_fail
 s_branch Lz_75
Lzs_78:
 buffer_load_dwordx4 v[194:197], v2, s[4:7], s56 offen offset:1024 sc1
 buffer_load_dwordx4 v[198:201], v2, s[4:7], s56 offen offset:2048 sc1
 buffer_load_dwordx4 v[202:205], v2, s[4:7], s56 offen offset:3072 sc1
 buffer_load_dwordx4 v[206:209], v2, s[4:7], s57 offen offset:0 sc1
 s_add_u32 s41, s41, 1
 s_cmp_gt_u32 s41, 200000
 s_cbranch_scc1 L_fail
 s_branch Lz_77
Lzs_80:
 buffer_load_dwordx4 v[198:201], v2, s[4:7], s56 offen offset:2048 sc1
 buffer_load_dwordx4 v[202:205], v2, s[4:7], s56 offen offset:3072 sc1
 buffer_load_dwordx4 v[206:209], v2, s[4:7], s57 offen offset:0 sc1
 s_add_u32 s41, s41, 1
 s_cmp_gt_u32 s41, 200000
 s_cbranch_scc1 L_fail
 s_branch Lz_79
Lzs_82:
 buffer_load_dwordx4 v[202:205], v2, s[4:7], s56 offen offset:3072 sc1
 buffer_load_dwordx4 v[206:209], v2, s[4:7], s57 offen offset:0 sc1
 s_add_u32 s41, s41, 1
 s_cmp_gt_u32 s41, 200000
 s_cbranch_scc1 L_fail
 s_branch Lz_81
Lzs_84:
 buffer_load_dwordx4 v[206:209], v2, s[4:7], s57 offen offset:0 sc1
 s_add_u32 s41, s41, 1
 s_cmp_gt_u32 s41, 200000
 s_cbranch_scc1 L_fail
 s_branch Lz_83
Lfs_89:
 v_max3_u32 v222, v194, v195, v196
 v_max3_u32 v222, v222, v197, v198
 v_max3_u32 v222, v222, v199, v200
 v_max3_u32 v222, v222, v201, v202
 v_max3_u32 v222, v222, v203, v204
 v_max_u32 v222, v222, v205
 v_cmp_eq_u32 vcc, -1, v222
 s_cbranch_vccz Lfok_90
 buffer_load_dwordx4 v[194:197], v2, s[4:7], s27 offen offset:0 sc1
 buffer_load_dwordx4 v[198:201], v2, s[4:7], s27 offen offset:1024 sc1
 buffer_load_dwordx4 v[202:205], v2, s[4:7], s27 offen offset:2048 sc1
 s_add_u32 s41, s41, 1
 s_cmp_gt_u32 s41, 200000
 s_cbranch_scc1 L_fail
 s_branch Lf_88
Los_92:
 buffer_load_dwordx4 v[190:193], v2, s[4:7], s27 offen offset:0 sc1
 buffer_load_dwordx4 v[194:197], v2, s[4:7], s27 offen offset:1024 sc1
 buffer_load_dwordx4 v[198:201], v2, s[4:7], s27 offen offset:2048 sc1
 buffer_load_dwordx4 v[202:205], v2, s[4:7], s27 offen offset:3072 sc1
 buffer_load_dwordx4 v[206:209], v2, s[4:7], s28 offen offset:0 sc1
 buffer_load_dwordx4 v[210:213], v2, s[4:7], s28 offen offset:1024 sc1
 s_add_u32 s41, s41, 1
 s_cmp_gt_u32 s41, 200000
 s_cbranch_scc1 L_fail
 s_branch Lo_91
Los_94:
 buffer_load_dwordx4 v[194:197], v2, s[4:7], s27 offen offset:1024 sc1
 buffer_load_dwordx4 v[198:201], v2, s[4:7], s27 offen offset:2048 sc1
 buffer_load_dwordx4 v[202:205], v2, s[4:7], s27 offen offset:3072 sc1
 buffer_load_dwordx4 v[206:209], v2, s[4:7], s28 offen offset:0 sc1
 buffer_load_dwordx4 v[210:213], v2, s[4:7], s28 offen offset:1024 sc1
 s_waitcnt vmcnt(4)
 v_max3_u32 v1, v194, v195, v196
 v_max_u32 v1, v1, v197
 v_cmp_eq_u32 vcc, -1, v1
 s_add_u32 s41, s41, 1
 s_cmp_gt_u32 s41, 200000
 s_cbranch_scc1 L_fail
 s_branch Lo_93
Los_96:
 buffer_load_dwordx4 v[198:201], v2, s[4:7], s27 offen offset:2048 sc1
 buffer_load_dwordx4 v[202:205], v2, s[4:7], s27 offen offset:3072 sc1
 buffer_load_dwordx4 v[206:209], v2, s[4:7], s28 offen offset:0 sc1
 buffer_load_dwordx4 v[210:213], v2, s[4:7], s28 offen offset:1024 sc1
 s_waitcnt vmcnt(3)
 v_max3_u32 v1, v198, v199, v200
 v_max_u32 v1, v1, v201
 v_cmp_eq_u32 vcc, -1, v1
 s_add_u32 s41, s41, 1
 s_cmp_gt_u32 s41, 200000
 s_cbranch_scc1 L_fail
 s_branch Lo_95
Los_98:
 buffer_load_dwordx4 v[202:205], v2, s[4:7], s27 offen offset:3072 sc1
 buffer_load_dwordx4 v[206:209], v2, s[4:7], s28 offen offset:0 sc1
 buffer_load_dwordx4 v[210:213], v2, s[4:7], s28 offen offset:1024 sc1
 s_waitcnt vmcnt(2)
 v_max3_u32 v1, v202, v203, v204
 v_max_u32 v1, v1, v205
 v_cmp_eq_u32 vcc, -1, v1
 s_add_u32 s41, s41, 1
 s_cmp_gt_u32 s41, 200000
 s_cbranch_scc1 L_fail
 s_branch Lo_97
Los_100:
 buffer_load_dwordx4 v[206:209], v2, s[4:7], s28 offen offset:0 sc1
 buffer_load_dwordx4 v[210:213], v2, s[4:7], s28 offen offset:1024 sc1
 s_waitcnt vmcnt(1)
 v_max3_u32 v1, v206, v207, v208
 v_max_u32 v1, v1, v209
 v_cmp_eq_u32 vcc, -1, v1
 s_add_u32 s41, s41, 1
 s_cmp_gt_u32 s41, 200000
 s_cbranch_scc1 L_fail
 s_branch Lo_99
Los_102:
 buffer_load_dwordx4 v[210:213], v2, s[4:7], s28 offen offset:1024 sc1
 s_waitcnt vmcnt(0)
 v_max3_u32 v1, v210, v211, v212
 v_max_u32 v1, v1, v213
 v_cmp_eq_u32 vcc, -1, v1
 s_add_u32 s41, s41, 1
 s_cmp_gt_u32 s41, 200000
 s_cbranch_scc1 L_fail
 s_branch Lo_101
Ljs_105:
 buffer_load_dwordx4 v[190:193], v2, s[4:7], s27 offen offset:0 sc1
 buffer_load_dwordx4 v[194:197], v2, s[4:7], s27 offen offset:1024 sc1
 s_waitcnt vmcnt(0)
 s_add_u32 s41, s41, 1
 s_cmp_gt_u32 s41, 200000
 s_cbranch_scc1 L_fail
 s_branch Lj_104
Lov_108:
 s_mov_b32 exec_lo, 0xff00ff00
 s_mov_b32 exec_hi, 0xff00ff00
 v_mov_b32 v214, v128
 v_mov_b32 v215, v129
 s_mov_b64 exec, -1
 s_add_u32 s41, s41, 1
 s_cmp_gt_u32 s41, 200000
 s_cbranch_scc1 L_fail
 s_branch Lnov_109
Lpwn_73:
 s_cmp_eq_u32 s3, 2
 s_cbranch_scc0 Lpwn_110
 s_waitcnt vmcnt(0)
 s_barrier
L_rec_top_2l:
 s_mov_b32 s41, 0
 s_sleep 2
 buffer_load_dwordx4 v[190:193], v2, s[4:7], s56 offen offset:0 sc1
 s_nop 11
 buffer_load_dwordx4 v[194:197], v2, s[4:7], s56 offen offset:1024 sc1
 s_nop 11
 buffer_load_dwordx4 v[198:201], v2, s[4:7], s56 offen offset:2048 sc1
 s_nop 11
 buffer_load_dwordx4 v[202:205], v2, s[4:7], s56 offen offset:3072 sc1
 s_nop 11
 buffer_load_dwordx4 v[206:209], v2, s[4:7], s57 offen offset:0 sc1
Lz_111:
 s_waitcnt vmcnt(4)
 ds_write_b128 v108, v[190:193] offset:0
 v_mfma_f32_16x16x32_bf16 v[226:229], a[0:3], v[190:193], 0
 v_max3_u32 v1, v190, v191, v192
 v_max_u32 v1, v1, v193
 v_mfma_f32_16x16x32_bf16 v[230:233], a[80:83], v[190:193], 0
 v_cmp_eq_u32 vcc, -1, v1
 v_mfma_f32_16x16x32_bf16 v[234:237], a[160:163], v[190:193], 0
 s_cbranch_vccnz Lzs_112
Lz_113:
 s_waitcnt vmcnt(3)
 ds_write_b128 v108, v[194:197] offset:1024
 v_max3_u32 v1, v194, v195, v196
 v_max_u32 v1, v1, v197
 v_cmp_eq_u32 vcc, -1, v1
 s_cbranch_vccnz Lzs_114
 v_mfma_f32_16x16x32_bf16 v[226:229], a[4:7], v[194:197], v[226:229]
 v_mfma_f32_16x16x32_bf16 v[230:233], a[84:87], v[194:197], v[230:233]
 v_mfma_f32_16x16x32_bf16 v[234:237], a[164:167], v[194:197], v[234:237]
Lz_115:
 s_waitcnt vmcnt(2)
 ds_write_b128 v108, v[198:201] offset:2048
 v_max3_u32 v1, v198, v199, v200
 v_max_u32 v1, v1, v201
 v_cmp_eq_u32 vcc, -1, v1
 s_cbranch_vccnz Lzs_116
 v_mfma_f32_16x16x32_bf16 v[226:229], a[8:11], v[198:201], v[226:229]
 v_mfma_f32_16x16x32_bf16 v[230:233], a[88:91], v[198:201], v[230:233]
 v_mfma_f32_16x16x32_bf16 v[234:237], a[168:171], v[198:201], v[234:237]
Lz_117:
 s_waitcnt vmcnt(1)
 ds_write_b128 v108, v[202:205] offset:3072
 v_max3_u32 v1, v202, v203, v204
 v_max_u32 v1, v1, v205
 v_cmp_eq_u32 vcc, -1, v1
 s_cbranch_vccnz Lzs_118
Lz_119:
 s_waitcnt vmcnt(0)
 ds_write_b128 v108, v[206:209] offset:4096
 v_max3_u32 v1, v206, v207, v208
 v_max_u32 v1, v1, v209
 v_cmp_eq_u32 vcc, -1, v1
 s_cbranch_vccnz Lzs_120
 s_waitcnt lgkmcnt(0)
 s_barrier
 ds_read_b128 v[214:217], v109 offset:0
 ds_read_b128 v[218:221], v109 offset:1024
 ds_read_b128 v[222:225], v109 offset:2048
 v_mfma_f32_16x16x32_bf16 v[226:229], a[12:15], v[202:205], v[226:229]
 buffer_load_dword v126, v124, s[4:7], 0 offen sc1
 v_mfma_f32_16x16x32_bf16 v[230:233], a[92:95], v[202:205], v[230:233]
 v_mfma_f32_16x16x32_bf16 v[234:237], a[172:175], v[202:205], v[234:237]
 v_mfma_f32_16x16x32_bf16 v[226:229], a[16:19], v[206:209], v[226:229]
 s_add_u32 s25, s67, s50
 v_mfma_f32_16x16x32_bf16 v[230:233], a[96:99], v[206:209], v[230:233]
 buffer_load_dwordx4 v[142:145], v2, s[4:7], s25 offen sc1
 v_mfma_f32_16x16x32_bf16 v[234:237], a[176:179], v[206:209], v[234:237]
 ds_read_b128 v[210:213], v109 offset:3072
 s_waitcnt lgkmcnt(3)
 v_mfma_f32_16x16x32_bf16 v[226:229], a[20:23], v[214:217], v[226:229]
 s_add_u32 s25, s68, s50
 v_mfma_f32_16x16x32_bf16 v[230:233], a[100:103], v[214:217], v[230:233]
 buffer_load_dwordx4 v[150:153], v2, s[4:7], s25 offen sc1
 v_mfma_f32_16x16x32_bf16 v[234:237], a[180:183], v[214:217], v[234:237]
 ds_read_b128 v[214:217], v109 offset:4096
 s_waitcnt lgkmcnt(3)
 v_mfma_f32_16x16x32_bf16 v[226:229], a[24:27], v[218:221], v[226:229]
 s_add_u32 s25, s46, s63
 v_mfma_f32_16x16x32_bf16 v[230:233], a[104:107], v[218:221], v[230:233]
 s_add_u32 s25, s25, 0
 v_mfma_f32_16x16x32_bf16 v[234:237], a[184:187], v[218:221], v[234:237]
 buffer_store_dwordx4 v[182:185], v120, s[4:7], s25 offen sc1
 ds_read_b128 v[218:221], v110 offset:0
 s_waitcnt lgkmcnt(3)
 v_mfma_f32_16x16x32_bf16 v[226:229], a[28:31], v[222:225], v[226:229]
 s_add_u32 s25, s25, 8192
 s_mov_b32 exec_lo, 0xffff
 v_mfma_f32_16x16x32_bf16 v[230:233], a[108:111], v[222:225], v[230:233]
 s_mov_b32 exec_hi, 0xffff
 buffer_store_dwordx4 v[182:185], v120, s[4:7], s25 offen sc1
 v_mfma_f32_16x16x32_bf16 v[234:237], a[188:191], v[222:225], v[234:237]
 s_mov_b64 exec, -1
 ds_read_b128 v[222:225], v110 offset:1024
 s_waitcnt lgkmcnt(3)
 v_mfma_f32_16x16x32_bf16 v[226:229], a[32:35], v[210:213], v[226:229]
 s_add_u32 s25, s46, s63
 v_mfma_f32_16x16x32_bf16 v[230:233], a[112:115], v[210:213], v[230:233]
 s_add_u32 s25, s25, 655360
 v_mfma_f32_16x16x32_bf16 v[234:237], a[192:195], v[210:213], v[234:237]
 buffer_store_dwordx4 v[182:185], v120, s[4:7], s25 offen
 ds_read_b128 v[210:213], v110 offset:2048
 s_waitcnt lgkmcnt(3)
 v_mfma_f32_16x16x32_bf16 v[226:229], a[36:39], v[214:217], v[226:229]
 s_add_u32 s25, s25, 8192
 s_mov_b32 exec_lo, 0xffff
 v_mfma_f32_16x16x32_bf16 v[230:233], a[116:119], v[214:217], v[230:233]
 s_mov_b32 exec_hi, 0xffff
 buffer_store_dwordx4 v[182:185], v120, s[4:7], s25 offen
 v_mfma_f32_16x16x32_bf16 v[234:237], a[196:199], v[214:217], v[234:237]
 s_mov_b64 exec, -1
 ds_read_b128 v[214:217], v110 offset:3072
 s_waitcnt lgkmcnt(3)
 v_mfma_f32_16x16x32_bf16 v[226:229], a[40:43], v[218:221], v[226:229]
 s_add_u32 s25, s31, 1
 s_mul_i32 s67, s25, 393216
 v_mfma_f32_16x16x32_bf16 v[230:233], a[120:123], v[218:221], v[230:233]
 s_add_u32 s67, s67, 84312064
 s_cmp_lt_u32 s25, 64
 v_mfma_f32_16x16x32_bf16 v[234:237], a[200:203], v[218:221], v[234:237]
 s_cselect_b32 s67, s67, 2146435072
 ds_read_b128 v[218:221], v110 offset:4096
 s_waitcnt lgkmcnt(3)
 v_mfma_f32_16x16x32_bf16 v[226:229], a[44:47], v[222:225], v[226:229]
 s_sub_u32 s26, s25, 9
 s_mul_i32 s68, s26, 393216
 v_mfma_f32_16x16x32_bf16 v[230:233], a[124:127], v[222:225], v[230:233]
 s_add_u32 s68, s68, 134643712
 s_cmp_lt_u32 s26, 64
 v_mfma_f32_16x16x32_bf16 v[234:237], a[204:207], v[222:225], v[234:237]
 s_cselect_b32 s68, s68, 2146435072
 ds_read_b128 v[222:225], v111 offset:0
 s_waitcnt lgkmcnt(3)
 v_mfma_f32_16x16x32_bf16 v[226:229], a[48:51], v[210:213], v[226:229]
 s_add_u32 s25, s67, 4269801472
 s_add_u32 s26, s68, 4269801472
 v_mfma_f32_16x16x32_bf16 v[230:233], a[128:131], v[210:213], v[230:233]
 s_cmp_lt_u32 s3, 2
 s_cselect_b32 s66, s25, s26
 v_mfma_f32_16x16x32_bf16 v[234:237], a[208:211], v[210:213], v[234:237]
 s_add_u32 s66, s66, s49
 ds_read_b128 v[210:213], v111 offset:1024
 s_waitcnt lgkmcnt(3)
 v_mfma_f32_16x16x32_bf16 v[226:229], a[52:55], v[214:217], v[226:229]
 v_mfma_f32_16x16x32_bf16 v[230:233], a[132:135], v[214:217], v[230:233]
 v_mfma_f32_16x16x32_bf16 v[234:237], a[212:215], v[214:217], v[234:237]
 ds_read_b128 v[214:217], v111 offset:2048
 s_waitcnt lgkmcnt(3)
 v_mfma_f32_16x16x32_bf16 v[226:229], a[56:59], v[218:221], v[226:229]
 v_mfma_f32_16x16x32_bf16 v[230:233], a[136:139], v[218:221], v[230:233]
 v_mfma_f32_16x16x32_bf16 v[234:237], a[216:219], v[218:221], v[234:237]
 ds_read_b128 v[218:221], v111 offset:3072
 s_waitcnt lgkmcnt(3)
 v_mfma_f32_16x16x32_bf16 v[226:229], a[60:63], v[222:225], v[226:229]
 v_mfma_f32_16x16x32_bf16 v[230:233], a[140:143], v[222:225], v[230:233]
 v_mfma_f32_16x16x32_bf16 v[234:237], a[220:223], v[222:225], v[234:237]
 ds_read_b128 v[222:225], v111 offset:4096
 s_waitcnt lgkmcnt(3)
 v_mfma_f32_16x16x32_bf16 v[226:229], a[64:67], v[210:213], v[226:229]
 v_mfma_f32_16x16x32_bf16 v[230:233], a[144:147], v[210:213], v[230:233]
 v_mfma_f32_16x16x32_bf16 v[234:237], a[224:227], v[210:213], v[234:237]
 s_waitcnt lgkmcnt(2)
 v_mfma_f32_16x16x32_bf16 v[226:229], a[68:71], v[214:217], v[226:229]
 v_mfma_f32_16x16x32_bf16 v[230:233], a[148:151], v[214:217], v[230:233]
 v_mfma_f32_16x16x32_bf16 v[234:237], a[228:231], v[214:217], v[234:237]
 s_waitcnt lgkmcnt(1)
 v_mfma_f32_16x16x32_bf16 v[226:229], a[72:75], v[218:221], v[226:229]
 v_mfma_f32_16x16x32_bf16 v[230:233], a[152:155], v[218:221], v[230:233]
 v_mfma_f32_16x16x32_bf16 v[234:237], a[232:235], v[218:221], v[234:237]
 s_waitcnt lgkmcnt(0)
 v_mfma_f32_16x16x32_bf16 v[226:229], a[76:79], v[222:225], v[226:229]
 v_mfma_f32_16x16x32_bf16 v[230:233], a[156:159], v[222:225], v[230:233]
 v_mfma_f32_16x16x32_bf16 v[234:237], a[236:239], v[222:225], v[234:237]
 s_nop 1
 v_cvt_pk_bf16_f32 v190, v226, v227
 v_cvt_pk_bf16_f32 v191, v228, v229
 ds_write_b64 v112, v[190:191] offset:0
 v_cvt_pk_bf16_f32 v192, v230, v231
 v_cvt_pk_bf16_f32 v193, v232, v233
 ds_write_b64 v113, v[192:193] offset:0
 v_cvt_pk_bf16_f32 v194, v234, v235
 v_cvt_pk_bf16_f32 v195, v236, v237
 ds_write_b64 v112, v[194:195] offset:1024
 s_add_u32 s26, s60, s44
 s_add_u32 s27, s60, s45
 s_waitcnt lgkmcnt(0)
 s_barrier
 ds_read_b128 v[198:201], v3 offset:20480
 ds_read_b128 v[202:205], v3 offset:21504
 ds_read_b128 v[206:209], v3 offset:22528
 ds_read_b128 v[226:229], v3 offset:23552
 ds_read_b128 v[230:233], v3 offset:24576
 ds_read_b128 v[234:237], v3 offset:25600
 ds_read_b128 v[210:213], v108 offset:0
 ds_read_b128 v[214:217], v108 offset:1024
 ds_read_b128 v[218:221], v108 offset:2048
 s_waitcnt lgkmcnt(8)
 v_mfma_f32_16x16x32_bf16 v[194:197], v[130:133], v[198:201], 0
 s_waitcnt lgkmcnt(7)
 v_mfma_f32_16x16x32_bf16 v[194:197], v[134:137], v[202:205], v[194:197]
 s_waitcnt lgkmcnt(6)
 v_mfma_f32_16x16x32_bf16 v[194:197], v[138:141], v[206:209], v[194:197]
 s_waitcnt lgkmcnt(5)
 v_mfma_f32_16x16x32_bf16 v[190:193], v[226:229], v[198:201], v[158:161]
 s_waitcnt lgkmcnt(4)
 v_mfma_f32_16x16x32_bf16 v[190:193], v[230:233], v[202:205], v[190:193]
 s_mov_b32 exec_lo, 0xff00ff00
 s_mov_b32 exec_hi, 0xff00ff00
 s_waitcnt lgkmcnt(3)
 v_mfma_f32_16x16x32_bf16 v[190:193], v[234:237], v[206:209], v[190:193]
 buffer_store_dwordx4 v[194:197], v2, s[4:7], s26 offen offset:0
 ds_write_b128 v116, v[194:197] offset:26624
 s_mov_b64 exec, -1
 ds_read_b128 v[222:225], v108 offset:3072
 s_waitcnt lgkmcnt(4)
 v_mfma_f32_16x16x32_bf16 v[226:229], v[210:213], a[240:243], 0
 v_mfma_f32_16x16x32_bf16 v[230:233], v[210:213], v[68:71], 0
 ds_read_b128 v[210:213], v108 offset:4096
 s_waitcnt lgkmcnt(4)
 v_mfma_f32_16x16x32_bf16 v[226:229], v[214:217], a[244:247], v[226:229]
 v_mfma_f32_16x16x32_bf16 v[230:233], v[214:217], v[72:75], v[230:233]
 ds_read_b128 v[214:217], v109 offset:0
 s_waitcnt lgkmcnt(4)
 v_mfma_f32_16x16x32_bf16 v[226:229], v[218:221], a[248:251], v[226:229]
 v_mfma_f32_16x16x32_bf16 v[230:233], v[218:221], v[76:79], v[230:233]
 ds_read_b128 v[218:221], v109 offset:1024
 s_waitcnt lgkmcnt(3)
 v_mfma_f32_16x16x32_bf16 v[226:229], v[222:225], a[252:255], v[226:229]
 v_mfma_f32_16x16x32_bf16 v[230:233], v[222:225], v[80:83], v[230:233]
 s_waitcnt vmcnt(7)
 s_mov_b32 s41, 0
 v_min_i32 v1, 64, v125
 v_cmp_ge_i32 vcc, v126, v1
 s_nop 0
 s_cmp_eq_u64 vcc, -1
 s_cbranch_scc1 Lflok_122
Lfl_121:
 s_add_u32 s41, s41, 1
 s_cmp_gt_u32 s41, 200000
 s_cbranch_scc1 L_fail
 buffer_load_dword v126, v124, s[4:7], 0 offen sc1
 s_waitcnt vmcnt(0)
 v_cmp_ge_i32 vcc, v126, v1
 s_nop 0
 s_cmp_eq_u64 vcc, -1
 s_cbranch_scc0 Lfl_121
Lflok_122:
 v_add_u32 v125, 1, v125
 ds_read_b128 v[222:225], v109 offset:2048
 s_waitcnt lgkmcnt(3)
 v_mfma_f32_16x16x32_bf16 v[226:229], v[210:213], v[4:7], v[226:229]
 v_mfma_f32_16x16x32_bf16 v[230:233], v[210:213], v[84:87], v[230:233]
 s_barrier
 ds_read_b128 v[234:237], v3 offset:26624
 ds_read_b128 v[238:241], v3 offset:27648
 ds_read_b128 v[210:213], v109 offset:3072
 s_waitcnt lgkmcnt(5)
 v_mfma_f32_16x16x32_bf16 v[226:229], v[214:217], v[8:11], v[226:229]
 v_mfma_f32_16x16x32_bf16 v[230:233], v[214:217], v[88:91], v[230:233]
 ds_read_b128 v[214:217], v109 offset:4096
 s_waitcnt lgkmcnt(5)
 v_mfma_f32_16x16x32_bf16 v[226:229], v[218:221], v[12:15], v[226:229]
 v_mfma_f32_16x16x32_bf16 v[230:233], v[218:221], v[92:95], v[230:233]
 ds_read_b128 v[218:221], v110 offset:0
 s_waitcnt lgkmcnt(5)
 v_mfma_f32_16x16x32_bf16 v[226:229], v[222:225], v[16:19], v[226:229]
 v_mfma_f32_16x16x32_bf16 v[230:233], v[222:225], v[96:99], v[230:233]
 ds_read_b128 v[222:225], v110 offset:1024
 s_waitcnt lgkmcnt(3)
 v_mfma_f32_16x16x32_bf16 v[226:229], v[210:213], v[20:23], v[226:229]
 v_mfma_f32_16x16x32_bf16 v[230:233], v[210:213], v[100:103], v[230:233]
 buffer_load_dwordx4 v[194:197], v2, s[4:7], s27 offen offset:0 sc1
 ds_read_b128 v[210:213], v110 offset:2048
 s_waitcnt lgkmcnt(3)
 v_mfma_f32_16x16x32_bf16 v[226:229], v[214:217], v[24:27], v[226:229]
 v_mfma_f32_16x16x32_bf16 v[230:233], v[214:217], v[104:107], v[230:233]
 ds_read_b128 v[214:217], v110 offset:3072
 s_waitcnt lgkmcnt(3)
 v_mfma_f32_16x16x32_bf16 v[226:229], v[218:221], v[28:31], v[226:229]
 ds_read_b128 v[218:221], v110 offset:4096
 s_waitcnt lgkmcnt(3)
 v_mfma_f32_16x16x32_bf16 v[226:229], v[222:225], v[32:35], v[226:229]
 buffer_load_dwordx4 v[198:201], v2, s[4:7], s27 offen offset:1024 sc1
 ds_read_b128 v[222:225], v111 offset:0
 s_waitcnt lgkmcnt(3)
 v_mfma_f32_16x16x32_bf16 v[226:229], v[210:213], v[36:39], v[226:229]
 ds_write_b128 v116, v[230:233] offset:28672
 ds_read_b128 v[210:213], v111 offset:1024
 s_waitcnt lgkmcnt(4)
 v_mfma_f32_16x16x32_bf16 v[226:229], v[214:217], v[40:43], v[226:229]
 ds_read_b128 v[214:217], v111 offset:2048
 s_waitcnt lgkmcnt(4)
 v_mfma_f32_16x16x32_bf16 v[226:229], v[218:221], v[44:47], v[226:229]
 buffer_load_dwordx4 v[202:205], v2, s[4:7], s27 offen offset:2048 sc1
 ds_read_b128 v[218:221], v111 offset:3072
 s_waitcnt lgkmcnt(4)
 v_mfma_f32_16x16x32_bf16 v[226:229], v[222:225], v[48:51], v[226:229]
 ds_read_b128 v[222:225], v111 offset:4096
 s_waitcnt lgkmcnt(3)
 v_mfma_f32_16x16x32_bf16 v[226:229], v[210:213], v[52:55], v[226:229]
 s_waitcnt lgkmcnt(2)
 v_mfma_f32_16x16x32_bf16 v[226:229], v[214:217], v[56:59], v[226:229]
 s_barrier
 s_waitcnt lgkmcnt(1)
 v_mfma_f32_16x16x32_bf16 v[226:229], v[218:221], v[60:63], v[226:229]
 s_waitcnt lgkmcnt(0)
 v_mfma_f32_16x16x32_bf16 v[226:229], v[222:225], v[64:67], v[226:229]
 s_cmp_eq_u32 s31, 72
 s_cbranch_scc1 Lfin_123
 s_mov_b32 s41, 0
Lf_124:
 s_waitcnt vmcnt(2)
 v_add_f32 v210, v234, v194
 v_add_f32 v211, v235, v195
 v_add_f32 v212, v236, v196
 v_add_f32 v213, v237, v197
 s_waitcnt vmcnt(1)
 v_add_f32 v214, v238, v198
 v_add_f32 v215, v239, v199
 v_add_f32 v216, v240, v200
 v_add_f32 v217, v241, v201
 v_maximum3_f32 v1, v210, v211, v212
 v_maximum3_f32 v127, v213, v214, v215
 v_maximum3_f32 v1, v1, v216, v217
 s_waitcnt vmcnt(0)
 v_add_f32 v218, v190, v202
 v_add_f32 v219, v191, v203
 v_add_f32 v220, v192, v204
 v_add_f32 v221, v193, v205
 v_maximum3_f32 v127, v127, v218, v219
 v_maximum3_f32 v1, v1, v220, v221
 v_maximum3_f32 v1, v1, v127, v127
 v_cmp_u_f32 vcc, v1, v1
 v_mov_b32 v127, v1
 s_cbranch_vccnz Lfs_125
Lfok_126:
 s_nop 0
 v_permlane32_swap_b32 v1, v127
 v_max_f32 v1, v1, v127
 v_mov_b32 v127, v1
 v_cvt_pk_bf16_f32 v178, v226, v227
 v_cvt_pk_bf16_f32 v179, v228, v229
 v_permlane16_swap_b32 v1, v127
 v_max_f32 v1, v1, v127
 v_mul_f32 v1, s71, v1
 v_fma_f32 v210, v210, s71, -v1
 v_fma_f32 v211, v211, s71, -v1
 v_fma_f32 v212, v212, s71, -v1
 v_fma_f32 v213, v213, s71, -v1
 v_fma_f32 v214, v214, s71, -v1
 v_fma_f32 v215, v215, s71, -v1
 v_fma_f32 v216, v216, s71, -v1
 v_fma_f32 v217, v217, s71, -v1
 v_fma_f32 v218, v218, s71, -v1
 v_fma_f32 v219, v219, s71, -v1
 v_fma_f32 v220, v220, s71, -v1
 v_fma_f32 v221, v221, s71, -v1
 v_exp_f32 v210, v210
 v_exp_f32 v211, v211
 v_exp_f32 v212, v212
 v_exp_f32 v213, v213
 v_exp_f32 v214, v214
 v_exp_f32 v215, v215
 v_exp_f32 v216, v216
 v_exp_f32 v217, v217
 s_mov_b32 exec_lo, 0x00ff00ff
 s_mov_b32 exec_hi, 0x00ff00ff
 v_cvt_pk_bf16_f32 v162, v210, v211
 v_cvt_pk_bf16_f32 v163, v212, v213
 v_cvt_pk_bf16_f32 v164, v214, v215
 v_cvt_pk_bf16_f32 v165, v216, v217
 s_not_b64 exec, exec
 v_cvt_pk_bf16_f32 v166, v210, v211
 v_cvt_pk_bf16_f32 v167, v212, v213
 v_cvt_pk_bf16_f32 v168, v214, v215
 v_cvt_pk_bf16_f32 v169, v216, v217
 s_mov_b64 exec, -1
 v_mfma_f32_16x16x32_bf16 v[200:203], v[186:189], v[162:165], 0
 v_exp_f32 v218, v218
 v_exp_f32 v219, v219
 v_mfma_f32_16x16x32_bf16 v[192:195], v[142:145], v[162:165], 0
 v_exp_f32 v220, v220
 v_exp_f32 v221, v221
 v_mfma_f32_16x16x32_bf16 v[200:203], v[186:189], v[166:169], v[200:203]
 v_cvt_pk_bf16_f32 v190, v218, v219
 v_mfma_f32_16x16x32_bf16 v[192:195], v[150:153], v[166:169], v[192:195]
 v_cvt_pk_bf16_f32 v191, v220, v221
 s_nop 1
 v_mfma_f32_16x16x16_bf16 v[200:203], v[186:187], v[190:191], v[200:203]
 s_add_u32 s25, s60, s54
 s_add_u32 s27, s60, s55
 v_mfma_f32_16x16x16_bf16 v[192:195], v[178:179], v[190:191], v[192:195]
 s_add_u32 s28, s27, 4096
 s_mov_b32 s41, 0
 s_nop 2
 v_rcp_f32 v127, v200
 s_nop 1
 v_mul_f32 v192, v192, v127
 v_mul_f32 v193, v193, v127
 v_mul_f32 v194, v194, v127
 v_mul_f32 v195, v195, v127
 v_cvt_pk_bf16_f32 v204, v192, v193
 v_cvt_pk_bf16_f32 v205, v194, v195
 buffer_store_dwordx2 v[204:205], v2, s[4:7], s25 offen
 ds_write_b64 v117, v[178:179] offset:1024
 s_sleep 4
 buffer_load_dwordx4 v[190:193], v2, s[4:7], s27 offen offset:0 sc1
 ds_read_b128 v[142:145], v114 offset:0
 ds_read_b128 v[146:149], v114 offset:1024
 s_nop 7
 buffer_load_dwordx4 v[194:197], v2, s[4:7], s27 offen offset:1024 sc1
 ds_read_b128 v[150:153], v114 offset:2048
 ds_read_b128 v[154:157], v114 offset:3072
 s_nop 7
 buffer_load_dwordx4 v[198:201], v2, s[4:7], s27 offen offset:2048 sc1
 ds_read_b128 v[234:237], v114 offset:4096
 ds_read_b128 v[238:241], v114 offset:5120
 s_nop 7
 buffer_load_dwordx4 v[202:205], v2, s[4:7], s27 offen offset:3072 sc1
 ds_read_b128 v[242:245], v114 offset:6144
 ds_read_b128 v[246:249], v114 offset:7168
 s_nop 7
 buffer_load_dwordx4 v[206:209], v2, s[4:7], s28 offen offset:0 sc1
 s_nop 7
 buffer_load_dwordx4 v[210:213], v2, s[4:7], s28 offen offset:1024 sc1
 s_waitcnt lgkmcnt(0)
Lo_127:
 s_waitcnt vmcnt(5)
 v_max3_u32 v1, v190, v191, v192
 v_max_u32 v1, v1, v193
 v_cmp_eq_u32 vcc, -1, v1
 s_cbranch_vccnz Los_128
 v_mfma_f32_16x16x32_bf16 v[214:217], v[142:145], v[190:193], 0
 ds_read_b128 v[142:145], v114 offset:8192
 v_mfma_f32_16x16x32_bf16 v[218:221], v[146:149], v[190:193], 0
 ds_read_b128 v[146:149], v114 offset:9216
 s_waitcnt vmcnt(4)
 v_max3_u32 v1, v194, v195, v196
 v_mfma_f32_16x16x32_bf16 v[222:225], v[150:153], v[190:193], 0
 ds_read_b128 v[150:153], v114 offset:10240
 v_max_u32 v1, v1, v197
 v_mfma_f32_16x16x32_bf16 v[226:229], v[154:157], v[190:193], 0
 ds_read_b128 v[154:157], v114 offset:11264
 v_cmp_eq_u32 vcc, -1, v1
 v_mfma_f32_16x16x32_bf16 v[230:233], v[234:237], v[190:193], 0
 ds_read_b128 v[234:237], v114 offset:12288
Lo_129:
 s_cbranch_vccnz Los_130
 v_mfma_f32_16x16x32_bf16 v[214:217], v[238:241], v[194:197], v[214:217]
 ds_read_b128 v[238:241], v114 offset:13312
 v_mfma_f32_16x16x32_bf16 v[218:221], v[242:245], v[194:197], v[218:221]
 ds_read_b128 v[242:245], v114 offset:14336
 s_waitcnt vmcnt(3)
 v_max3_u32 v1, v198, v199, v200
 v_mfma_f32_16x16x32_bf16 v[222:225], v[246:249], v[194:197], v[222:225]
 ds_read_b128 v[246:249], v115 offset:0
 v_max_u32 v1, v1, v201
 s_waitcnt lgkmcnt(6)
 v_mfma_f32_16x16x32_bf16 v[226:229], v[142:145], v[194:197], v[226:229]
 ds_read_b128 v[142:145], v115 offset:1024
 v_cmp_eq_u32 vcc, -1, v1
 v_mfma_f32_16x16x32_bf16 v[230:233], v[146:149], v[194:197], v[230:233]
 ds_read_b128 v[146:149], v115 offset:2048
Lo_131:
 s_cbranch_vccnz Los_132
 s_waitcnt lgkmcnt(6)
 v_mfma_f32_16x16x32_bf16 v[214:217], v[150:153], v[198:201], v[214:217]
 ds_read_b128 v[150:153], v115 offset:3072
 v_mfma_f32_16x16x32_bf16 v[218:221], v[154:157], v[198:201], v[218:221]
 ds_read_b128 v[154:157], v115 offset:4096
 s_waitcnt vmcnt(2)
 v_max3_u32 v1, v202, v203, v204
 s_waitcnt lgkmcnt(6)
 v_mfma_f32_16x16x32_bf16 v[222:225], v[234:237], v[198:201], v[222:225]
 ds_read_b128 v[234:237], v115 offset:5120
 v_max_u32 v1, v1, v205
 v_mfma_f32_16x16x32_bf16 v[226:229], v[238:241], v[198:201], v[226:229]
 ds_read_b128 v[238:241], v115 offset:6144
 v_cmp_eq_u32 vcc, -1, v1
 s_waitcnt lgkmcnt(6)
 v_mfma_f32_16x16x32_bf16 v[230:233], v[242:245], v[198:201], v[230:233]
 ds_read_b128 v[242:245], v115 offset:7168
Lo_133:
 s_cbranch_vccnz Los_134
 v_mfma_f32_16x16x32_bf16 v[214:217], v[246:249], v[202:205], v[214:217]
 ds_read_b128 v[246:249], v115 offset:8192
 s_waitcnt lgkmcnt(6)
 v_mfma_f32_16x16x32_bf16 v[218:221], v[142:145], v[202:205], v[218:221]
 ds_read_b128 v[142:145], v115 offset:9216
 s_waitcnt vmcnt(1)
 v_max3_u32 v1, v206, v207, v208
 v_mfma_f32_16x16x32_bf16 v[222:225], v[146:149], v[202:205], v[222:225]
 ds_read_b128 v[146:149], v115 offset:10240
 v_max_u32 v1, v1, v209
 s_waitcnt lgkmcnt(6)
 v_mfma_f32_16x16x32_bf16 v[226:229], v[150:153], v[202:205], v[226:229]
 ds_read_b128 v[150:153], v115 offset:11264
 v_cmp_eq_u32 vcc, -1, v1
 v_mfma_f32_16x16x32_bf16 v[230:233], v[154:157], v[202:205], v[230:233]
 ds_read_b128 v[154:157], v115 offset:12288
Lo_135:
 s_cbranch_vccnz Los_136
 s_waitcnt lgkmcnt(6)
 v_mfma_f32_16x16x32_bf16 v[214:217], v[234:237], v[206:209], v[214:217]
 ds_read_b128 v[234:237], v115 offset:13312
 v_mfma_f32_16x16x32_bf16 v[218:221], v[238:241], v[206:209], v[218:221]
 ds_read_b128 v[238:241], v115 offset:14336
 s_waitcnt vmcnt(0)
 v_max3_u32 v1, v210, v211, v212
 s_waitcnt lgkmcnt(6)
 v_mfma_f32_16x16x32_bf16 v[222:225], v[242:245], v[206:209], v[222:225]
 v_max_u32 v1, v1, v213
 v_mfma_f32_16x16x32_bf16 v[226:229], v[246:249], v[206:209], v[226:229]
 v_cmp_eq_u32 vcc, -1, v1
 s_waitcnt lgkmcnt(4)
 v_mfma_f32_16x16x32_bf16 v[230:233], v[142:145], v[206:209], v[230:233]
Lo_137:
 s_cbranch_vccnz Los_138
 v_mfma_f32_16x16x32_bf16 v[214:217], v[146:149], v[210:213], v[214:217]
 buffer_load_dwordx4 v[130:133], v2, s[4:7], s66 offen sc1
 s_waitcnt lgkmcnt(2)
 v_mfma_f32_16x16x32_bf16 v[218:221], v[150:153], v[210:213], v[218:221]
 buffer_load_dwordx4 v[134:137], v2, s[4:7], s66 offen offset:2048 sc1
 v_mfma_f32_16x16x32_bf16 v[222:225], v[154:157], v[210:213], v[222:225]
 s_add_u32 s25, s66, 4096
 buffer_load_dwordx4 v[138:141], v2, s[4:7], s25 offen sc1
 s_waitcnt lgkmcnt(0)
 v_mfma_f32_16x16x32_bf16 v[226:229], v[234:237], v[210:213], v[226:229]
 v_mfma_f32_16x16x32_bf16 v[230:233], v[238:241], v[210:213], v[230:233]
 v_cvt_pk_bf16_f32 v190, v214, v215
 v_cvt_pk_bf16_f32 v191, v216, v217
 v_cvt_pk_bf16_f32 v192, v218, v219
 v_cvt_pk_bf16_f32 v193, v220, v221
 ds_write_b128 v118, v[190:193]
 v_cvt_pk_bf16_f32 v194, v222, v223
 v_cvt_pk_bf16_f32 v195, v224, v225
 v_cvt_pk_bf16_f32 v196, v226, v227
 v_cvt_pk_bf16_f32 v197, v228, v229
 ds_write_b128 v118, v[194:197] offset:4096
 v_cvt_pk_bf16_f32 v198, v230, v231
 v_cvt_pk_bf16_f32 v199, v232, v233
 ds_write_b64 v119, v[198:199] offset:8192
 s_add_u32 s25, s62, s46
 s_add_u32 s26, s25, 8192
 s_add_u32 s27, s25, 655360
 s_add_u32 s28, s26, 655360
 s_waitcnt lgkmcnt(0)
 s_barrier
 ds_read_b128 v[190:193], v3 offset:0
 ds_read_b128 v[194:197], v3 offset:1024
 ds_read_b128 v[198:201], v3 offset:2048
 ds_read_b128 v[202:205], v3 offset:3072
 ds_read_b128 v[206:209], v3 offset:8192
 ds_read_b128 v[210:213], v3 offset:9216
 s_waitcnt lgkmcnt(5)
 v_mfma_f32_16x16x32_bf16 v[214:217], v[170:173], v[190:193], 0
 s_waitcnt lgkmcnt(4)
 v_mfma_f32_16x16x32_bf16 v[214:217], v[174:177], v[194:197], v[214:217]
 s_waitcnt lgkmcnt(3)
 v_mfma_f32_16x16x32_bf16 v[218:221], v[170:173], v[198:201], 0
 s_waitcnt lgkmcnt(2)
 v_mfma_f32_16x16x32_bf16 v[218:221], v[174:177], v[202:205], v[218:221]
 s_waitcnt lgkmcnt(1)
 v_mfma_f32_16x16x32_bf16 v[222:225], v[170:173], v[206:209], 0
 v_cvt_pk_bf16_f32 v226, v214, v215
 v_cvt_pk_bf16_f32 v227, v216, v217
 s_waitcnt lgkmcnt(0)
 v_mfma_f32_16x16x32_bf16 v[222:225], v[174:177], v[210:213], v[222:225]
 s_nop 1
 v_cvt_pk_bf16_f32 v228, v218, v219
 v_cvt_pk_bf16_f32 v229, v220, v221
 s_nop 0
 v_permlane16_swap_b32 v226, v228
 v_permlane16_swap_b32 v227, v229
 buffer_store_dwordx4 v[226:229], v120, s[4:7], s25 offen sc1
 v_cvt_pk_bf16_f32 v230, v222, v223
 v_cvt_pk_bf16_f32 v231, v224, v225
 v_cvt_pk_bf16_f32 v232, v222, v223
 v_cvt_pk_bf16_f32 v233, v224, v225
 s_nop 0
 v_permlane16_swap_b32 v230, v232
 v_permlane16_swap_b32 v231, v233
 s_mov_b32 exec_lo, 0xffff
 s_mov_b32 exec_hi, 0xffff
 buffer_store_dwordx4 v[230:233], v120, s[4:7], s26 offen sc1
 buffer_store_dwordx4 v[230:233], v120, s[4:7], s28 offen
 s_mov_b64 exec, -1
 buffer_store_dwordx4 v[226:229], v120, s[4:7], s27 offen
 s_add_u32 s70, s69, s52
 s_add_u32 s27, s62, s47
 s_add_u32 s28, s62, s48
 s_add_u32 s69, s31, 1
 s_and_b32 s25, s69, 3
 s_mul_i32 s26, s25, 20480
 s_add_u32 s56, s26, s42
 s_add_u32 s57, s56, 4096
 s_add_u32 s58, s26, s43
 s_mul_i32 s62, s25, 163840
 s_xor_b32 s26, s25, 2
 s_mul_i32 s63, s26, 163840
 s_add_u32 s25, s25, 3
 s_and_b32 s25, s25, 3
 s_mul_i32 s26, s25, 20480
 s_add_u32 s59, s26, s43
 s_and_b32 s25, s69, 1
 s_mul_i32 s60, s25, 196608
 s_xor_b32 s25, s25, 1
 s_mul_i32 s61, s25, 196608
 s_mul_i32 s69, s69, 196608
 s_add_u32 s31, s31, 1
 s_barrier
 s_branch L_rec_top_2l
Lfin_123:
 s_waitcnt lgkmcnt(0)
 s_nop 4
 v_cvt_pk_bf16_f32 v178, v226, v227
 v_cvt_pk_bf16_f32 v179, v228, v229
 ds_write_b64 v117, v[178:179] offset:1024
 s_waitcnt lgkmcnt(0)
 s_barrier
 s_endpgm
Lzs_112:
 buffer_load_dwordx4 v[190:193], v2, s[4:7], s56 offen offset:0 sc1
 buffer_load_dwordx4 v[194:197], v2, s[4:7], s56 offen offset:1024 sc1
 buffer_load_dwordx4 v[198:201], v2, s[4:7], s56 offen offset:2048 sc1
 buffer_load_dwordx4 v[202:205], v2, s[4:7], s56 offen offset:3072 sc1
 buffer_load_dwordx4 v[206:209], v2, s[4:7], s57 offen offset:0 sc1
 s_add_u32 s41, s41, 1
 s_cmp_gt_u32 s41, 200000
 s_cbranch_scc1 L_fail
 s_branch Lz_111
Lzs_114:
 buffer_load_dwordx4 v[194:197], v2, s[4:7], s56 offen offset:1024 sc1
 buffer_load_dwordx4 v[198:201], v2, s[4:7], s56 offen offset:2048 sc1
 buffer_load_dwordx4 v[202:205], v2, s[4:7], s56 offen offset:3072 sc1
 buffer_load_dwordx4 v[206:209], v2, s[4:7], s57 offen offset:0 sc1
 s_add_u32 s41, s41, 1
 s_cmp_gt_u32 s41, 200000
 s_cbranch_scc1 L_fail
 s_branch Lz_113
Lzs_116:
 buffer_load_dwordx4 v[198:201], v2, s[4:7], s56 offen offset:2048 sc1
 buffer_load_dwordx4 v[202:205], v2, s[4:7], s56 offen offset:3072 sc1
 buffer_load_dwordx4 v[206:209], v2, s[4:7], s57 offen offset:0 sc1
 s_add_u32 s41, s41, 1
 s_cmp_gt_u32 s41, 200000
 s_cbranch_scc1 L_fail
 s_branch Lz_115
Lzs_118:
 buffer_load_dwordx4 v[202:205], v2, s[4:7], s56 offen offset:3072 sc1
 buffer_load_dwordx4 v[206:209], v2, s[4:7], s57 offen offset:0 sc1
 s_add_u32 s41, s41, 1
 s_cmp_gt_u32 s41, 200000
 s_cbranch_scc1 L_fail
 s_branch Lz_117
Lzs_120:
 buffer_load_dwordx4 v[206:209], v2, s[4:7], s57 offen offset:0 sc1
 s_add_u32 s41, s41, 1
 s_cmp_gt_u32 s41, 200000
 s_cbranch_scc1 L_fail
 s_branch Lz_119
Lfs_125:
 v_max3_u32 v222, v194, v195, v196
 v_max3_u32 v222, v222, v197, v198
 v_max3_u32 v222, v222, v199, v200
 v_max3_u32 v222, v222, v201, v202
 v_max3_u32 v222, v222, v203, v204
 v_max_u32 v222, v222, v205
 v_cmp_eq_u32 vcc, -1, v222
 s_cbranch_vccz Lfok_126
 buffer_load_dwordx4 v[194:197], v2, s[4:7], s27 offen offset:0 sc1
 buffer_load_dwordx4 v[198:201], v2, s[4:7], s27 offen offset:1024 sc1
 buffer_load_dwordx4 v[202:205], v2, s[4:7], s27 offen offset:2048 sc1
 s_add_u32 s41, s41, 1
 s_cmp_gt_u32 s41, 200000
 s_cbranch_scc1 L_fail
 s_branch Lf_124
Los_128:
 buffer_load_dwordx4 v[190:193], v2, s[4:7], s27 offen offset:0 sc1
 buffer_load_dwordx4 v[194:197], v2, s[4:7], s27 offen offset:1024 sc1
 buffer_load_dwordx4 v[198:201], v2, s[4:7], s27 offen offset:2048 sc1
 buffer_load_dwordx4 v[202:205], v2, s[4:7], s27 offen offset:3072 sc1
 buffer_load_dwordx4 v[206:209], v2, s[4:7], s28 offen offset:0 sc1
 buffer_load_dwordx4 v[210:213], v2, s[4:7], s28 offen offset:1024 sc1
 s_add_u32 s41, s41, 1
 s_cmp_gt_u32 s41, 200000
 s_cbranch_scc1 L_fail
 s_branch Lo_127
Los_130:
 buffer_load_dwordx4 v[194:197], v2, s[4:7], s27 offen offset:1024 sc1
 buffer_load_dwordx4 v[198:201], v2, s[4:7], s27 offen offset:2048 sc1
 buffer_load_dwordx4 v[202:205], v2, s[4:7], s27 offen offset:3072 sc1
 buffer_load_dwordx4 v[206:209], v2, s[4:7], s28 offen offset:0 sc1
 buffer_load_dwordx4 v[210:213], v2, s[4:7], s28 offen offset:1024 sc1
 s_waitcnt vmcnt(4)
 v_max3_u32 v1, v194, v195, v196
 v_max_u32 v1, v1, v197
 v_cmp_eq_u32 vcc, -1, v1
 s_add_u32 s41, s41, 1
 s_cmp_gt_u32 s41, 200000
 s_cbranch_scc1 L_fail
 s_branch Lo_129
Los_132:
 buffer_load_dwordx4 v[198:201], v2, s[4:7], s27 offen offset:2048 sc1
 buffer_load_dwordx4 v[202:205], v2, s[4:7], s27 offen offset:3072 sc1
 buffer_load_dwordx4 v[206:209], v2, s[4:7], s28 offen offset:0 sc1
 buffer_load_dwordx4 v[210:213], v2, s[4:7], s28 offen offset:1024 sc1
 s_waitcnt vmcnt(3)
 v_max3_u32 v1, v198, v199, v200
 v_max_u32 v1, v1, v201
 v_cmp_eq_u32 vcc, -1, v1
 s_add_u32 s41, s41, 1
 s_cmp_gt_u32 s41, 200000
 s_cbranch_scc1 L_fail
 s_branch Lo_131
Los_134:
 buffer_load_dwordx4 v[202:205], v2, s[4:7], s27 offen offset:3072 sc1
 buffer_load_dwordx4 v[206:209], v2, s[4:7], s28 offen offset:0 sc1
 buffer_load_dwordx4 v[210:213], v2, s[4:7], s28 offen offset:1024 sc1
 s_waitcnt vmcnt(2)
 v_max3_u32 v1, v202, v203, v204
 v_max_u32 v1, v1, v205
 v_cmp_eq_u32 vcc, -1, v1
 s_add_u32 s41, s41, 1
 s_cmp_gt_u32 s41, 200000
 s_cbranch_scc1 L_fail
 s_branch Lo_133
Los_136:
 buffer_load_dwordx4 v[206:209], v2, s[4:7], s28 offen offset:0 sc1
 buffer_load_dwordx4 v[210:213], v2, s[4:7], s28 offen offset:1024 sc1
 s_waitcnt vmcnt(1)
 v_max3_u32 v1, v206, v207, v208
 v_max_u32 v1, v1, v209
 v_cmp_eq_u32 vcc, -1, v1
 s_add_u32 s41, s41, 1
 s_cmp_gt_u32 s41, 200000
 s_cbranch_scc1 L_fail
 s_branch Lo_135
Los_138:
 buffer_load_dwordx4 v[210:213], v2, s[4:7], s28 offen offset:1024 sc1
 s_waitcnt vmcnt(0)
 v_max3_u32 v1, v210, v211, v212
 v_max_u32 v1, v1, v213
 v_cmp_eq_u32 vcc, -1, v1
 s_add_u32 s41, s41, 1
 s_cmp_gt_u32 s41, 200000
 s_cbranch_scc1 L_fail
 s_branch Lo_137
Lpwn_110:
 s_waitcnt vmcnt(0)
 s_barrier
L_rec_top_3l:
 s_mov_b32 s41, 0
 s_sleep 2
 buffer_load_dwordx4 v[190:193], v2, s[4:7], s56 offen offset:0 sc1
 s_nop 11
 buffer_load_dwordx4 v[194:197], v2, s[4:7], s56 offen offset:1024 sc1
 s_nop 11
 buffer_load_dwordx4 v[198:201], v2, s[4:7], s56 offen offset:2048 sc1
 s_nop 11
 buffer_load_dwordx4 v[202:205], v2, s[4:7], s56 offen offset:3072 sc1
 s_nop 11
 buffer_load_dwordx4 v[206:209], v2, s[4:7], s57 offen offset:0 sc1
Lz_140:
 s_waitcnt vmcnt(4)
 ds_write_b128 v108, v[190:193] offset:0
 v_mfma_f32_16x16x32_bf16 v[226:229], a[0:3], v[190:193], 0
 v_max3_u32 v1, v190, v191, v192
 v_max_u32 v1, v1, v193
 v_mfma_f32_16x16x32_bf16 v[230:233], a[80:83], v[190:193], 0
 v_cmp_eq_u32 vcc, -1, v1
 v_mfma_f32_16x16x32_bf16 v[234:237], a[160:163], v[190:193], 0
 s_cbranch_vccnz Lzs_141
Lz_142:
 s_waitcnt vmcnt(3)
 ds_write_b128 v108, v[194:197] offset:1024
 v_max3_u32 v1, v194, v195, v196
 v_max_u32 v1, v1, v197
 v_cmp_eq_u32 vcc, -1, v1
 s_cbranch_vccnz Lzs_143
 v_mfma_f32_16x16x32_bf16 v[226:229], a[4:7], v[194:197], v[226:229]
 v_mfma_f32_16x16x32_bf16 v[230:233], a[84:87], v[194:197], v[230:233]
 v_mfma_f32_16x16x32_bf16 v[234:237], a[164:167], v[194:197], v[234:237]
Lz_144:
 s_waitcnt vmcnt(2)
 ds_write_b128 v108, v[198:201] offset:2048
 v_max3_u32 v1, v198, v199, v200
 v_max_u32 v1, v1, v201
 v_cmp_eq_u32 vcc, -1, v1
 s_cbranch_vccnz Lzs_145
 v_mfma_f32_16x16x32_bf16 v[226:229], a[8:11], v[198:201], v[226:229]
 v_mfma_f32_16x16x32_bf16 v[230:233], a[88:91], v[198:201], v[230:233]
 v_mfma_f32_16x16x32_bf16 v[234:237], a[168:171], v[198:201], v[234:237]
Lz_146:
 s_waitcnt vmcnt(1)
 ds_write_b128 v108, v[202:205] offset:3072
 v_max3_u32 v1, v202, v203, v204
 v_max_u32 v1, v1, v205
 v_cmp_eq_u32 vcc, -1, v1
 s_cbranch_vccnz Lzs_147
Lz_148:
 s_waitcnt vmcnt(0)
 ds_write_b128 v108, v[206:209] offset:4096
 v_max3_u32 v1, v206, v207, v208
 v_max_u32 v1, v1, v209
 v_cmp_eq_u32 vcc, -1, v1
 s_cbranch_vccnz Lzs_149
 s_waitcnt lgkmcnt(0)
 s_barrier
 ds_read_b128 v[214:217], v109 offset:0
 ds_read_b128 v[218:221], v109 offset:1024
 ds_read_b128 v[222:225], v109 offset:2048
 v_mfma_f32_16x16x32_bf16 v[226:229], a[12:15], v[202:205], v[226:229]
 buffer_load_dword v126, v124, s[4:7], 0 offen sc1
 v_mfma_f32_16x16x32_bf16 v[230:233], a[92:95], v[202:205], v[230:233]
 v_mfma_f32_16x16x32_bf16 v[234:237], a[172:175], v[202:205], v[234:237]
 v_mfma_f32_16x16x32_bf16 v[226:229], a[16:19], v[206:209], v[226:229]
 s_add_u32 s25, s67, s50
 v_mfma_f32_16x16x32_bf16 v[230:233], a[96:99], v[206:209], v[230:233]
 buffer_load_dwordx4 v[142:145], v2, s[4:7], s25 offen sc1
 v_mfma_f32_16x16x32_bf16 v[234:237], a[176:179], v[206:209], v[234:237]
 ds_read_b128 v[210:213], v109 offset:3072
 s_waitcnt lgkmcnt(3)
 v_mfma_f32_16x16x32_bf16 v[226:229], a[20:23], v[214:217], v[226:229]
 s_add_u32 s25, s68, s50
 v_mfma_f32_16x16x32_bf16 v[230:233], a[100:103], v[214:217], v[230:233]
 buffer_load_dwordx4 v[150:153], v2, s[4:7], s25 offen sc1
 v_mfma_f32_16x16x32_bf16 v[234:237], a[180:183], v[214:217], v[234:237]
 ds_read_b128 v[214:217], v109 offset:4096
 s_waitcnt lgkmcnt(3)
 v_mfma_f32_16x16x32_bf16 v[226:229], a[24:27], v[218:221], v[226:229]
 s_add_u32 s25, s46, s63
 v_mfma_f32_16x16x32_bf16 v[230:233], a[104:107], v[218:221], v[230:233]
 s_add_u32 s25, s25, 0
 v_mfma_f32_16x16x32_bf16 v[234:237], a[184:187], v[218:221], v[234:237]
 buffer_store_dwordx4 v[182:185], v120, s[4:7], s25 offen sc1
 ds_read_b128 v[218:221], v110 offset:0
 s_waitcnt lgkmcnt(3)
 v_mfma_f32_16x16x32_bf16 v[226:229], a[28:31], v[222:225], v[226:229]
 s_add_u32 s25, s46, s63
 v_mfma_f32_16x16x32_bf16 v[230:233], a[108:111], v[222:225], v[230:233]
 s_add_u32 s25, s25, 655360
 v_mfma_f32_16x16x32_bf16 v[234:237], a[188:191], v[222:225], v[234:237]
 buffer_store_dwordx4 v[182:185], v120, s[4:7], s25 offen
 ds_read_b128 v[222:225], v110 offset:1024
 s_waitcnt lgkmcnt(3)
 v_mfma_f32_16x16x32_bf16 v[226:229], a[32:35], v[210:213], v[226:229]
 s_add_u32 s25, s31, 1
 s_mul_i32 s67, s25, 393216
 v_mfma_f32_16x16x32_bf16 v[230:233], a[112:115], v[210:213], v[230:233]
 s_add_u32 s67, s67, 84312064
 s_cmp_lt_u32 s25, 64
 v_mfma_f32_16x16x32_bf16 v[234:237], a[192:195], v[210:213], v[234:237]
 s_cselect_b32 s67, s67, 2146435072
 ds_read_b128 v[210:213], v110 offset:2048
 s_waitcnt lgkmcnt(3)
 v_mfma_f32_16x16x32_bf16 v[226:229], a[36:39], v[214:217], v[226:229]
 s_sub_u32 s26, s25, 9
 s_mul_i32 s68, s26, 393216
 v_mfma_f32_16x16x32_bf16 v[230:233], a[116:119], v[214:217], v[230:233]
 s_add_u32 s68, s68, 134643712
 s_cmp_lt_u32 s26, 64
 v_mfma_f32_16x16x32_bf16 v[234:237], a[196:199], v[214:217], v[234:237]
 s_cselect_b32 s68, s68, 2146435072
 ds_read_b128 v[214:217], v110 offset:3072
 s_waitcnt lgkmcnt(3)
 v_mfma_f32_16x16x32_bf16 v[226:229], a[40:43], v[218:221], v[226:229]
 s_add_u32 s25, s67, 4269801472
 s_add_u32 s26, s68, 4269801472
 v_mfma_f32_16x16x32_bf16 v[230:233], a[120:123], v[218:221], v[230:233]
 s_cmp_lt_u32 s3, 2
 s_cselect_b32 s66, s25, s26
 v_mfma_f32_16x16x32_bf16 v[234:237], a[200:203], v[218:221], v[234:237]
 s_add_u32 s66, s66, s49
 ds_read_b128 v[218:221], v110 offset:4096
 s_waitcnt lgkmcnt(3)
 v_mfma_f32_16x16x32_bf16 v[226:229], a[44:47], v[222:225], v[226:229]
 v_mfma_f32_16x16x32_bf16 v[230:233], a[124:127], v[222:225], v[230:233]
 v_mfma_f32_16x16x32_bf16 v[234:237], a[204:207], v[222:225], v[234:237]
 ds_read_b128 v[222:225], v111 offset:0
 s_waitcnt lgkmcnt(3)
 v_mfma_f32_16x16x32_bf16 v[226:229], a[48:51], v[210:213], v[226:229]
 v_mfma_f32_16x16x32_bf16 v[230:233], a[128:131], v[210:213], v[230:233]
 v_mfma_f32_16x16x32_bf16 v[234:237], a[208:211], v[210:213], v[234:237]
 ds_read_b128 v[210:213], v111 offset:1024
 s_waitcnt lgkmcnt(3)
 v_mfma_f32_16x16x32_bf16 v[226:229], a[52:55], v[214:217], v[226:229]
 v_mfma_f32_16x16x32_bf16 v[230:233], a[132:135], v[214:217], v[230:233]
 v_mfma_f32_16x16x32_bf16 v[234:237], a[212:215], v[214:217], v[234:237]
 ds_read_b128 v[214:217], v111 offset:2048
 s_waitcnt lgkmcnt(3)
 v_mfma_f32_16x16x32_bf16 v[226:229], a[56:59], v[218:221], v[226:229]
 v_mfma_f32_16x16x32_bf16 v[230:233], a[136:139], v[218:221], v[230:233]
 v_mfma_f32_16x16x32_bf16 v[234:237], a[216:219], v[218:221], v[234:237]
 ds_read_b128 v[218:221], v111 offset:3072
 s_waitcnt lgkmcnt(3)
 v_mfma_f32_16x16x32_bf16 v[226:229], a[60:63], v[222:225], v[226:229]
 v_mfma_f32_16x16x32_bf16 v[230:233], a[140:143], v[222:225], v[230:233]
 v_mfma_f32_16x16x32_bf16 v[234:237], a[220:223], v[222:225], v[234:237]
 ds_read_b128 v[222:225], v111 offset:4096
 s_waitcnt lgkmcnt(3)
 v_mfma_f32_16x16x32_bf16 v[226:229], a[64:67], v[210:213], v[226:229]
 v_mfma_f32_16x16x32_bf16 v[230:233], a[144:147], v[210:213], v[230:233]
 v_mfma_f32_16x16x32_bf16 v[234:237], a[224:227], v[210:213], v[234:237]
 s_waitcnt lgkmcnt(2)
 v_mfma_f32_16x16x32_bf16 v[226:229], a[68:71], v[214:217], v[226:229]
 v_mfma_f32_16x16x32_bf16 v[230:233], a[148:151], v[214:217], v[230:233]
 v_mfma_f32_16x16x32_bf16 v[234:237], a[228:231], v[214:217], v[234:237]
 s_waitcnt lgkmcnt(1)
 v_mfma_f32_16x16x32_bf16 v[226:229], a[72:75], v[218:221], v[226:229]
 v_mfma_f32_16x16x32_bf16 v[230:233], a[152:155], v[218:221], v[230:233]
 v_mfma_f32_16x16x32_bf16 v[234:237], a[232:235], v[218:221], v[234:237]
 s_waitcnt lgkmcnt(0)
 v_mfma_f32_16x16x32_bf16 v[226:229], a[76:79], v[222:225], v[226:229]
 v_mfma_f32_16x16x32_bf16 v[230:233], a[156:159], v[222:225], v[230:233]
 v_mfma_f32_16x16x32_bf16 v[234:237], a[236:239], v[222:225], v[234:237]
 s_nop 1
 v_cvt_pk_bf16_f32 v190, v226, v227
 v_cvt_pk_bf16_f32 v191, v228, v229
 ds_write_b64 v112, v[190:191] offset:0
 v_cvt_pk_bf16_f32 v192, v230, v231
 v_cvt_pk_bf16_f32 v193, v232, v233
 ds_write_b64 v113, v[192:193] offset:0
 v_cvt_pk_bf16_f32 v194, v234, v235
 v_cvt_pk_bf16_f32 v195, v236, v237
 ds_write_b64 v112, v[194:195] offset:1024
 s_add_u32 s26, s60, s44
 s_add_u32 s27, s60, s45
 s_waitcnt lgkmcnt(0)
 s_barrier
 ds_read_b128 v[198:201], v3 offset:20480
 ds_read_b128 v[202:205], v3 offset:21504
 ds_read_b128 v[206:209], v3 offset:22528
 ds_read_b128 v[226:229], v3 offset:23552
 ds_read_b128 v[230:233], v3 offset:24576
 ds_read_b128 v[234:237], v3 offset:25600
 ds_read_b128 v[210:213], v108 offset:0
 ds_read_b128 v[214:217], v108 offset:1024
 ds_read_b128 v[218:221], v108 offset:2048
 s_waitcnt lgkmcnt(8)
 v_mfma_f32_16x16x32_bf16 v[194:197], v[130:133], v[198:201], 0
 s_waitcnt lgkmcnt(7)
 v_mfma_f32_16x16x32_bf16 v[194:197], v[134:137], v[202:205], v[194:197]
 s_waitcnt lgkmcnt(6)
 v_mfma_f32_16x16x32_bf16 v[194:197], v[138:141], v[206:209], v[194:197]
 s_waitcnt lgkmcnt(5)
 v_mfma_f32_16x16x32_bf16 v[190:193], v[226:229], v[198:201], v[158:161]
 s_waitcnt lgkmcnt(4)
 v_mfma_f32_16x16x32_bf16 v[190:193], v[230:233], v[202:205], v[190:193]
 s_mov_b32 exec_lo, 0xff00ff00
 s_mov_b32 exec_hi, 0xff00ff00
 s_waitcnt lgkmcnt(3)
 v_mfma_f32_16x16x32_bf16 v[190:193], v[234:237], v[206:209], v[190:193]
 buffer_store_dwordx4 v[194:197], v2, s[4:7], s26 offen offset:1024
 ds_write_b128 v116, v[194:197] offset:26624
 s_mov_b64 exec, -1
 ds_read_b128 v[222:225], v108 offset:3072
 s_waitcnt lgkmcnt(4)
 v_mfma_f32_16x16x32_bf16 v[226:229], v[210:213], a[240:243], 0
 v_mfma_f32_16x16x32_bf16 v[230:233], v[210:213], v[68:71], 0
 s_nop 0
 buffer_store_dwordx4 v[190:193], v2, s[4:7], s26 offen offset:2048
 ds_read_b128 v[210:213], v108 offset:4096
 s_waitcnt lgkmcnt(4)
 v_mfma_f32_16x16x32_bf16 v[226:229], v[214:217], a[244:247], v[226:229]
 v_mfma_f32_16x16x32_bf16 v[230:233], v[214:217], v[72:75], v[230:233]
 ds_read_b128 v[214:217], v109 offset:0
 s_waitcnt lgkmcnt(4)
 v_mfma_f32_16x16x32_bf16 v[226:229], v[218:221], a[248:251], v[226:229]
 v_mfma_f32_16x16x32_bf16 v[230:233], v[218:221], v[76:79], v[230:233]
 ds_read_b128 v[218:221], v109 offset:1024
 s_waitcnt lgkmcnt(3)
 v_mfma_f32_16x16x32_bf16 v[226:229], v[222:225], a[252:255], v[226:229]
 v_mfma_f32_16x16x32_bf16 v[230:233], v[222:225], v[80:83], v[230:233]
 s_waitcnt vmcnt(6)
 s_mov_b32 s41, 0
 v_min_i32 v1, 64, v125
 v_cmp_ge_i32 vcc, v126, v1
 s_nop 0
 s_cmp_eq_u64 vcc, -1
 s_cbranch_scc1 Lflok_151
Lfl_150:
 s_add_u32 s41, s41, 1
 s_cmp_gt_u32 s41, 200000
 s_cbranch_scc1 L_fail
 buffer_load_dword v126, v124, s[4:7], 0 offen sc1
 s_waitcnt vmcnt(0)
 v_cmp_ge_i32 vcc, v126, v1
 s_nop 0
 s_cmp_eq_u64 vcc, -1
 s_cbranch_scc0 Lfl_150
Lflok_151:
 v_add_u32 v125, 1, v125
 ds_read_b128 v[222:225], v109 offset:2048
 s_waitcnt lgkmcnt(3)
 v_mfma_f32_16x16x32_bf16 v[226:229], v[210:213], v[4:7], v[226:229]
 v_mfma_f32_16x16x32_bf16 v[230:233], v[210:213], v[84:87], v[230:233]
 s_barrier
 ds_read_b128 v[234:237], v3 offset:26624
 ds_read_b128 v[238:241], v3 offset:27648
 ds_read_b128 v[210:213], v109 offset:3072
 s_waitcnt lgkmcnt(5)
 v_mfma_f32_16x16x32_bf16 v[226:229], v[214:217], v[8:11], v[226:229]
 v_mfma_f32_16x16x32_bf16 v[230:233], v[214:217], v[88:91], v[230:233]
 ds_read_b128 v[214:217], v109 offset:4096
 s_waitcnt lgkmcnt(5)
 v_mfma_f32_16x16x32_bf16 v[226:229], v[218:221], v[12:15], v[226:229]
 v_mfma_f32_16x16x32_bf16 v[230:233], v[218:221], v[92:95], v[230:233]
 ds_read_b128 v[218:221], v110 offset:0
 s_waitcnt lgkmcnt(5)
 v_mfma_f32_16x16x32_bf16 v[226:229], v[222:225], v[16:19], v[226:229]
 v_mfma_f32_16x16x32_bf16 v[230:233], v[222:225], v[96:99], v[230:233]
 ds_read_b128 v[222:225], v110 offset:1024
 s_waitcnt lgkmcnt(3)
 v_mfma_f32_16x16x32_bf16 v[226:229], v[210:213], v[20:23], v[226:229]
 v_mfma_f32_16x16x32_bf16 v[230:233], v[210:213], v[100:103], v[230:233]
 buffer_load_dwordx4 v[194:197], v2, s[4:7], s27 offen offset:0 sc1
 ds_read_b128 v[210:213], v110 offset:2048
 s_waitcnt lgkmcnt(3)
 v_mfma_f32_16x16x32_bf16 v[226:229], v[214:217], v[24:27], v[226:229]
 v_mfma_f32_16x16x32_bf16 v[230:233], v[214:217], v[104:107], v[230:233]
 ds_read_b128 v[214:217], v110 offset:3072
 s_waitcnt lgkmcnt(3)
 v_mfma_f32_16x16x32_bf16 v[226:229], v[218:221], v[28:31], v[226:229]
 ds_read_b128 v[218:221], v110 offset:4096
 s_waitcnt lgkmcnt(3)
 v_mfma_f32_16x16x32_bf16 v[226:229], v[222:225], v[32:35], v[226:229]
 buffer_load_dwordx4 v[198:201], v2, s[4:7], s27 offen offset:1024 sc1
 ds_read_b128 v[222:225], v111 offset:0
 s_waitcnt lgkmcnt(3)
 v_mfma_f32_16x16x32_bf16 v[226:229], v[210:213], v[36:39], v[226:229]
 ds_write_b128 v116, v[230:233] offset:28672
 ds_read_b128 v[210:213], v111 offset:1024
 s_waitcnt lgkmcnt(4)
 v_mfma_f32_16x16x32_bf16 v[226:229], v[214:217], v[40:43], v[226:229]
 ds_read_b128 v[214:217], v111 offset:2048
 s_waitcnt lgkmcnt(4)
 v_mfma_f32_16x16x32_bf16 v[226:229], v[218:221], v[44:47], v[226:229]
 buffer_load_dwordx4 v[202:205], v2, s[4:7], s27 offen offset:2048 sc1
 ds_read_b128 v[218:221], v111 offset:3072
 s_waitcnt lgkmcnt(4)
 v_mfma_f32_16x16x32_bf16 v[226:229], v[222:225], v[48:51], v[226:229]
 ds_read_b128 v[222:225], v111 offset:4096
 s_waitcnt lgkmcnt(3)
 v_mfma_f32_16x16x32_bf16 v[226:229], v[210:213], v[52:55], v[226:229]
 s_waitcnt lgkmcnt(2)
 v_mfma_f32_16x16x32_bf16 v[226:229], v[214:217], v[56:59], v[226:229]
 s_barrier
 s_waitcnt lgkmcnt(1)
 v_mfma_f32_16x16x32_bf16 v[226:229], v[218:221], v[60:63], v[226:229]
 s_waitcnt lgkmcnt(0)
 v_mfma_f32_16x16x32_bf16 v[226:229], v[222:225], v[64:67], v[226:229]
 s_cmp_eq_u32 s31, 72
 s_cbranch_scc1 Lfin_152
 s_mov_b32 s41, 0
Lf_153:
 s_waitcnt vmcnt(2)
 v_add_f32 v210, v234, v194
 v_add_f32 v211, v235, v195
 v_add_f32 v212, v236, v196
 v_add_f32 v213, v237, v197
 s_waitcnt vmcnt(1)
 v_add_f32 v214, v238, v198
 v_add_f32 v215, v239, v199
 v_add_f32 v216, v240, v200
 v_add_f32 v217, v241, v201
 v_maximum3_f32 v1, v210, v211, v212
 v_maximum3_f32 v127, v213, v214, v215
 v_maximum3_f32 v1, v1, v216, v217
 s_waitcnt vmcnt(0)
 v_add_f32 v218, v190, v202
 v_add_f32 v219, v191, v203
 v_add_f32 v220, v192, v204
 v_add_f32 v221, v193, v205
 v_maximum3_f32 v127, v127, v218, v219
 v_maximum3_f32 v1, v1, v220, v221
 v_maximum3_f32 v1, v1, v127, v127
 v_cmp_u_f32 vcc, v1, v1
 v_mov_b32 v127, v1
 s_cbranch_vccnz Lfs_154
Lfok_155:
 s_nop 0
 v_permlane32_swap_b32 v1, v127
 v_max_f32 v1, v1, v127
 v_mov_b32 v127, v1
 v_cvt_pk_bf16_f32 v178, v226, v227
 v_cvt_pk_bf16_f32 v179, v228, v229
 v_permlane16_swap_b32 v1, v127
 v_max_f32 v1, v1, v127
 v_mul_f32 v1, s71, v1
 v_fma_f32 v210, v210, s71, -v1
 v_fma_f32 v211, v211, s71, -v1
 v_fma_f32 v212, v212, s71, -v1
 v_fma_f32 v213, v213, s71, -v1
 v_fma_f32 v214, v214, s71, -v1
 v_fma_f32 v215, v215, s71, -v1
 v_fma_f32 v216, v216, s71, -v1
 v_fma_f32 v217, v217, s71, -v1
 v_fma_f32 v218, v218, s71, -v1
 v_fma_f32 v219, v219, s71, -v1
 v_fma_f32 v220, v220, s71, -v1
 v_fma_f32 v221, v221, s71, -v1
 v_exp_f32 v210, v210
 v_exp_f32 v211, v211
 v_exp_f32 v212, v212
 v_exp_f32 v213, v213
 v_exp_f32 v214, v214
 v_exp_f32 v215, v215
 v_exp_f32 v216, v216
 v_exp_f32 v217, v217
 s_mov_b32 exec_lo, 0x00ff00ff
 s_mov_b32 exec_hi, 0x00ff00ff
 v_cvt_pk_bf16_f32 v162, v210, v211
 v_cvt_pk_bf16_f32 v163, v212, v213
 v_cvt_pk_bf16_f32 v164, v214, v215
 v_cvt_pk_bf16_f32 v165, v216, v217
 s_not_b64 exec, exec
 v_cvt_pk_bf16_f32 v166, v210, v211
 v_cvt_pk_bf16_f32 v167, v212, v213
 v_cvt_pk_bf16_f32 v168, v214, v215
 v_cvt_pk_bf16_f32 v169, v216, v217
 s_mov_b64 exec, -1
 v_mfma_f32_16x16x32_bf16 v[200:203], v[186:189], v[162:165], 0
 v_exp_f32 v218, v218
 v_exp_f32 v219, v219
 v_mfma_f32_16x16x32_bf16 v[192:195], v[142:145], v[162:165], 0
 v_exp_f32 v220, v220
 v_exp_f32 v221, v221
 v_mfma_f32_16x16x32_bf16 v[200:203], v[186:189], v[166:169], v[200:203]
 v_cvt_pk_bf16_f32 v190, v218, v219
 v_mfma_f32_16x16x32_bf16 v[192:195], v[150:153], v[166:169], v[192:195]
 v_cvt_pk_bf16_f32 v191, v220, v221
 s_nop 1
 v_mfma_f32_16x16x16_bf16 v[200:203], v[186:187], v[190:191], v[200:203]
 s_add_u32 s25, s60, s54
 s_add_u32 s27, s60, s55
 v_mfma_f32_16x16x16_bf16 v[192:195], v[178:179], v[190:191], v[192:195]
 s_add_u32 s28, s27, 4096
 s_mov_b32 s41, 0
 s_nop 2
 v_rcp_f32 v127, v200
 s_nop 1
 v_mul_f32 v192, v192, v127
 v_mul_f32 v193, v193, v127
 v_mul_f32 v194, v194, v127
 v_mul_f32 v195, v195, v127
 v_cvt_pk_bf16_f32 v204, v192, v193
 v_cvt_pk_bf16_f32 v205, v194, v195
 buffer_store_dwordx2 v[204:205], v2, s[4:7], s25 offen
 ds_write_b64 v117, v[178:179] offset:1536
 s_sleep 4
 buffer_load_dwordx4 v[190:193], v2, s[4:7], s27 offen offset:0 sc1
 ds_read_b128 v[142:145], v114 offset:0
 ds_read_b128 v[146:149], v114 offset:1024
 s_nop 7
 buffer_load_dwordx4 v[194:197], v2, s[4:7], s27 offen offset:1024 sc1
 ds_read_b128 v[150:153], v114 offset:2048
 ds_read_b128 v[154:157], v114 offset:3072
 s_nop 7
 buffer_load_dwordx4 v[198:201], v2, s[4:7], s27 offen offset:2048 sc1
 ds_read_b128 v[234:237], v114 offset:4096
 ds_read_b128 v[238:241], v114 offset:5120
 s_nop 7
 buffer_load_dwordx4 v[202:205], v2, s[4:7], s27 offen offset:3072 sc1
 ds_read_b128 v[242:245], v114 offset:6144
 ds_read_b128 v[246:249], v114 offset:7168
 s_nop 7
 buffer_load_dwordx4 v[206:209], v2, s[4:7], s28 offen offset:0 sc1
 s_nop 7
 buffer_load_dwordx4 v[210:213], v2, s[4:7], s28 offen offset:1024 sc1
 s_waitcnt lgkmcnt(0)
Lo_156:
 s_waitcnt vmcnt(5)
 v_max3_u32 v1, v190, v191, v192
 v_max_u32 v1, v1, v193
 v_cmp_eq_u32 vcc, -1, v1
 s_cbranch_vccnz Los_157
 v_mfma_f32_16x16x32_bf16 v[214:217], v[142:145], v[190:193], 0
 ds_read_b128 v[142:145], v114 offset:8192
 v_mfma_f32_16x16x32_bf16 v[218:221], v[146:149], v[190:193], 0
 ds_read_b128 v[146:149], v114 offset:9216
 s_waitcnt vmcnt(4)
 v_max3_u32 v1, v194, v195, v196
 v_mfma_f32_16x16x32_bf16 v[222:225], v[150:153], v[190:193], 0
 ds_read_b128 v[150:153], v114 offset:10240
 v_max_u32 v1, v1, v197
 v_mfma_f32_16x16x32_bf16 v[226:229], v[154:157], v[190:193], 0
 ds_read_b128 v[154:157], v114 offset:11264
 v_cmp_eq_u32 vcc, -1, v1
 v_mfma_f32_16x16x32_bf16 v[230:233], v[234:237], v[190:193], 0
 ds_read_b128 v[234:237], v114 offset:12288
Lo_158:
 s_cbranch_vccnz Los_159
 v_mfma_f32_16x16x32_bf16 v[214:217], v[238:241], v[194:197], v[214:217]
 ds_read_b128 v[238:241], v114 offset:13312
 v_mfma_f32_16x16x32_bf16 v[218:221], v[242:245], v[194:197], v[218:221]
 ds_read_b128 v[242:245], v114 offset:14336
 s_waitcnt vmcnt(3)
 v_max3_u32 v1, v198, v199, v200
 v_mfma_f32_16x16x32_bf16 v[222:225], v[246:249], v[194:197], v[222:225]
 ds_read_b128 v[246:249], v115 offset:0
 v_max_u32 v1, v1, v201
 s_waitcnt lgkmcnt(6)
 v_mfma_f32_16x16x32_bf16 v[226:229], v[142:145], v[194:197], v[226:229]
 ds_read_b128 v[142:145], v115 offset:1024
 v_cmp_eq_u32 vcc, -1, v1
 v_mfma_f32_16x16x32_bf16 v[230:233], v[146:149], v[194:197], v[230:233]
 ds_read_b128 v[146:149], v115 offset:2048
Lo_160:
 s_cbranch_vccnz Los_161
 s_waitcnt lgkmcnt(6)
 v_mfma_f32_16x16x32_bf16 v[214:217], v[150:153], v[198:201], v[214:217]
 ds_read_b128 v[150:153], v115 offset:3072
 v_mfma_f32_16x16x32_bf16 v[218:221], v[154:157], v[198:201], v[218:221]
 ds_read_b128 v[154:157], v115 offset:4096
 s_waitcnt vmcnt(2)
 v_max3_u32 v1, v202, v203, v204
 s_waitcnt lgkmcnt(6)
 v_mfma_f32_16x16x32_bf16 v[222:225], v[234:237], v[198:201], v[222:225]
 ds_read_b128 v[234:237], v115 offset:5120
 v_max_u32 v1, v1, v205
 v_mfma_f32_16x16x32_bf16 v[226:229], v[238:241], v[198:201], v[226:229]
 ds_read_b128 v[238:241], v115 offset:6144
 v_cmp_eq_u32 vcc, -1, v1
 s_waitcnt lgkmcnt(6)
 v_mfma_f32_16x16x32_bf16 v[230:233], v[242:245], v[198:201], v[230:233]
 ds_read_b128 v[242:245], v115 offset:7168
Lo_162:
 s_cbranch_vccnz Los_163
 v_mfma_f32_16x16x32_bf16 v[214:217], v[246:249], v[202:205], v[214:217]
 ds_read_b128 v[246:249], v115 offset:8192
 s_waitcnt lgkmcnt(6)
 v_mfma_f32_16x16x32_bf16 v[218:221], v[142:145], v[202:205], v[218:221]
 ds_read_b128 v[142:145], v115 offset:9216
 s_waitcnt vmcnt(1)
 v_max3_u32 v1, v206, v207, v208
 v_mfma_f32_16x16x32_bf16 v[222:225], v[146:149], v[202:205], v[222:225]
 ds_read_b128 v[146:149], v115 offset:10240
 v_max_u32 v1, v1, v209
 s_waitcnt lgkmcnt(6)
 v_mfma_f32_16x16x32_bf16 v[226:229], v[150:153], v[202:205], v[226:229]
 ds_read_b128 v[150:153], v115 offset:11264
 v_cmp_eq_u32 vcc, -1, v1
 v_mfma_f32_16x16x32_bf16 v[230:233], v[154:157], v[202:205], v[230:233]
 ds_read_b128 v[154:157], v115 offset:12288
Lo_164:
 s_cbranch_vccnz Los_165
 s_waitcnt lgkmcnt(6)
 v_mfma_f32_16x16x32_bf16 v[214:217], v[234:237], v[206:209], v[214:217]
 ds_read_b128 v[234:237], v115 offset:13312
 v_mfma_f32_16x16x32_bf16 v[218:221], v[238:241], v[206:209], v[218:221]
 ds_read_b128 v[238:241], v115 offset:14336
 s_waitcnt vmcnt(0)
 v_max3_u32 v1, v210, v211, v212
 s_waitcnt lgkmcnt(6)
 v_mfma_f32_16x16x32_bf16 v[222:225], v[242:245], v[206:209], v[222:225]
 v_max_u32 v1, v1, v213
 v_mfma_f32_16x16x32_bf16 v[226:229], v[246:249], v[206:209], v[226:229]
 v_cmp_eq_u32 vcc, -1, v1
 s_waitcnt lgkmcnt(4)
 v_mfma_f32_16x16x32_bf16 v[230:233], v[142:145], v[206:209], v[230:233]
Lo_166:
 s_cbranch_vccnz Los_167
 v_mfma_f32_16x16x32_bf16 v[214:217], v[146:149], v[210:213], v[214:217]
 buffer_load_dwordx4 v[130:133], v2, s[4:7], s66 offen sc1
 s_waitcnt lgkmcnt(2)
 v_mfma_f32_16x16x32_bf16 v[218:221], v[150:153], v[210:213], v[218:221]
 buffer_load_dwordx4 v[134:137], v2, s[4:7], s66 offen offset:2048 sc1
 v_mfma_f32_16x16x32_bf16 v[222:225], v[154:157], v[210:213], v[222:225]
 s_add_u32 s25, s66, 4096
 buffer_load_dwordx4 v[138:141], v2, s[4:7], s25 offen sc1
 s_waitcnt lgkmcnt(0)
 v_mfma_f32_16x16x32_bf16 v[226:229], v[234:237], v[210:213], v[226:229]
 v_mfma_f32_16x16x32_bf16 v[230:233], v[238:241], v[210:213], v[230:233]
 v_cvt_pk_bf16_f32 v190, v214, v215
 v_cvt_pk_bf16_f32 v191, v216, v217
 v_cvt_pk_bf16_f32 v192, v218, v219
 v_cvt_pk_bf16_f32 v193, v220, v221
 ds_write_b128 v118, v[190:193]
 v_cvt_pk_bf16_f32 v194, v222, v223
 v_cvt_pk_bf16_f32 v195, v224, v225
 v_cvt_pk_bf16_f32 v196, v226, v227
 v_cvt_pk_bf16_f32 v197, v228, v229
 ds_write_b128 v118, v[194:197] offset:4096
 v_cvt_pk_bf16_f32 v198, v230, v231
 v_cvt_pk_bf16_f32 v199, v232, v233
 ds_write_b64 v119, v[198:199] offset:8192
 s_add_u32 s25, s62, s46
 s_add_u32 s26, s25, 8192
 s_add_u32 s27, s25, 655360
 s_add_u32 s28, s26, 655360
 s_waitcnt lgkmcnt(0)
 s_barrier
 ds_read_b128 v[190:193], v3 offset:4096
 ds_read_b128 v[194:197], v3 offset:5120
 ds_read_b128 v[198:201], v3 offset:6144
 ds_read_b128 v[202:205], v3 offset:7168
 s_waitcnt lgkmcnt(3)
 v_mfma_f32_16x16x32_bf16 v[214:217], v[170:173], v[190:193], 0
 s_waitcnt lgkmcnt(2)
 v_mfma_f32_16x16x32_bf16 v[214:217], v[174:177], v[194:197], v[214:217]
 s_waitcnt lgkmcnt(1)
 v_mfma_f32_16x16x32_bf16 v[218:221], v[170:173], v[198:201], 0
 s_waitcnt lgkmcnt(0)
 v_mfma_f32_16x16x32_bf16 v[218:221], v[174:177], v[202:205], v[218:221]
 s_nop 1
 v_cvt_pk_bf16_f32 v226, v214, v215
 v_cvt_pk_bf16_f32 v227, v216, v217
 s_nop 3
 v_cvt_pk_bf16_f32 v228, v218, v219
 v_cvt_pk_bf16_f32 v229, v220, v221
 s_nop 0
 v_permlane16_swap_b32 v226, v228
 v_permlane16_swap_b32 v227, v229
 buffer_store_dwordx4 v[226:229], v120, s[4:7], s25 offen sc1
 buffer_store_dwordx4 v[226:229], v120, s[4:7], s27 offen
 s_add_u32 s70, s69, s52
 ds_read_b128 v[190:193], v3 offset:23552
 ds_read_b128 v[194:197], v3 offset:24576
 ds_read_b128 v[198:201], v3 offset:25600
 ds_read_b64 v[202:203], v117 offset:0
 ds_read_b64 v[204:205], v117 offset:512
 ds_read_b64 v[206:207], v117 offset:1024
 ds_read_b64 v[208:209], v117 offset:1536
 ds_read_b64 v[210:211], v117 offset:2048
 ds_read_b64 v[212:213], v117 offset:2560
 s_sleep 10
 s_add_u32 s25, s70, 15728640
 s_waitcnt lgkmcnt(0)
 buffer_store_dwordx4 v[190:193], v2, s[4:7], s70 offen offset:0 sc1
 buffer_store_dwordx4 v[194:197], v2, s[4:7], s70 offen offset:1024 sc1
 buffer_store_dwordx4 v[198:201], v2, s[4:7], s70 offen offset:2048 sc1
 buffer_store_dwordx4 v[202:205], v2, s[4:7], s25 offen offset:0 sc1
 buffer_store_dwordx4 v[206:209], v2, s[4:7], s25 offen offset:1024 sc1
 buffer_store_dwordx4 v[210:213], v2, s[4:7], s25 offen offset:2048 sc1
 s_add_u32 s25, s31, 1
 s_mov_b64 exec, 1
 v_mov_b32 v190, s25
 s_waitcnt vmcnt(0)
 buffer_store_dword v190, off, s[4:7], s53 sc1
 s_mov_b64 exec, -1
 s_add_u32 s27, s62, s47
 s_add_u32 s28, s62, s48
 s_add_u32 s69, s31, 1
 s_and_b32 s25, s69, 3
 s_mul_i32 s26, s25, 20480
 s_add_u32 s56, s26, s42
 s_add_u32 s57, s56, 4096
 s_add_u32 s58, s26, s43
 s_mul_i32 s62, s25, 163840
 s_xor_b32 s26, s25, 2
 s_mul_i32 s63, s26, 163840
 s_add_u32 s25, s25, 3
 s_and_b32 s25, s25, 3
 s_mul_i32 s26, s25, 20480
 s_add_u32 s59, s26, s43
 s_and_b32 s25, s69, 1
 s_mul_i32 s60, s25, 196608
 s_xor_b32 s25, s25, 1
 s_mul_i32 s61, s25, 196608
 s_mul_i32 s69, s69, 196608
 s_add_u32 s31, s31, 1
 s_barrier
 s_branch L_rec_top_3l
Lfin_152:
 s_waitcnt lgkmcnt(0)
 s_nop 4
 v_cvt_pk_bf16_f32 v178, v226, v227
 v_cvt_pk_bf16_f32 v179, v228, v229
 ds_write_b64 v117, v[178:179] offset:1536
 s_waitcnt lgkmcnt(0)
 s_barrier
 s_waitcnt vmcnt(0)
 ds_read_b128 v[142:145], v3 offset:23552
 ds_read_b128 v[146:149], v3 offset:24576
 ds_read_b128 v[150:153], v3 offset:25600
 ds_read_b64 v[154:155], v117 offset:0
 ds_read_b64 v[156:157], v117 offset:512
 ds_read_b64 v[130:131], v117 offset:1024
 ds_read_b64 v[132:133], v117 offset:1536
 ds_read_b64 v[134:135], v117 offset:2048
 ds_read_b64 v[136:137], v117 offset:2560
 s_add_u32 s26, s69, s52
 s_add_u32 s25, s26, 15728640
 s_waitcnt lgkmcnt(0)
 buffer_store_dwordx4 v[142:145], v2, s[4:7], s26 offen offset:0 sc1
 buffer_store_dwordx4 v[146:149], v2, s[4:7], s26 offen offset:1024 sc1
 buffer_store_dwordx4 v[150:153], v2, s[4:7], s26 offen offset:2048 sc1
 buffer_store_dwordx4 v[154:157], v2, s[4:7], s25 offen offset:0 sc1
 buffer_store_dwordx4 v[130:133], v2, s[4:7], s25 offen offset:1024 sc1
 buffer_store_dwordx4 v[134:137], v2, s[4:7], s25 offen offset:2048 sc1
 s_mov_b64 exec, 1
 v_mov_b32 v1, 73
 s_waitcnt vmcnt(0)
 buffer_store_dword v1, off, s[4:7], s53 sc1
 s_mov_b64 exec, -1
 s_endpgm
Lzs_141:
 buffer_load_dwordx4 v[190:193], v2, s[4:7], s56 offen offset:0 sc1
 buffer_load_dwordx4 v[194:197], v2, s[4:7], s56 offen offset:1024 sc1
 buffer_load_dwordx4 v[198:201], v2, s[4:7], s56 offen offset:2048 sc1
 buffer_load_dwordx4 v[202:205], v2, s[4:7], s56 offen offset:3072 sc1
 buffer_load_dwordx4 v[206:209], v2, s[4:7], s57 offen offset:0 sc1
 s_add_u32 s41, s41, 1
 s_cmp_gt_u32 s41, 200000
 s_cbranch_scc1 L_fail
 s_branch Lz_140
Lzs_143:
 buffer_load_dwordx4 v[194:197], v2, s[4:7], s56 offen offset:1024 sc1
 buffer_load_dwordx4 v[198:201], v2, s[4:7], s56 offen offset:2048 sc1
 buffer_load_dwordx4 v[202:205], v2, s[4:7], s56 offen offset:3072 sc1
 buffer_load_dwordx4 v[206:209], v2, s[4:7], s57 offen offset:0 sc1
 s_add_u32 s41, s41, 1
 s_cmp_gt_u32 s41, 200000
 s_cbranch_scc1 L_fail
 s_branch Lz_142
Lzs_145:
 buffer_load_dwordx4 v[198:201], v2, s[4:7], s56 offen offset:2048 sc1
 buffer_load_dwordx4 v[202:205], v2, s[4:7], s56 offen offset:3072 sc1
 buffer_load_dwordx4 v[206:209], v2, s[4:7], s57 offen offset:0 sc1
 s_add_u32 s41, s41, 1
 s_cmp_gt_u32 s41, 200000
 s_cbranch_scc1 L_fail
 s_branch Lz_144
Lzs_147:
 buffer_load_dwordx4 v[202:205], v2, s[4:7], s56 offen offset:3072 sc1
 buffer_load_dwordx4 v[206:209], v2, s[4:7], s57 offen offset:0 sc1
 s_add_u32 s41, s41, 1
 s_cmp_gt_u32 s41, 200000
 s_cbranch_scc1 L_fail
 s_branch Lz_146
Lzs_149:
 buffer_load_dwordx4 v[206:209], v2, s[4:7], s57 offen offset:0 sc1
 s_add_u32 s41, s41, 1
 s_cmp_gt_u32 s41, 200000
 s_cbranch_scc1 L_fail
 s_branch Lz_148
Lfs_154:
 v_max3_u32 v222, v194, v195, v196
 v_max3_u32 v222, v222, v197, v198
 v_max3_u32 v222, v222, v199, v200
 v_max3_u32 v222, v222, v201, v202
 v_max3_u32 v222, v222, v203, v204
 v_max_u32 v222, v222, v205
 v_cmp_eq_u32 vcc, -1, v222
 s_cbranch_vccz Lfok_155
 buffer_load_dwordx4 v[194:197], v2, s[4:7], s27 offen offset:0 sc1
 buffer_load_dwordx4 v[198:201], v2, s[4:7], s27 offen offset:1024 sc1
 buffer_load_dwordx4 v[202:205], v2, s[4:7], s27 offen offset:2048 sc1
 s_add_u32 s41, s41, 1
 s_cmp_gt_u32 s41, 200000
 s_cbranch_scc1 L_fail
 s_branch Lf_153
Los_157:
 buffer_load_dwordx4 v[190:193], v2, s[4:7], s27 offen offset:0 sc1
 buffer_load_dwordx4 v[194:197], v2, s[4:7], s27 offen offset:1024 sc1
 buffer_load_dwordx4 v[198:201], v2, s[4:7], s27 offen offset:2048 sc1
 buffer_load_dwordx4 v[202:205], v2, s[4:7], s27 offen offset:3072 sc1
 buffer_load_dwordx4 v[206:209], v2, s[4:7], s28 offen offset:0 sc1
 buffer_load_dwordx4 v[210:213], v2, s[4:7], s28 offen offset:1024 sc1
 s_add_u32 s41, s41, 1
 s_cmp_gt_u32 s41, 200000
 s_cbranch_scc1 L_fail
 s_branch Lo_156
Los_159:
 buffer_load_dwordx4 v[194:197], v2, s[4:7], s27 offen offset:1024 sc1
 buffer_load_dwordx4 v[198:201], v2, s[4:7], s27 offen offset:2048 sc1
 buffer_load_dwordx4 v[202:205], v2, s[4:7], s27 offen offset:3072 sc1
 buffer_load_dwordx4 v[206:209], v2, s[4:7], s28 offen offset:0 sc1
 buffer_load_dwordx4 v[210:213], v2, s[4:7], s28 offen offset:1024 sc1
 s_waitcnt vmcnt(4)
 v_max3_u32 v1, v194, v195, v196
 v_max_u32 v1, v1, v197
 v_cmp_eq_u32 vcc, -1, v1
 s_add_u32 s41, s41, 1
 s_cmp_gt_u32 s41, 200000
 s_cbranch_scc1 L_fail
 s_branch Lo_158
Los_161:
 buffer_load_dwordx4 v[198:201], v2, s[4:7], s27 offen offset:2048 sc1
 buffer_load_dwordx4 v[202:205], v2, s[4:7], s27 offen offset:3072 sc1
 buffer_load_dwordx4 v[206:209], v2, s[4:7], s28 offen offset:0 sc1
 buffer_load_dwordx4 v[210:213], v2, s[4:7], s28 offen offset:1024 sc1
 s_waitcnt vmcnt(3)
 v_max3_u32 v1, v198, v199, v200
 v_max_u32 v1, v1, v201
 v_cmp_eq_u32 vcc, -1, v1
 s_add_u32 s41, s41, 1
 s_cmp_gt_u32 s41, 200000
 s_cbranch_scc1 L_fail
 s_branch Lo_160
Los_163:
 buffer_load_dwordx4 v[202:205], v2, s[4:7], s27 offen offset:3072 sc1
 buffer_load_dwordx4 v[206:209], v2, s[4:7], s28 offen offset:0 sc1
 buffer_load_dwordx4 v[210:213], v2, s[4:7], s28 offen offset:1024 sc1
 s_waitcnt vmcnt(2)
 v_max3_u32 v1, v202, v203, v204
 v_max_u32 v1, v1, v205
 v_cmp_eq_u32 vcc, -1, v1
 s_add_u32 s41, s41, 1
 s_cmp_gt_u32 s41, 200000
 s_cbranch_scc1 L_fail
 s_branch Lo_162
Los_165:
 buffer_load_dwordx4 v[206:209], v2, s[4:7], s28 offen offset:0 sc1
 buffer_load_dwordx4 v[210:213], v2, s[4:7], s28 offen offset:1024 sc1
 s_waitcnt vmcnt(1)
 v_max3_u32 v1, v206, v207, v208
 v_max_u32 v1, v1, v209
 v_cmp_eq_u32 vcc, -1, v1
 s_add_u32 s41, s41, 1
 s_cmp_gt_u32 s41, 200000
 s_cbranch_scc1 L_fail
 s_branch Lo_164
Los_167:
 buffer_load_dwordx4 v[210:213], v2, s[4:7], s28 offen offset:1024 sc1
 s_waitcnt vmcnt(0)
 v_max3_u32 v1, v210, v211, v212
 v_max_u32 v1, v1, v213
 v_cmp_eq_u32 vcc, -1, v1
 s_add_u32 s41, s41, 1
 s_cmp_gt_u32 s41, 200000
 s_cbranch_scc1 L_fail
 s_branch Lo_166
L_rec_remote:
 s_cmp_eq_u32 s3, 0
 s_cbranch_scc0 Lpwn_169
 s_waitcnt vmcnt(0)
 s_cmp_eq_u32 s40, 0
 s_cbranch_scc1 Lz0_170
 buffer_store_dwordx2 v[128:129], v121, s[4:7], s43 offen sc1
Lz0_170:
 s_barrier
L_rec_top_0r:
 s_mov_b32 s41, 0
 s_sleep 2
 buffer_load_dwordx4 v[190:193], v2, s[4:7], s56 offen offset:0 sc1
 s_nop 11
 buffer_load_dwordx4 v[194:197], v2, s[4:7], s56 offen offset:1024 sc1
 s_nop 11
 buffer_load_dwordx4 v[198:201], v2, s[4:7], s56 offen offset:2048 sc1
 s_nop 11
 buffer_load_dwordx4 v[202:205], v2, s[4:7], s56 offen offset:3072 sc1
 s_nop 11
 buffer_load_dwordx4 v[206:209], v2, s[4:7], s57 offen offset:0 sc1
Lz_171:
 s_waitcnt vmcnt(4)
 ds_write_b128 v108, v[190:193] offset:0
 v_mfma_f32_16x16x32_bf16 v[226:229], a[0:3], v[190:193], 0
 v_max3_u32 v1, v190, v191, v192
 v_max_u32 v1, v1, v193
 v_mfma_f32_16x16x32_bf16 v[230:233], a[80:83], v[190:193], 0
 v_cmp_eq_u32 vcc, -1, v1
 v_mfma_f32_16x16x32_bf16 v[234:237], a[160:163], v[190:193], 0
 s_cbranch_vccnz Lzs_172
Lz_173:
 s_waitcnt vmcnt(3)
 ds_write_b128 v108, v[194:197] offset:1024
 v_max3_u32 v1, v194, v195, v196
 v_max_u32 v1, v1, v197
 v_cmp_eq_u32 vcc, -1, v1
 s_cbranch_vccnz Lzs_174
 v_mfma_f32_16x16x32_bf16 v[226:229], a[4:7], v[194:197], v[226:229]
 v_mfma_f32_16x16x32_bf16 v[230:233], a[84:87], v[194:197], v[230:233]
 v_mfma_f32_16x16x32_bf16 v[234:237], a[164:167], v[194:197], v[234:237]
Lz_175:
 s_waitcnt vmcnt(2)
 ds_write_b128 v108, v[198:201] offset:2048
 v_max3_u32 v1, v198, v199, v200
 v_max_u32 v1, v1, v201
 v_cmp_eq_u32 vcc, -1, v1
 s_cbranch_vccnz Lzs_176
 v_mfma_f32_16x16x32_bf16 v[226:229], a[8:11], v[198:201], v[226:229]
 v_mfma_f32_16x16x32_bf16 v[230:233], a[88:91], v[198:201], v[230:233]
 v_mfma_f32_16x16x32_bf16 v[234:237], a[168:171], v[198:201], v[234:237]
Lz_177:
 s_waitcnt vmcnt(1)
 ds_write_b128 v108, v[202:205] offset:3072
 v_max3_u32 v1, v202, v203, v204
 v_max_u32 v1, v1, v205
 v_cmp_eq_u32 vcc, -1, v1
 s_cbranch_vccnz Lzs_178
Lz_179:
 s_waitcnt vmcnt(0)
 ds_write_b128 v108, v[206:209] offset:4096
 v_max3_u32 v1, v206, v207, v208
 v_max_u32 v1, v1, v209
 v_cmp_eq_u32 vcc, -1, v1
 s_cbranch_vccnz Lzs_180
 s_waitcnt lgkmcnt(0)
 s_barrier
 ds_read_b128 v[214:217], v109 offset:0
 ds_read_b128 v[218:221], v109 offset:1024
 ds_read_b128 v[222:225], v109 offset:2048
 v_mfma_f32_16x16x32_bf16 v[226:229], a[12:15], v[202:205], v[226:229]
 buffer_load_dword v126, v124, s[4:7], 0 offen sc1
 v_mfma_f32_16x16x32_bf16 v[230:233], a[92:95], v[202:205], v[230:233]
 v_mfma_f32_16x16x32_bf16 v[234:237], a[172:175], v[202:205], v[234:237]
 v_mfma_f32_16x16x32_bf16 v[226:229], a[16:19], v[206:209], v[226:229]
 s_add_u32 s25, s67, s50
 v_mfma_f32_16x16x32_bf16 v[230:233], a[96:99], v[206:209], v[230:233]
 buffer_load_dwordx4 v[142:145], v2, s[4:7], s25 offen sc1
 v_mfma_f32_16x16x32_bf16 v[234:237], a[176:179], v[206:209], v[234:237]
 ds_read_b128 v[210:213], v109 offset:3072
 s_waitcnt lgkmcnt(3)
 v_mfma_f32_16x16x32_bf16 v[226:229], a[20:23], v[214:217], v[226:229]
 s_add_u32 s25, s67, s51
 v_mfma_f32_16x16x32_bf16 v[230:233], a[100:103], v[214:217], v[230:233]
 buffer_load_dwordx4 v[146:149], v2, s[4:7], s25 offen sc1
 v_mfma_f32_16x16x32_bf16 v[234:237], a[180:183], v[214:217], v[234:237]
 ds_read_b128 v[214:217], v109 offset:4096
 s_waitcnt lgkmcnt(3)
 v_mfma_f32_16x16x32_bf16 v[226:229], a[24:27], v[218:221], v[226:229]
 s_add_u32 s25, s68, s50
 v_mfma_f32_16x16x32_bf16 v[230:233], a[104:107], v[218:221], v[230:233]
 buffer_load_dwordx4 v[150:153], v2, s[4:7], s25 offen sc1
 v_mfma_f32_16x16x32_bf16 v[234:237], a[184:187], v[218:221], v[234:237]
 ds_read_b128 v[218:221], v110 offset:0
 s_waitcnt lgkmcnt(3)
 v_mfma_f32_16x16x32_bf16 v[226:229], a[28:31], v[222:225], v[226:229]
 s_add_u32 s25, s68, s51
 v_mfma_f32_16x16x32_bf16 v[230:233], a[108:111], v[222:225], v[230:233]
 buffer_load_dwordx4 v[154:157], v2, s[4:7], s25 offen sc1
 v_mfma_f32_16x16x32_bf16 v[234:237], a[188:191], v[222:225], v[234:237]
 ds_read_b128 v[222:225], v110 offset:1024
 s_waitcnt lgkmcnt(3)
 v_mfma_f32_16x16x32_bf16 v[226:229], a[32:35], v[210:213], v[226:229]
 s_add_u32 s25, s44, s61
 v_mfma_f32_16x16x32_bf16 v[230:233], a[112:115], v[210:213], v[230:233]
 s_add_u32 s25, s25, 0
 v_mfma_f32_16x16x32_bf16 v[234:237], a[192:195], v[210:213], v[234:237]
 buffer_store_dwordx4 v[182:185], v2, s[4:7], s25 offen offset:0 sc1
 ds_read_b128 v[210:213], v110 offset:2048
 s_waitcnt lgkmcnt(3)
 v_mfma_f32_16x16x32_bf16 v[226:229], a[36:39], v[214:217], v[226:229]
 s_add_u32 s25, s44, s61
 v_mfma_f32_16x16x32_bf16 v[230:233], a[116:119], v[214:217], v[230:233]
 s_add_u32 s25, s25, 0
 v_mfma_f32_16x16x32_bf16 v[234:237], a[196:199], v[214:217], v[234:237]
 buffer_store_dwordx4 v[182:185], v2, s[4:7], s25 offen offset:1024 sc1
 ds_read_b128 v[214:217], v110 offset:3072
 s_waitcnt lgkmcnt(3)
 v_mfma_f32_16x16x32_bf16 v[226:229], a[40:43], v[218:221], v[226:229]
 s_add_u32 s25, s44, s61
 v_mfma_f32_16x16x32_bf16 v[230:233], a[120:123], v[218:221], v[230:233]
 s_add_u32 s25, s25, 0
 v_mfma_f32_16x16x32_bf16 v[234:237], a[200:203], v[218:221], v[234:237]
 buffer_store_dwordx4 v[182:185], v2, s[4:7], s25 offen offset:2048 sc1
 ds_read_b128 v[218:221], v110 offset:4096
 s_waitcnt lgkmcnt(3)
 v_mfma_f32_16x16x32_bf16 v[226:229], a[44:47], v[222:225], v[226:229]
 s_add_u32 s25, s31, 1
 s_mul_i32 s67, s25, 393216
 v_mfma_f32_16x16x32_bf16 v[230:233], a[124:127], v[222:225], v[230:233]
 s_add_u32 s67, s67, 84312064
 s_cmp_lt_u32 s25, 64
 v_mfma_f32_16x16x32_bf16 v[234:237], a[204:207], v[222:225], v[234:237]
 s_cselect_b32 s67, s67, 2146435072
 ds_read_b128 v[222:225], v111 offset:0
 s_waitcnt lgkmcnt(3)
 v_mfma_f32_16x16x32_bf16 v[226:229], a[48:51], v[210:213], v[226:229]
 s_sub_u32 s26, s25, 9
 s_mul_i32 s68, s26, 393216
 v_mfma_f32_16x16x32_bf16 v[230:233], a[128:131], v[210:213], v[230:233]
 s_add_u32 s68, s68, 134643712
 s_cmp_lt_u32 s26, 64
 v_mfma_f32_16x16x32_bf16 v[234:237], a[208:211], v[210:213], v[234:237]
 s_cselect_b32 s68, s68, 2146435072
 ds_read_b128 v[210:213], v111 offset:1024
 s_waitcnt lgkmcnt(3)
 v_mfma_f32_16x16x32_bf16 v[226:229], a[52:55], v[214:217], v[226:229]
 s_add_u32 s25, s67, 4269801472
 s_add_u32 s26, s68, 4269801472
 v_mfma_f32_16x16x32_bf16 v[230:233], a[132:135], v[214:217], v[230:233]
 s_cmp_lt_u32 s3, 2
 s_cselect_b32 s66, s25, s26
 v_mfma_f32_16x16x32_bf16 v[234:237], a[212:215], v[214:217], v[234:237]
 s_add_u32 s66, s66, s49
 ds_read_b128 v[214:217], v111 offset:2048
 s_waitcnt lgkmcnt(3)
 v_mfma_f32_16x16x32_bf16 v[226:229], a[56:59], v[218:221], v[226:229]
 v_mfma_f32_16x16x32_bf16 v[230:233], a[136:139], v[218:221], v[230:233]
 v_mfma_f32_16x16x32_bf16 v[234:237], a[216:219], v[218:221], v[234:237]
 ds_read_b128 v[218:221], v111 offset:3072
 s_waitcnt lgkmcnt(3)
 v_mfma_f32_16x16x32_bf16 v[226:229], a[60:63], v[222:225], v[226:229]
 v_mfma_f32_16x16x32_bf16 v[230:233], a[140:143], v[222:225], v[230:233]
 v_mfma_f32_16x16x32_bf16 v[234:237], a[220:223], v[222:225], v[234:237]
 ds_read_b128 v[222:225], v111 offset:4096
 s_waitcnt lgkmcnt(3)
 v_mfma_f32_16x16x32_bf16 v[226:229], a[64:67], v[210:213], v[226:229]
 v_mfma_f32_16x16x32_bf16 v[230:233], a[144:147], v[210:213], v[230:233]
 v_mfma_f32_16x16x32_bf16 v[234:237], a[224:227], v[210:213], v[234:237]
 s_waitcnt lgkmcnt(2)
 v_mfma_f32_16x16x32_bf16 v[226:229], a[68:71], v[214:217], v[226:229]
 v_mfma_f32_16x16x32_bf16 v[230:233], a[148:151], v[214:217], v[230:233]
 v_mfma_f32_16x16x32_bf16 v[234:237], a[228:231], v[214:217], v[234:237]
 s_waitcnt lgkmcnt(1)
 v_mfma_f32_16x16x32_bf16 v[226:229], a[72:75], v[218:221], v[226:229]
 v_mfma_f32_16x16x32_bf16 v[230:233], a[152:155], v[218:221], v[230:233]
 v_mfma_f32_16x16x32_bf16 v[234:237], a[232:235], v[218:221], v[234:237]
 s_waitcnt lgkmcnt(0)
 v_mfma_f32_16x16x32_bf16 v[226:229], a[76:79], v[222:225], v[226:229]
 v_mfma_f32_16x16x32_bf16 v[230:233], a[156:159], v[222:225], v[230:233]
 v_mfma_f32_16x16x32_bf16 v[234:237], a[236:239], v[222:225], v[234:237]
 s_nop 1
 v_cvt_pk_bf16_f32 v190, v226, v227
 v_cvt_pk_bf16_f32 v191, v228, v229
 ds_write_b64 v112, v[190:191] offset:0
 v_cvt_pk_bf16_f32 v192, v230, v231
 v_cvt_pk_bf16_f32 v193, v232, v233
 ds_write_b64 v113, v[192:193] offset:0
 v_cvt_pk_bf16_f32 v194, v234, v235
 v_cvt_pk_bf16_f32 v195, v236, v237
 ds_write_b64 v112, v[194:195] offset:1024
 s_add_u32 s26, s60, s44
 s_add_u32 s27, s60, s45
 s_waitcnt lgkmcnt(0)
 s_barrier
 ds_read_b128 v[198:201], v3 offset:20480
 ds_read_b128 v[202:205], v3 offset:21504
 ds_read_b128 v[206:209], v3 offset:22528
 ds_read_b128 v[226:229], v3 offset:23552
 ds_read_b128 v[230:233], v3 offset:24576
 ds_read_b128 v[234:237], v3 offset:25600
 ds_read_b128 v[210:213], v108 offset:0
 ds_read_b128 v[214:217], v108 offset:1024
 ds_read_b128 v[218:221], v108 offset:2048
 s_waitcnt lgkmcnt(8)
 v_mfma_f32_16x16x32_bf16 v[194:197], v[130:133], v[198:201], 0
 s_waitcnt lgkmcnt(7)
 v_mfma_f32_16x16x32_bf16 v[194:197], v[134:137], v[202:205], v[194:197]
 s_waitcnt lgkmcnt(6)
 v_mfma_f32_16x16x32_bf16 v[194:197], v[138:141], v[206:209], v[194:197]
 s_waitcnt lgkmcnt(5)
 v_mfma_f32_16x16x32_bf16 v[190:193], v[226:229], v[198:201], v[158:161]
 s_waitcnt lgkmcnt(4)
 v_mfma_f32_16x16x32_bf16 v[190:193], v[230:233], v[202:205], v[190:193]
 s_mov_b32 exec_lo, 0x00ff00ff
 s_mov_b32 exec_hi, 0x00ff00ff
 s_waitcnt lgkmcnt(3)
 v_mfma_f32_16x16x32_bf16 v[190:193], v[234:237], v[206:209], v[190:193]
 buffer_store_dwordx4 v[194:197], v2, s[4:7], s26 offen offset:0 sc1
 ds_write_b128 v116, v[194:197] offset:26624
 s_mov_b64 exec, -1
 ds_read_b128 v[222:225], v108 offset:3072
 s_waitcnt lgkmcnt(4)
 v_mfma_f32_16x16x32_bf16 v[226:229], v[210:213], a[240:243], 0
 v_mfma_f32_16x16x32_bf16 v[230:233], v[210:213], v[68:71], 0
 ds_read_b128 v[210:213], v108 offset:4096
 s_waitcnt lgkmcnt(4)
 v_mfma_f32_16x16x32_bf16 v[226:229], v[214:217], a[244:247], v[226:229]
 v_mfma_f32_16x16x32_bf16 v[230:233], v[214:217], v[72:75], v[230:233]
 ds_read_b128 v[214:217], v109 offset:0
 s_waitcnt lgkmcnt(4)
 v_mfma_f32_16x16x32_bf16 v[226:229], v[218:221], a[248:251], v[226:229]
 v_mfma_f32_16x16x32_bf16 v[230:233], v[218:221], v[76:79], v[230:233]
 ds_read_b128 v[218:221], v109 offset:1024
 s_waitcnt lgkmcnt(3)
 v_mfma_f32_16x16x32_bf16 v[226:229], v[222:225], a[252:255], v[226:229]
 v_mfma_f32_16x16x32_bf16 v[230:233], v[222:225], v[80:83], v[230:233]
 s_waitcnt vmcnt(8)
 s_mov_b32 s41, 0
 v_min_i32 v1, 64, v125
 v_cmp_ge_i32 vcc, v126, v1
 s_nop 0
 s_cmp_eq_u64 vcc, -1
 s_cbranch_scc1 Lflok_182
Lfl_181:
 s_add_u32 s41, s41, 1
 s_cmp_gt_u32 s41, 200000
 s_cbranch_scc1 L_fail
 buffer_load_dword v126, v124, s[4:7], 0 offen sc1
 s_waitcnt vmcnt(0)
 v_cmp_ge_i32 vcc, v126, v1
 s_nop 0
 s_cmp_eq_u64 vcc, -1
 s_cbranch_scc0 Lfl_181
Lflok_182:
 v_add_u32 v125, 1, v125
 ds_read_b128 v[222:225], v109 offset:2048
 s_waitcnt lgkmcnt(3)
 v_mfma_f32_16x16x32_bf16 v[226:229], v[210:213], v[4:7], v[226:229]
 v_mfma_f32_16x16x32_bf16 v[230:233], v[210:213], v[84:87], v[230:233]
 s_barrier
 ds_read_b128 v[234:237], v3 offset:26624
 ds_read_b128 v[238:241], v3 offset:27648
 ds_read_b128 v[210:213], v109 offset:3072
 s_waitcnt lgkmcnt(5)
 v_mfma_f32_16x16x32_bf16 v[226:229], v[214:217], v[8:11], v[226:229]
 v_mfma_f32_16x16x32_bf16 v[230:233], v[214:217], v[88:91], v[230:233]
 ds_read_b128 v[214:217], v109 offset:4096
 s_waitcnt lgkmcnt(5)
 v_mfma_f32_16x16x32_bf16 v[226:229], v[218:221], v[12:15], v[226:229]
 v_mfma_f32_16x16x32_bf16 v[230:233], v[218:221], v[92:95], v[230:233]
 ds_read_b128 v[218:221], v110 offset:0
 s_waitcnt lgkmcnt(5)
 v_mfma_f32_16x16x32_bf16 v[226:229], v[222:225], v[16:19], v[226:229]
 v_mfma_f32_16x16x32_bf16 v[230:233], v[222:225], v[96:99], v[230:233]
 ds_read_b128 v[222:225], v110 offset:1024
 s_waitcnt lgkmcnt(3)
 v_mfma_f32_16x16x32_bf16 v[226:229], v[210:213], v[20:23], v[226:229]
 v_mfma_f32_16x16x32_bf16 v[230:233], v[210:213], v[100:103], v[230:233]
 buffer_load_dwordx4 v[194:197], v2, s[4:7], s27 offen offset:0 sc1
 ds_read_b128 v[210:213], v110 offset:2048
 s_waitcnt lgkmcnt(3)
 v_mfma_f32_16x16x32_bf16 v[226:229], v[214:217], v[24:27], v[226:229]
 v_mfma_f32_16x16x32_bf16 v[230:233], v[214:217], v[104:107], v[230:233]
 ds_read_b128 v[214:217], v110 offset:3072
 s_waitcnt lgkmcnt(3)
 v_mfma_f32_16x16x32_bf16 v[226:229], v[218:221], v[28:31], v[226:229]
 ds_read_b128 v[218:221], v110 offset:4096
 s_waitcnt lgkmcnt(3)
 v_mfma_f32_16x16x32_bf16 v[226:229], v[222:225], v[32:35], v[226:229]
 buffer_load_dwordx4 v[198:201], v2, s[4:7], s27 offen offset:1024 sc1
 ds_read_b128 v[222:225], v111 offset:0
 s_waitcnt lgkmcnt(3)
 v_mfma_f32_16x16x32_bf16 v[226:229], v[210:213], v[36:39], v[226:229]
 ds_read_b128 v[210:213], v111 offset:1024
 s_waitcnt lgkmcnt(3)
 v_mfma_f32_16x16x32_bf16 v[226:229], v[214:217], v[40:43], v[226:229]
 ds_read_b128 v[214:217], v111 offset:2048
 s_waitcnt lgkmcnt(3)
 v_mfma_f32_16x16x32_bf16 v[226:229], v[218:221], v[44:47], v[226:229]
 buffer_load_dwordx4 v[202:205], v2, s[4:7], s27 offen offset:2048 sc1
 ds_read_b128 v[218:221], v111 offset:3072
 s_waitcnt lgkmcnt(3)
 v_mfma_f32_16x16x32_bf16 v[226:229], v[222:225], v[48:51], v[226:229]
 ds_read_b128 v[222:225], v111 offset:4096
 s_waitcnt lgkmcnt(3)
 v_mfma_f32_16x16x32_bf16 v[226:229], v[210:213], v[52:55], v[226:229]
 s_waitcnt lgkmcnt(2)
 v_mfma_f32_16x16x32_bf16 v[226:229], v[214:217], v[56:59], v[226:229]
 s_barrier
 ds_read_b128 v[206:209], v116 offset:28672
 s_waitcnt lgkmcnt(2)
 v_mfma_f32_16x16x32_bf16 v[226:229], v[218:221], v[60:63], v[226:229]
 s_waitcnt lgkmcnt(1)
 v_mfma_f32_16x16x32_bf16 v[226:229], v[222:225], v[64:67], v[226:229]
 s_cmp_eq_u32 s31, 72
 s_cbranch_scc1 Lfin_183
 s_mov_b32 s41, 0
Lf_184:
 s_waitcnt vmcnt(2)
 v_add_f32 v210, v234, v194
 v_add_f32 v211, v235, v195
 v_add_f32 v212, v236, v196
 v_add_f32 v213, v237, v197
 s_waitcnt vmcnt(1)
 v_add_f32 v214, v238, v198
 v_add_f32 v215, v239, v199
 v_add_f32 v216, v240, v200
 v_add_f32 v217, v241, v201
 v_maximum3_f32 v1, v210, v211, v212
 v_maximum3_f32 v127, v213, v214, v215
 v_maximum3_f32 v1, v1, v216, v217
 s_waitcnt vmcnt(0)
 v_add_f32 v218, v190, v202
 v_add_f32 v219, v191, v203
 v_add_f32 v220, v192, v204
 v_add_f32 v221, v193, v205
 v_maximum3_f32 v127, v127, v218, v219
 v_maximum3_f32 v1, v1, v220, v221
 v_maximum3_f32 v1, v1, v127, v127
 v_cmp_u_f32 vcc, v1, v1
 v_mov_b32 v127, v1
 s_cbranch_vccnz Lfs_185
Lfok_186:
 s_nop 0
 v_permlane32_swap_b32 v1, v127
 v_max_f32 v1, v1, v127
 v_mov_b32 v127, v1
 v_cvt_pk_bf16_f32 v178, v226, v227
 v_cvt_pk_bf16_f32 v179, v228, v229
 v_permlane16_swap_b32 v1, v127
 v_max_f32 v1, v1, v127
 v_mul_f32 v1, s71, v1
 v_fma_f32 v210, v210, s71, -v1
 v_fma_f32 v211, v211, s71, -v1
 v_fma_f32 v212, v212, s71, -v1
 v_fma_f32 v213, v213, s71, -v1
 v_fma_f32 v214, v214, s71, -v1
 v_fma_f32 v215, v215, s71, -v1
 v_fma_f32 v216, v216, s71, -v1
 v_fma_f32 v217, v217, s71, -v1
 v_fma_f32 v218, v218, s71, -v1
 v_fma_f32 v219, v219, s71, -v1
 v_fma_f32 v220, v220, s71, -v1
 v_fma_f32 v221, v221, s71, -v1
 v_exp_f32 v210, v210
 v_exp_f32 v211, v211
 v_exp_f32 v212, v212
 v_exp_f32 v213, v213
 v_exp_f32 v214, v214
 v_exp_f32 v215, v215
 v_exp_f32 v216, v216
 v_exp_f32 v217, v217
 s_mov_b32 exec_lo, 0x00ff00ff
 s_mov_b32 exec_hi, 0x00ff00ff
 v_cvt_pk_bf16_f32 v162, v210, v211
 v_cvt_pk_bf16_f32 v163, v212, v213
 v_cvt_pk_bf16_f32 v164, v214, v215
 v_cvt_pk_bf16_f32 v165, v216, v217
 s_not_b64 exec, exec
 v_cvt_pk_bf16_f32 v166, v210, v211
 v_cvt_pk_bf16_f32 v167, v212, v213
 v_cvt_pk_bf16_f32 v168, v214, v215
 v_cvt_pk_bf16_f32 v169, v216, v217
 s_mov_b64 exec, -1
 v_mfma_f32_16x16x32_bf16 v[200:203], v[186:189], v[162:165], 0
 v_exp_f32 v218, v218
 v_exp_f32 v219, v219
 v_mfma_f32_16x16x32_bf16 v[192:195], v[142:145], v[162:165], 0
 v_exp_f32 v220, v220
 v_mfma_f32_16x16x32_bf16 v[196:199], v[146:149], v[162:165], 0
 v_exp_f32 v221, v221
 v_mfma_f32_16x16x32_bf16 v[200:203], v[186:189], v[166:169], v[200:203]
 v_cvt_pk_bf16_f32 v190, v218, v219
 v_cvt_pk_bf16_f32 v191, v220, v221
 s_waitcnt lgkmcnt(0)
 v_mfma_f32_16x16x32_bf16 v[192:195], v[150:153], v[166:169], v[192:195]
 v_add_f32 v230, v230, v206
 v_add_f32 v231, v231, v207
 v_add_f32 v232, v232, v208
 v_mfma_f32_16x16x32_bf16 v[196:199], v[154:157], v[166:169], v[196:199]
 v_add_f32 v233, v233, v209
 v_cvt_pk_bf16_f32 v180, v230, v231
 v_cvt_pk_bf16_f32 v181, v232, v233
 v_mfma_f32_16x16x16_bf16 v[200:203], v[186:187], v[190:191], v[200:203]
 s_add_u32 s25, s60, s54
 s_add_u32 s27, s60, s55
 v_mfma_f32_16x16x16_bf16 v[192:195], v[178:179], v[190:191], v[192:195]
 s_add_u32 s28, s27, 4096
 v_mfma_f32_16x16x16_bf16 v[196:199], v[180:181], v[190:191], v[196:199]
 s_mov_b32 s41, 0
 s_nop 0
 v_rcp_f32 v127, v200
 s_nop 1
 v_mul_f32 v192, v192, v127
 v_mul_f32 v193, v193, v127
 v_mul_f32 v194, v194, v127
 v_mul_f32 v195, v195, v127
 v_cvt_pk_bf16_f32 v204, v192, v193
 v_cvt_pk_bf16_f32 v205, v194, v195
 v_mul_f32 v196, v196, v127
 v_mul_f32 v197, v197, v127
 v_mul_f32 v198, v198, v127
 v_mul_f32 v199, v199, v127
 v_cvt_pk_bf16_f32 v206, v196, v197
 v_cvt_pk_bf16_f32 v207, v198, v199
 buffer_store_dwordx4 v[204:207], v2, s[4:7], s25 offen sc1
 ds_write_b64 v117, v[178:179] offset:0
 ds_write_b64 v117, v[180:181] offset:2048
 s_sleep 4
 buffer_load_dwordx4 v[190:193], v2, s[4:7], s27 offen offset:0 sc1
 ds_read_b128 v[142:145], v114 offset:0
 ds_read_b128 v[146:149], v114 offset:1024
 s_nop 7
 buffer_load_dwordx4 v[194:197], v2, s[4:7], s27 offen offset:1024 sc1
 ds_read_b128 v[150:153], v114 offset:2048
 ds_read_b128 v[154:157], v114 offset:3072
 s_nop 7
 buffer_load_dwordx4 v[198:201], v2, s[4:7], s27 offen offset:2048 sc1
 ds_read_b128 v[234:237], v114 offset:4096
 ds_read_b128 v[238:241], v114 offset:5120
 s_nop 7
 buffer_load_dwordx4 v[202:205], v2, s[4:7], s27 offen offset:3072 sc1
 ds_read_b128 v[242:245], v114 offset:6144
 ds_read_b128 v[246:249], v114 offset:7168
 s_nop 7
 buffer_load_dwordx4 v[206:209], v2, s[4:7], s28 offen offset:0 sc1
 s_nop 7
 buffer_load_dwordx4 v[210:213], v2, s[4:7], s28 offen offset:1024 sc1
 s_waitcnt lgkmcnt(0)
Lo_187:
 s_waitcnt vmcnt(5)
 v_max3_u32 v1, v190, v191, v192
 v_max_u32 v1, v1, v193
 v_cmp_eq_u32 vcc, -1, v1
 s_cbranch_vccnz Los_188
 v_mfma_f32_16x16x32_bf16 v[214:217], v[142:145], v[190:193], 0
 ds_read_b128 v[142:145], v114 offset:8192
 v_mfma_f32_16x16x32_bf16 v[218:221], v[146:149], v[190:193], 0
 ds_read_b128 v[146:149], v114 offset:9216
 s_waitcnt vmcnt(4)
 v_max3_u32 v1, v194, v195, v196
 v_mfma_f32_16x16x32_bf16 v[222:225], v[150:153], v[190:193], 0
 ds_read_b128 v[150:153], v114 offset:10240
 v_max_u32 v1, v1, v197
 v_mfma_f32_16x16x32_bf16 v[226:229], v[154:157], v[190:193], 0
 ds_read_b128 v[154:157], v114 offset:11264
 v_cmp_eq_u32 vcc, -1, v1
 v_mfma_f32_16x16x32_bf16 v[230:233], v[234:237], v[190:193], 0
 ds_read_b128 v[234:237], v114 offset:12288
Lo_189:
 s_cbranch_vccnz Los_190
 v_mfma_f32_16x16x32_bf16 v[214:217], v[238:241], v[194:197], v[214:217]
 ds_read_b128 v[238:241], v114 offset:13312
 v_mfma_f32_16x16x32_bf16 v[218:221], v[242:245], v[194:197], v[218:221]
 ds_read_b128 v[242:245], v114 offset:14336
 s_waitcnt vmcnt(3)
 v_max3_u32 v1, v198, v199, v200
 v_mfma_f32_16x16x32_bf16 v[222:225], v[246:249], v[194:197], v[222:225]
 ds_read_b128 v[246:249], v115 offset:0
 v_max_u32 v1, v1, v201
 s_waitcnt lgkmcnt(6)
 v_mfma_f32_16x16x32_bf16 v[226:229], v[142:145], v[194:197], v[226:229]
 ds_read_b128 v[142:145], v115 offset:1024
 v_cmp_eq_u32 vcc, -1, v1
 v_mfma_f32_16x16x32_bf16 v[230:233], v[146:149], v[194:197], v[230:233]
 ds_read_b128 v[146:149], v115 offset:2048
Lo_191:
 s_cbranch_vccnz Los_192
 s_waitcnt lgkmcnt(6)
 v_mfma_f32_16x16x32_bf16 v[214:217], v[150:153], v[198:201], v[214:217]
 ds_read_b128 v[150:153], v115 offset:3072
 v_mfma_f32_16x16x32_bf16 v[218:221], v[154:157], v[198:201], v[218:221]
 ds_read_b128 v[154:157], v115 offset:4096
 s_waitcnt vmcnt(2)
 v_max3_u32 v1, v202, v203, v204
 s_waitcnt lgkmcnt(6)
 v_mfma_f32_16x16x32_bf16 v[222:225], v[234:237], v[198:201], v[222:225]
 ds_read_b128 v[234:237], v115 offset:5120
 v_max_u32 v1, v1, v205
 v_mfma_f32_16x16x32_bf16 v[226:229], v[238:241], v[198:201], v[226:229]
 ds_read_b128 v[238:241], v115 offset:6144
 v_cmp_eq_u32 vcc, -1, v1
 s_waitcnt lgkmcnt(6)
 v_mfma_f32_16x16x32_bf16 v[230:233], v[242:245], v[198:201], v[230:233]
 ds_read_b128 v[242:245], v115 offset:7168
Lo_193:
 s_cbranch_vccnz Los_194
 v_mfma_f32_16x16x32_bf16 v[214:217], v[246:249], v[202:205], v[214:217]
 ds_read_b128 v[246:249], v115 offset:8192
 s_waitcnt lgkmcnt(6)
 v_mfma_f32_16x16x32_bf16 v[218:221], v[142:145], v[202:205], v[218:221]
 ds_read_b128 v[142:145], v115 offset:9216
 s_waitcnt vmcnt(1)
 v_max3_u32 v1, v206, v207, v208
 v_mfma_f32_16x16x32_bf16 v[222:225], v[146:149], v[202:205], v[222:225]
 ds_read_b128 v[146:149], v115 offset:10240
 v_max_u32 v1, v1, v209
 s_waitcnt lgkmcnt(6)
 v_mfma_f32_16x16x32_bf16 v[226:229], v[150:153], v[202:205], v[226:229]
 ds_read_b128 v[150:153], v115 offset:11264
 v_cmp_eq_u32 vcc, -1, v1
 v_mfma_f32_16x16x32_bf16 v[230:233], v[154:157], v[202:205], v[230:233]
 ds_read_b128 v[154:157], v115 offset:12288
Lo_195:
 s_cbranch_vccnz Los_196
 s_waitcnt lgkmcnt(6)
 v_mfma_f32_16x16x32_bf16 v[214:217], v[234:237], v[206:209], v[214:217]
 ds_read_b128 v[234:237], v115 offset:13312
 v_mfma_f32_16x16x32_bf16 v[218:221], v[238:241], v[206:209], v[218:221]
 ds_read_b128 v[238:241], v115 offset:14336
 s_waitcnt vmcnt(0)
 v_max3_u32 v1, v210, v211, v212
 s_waitcnt lgkmcnt(6)
 v_mfma_f32_16x16x32_bf16 v[222:225], v[242:245], v[206:209], v[222:225]
 v_max_u32 v1, v1, v213
 v_mfma_f32_16x16x32_bf16 v[226:229], v[246:249], v[206:209], v[226:229]
 v_cmp_eq_u32 vcc, -1, v1
 s_waitcnt lgkmcnt(4)
 v_mfma_f32_16x16x32_bf16 v[230:233], v[142:145], v[206:209], v[230:233]
Lo_197:
 s_cbranch_vccnz Los_198
 v_mfma_f32_16x16x32_bf16 v[214:217], v[146:149], v[210:213], v[214:217]
 buffer_load_dwordx4 v[130:133], v2, s[4:7], s66 offen sc1
 s_waitcnt lgkmcnt(2)
 v_mfma_f32_16x16x32_bf16 v[218:221], v[150:153], v[210:213], v[218:221]
 buffer_load_dwordx4 v[134:137], v2, s[4:7], s66 offen offset:2048 sc1
 v_mfma_f32_16x16x32_bf16 v[222:225], v[154:157], v[210:213], v[222:225]
 s_add_u32 s25, s66, 4096
 buffer_load_dwordx4 v[138:141], v2, s[4:7], s25 offen sc1
 s_waitcnt lgkmcnt(0)
 v_mfma_f32_16x16x32_bf16 v[226:229], v[234:237], v[210:213], v[226:229]
 v_mfma_f32_16x16x32_bf16 v[230:233], v[238:241], v[210:213], v[230:233]
 v_cvt_pk_bf16_f32 v190, v214, v215
 v_cvt_pk_bf16_f32 v191, v216, v217
 v_cvt_pk_bf16_f32 v192, v218, v219
 v_cvt_pk_bf16_f32 v193, v220, v221
 ds_write_b128 v118, v[190:193]
 v_cvt_pk_bf16_f32 v194, v222, v223
 v_cvt_pk_bf16_f32 v195, v224, v225
 v_cvt_pk_bf16_f32 v196, v226, v227
 v_cvt_pk_bf16_f32 v197, v228, v229
 ds_write_b128 v118, v[194:197] offset:4096
 v_cvt_pk_bf16_f32 v198, v230, v231
 v_cvt_pk_bf16_f32 v199, v232, v233
 ds_write_b64 v119, v[198:199] offset:8192
 s_add_u32 s25, s62, s46
 s_add_u32 s26, s25, 8192
 s_add_u32 s27, s25, 655360
 s_add_u32 s28, s26, 655360
 s_waitcnt lgkmcnt(0)
 s_barrier
 s_add_u32 s70, s69, s52
 s_add_u32 s27, s62, s47
 s_add_u32 s28, s62, s48
 s_add_u32 s69, s31, 1
 s_and_b32 s25, s69, 3
 s_mul_i32 s26, s25, 20480
 s_add_u32 s56, s26, s42
 s_add_u32 s57, s56, 4096
 s_add_u32 s58, s26, s43
 s_mul_i32 s62, s25, 163840
 s_xor_b32 s26, s25, 2
 s_mul_i32 s63, s26, 163840
 s_add_u32 s25, s25, 3
 s_and_b32 s25, s25, 3
 s_mul_i32 s26, s25, 20480
 s_add_u32 s59, s26, s43
 s_and_b32 s25, s69, 1
 s_mul_i32 s60, s25, 196608
 s_xor_b32 s25, s25, 1
 s_mul_i32 s61, s25, 196608
 s_mul_i32 s69, s69, 196608
 s_sleep 11
 s_mov_b32 s41, 0
 buffer_load_dwordx4 v[190:193], v2, s[4:7], s27 offen offset:0 sc1
 buffer_load_dwordx4 v[194:197], v2, s[4:7], s27 offen offset:1024 sc1
 buffer_load_dwordx4 v[198:201], v2, s[4:7], s28 offen offset:0 sc1
 buffer_load_dwordx4 v[202:205], v2, s[4:7], s28 offen offset:1024 sc1
 s_waitcnt vmcnt(2)
Lj_200:
 v_mfma_f32_16x16x32_bf16 v[210:213], v[170:173], v[190:193], 0
 v_max3_u32 v214, v190, v191, v192
 v_max3_u32 v215, v193, v194, v195
 v_mfma_f32_16x16x32_bf16 v[210:213], v[174:177], v[194:197], v[210:213]
 v_max3_u32 v214, v214, v196, v197
 v_max_u32 v214, v214, v215
 v_cmp_eq_u32 vcc, -1, v214
 s_cbranch_vccnz Ljs_201
Ly_203:
 s_waitcnt vmcnt(0)
 v_mfma_f32_16x16x32_bf16 v[206:209], v[170:173], v[198:201], v[210:213]
 v_max3_u32 v214, v198, v199, v200
 v_max3_u32 v215, v201, v202, v203
 v_mfma_f32_16x16x32_bf16 v[206:209], v[174:177], v[202:205], v[206:209]
 v_max3_u32 v214, v214, v204, v205
 v_max_u32 v214, v214, v215
 v_cmp_eq_u32 vcc, -1, v214
 s_cbranch_vccz Lyd_202
 buffer_load_dwordx4 v[198:201], v2, s[4:7], s28 offen offset:0 sc1
 buffer_load_dwordx4 v[202:205], v2, s[4:7], s28 offen offset:1024 sc1
 s_add_u32 s41, s41, 1
 s_cmp_gt_u32 s41, 200000
 s_cbranch_scc1 L_fail
 s_branch Ly_203
Lyd_202:
 s_nop 3
 v_cvt_pk_bf16_f32 v214, v206, v207
 v_cvt_pk_bf16_f32 v215, v208, v209
 s_cmp_eq_u32 s31, 8
 s_cbranch_scc1 Lov_204
Lnov_205:
 buffer_store_dwordx2 v[214:215], v121, s[4:7], s58 offen sc1
 buffer_store_dwordx2 v[182:183], v121, s[4:7], s59 offen sc1
Lnr_199:
 s_add_u32 s31, s31, 1
 s_barrier
 s_branch L_rec_top_0r
Lfin_183:
 s_waitcnt lgkmcnt(0)
 s_nop 4
 v_cvt_pk_bf16_f32 v178, v226, v227
 v_cvt_pk_bf16_f32 v179, v228, v229
 v_add_f32 v230, v230, v206
 v_add_f32 v231, v231, v207
 v_add_f32 v232, v232, v208
 v_add_f32 v233, v233, v209
 v_cvt_pk_bf16_f32 v180, v230, v231
 v_cvt_pk_bf16_f32 v181, v232, v233
 ds_write_b64 v117, v[178:179] offset:0
 ds_write_b64 v117, v[180:181] offset:2048
 s_waitcnt lgkmcnt(0)
 s_barrier
 s_endpgm
Lzs_172:
 buffer_load_dwordx4 v[190:193], v2, s[4:7], s56 offen offset:0 sc1
 buffer_load_dwordx4 v[194:197], v2, s[4:7], s56 offen offset:1024 sc1
 buffer_load_dwordx4 v[198:201], v2, s[4:7], s56 offen offset:2048 sc1
 buffer_load_dwordx4 v[202:205], v2, s[4:7], s56 offen offset:3072 sc1
 buffer_load_dwordx4 v[206:209], v2, s[4:7], s57 offen offset:0 sc1
 s_add_u32 s41, s41, 1
 s_cmp_gt_u32 s41, 200000
 s_cbranch_scc1 L_fail
 s_branch Lz_171
Lzs_174:
 buffer_load_dwordx4 v[194:197], v2, s[4:7], s56 offen offset:1024 sc1
 buffer_load_dwordx4 v[198:201], v2, s[4:7], s56 offen offset:2048 sc1
 buffer_load_dwordx4 v[202:205], v2, s[4:7], s56 offen offset:3072 sc1
 buffer_load_dwordx4 v[206:209], v2, s[4:7], s57 offen offset:0 sc1
 s_add_u32 s41, s41, 1
 s_cmp_gt_u32 s41, 200000
 s_cbranch_scc1 L_fail
 s_branch Lz_173
Lzs_176:
 buffer_load_dwordx4 v[198:201], v2, s[4:7], s56 offen offset:2048 sc1
 buffer_load_dwordx4 v[202:205], v2, s[4:7], s56 offen offset:3072 sc1
 buffer_load_dwordx4 v[206:209], v2, s[4:7], s57 offen offset:0 sc1
 s_add_u32 s41, s41, 1
 s_cmp_gt_u32 s41, 200000
 s_cbranch_scc1 L_fail
 s_branch Lz_175
Lzs_178:
 buffer_load_dwordx4 v[202:205], v2, s[4:7], s56 offen offset:3072 sc1
 buffer_load_dwordx4 v[206:209], v2, s[4:7], s57 offen offset:0 sc1
 s_add_u32 s41, s41, 1
 s_cmp_gt_u32 s41, 200000
 s_cbranch_scc1 L_fail
 s_branch Lz_177
Lzs_180:
 buffer_load_dwordx4 v[206:209], v2, s[4:7], s57 offen offset:0 sc1
 s_add_u32 s41, s41, 1
 s_cmp_gt_u32 s41, 200000
 s_cbranch_scc1 L_fail
 s_branch Lz_179
Lfs_185:
 v_max3_u32 v222, v194, v195, v196
 v_max3_u32 v222, v222, v197, v198
 v_max3_u32 v222, v222, v199, v200
 v_max3_u32 v222, v222, v201, v202
 v_max3_u32 v222, v222, v203, v204
 v_max_u32 v222, v222, v205
 v_cmp_eq_u32 vcc, -1, v222
 s_cbranch_vccz Lfok_186
 buffer_load_dwordx4 v[194:197], v2, s[4:7], s27 offen offset:0 sc1
 buffer_load_dwordx4 v[198:201], v2, s[4:7], s27 offen offset:1024 sc1
 buffer_load_dwordx4 v[202:205], v2, s[4:7], s27 offen offset:2048 sc1
 s_add_u32 s41, s41, 1
 s_cmp_gt_u32 s41, 200000
 s_cbranch_scc1 L_fail
 s_branch Lf_184
Los_188:
 buffer_load_dwordx4 v[190:193], v2, s[4:7], s27 offen offset:0 sc1
 buffer_load_dwordx4 v[194:197], v2, s[4:7], s27 offen offset:1024 sc1
 buffer_load_dwordx4 v[198:201], v2, s[4:7], s27 offen offset:2048 sc1
 buffer_load_dwordx4 v[202:205], v2, s[4:7], s27 offen offset:3072 sc1
 buffer_load_dwordx4 v[206:209], v2, s[4:7], s28 offen offset:0 sc1
 buffer_load_dwordx4 v[210:213], v2, s[4:7], s28 offen offset:1024 sc1
 s_add_u32 s41, s41, 1
 s_cmp_gt_u32 s41, 200000
 s_cbranch_scc1 L_fail
 s_branch Lo_187
Los_190:
 buffer_load_dwordx4 v[194:197], v2, s[4:7], s27 offen offset:1024 sc1
 buffer_load_dwordx4 v[198:201], v2, s[4:7], s27 offen offset:2048 sc1
 buffer_load_dwordx4 v[202:205], v2, s[4:7], s27 offen offset:3072 sc1
 buffer_load_dwordx4 v[206:209], v2, s[4:7], s28 offen offset:0 sc1
 buffer_load_dwordx4 v[210:213], v2, s[4:7], s28 offen offset:1024 sc1
 s_waitcnt vmcnt(4)
 v_max3_u32 v1, v194, v195, v196
 v_max_u32 v1, v1, v197
 v_cmp_eq_u32 vcc, -1, v1
 s_add_u32 s41, s41, 1
 s_cmp_gt_u32 s41, 200000
 s_cbranch_scc1 L_fail
 s_branch Lo_189
Los_192:
 buffer_load_dwordx4 v[198:201], v2, s[4:7], s27 offen offset:2048 sc1
 buffer_load_dwordx4 v[202:205], v2, s[4:7], s27 offen offset:3072 sc1
 buffer_load_dwordx4 v[206:209], v2, s[4:7], s28 offen offset:0 sc1
 buffer_load_dwordx4 v[210:213], v2, s[4:7], s28 offen offset:1024 sc1
 s_waitcnt vmcnt(3)
 v_max3_u32 v1, v198, v199, v200
 v_max_u32 v1, v1, v201
 v_cmp_eq_u32 vcc, -1, v1
 s_add_u32 s41, s41, 1
 s_cmp_gt_u32 s41, 200000
 s_cbranch_scc1 L_fail
 s_branch Lo_191
Los_194:
 buffer_load_dwordx4 v[202:205], v2, s[4:7], s27 offen offset:3072 sc1
 buffer_load_dwordx4 v[206:209], v2, s[4:7], s28 offen offset:0 sc1
 buffer_load_dwordx4 v[210:213], v2, s[4:7], s28 offen offset:1024 sc1
 s_waitcnt vmcnt(2)
 v_max3_u32 v1, v202, v203, v204
 v_max_u32 v1, v1, v205
 v_cmp_eq_u32 vcc, -1, v1
 s_add_u32 s41, s41, 1
 s_cmp_gt_u32 s41, 200000
 s_cbranch_scc1 L_fail
 s_branch Lo_193
Los_196:
 buffer_load_dwordx4 v[206:209], v2, s[4:7], s28 offen offset:0 sc1
 buffer_load_dwordx4 v[210:213], v2, s[4:7], s28 offen offset:1024 sc1
 s_waitcnt vmcnt(1)
 v_max3_u32 v1, v206, v207, v208
 v_max_u32 v1, v1, v209
 v_cmp_eq_u32 vcc, -1, v1
 s_add_u32 s41, s41, 1
 s_cmp_gt_u32 s41, 200000
 s_cbranch_scc1 L_fail
 s_branch Lo_195
Los_198:
 buffer_load_dwordx4 v[210:213], v2, s[4:7], s28 offen offset:1024 sc1
 s_waitcnt vmcnt(0)
 v_max3_u32 v1, v210, v211, v212
 v_max_u32 v1, v1, v213
 v_cmp_eq_u32 vcc, -1, v1
 s_add_u32 s41, s41, 1
 s_cmp_gt_u32 s41, 200000
 s_cbranch_scc1 L_fail
 s_branch Lo_197
Ljs_201:
 buffer_load_dwordx4 v[190:193], v2, s[4:7], s27 offen offset:0 sc1
 buffer_load_dwordx4 v[194:197], v2, s[4:7], s27 offen offset:1024 sc1
 s_waitcnt vmcnt(0)
 s_add_u32 s41, s41, 1
 s_cmp_gt_u32 s41, 200000
 s_cbranch_scc1 L_fail
 s_branch Lj_200
Lov_204:
 s_mov_b32 exec_lo, 0xff00ff00
 s_mov_b32 exec_hi, 0xff00ff00
 v_mov_b32 v214, v128
 v_mov_b32 v215, v129
 s_mov_b64 exec, -1
 s_add_u32 s41, s41, 1
 s_cmp_gt_u32 s41, 200000
 s_cbranch_scc1 L_fail
 s_branch Lnov_205
Lpwn_169:
 s_cmp_eq_u32 s3, 1
 s_cbranch_scc0 Lpwn_206
 s_waitcnt vmcnt(0)
 s_cmp_eq_u32 s40, 0
 s_cbranch_scc1 Lz0_207
 buffer_store_dwordx2 v[128:129], v121, s[4:7], s43 offen sc1
Lz0_207:
 s_barrier
L_rec_top_1r:
 s_mov_b32 s41, 0
 s_sleep 2
 buffer_load_dwordx4 v[190:193], v2, s[4:7], s56 offen offset:0 sc1
 s_nop 11
 buffer_load_dwordx4 v[194:197], v2, s[4:7], s56 offen offset:1024 sc1
 s_nop 11
 buffer_load_dwordx4 v[198:201], v2, s[4:7], s56 offen offset:2048 sc1
 s_nop 11
 buffer_load_dwordx4 v[202:205], v2, s[4:7], s56 offen offset:3072 sc1
 s_nop 11
 buffer_load_dwordx4 v[206:209], v2, s[4:7], s57 offen offset:0 sc1
Lz_208:
 s_waitcnt vmcnt(4)
 ds_write_b128 v108, v[190:193] offset:0
 v_mfma_f32_16x16x32_bf16 v[226:229], a[0:3], v[190:193], 0
 v_max3_u32 v1, v190, v191, v192
 v_max_u32 v1, v1, v193
 v_mfma_f32_16x16x32_bf16 v[230:233], a[80:83], v[190:193], 0
 v_cmp_eq_u32 vcc, -1, v1
 v_mfma_f32_16x16x32_bf16 v[234:237], a[160:163], v[190:193], 0
 s_cbranch_vccnz Lzs_209
Lz_210:
 s_waitcnt vmcnt(3)
 ds_write_b128 v108, v[194:197] offset:1024
 v_max3_u32 v1, v194, v195, v196
 v_max_u32 v1, v1, v197
 v_cmp_eq_u32 vcc, -1, v1
 s_cbranch_vccnz Lzs_211
 v_mfma_f32_16x16x32_bf16 v[226:229], a[4:7], v[194:197], v[226:229]
 v_mfma_f32_16x16x32_bf16 v[230:233], a[84:87], v[194:197], v[230:233]
 v_mfma_f32_16x16x32_bf16 v[234:237], a[164:167], v[194:197], v[234:237]
Lz_212:
 s_waitcnt vmcnt(2)
 ds_write_b128 v108, v[198:201] offset:2048
 v_max3_u32 v1, v198, v199, v200
 v_max_u32 v1, v1, v201
 v_cmp_eq_u32 vcc, -1, v1
 s_cbranch_vccnz Lzs_213
 v_mfma_f32_16x16x32_bf16 v[226:229], a[8:11], v[198:201], v[226:229]
 v_mfma_f32_16x16x32_bf16 v[230:233], a[88:91], v[198:201], v[230:233]
 v_mfma_f32_16x16x32_bf16 v[234:237], a[168:171], v[198:201], v[234:237]
Lz_214:
 s_waitcnt vmcnt(1)
 ds_write_b128 v108, v[202:205] offset:3072
 v_max3_u32 v1, v202, v203, v204
 v_max_u32 v1, v1, v205
 v_cmp_eq_u32 vcc, -1, v1
 s_cbranch_vccnz Lzs_215
Lz_216:
 s_waitcnt vmcnt(0)
 ds_write_b128 v108, v[206:209] offset:4096
 v_max3_u32 v1, v206, v207, v208
 v_max_u32 v1, v1, v209
 v_cmp_eq_u32 vcc, -1, v1
 s_cbranch_vccnz Lzs_217
 s_waitcnt lgkmcnt(0)
 s_barrier
 ds_read_b128 v[214:217], v109 offset:0
 ds_read_b128 v[218:221], v109 offset:1024
 ds_read_b128 v[222:225], v109 offset:2048
 v_mfma_f32_16x16x32_bf16 v[226:229], a[12:15], v[202:205], v[226:229]
 buffer_load_dword v126, v124, s[4:7], 0 offen sc1
 v_mfma_f32_16x16x32_bf16 v[230:233], a[92:95], v[202:205], v[230:233]
 v_mfma_f32_16x16x32_bf16 v[234:237], a[172:175], v[202:205], v[234:237]
 v_mfma_f32_16x16x32_bf16 v[226:229], a[16:19], v[206:209], v[226:229]
 s_add_u32 s25, s67, s50
 v_mfma_f32_16x16x32_bf16 v[230:233], a[96:99], v[206:209], v[230:233]
 buffer_load_dwordx4 v[142:145], v2, s[4:7], s25 offen sc1
 v_mfma_f32_16x16x32_bf16 v[234:237], a[176:179], v[206:209], v[234:237]
 ds_read_b128 v[210:213], v109 offset:3072
 s_waitcnt lgkmcnt(3)
 v_mfma_f32_16x16x32_bf16 v[226:229], a[20:23], v[214:217], v[226:229]
 s_add_u32 s25, s67, s51
 v_mfma_f32_16x16x32_bf16 v[230:233], a[100:103], v[214:217], v[230:233]
 buffer_load_dwordx4 v[146:149], v2, s[4:7], s25 offen sc1
 v_mfma_f32_16x16x32_bf16 v[234:237], a[180:183], v[214:217], v[234:237]
 ds_read_b128 v[214:217], v109 offset:4096
 s_waitcnt lgkmcnt(3)
 v_mfma_f32_16x16x32_bf16 v[226:229], a[24:27], v[218:221], v[226:229]
 s_add_u32 s25, s68, s50
 v_mfma_f32_16x16x32_bf16 v[230:233], a[104:107], v[218:221], v[230:233]
 buffer_load_dwordx4 v[150:153], v2, s[4:7], s25 offen sc1
 v_mfma_f32_16x16x32_bf16 v[234:237], a[184:187], v[218:221], v[234:237]
 ds_read_b128 v[218:221], v110 offset:0
 s_waitcnt lgkmcnt(3)
 v_mfma_f32_16x16x32_bf16 v[226:229], a[28:31], v[222:225], v[226:229]
 s_add_u32 s25, s68, s51
 v_mfma_f32_16x16x32_bf16 v[230:233], a[108:111], v[222:225], v[230:233]
 buffer_load_dwordx4 v[154:157], v2, s[4:7], s25 offen sc1
 v_mfma_f32_16x16x32_bf16 v[234:237], a[188:191], v[222:225], v[234:237]
 ds_read_b128 v[222:225], v110 offset:1024
 s_waitcnt lgkmcnt(3)
 v_mfma_f32_16x16x32_bf16 v[226:229], a[32:35], v[210:213], v[226:229]
 s_add_u32 s25, s44, s61
 v_mfma_f32_16x16x32_bf16 v[230:233], a[112:115], v[210:213], v[230:233]
 s_add_u32 s25, s25, 1867776
 v_mfma_f32_16x16x32_bf16 v[234:237], a[192:195], v[210:213], v[234:237]
 buffer_store_dwordx4 v[182:185], v2, s[4:7], s25 offen offset:0 sc1
 ds_read_b128 v[210:213], v110 offset:2048
 s_waitcnt lgkmcnt(3)
 v_mfma_f32_16x16x32_bf16 v[226:229], a[36:39], v[214:217], v[226:229]
 s_add_u32 s25, s44, s61
 v_mfma_f32_16x16x32_bf16 v[230:233], a[116:119], v[214:217], v[230:233]
 s_add_u32 s25, s25, 1867776
 v_mfma_f32_16x16x32_bf16 v[234:237], a[196:199], v[214:217], v[234:237]
 buffer_store_dwordx4 v[182:185], v2, s[4:7], s25 offen offset:1024 sc1
 ds_read_b128 v[214:217], v110 offset:3072
 s_waitcnt lgkmcnt(3)
 v_mfma_f32_16x16x32_bf16 v[226:229], a[40:43], v[218:221], v[226:229]
 s_add_u32 s25, s44, s61
 v_mfma_f32_16x16x32_bf16 v[230:233], a[120:123], v[218:221], v[230:233]
 s_add_u32 s25, s25, 1867776
 v_mfma_f32_16x16x32_bf16 v[234:237], a[200:203], v[218:221], v[234:237]
 buffer_store_dwordx4 v[182:185], v2, s[4:7], s25 offen offset:2048 sc1
 ds_read_b128 v[218:221], v110 offset:4096
 s_waitcnt lgkmcnt(3)
 v_mfma_f32_16x16x32_bf16 v[226:229], a[44:47], v[222:225], v[226:229]
 s_add_u32 s25, s31, 1
 s_mul_i32 s67, s25, 393216
 v_mfma_f32_16x16x32_bf16 v[230:233], a[124:127], v[222:225], v[230:233]
 s_add_u32 s67, s67, 84312064
 s_cmp_lt_u32 s25, 64
 v_mfma_f32_16x16x32_bf16 v[234:237], a[204:207], v[222:225], v[234:237]
 s_cselect_b32 s67, s67, 2146435072
 ds_read_b128 v[222:225], v111 offset:0
 s_waitcnt lgkmcnt(3)
 v_mfma_f32_16x16x32_bf16 v[226:229], a[48:51], v[210:213], v[226:229]
 s_sub_u32 s26, s25, 9
 s_mul_i32 s68, s26, 393216
 v_mfma_f32_16x16x32_bf16 v[230:233], a[128:131], v[210:213], v[230:233]
 s_add_u32 s68, s68, 134643712
 s_cmp_lt_u32 s26, 64
 v_mfma_f32_16x16x32_bf16 v[234:237], a[208:211], v[210:213], v[234:237]
 s_cselect_b32 s68, s68, 2146435072
 ds_read_b128 v[210:213], v111 offset:1024
 s_waitcnt lgkmcnt(3)
 v_mfma_f32_16x16x32_bf16 v[226:229], a[52:55], v[214:217], v[226:229]
 s_add_u32 s25, s67, 4269801472
 s_add_u32 s26, s68, 4269801472
 v_mfma_f32_16x16x32_bf16 v[230:233], a[132:135], v[214:217], v[230:233]
 s_cmp_lt_u32 s3, 2
 s_cselect_b32 s66, s25, s26
 v_mfma_f32_16x16x32_bf16 v[234:237], a[212:215], v[214:217], v[234:237]
 s_add_u32 s66, s66, s49
 ds_read_b128 v[214:217], v111 offset:2048
 s_waitcnt lgkmcnt(3)
 v_mfma_f32_16x16x32_bf16 v[226:229], a[56:59], v[218:221], v[226:229]
 v_mfma_f32_16x16x32_bf16 v[230:233], a[136:139], v[218:221], v[230:233]
 v_mfma_f32_16x16x32_bf16 v[234:237], a[216:219], v[218:221], v[234:237]
 ds_read_b128 v[218:221], v111 offset:3072
 s_waitcnt lgkmcnt(3)
 v_mfma_f32_16x16x32_bf16 v[226:229], a[60:63], v[222:225], v[226:229]
 v_mfma_f32_16x16x32_bf16 v[230:233], a[140:143], v[222:225], v[230:233]
 v_mfma_f32_16x16x32_bf16 v[234:237], a[220:223], v[222:225], v[234:237]
 ds_read_b128 v[222:225], v111 offset:4096
 s_waitcnt lgkmcnt(3)
 v_mfma_f32_16x16x32_bf16 v[226:229], a[64:67], v[210:213], v[226:229]
 v_mfma_f32_16x16x32_bf16 v[230:233], a[144:147], v[210:213], v[230:233]
 v_mfma_f32_16x16x32_bf16 v[234:237], a[224:227], v[210:213], v[234:237]
 s_waitcnt lgkmcnt(2)
 v_mfma_f32_16x16x32_bf16 v[226:229], a[68:71], v[214:217], v[226:229]
 v_mfma_f32_16x16x32_bf16 v[230:233], a[148:151], v[214:217], v[230:233]
 v_mfma_f32_16x16x32_bf16 v[234:237], a[228:231], v[214:217], v[234:237]
 s_waitcnt lgkmcnt(1)
 v_mfma_f32_16x16x32_bf16 v[226:229], a[72:75], v[218:221], v[226:229]
 v_mfma_f32_16x16x32_bf16 v[230:233], a[152:155], v[218:221], v[230:233]
 v_mfma_f32_16x16x32_bf16 v[234:237], a[232:235], v[218:221], v[234:237]
 s_waitcnt lgkmcnt(0)
 v_mfma_f32_16x16x32_bf16 v[226:229], a[76:79], v[222:225], v[226:229]
 v_mfma_f32_16x16x32_bf16 v[230:233], a[156:159], v[222:225], v[230:233]
 v_mfma_f32_16x16x32_bf16 v[234:237], a[236:239], v[222:225], v[234:237]
 s_nop 1
 v_cvt_pk_bf16_f32 v190, v226, v227
 v_cvt_pk_bf16_f32 v191, v228, v229
 ds_write_b64 v112, v[190:191] offset:0
 v_cvt_pk_bf16_f32 v192, v230, v231
 v_cvt_pk_bf16_f32 v193, v232, v233
 ds_write_b64 v113, v[192:193] offset:0
 v_cvt_pk_bf16_f32 v194, v234, v235
 v_cvt_pk_bf16_f32 v195, v236, v237
 ds_write_b64 v112, v[194:195] offset:1024
 s_add_u32 s26, s60, s44
 s_add_u32 s27, s60, s45
 s_waitcnt lgkmcnt(0)
 s_barrier
 ds_read_b128 v[198:201], v3 offset:20480
 ds_read_b128 v[202:205], v3 offset:21504
 ds_read_b128 v[206:209], v3 offset:22528
 ds_read_b128 v[226:229], v3 offset:23552
 ds_read_b128 v[230:233], v3 offset:24576
 ds_read_b128 v[234:237], v3 offset:25600
 ds_read_b128 v[210:213], v108 offset:0
 ds_read_b128 v[214:217], v108 offset:1024
 ds_read_b128 v[218:221], v108 offset:2048
 s_waitcnt lgkmcnt(8)
 v_mfma_f32_16x16x32_bf16 v[194:197], v[130:133], v[198:201], 0
 s_waitcnt lgkmcnt(7)
 v_mfma_f32_16x16x32_bf16 v[194:197], v[134:137], v[202:205], v[194:197]
 s_waitcnt lgkmcnt(6)
 v_mfma_f32_16x16x32_bf16 v[194:197], v[138:141], v[206:209], v[194:197]
 s_waitcnt lgkmcnt(5)
 v_mfma_f32_16x16x32_bf16 v[190:193], v[226:229], v[198:201], v[158:161]
 s_waitcnt lgkmcnt(4)
 v_mfma_f32_16x16x32_bf16 v[190:193], v[230:233], v[202:205], v[190:193]
 s_mov_b32 exec_lo, 0x00ff00ff
 s_mov_b32 exec_hi, 0x00ff00ff
 s_waitcnt lgkmcnt(3)
 v_mfma_f32_16x16x32_bf16 v[190:193], v[234:237], v[206:209], v[190:193]
 buffer_store_dwordx4 v[194:197], v2, s[4:7], s26 offen offset:1024 sc1
 ds_write_b128 v116, v[194:197] offset:26624
 s_mov_b64 exec, -1
 ds_read_b128 v[222:225], v108 offset:3072
 s_waitcnt lgkmcnt(4)
 v_mfma_f32_16x16x32_bf16 v[226:229], v[210:213], a[240:243], 0
 v_mfma_f32_16x16x32_bf16 v[230:233], v[210:213], v[68:71], 0
 ds_read_b128 v[210:213], v108 offset:4096
 s_waitcnt lgkmcnt(4)
 v_mfma_f32_16x16x32_bf16 v[226:229], v[214:217], a[244:247], v[226:229]
 v_mfma_f32_16x16x32_bf16 v[230:233], v[214:217], v[72:75], v[230:233]
 ds_read_b128 v[214:217], v109 offset:0
 s_waitcnt lgkmcnt(4)
 v_mfma_f32_16x16x32_bf16 v[226:229], v[218:221], a[248:251], v[226:229]
 v_mfma_f32_16x16x32_bf16 v[230:233], v[218:221], v[76:79], v[230:233]
 ds_read_b128 v[218:221], v109 offset:1024
 s_waitcnt lgkmcnt(3)
 v_mfma_f32_16x16x32_bf16 v[226:229], v[222:225], a[252:255], v[226:229]
 v_mfma_f32_16x16x32_bf16 v[230:233], v[222:225], v[80:83], v[230:233]
 s_waitcnt vmcnt(8)
 s_mov_b32 s41, 0
 v_min_i32 v1, 64, v125
 v_cmp_ge_i32 vcc, v126, v1
 s_nop 0
 s_cmp_eq_u64 vcc, -1
 s_cbranch_scc1 Lflok_219
Lfl_218:
 s_add_u32 s41, s41, 1
 s_cmp_gt_u32 s41, 200000
 s_cbranch_scc1 L_fail
 buffer_load_dword v126, v124, s[4:7], 0 offen sc1
 s_waitcnt vmcnt(0)
 v_cmp_ge_i32 vcc, v126, v1
 s_nop 0
 s_cmp_eq_u64 vcc, -1
 s_cbranch_scc0 Lfl_218
Lflok_219:
 v_add_u32 v125, 1, v125
 ds_read_b128 v[222:225], v109 offset:2048
 s_waitcnt lgkmcnt(3)
 v_mfma_f32_16x16x32_bf16 v[226:229], v[210:213], v[4:7], v[226:229]
 v_mfma_f32_16x16x32_bf16 v[230:233], v[210:213], v[84:87], v[230:233]
 s_barrier
 ds_read_b128 v[234:237], v3 offset:26624
 ds_read_b128 v[238:241], v3 offset:27648
 ds_read_b128 v[210:213], v109 offset:3072
 s_waitcnt lgkmcnt(5)
 v_mfma_f32_16x16x32_bf16 v[226:229], v[214:217], v[8:11], v[226:229]
 v_mfma_f32_16x16x32_bf16 v[230:233], v[214:217], v[88:91], v[230:233]
 ds_read_b128 v[214:217], v109 offset:4096
 s_waitcnt lgkmcnt(5)
 v_mfma_f32_16x16x32_bf16 v[226:229], v[218:221], v[12:15], v[226:229]
 v_mfma_f32_16x16x32_bf16 v[230:233], v[218:221], v[92:95], v[230:233]
 ds_read_b128 v[218:221], v110 offset:0
 s_waitcnt lgkmcnt(5)
 v_mfma_f32_16x16x32_bf16 v[226:229], v[222:225], v[16:19], v[226:229]
 v_mfma_f32_16x16x32_bf16 v[230:233], v[222:225], v[96:99], v[230:233]
 ds_read_b128 v[222:225], v110 offset:1024
 s_waitcnt lgkmcnt(3)
 v_mfma_f32_16x16x32_bf16 v[226:229], v[210:213], v[20:23], v[226:229]
 v_mfma_f32_16x16x32_bf16 v[230:233], v[210:213], v[100:103], v[230:233]
 buffer_load_dwordx4 v[194:197], v2, s[4:7], s27 offen offset:0 sc1
 ds_read_b128 v[210:213], v110 offset:2048
 s_waitcnt lgkmcnt(3)
 v_mfma_f32_16x16x32_bf16 v[226:229], v[214:217], v[24:27], v[226:229]
 v_mfma_f32_16x16x32_bf16 v[230:233], v[214:217], v[104:107], v[230:233]
 ds_read_b128 v[214:217], v110 offset:3072
 s_waitcnt lgkmcnt(3)
 v_mfma_f32_16x16x32_bf16 v[226:229], v[218:221], v[28:31], v[226:229]
 ds_read_b128 v[218:221], v110 offset:4096
 s_waitcnt lgkmcnt(3)
 v_mfma_f32_16x16x32_bf16 v[226:229], v[222:225], v[32:35], v[226:229]
 buffer_load_dwordx4 v[198:201], v2, s[4:7], s27 offen offset:1024 sc1
 ds_read_b128 v[222:225], v111 offset:0
 s_waitcnt lgkmcnt(3)
 v_mfma_f32_16x16x32_bf16 v[226:229], v[210:213], v[36:39], v[226:229]
 ds_read_b128 v[210:213], v111 offset:1024
 s_waitcnt lgkmcnt(3)
 v_mfma_f32_16x16x32_bf16 v[226:229], v[214:217], v[40:43], v[226:229]
 ds_read_b128 v[214:217], v111 offset:2048
 s_waitcnt lgkmcnt(3)
 v_mfma_f32_16x16x32_bf16 v[226:229], v[218:221], v[44:47], v[226:229]
 buffer_load_dwordx4 v[202:205], v2, s[4:7], s27 offen offset:2048 sc1
 ds_read_b128 v[218:221], v111 offset:3072
 s_waitcnt lgkmcnt(3)
 v_mfma_f32_16x16x32_bf16 v[226:229], v[222:225], v[48:51], v[226:229]
 ds_read_b128 v[222:225], v111 offset:4096
 s_waitcnt lgkmcnt(3)
 v_mfma_f32_16x16x32_bf16 v[226:229], v[210:213], v[52:55], v[226:229]
 s_waitcnt lgkmcnt(2)
 v_mfma_f32_16x16x32_bf16 v[226:229], v[214:217], v[56:59], v[226:229]
 s_barrier
 ds_read_b128 v[206:209], v116 offset:28672
 s_waitcnt lgkmcnt(2)
 v_mfma_f32_16x16x32_bf16 v[226:229], v[218:221], v[60:63], v[226:229]
 s_waitcnt lgkmcnt(1)
 v_mfma_f32_16x16x32_bf16 v[226:229], v[222:225], v[64:67], v[226:229]
 s_cmp_eq_u32 s31, 72
 s_cbranch_scc1 Lfin_220
 s_mov_b32 s41, 0
Lf_221:
 s_waitcnt vmcnt(2)
 v_add_f32 v210, v234, v194
 v_add_f32 v211, v235, v195
 v_add_f32 v212, v236, v196
 v_add_f32 v213, v237, v197
 s_waitcnt vmcnt(1)
 v_add_f32 v214, v238, v198
 v_add_f32 v215, v239, v199
 v_add_f32 v216, v240, v200
 v_add_f32 v217, v241, v201
 v_maximum3_f32 v1, v210, v211, v212
 v_maximum3_f32 v127, v213, v214, v215
 v_maximum3_f32 v1, v1, v216, v217
 s_waitcnt vmcnt(0)
 v_add_f32 v218, v190, v202
 v_add_f32 v219, v191, v203
 v_add_f32 v220, v192, v204
 v_add_f32 v221, v193, v205
 v_maximum3_f32 v127, v127, v218, v219
 v_maximum3_f32 v1, v1, v220, v221
 v_maximum3_f32 v1, v1, v127, v127
 v_cmp_u_f32 vcc, v1, v1
 v_mov_b32 v127, v1
 s_cbranch_vccnz Lfs_222
Lfok_223:
 s_nop 0
 v_permlane32_swap_b32 v1, v127
 v_max_f32 v1, v1, v127
 v_mov_b32 v127, v1
 v_cvt_pk_bf16_f32 v178, v226, v227
 v_cvt_pk_bf16_f32 v179, v228, v229
 v_permlane16_swap_b32 v1, v127
 v_max_f32 v1, v1, v127
 v_mul_f32 v1, s71, v1
 v_fma_f32 v210, v210, s71, -v1
 v_fma_f32 v211, v211, s71, -v1
 v_fma_f32 v212, v212, s71, -v1
 v_fma_f32 v213, v213, s71, -v1
 v_fma_f32 v214, v214, s71, -v1
 v_fma_f32 v215, v215, s71, -v1
 v_fma_f32 v216, v216, s71, -v1
 v_fma_f32 v217, v217, s71, -v1
 v_fma_f32 v218, v218, s71, -v1
 v_fma_f32 v219, v219, s71, -v1
 v_fma_f32 v220, v220, s71, -v1
 v_fma_f32 v221, v221, s71, -v1
 v_exp_f32 v210, v210
 v_exp_f32 v211, v211
 v_exp_f32 v212, v212
 v_exp_f32 v213, v213
 v_exp_f32 v214, v214
 v_exp_f32 v215, v215
 v_exp_f32 v216, v216
 v_exp_f32 v217, v217
 s_mov_b32 exec_lo, 0x00ff00ff
 s_mov_b32 exec_hi, 0x00ff00ff
 v_cvt_pk_bf16_f32 v162, v210, v211
 v_cvt_pk_bf16_f32 v163, v212, v213
 v_cvt_pk_bf16_f32 v164, v214, v215
 v_cvt_pk_bf16_f32 v165, v216, v217
 s_not_b64 exec, exec
 v_cvt_pk_bf16_f32 v166, v210, v211
 v_cvt_pk_bf16_f32 v167, v212, v213
 v_cvt_pk_bf16_f32 v168, v214, v215
 v_cvt_pk_bf16_f32 v169, v216, v217
 s_mov_b64 exec, -1
 v_mfma_f32_16x16x32_bf16 v[200:203], v[186:189], v[162:165], 0
 v_exp_f32 v218, v218
 v_exp_f32 v219, v219
 v_mfma_f32_16x16x32_bf16 v[192:195], v[142:145], v[162:165], 0
 v_exp_f32 v220, v220
 v_mfma_f32_16x16x32_bf16 v[196:199], v[146:149], v[162:165], 0
 v_exp_f32 v221, v221
 v_mfma_f32_16x16x32_bf16 v[200:203], v[186:189], v[166:169], v[200:203]
 v_cvt_pk_bf16_f32 v190, v218, v219
 v_cvt_pk_bf16_f32 v191, v220, v221
 s_waitcnt lgkmcnt(0)
 v_mfma_f32_16x16x32_bf16 v[192:195], v[150:153], v[166:169], v[192:195]
 v_add_f32 v230, v230, v206
 v_add_f32 v231, v231, v207
 v_add_f32 v232, v232, v208
 v_mfma_f32_16x16x32_bf16 v[196:199], v[154:157], v[166:169], v[196:199]
 v_add_f32 v233, v233, v209
 v_cvt_pk_bf16_f32 v180, v230, v231
 v_cvt_pk_bf16_f32 v181, v232, v233
 v_mfma_f32_16x16x16_bf16 v[200:203], v[186:187], v[190:191], v[200:203]
 s_add_u32 s25, s60, s54
 s_add_u32 s27, s60, s55
 v_mfma_f32_16x16x16_bf16 v[192:195], v[178:179], v[190:191], v[192:195]
 s_add_u32 s28, s27, 4096
 v_mfma_f32_16x16x16_bf16 v[196:199], v[180:181], v[190:191], v[196:199]
 s_mov_b32 s41, 0
 s_nop 0
 v_rcp_f32 v127, v200
 s_nop 1
 v_mul_f32 v192, v192, v127
 v_mul_f32 v193, v193, v127
 v_mul_f32 v194, v194, v127
 v_mul_f32 v195, v195, v127
 v_cvt_pk_bf16_f32 v204, v192, v193
 v_cvt_pk_bf16_f32 v205, v194, v195
 v_mul_f32 v196, v196, v127
 v_mul_f32 v197, v197, v127
 v_mul_f32 v198, v198, v127
 v_mul_f32 v199, v199, v127
 v_cvt_pk_bf16_f32 v206, v196, v197
 v_cvt_pk_bf16_f32 v207, v198, v199
 buffer_store_dwordx4 v[204:207], v2, s[4:7], s25 offen sc1
 ds_write_b64 v117, v[178:179] offset:512
 ds_write_b64 v117, v[180:181] offset:2560
 s_sleep 4
 buffer_load_dwordx4 v[190:193], v2, s[4:7], s27 offen offset:0 sc1
 ds_read_b128 v[142:145], v114 offset:0
 ds_read_b128 v[146:149], v114 offset:1024
 s_nop 7
 buffer_load_dwordx4 v[194:197], v2, s[4:7], s27 offen offset:1024 sc1
 ds_read_b128 v[150:153], v114 offset:2048
 ds_read_b128 v[154:157], v114 offset:3072
 s_nop 7
 buffer_load_dwordx4 v[198:201], v2, s[4:7], s27 offen offset:2048 sc1
 ds_read_b128 v[234:237], v114 offset:4096
 ds_read_b128 v[238:241], v114 offset:5120
 s_nop 7
 buffer_load_dwordx4 v[202:205], v2, s[4:7], s27 offen offset:3072 sc1
 ds_read_b128 v[242:245], v114 offset:6144
 ds_read_b128 v[246:249], v114 offset:7168
 s_nop 7
 buffer_load_dwordx4 v[206:209], v2, s[4:7], s28 offen offset:0 sc1
 s_nop 7
 buffer_load_dwordx4 v[210:213], v2, s[4:7], s28 offen offset:1024 sc1
 s_waitcnt lgkmcnt(0)
Lo_224:
 s_waitcnt vmcnt(5)
 v_max3_u32 v1, v190, v191, v192
 v_max_u32 v1, v1, v193
 v_cmp_eq_u32 vcc, -1, v1
 s_cbranch_vccnz Los_225
 v_mfma_f32_16x16x32_bf16 v[214:217], v[142:145], v[190:193], 0
 ds_read_b128 v[142:145], v114 offset:8192
 v_mfma_f32_16x16x32_bf16 v[218:221], v[146:149], v[190:193], 0
 ds_read_b128 v[146:149], v114 offset:9216
 s_waitcnt vmcnt(4)
 v_max3_u32 v1, v194, v195, v196
 v_mfma_f32_16x16x32_bf16 v[222:225], v[150:153], v[190:193], 0
 ds_read_b128 v[150:153], v114 offset:10240
 v_max_u32 v1, v1, v197
 v_mfma_f32_16x16x32_bf16 v[226:229], v[154:157], v[190:193], 0
 ds_read_b128 v[154:157], v114 offset:11264
 v_cmp_eq_u32 vcc, -1, v1
 v_mfma_f32_16x16x32_bf16 v[230:233], v[234:237], v[190:193], 0
 ds_read_b128 v[234:237], v114 offset:12288
Lo_226:
 s_cbranch_vccnz Los_227
 v_mfma_f32_16x16x32_bf16 v[214:217], v[238:241], v[194:197], v[214:217]
 ds_read_b128 v[238:241], v114 offset:13312
 v_mfma_f32_16x16x32_bf16 v[218:221], v[242:245], v[194:197], v[218:221]
 ds_read_b128 v[242:245], v114 offset:14336
 s_waitcnt vmcnt(3)
 v_max3_u32 v1, v198, v199, v200
 v_mfma_f32_16x16x32_bf16 v[222:225], v[246:249], v[194:197], v[222:225]
 ds_read_b128 v[246:249], v115 offset:0
 v_max_u32 v1, v1, v201
 s_waitcnt lgkmcnt(6)
 v_mfma_f32_16x16x32_bf16 v[226:229], v[142:145], v[194:197], v[226:229]
 ds_read_b128 v[142:145], v115 offset:1024
 v_cmp_eq_u32 vcc, -1, v1
 v_mfma_f32_16x16x32_bf16 v[230:233], v[146:149], v[194:197], v[230:233]
 ds_read_b128 v[146:149], v115 offset:2048
Lo_228:
 s_cbranch_vccnz Los_229
 s_waitcnt lgkmcnt(6)
 v_mfma_f32_16x16x32_bf16 v[214:217], v[150:153], v[198:201], v[214:217]
 ds_read_b128 v[150:153], v115 offset:3072
 v_mfma_f32_16x16x32_bf16 v[218:221], v[154:157], v[198:201], v[218:221]
 ds_read_b128 v[154:157], v115 offset:4096
 s_waitcnt vmcnt(2)
 v_max3_u32 v1, v202, v203, v204
 s_waitcnt lgkmcnt(6)
 v_mfma_f32_16x16x32_bf16 v[222:225], v[234:237], v[198:201], v[222:225]
 ds_read_b128 v[234:237], v115 offset:5120
 v_max_u32 v1, v1, v205
 v_mfma_f32_16x16x32_bf16 v[226:229], v[238:241], v[198:201], v[226:229]
 ds_read_b128 v[238:241], v115 offset:6144
 v_cmp_eq_u32 vcc, -1, v1
 s_waitcnt lgkmcnt(6)
 v_mfma_f32_16x16x32_bf16 v[230:233], v[242:245], v[198:201], v[230:233]
 ds_read_b128 v[242:245], v115 offset:7168
Lo_230:
 s_cbranch_vccnz Los_231
 v_mfma_f32_16x16x32_bf16 v[214:217], v[246:249], v[202:205], v[214:217]
 ds_read_b128 v[246:249], v115 offset:8192
 s_waitcnt lgkmcnt(6)
 v_mfma_f32_16x16x32_bf16 v[218:221], v[142:145], v[202:205], v[218:221]
 ds_read_b128 v[142:145], v115 offset:9216
 s_waitcnt vmcnt(1)
 v_max3_u32 v1, v206, v207, v208
 v_mfma_f32_16x16x32_bf16 v[222:225], v[146:149], v[202:205], v[222:225]
 ds_read_b128 v[146:149], v115 offset:10240
 v_max_u32 v1, v1, v209
 s_waitcnt lgkmcnt(6)
 v_mfma_f32_16x16x32_bf16 v[226:229], v[150:153], v[202:205], v[226:229]
 ds_read_b128 v[150:153], v115 offset:11264
 v_cmp_eq_u32 vcc, -1, v1
 v_mfma_f32_16x16x32_bf16 v[230:233], v[154:157], v[202:205], v[230:233]
 ds_read_b128 v[154:157], v115 offset:12288
Lo_232:
 s_cbranch_vccnz Los_233
 s_waitcnt lgkmcnt(6)
 v_mfma_f32_16x16x32_bf16 v[214:217], v[234:237], v[206:209], v[214:217]
 ds_read_b128 v[234:237], v115 offset:13312
 v_mfma_f32_16x16x32_bf16 v[218:221], v[238:241], v[206:209], v[218:221]
 ds_read_b128 v[238:241], v115 offset:14336
 s_waitcnt vmcnt(0)
 v_max3_u32 v1, v210, v211, v212
 s_waitcnt lgkmcnt(6)
 v_mfma_f32_16x16x32_bf16 v[222:225], v[242:245], v[206:209], v[222:225]
 v_max_u32 v1, v1, v213
 v_mfma_f32_16x16x32_bf16 v[226:229], v[246:249], v[206:209], v[226:229]
 v_cmp_eq_u32 vcc, -1, v1
 s_waitcnt lgkmcnt(4)
 v_mfma_f32_16x16x32_bf16 v[230:233], v[142:145], v[206:209], v[230:233]
Lo_234:
 s_cbranch_vccnz Los_235
 v_mfma_f32_16x16x32_bf16 v[214:217], v[146:149], v[210:213], v[214:217]
 buffer_load_dwordx4 v[130:133], v2, s[4:7], s66 offen sc1
 s_waitcnt lgkmcnt(2)
 v_mfma_f32_16x16x32_bf16 v[218:221], v[150:153], v[210:213], v[218:221]
 buffer_load_dwordx4 v[134:137], v2, s[4:7], s66 offen offset:2048 sc1
 v_mfma_f32_16x16x32_bf16 v[222:225], v[154:157], v[210:213], v[222:225]
 s_add_u32 s25, s66, 4096
 buffer_load_dwordx4 v[138:141], v2, s[4:7], s25 offen sc1
 s_waitcnt lgkmcnt(0)
 v_mfma_f32_16x16x32_bf16 v[226:229], v[234:237], v[210:213], v[226:229]
 v_mfma_f32_16x16x32_bf16 v[230:233], v[238:241], v[210:213], v[230:233]
 v_cvt_pk_bf16_f32 v190, v214, v215
 v_cvt_pk_bf16_f32 v191, v216, v217
 v_cvt_pk_bf16_f32 v192, v218, v219
 v_cvt_pk_bf16_f32 v193, v220, v221
 ds_write_b128 v118, v[190:193]
 v_cvt_pk_bf16_f32 v194, v222, v223
 v_cvt_pk_bf16_f32 v195, v224, v225
 v_cvt_pk_bf16_f32 v196, v226, v227
 v_cvt_pk_bf16_f32 v197, v228, v229
 ds_write_b128 v118, v[194:197] offset:4096
 v_cvt_pk_bf16_f32 v198, v230, v231
 v_cvt_pk_bf16_f32 v199, v232, v233
 ds_write_b64 v119, v[198:199] offset:8192
 s_add_u32 s25, s62, s46
 s_add_u32 s26, s25, 8192
 s_add_u32 s27, s25, 655360
 s_add_u32 s28, s26, 655360
 s_waitcnt lgkmcnt(0)
 s_barrier
 s_add_u32 s70, s69, s52
 s_add_u32 s27, s62, s47
 s_add_u32 s28, s62, s48
 s_add_u32 s69, s31, 1
 s_and_b32 s25, s69, 3
 s_mul_i32 s26, s25, 20480
 s_add_u32 s56, s26, s42
 s_add_u32 s57, s56, 4096
 s_add_u32 s58, s26, s43
 s_mul_i32 s62, s25, 163840
 s_xor_b32 s26, s25, 2
 s_mul_i32 s63, s26, 163840
 s_add_u32 s25, s25, 3
 s_and_b32 s25, s25, 3
 s_mul_i32 s26, s25, 20480
 s_add_u32 s59, s26, s43
 s_and_b32 s25, s69, 1
 s_mul_i32 s60, s25, 196608
 s_xor_b32 s25, s25, 1
 s_mul_i32 s61, s25, 196608
 s_mul_i32 s69, s69, 196608
 s_cmp_eq_u32 s40, 0
 s_cbranch_scc1 Lnr_236
 s_sleep 11
 s_mov_b32 s41, 0
 buffer_load_dwordx4 v[190:193], v2, s[4:7], s27 offen offset:0 sc1
 buffer_load_dwordx4 v[194:197], v2, s[4:7], s27 offen offset:1024 sc1
 buffer_load_dwordx4 v[198:201], v2, s[4:7], s28 offen offset:0 sc1
 buffer_load_dwordx4 v[202:205], v2, s[4:7], s28 offen offset:1024 sc1
 s_waitcnt vmcnt(2)
Lj_237:
 v_mfma_f32_16x16x32_bf16 v[210:213], v[170:173], v[190:193], 0
 v_max3_u32 v214, v190, v191, v192
 v_max3_u32 v215, v193, v194, v195
 v_mfma_f32_16x16x32_bf16 v[210:213], v[174:177], v[194:197], v[210:213]
 v_max3_u32 v214, v214, v196, v197
 v_max_u32 v214, v214, v215
 v_cmp_eq_u32 vcc, -1, v214
 s_cbranch_vccnz Ljs_238
Ly_240:
 s_waitcnt vmcnt(0)
 v_mfma_f32_16x16x32_bf16 v[206:209], v[170:173], v[198:201], v[210:213]
 v_max3_u32 v214, v198, v199, v200
 v_max3_u32 v215, v201, v202, v203
 v_mfma_f32_16x16x32_bf16 v[206:209], v[174:177], v[202:205], v[206:209]
 v_max3_u32 v214, v214, v204, v205
 v_max_u32 v214, v214, v215
 v_cmp_eq_u32 vcc, -1, v214
 s_cbranch_vccz Lyd_239
 buffer_load_dwordx4 v[198:201], v2, s[4:7], s28 offen offset:0 sc1
 buffer_load_dwordx4 v[202:205], v2, s[4:7], s28 offen offset:1024 sc1
 s_add_u32 s41, s41, 1
 s_cmp_gt_u32 s41, 200000
 s_cbranch_scc1 L_fail
 s_branch Ly_240
Lyd_239:
 s_nop 3
 v_cvt_pk_bf16_f32 v214, v206, v207
 v_cvt_pk_bf16_f32 v215, v208, v209
 s_cmp_eq_u32 s31, 8
 s_cbranch_scc1 Lov_241
Lnov_242:
 buffer_store_dwordx2 v[214:215], v121, s[4:7], s58 offen sc1
 buffer_store_dwordx2 v[182:183], v121, s[4:7], s59 offen sc1
Lnr_236:
 s_add_u32 s31, s31, 1
 s_barrier
 s_branch L_rec_top_1r
Lfin_220:
 s_waitcnt lgkmcnt(0)
 s_nop 4
 v_cvt_pk_bf16_f32 v178, v226, v227
 v_cvt_pk_bf16_f32 v179, v228, v229
 v_add_f32 v230, v230, v206
 v_add_f32 v231, v231, v207
 v_add_f32 v232, v232, v208
 v_add_f32 v233, v233, v209
 v_cvt_pk_bf16_f32 v180, v230, v231
 v_cvt_pk_bf16_f32 v181, v232, v233
 ds_write_b64 v117, v[178:179] offset:512
 ds_write_b64 v117, v[180:181] offset:2560
 s_waitcnt lgkmcnt(0)
 s_barrier
 s_endpgm
Lzs_209:
 buffer_load_dwordx4 v[190:193], v2, s[4:7], s56 offen offset:0 sc1
 buffer_load_dwordx4 v[194:197], v2, s[4:7], s56 offen offset:1024 sc1
 buffer_load_dwordx4 v[198:201], v2, s[4:7], s56 offen offset:2048 sc1
 buffer_load_dwordx4 v[202:205], v2, s[4:7], s56 offen offset:3072 sc1
 buffer_load_dwordx4 v[206:209], v2, s[4:7], s57 offen offset:0 sc1
 s_add_u32 s41, s41, 1
 s_cmp_gt_u32 s41, 200000
 s_cbranch_scc1 L_fail
 s_branch Lz_208
Lzs_211:
 buffer_load_dwordx4 v[194:197], v2, s[4:7], s56 offen offset:1024 sc1
 buffer_load_dwordx4 v[198:201], v2, s[4:7], s56 offen offset:2048 sc1
 buffer_load_dwordx4 v[202:205], v2, s[4:7], s56 offen offset:3072 sc1
 buffer_load_dwordx4 v[206:209], v2, s[4:7], s57 offen offset:0 sc1
 s_add_u32 s41, s41, 1
 s_cmp_gt_u32 s41, 200000
 s_cbranch_scc1 L_fail
 s_branch Lz_210
Lzs_213:
 buffer_load_dwordx4 v[198:201], v2, s[4:7], s56 offen offset:2048 sc1
 buffer_load_dwordx4 v[202:205], v2, s[4:7], s56 offen offset:3072 sc1
 buffer_load_dwordx4 v[206:209], v2, s[4:7], s57 offen offset:0 sc1
 s_add_u32 s41, s41, 1
 s_cmp_gt_u32 s41, 200000
 s_cbranch_scc1 L_fail
 s_branch Lz_212
Lzs_215:
 buffer_load_dwordx4 v[202:205], v2, s[4:7], s56 offen offset:3072 sc1
 buffer_load_dwordx4 v[206:209], v2, s[4:7], s57 offen offset:0 sc1
 s_add_u32 s41, s41, 1
 s_cmp_gt_u32 s41, 200000
 s_cbranch_scc1 L_fail
 s_branch Lz_214
Lzs_217:
 buffer_load_dwordx4 v[206:209], v2, s[4:7], s57 offen offset:0 sc1
 s_add_u32 s41, s41, 1
 s_cmp_gt_u32 s41, 200000
 s_cbranch_scc1 L_fail
 s_branch Lz_216
Lfs_222:
 v_max3_u32 v222, v194, v195, v196
 v_max3_u32 v222, v222, v197, v198
 v_max3_u32 v222, v222, v199, v200
 v_max3_u32 v222, v222, v201, v202
 v_max3_u32 v222, v222, v203, v204
 v_max_u32 v222, v222, v205
 v_cmp_eq_u32 vcc, -1, v222
 s_cbranch_vccz Lfok_223
 buffer_load_dwordx4 v[194:197], v2, s[4:7], s27 offen offset:0 sc1
 buffer_load_dwordx4 v[198:201], v2, s[4:7], s27 offen offset:1024 sc1
 buffer_load_dwordx4 v[202:205], v2, s[4:7], s27 offen offset:2048 sc1
 s_add_u32 s41, s41, 1
 s_cmp_gt_u32 s41, 200000
 s_cbranch_scc1 L_fail
 s_branch Lf_221
Los_225:
 buffer_load_dwordx4 v[190:193], v2, s[4:7], s27 offen offset:0 sc1
 buffer_load_dwordx4 v[194:197], v2, s[4:7], s27 offen offset:1024 sc1
 buffer_load_dwordx4 v[198:201], v2, s[4:7], s27 offen offset:2048 sc1
 buffer_load_dwordx4 v[202:205], v2, s[4:7], s27 offen offset:3072 sc1
 buffer_load_dwordx4 v[206:209], v2, s[4:7], s28 offen offset:0 sc1
 buffer_load_dwordx4 v[210:213], v2, s[4:7], s28 offen offset:1024 sc1
 s_add_u32 s41, s41, 1
 s_cmp_gt_u32 s41, 200000
 s_cbranch_scc1 L_fail
 s_branch Lo_224
Los_227:
 buffer_load_dwordx4 v[194:197], v2, s[4:7], s27 offen offset:1024 sc1
 buffer_load_dwordx4 v[198:201], v2, s[4:7], s27 offen offset:2048 sc1
 buffer_load_dwordx4 v[202:205], v2, s[4:7], s27 offen offset:3072 sc1
 buffer_load_dwordx4 v[206:209], v2, s[4:7], s28 offen offset:0 sc1
 buffer_load_dwordx4 v[210:213], v2, s[4:7], s28 offen offset:1024 sc1
 s_waitcnt vmcnt(4)
 v_max3_u32 v1, v194, v195, v196
 v_max_u32 v1, v1, v197
 v_cmp_eq_u32 vcc, -1, v1
 s_add_u32 s41, s41, 1
 s_cmp_gt_u32 s41, 200000
 s_cbranch_scc1 L_fail
 s_branch Lo_226
Los_229:
 buffer_load_dwordx4 v[198:201], v2, s[4:7], s27 offen offset:2048 sc1
 buffer_load_dwordx4 v[202:205], v2, s[4:7], s27 offen offset:3072 sc1
 buffer_load_dwordx4 v[206:209], v2, s[4:7], s28 offen offset:0 sc1
 buffer_load_dwordx4 v[210:213], v2, s[4:7], s28 offen offset:1024 sc1
 s_waitcnt vmcnt(3)
 v_max3_u32 v1, v198, v199, v200
 v_max_u32 v1, v1, v201
 v_cmp_eq_u32 vcc, -1, v1
 s_add_u32 s41, s41, 1
 s_cmp_gt_u32 s41, 200000
 s_cbranch_scc1 L_fail
 s_branch Lo_228
Los_231:
 buffer_load_dwordx4 v[202:205], v2, s[4:7], s27 offen offset:3072 sc1
 buffer_load_dwordx4 v[206:209], v2, s[4:7], s28 offen offset:0 sc1
 buffer_load_dwordx4 v[210:213], v2, s[4:7], s28 offen offset:1024 sc1
 s_waitcnt vmcnt(2)
 v_max3_u32 v1, v202, v203, v204
 v_max_u32 v1, v1, v205
 v_cmp_eq_u32 vcc, -1, v1
 s_add_u32 s41, s41, 1
 s_cmp_gt_u32 s41, 200000
 s_cbranch_scc1 L_fail
 s_branch Lo_230
Los_233:
 buffer_load_dwordx4 v[206:209], v2, s[4:7], s28 offen offset:0 sc1
 buffer_load_dwordx4 v[210:213], v2, s[4:7], s28 offen offset:1024 sc1
 s_waitcnt vmcnt(1)
 v_max3_u32 v1, v206, v207, v208
 v_max_u32 v1, v1, v209
 v_cmp_eq_u32 vcc, -1, v1
 s_add_u32 s41, s41, 1
 s_cmp_gt_u32 s41, 200000
 s_cbranch_scc1 L_fail
 s_branch Lo_232
Los_235:
 buffer_load_dwordx4 v[210:213], v2, s[4:7], s28 offen offset:1024 sc1
 s_waitcnt vmcnt(0)
 v_max3_u32 v1, v210, v211, v212
 v_max_u32 v1, v1, v213
 v_cmp_eq_u32 vcc, -1, v1
 s_add_u32 s41, s41, 1
 s_cmp_gt_u32 s41, 200000
 s_cbranch_scc1 L_fail
 s_branch Lo_234
Ljs_238:
 buffer_load_dwordx4 v[190:193], v2, s[4:7], s27 offen offset:0 sc1
 buffer_load_dwordx4 v[194:197], v2, s[4:7], s27 offen offset:1024 sc1
 s_waitcnt vmcnt(0)
 s_add_u32 s41, s41, 1
 s_cmp_gt_u32 s41, 200000
 s_cbranch_scc1 L_fail
 s_branch Lj_237
Lov_241:
 s_mov_b32 exec_lo, 0xff00ff00
 s_mov_b32 exec_hi, 0xff00ff00
 v_mov_b32 v214, v128
 v_mov_b32 v215, v129
 s_mov_b64 exec, -1
 s_add_u32 s41, s41, 1
 s_cmp_gt_u32 s41, 200000
 s_cbranch_scc1 L_fail
 s_branch Lnov_242
Lpwn_206:
 s_cmp_eq_u32 s3, 2
 s_cbranch_scc0 Lpwn_243
 s_waitcnt vmcnt(0)
 s_barrier
L_rec_top_2r:
 s_mov_b32 s41, 0
 s_sleep 2
 buffer_load_dwordx4 v[190:193], v2, s[4:7], s56 offen offset:0 sc1
 s_nop 11
 buffer_load_dwordx4 v[194:197], v2, s[4:7], s56 offen offset:1024 sc1
 s_nop 11
 buffer_load_dwordx4 v[198:201], v2, s[4:7], s56 offen offset:2048 sc1
 s_nop 11
 buffer_load_dwordx4 v[202:205], v2, s[4:7], s56 offen offset:3072 sc1
 s_nop 11
 buffer_load_dwordx4 v[206:209], v2, s[4:7], s57 offen offset:0 sc1
Lz_244:
 s_waitcnt vmcnt(4)
 ds_write_b128 v108, v[190:193] offset:0
 v_mfma_f32_16x16x32_bf16 v[226:229], a[0:3], v[190:193], 0
 v_max3_u32 v1, v190, v191, v192
 v_max_u32 v1, v1, v193
 v_mfma_f32_16x16x32_bf16 v[230:233], a[80:83], v[190:193], 0
 v_cmp_eq_u32 vcc, -1, v1
 v_mfma_f32_16x16x32_bf16 v[234:237], a[160:163], v[190:193], 0
 s_cbranch_vccnz Lzs_245
Lz_246:
 s_waitcnt vmcnt(3)
 ds_write_b128 v108, v[194:197] offset:1024
 v_max3_u32 v1, v194, v195, v196
 v_max_u32 v1, v1, v197
 v_cmp_eq_u32 vcc, -1, v1
 s_cbranch_vccnz Lzs_247
 v_mfma_f32_16x16x32_bf16 v[226:229], a[4:7], v[194:197], v[226:229]
 v_mfma_f32_16x16x32_bf16 v[230:233], a[84:87], v[194:197], v[230:233]
 v_mfma_f32_16x16x32_bf16 v[234:237], a[164:167], v[194:197], v[234:237]
Lz_248:
 s_waitcnt vmcnt(2)
 ds_write_b128 v108, v[198:201] offset:2048
 v_max3_u32 v1, v198, v199, v200
 v_max_u32 v1, v1, v201
 v_cmp_eq_u32 vcc, -1, v1
 s_cbranch_vccnz Lzs_249
 v_mfma_f32_16x16x32_bf16 v[226:229], a[8:11], v[198:201], v[226:229]
 v_mfma_f32_16x16x32_bf16 v[230:233], a[88:91], v[198:201], v[230:233]
 v_mfma_f32_16x16x32_bf16 v[234:237], a[168:171], v[198:201], v[234:237]
Lz_250:
 s_waitcnt vmcnt(1)
 ds_write_b128 v108, v[202:205] offset:3072
 v_max3_u32 v1, v202, v203, v204
 v_max_u32 v1, v1, v205
 v_cmp_eq_u32 vcc, -1, v1
 s_cbranch_vccnz Lzs_251
Lz_252:
 s_waitcnt vmcnt(0)
 ds_write_b128 v108, v[206:209] offset:4096
 v_max3_u32 v1, v206, v207, v208
 v_max_u32 v1, v1, v209
 v_cmp_eq_u32 vcc, -1, v1
 s_cbranch_vccnz Lzs_253
 s_waitcnt lgkmcnt(0)
 s_barrier
 ds_read_b128 v[214:217], v109 offset:0
 ds_read_b128 v[218:221], v109 offset:1024
 ds_read_b128 v[222:225], v109 offset:2048
 v_mfma_f32_16x16x32_bf16 v[226:229], a[12:15], v[202:205], v[226:229]
 buffer_load_dword v126, v124, s[4:7], 0 offen sc1
 v_mfma_f32_16x16x32_bf16 v[230:233], a[92:95], v[202:205], v[230:233]
 v_mfma_f32_16x16x32_bf16 v[234:237], a[172:175], v[202:205], v[234:237]
 v_mfma_f32_16x16x32_bf16 v[226:229], a[16:19], v[206:209], v[226:229]
 s_add_u32 s25, s67, s50
 v_mfma_f32_16x16x32_bf16 v[230:233], a[96:99], v[206:209], v[230:233]
 buffer_load_dwordx4 v[142:145], v2, s[4:7], s25 offen sc1
 v_mfma_f32_16x16x32_bf16 v[234:237], a[176:179], v[206:209], v[234:237]
 ds_read_b128 v[210:213], v109 offset:3072
 s_waitcnt lgkmcnt(3)
 v_mfma_f32_16x16x32_bf16 v[226:229], a[20:23], v[214:217], v[226:229]
 s_add_u32 s25, s68, s50
 v_mfma_f32_16x16x32_bf16 v[230:233], a[100:103], v[214:217], v[230:233]
 buffer_load_dwordx4 v[150:153], v2, s[4:7], s25 offen sc1
 v_mfma_f32_16x16x32_bf16 v[234:237], a[180:183], v[214:217], v[234:237]
 ds_read_b128 v[214:217], v109 offset:4096
 s_waitcnt lgkmcnt(3)
 v_mfma_f32_16x16x32_bf16 v[226:229], a[24:27], v[218:221], v[226:229]
 s_add_u32 s25, s46, s63
 v_mfma_f32_16x16x32_bf16 v[230:233], a[104:107], v[218:221], v[230:233]
 s_add_u32 s25, s25, 0
 v_mfma_f32_16x16x32_bf16 v[234:237], a[184:187], v[218:221], v[234:237]
 buffer_store_dwordx4 v[182:185], v120, s[4:7], s25 offen sc1
 ds_read_b128 v[218:221], v110 offset:0
 s_waitcnt lgkmcnt(3)
 v_mfma_f32_16x16x32_bf16 v[226:229], a[28:31], v[222:225], v[226:229]
 s_add_u32 s25, s25, 8192
 s_mov_b32 exec_lo, 0xffff
 v_mfma_f32_16x16x32_bf16 v[230:233], a[108:111], v[222:225], v[230:233]
 s_mov_b32 exec_hi, 0xffff
 buffer_store_dwordx4 v[182:185], v120, s[4:7], s25 offen sc1
 v_mfma_f32_16x16x32_bf16 v[234:237], a[188:191], v[222:225], v[234:237]
 s_mov_b64 exec, -1
 ds_read_b128 v[222:225], v110 offset:1024
 s_waitcnt lgkmcnt(3)
 v_mfma_f32_16x16x32_bf16 v[226:229], a[32:35], v[210:213], v[226:229]
 s_add_u32 s25, s46, s63
 v_mfma_f32_16x16x32_bf16 v[230:233], a[112:115], v[210:213], v[230:233]
 s_add_u32 s25, s25, 655360
 v_mfma_f32_16x16x32_bf16 v[234:237], a[192:195], v[210:213], v[234:237]
 buffer_store_dwordx4 v[182:185], v120, s[4:7], s25 offen sc1
 ds_read_b128 v[210:213], v110 offset:2048
 s_waitcnt lgkmcnt(3)
 v_mfma_f32_16x16x32_bf16 v[226:229], a[36:39], v[214:217], v[226:229]
 s_add_u32 s25, s25, 8192
 s_mov_b32 exec_lo, 0xffff
 v_mfma_f32_16x16x32_bf16 v[230:233], a[116:119], v[214:217], v[230:233]
 s_mov_b32 exec_hi, 0xffff
 buffer_store_dwordx4 v[182:185], v120, s[4:7], s25 offen sc1
 v_mfma_f32_16x16x32_bf16 v[234:237], a[196:199], v[214:217], v[234:237]
 s_mov_b64 exec, -1
 ds_read_b128 v[214:217], v110 offset:3072
 s_waitcnt lgkmcnt(3)
 v_mfma_f32_16x16x32_bf16 v[226:229], a[40:43], v[218:221], v[226:229]
 s_add_u32 s25, s31, 1
 s_mul_i32 s67, s25, 393216
 v_mfma_f32_16x16x32_bf16 v[230:233], a[120:123], v[218:221], v[230:233]
 s_add_u32 s67, s67, 84312064
 s_cmp_lt_u32 s25, 64
 v_mfma_f32_16x16x32_bf16 v[234:237], a[200:203], v[218:221], v[234:237]
 s_cselect_b32 s67, s67, 2146435072
 ds_read_b128 v[218:221], v110 offset:4096
 s_waitcnt lgkmcnt(3)
 v_mfma_f32_16x16x32_bf16 v[226:229], a[44:47], v[222:225], v[226:229]
 s_sub_u32 s26, s25, 9
 s_mul_i32 s68, s26, 393216
 v_mfma_f32_16x16x32_bf16 v[230:233], a[124:127], v[222:225], v[230:233]
 s_add_u32 s68, s68, 134643712
 s_cmp_lt_u32 s26, 64
 v_mfma_f32_16x16x32_bf16 v[234:237], a[204:207], v[222:225], v[234:237]
 s_cselect_b32 s68, s68, 2146435072
 ds_read_b128 v[222:225], v111 offset:0
 s_waitcnt lgkmcnt(3)
 v_mfma_f32_16x16x32_bf16 v[226:229], a[48:51], v[210:213], v[226:229]
 s_add_u32 s25, s67, 4269801472
 s_add_u32 s26, s68, 4269801472
 v_mfma_f32_16x16x32_bf16 v[230:233], a[128:131], v[210:213], v[230:233]
 s_cmp_lt_u32 s3, 2
 s_cselect_b32 s66, s25, s26
 v_mfma_f32_16x16x32_bf16 v[234:237], a[208:211], v[210:213], v[234:237]
 s_add_u32 s66, s66, s49
 ds_read_b128 v[210:213], v111 offset:1024
 s_waitcnt lgkmcnt(3)
 v_mfma_f32_16x16x32_bf16 v[226:229], a[52:55], v[214:217], v[226:229]
 v_mfma_f32_16x16x32_bf16 v[230:233], a[132:135], v[214:217], v[230:233]
 v_mfma_f32_16x16x32_bf16 v[234:237], a[212:215], v[214:217], v[234:237]
 ds_read_b128 v[214:217], v111 offset:2048
 s_waitcnt lgkmcnt(3)
 v_mfma_f32_16x16x32_bf16 v[226:229], a[56:59], v[218:221], v[226:229]
 v_mfma_f32_16x16x32_bf16 v[230:233], a[136:139], v[218:221], v[230:233]
 v_mfma_f32_16x16x32_bf16 v[234:237], a[216:219], v[218:221], v[234:237]
 ds_read_b128 v[218:221], v111 offset:3072
 s_waitcnt lgkmcnt(3)
 v_mfma_f32_16x16x32_bf16 v[226:229], a[60:63], v[222:225], v[226:229]
 v_mfma_f32_16x16x32_bf16 v[230:233], a[140:143], v[222:225], v[230:233]
 v_mfma_f32_16x16x32_bf16 v[234:237], a[220:223], v[222:225], v[234:237]
 ds_read_b128 v[222:225], v111 offset:4096
 s_waitcnt lgkmcnt(3)
 v_mfma_f32_16x16x32_bf16 v[226:229], a[64:67], v[210:213], v[226:229]
 v_mfma_f32_16x16x32_bf16 v[230:233], a[144:147], v[210:213], v[230:233]
 v_mfma_f32_16x16x32_bf16 v[234:237], a[224:227], v[210:213], v[234:237]
 s_waitcnt lgkmcnt(2)
 v_mfma_f32_16x16x32_bf16 v[226:229], a[68:71], v[214:217], v[226:229]
 v_mfma_f32_16x16x32_bf16 v[230:233], a[148:151], v[214:217], v[230:233]
 v_mfma_f32_16x16x32_bf16 v[234:237], a[228:231], v[214:217], v[234:237]
 s_waitcnt lgkmcnt(1)
 v_mfma_f32_16x16x32_bf16 v[226:229], a[72:75], v[218:221], v[226:229]
 v_mfma_f32_16x16x32_bf16 v[230:233], a[152:155], v[218:221], v[230:233]
 v_mfma_f32_16x16x32_bf16 v[234:237], a[232:235], v[218:221], v[234:237]
 s_waitcnt lgkmcnt(0)
 v_mfma_f32_16x16x32_bf16 v[226:229], a[76:79], v[222:225], v[226:229]
 v_mfma_f32_16x16x32_bf16 v[230:233], a[156:159], v[222:225], v[230:233]
 v_mfma_f32_16x16x32_bf16 v[234:237], a[236:239], v[222:225], v[234:237]
 s_nop 1
 v_cvt_pk_bf16_f32 v190, v226, v227
 v_cvt_pk_bf16_f32 v191, v228, v229
 ds_write_b64 v112, v[190:191] offset:0
 v_cvt_pk_bf16_f32 v192, v230, v231
 v_cvt_pk_bf16_f32 v193, v232, v233
 ds_write_b64 v113, v[192:193] offset:0
 v_cvt_pk_bf16_f32 v194, v234, v235
 v_cvt_pk_bf16_f32 v195, v236, v237
 ds_write_b64 v112, v[194:195] offset:1024
 s_add_u32 s26, s60, s44
 s_add_u32 s27, s60, s45
 s_waitcnt lgkmcnt(0)
 s_barrier
 ds_read_b128 v[198:201], v3 offset:20480
 ds_read_b128 v[202:205], v3 offset:21504
 ds_read_b128 v[206:209], v3 offset:22528
 ds_read_b128 v[226:229], v3 offset:23552
 ds_read_b128 v[230:233], v3 offset:24576
 ds_read_b128 v[234:237], v3 offset:25600
 ds_read_b128 v[210:213], v108 offset:0
 ds_read_b128 v[214:217], v108 offset:1024
 ds_read_b128 v[218:221], v108 offset:2048
 s_waitcnt lgkmcnt(8)
 v_mfma_f32_16x16x32_bf16 v[194:197], v[130:133], v[198:201], 0
 s_waitcnt lgkmcnt(7)
 v_mfma_f32_16x16x32_bf16 v[194:197], v[134:137], v[202:205], v[194:197]
 s_waitcnt lgkmcnt(6)
 v_mfma_f32_16x16x32_bf16 v[194:197], v[138:141], v[206:209], v[194:197]
 s_waitcnt lgkmcnt(5)
 v_mfma_f32_16x16x32_bf16 v[190:193], v[226:229], v[198:201], v[158:161]
 s_waitcnt lgkmcnt(4)
 v_mfma_f32_16x16x32_bf16 v[190:193], v[230:233], v[202:205], v[190:193]
 s_mov_b32 exec_lo, 0xff00ff00
 s_mov_b32 exec_hi, 0xff00ff00
 s_waitcnt lgkmcnt(3)
 v_mfma_f32_16x16x32_bf16 v[190:193], v[234:237], v[206:209], v[190:193]
 buffer_store_dwordx4 v[194:197], v2, s[4:7], s26 offen offset:0 sc1
 ds_write_b128 v116, v[194:197] offset:26624
 s_mov_b64 exec, -1
 ds_read_b128 v[222:225], v108 offset:3072
 s_waitcnt lgkmcnt(4)
 v_mfma_f32_16x16x32_bf16 v[226:229], v[210:213], a[240:243], 0
 v_mfma_f32_16x16x32_bf16 v[230:233], v[210:213], v[68:71], 0
 ds_read_b128 v[210:213], v108 offset:4096
 s_waitcnt lgkmcnt(4)
 v_mfma_f32_16x16x32_bf16 v[226:229], v[214:217], a[244:247], v[226:229]
 v_mfma_f32_16x16x32_bf16 v[230:233], v[214:217], v[72:75], v[230:233]
 ds_read_b128 v[214:217], v109 offset:0
 s_waitcnt lgkmcnt(4)
 v_mfma_f32_16x16x32_bf16 v[226:229], v[218:221], a[248:251], v[226:229]
 v_mfma_f32_16x16x32_bf16 v[230:233], v[218:221], v[76:79], v[230:233]
 ds_read_b128 v[218:221], v109 offset:1024
 s_waitcnt lgkmcnt(3)
 v_mfma_f32_16x16x32_bf16 v[226:229], v[222:225], a[252:255], v[226:229]
 v_mfma_f32_16x16x32_bf16 v[230:233], v[222:225], v[80:83], v[230:233]
 s_waitcnt vmcnt(7)
 s_mov_b32 s41, 0
 v_min_i32 v1, 64, v125
 v_cmp_ge_i32 vcc, v126, v1
 s_nop 0
 s_cmp_eq_u64 vcc, -1
 s_cbranch_scc1 Lflok_255
Lfl_254:
 s_add_u32 s41, s41, 1
 s_cmp_gt_u32 s41, 200000
 s_cbranch_scc1 L_fail
 buffer_load_dword v126, v124, s[4:7], 0 offen sc1
 s_waitcnt vmcnt(0)
 v_cmp_ge_i32 vcc, v126, v1
 s_nop 0
 s_cmp_eq_u64 vcc, -1
 s_cbranch_scc0 Lfl_254
Lflok_255:
 v_add_u32 v125, 1, v125
 ds_read_b128 v[222:225], v109 offset:2048
 s_waitcnt lgkmcnt(3)
 v_mfma_f32_16x16x32_bf16 v[226:229], v[210:213], v[4:7], v[226:229]
 v_mfma_f32_16x16x32_bf16 v[230:233], v[210:213], v[84:87], v[230:233]
 s_barrier
 ds_read_b128 v[234:237], v3 offset:26624
 ds_read_b128 v[238:241], v3 offset:27648
 ds_read_b128 v[210:213], v109 offset:3072
 s_waitcnt lgkmcnt(5)
 v_mfma_f32_16x16x32_bf16 v[226:229], v[214:217], v[8:11], v[226:229]
 v_mfma_f32_16x16x32_bf16 v[230:233], v[214:217], v[88:91], v[230:233]
 ds_read_b128 v[214:217], v109 offset:4096
 s_waitcnt lgkmcnt(5)
 v_mfma_f32_16x16x32_bf16 v[226:229], v[218:221], v[12:15], v[226:229]
 v_mfma_f32_16x16x32_bf16 v[230:233], v[218:221], v[92:95], v[230:233]
 ds_read_b128 v[218:221], v110 offset:0
 s_waitcnt lgkmcnt(5)
 v_mfma_f32_16x16x32_bf16 v[226:229], v[222:225], v[16:19], v[226:229]
 v_mfma_f32_16x16x32_bf16 v[230:233], v[222:225], v[96:99], v[230:233]
 ds_read_b128 v[222:225], v110 offset:1024
 s_waitcnt lgkmcnt(3)
 v_mfma_f32_16x16x32_bf16 v[226:229], v[210:213], v[20:23], v[226:229]
 v_mfma_f32_16x16x32_bf16 v[230:233], v[210:213], v[100:103], v[230:233]
 buffer_load_dwordx4 v[194:197], v2, s[4:7], s27 offen offset:0 sc1
 ds_read_b128 v[210:213], v110 offset:2048
 s_waitcnt lgkmcnt(3)
 v_mfma_f32_16x16x32_bf16 v[226:229], v[214:217], v[24:27], v[226:229]
 v_mfma_f32_16x16x32_bf16 v[230:233], v[214:217], v[104:107], v[230:233]
 ds_read_b128 v[214:217], v110 offset:3072
 s_waitcnt lgkmcnt(3)
 v_mfma_f32_16x16x32_bf16 v[226:229], v[218:221], v[28:31], v[226:229]
 ds_read_b128 v[218:221], v110 offset:4096
 s_waitcnt lgkmcnt(3)
 v_mfma_f32_16x16x32_bf16 v[226:229], v[222:225], v[32:35], v[226:229]
 buffer_load_dwordx4 v[198:201], v2, s[4:7], s27 offen offset:1024 sc1
 ds_read_b128 v[222:225], v111 offset:0
 s_waitcnt lgkmcnt(3)
 v_mfma_f32_16x16x32_bf16 v[226:229], v[210:213], v[36:39], v[226:229]
 ds_write_b128 v116, v[230:233] offset:28672
 ds_read_b128 v[210:213], v111 offset:1024
 s_waitcnt lgkmcnt(4)
 v_mfma_f32_16x16x32_bf16 v[226:229], v[214:217], v[40:43], v[226:229]
 ds_read_b128 v[214:217], v111 offset:2048
 s_waitcnt lgkmcnt(4)
 v_mfma_f32_16x16x32_bf16 v[226:229], v[218:221], v[44:47], v[226:229]
 buffer_load_dwordx4 v[202:205], v2, s[4:7], s27 offen offset:2048 sc1
 ds_read_b128 v[218:221], v111 offset:3072
 s_waitcnt lgkmcnt(4)
 v_mfma_f32_16x16x32_bf16 v[226:229], v[222:225], v[48:51], v[226:229]
 ds_read_b128 v[222:225], v111 offset:4096
 s_waitcnt lgkmcnt(3)
 v_mfma_f32_16x16x32_bf16 v[226:229], v[210:213], v[52:55], v[226:229]
 s_waitcnt lgkmcnt(2)
 v_mfma_f32_16x16x32_bf16 v[226:229], v[214:217], v[56:59], v[226:229]
 s_barrier
 s_waitcnt lgkmcnt(1)
 v_mfma_f32_16x16x32_bf16 v[226:229], v[218:221], v[60:63], v[226:229]
 s_waitcnt lgkmcnt(0)
 v_mfma_f32_16x16x32_bf16 v[226:229], v[222:225], v[64:67], v[226:229]
 s_cmp_eq_u32 s31, 72
 s_cbranch_scc1 Lfin_256
 s_mov_b32 s41, 0
Lf_257:
 s_waitcnt vmcnt(2)
 v_add_f32 v210, v234, v194
 v_add_f32 v211, v235, v195
 v_add_f32 v212, v236, v196
 v_add_f32 v213, v237, v197
 s_waitcnt vmcnt(1)
 v_add_f32 v214, v238, v198
 v_add_f32 v215, v239, v199
 v_add_f32 v216, v240, v200
 v_add_f32 v217, v241, v201
 v_maximum3_f32 v1, v210, v211, v212
 v_maximum3_f32 v127, v213, v214, v215
 v_maximum3_f32 v1, v1, v216, v217
 s_waitcnt vmcnt(0)
 v_add_f32 v218, v190, v202
 v_add_f32 v219, v191, v203
 v_add_f32 v220, v192, v204
 v_add_f32 v221, v193, v205
 v_maximum3_f32 v127, v127, v218, v219
 v_maximum3_f32 v1, v1, v220, v221
 v_maximum3_f32 v1, v1, v127, v127
 v_cmp_u_f32 vcc, v1, v1
 v_mov_b32 v127, v1
 s_cbranch_vccnz Lfs_258
Lfok_259:
 s_nop 0
 v_permlane32_swap_b32 v1, v127
 v_max_f32 v1, v1, v127
 v_mov_b32 v127, v1
 v_cvt_pk_bf16_f32 v178, v226, v227
 v_cvt_pk_bf16_f32 v179, v228, v229
 v_permlane16_swap_b32 v1, v127
 v_max_f32 v1, v1, v127
 v_mul_f32 v1, s71, v1
 v_fma_f32 v210, v210, s71, -v1
 v_fma_f32 v211, v211, s71, -v1
 v_fma_f32 v212, v212, s71, -v1
 v_fma_f32 v213, v213, s71, -v1
 v_fma_f32 v214, v214, s71, -v1
 v_fma_f32 v215, v215, s71, -v1
 v_fma_f32 v216, v216, s71, -v1
 v_fma_f32 v217, v217, s71, -v1
 v_fma_f32 v218, v218, s71, -v1
 v_fma_f32 v219, v219, s71, -v1
 v_fma_f32 v220, v220, s71, -v1
 v_fma_f32 v221, v221, s71, -v1
 v_exp_f32 v210, v210
 v_exp_f32 v211, v211
 v_exp_f32 v212, v212
 v_exp_f32 v213, v213
 v_exp_f32 v214, v214
 v_exp_f32 v215, v215
 v_exp_f32 v216, v216
 v_exp_f32 v217, v217
 s_mov_b32 exec_lo, 0x00ff00ff
 s_mov_b32 exec_hi, 0x00ff00ff
 v_cvt_pk_bf16_f32 v162, v210, v211
 v_cvt_pk_bf16_f32 v163, v212, v213
 v_cvt_pk_bf16_f32 v164, v214, v215
 v_cvt_pk_bf16_f32 v165, v216, v217
 s_not_b64 exec, exec
 v_cvt_pk_bf16_f32 v166, v210, v211
 v_cvt_pk_bf16_f32 v167, v212, v213
 v_cvt_pk_bf16_f32 v168, v214, v215
 v_cvt_pk_bf16_f32 v169, v216, v217
 s_mov_b64 exec, -1
 v_mfma_f32_16x16x32_bf16 v[200:203], v[186:189], v[162:165], 0
 v_exp_f32 v218, v218
 v_exp_f32 v219, v219
 v_mfma_f32_16x16x32_bf16 v[192:195], v[142:145], v[162:165], 0
 v_exp_f32 v220, v220
 v_exp_f32 v221, v221
 v_mfma_f32_16x16x32_bf16 v[200:203], v[186:189], v[166:169], v[200:203]
 v_cvt_pk_bf16_f32 v190, v218, v219
 v_mfma_f32_16x16x32_bf16 v[192:195], v[150:153], v[166:169], v[192:195]
 v_cvt_pk_bf16_f32 v191, v220, v221
 s_nop 1
 v_mfma_f32_16x16x16_bf16 v[200:203], v[186:187], v[190:191], v[200:203]
 s_add_u32 s25, s60, s54
 s_add_u32 s27, s60, s55
 v_mfma_f32_16x16x16_bf16 v[192:195], v[178:179], v[190:191], v[192:195]
 s_add_u32 s28, s27, 4096
 s_mov_b32 s41, 0
 s_nop 2
 v_rcp_f32 v127, v200
 s_nop 1
 v_mul_f32 v192, v192, v127
 v_mul_f32 v193, v193, v127
 v_mul_f32 v194, v194, v127
 v_mul_f32 v195, v195, v127
 v_cvt_pk_bf16_f32 v204, v192, v193
 v_cvt_pk_bf16_f32 v205, v194, v195
 buffer_store_dwordx2 v[204:205], v2, s[4:7], s25 offen sc1
 ds_write_b64 v117, v[178:179] offset:1024
 s_sleep 4
 buffer_load_dwordx4 v[190:193], v2, s[4:7], s27 offen offset:0 sc1
 ds_read_b128 v[142:145], v114 offset:0
 ds_read_b128 v[146:149], v114 offset:1024
 s_nop 7
 buffer_load_dwordx4 v[194:197], v2, s[4:7], s27 offen offset:1024 sc1
 ds_read_b128 v[150:153], v114 offset:2048
 ds_read_b128 v[154:157], v114 offset:3072
 s_nop 7
 buffer_load_dwordx4 v[198:201], v2, s[4:7], s27 offen offset:2048 sc1
 ds_read_b128 v[234:237], v114 offset:4096
 ds_read_b128 v[238:241], v114 offset:5120
 s_nop 7
 buffer_load_dwordx4 v[202:205], v2, s[4:7], s27 offen offset:3072 sc1
 ds_read_b128 v[242:245], v114 offset:6144
 ds_read_b128 v[246:249], v114 offset:7168
 s_nop 7
 buffer_load_dwordx4 v[206:209], v2, s[4:7], s28 offen offset:0 sc1
 s_nop 7
 buffer_load_dwordx4 v[210:213], v2, s[4:7], s28 offen offset:1024 sc1
 s_waitcnt lgkmcnt(0)
Lo_260:
 s_waitcnt vmcnt(5)
 v_max3_u32 v1, v190, v191, v192
 v_max_u32 v1, v1, v193
 v_cmp_eq_u32 vcc, -1, v1
 s_cbranch_vccnz Los_261
 v_mfma_f32_16x16x32_bf16 v[214:217], v[142:145], v[190:193], 0
 ds_read_b128 v[142:145], v114 offset:8192
 v_mfma_f32_16x16x32_bf16 v[218:221], v[146:149], v[190:193], 0
 ds_read_b128 v[146:149], v114 offset:9216
 s_waitcnt vmcnt(4)
 v_max3_u32 v1, v194, v195, v196
 v_mfma_f32_16x16x32_bf16 v[222:225], v[150:153], v[190:193], 0
 ds_read_b128 v[150:153], v114 offset:10240
 v_max_u32 v1, v1, v197
 v_mfma_f32_16x16x32_bf16 v[226:229], v[154:157], v[190:193], 0
 ds_read_b128 v[154:157], v114 offset:11264
 v_cmp_eq_u32 vcc, -1, v1
 v_mfma_f32_16x16x32_bf16 v[230:233], v[234:237], v[190:193], 0
 ds_read_b128 v[234:237], v114 offset:12288
Lo_262:
 s_cbranch_vccnz Los_263
 v_mfma_f32_16x16x32_bf16 v[214:217], v[238:241], v[194:197], v[214:217]
 ds_read_b128 v[238:241], v114 offset:13312
 v_mfma_f32_16x16x32_bf16 v[218:221], v[242:245], v[194:197], v[218:221]
 ds_read_b128 v[242:245], v114 offset:14336
 s_waitcnt vmcnt(3)
 v_max3_u32 v1, v198, v199, v200
 v_mfma_f32_16x16x32_bf16 v[222:225], v[246:249], v[194:197], v[222:225]
 ds_read_b128 v[246:249], v115 offset:0
 v_max_u32 v1, v1, v201
 s_waitcnt lgkmcnt(6)
 v_mfma_f32_16x16x32_bf16 v[226:229], v[142:145], v[194:197], v[226:229]
 ds_read_b128 v[142:145], v115 offset:1024
 v_cmp_eq_u32 vcc, -1, v1
 v_mfma_f32_16x16x32_bf16 v[230:233], v[146:149], v[194:197], v[230:233]
 ds_read_b128 v[146:149], v115 offset:2048
Lo_264:
 s_cbranch_vccnz Los_265
 s_waitcnt lgkmcnt(6)
 v_mfma_f32_16x16x32_bf16 v[214:217], v[150:153], v[198:201], v[214:217]
 ds_read_b128 v[150:153], v115 offset:3072
 v_mfma_f32_16x16x32_bf16 v[218:221], v[154:157], v[198:201], v[218:221]
 ds_read_b128 v[154:157], v115 offset:4096
 s_waitcnt vmcnt(2)
 v_max3_u32 v1, v202, v203, v204
 s_waitcnt lgkmcnt(6)
 v_mfma_f32_16x16x32_bf16 v[222:225], v[234:237], v[198:201], v[222:225]
 ds_read_b128 v[234:237], v115 offset:5120
 v_max_u32 v1, v1, v205
 v_mfma_f32_16x16x32_bf16 v[226:229], v[238:241], v[198:201], v[226:229]
 ds_read_b128 v[238:241], v115 offset:6144
 v_cmp_eq_u32 vcc, -1, v1
 s_waitcnt lgkmcnt(6)
 v_mfma_f32_16x16x32_bf16 v[230:233], v[242:245], v[198:201], v[230:233]
 ds_read_b128 v[242:245], v115 offset:7168
Lo_266:
 s_cbranch_vccnz Los_267
 v_mfma_f32_16x16x32_bf16 v[214:217], v[246:249], v[202:205], v[214:217]
 ds_read_b128 v[246:249], v115 offset:8192
 s_waitcnt lgkmcnt(6)
 v_mfma_f32_16x16x32_bf16 v[218:221], v[142:145], v[202:205], v[218:221]
 ds_read_b128 v[142:145], v115 offset:9216
 s_waitcnt vmcnt(1)
 v_max3_u32 v1, v206, v207, v208
 v_mfma_f32_16x16x32_bf16 v[222:225], v[146:149], v[202:205], v[222:225]
 ds_read_b128 v[146:149], v115 offset:10240
 v_max_u32 v1, v1, v209
 s_waitcnt lgkmcnt(6)
 v_mfma_f32_16x16x32_bf16 v[226:229], v[150:153], v[202:205], v[226:229]
 ds_read_b128 v[150:153], v115 offset:11264
 v_cmp_eq_u32 vcc, -1, v1
 v_mfma_f32_16x16x32_bf16 v[230:233], v[154:157], v[202:205], v[230:233]
 ds_read_b128 v[154:157], v115 offset:12288
Lo_268:
 s_cbranch_vccnz Los_269
 s_waitcnt lgkmcnt(6)
 v_mfma_f32_16x16x32_bf16 v[214:217], v[234:237], v[206:209], v[214:217]
 ds_read_b128 v[234:237], v115 offset:13312
 v_mfma_f32_16x16x32_bf16 v[218:221], v[238:241], v[206:209], v[218:221]
 ds_read_b128 v[238:241], v115 offset:14336
 s_waitcnt vmcnt(0)
 v_max3_u32 v1, v210, v211, v212
 s_waitcnt lgkmcnt(6)
 v_mfma_f32_16x16x32_bf16 v[222:225], v[242:245], v[206:209], v[222:225]
 v_max_u32 v1, v1, v213
 v_mfma_f32_16x16x32_bf16 v[226:229], v[246:249], v[206:209], v[226:229]
 v_cmp_eq_u32 vcc, -1, v1
 s_waitcnt lgkmcnt(4)
 v_mfma_f32_16x16x32_bf16 v[230:233], v[142:145], v[206:209], v[230:233]
Lo_270:
 s_cbranch_vccnz Los_271
 v_mfma_f32_16x16x32_bf16 v[214:217], v[146:149], v[210:213], v[214:217]
 buffer_load_dwordx4 v[130:133], v2, s[4:7], s66 offen sc1
 s_waitcnt lgkmcnt(2)
 v_mfma_f32_16x16x32_bf16 v[218:221], v[150:153], v[210:213], v[218:221]
 buffer_load_dwordx4 v[134:137], v2, s[4:7], s66 offen offset:2048 sc1
 v_mfma_f32_16x16x32_bf16 v[222:225], v[154:157], v[210:213], v[222:225]
 s_add_u32 s25, s66, 4096
 buffer_load_dwordx4 v[138:141], v2, s[4:7], s25 offen sc1
 s_waitcnt lgkmcnt(0)
 v_mfma_f32_16x16x32_bf16 v[226:229], v[234:237], v[210:213], v[226:229]
 v_mfma_f32_16x16x32_bf16 v[230:233], v[238:241], v[210:213], v[230:233]
 v_cvt_pk_bf16_f32 v190, v214, v215
 v_cvt_pk_bf16_f32 v191, v216, v217
 v_cvt_pk_bf16_f32 v192, v218, v219
 v_cvt_pk_bf16_f32 v193, v220, v221
 ds_write_b128 v118, v[190:193]
 v_cvt_pk_bf16_f32 v194, v222, v223
 v_cvt_pk_bf16_f32 v195, v224, v225
 v_cvt_pk_bf16_f32 v196, v226, v227
 v_cvt_pk_bf16_f32 v197, v228, v229
 ds_write_b128 v118, v[194:197] offset:4096
 v_cvt_pk_bf16_f32 v198, v230, v231
 v_cvt_pk_bf16_f32 v199, v232, v233
 ds_write_b64 v119, v[198:199] offset:8192
 s_add_u32 s25, s62, s46
 s_add_u32 s26, s25, 8192
 s_add_u32 s27, s25, 655360
 s_add_u32 s28, s26, 655360
 s_waitcnt lgkmcnt(0)
 s_barrier
 ds_read_b128 v[190:193], v3 offset:0
 ds_read_b128 v[194:197], v3 offset:1024
 ds_read_b128 v[198:201], v3 offset:2048
 ds_read_b128 v[202:205], v3 offset:3072
 ds_read_b128 v[206:209], v3 offset:8192
 ds_read_b128 v[210:213], v3 offset:9216
 s_waitcnt lgkmcnt(5)
 v_mfma_f32_16x16x32_bf16 v[214:217], v[170:173], v[190:193], 0
 s_waitcnt lgkmcnt(4)
 v_mfma_f32_16x16x32_bf16 v[214:217], v[174:177], v[194:197], v[214:217]
 s_waitcnt lgkmcnt(3)
 v_mfma_f32_16x16x32_bf16 v[218:221], v[170:173], v[198:201], 0
 s_waitcnt lgkmcnt(2)
 v_mfma_f32_16x16x32_bf16 v[218:221], v[174:177], v[202:205], v[218:221]
 s_waitcnt lgkmcnt(1)
 v_mfma_f32_16x16x32_bf16 v[222:225], v[170:173], v[206:209], 0
 v_cvt_pk_bf16_f32 v226, v214, v215
 v_cvt_pk_bf16_f32 v227, v216, v217
 s_waitcnt lgkmcnt(0)
 v_mfma_f32_16x16x32_bf16 v[222:225], v[174:177], v[210:213], v[222:225]
 s_nop 1
 v_cvt_pk_bf16_f32 v228, v218, v219
 v_cvt_pk_bf16_f32 v229, v220, v221
 s_nop 0
 v_permlane16_swap_b32 v226, v228
 v_permlane16_swap_b32 v227, v229
 buffer_store_dwordx4 v[226:229], v120, s[4:7], s25 offen sc1
 v_cvt_pk_bf16_f32 v230, v222, v223
 v_cvt_pk_bf16_f32 v231, v224, v225
 v_cvt_pk_bf16_f32 v232, v222, v223
 v_cvt_pk_bf16_f32 v233, v224, v225
 s_nop 0
 v_permlane16_swap_b32 v230, v232
 v_permlane16_swap_b32 v231, v233
 s_mov_b32 exec_lo, 0xffff
 s_mov_b32 exec_hi, 0xffff
 buffer_store_dwordx4 v[230:233], v120, s[4:7], s26 offen sc1
 buffer_store_dwordx4 v[230:233], v120, s[4:7], s28 offen sc1
 s_mov_b64 exec, -1
 buffer_store_dwordx4 v[226:229], v120, s[4:7], s27 offen sc1
 s_add_u32 s70, s69, s52
 s_add_u32 s27, s62, s47
 s_add_u32 s28, s62, s48
 s_add_u32 s69, s31, 1
 s_and_b32 s25, s69, 3
 s_mul_i32 s26, s25, 20480
 s_add_u32 s56, s26, s42
 s_add_u32 s57, s56, 4096
 s_add_u32 s58, s26, s43
 s_mul_i32 s62, s25, 163840
 s_xor_b32 s26, s25, 2
 s_mul_i32 s63, s26, 163840
 s_add_u32 s25, s25, 3
 s_and_b32 s25, s25, 3
 s_mul_i32 s26, s25, 20480
 s_add_u32 s59, s26, s43
 s_and_b32 s25, s69, 1
 s_mul_i32 s60, s25, 196608
 s_xor_b32 s25, s25, 1
 s_mul_i32 s61, s25, 196608
 s_mul_i32 s69, s69, 196608
 s_add_u32 s31, s31, 1
 s_barrier
 s_branch L_rec_top_2r
Lfin_256:
 s_waitcnt lgkmcnt(0)
 s_nop 4
 v_cvt_pk_bf16_f32 v178, v226, v227
 v_cvt_pk_bf16_f32 v179, v228, v229
 ds_write_b64 v117, v[178:179] offset:1024
 s_waitcnt lgkmcnt(0)
 s_barrier
 s_endpgm
Lzs_245:
 buffer_load_dwordx4 v[190:193], v2, s[4:7], s56 offen offset:0 sc1
 buffer_load_dwordx4 v[194:197], v2, s[4:7], s56 offen offset:1024 sc1
 buffer_load_dwordx4 v[198:201], v2, s[4:7], s56 offen offset:2048 sc1
 buffer_load_dwordx4 v[202:205], v2, s[4:7], s56 offen offset:3072 sc1
 buffer_load_dwordx4 v[206:209], v2, s[4:7], s57 offen offset:0 sc1
 s_add_u32 s41, s41, 1
 s_cmp_gt_u32 s41, 200000
 s_cbranch_scc1 L_fail
 s_branch Lz_244
Lzs_247:
 buffer_load_dwordx4 v[194:197], v2, s[4:7], s56 offen offset:1024 sc1
 buffer_load_dwordx4 v[198:201], v2, s[4:7], s56 offen offset:2048 sc1
 buffer_load_dwordx4 v[202:205], v2, s[4:7], s56 offen offset:3072 sc1
 buffer_load_dwordx4 v[206:209], v2, s[4:7], s57 offen offset:0 sc1
 s_add_u32 s41, s41, 1
 s_cmp_gt_u32 s41, 200000
 s_cbranch_scc1 L_fail
 s_branch Lz_246
Lzs_249:
 buffer_load_dwordx4 v[198:201], v2, s[4:7], s56 offen offset:2048 sc1
 buffer_load_dwordx4 v[202:205], v2, s[4:7], s56 offen offset:3072 sc1
 buffer_load_dwordx4 v[206:209], v2, s[4:7], s57 offen offset:0 sc1
 s_add_u32 s41, s41, 1
 s_cmp_gt_u32 s41, 200000
 s_cbranch_scc1 L_fail
 s_branch Lz_248
Lzs_251:
 buffer_load_dwordx4 v[202:205], v2, s[4:7], s56 offen offset:3072 sc1
 buffer_load_dwordx4 v[206:209], v2, s[4:7], s57 offen offset:0 sc1
 s_add_u32 s41, s41, 1
 s_cmp_gt_u32 s41, 200000
 s_cbranch_scc1 L_fail
 s_branch Lz_250
Lzs_253:
 buffer_load_dwordx4 v[206:209], v2, s[4:7], s57 offen offset:0 sc1
 s_add_u32 s41, s41, 1
 s_cmp_gt_u32 s41, 200000
 s_cbranch_scc1 L_fail
 s_branch Lz_252
Lfs_258:
 v_max3_u32 v222, v194, v195, v196
 v_max3_u32 v222, v222, v197, v198
 v_max3_u32 v222, v222, v199, v200
 v_max3_u32 v222, v222, v201, v202
 v_max3_u32 v222, v222, v203, v204
 v_max_u32 v222, v222, v205
 v_cmp_eq_u32 vcc, -1, v222
 s_cbranch_vccz Lfok_259
 buffer_load_dwordx4 v[194:197], v2, s[4:7], s27 offen offset:0 sc1
 buffer_load_dwordx4 v[198:201], v2, s[4:7], s27 offen offset:1024 sc1
 buffer_load_dwordx4 v[202:205], v2, s[4:7], s27 offen offset:2048 sc1
 s_add_u32 s41, s41, 1
 s_cmp_gt_u32 s41, 200000
 s_cbranch_scc1 L_fail
 s_branch Lf_257
Los_261:
 buffer_load_dwordx4 v[190:193], v2, s[4:7], s27 offen offset:0 sc1
 buffer_load_dwordx4 v[194:197], v2, s[4:7], s27 offen offset:1024 sc1
 buffer_load_dwordx4 v[198:201], v2, s[4:7], s27 offen offset:2048 sc1
 buffer_load_dwordx4 v[202:205], v2, s[4:7], s27 offen offset:3072 sc1
 buffer_load_dwordx4 v[206:209], v2, s[4:7], s28 offen offset:0 sc1
 buffer_load_dwordx4 v[210:213], v2, s[4:7], s28 offen offset:1024 sc1
 s_add_u32 s41, s41, 1
 s_cmp_gt_u32 s41, 200000
 s_cbranch_scc1 L_fail
 s_branch Lo_260
Los_263:
 buffer_load_dwordx4 v[194:197], v2, s[4:7], s27 offen offset:1024 sc1
 buffer_load_dwordx4 v[198:201], v2, s[4:7], s27 offen offset:2048 sc1
 buffer_load_dwordx4 v[202:205], v2, s[4:7], s27 offen offset:3072 sc1
 buffer_load_dwordx4 v[206:209], v2, s[4:7], s28 offen offset:0 sc1
 buffer_load_dwordx4 v[210:213], v2, s[4:7], s28 offen offset:1024 sc1
 s_waitcnt vmcnt(4)
 v_max3_u32 v1, v194, v195, v196
 v_max_u32 v1, v1, v197
 v_cmp_eq_u32 vcc, -1, v1
 s_add_u32 s41, s41, 1
 s_cmp_gt_u32 s41, 200000
 s_cbranch_scc1 L_fail
 s_branch Lo_262
Los_265:
 buffer_load_dwordx4 v[198:201], v2, s[4:7], s27 offen offset:2048 sc1
 buffer_load_dwordx4 v[202:205], v2, s[4:7], s27 offen offset:3072 sc1
 buffer_load_dwordx4 v[206:209], v2, s[4:7], s28 offen offset:0 sc1
 buffer_load_dwordx4 v[210:213], v2, s[4:7], s28 offen offset:1024 sc1
 s_waitcnt vmcnt(3)
 v_max3_u32 v1, v198, v199, v200
 v_max_u32 v1, v1, v201
 v_cmp_eq_u32 vcc, -1, v1
 s_add_u32 s41, s41, 1
 s_cmp_gt_u32 s41, 200000
 s_cbranch_scc1 L_fail
 s_branch Lo_264
Los_267:
 buffer_load_dwordx4 v[202:205], v2, s[4:7], s27 offen offset:3072 sc1
 buffer_load_dwordx4 v[206:209], v2, s[4:7], s28 offen offset:0 sc1
 buffer_load_dwordx4 v[210:213], v2, s[4:7], s28 offen offset:1024 sc1
 s_waitcnt vmcnt(2)
 v_max3_u32 v1, v202, v203, v204
 v_max_u32 v1, v1, v205
 v_cmp_eq_u32 vcc, -1, v1
 s_add_u32 s41, s41, 1
 s_cmp_gt_u32 s41, 200000
 s_cbranch_scc1 L_fail
 s_branch Lo_266
Los_269:
 buffer_load_dwordx4 v[206:209], v2, s[4:7], s28 offen offset:0 sc1
 buffer_load_dwordx4 v[210:213], v2, s[4:7], s28 offen offset:1024 sc1
 s_waitcnt vmcnt(1)
 v_max3_u32 v1, v206, v207, v208
 v_max_u32 v1, v1, v209
 v_cmp_eq_u32 vcc, -1, v1
 s_add_u32 s41, s41, 1
 s_cmp_gt_u32 s41, 200000
 s_cbranch_scc1 L_fail
 s_branch Lo_268
Los_271:
 buffer_load_dwordx4 v[210:213], v2, s[4:7], s28 offen offset:1024 sc1
 s_waitcnt vmcnt(0)
 v_max3_u32 v1, v210, v211, v212
 v_max_u32 v1, v1, v213
 v_cmp_eq_u32 vcc, -1, v1
 s_add_u32 s41, s41, 1
 s_cmp_gt_u32 s41, 200000
 s_cbranch_scc1 L_fail
 s_branch Lo_270
Lpwn_243:
 s_waitcnt vmcnt(0)
 s_barrier
L_rec_top_3r:
 s_mov_b32 s41, 0
 s_sleep 2
 buffer_load_dwordx4 v[190:193], v2, s[4:7], s56 offen offset:0 sc1
 s_nop 11
 buffer_load_dwordx4 v[194:197], v2, s[4:7], s56 offen offset:1024 sc1
 s_nop 11
 buffer_load_dwordx4 v[198:201], v2, s[4:7], s56 offen offset:2048 sc1
 s_nop 11
 buffer_load_dwordx4 v[202:205], v2, s[4:7], s56 offen offset:3072 sc1
 s_nop 11
 buffer_load_dwordx4 v[206:209], v2, s[4:7], s57 offen offset:0 sc1
Lz_273:
 s_waitcnt vmcnt(4)
 ds_write_b128 v108, v[190:193] offset:0
 v_mfma_f32_16x16x32_bf16 v[226:229], a[0:3], v[190:193], 0
 v_max3_u32 v1, v190, v191, v192
 v_max_u32 v1, v1, v193
 v_mfma_f32_16x16x32_bf16 v[230:233], a[80:83], v[190:193], 0
 v_cmp_eq_u32 vcc, -1, v1
 v_mfma_f32_16x16x32_bf16 v[234:237], a[160:163], v[190:193], 0
 s_cbranch_vccnz Lzs_274
Lz_275:
 s_waitcnt vmcnt(3)
 ds_write_b128 v108, v[194:197] offset:1024
 v_max3_u32 v1, v194, v195, v196
 v_max_u32 v1, v1, v197
 v_cmp_eq_u32 vcc, -1, v1
 s_cbranch_vccnz Lzs_276
 v_mfma_f32_16x16x32_bf16 v[226:229], a[4:7], v[194:197], v[226:229]
 v_mfma_f32_16x16x32_bf16 v[230:233], a[84:87], v[194:197], v[230:233]
 v_mfma_f32_16x16x32_bf16 v[234:237], a[164:167], v[194:197], v[234:237]
Lz_277:
 s_waitcnt vmcnt(2)
 ds_write_b128 v108, v[198:201] offset:2048
 v_max3_u32 v1, v198, v199, v200
 v_max_u32 v1, v1, v201
 v_cmp_eq_u32 vcc, -1, v1
 s_cbranch_vccnz Lzs_278
 v_mfma_f32_16x16x32_bf16 v[226:229], a[8:11], v[198:201], v[226:229]
 v_mfma_f32_16x16x32_bf16 v[230:233], a[88:91], v[198:201], v[230:233]
 v_mfma_f32_16x16x32_bf16 v[234:237], a[168:171], v[198:201], v[234:237]
Lz_279:
 s_waitcnt vmcnt(1)
 ds_write_b128 v108, v[202:205] offset:3072
 v_max3_u32 v1, v202, v203, v204
 v_max_u32 v1, v1, v205
 v_cmp_eq_u32 vcc, -1, v1
 s_cbranch_vccnz Lzs_280
Lz_281:
 s_waitcnt vmcnt(0)
 ds_write_b128 v108, v[206:209] offset:4096
 v_max3_u32 v1, v206, v207, v208
 v_max_u32 v1, v1, v209
 v_cmp_eq_u32 vcc, -1, v1
 s_cbranch_vccnz Lzs_282
 s_waitcnt lgkmcnt(0)
 s_barrier
 ds_read_b128 v[214:217], v109 offset:0
 ds_read_b128 v[218:221], v109 offset:1024
 ds_read_b128 v[222:225], v109 offset:2048
 v_mfma_f32_16x16x32_bf16 v[226:229], a[12:15], v[202:205], v[226:229]
 buffer_load_dword v126, v124, s[4:7], 0 offen sc1
 v_mfma_f32_16x16x32_bf16 v[230:233], a[92:95], v[202:205], v[230:233]
 v_mfma_f32_16x16x32_bf16 v[234:237], a[172:175], v[202:205], v[234:237]
 v_mfma_f32_16x16x32_bf16 v[226:229], a[16:19], v[206:209], v[226:229]
 s_add_u32 s25, s67, s50
 v_mfma_f32_16x16x32_bf16 v[230:233], a[96:99], v[206:209], v[230:233]
 buffer_load_dwordx4 v[142:145], v2, s[4:7], s25 offen sc1
 v_mfma_f32_16x16x32_bf16 v[234:237], a[176:179], v[206:209], v[234:237]
 ds_read_b128 v[210:213], v109 offset:3072
 s_waitcnt lgkmcnt(3)
 v_mfma_f32_16x16x32_bf16 v[226:229], a[20:23], v[214:217], v[226:229]
 s_add_u32 s25, s68, s50
 v_mfma_f32_16x16x32_bf16 v[230:233], a[100:103], v[214:217], v[230:233]
 buffer_load_dwordx4 v[150:153], v2, s[4:7], s25 offen sc1
 v_mfma_f32_16x16x32_bf16 v[234:237], a[180:183], v[214:217], v[234:237]
 ds_read_b128 v[214:217], v109 offset:4096
 s_waitcnt lgkmcnt(3)
 v_mfma_f32_16x16x32_bf16 v[226:229], a[24:27], v[218:221], v[226:229]
 s_add_u32 s25, s46, s63
 v_mfma_f32_16x16x32_bf16 v[230:233], a[104:107], v[218:221], v[230:233]
 s_add_u32 s25, s25, 0
 v_mfma_f32_16x16x32_bf16 v[234:237], a[184:187], v[218:221], v[234:237]
 buffer_store_dwordx4 v[182:185], v120, s[4:7], s25 offen sc1
 ds_read_b128 v[218:221], v110 offset:0
 s_waitcnt lgkmcnt(3)
 v_mfma_f32_16x16x32_bf16 v[226:229], a[28:31], v[222:225], v[226:229]
 s_add_u32 s25, s46, s63
 v_mfma_f32_16x16x32_bf16 v[230:233], a[108:111], v[222:225], v[230:233]
 s_add_u32 s25, s25, 655360
 v_mfma_f32_16x16x32_bf16 v[234:237], a[188:191], v[222:225], v[234:237]
 buffer_store_dwordx4 v[182:185], v120, s[4:7], s25 offen sc1
 ds_read_b128 v[222:225], v110 offset:1024
 s_waitcnt lgkmcnt(3)
 v_mfma_f32_16x16x32_bf16 v[226:229], a[32:35], v[210:213], v[226:229]
 s_add_u32 s25, s31, 1
 s_mul_i32 s67, s25, 393216
 v_mfma_f32_16x16x32_bf16 v[230:233], a[112:115], v[210:213], v[230:233]
 s_add_u32 s67, s67, 84312064
 s_cmp_lt_u32 s25, 64
 v_mfma_f32_16x16x32_bf16 v[234:237], a[192:195], v[210:213], v[234:237]
 s_cselect_b32 s67, s67, 2146435072
 ds_read_b128 v[210:213], v110 offset:2048
 s_waitcnt lgkmcnt(3)
 v_mfma_f32_16x16x32_bf16 v[226:229], a[36:39], v[214:217], v[226:229]
 s_sub_u32 s26, s25, 9
 s_mul_i32 s68, s26, 393216
 v_mfma_f32_16x16x32_bf16 v[230:233], a[116:119], v[214:217], v[230:233]
 s_add_u32 s68, s68, 134643712
 s_cmp_lt_u32 s26, 64
 v_mfma_f32_16x16x32_bf16 v[234:237], a[196:199], v[214:217], v[234:237]
 s_cselect_b32 s68, s68, 2146435072
 ds_read_b128 v[214:217], v110 offset:3072
 s_waitcnt lgkmcnt(3)
 v_mfma_f32_16x16x32_bf16 v[226:229], a[40:43], v[218:221], v[226:229]
 s_add_u32 s25, s67, 4269801472
 s_add_u32 s26, s68, 4269801472
 v_mfma_f32_16x16x32_bf16 v[230:233], a[120:123], v[218:221], v[230:233]
 s_cmp_lt_u32 s3, 2
 s_cselect_b32 s66, s25, s26
 v_mfma_f32_16x16x32_bf16 v[234:237], a[200:203], v[218:221], v[234:237]
 s_add_u32 s66, s66, s49
 ds_read_b128 v[218:221], v110 offset:4096
 s_waitcnt lgkmcnt(3)
 v_mfma_f32_16x16x32_bf16 v[226:229], a[44:47], v[222:225], v[226:229]
 v_mfma_f32_16x16x32_bf16 v[230:233], a[124:127], v[222:225], v[230:233]
 v_mfma_f32_16x16x32_bf16 v[234:237], a[204:207], v[222:225], v[234:237]
 ds_read_b128 v[222:225], v111 offset:0
 s_waitcnt lgkmcnt(3)
 v_mfma_f32_16x16x32_bf16 v[226:229], a[48:51], v[210:213], v[226:229]
 v_mfma_f32_16x16x32_bf16 v[230:233], a[128:131], v[210:213], v[230:233]
 v_mfma_f32_16x16x32_bf16 v[234:237], a[208:211], v[210:213], v[234:237]
 ds_read_b128 v[210:213], v111 offset:1024
 s_waitcnt lgkmcnt(3)
 v_mfma_f32_16x16x32_bf16 v[226:229], a[52:55], v[214:217], v[226:229]
 v_mfma_f32_16x16x32_bf16 v[230:233], a[132:135], v[214:217], v[230:233]
 v_mfma_f32_16x16x32_bf16 v[234:237], a[212:215], v[214:217], v[234:237]
 ds_read_b128 v[214:217], v111 offset:2048
 s_waitcnt lgkmcnt(3)
 v_mfma_f32_16x16x32_bf16 v[226:229], a[56:59], v[218:221], v[226:229]
 v_mfma_f32_16x16x32_bf16 v[230:233], a[136:139], v[218:221], v[230:233]
 v_mfma_f32_16x16x32_bf16 v[234:237], a[216:219], v[218:221], v[234:237]
 ds_read_b128 v[218:221], v111 offset:3072
 s_waitcnt lgkmcnt(3)
 v_mfma_f32_16x16x32_bf16 v[226:229], a[60:63], v[222:225], v[226:229]
 v_mfma_f32_16x16x32_bf16 v[230:233], a[140:143], v[222:225], v[230:233]
 v_mfma_f32_16x16x32_bf16 v[234:237], a[220:223], v[222:225], v[234:237]
 ds_read_b128 v[222:225], v111 offset:4096
 s_waitcnt lgkmcnt(3)
 v_mfma_f32_16x16x32_bf16 v[226:229], a[64:67], v[210:213], v[226:229]
 v_mfma_f32_16x16x32_bf16 v[230:233], a[144:147], v[210:213], v[230:233]
 v_mfma_f32_16x16x32_bf16 v[234:237], a[224:227], v[210:213], v[234:237]
 s_waitcnt lgkmcnt(2)
 v_mfma_f32_16x16x32_bf16 v[226:229], a[68:71], v[214:217], v[226:229]
 v_mfma_f32_16x16x32_bf16 v[230:233], a[148:151], v[214:217], v[230:233]
 v_mfma_f32_16x16x32_bf16 v[234:237], a[228:231], v[214:217], v[234:237]
 s_waitcnt lgkmcnt(1)
 v_mfma_f32_16x16x32_bf16 v[226:229], a[72:75], v[218:221], v[226:229]
 v_mfma_f32_16x16x32_bf16 v[230:233], a[152:155], v[218:221], v[230:233]
 v_mfma_f32_16x16x32_bf16 v[234:237], a[232:235], v[218:221], v[234:237]
 s_waitcnt lgkmcnt(0)
 v_mfma_f32_16x16x32_bf16 v[226:229], a[76:79], v[222:225], v[226:229]
 v_mfma_f32_16x16x32_bf16 v[230:233], a[156:159], v[222:225], v[230:233]
 v_mfma_f32_16x16x32_bf16 v[234:237], a[236:239], v[222:225], v[234:237]
 s_nop 1
 v_cvt_pk_bf16_f32 v190, v226, v227
 v_cvt_pk_bf16_f32 v191, v228, v229
 ds_write_b64 v112, v[190:191] offset:0
 v_cvt_pk_bf16_f32 v192, v230, v231
 v_cvt_pk_bf16_f32 v193, v232, v233
 ds_write_b64 v113, v[192:193] offset:0
 v_cvt_pk_bf16_f32 v194, v234, v235
 v_cvt_pk_bf16_f32 v195, v236, v237
 ds_write_b64 v112, v[194:195] offset:1024
 s_add_u32 s26, s60, s44
 s_add_u32 s27, s60, s45
 s_waitcnt lgkmcnt(0)
 s_barrier
 ds_read_b128 v[198:201], v3 offset:20480
 ds_read_b128 v[202:205], v3 offset:21504
 ds_read_b128 v[206:209], v3 offset:22528
 ds_read_b128 v[226:229], v3 offset:23552
 ds_read_b128 v[230:233], v3 offset:24576
 ds_read_b128 v[234:237], v3 offset:25600
 ds_read_b128 v[210:213], v108 offset:0
 ds_read_b128 v[214:217], v108 offset:1024
 ds_read_b128 v[218:221], v108 offset:2048
 s_waitcnt lgkmcnt(8)
 v_mfma_f32_16x16x32_bf16 v[194:197], v[130:133], v[198:201], 0
 s_waitcnt lgkmcnt(7)
 v_mfma_f32_16x16x32_bf16 v[194:197], v[134:137], v[202:205], v[194:197]
 s_waitcnt lgkmcnt(6)
 v_mfma_f32_16x16x32_bf16 v[194:197], v[138:141], v[206:209], v[194:197]
 s_waitcnt lgkmcnt(5)
 v_mfma_f32_16x16x32_bf16 v[190:193], v[226:229], v[198:201], v[158:161]
 s_waitcnt lgkmcnt(4)
 v_mfma_f32_16x16x32_bf16 v[190:193], v[230:233], v[202:205], v[190:193]
 s_mov_b32 exec_lo, 0xff00ff00
 s_mov_b32 exec_hi, 0xff00ff00
 s_waitcnt lgkmcnt(3)
 v_mfma_f32_16x16x32_bf16 v[190:193], v[234:237], v[206:209], v[190:193]
 buffer_store_dwordx4 v[194:197], v2, s[4:7], s26 offen offset:1024 sc1
 ds_write_b128 v116, v[194:197] offset:26624
 s_mov_b64 exec, -1
 ds_read_b128 v[222:225], v108 offset:3072
 s_waitcnt lgkmcnt(4)
 v_mfma_f32_16x16x32_bf16 v[226:229], v[210:213], a[240:243], 0
 v_mfma_f32_16x16x32_bf16 v[230:233], v[210:213], v[68:71], 0
 s_nop 0
 buffer_store_dwordx4 v[190:193], v2, s[4:7], s26 offen offset:2048 sc1
 ds_read_b128 v[210:213], v108 offset:4096
 s_waitcnt lgkmcnt(4)
 v_mfma_f32_16x16x32_bf16 v[226:229], v[214:217], a[244:247], v[226:229]
 v_mfma_f32_16x16x32_bf16 v[230:233], v[214:217], v[72:75], v[230:233]
 ds_read_b128 v[214:217], v109 offset:0
 s_waitcnt lgkmcnt(4)
 v_mfma_f32_16x16x32_bf16 v[226:229], v[218:221], a[248:251], v[226:229]
 v_mfma_f32_16x16x32_bf16 v[230:233], v[218:221], v[76:79], v[230:233]
 ds_read_b128 v[218:221], v109 offset:1024
 s_waitcnt lgkmcnt(3)
 v_mfma_f32_16x16x32_bf16 v[226:229], v[222:225], a[252:255], v[226:229]
 v_mfma_f32_16x16x32_bf16 v[230:233], v[222:225], v[80:83], v[230:233]
 s_waitcnt vmcnt(6)
 s_mov_b32 s41, 0
 v_min_i32 v1, 64, v125
 v_cmp_ge_i32 vcc, v126, v1
 s_nop 0
 s_cmp_eq_u64 vcc, -1
 s_cbranch_scc1 Lflok_284
Lfl_283:
 s_add_u32 s41, s41, 1
 s_cmp_gt_u32 s41, 200000
 s_cbranch_scc1 L_fail
 buffer_load_dword v126, v124, s[4:7], 0 offen sc1
 s_waitcnt vmcnt(0)
 v_cmp_ge_i32 vcc, v126, v1
 s_nop 0
 s_cmp_eq_u64 vcc, -1
 s_cbranch_scc0 Lfl_283
Lflok_284:
 v_add_u32 v125, 1, v125
 ds_read_b128 v[222:225], v109 offset:2048
 s_waitcnt lgkmcnt(3)
 v_mfma_f32_16x16x32_bf16 v[226:229], v[210:213], v[4:7], v[226:229]
 v_mfma_f32_16x16x32_bf16 v[230:233], v[210:213], v[84:87], v[230:233]
 s_barrier
 ds_read_b128 v[234:237], v3 offset:26624
 ds_read_b128 v[238:241], v3 offset:27648
 ds_read_b128 v[210:213], v109 offset:3072
 s_waitcnt lgkmcnt(5)
 v_mfma_f32_16x16x32_bf16 v[226:229], v[214:217], v[8:11], v[226:229]
 v_mfma_f32_16x16x32_bf16 v[230:233], v[214:217], v[88:91], v[230:233]
 ds_read_b128 v[214:217], v109 offset:4096
 s_waitcnt lgkmcnt(5)
 v_mfma_f32_16x16x32_bf16 v[226:229], v[218:221], v[12:15], v[226:229]
 v_mfma_f32_16x16x32_bf16 v[230:233], v[218:221], v[92:95], v[230:233]
 ds_read_b128 v[218:221], v110 offset:0
 s_waitcnt lgkmcnt(5)
 v_mfma_f32_16x16x32_bf16 v[226:229], v[222:225], v[16:19], v[226:229]
 v_mfma_f32_16x16x32_bf16 v[230:233], v[222:225], v[96:99], v[230:233]
 ds_read_b128 v[222:225], v110 offset:1024
 s_waitcnt lgkmcnt(3)
 v_mfma_f32_16x16x32_bf16 v[226:229], v[210:213], v[20:23], v[226:229]
 v_mfma_f32_16x16x32_bf16 v[230:233], v[210:213], v[100:103], v[230:233]
 buffer_load_dwordx4 v[194:197], v2, s[4:7], s27 offen offset:0 sc1
 ds_read_b128 v[210:213], v110 offset:2048
 s_waitcnt lgkmcnt(3)
 v_mfma_f32_16x16x32_bf16 v[226:229], v[214:217], v[24:27], v[226:229]
 v_mfma_f32_16x16x32_bf16 v[230:233], v[214:217], v[104:107], v[230:233]
 ds_read_b128 v[214:217], v110 offset:3072
 s_waitcnt lgkmcnt(3)
 v_mfma_f32_16x16x32_bf16 v[226:229], v[218:221], v[28:31], v[226:229]
 ds_read_b128 v[218:221], v110 offset:4096
 s_waitcnt lgkmcnt(3)
 v_mfma_f32_16x16x32_bf16 v[226:229], v[222:225], v[32:35], v[226:229]
 buffer_load_dwordx4 v[198:201], v2, s[4:7], s27 offen offset:1024 sc1
 ds_read_b128 v[222:225], v111 offset:0
 s_waitcnt lgkmcnt(3)
 v_mfma_f32_16x16x32_bf16 v[226:229], v[210:213], v[36:39], v[226:229]
 ds_write_b128 v116, v[230:233] offset:28672
 ds_read_b128 v[210:213], v111 offset:1024
 s_waitcnt lgkmcnt(4)
 v_mfma_f32_16x16x32_bf16 v[226:229], v[214:217], v[40:43], v[226:229]
 ds_read_b128 v[214:217], v111 offset:2048
 s_waitcnt lgkmcnt(4)
 v_mfma_f32_16x16x32_bf16 v[226:229], v[218:221], v[44:47], v[226:229]
 buffer_load_dwordx4 v[202:205], v2, s[4:7], s27 offen offset:2048 sc1
 ds_read_b128 v[218:221], v111 offset:3072
 s_waitcnt lgkmcnt(4)
 v_mfma_f32_16x16x32_bf16 v[226:229], v[222:225], v[48:51], v[226:229]
 ds_read_b128 v[222:225], v111 offset:4096
 s_waitcnt lgkmcnt(3)
 v_mfma_f32_16x16x32_bf16 v[226:229], v[210:213], v[52:55], v[226:229]
 s_waitcnt lgkmcnt(2)
 v_mfma_f32_16x16x32_bf16 v[226:229], v[214:217], v[56:59], v[226:229]
 s_barrier
 s_waitcnt lgkmcnt(1)
 v_mfma_f32_16x16x32_bf16 v[226:229], v[218:221], v[60:63], v[226:229]
 s_waitcnt lgkmcnt(0)
 v_mfma_f32_16x16x32_bf16 v[226:229], v[222:225], v[64:67], v[226:229]
 s_cmp_eq_u32 s31, 72
 s_cbranch_scc1 Lfin_285
 s_mov_b32 s41, 0
Lf_286:
 s_waitcnt vmcnt(2)
 v_add_f32 v210, v234, v194
 v_add_f32 v211, v235, v195
 v_add_f32 v212, v236, v196
 v_add_f32 v213, v237, v197
 s_waitcnt vmcnt(1)
 v_add_f32 v214, v238, v198
 v_add_f32 v215, v239, v199
 v_add_f32 v216, v240, v200
 v_add_f32 v217, v241, v201
 v_maximum3_f32 v1, v210, v211, v212
 v_maximum3_f32 v127, v213, v214, v215
 v_maximum3_f32 v1, v1, v216, v217
 s_waitcnt vmcnt(0)
 v_add_f32 v218, v190, v202
 v_add_f32 v219, v191, v203
 v_add_f32 v220, v192, v204
 v_add_f32 v221, v193, v205
 v_maximum3_f32 v127, v127, v218, v219
 v_maximum3_f32 v1, v1, v220, v221
 v_maximum3_f32 v1, v1, v127, v127
 v_cmp_u_f32 vcc, v1, v1
 v_mov_b32 v127, v1
 s_cbranch_vccnz Lfs_287
Lfok_288:
 s_nop 0
 v_permlane32_swap_b32 v1, v127
 v_max_f32 v1, v1, v127
 v_mov_b32 v127, v1
 v_cvt_pk_bf16_f32 v178, v226, v227
 v_cvt_pk_bf16_f32 v179, v228, v229
 v_permlane16_swap_b32 v1, v127
 v_max_f32 v1, v1, v127
 v_mul_f32 v1, s71, v1
 v_fma_f32 v210, v210, s71, -v1
 v_fma_f32 v211, v211, s71, -v1
 v_fma_f32 v212, v212, s71, -v1
 v_fma_f32 v213, v213, s71, -v1
 v_fma_f32 v214, v214, s71, -v1
 v_fma_f32 v215, v215, s71, -v1
 v_fma_f32 v216, v216, s71, -v1
 v_fma_f32 v217, v217, s71, -v1
 v_fma_f32 v218, v218, s71, -v1
 v_fma_f32 v219, v219, s71, -v1
 v_fma_f32 v220, v220, s71, -v1
 v_fma_f32 v221, v221, s71, -v1
 v_exp_f32 v210, v210
 v_exp_f32 v211, v211
 v_exp_f32 v212, v212
 v_exp_f32 v213, v213
 v_exp_f32 v214, v214
 v_exp_f32 v215, v215
 v_exp_f32 v216, v216
 v_exp_f32 v217, v217
 s_mov_b32 exec_lo, 0x00ff00ff
 s_mov_b32 exec_hi, 0x00ff00ff
 v_cvt_pk_bf16_f32 v162, v210, v211
 v_cvt_pk_bf16_f32 v163, v212, v213
 v_cvt_pk_bf16_f32 v164, v214, v215
 v_cvt_pk_bf16_f32 v165, v216, v217
 s_not_b64 exec, exec
 v_cvt_pk_bf16_f32 v166, v210, v211
 v_cvt_pk_bf16_f32 v167, v212, v213
 v_cvt_pk_bf16_f32 v168, v214, v215
 v_cvt_pk_bf16_f32 v169, v216, v217
 s_mov_b64 exec, -1
 v_mfma_f32_16x16x32_bf16 v[200:203], v[186:189], v[162:165], 0
 v_exp_f32 v218, v218
 v_exp_f32 v219, v219
 v_mfma_f32_16x16x32_bf16 v[192:195], v[142:145], v[162:165], 0
 v_exp_f32 v220, v220
 v_exp_f32 v221, v221
 v_mfma_f32_16x16x32_bf16 v[200:203], v[186:189], v[166:169], v[200:203]
 v_cvt_pk_bf16_f32 v190, v218, v219
 v_mfma_f32_16x16x32_bf16 v[192:195], v[150:153], v[166:169], v[192:195]
 v_cvt_pk_bf16_f32 v191, v220, v221
 s_nop 1
 v_mfma_f32_16x16x16_bf16 v[200:203], v[186:187], v[190:191], v[200:203]
 s_add_u32 s25, s60, s54
 s_add_u32 s27, s60, s55
 v_mfma_f32_16x16x16_bf16 v[192:195], v[178:179], v[190:191], v[192:195]
 s_add_u32 s28, s27, 4096
 s_mov_b32 s41, 0
 s_nop 2
 v_rcp_f32 v127, v200
 s_nop 1
 v_mul_f32 v192, v192, v127
 v_mul_f32 v193, v193, v127
 v_mul_f32 v194, v194, v127
 v_mul_f32 v195, v195, v127
 v_cvt_pk_bf16_f32 v204, v192, v193
 v_cvt_pk_bf16_f32 v205, v194, v195
 buffer_store_dwordx2 v[204:205], v2, s[4:7], s25 offen sc1
 ds_write_b64 v117, v[178:179] offset:1536
 s_sleep 4
 buffer_load_dwordx4 v[190:193], v2, s[4:7], s27 offen offset:0 sc1
 ds_read_b128 v[142:145], v114 offset:0
 ds_read_b128 v[146:149], v114 offset:1024
 s_nop 7
 buffer_load_dwordx4 v[194:197], v2, s[4:7], s27 offen offset:1024 sc1
 ds_read_b128 v[150:153], v114 offset:2048
 ds_read_b128 v[154:157], v114 offset:3072
 s_nop 7
 buffer_load_dwordx4 v[198:201], v2, s[4:7], s27 offen offset:2048 sc1
 ds_read_b128 v[234:237], v114 offset:4096
 ds_read_b128 v[238:241], v114 offset:5120
 s_nop 7
 buffer_load_dwordx4 v[202:205], v2, s[4:7], s27 offen offset:3072 sc1
 ds_read_b128 v[242:245], v114 offset:6144
 ds_read_b128 v[246:249], v114 offset:7168
 s_nop 7
 buffer_load_dwordx4 v[206:209], v2, s[4:7], s28 offen offset:0 sc1
 s_nop 7
 buffer_load_dwordx4 v[210:213], v2, s[4:7], s28 offen offset:1024 sc1
 s_waitcnt lgkmcnt(0)
Lo_289:
 s_waitcnt vmcnt(5)
 v_max3_u32 v1, v190, v191, v192
 v_max_u32 v1, v1, v193
 v_cmp_eq_u32 vcc, -1, v1
 s_cbranch_vccnz Los_290
 v_mfma_f32_16x16x32_bf16 v[214:217], v[142:145], v[190:193], 0
 ds_read_b128 v[142:145], v114 offset:8192
 v_mfma_f32_16x16x32_bf16 v[218:221], v[146:149], v[190:193], 0
 ds_read_b128 v[146:149], v114 offset:9216
 s_waitcnt vmcnt(4)
 v_max3_u32 v1, v194, v195, v196
 v_mfma_f32_16x16x32_bf16 v[222:225], v[150:153], v[190:193], 0
 ds_read_b128 v[150:153], v114 offset:10240
 v_max_u32 v1, v1, v197
 v_mfma_f32_16x16x32_bf16 v[226:229], v[154:157], v[190:193], 0
 ds_read_b128 v[154:157], v114 offset:11264
 v_cmp_eq_u32 vcc, -1, v1
 v_mfma_f32_16x16x32_bf16 v[230:233], v[234:237], v[190:193], 0
 ds_read_b128 v[234:237], v114 offset:12288
Lo_291:
 s_cbranch_vccnz Los_292
 v_mfma_f32_16x16x32_bf16 v[214:217], v[238:241], v[194:197], v[214:217]
 ds_read_b128 v[238:241], v114 offset:13312
 v_mfma_f32_16x16x32_bf16 v[218:221], v[242:245], v[194:197], v[218:221]
 ds_read_b128 v[242:245], v114 offset:14336
 s_waitcnt vmcnt(3)
 v_max3_u32 v1, v198, v199, v200
 v_mfma_f32_16x16x32_bf16 v[222:225], v[246:249], v[194:197], v[222:225]
 ds_read_b128 v[246:249], v115 offset:0
 v_max_u32 v1, v1, v201
 s_waitcnt lgkmcnt(6)
 v_mfma_f32_16x16x32_bf16 v[226:229], v[142:145], v[194:197], v[226:229]
 ds_read_b128 v[142:145], v115 offset:1024
 v_cmp_eq_u32 vcc, -1, v1
 v_mfma_f32_16x16x32_bf16 v[230:233], v[146:149], v[194:197], v[230:233]
 ds_read_b128 v[146:149], v115 offset:2048
Lo_293:
 s_cbranch_vccnz Los_294
 s_waitcnt lgkmcnt(6)
 v_mfma_f32_16x16x32_bf16 v[214:217], v[150:153], v[198:201], v[214:217]
 ds_read_b128 v[150:153], v115 offset:3072
 v_mfma_f32_16x16x32_bf16 v[218:221], v[154:157], v[198:201], v[218:221]
 ds_read_b128 v[154:157], v115 offset:4096
 s_waitcnt vmcnt(2)
 v_max3_u32 v1, v202, v203, v204
 s_waitcnt lgkmcnt(6)
 v_mfma_f32_16x16x32_bf16 v[222:225], v[234:237], v[198:201], v[222:225]
 ds_read_b128 v[234:237], v115 offset:5120
 v_max_u32 v1, v1, v205
 v_mfma_f32_16x16x32_bf16 v[226:229], v[238:241], v[198:201], v[226:229]
 ds_read_b128 v[238:241], v115 offset:6144
 v_cmp_eq_u32 vcc, -1, v1
 s_waitcnt lgkmcnt(6)
 v_mfma_f32_16x16x32_bf16 v[230:233], v[242:245], v[198:201], v[230:233]
 ds_read_b128 v[242:245], v115 offset:7168
Lo_295:
 s_cbranch_vccnz Los_296
 v_mfma_f32_16x16x32_bf16 v[214:217], v[246:249], v[202:205], v[214:217]
 ds_read_b128 v[246:249], v115 offset:8192
 s_waitcnt lgkmcnt(6)
 v_mfma_f32_16x16x32_bf16 v[218:221], v[142:145], v[202:205], v[218:221]
 ds_read_b128 v[142:145], v115 offset:9216
 s_waitcnt vmcnt(1)
 v_max3_u32 v1, v206, v207, v208
 v_mfma_f32_16x16x32_bf16 v[222:225], v[146:149], v[202:205], v[222:225]
 ds_read_b128 v[146:149], v115 offset:10240
 v_max_u32 v1, v1, v209
 s_waitcnt lgkmcnt(6)
 v_mfma_f32_16x16x32_bf16 v[226:229], v[150:153], v[202:205], v[226:229]
 ds_read_b128 v[150:153], v115 offset:11264
 v_cmp_eq_u32 vcc, -1, v1
 v_mfma_f32_16x16x32_bf16 v[230:233], v[154:157], v[202:205], v[230:233]
 ds_read_b128 v[154:157], v115 offset:12288
Lo_297:
 s_cbranch_vccnz Los_298
 s_waitcnt lgkmcnt(6)
 v_mfma_f32_16x16x32_bf16 v[214:217], v[234:237], v[206:209], v[214:217]
 ds_read_b128 v[234:237], v115 offset:13312
 v_mfma_f32_16x16x32_bf16 v[218:221], v[238:241], v[206:209], v[218:221]
 ds_read_b128 v[238:241], v115 offset:14336
 s_waitcnt vmcnt(0)
 v_max3_u32 v1, v210, v211, v212
 s_waitcnt lgkmcnt(6)
 v_mfma_f32_16x16x32_bf16 v[222:225], v[242:245], v[206:209], v[222:225]
 v_max_u32 v1, v1, v213
 v_mfma_f32_16x16x32_bf16 v[226:229], v[246:249], v[206:209], v[226:229]
 v_cmp_eq_u32 vcc, -1, v1
 s_waitcnt lgkmcnt(4)
 v_mfma_f32_16x16x32_bf16 v[230:233], v[142:145], v[206:209], v[230:233]
Lo_299:
 s_cbranch_vccnz Los_300
 v_mfma_f32_16x16x32_bf16 v[214:217], v[146:149], v[210:213], v[214:217]
 buffer_load_dwordx4 v[130:133], v2, s[4:7], s66 offen sc1
 s_waitcnt lgkmcnt(2)
 v_mfma_f32_16x16x32_bf16 v[218:221], v[150:153], v[210:213], v[218:221]
 buffer_load_dwordx4 v[134:137], v2, s[4:7], s66 offen offset:2048 sc1
 v_mfma_f32_16x16x32_bf16 v[222:225], v[154:157], v[210:213], v[222:225]
 s_add_u32 s25, s66, 4096
 buffer_load_dwordx4 v[138:141], v2, s[4:7], s25 offen sc1
 s_waitcnt lgkmcnt(0)
 v_mfma_f32_16x16x32_bf16 v[226:229], v[234:237], v[210:213], v[226:229]
 v_mfma_f32_16x16x32_bf16 v[230:233], v[238:241], v[210:213], v[230:233]
 v_cvt_pk_bf16_f32 v190, v214, v215
 v_cvt_pk_bf16_f32 v191, v216, v217
 v_cvt_pk_bf16_f32 v192, v218, v219
 v_cvt_pk_bf16_f32 v193, v220, v221
 ds_write_b128 v118, v[190:193]
 v_cvt_pk_bf16_f32 v194, v222, v223
 v_cvt_pk_bf16_f32 v195, v224, v225
 v_cvt_pk_bf16_f32 v196, v226, v227
 v_cvt_pk_bf16_f32 v197, v228, v229
 ds_write_b128 v118, v[194:197] offset:4096
 v_cvt_pk_bf16_f32 v198, v230, v231
 v_cvt_pk_bf16_f32 v199, v232, v233
 ds_write_b64 v119, v[198:199] offset:8192
 s_add_u32 s25, s62, s46
 s_add_u32 s26, s25, 8192
 s_add_u32 s27, s25, 655360
 s_add_u32 s28, s26, 655360
 s_waitcnt lgkmcnt(0)
 s_barrier
 ds_read_b128 v[190:193], v3 offset:4096
 ds_read_b128 v[194:197], v3 offset:5120
 ds_read_b128 v[198:201], v3 offset:6144
 ds_read_b128 v[202:205], v3 offset:7168
 s_waitcnt lgkmcnt(3)
 v_mfma_f32_16x16x32_bf16 v[214:217], v[170:173], v[190:193], 0
 s_waitcnt lgkmcnt(2)
 v_mfma_f32_16x16x32_bf16 v[214:217], v[174:177], v[194:197], v[214:217]
 s_waitcnt lgkmcnt(1)
 v_mfma_f32_16x16x32_bf16 v[218:221], v[170:173], v[198:201], 0
 s_waitcnt lgkmcnt(0)
 v_mfma_f32_16x16x32_bf16 v[218:221], v[174:177], v[202:205], v[218:221]
 s_nop 1
 v_cvt_pk_bf16_f32 v226, v214, v215
 v_cvt_pk_bf16_f32 v227, v216, v217
 s_nop 3
 v_cvt_pk_bf16_f32 v228, v218, v219
 v_cvt_pk_bf16_f32 v229, v220, v221
 s_nop 0
 v_permlane16_swap_b32 v226, v228
 v_permlane16_swap_b32 v227, v229
 buffer_store_dwordx4 v[226:229], v120, s[4:7], s25 offen sc1
 buffer_store_dwordx4 v[226:229], v120, s[4:7], s27 offen sc1
 s_add_u32 s70, s69, s52
 ds_read_b128 v[190:193], v3 offset:23552
 ds_read_b128 v[194:197], v3 offset:24576
 ds_read_b128 v[198:201], v3 offset:25600
 ds_read_b64 v[202:203], v117 offset:0
 ds_read_b64 v[204:205], v117 offset:512
 ds_read_b64 v[206:207], v117 offset:1024
 ds_read_b64 v[208:209], v117 offset:1536
 ds_read_b64 v[210:211], v117 offset:2048
 ds_read_b64 v[212:213], v117 offset:2560
 s_sleep 10
 s_add_u32 s25, s70, 15728640
 s_waitcnt lgkmcnt(0)
 buffer_store_dwordx4 v[190:193], v2, s[4:7], s70 offen offset:0 sc1
 buffer_store_dwordx4 v[194:197], v2, s[4:7], s70 offen offset:1024 sc1
 buffer_store_dwordx4 v[198:201], v2, s[4:7], s70 offen offset:2048 sc1
 buffer_store_dwordx4 v[202:205], v2, s[4:7], s25 offen offset:0 sc1
 buffer_store_dwordx4 v[206:209], v2, s[4:7], s25 offen offset:1024 sc1
 buffer_store_dwordx4 v[210:213], v2, s[4:7], s25 offen offset:2048 sc1
 s_add_u32 s25, s31, 1
 s_mov_b64 exec, 1
 v_mov_b32 v190, s25
 s_waitcnt vmcnt(0)
 buffer_store_dword v190, off, s[4:7], s53 sc1
 s_mov_b64 exec, -1
 s_add_u32 s27, s62, s47
 s_add_u32 s28, s62, s48
 s_add_u32 s69, s31, 1
 s_and_b32 s25, s69, 3
 s_mul_i32 s26, s25, 20480
 s_add_u32 s56, s26, s42
 s_add_u32 s57, s56, 4096
 s_add_u32 s58, s26, s43
 s_mul_i32 s62, s25, 163840
 s_xor_b32 s26, s25, 2
 s_mul_i32 s63, s26, 163840
 s_add_u32 s25, s25, 3
 s_and_b32 s25, s25, 3
 s_mul_i32 s26, s25, 20480
 s_add_u32 s59, s26, s43
 s_and_b32 s25, s69, 1
 s_mul_i32 s60, s25, 196608
 s_xor_b32 s25, s25, 1
 s_mul_i32 s61, s25, 196608
 s_mul_i32 s69, s69, 196608
 s_add_u32 s31, s31, 1
 s_barrier
 s_branch L_rec_top_3r
Lfin_285:
 s_waitcnt lgkmcnt(0)
 s_nop 4
 v_cvt_pk_bf16_f32 v178, v226, v227
 v_cvt_pk_bf16_f32 v179, v228, v229
 ds_write_b64 v117, v[178:179] offset:1536
 s_waitcnt lgkmcnt(0)
 s_barrier
 s_waitcnt vmcnt(0)
 ds_read_b128 v[142:145], v3 offset:23552
 ds_read_b128 v[146:149], v3 offset:24576
 ds_read_b128 v[150:153], v3 offset:25600
 ds_read_b64 v[154:155], v117 offset:0
 ds_read_b64 v[156:157], v117 offset:512
 ds_read_b64 v[130:131], v117 offset:1024
 ds_read_b64 v[132:133], v117 offset:1536
 ds_read_b64 v[134:135], v117 offset:2048
 ds_read_b64 v[136:137], v117 offset:2560
 s_add_u32 s26, s69, s52
 s_add_u32 s25, s26, 15728640
 s_waitcnt lgkmcnt(0)
 buffer_store_dwordx4 v[142:145], v2, s[4:7], s26 offen offset:0 sc1
 buffer_store_dwordx4 v[146:149], v2, s[4:7], s26 offen offset:1024 sc1
 buffer_store_dwordx4 v[150:153], v2, s[4:7], s26 offen offset:2048 sc1
 buffer_store_dwordx4 v[154:157], v2, s[4:7], s25 offen offset:0 sc1
 buffer_store_dwordx4 v[130:133], v2, s[4:7], s25 offen offset:1024 sc1
 buffer_store_dwordx4 v[134:137], v2, s[4:7], s25 offen offset:2048 sc1
 s_mov_b64 exec, 1
 v_mov_b32 v1, 73
 s_waitcnt vmcnt(0)
 buffer_store_dword v1, off, s[4:7], s53 sc1
 s_mov_b64 exec, -1
 s_endpgm
Lzs_274:
 buffer_load_dwordx4 v[190:193], v2, s[4:7], s56 offen offset:0 sc1
 buffer_load_dwordx4 v[194:197], v2, s[4:7], s56 offen offset:1024 sc1
 buffer_load_dwordx4 v[198:201], v2, s[4:7], s56 offen offset:2048 sc1
 buffer_load_dwordx4 v[202:205], v2, s[4:7], s56 offen offset:3072 sc1
 buffer_load_dwordx4 v[206:209], v2, s[4:7], s57 offen offset:0 sc1
 s_add_u32 s41, s41, 1
 s_cmp_gt_u32 s41, 200000
 s_cbranch_scc1 L_fail
 s_branch Lz_273
Lzs_276:
 buffer_load_dwordx4 v[194:197], v2, s[4:7], s56 offen offset:1024 sc1
 buffer_load_dwordx4 v[198:201], v2, s[4:7], s56 offen offset:2048 sc1
 buffer_load_dwordx4 v[202:205], v2, s[4:7], s56 offen offset:3072 sc1
 buffer_load_dwordx4 v[206:209], v2, s[4:7], s57 offen offset:0 sc1
 s_add_u32 s41, s41, 1
 s_cmp_gt_u32 s41, 200000
 s_cbranch_scc1 L_fail
 s_branch Lz_275
Lzs_278:
 buffer_load_dwordx4 v[198:201], v2, s[4:7], s56 offen offset:2048 sc1
 buffer_load_dwordx4 v[202:205], v2, s[4:7], s56 offen offset:3072 sc1
 buffer_load_dwordx4 v[206:209], v2, s[4:7], s57 offen offset:0 sc1
 s_add_u32 s41, s41, 1
 s_cmp_gt_u32 s41, 200000
 s_cbranch_scc1 L_fail
 s_branch Lz_277
Lzs_280:
 buffer_load_dwordx4 v[202:205], v2, s[4:7], s56 offen offset:3072 sc1
 buffer_load_dwordx4 v[206:209], v2, s[4:7], s57 offen offset:0 sc1
 s_add_u32 s41, s41, 1
 s_cmp_gt_u32 s41, 200000
 s_cbranch_scc1 L_fail
 s_branch Lz_279
Lzs_282:
 buffer_load_dwordx4 v[206:209], v2, s[4:7], s57 offen offset:0 sc1
 s_add_u32 s41, s41, 1
 s_cmp_gt_u32 s41, 200000
 s_cbranch_scc1 L_fail
 s_branch Lz_281
Lfs_287:
 v_max3_u32 v222, v194, v195, v196
 v_max3_u32 v222, v222, v197, v198
 v_max3_u32 v222, v222, v199, v200
 v_max3_u32 v222, v222, v201, v202
 v_max3_u32 v222, v222, v203, v204
 v_max_u32 v222, v222, v205
 v_cmp_eq_u32 vcc, -1, v222
 s_cbranch_vccz Lfok_288
 buffer_load_dwordx4 v[194:197], v2, s[4:7], s27 offen offset:0 sc1
 buffer_load_dwordx4 v[198:201], v2, s[4:7], s27 offen offset:1024 sc1
 buffer_load_dwordx4 v[202:205], v2, s[4:7], s27 offen offset:2048 sc1
 s_add_u32 s41, s41, 1
 s_cmp_gt_u32 s41, 200000
 s_cbranch_scc1 L_fail
 s_branch Lf_286
Los_290:
 buffer_load_dwordx4 v[190:193], v2, s[4:7], s27 offen offset:0 sc1
 buffer_load_dwordx4 v[194:197], v2, s[4:7], s27 offen offset:1024 sc1
 buffer_load_dwordx4 v[198:201], v2, s[4:7], s27 offen offset:2048 sc1
 buffer_load_dwordx4 v[202:205], v2, s[4:7], s27 offen offset:3072 sc1
 buffer_load_dwordx4 v[206:209], v2, s[4:7], s28 offen offset:0 sc1
 buffer_load_dwordx4 v[210:213], v2, s[4:7], s28 offen offset:1024 sc1
 s_add_u32 s41, s41, 1
 s_cmp_gt_u32 s41, 200000
 s_cbranch_scc1 L_fail
 s_branch Lo_289
Los_292:
 buffer_load_dwordx4 v[194:197], v2, s[4:7], s27 offen offset:1024 sc1
 buffer_load_dwordx4 v[198:201], v2, s[4:7], s27 offen offset:2048 sc1
 buffer_load_dwordx4 v[202:205], v2, s[4:7], s27 offen offset:3072 sc1
 buffer_load_dwordx4 v[206:209], v2, s[4:7], s28 offen offset:0 sc1
 buffer_load_dwordx4 v[210:213], v2, s[4:7], s28 offen offset:1024 sc1
 s_waitcnt vmcnt(4)
 v_max3_u32 v1, v194, v195, v196
 v_max_u32 v1, v1, v197
 v_cmp_eq_u32 vcc, -1, v1
 s_add_u32 s41, s41, 1
 s_cmp_gt_u32 s41, 200000
 s_cbranch_scc1 L_fail
 s_branch Lo_291
Los_294:
 buffer_load_dwordx4 v[198:201], v2, s[4:7], s27 offen offset:2048 sc1
 buffer_load_dwordx4 v[202:205], v2, s[4:7], s27 offen offset:3072 sc1
 buffer_load_dwordx4 v[206:209], v2, s[4:7], s28 offen offset:0 sc1
 buffer_load_dwordx4 v[210:213], v2, s[4:7], s28 offen offset:1024 sc1
 s_waitcnt vmcnt(3)
 v_max3_u32 v1, v198, v199, v200
 v_max_u32 v1, v1, v201
 v_cmp_eq_u32 vcc, -1, v1
 s_add_u32 s41, s41, 1
 s_cmp_gt_u32 s41, 200000
 s_cbranch_scc1 L_fail
 s_branch Lo_293
Los_296:
 buffer_load_dwordx4 v[202:205], v2, s[4:7], s27 offen offset:3072 sc1
 buffer_load_dwordx4 v[206:209], v2, s[4:7], s28 offen offset:0 sc1
 buffer_load_dwordx4 v[210:213], v2, s[4:7], s28 offen offset:1024 sc1
 s_waitcnt vmcnt(2)
 v_max3_u32 v1, v202, v203, v204
 v_max_u32 v1, v1, v205
 v_cmp_eq_u32 vcc, -1, v1
 s_add_u32 s41, s41, 1
 s_cmp_gt_u32 s41, 200000
 s_cbranch_scc1 L_fail
 s_branch Lo_295
Los_298:
 buffer_load_dwordx4 v[206:209], v2, s[4:7], s28 offen offset:0 sc1
 buffer_load_dwordx4 v[210:213], v2, s[4:7], s28 offen offset:1024 sc1
 s_waitcnt vmcnt(1)
 v_max3_u32 v1, v206, v207, v208
 v_max_u32 v1, v1, v209
 v_cmp_eq_u32 vcc, -1, v1
 s_add_u32 s41, s41, 1
 s_cmp_gt_u32 s41, 200000
 s_cbranch_scc1 L_fail
 s_branch Lo_297
Los_300:
 buffer_load_dwordx4 v[210:213], v2, s[4:7], s28 offen offset:1024 sc1
 s_waitcnt vmcnt(0)
 v_max3_u32 v1, v210, v211, v212
 v_max_u32 v1, v1, v213
 v_cmp_eq_u32 vcc, -1, v1
 s_add_u32 s41, s41, 1
 s_cmp_gt_u32 s41, 200000
 s_cbranch_scc1 L_fail
 s_branch Lo_299
L_role_qkv:
 s_sub_u32 s12, s12, 64
 v_and_b32 v1, 63, v0
 v_lshlrev_b32 v2, 4, v1
 s_load_dwordx4 s[32:35], s[0:1], 16
 s_load_dwordx2 s[36:37], s[0:1], 32
 s_cmp_ge_u32 s12, 24
 s_cselect_b32 s25, 1, 0
 s_cmp_ge_u32 s12, 48
 s_cselect_b32 s25, 2, s25
 s_mul_i32 s19, s25, 24
 s_sub_u32 s26, s12, s19
 s_lshl_b32 s26, s26, 2
 s_add_u32 s26, s26, s3
 s_waitcnt lgkmcnt(0)
 s_cmp_eq_u32 s25, 1
 s_cselect_b32 s32, s34, s32
 s_cselect_b32 s33, s35, s33
 s_cmp_eq_u32 s25, 2
 s_cselect_b32 s32, s36, s32
 s_cselect_b32 s33, s37, s33
 s_lshl_b32 s23, s26, 7
 s_mov_b32 s28, s32
 s_mov_b32 s29, s33
 s_mov_b32 s30, 7864320
 s_mov_b32 s31, 0x20000
 v_lshrrev_b32 v68, 3, v1
 v_mul_u32_u24 v68, 12288, v68
 v_and_b32 v3, 7, v1
 v_lshl_add_u32 v68, v3, 4, v68
 v_lshrrev_b32 v69, 4, v1
 v_lshlrev_b32 v69, 3, v69
 v_bfe_u32 v3, v1, 2, 2
 v_add_u32 v69, v69, v3
 v_mul_u32_u24 v69, 128, v69
 v_and_b32 v3, 3, v1
 v_lshl_add_u32 v69, v3, 3, v69
 s_mul_i32 s19, s3, 40960
 s_add_u32 s19, s19, 0
 v_add_u32 v69, s19, v69
 s_mul_i32 s19, s3, 40960
 s_add_u32 m0, s19, 0
 s_add_u32 s20, s23, 0
 buffer_load_dwordx4 v68, s[28:31], s20 offen lds
 s_add_u32 m0, s19, 1024
 s_add_u32 s20, s23, 98304
 buffer_load_dwordx4 v68, s[28:31], s20 offen lds
 s_add_u32 m0, s19, 2048
 s_add_u32 s20, s23, 196608
 buffer_load_dwordx4 v68, s[28:31], s20 offen lds
 s_add_u32 m0, s19, 3072
 s_add_u32 s20, s23, 294912
 buffer_load_dwordx4 v68, s[28:31], s20 offen lds
 s_add_u32 m0, s19, 4096
 s_add_u32 s20, s23, 393216
 buffer_load_dwordx4 v68, s[28:31], s20 offen lds
 s_add_u32 m0, s19, 5120
 s_add_u32 s20, s23, 491520
 buffer_load_dwordx4 v68, s[28:31], s20 offen lds
 s_add_u32 m0, s19, 6144
 s_add_u32 s20, s23, 589824
 buffer_load_dwordx4 v68, s[28:31], s20 offen lds
 s_add_u32 m0, s19, 7168
 s_add_u32 s20, s23, 688128
 buffer_load_dwordx4 v68, s[28:31], s20 offen lds
 s_add_u32 m0, s19, 8192
 s_add_u32 s20, s23, 786432
 buffer_load_dwordx4 v68, s[28:31], s20 offen lds
 s_add_u32 m0, s19, 9216
 s_add_u32 s20, s23, 884736
 buffer_load_dwordx4 v68, s[28:31], s20 offen lds
 s_add_u32 m0, s19, 10240
 s_add_u32 s20, s23, 983040
 buffer_load_dwordx4 v68, s[28:31], s20 offen lds
 s_add_u32 m0, s19, 11264
 s_add_u32 s20, s23, 1081344
 buffer_load_dwordx4 v68, s[28:31], s20 offen lds
 s_add_u32 m0, s19, 12288
 s_add_u32 s20, s23, 1179648
 buffer_load_dwordx4 v68, s[28:31], s20 offen lds
 s_add_u32 m0, s19, 13312
 s_add_u32 s20, s23, 1277952
 buffer_load_dwordx4 v68, s[28:31], s20 offen lds
 s_add_u32 m0, s19, 14336
 s_add_u32 s20, s23, 1376256
 buffer_load_dwordx4 v68, s[28:31], s20 offen lds
 s_add_u32 m0, s19, 15360
 s_add_u32 s20, s23, 1474560
 buffer_load_dwordx4 v68, s[28:31], s20 offen lds
 s_add_u32 m0, s19, 16384
 s_add_u32 s20, s23, 1572864
 buffer_load_dwordx4 v68, s[28:31], s20 offen lds
 s_add_u32 m0, s19, 17408
 s_add_u32 s20, s23, 1671168
 buffer_load_dwordx4 v68, s[28:31], s20 offen lds
 s_add_u32 m0, s19, 18432
 s_add_u32 s20, s23, 1769472
 buffer_load_dwordx4 v68, s[28:31], s20 offen lds
 s_add_u32 m0, s19, 19456
 s_add_u32 s20, s23, 1867776
 buffer_load_dwordx4 v68, s[28:31], s20 offen lds
 s_mul_i32 s19, s3, 40960
 s_add_u32 m0, s19, 20480
 s_add_u32 s20, s23, 1966080
 buffer_load_dwordx4 v68, s[28:31], s20 offen lds
 s_add_u32 m0, s19, 21504
 s_add_u32 s20, s23, 2064384
 buffer_load_dwordx4 v68, s[28:31], s20 offen lds
 s_add_u32 m0, s19, 22528
 s_add_u32 s20, s23, 2162688
 buffer_load_dwordx4 v68, s[28:31], s20 offen lds
 s_add_u32 m0, s19, 23552
 s_add_u32 s20, s23, 2260992
 buffer_load_dwordx4 v68, s[28:31], s20 offen lds
 s_add_u32 m0, s19, 24576
 s_add_u32 s20, s23, 2359296
 buffer_load_dwordx4 v68, s[28:31], s20 offen lds
 s_add_u32 m0, s19, 25600
 s_add_u32 s20, s23, 2457600
 buffer_load_dwordx4 v68, s[28:31], s20 offen lds
 s_add_u32 m0, s19, 26624
 s_add_u32 s20, s23, 2555904
 buffer_load_dwordx4 v68, s[28:31], s20 offen lds
 s_add_u32 m0, s19, 27648
 s_add_u32 s20, s23, 2654208
 buffer_load_dwordx4 v68, s[28:31], s20 offen lds
 s_add_u32 m0, s19, 28672
 s_add_u32 s20, s23, 2752512
 buffer_load_dwordx4 v68, s[28:31], s20 offen lds
 s_add_u32 m0, s19, 29696
 s_add_u32 s20, s23, 2850816
 buffer_load_dwordx4 v68, s[28:31], s20 offen lds
 s_add_u32 m0, s19, 30720
 s_add_u32 s20, s23, 2949120
 buffer_load_dwordx4 v68, s[28:31], s20 offen lds
 s_add_u32 m0, s19, 31744
 s_add_u32 s20, s23, 3047424
 buffer_load_dwordx4 v68, s[28:31], s20 offen lds
 s_add_u32 m0, s19, 32768
 s_add_u32 s20, s23, 3145728
 buffer_load_dwordx4 v68, s[28:31], s20 offen lds
 s_add_u32 m0, s19, 33792
 s_add_u32 s20, s23, 3244032
 buffer_load_dwordx4 v68, s[28:31], s20 offen lds
 s_add_u32 m0, s19, 34816
 s_add_u32 s20, s23, 3342336
 buffer_load_dwordx4 v68, s[28:31], s20 offen lds
 s_add_u32 m0, s19, 35840
 s_add_u32 s20, s23, 3440640
 buffer_load_dwordx4 v68, s[28:31], s20 offen lds
 s_add_u32 m0, s19, 36864
 s_add_u32 s20, s23, 3538944
 buffer_load_dwordx4 v68, s[28:31], s20 offen lds
 s_add_u32 m0, s19, 37888
 s_add_u32 s20, s23, 3637248
 buffer_load_dwordx4 v68, s[28:31], s20 offen lds
 s_add_u32 m0, s19, 38912
 s_add_u32 s20, s23, 3735552
 buffer_load_dwordx4 v68, s[28:31], s20 offen lds
 s_add_u32 m0, s19, 39936
 s_add_u32 s20, s23, 3833856
 buffer_load_dwordx4 v68, s[28:31], s20 offen lds
 s_waitcnt vmcnt(20)
 ds_read_b64_tr_b16 a[0:1], v69 offset:0
 ds_read_b64_tr_b16 a[2:3], v69 offset:512
 ds_read_b64_tr_b16 a[80:81], v69 offset:32
 ds_read_b64_tr_b16 a[82:83], v69 offset:544
 ds_read_b64_tr_b16 a[160:161], v69 offset:64
 ds_read_b64_tr_b16 a[162:163], v69 offset:576
 ds_read_b64_tr_b16 a[240:241], v69 offset:96
 ds_read_b64_tr_b16 a[242:243], v69 offset:608
 ds_read_b64_tr_b16 a[4:5], v69 offset:4096
 ds_read_b64_tr_b16 a[6:7], v69 offset:4608
 ds_read_b64_tr_b16 a[84:85], v69 offset:4128
 ds_read_b64_tr_b16 a[86:87], v69 offset:4640
 ds_read_b64_tr_b16 a[164:165], v69 offset:4160
 ds_read_b64_tr_b16 a[166:167], v69 offset:4672
 ds_read_b64_tr_b16 a[244:245], v69 offset:4192
 ds_read_b64_tr_b16 a[246:247], v69 offset:4704
 ds_read_b64_tr_b16 a[8:9], v69 offset:8192
 ds_read_b64_tr_b16 a[10:11], v69 offset:8704
 ds_read_b64_tr_b16 a[88:89], v69 offset:8224
 ds_read_b64_tr_b16 a[90:91], v69 offset:8736
 ds_read_b64_tr_b16 a[168:169], v69 offset:8256
 ds_read_b64_tr_b16 a[170:171], v69 offset:8768
 ds_read_b64_tr_b16 a[248:249], v69 offset:8288
 ds_read_b64_tr_b16 a[250:251], v69 offset:8800
 ds_read_b64_tr_b16 a[12:13], v69 offset:12288
 ds_read_b64_tr_b16 a[14:15], v69 offset:12800
 ds_read_b64_tr_b16 a[92:93], v69 offset:12320
 ds_read_b64_tr_b16 a[94:95], v69 offset:12832
 ds_read_b64_tr_b16 a[172:173], v69 offset:12352
 ds_read_b64_tr_b16 a[174:175], v69 offset:12864
 ds_read_b64_tr_b16 a[252:253], v69 offset:12384
 ds_read_b64_tr_b16 a[254:255], v69 offset:12896
 ds_read_b64_tr_b16 a[16:17], v69 offset:16384
 ds_read_b64_tr_b16 a[18:19], v69 offset:16896
 ds_read_b64_tr_b16 a[96:97], v69 offset:16416
 ds_read_b64_tr_b16 a[98:99], v69 offset:16928
 ds_read_b64_tr_b16 a[176:177], v69 offset:16448
 ds_read_b64_tr_b16 a[178:179], v69 offset:16960
 ds_read_b64_tr_b16 v[4:5], v69 offset:16480
 ds_read_b64_tr_b16 v[6:7], v69 offset:16992
 s_waitcnt lgkmcnt(0)
 s_mul_i32 s19, s3, 40960
 s_add_u32 m0, s19, 0
 s_add_u32 s20, s23, 3932160
 buffer_load_dwordx4 v68, s[28:31], s20 offen lds
 s_add_u32 m0, s19, 1024
 s_add_u32 s20, s23, 4030464
 buffer_load_dwordx4 v68, s[28:31], s20 offen lds
 s_add_u32 m0, s19, 2048
 s_add_u32 s20, s23, 4128768
 buffer_load_dwordx4 v68, s[28:31], s20 offen lds
 s_add_u32 m0, s19, 3072
 s_add_u32 s20, s23, 4227072
 buffer_load_dwordx4 v68, s[28:31], s20 offen lds
 s_add_u32 m0, s19, 4096
 s_add_u32 s20, s23, 4325376
 buffer_load_dwordx4 v68, s[28:31], s20 offen lds
 s_add_u32 m0, s19, 5120
 s_add_u32 s20, s23, 4423680
 buffer_load_dwordx4 v68, s[28:31], s20 offen lds
 s_add_u32 m0, s19, 6144
 s_add_u32 s20, s23, 4521984
 buffer_load_dwordx4 v68, s[28:31], s20 offen lds
 s_add_u32 m0, s19, 7168
 s_add_u32 s20, s23, 4620288
 buffer_load_dwordx4 v68, s[28:31], s20 offen lds
 s_add_u32 m0, s19, 8192
 s_add_u32 s20, s23, 4718592
 buffer_load_dwordx4 v68, s[28:31], s20 offen lds
 s_add_u32 m0, s19, 9216
 s_add_u32 s20, s23, 4816896
 buffer_load_dwordx4 v68, s[28:31], s20 offen lds
 s_add_u32 m0, s19, 10240
 s_add_u32 s20, s23, 4915200
 buffer_load_dwordx4 v68, s[28:31], s20 offen lds
 s_add_u32 m0, s19, 11264
 s_add_u32 s20, s23, 5013504
 buffer_load_dwordx4 v68, s[28:31], s20 offen lds
 s_add_u32 m0, s19, 12288
 s_add_u32 s20, s23, 5111808
 buffer_load_dwordx4 v68, s[28:31], s20 offen lds
 s_add_u32 m0, s19, 13312
 s_add_u32 s20, s23, 5210112
 buffer_load_dwordx4 v68, s[28:31], s20 offen lds
 s_add_u32 m0, s19, 14336
 s_add_u32 s20, s23, 5308416
 buffer_load_dwordx4 v68, s[28:31], s20 offen lds
 s_add_u32 m0, s19, 15360
 s_add_u32 s20, s23, 5406720
 buffer_load_dwordx4 v68, s[28:31], s20 offen lds
 s_add_u32 m0, s19, 16384
 s_add_u32 s20, s23, 5505024
 buffer_load_dwordx4 v68, s[28:31], s20 offen lds
 s_add_u32 m0, s19, 17408
 s_add_u32 s20, s23, 5603328
 buffer_load_dwordx4 v68, s[28:31], s20 offen lds
 s_add_u32 m0, s19, 18432
 s_add_u32 s20, s23, 5701632
 buffer_load_dwordx4 v68, s[28:31], s20 offen lds
 s_add_u32 m0, s19, 19456
 s_add_u32 s20, s23, 5799936
 buffer_load_dwordx4 v68, s[28:31], s20 offen lds
 s_waitcnt vmcnt(20)
 ds_read_b64_tr_b16 a[20:21], v69 offset:20480
 ds_read_b64_tr_b16 a[22:23], v69 offset:20992
 ds_read_b64_tr_b16 a[100:101], v69 offset:20512
 ds_read_b64_tr_b16 a[102:103], v69 offset:21024
 ds_read_b64_tr_b16 a[180:181], v69 offset:20544
 ds_read_b64_tr_b16 a[182:183], v69 offset:21056
 ds_read_b64_tr_b16 v[8:9], v69 offset:20576
 ds_read_b64_tr_b16 v[10:11], v69 offset:21088
 ds_read_b64_tr_b16 a[24:25], v69 offset:24576
 ds_read_b64_tr_b16 a[26:27], v69 offset:25088
 ds_read_b64_tr_b16 a[104:105], v69 offset:24608
 ds_read_b64_tr_b16 a[106:107], v69 offset:25120
 ds_read_b64_tr_b16 a[184:185], v69 offset:24640
 ds_read_b64_tr_b16 a[186:187], v69 offset:25152
 ds_read_b64_tr_b16 v[12:13], v69 offset:24672
 ds_read_b64_tr_b16 v[14:15], v69 offset:25184
 ds_read_b64_tr_b16 a[28:29], v69 offset:28672
 ds_read_b64_tr_b16 a[30:31], v69 offset:29184
 ds_read_b64_tr_b16 a[108:109], v69 offset:28704
 ds_read_b64_tr_b16 a[110:111], v69 offset:29216
 ds_read_b64_tr_b16 a[188:189], v69 offset:28736
 ds_read_b64_tr_b16 a[190:191], v69 offset:29248
 ds_read_b64_tr_b16 v[16:17], v69 offset:28768
 ds_read_b64_tr_b16 v[18:19], v69 offset:29280
 ds_read_b64_tr_b16 a[32:33], v69 offset:32768
 ds_read_b64_tr_b16 a[34:35], v69 offset:33280
 ds_read_b64_tr_b16 a[112:113], v69 offset:32800
 ds_read_b64_tr_b16 a[114:115], v69 offset:33312
 ds_read_b64_tr_b16 a[192:193], v69 offset:32832
 ds_read_b64_tr_b16 a[194:195], v69 offset:33344
 ds_read_b64_tr_b16 v[20:21], v69 offset:32864
 ds_read_b64_tr_b16 v[22:23], v69 offset:33376
 ds_read_b64_tr_b16 a[36:37], v69 offset:36864
 ds_read_b64_tr_b16 a[38:39], v69 offset:37376
 ds_read_b64_tr_b16 a[116:117], v69 offset:36896
 ds_read_b64_tr_b16 a[118:119], v69 offset:37408
 ds_read_b64_tr_b16 a[196:197], v69 offset:36928
 ds_read_b64_tr_b16 a[198:199], v69 offset:37440
 ds_read_b64_tr_b16 v[24:25], v69 offset:36960
 ds_read_b64_tr_b16 v[26:27], v69 offset:37472
 s_waitcnt lgkmcnt(0)
 s_mul_i32 s19, s3, 40960
 s_add_u32 m0, s19, 20480
 s_add_u32 s20, s23, 5898240
 buffer_load_dwordx4 v68, s[28:31], s20 offen lds
 s_add_u32 m0, s19, 21504
 s_add_u32 s20, s23, 5996544
 buffer_load_dwordx4 v68, s[28:31], s20 offen lds
 s_add_u32 m0, s19, 22528
 s_add_u32 s20, s23, 6094848
 buffer_load_dwordx4 v68, s[28:31], s20 offen lds
 s_add_u32 m0, s19, 23552
 s_add_u32 s20, s23, 6193152
 buffer_load_dwordx4 v68, s[28:31], s20 offen lds
 s_add_u32 m0, s19, 24576
 s_add_u32 s20, s23, 6291456
 buffer_load_dwordx4 v68, s[28:31], s20 offen lds
 s_add_u32 m0, s19, 25600
 s_add_u32 s20, s23, 6389760
 buffer_load_dwordx4 v68, s[28:31], s20 offen lds
 s_add_u32 m0, s19, 26624
 s_add_u32 s20, s23, 6488064
 buffer_load_dwordx4 v68, s[28:31], s20 offen lds
 s_add_u32 m0, s19, 27648
 s_add_u32 s20, s23, 6586368
 buffer_load_dwordx4 v68, s[28:31], s20 offen lds
 s_add_u32 m0, s19, 28672
 s_add_u32 s20, s23, 6684672
 buffer_load_dwordx4 v68, s[28:31], s20 offen lds
 s_add_u32 m0, s19, 29696
 s_add_u32 s20, s23, 6782976
 buffer_load_dwordx4 v68, s[28:31], s20 offen lds
 s_add_u32 m0, s19, 30720
 s_add_u32 s20, s23, 6881280
 buffer_load_dwordx4 v68, s[28:31], s20 offen lds
 s_add_u32 m0, s19, 31744
 s_add_u32 s20, s23, 6979584
 buffer_load_dwordx4 v68, s[28:31], s20 offen lds
 s_add_u32 m0, s19, 32768
 s_add_u32 s20, s23, 7077888
 buffer_load_dwordx4 v68, s[28:31], s20 offen lds
 s_add_u32 m0, s19, 33792
 s_add_u32 s20, s23, 7176192
 buffer_load_dwordx4 v68, s[28:31], s20 offen lds
 s_add_u32 m0, s19, 34816
 s_add_u32 s20, s23, 7274496
 buffer_load_dwordx4 v68, s[28:31], s20 offen lds
 s_add_u32 m0, s19, 35840
 s_add_u32 s20, s23, 7372800
 buffer_load_dwordx4 v68, s[28:31], s20 offen lds
 s_add_u32 m0, s19, 36864
 s_add_u32 s20, s23, 7471104
 buffer_load_dwordx4 v68, s[28:31], s20 offen lds
 s_add_u32 m0, s19, 37888
 s_add_u32 s20, s23, 7569408
 buffer_load_dwordx4 v68, s[28:31], s20 offen lds
 s_add_u32 m0, s19, 38912
 s_add_u32 s20, s23, 7667712
 buffer_load_dwordx4 v68, s[28:31], s20 offen lds
 s_add_u32 m0, s19, 39936
 s_add_u32 s20, s23, 7766016
 buffer_load_dwordx4 v68, s[28:31], s20 offen lds
 s_waitcnt vmcnt(20)
 ds_read_b64_tr_b16 a[40:41], v69 offset:0
 ds_read_b64_tr_b16 a[42:43], v69 offset:512
 ds_read_b64_tr_b16 a[120:121], v69 offset:32
 ds_read_b64_tr_b16 a[122:123], v69 offset:544
 ds_read_b64_tr_b16 a[200:201], v69 offset:64
 ds_read_b64_tr_b16 a[202:203], v69 offset:576
 ds_read_b64_tr_b16 v[28:29], v69 offset:96
 ds_read_b64_tr_b16 v[30:31], v69 offset:608
 ds_read_b64_tr_b16 a[44:45], v69 offset:4096
 ds_read_b64_tr_b16 a[46:47], v69 offset:4608
 ds_read_b64_tr_b16 a[124:125], v69 offset:4128
 ds_read_b64_tr_b16 a[126:127], v69 offset:4640
 ds_read_b64_tr_b16 a[204:205], v69 offset:4160
 ds_read_b64_tr_b16 a[206:207], v69 offset:4672
 ds_read_b64_tr_b16 v[32:33], v69 offset:4192
 ds_read_b64_tr_b16 v[34:35], v69 offset:4704
 ds_read_b64_tr_b16 a[48:49], v69 offset:8192
 ds_read_b64_tr_b16 a[50:51], v69 offset:8704
 ds_read_b64_tr_b16 a[128:129], v69 offset:8224
 ds_read_b64_tr_b16 a[130:131], v69 offset:8736
 ds_read_b64_tr_b16 a[208:209], v69 offset:8256
 ds_read_b64_tr_b16 a[210:211], v69 offset:8768
 ds_read_b64_tr_b16 v[36:37], v69 offset:8288
 ds_read_b64_tr_b16 v[38:39], v69 offset:8800
 ds_read_b64_tr_b16 a[52:53], v69 offset:12288
 ds_read_b64_tr_b16 a[54:55], v69 offset:12800
 ds_read_b64_tr_b16 a[132:133], v69 offset:12320
 ds_read_b64_tr_b16 a[134:135], v69 offset:12832
 ds_read_b64_tr_b16 a[212:213], v69 offset:12352
 ds_read_b64_tr_b16 a[214:215], v69 offset:12864
 ds_read_b64_tr_b16 v[40:41], v69 offset:12384
 ds_read_b64_tr_b16 v[42:43], v69 offset:12896
 ds_read_b64_tr_b16 a[56:57], v69 offset:16384
 ds_read_b64_tr_b16 a[58:59], v69 offset:16896
 ds_read_b64_tr_b16 a[136:137], v69 offset:16416
 ds_read_b64_tr_b16 a[138:139], v69 offset:16928
 ds_read_b64_tr_b16 a[216:217], v69 offset:16448
 ds_read_b64_tr_b16 a[218:219], v69 offset:16960
 ds_read_b64_tr_b16 v[44:45], v69 offset:16480
 ds_read_b64_tr_b16 v[46:47], v69 offset:16992
 s_waitcnt lgkmcnt(0)
 s_waitcnt vmcnt(0)
 ds_read_b64_tr_b16 a[60:61], v69 offset:20480
 ds_read_b64_tr_b16 a[62:63], v69 offset:20992
 ds_read_b64_tr_b16 a[140:141], v69 offset:20512
 ds_read_b64_tr_b16 a[142:143], v69 offset:21024
 ds_read_b64_tr_b16 a[220:221], v69 offset:20544
 ds_read_b64_tr_b16 a[222:223], v69 offset:21056
 ds_read_b64_tr_b16 v[48:49], v69 offset:20576
 ds_read_b64_tr_b16 v[50:51], v69 offset:21088
 ds_read_b64_tr_b16 a[64:65], v69 offset:24576
 ds_read_b64_tr_b16 a[66:67], v69 offset:25088
 ds_read_b64_tr_b16 a[144:145], v69 offset:24608
 ds_read_b64_tr_b16 a[146:147], v69 offset:25120
 ds_read_b64_tr_b16 a[224:225], v69 offset:24640
 ds_read_b64_tr_b16 a[226:227], v69 offset:25152
 ds_read_b64_tr_b16 v[52:53], v69 offset:24672
 ds_read_b64_tr_b16 v[54:55], v69 offset:25184
 ds_read_b64_tr_b16 a[68:69], v69 offset:28672
 ds_read_b64_tr_b16 a[70:71], v69 offset:29184
 ds_read_b64_tr_b16 a[148:149], v69 offset:28704
 ds_read_b64_tr_b16 a[150:151], v69 offset:29216
 ds_read_b64_tr_b16 a[228:229], v69 offset:28736
 ds_read_b64_tr_b16 a[230:231], v69 offset:29248
 ds_read_b64_tr_b16 v[56:57], v69 offset:28768
 ds_read_b64_tr_b16 v[58:59], v69 offset:29280
 ds_read_b64_tr_b16 a[72:73], v69 offset:32768
 ds_read_b64_tr_b16 a[74:75], v69 offset:33280
 ds_read_b64_tr_b16 a[152:153], v69 offset:32800
 ds_read_b64_tr_b16 a[154:155], v69 offset:33312
 ds_read_b64_tr_b16 a[232:233], v69 offset:32832
 ds_read_b64_tr_b16 a[234:235], v69 offset:33344
 ds_read_b64_tr_b16 v[60:61], v69 offset:32864
 ds_read_b64_tr_b16 v[62:63], v69 offset:33376
 ds_read_b64_tr_b16 a[76:77], v69 offset:36864
 ds_read_b64_tr_b16 a[78:79], v69 offset:37376
 ds_read_b64_tr_b16 a[156:157], v69 offset:36896
 ds_read_b64_tr_b16 a[158:159], v69 offset:37408
 ds_read_b64_tr_b16 a[236:237], v69 offset:36928
 ds_read_b64_tr_b16 a[238:239], v69 offset:37440
 ds_read_b64_tr_b16 v[64:65], v69 offset:36960
 ds_read_b64_tr_b16 v[66:67], v69 offset:37472
 s_waitcnt lgkmcnt(0)
 s_barrier
 s_cmp_eq_u32 s13, 1
 s_cbranch_scc1 Lverok_302
 s_mov_b32 s18, 0
Lver_301:
 s_add_u32 s18, s18, 1
 s_cmp_gt_u32 s18, 200000
 s_cbranch_scc1 L_fail
 v_and_b32 v254, 7, v0
 v_lshlrev_b32 v254, 2, v254
 buffer_load_dword v255, v254, s[8:11], 0 offen sc1
 s_waitcnt vmcnt(0)
 v_cmp_eq_u32 vcc, 32, v255
 s_nop 0
 s_cmp_eq_u64 vcc, -1
 s_cbranch_scc1 Lverok_302
 s_mov_b32 s17, 0
 v_readlane_b32 s14, v255, 0
 s_nop 0
 s_add_u32 s17, s17, s14
 v_readlane_b32 s14, v255, 1
 s_nop 0
 s_add_u32 s17, s17, s14
 v_readlane_b32 s14, v255, 2
 s_nop 0
 s_add_u32 s17, s17, s14
 v_readlane_b32 s14, v255, 3
 s_nop 0
 s_add_u32 s17, s17, s14
 v_readlane_b32 s14, v255, 4
 s_nop 0
 s_add_u32 s17, s17, s14
 v_readlane_b32 s14, v255, 5
 s_nop 0
 s_add_u32 s17, s17, s14
 v_readlane_b32 s14, v255, 6
 s_nop 0
 s_add_u32 s17, s17, s14
 v_readlane_b32 s14, v255, 7
 s_nop 0
 s_add_u32 s17, s17, s14
 s_cmp_eq_u32 s17, 256
 s_cbranch_scc1 L_fallback
 s_branch Lver_301
Lverok_302:
 v_lshrrev_b32 v70, 3, v1
 s_lshl_b32 s19, s3, 3
 v_add_u32 v70, s19, v70
 v_bfe_u32 v71, v70, 1, 3
 v_mul_u32_u24 v70, 1280, v70
 v_and_b32 v3, 7, v1
 v_xor_b32 v3, v3, v71
 v_lshl_add_u32 v3, v3, 4, v70
 v_and_b32 v70, 15, v1
 v_bfe_u32 v71, v1, 1, 3
 v_lshrrev_b32 v68, 4, v1
 v_add_u32 v69, 4, v68
 v_xor_b32 v68, v68, v71
 v_xor_b32 v69, v69, v71
 v_lshlrev_b32 v70, 7, v70
 v_lshl_add_u32 v68, v68, 4, v70
 v_lshl_add_u32 v69, v69, 4, v70
 v_and_b32 v73, 3, v1
 v_lshlrev_b32 v73, 7, v73
 v_add_u32 v73, 237568, v73
 v_add_u32 v70, 40960, v68
 v_add_u32 v71, 40960, v69
 s_lshl_b32 s19, s26, 12
 s_mov_b32 s20, 33980416
 s_cmp_eq_u32 s25, 1
 s_cselect_b32 s43, 59146240, s20
 s_cselect_b32 s44, 109477888, s20
 s_cmp_eq_u32 s25, 2
 s_cselect_b32 s43, 84312064, s43
 s_cselect_b32 s44, 134643712, s44
 s_add_u32 s43, s43, s19
 s_add_u32 s44, s44, s19
 s_lshl_b32 s45, s12, 2
 s_add_u32 s45, s45, s3
 s_lshl_b32 s45, s45, 7
 s_add_u32 s45, s45, 0
 s_mov_b32 s27, 0
 s_mov_b32 s40, 0
 s_mov_b32 s41, 0
 s_lshl_b32 s47, s3, 10
 s_mov_b32 s46, 184975360
 s_cmp_eq_u32 s25, 2
 s_cbranch_scc1 L_qkv_v
 s_branch Lqf_303
Lqc_304:
 v_cvt_pk_bf16_f32 v164, v108, v109
 v_cvt_pk_bf16_f32 v165, v110, v111
 v_cvt_pk_bf16_f32 v166, v116, v117
 v_cvt_pk_bf16_f32 v167, v118, v119
 buffer_store_dwordx4 v[164:167], v2, s[4:7], s50 offen offset:0 sc1
 v_cvt_pk_bf16_f32 v168, v112, v113
 v_cvt_pk_bf16_f32 v169, v114, v115
 v_cvt_pk_bf16_f32 v170, v120, v121
 v_cvt_pk_bf16_f32 v171, v122, v123
 buffer_store_dwordx4 v[168:171], v2, s[4:7], s50 offen offset:1024 sc1
 v_cvt_pk_bf16_f32 v172, v124, v125
 v_cvt_pk_bf16_f32 v173, v126, v127
 v_cvt_pk_bf16_f32 v174, v132, v133
 v_cvt_pk_bf16_f32 v175, v134, v135
 buffer_store_dwordx4 v[172:175], v2, s[4:7], s50 offen offset:2048 sc1
 v_cvt_pk_bf16_f32 v176, v128, v129
 v_cvt_pk_bf16_f32 v177, v130, v131
 v_cvt_pk_bf16_f32 v178, v136, v137
 v_cvt_pk_bf16_f32 v179, v138, v139
 buffer_store_dwordx4 v[176:179], v2, s[4:7], s50 offen offset:3072 sc1
 buffer_load_dword v72, v73, s[4:7], 0 offen sc1
 s_waitcnt vmcnt(1)
 s_mov_b64 exec, 1
 v_mov_b32 v74, s49
 buffer_store_dword v74, off, s[4:7], s48 sc1
 s_mov_b64 exec, -1
 s_cmp_ge_u32 s27, 128
 s_cbranch_scc1 Lqd_311
 s_waitcnt vmcnt(1)
 v_cmp_lt_u32 vcc, s41, v72
 s_nop 0
 s_cmp_eq_u64 vcc, -1
 s_cbranch_scc1 Lqs_312
Lqf_303:
 s_cmp_eq_u32 s40, 0
 s_cbranch_scc1 Lqs_312
 s_add_u32 s22, s41, 1
 s_mov_b32 s24, 0
Lw_313:
 s_add_u32 s24, s24, 1
 s_cmp_gt_u32 s24, 200000
 s_cbranch_scc1 L_fail
 buffer_load_dword v72, v73, s[4:7], 0 offen sc1
 s_waitcnt vmcnt(0)
 v_cmp_le_u32 vcc, s22, v72
 s_nop 0
 s_cmp_eq_u64 vcc, -1
 s_cbranch_scc0 Lw_313
Lqs_312:
 buffer_load_dword v72, v73, s[4:7], 0 offen sc1
 s_mov_b32 s42, 0
 s_add_u32 m0, s47, 0
 s_nop 0
 buffer_load_dwordx4 v3, s[4:7], s46 offen offset:0 sc1 lds
 s_add_u32 m0, s47, 3968
 s_nop 0
 buffer_load_dwordx4 v3, s[4:7], s46 offen offset:128 sc1 lds
 s_add_u32 m0, s47, 7936
 s_nop 0
 buffer_load_dwordx4 v3, s[4:7], s46 offen offset:256 sc1 lds
 s_add_u32 m0, s47, 11904
 s_nop 0
 buffer_load_dwordx4 v3, s[4:7], s46 offen offset:384 sc1 lds
 s_add_u32 m0, s47, 15872
 s_nop 0
 buffer_load_dwordx4 v3, s[4:7], s46 offen offset:512 sc1 lds
 s_add_u32 m0, s47, 19840
 s_nop 0
 buffer_load_dwordx4 v3, s[4:7], s46 offen offset:640 sc1 lds
 s_add_u32 m0, s47, 23808
 s_nop 0
 buffer_load_dwordx4 v3, s[4:7], s46 offen offset:768 sc1 lds
 s_add_u32 m0, s47, 27776
 s_nop 0
 buffer_load_dwordx4 v3, s[4:7], s46 offen offset:896 sc1 lds
 s_add_u32 m0, s47, 31744
 s_nop 0
 buffer_load_dwordx4 v3, s[4:7], s46 offen offset:1024 sc1 lds
 s_add_u32 m0, s47, 35712
 s_nop 0
 buffer_load_dwordx4 v3, s[4:7], s46 offen offset:1152 sc1 lds
 s_waitcnt vmcnt(9)
 s_barrier
 ds_read_b128 v[140:143], v68 offset:0
 ds_read_b128 v[144:147], v68 offset:2048
 ds_read_b128 v[148:151], v69 offset:0
 ds_read_b128 v[152:155], v69 offset:2048
 s_waitcnt vmcnt(7)
 s_barrier
 ds_read_b128 v[156:159], v68 offset:4096
 ds_read_b128 v[160:163], v68 offset:6144
 s_waitcnt lgkmcnt(5)
 v_mfma_f32_16x16x32_bf16 v[76:79], a[0:3], v[140:143], 0
 s_mul_i32 s19, s41, 393216
 v_mfma_f32_16x16x32_bf16 v[84:87], a[80:83], v[140:143], 0
 s_cmp_eq_u32 s40, 0
 v_mfma_f32_16x16x32_bf16 v[92:95], a[160:163], v[140:143], 0
 s_cselect_b32 s20, s43, s44
 v_mfma_f32_16x16x32_bf16 v[100:103], a[240:243], v[140:143], 0
 s_add_u32 s53, s19, s20
 s_waitcnt lgkmcnt(4)
 v_mfma_f32_16x16x32_bf16 v[80:83], a[0:3], v[144:147], 0
 s_lshl_b32 s51, s40, 16
 v_mfma_f32_16x16x32_bf16 v[88:91], a[80:83], v[144:147], 0
 s_add_u32 s51, s51, s45
 v_mfma_f32_16x16x32_bf16 v[96:99], a[160:163], v[144:147], 0
 s_add_u32 s52, s41, 1
 v_mfma_f32_16x16x32_bf16 v[104:107], a[240:243], v[144:147], 0
 ds_read_b128 v[140:143], v69 offset:4096
 ds_read_b128 v[144:147], v69 offset:6144
 s_waitcnt lgkmcnt(4)
 v_mfma_f32_16x16x32_bf16 v[76:79], a[4:7], v[148:151], v[76:79]
 s_add_u32 s27, s27, 1
 v_mfma_f32_16x16x32_bf16 v[84:87], a[84:87], v[148:151], v[84:87]
 s_sub_u32 s19, s27, 13
 v_mfma_f32_16x16x32_bf16 v[92:95], a[164:167], v[148:151], v[92:95]
 s_lshr_b32 s20, s19, 1
 v_mfma_f32_16x16x32_bf16 v[100:103], a[244:247], v[148:151], v[100:103]
 s_add_u32 s21, s20, 13
 v_mfma_f32_16x16x32_bf16 v[80:83], a[4:7], v[152:155], v[80:83]
 s_bitcmp1_b32 s19, 0
 v_mfma_f32_16x16x32_bf16 v[88:91], a[84:87], v[152:155], v[88:91]
 s_cselect_b32 s41, s21, s20
 v_mfma_f32_16x16x32_bf16 v[96:99], a[164:167], v[152:155], v[96:99]
 s_cselect_b32 s40, 0, 1
 v_mfma_f32_16x16x32_bf16 v[104:107], a[244:247], v[152:155], v[104:107]
 ds_read_b128 v[148:151], v68 offset:8192
 ds_read_b128 v[152:155], v68 offset:10240
 s_waitcnt lgkmcnt(4)
 v_mfma_f32_16x16x32_bf16 v[76:79], a[8:11], v[156:159], v[76:79]
 s_cmp_lt_u32 s27, 13
 v_mfma_f32_16x16x32_bf16 v[84:87], a[88:91], v[156:159], v[84:87]
 s_cselect_b32 s41, s27, s41
 v_mfma_f32_16x16x32_bf16 v[92:95], a[168:171], v[156:159], v[92:95]
 s_cselect_b32 s40, 0, s40
 v_mfma_f32_16x16x32_bf16 v[100:103], a[248:251], v[156:159], v[100:103]
 s_sub_u32 s19, s27, 64
 v_mfma_f32_16x16x32_bf16 v[80:83], a[8:11], v[160:163], v[80:83]
 s_cmp_ge_u32 s27, 115
 v_mfma_f32_16x16x32_bf16 v[88:91], a[88:91], v[160:163], v[88:91]
 s_cselect_b32 s41, s19, s41
 v_mfma_f32_16x16x32_bf16 v[96:99], a[168:171], v[160:163], v[96:99]
 s_cselect_b32 s40, 1, s40
 v_mfma_f32_16x16x32_bf16 v[104:107], a[248:251], v[160:163], v[104:107]
 ds_read_b128 v[156:159], v69 offset:8192
 ds_read_b128 v[160:163], v69 offset:10240
 s_waitcnt lgkmcnt(4)
 v_mfma_f32_16x16x32_bf16 v[76:79], a[12:15], v[140:143], v[76:79]
 s_mul_i32 s46, s41, 40960
 v_mfma_f32_16x16x32_bf16 v[84:87], a[92:95], v[140:143], v[84:87]
 s_cmp_eq_u32 s40, 0
 v_mfma_f32_16x16x32_bf16 v[92:95], a[172:175], v[140:143], v[92:95]
 s_cselect_b32 s19, 0, 2621440
 v_mfma_f32_16x16x32_bf16 v[100:103], a[252:255], v[140:143], v[100:103]
 s_add_u32 s46, s46, s19
 v_mfma_f32_16x16x32_bf16 v[80:83], a[12:15], v[144:147], v[80:83]
 s_add_u32 s46, s46, 184975360
 v_mfma_f32_16x16x32_bf16 v[88:91], a[92:95], v[144:147], v[88:91]
 s_xor_b32 s47, s47, 40960
 v_mfma_f32_16x16x32_bf16 v[96:99], a[172:175], v[144:147], v[96:99]
 v_mfma_f32_16x16x32_bf16 v[104:107], a[252:255], v[144:147], v[104:107]
 s_branch Lqm_308
Lqw_306:
 buffer_load_dword v72, v73, s[4:7], 0 offen sc1
 s_mov_b32 s42, 1
 s_waitcnt vmcnt(9)
 s_barrier
 ds_read_b128 v[140:143], v68 offset:0
 ds_read_b128 v[144:147], v68 offset:2048
 ds_read_b128 v[148:151], v69 offset:0
 ds_read_b128 v[152:155], v69 offset:2048
 s_waitcnt vmcnt(7)
 s_barrier
 ds_read_b128 v[156:159], v68 offset:4096
 ds_read_b128 v[160:163], v68 offset:6144
 s_waitcnt lgkmcnt(5)
 v_mfma_f32_16x16x32_bf16 v[76:79], a[0:3], v[140:143], 0
 v_cvt_pk_bf16_f32 v164, v108, v109
 v_cvt_pk_bf16_f32 v165, v110, v111
 v_mfma_f32_16x16x32_bf16 v[84:87], a[80:83], v[140:143], 0
 v_cvt_pk_bf16_f32 v166, v116, v117
 v_cvt_pk_bf16_f32 v167, v118, v119
 v_mfma_f32_16x16x32_bf16 v[92:95], a[160:163], v[140:143], 0
 buffer_store_dwordx4 v[164:167], v2, s[4:7], s50 offen offset:0 sc1
 s_mul_i32 s19, s41, 393216
 v_mfma_f32_16x16x32_bf16 v[100:103], a[240:243], v[140:143], 0
 s_cmp_eq_u32 s40, 0
 s_cselect_b32 s20, s43, s44
 s_waitcnt lgkmcnt(4)
 v_mfma_f32_16x16x32_bf16 v[80:83], a[0:3], v[144:147], 0
 s_add_u32 s53, s19, s20
 v_mfma_f32_16x16x32_bf16 v[88:91], a[80:83], v[144:147], 0
 s_lshl_b32 s51, s40, 16
 v_mfma_f32_16x16x32_bf16 v[96:99], a[160:163], v[144:147], 0
 s_add_u32 s51, s51, s45
 v_mfma_f32_16x16x32_bf16 v[104:107], a[240:243], v[144:147], 0
 s_add_u32 s52, s41, 1
 ds_read_b128 v[140:143], v69 offset:4096
 ds_read_b128 v[144:147], v69 offset:6144
 s_waitcnt lgkmcnt(4)
 v_mfma_f32_16x16x32_bf16 v[76:79], a[4:7], v[148:151], v[76:79]
 v_cvt_pk_bf16_f32 v168, v112, v113
 v_cvt_pk_bf16_f32 v169, v114, v115
 v_mfma_f32_16x16x32_bf16 v[84:87], a[84:87], v[148:151], v[84:87]
 v_cvt_pk_bf16_f32 v170, v120, v121
 v_cvt_pk_bf16_f32 v171, v122, v123
 v_mfma_f32_16x16x32_bf16 v[92:95], a[164:167], v[148:151], v[92:95]
 buffer_store_dwordx4 v[168:171], v2, s[4:7], s50 offen offset:1024 sc1
 s_add_u32 s27, s27, 1
 v_mfma_f32_16x16x32_bf16 v[100:103], a[244:247], v[148:151], v[100:103]
 s_sub_u32 s19, s27, 13
 s_lshr_b32 s20, s19, 1
 v_mfma_f32_16x16x32_bf16 v[80:83], a[4:7], v[152:155], v[80:83]
 s_add_u32 s21, s20, 13
 v_mfma_f32_16x16x32_bf16 v[88:91], a[84:87], v[152:155], v[88:91]
 s_bitcmp1_b32 s19, 0
 v_mfma_f32_16x16x32_bf16 v[96:99], a[164:167], v[152:155], v[96:99]
 s_cselect_b32 s41, s21, s20
 v_mfma_f32_16x16x32_bf16 v[104:107], a[244:247], v[152:155], v[104:107]
 s_cselect_b32 s40, 0, 1
 ds_read_b128 v[148:151], v68 offset:8192
 ds_read_b128 v[152:155], v68 offset:10240
 s_waitcnt lgkmcnt(4)
 v_mfma_f32_16x16x32_bf16 v[76:79], a[8:11], v[156:159], v[76:79]
 v_cvt_pk_bf16_f32 v172, v124, v125
 v_cvt_pk_bf16_f32 v173, v126, v127
 v_mfma_f32_16x16x32_bf16 v[84:87], a[88:91], v[156:159], v[84:87]
 v_cvt_pk_bf16_f32 v174, v132, v133
 v_cvt_pk_bf16_f32 v175, v134, v135
 v_mfma_f32_16x16x32_bf16 v[92:95], a[168:171], v[156:159], v[92:95]
 buffer_store_dwordx4 v[172:175], v2, s[4:7], s50 offen offset:2048 sc1
 s_cmp_lt_u32 s27, 13
 v_mfma_f32_16x16x32_bf16 v[100:103], a[248:251], v[156:159], v[100:103]
 s_cselect_b32 s41, s27, s41
 s_cselect_b32 s40, 0, s40
 v_mfma_f32_16x16x32_bf16 v[80:83], a[8:11], v[160:163], v[80:83]
 s_sub_u32 s19, s27, 64
 v_mfma_f32_16x16x32_bf16 v[88:91], a[88:91], v[160:163], v[88:91]
 s_cmp_ge_u32 s27, 115
 v_mfma_f32_16x16x32_bf16 v[96:99], a[168:171], v[160:163], v[96:99]
 s_cselect_b32 s41, s19, s41
 v_mfma_f32_16x16x32_bf16 v[104:107], a[248:251], v[160:163], v[104:107]
 s_cselect_b32 s40, 1, s40
 ds_read_b128 v[156:159], v69 offset:8192
 ds_read_b128 v[160:163], v69 offset:10240
 s_waitcnt lgkmcnt(4)
 v_mfma_f32_16x16x32_bf16 v[76:79], a[12:15], v[140:143], v[76:79]
 v_cvt_pk_bf16_f32 v176, v128, v129
 v_cvt_pk_bf16_f32 v177, v130, v131
 v_mfma_f32_16x16x32_bf16 v[84:87], a[92:95], v[140:143], v[84:87]
 v_cvt_pk_bf16_f32 v178, v136, v137
 v_cvt_pk_bf16_f32 v179, v138, v139
 v_mfma_f32_16x16x32_bf16 v[92:95], a[172:175], v[140:143], v[92:95]
 buffer_store_dwordx4 v[176:179], v2, s[4:7], s50 offen offset:3072 sc1
 s_mul_i32 s46, s41, 40960
 v_mfma_f32_16x16x32_bf16 v[100:103], a[252:255], v[140:143], v[100:103]
 s_cmp_eq_u32 s40, 0
 v_mfma_f32_16x16x32_bf16 v[80:83], a[12:15], v[144:147], v[80:83]
 s_cselect_b32 s19, 0, 2621440
 v_mfma_f32_16x16x32_bf16 v[88:91], a[92:95], v[144:147], v[88:91]
 s_add_u32 s46, s46, s19
 v_mfma_f32_16x16x32_bf16 v[96:99], a[172:175], v[144:147], v[96:99]
 s_add_u32 s46, s46, 184975360
 v_mfma_f32_16x16x32_bf16 v[104:107], a[252:255], v[144:147], v[104:107]
 s_xor_b32 s47, s47, 40960
Lqm_308:
 s_waitcnt vmcnt(5)
 s_barrier
 ds_read_b128 v[140:143], v68 offset:12288
 ds_read_b128 v[144:147], v68 offset:14336
 s_waitcnt lgkmcnt(4)
 v_mfma_f32_16x16x32_bf16 v[76:79], a[16:19], v[148:151], v[76:79]
 v_mfma_f32_16x16x32_bf16 v[84:87], a[96:99], v[148:151], v[84:87]
 v_mfma_f32_16x16x32_bf16 v[92:95], a[176:179], v[148:151], v[92:95]
 v_mfma_f32_16x16x32_bf16 v[100:103], v[4:7], v[148:151], v[100:103]
 v_mfma_f32_16x16x32_bf16 v[80:83], a[16:19], v[152:155], v[80:83]
 v_mfma_f32_16x16x32_bf16 v[88:91], a[96:99], v[152:155], v[88:91]
 v_mfma_f32_16x16x32_bf16 v[96:99], a[176:179], v[152:155], v[96:99]
 v_mfma_f32_16x16x32_bf16 v[104:107], v[4:7], v[152:155], v[104:107]
 ds_read_b128 v[148:151], v69 offset:12288
 ds_read_b128 v[152:155], v69 offset:14336
 s_waitcnt lgkmcnt(4)
 v_mfma_f32_16x16x32_bf16 v[76:79], a[20:23], v[156:159], v[76:79]
 v_mfma_f32_16x16x32_bf16 v[84:87], a[100:103], v[156:159], v[84:87]
 v_mfma_f32_16x16x32_bf16 v[92:95], a[180:183], v[156:159], v[92:95]
 v_mfma_f32_16x16x32_bf16 v[100:103], v[8:11], v[156:159], v[100:103]
 v_mfma_f32_16x16x32_bf16 v[80:83], a[20:23], v[160:163], v[80:83]
 v_mfma_f32_16x16x32_bf16 v[88:91], a[100:103], v[160:163], v[88:91]
 v_mfma_f32_16x16x32_bf16 v[96:99], a[180:183], v[160:163], v[96:99]
 v_mfma_f32_16x16x32_bf16 v[104:107], v[8:11], v[160:163], v[104:107]
 ds_read_b128 v[156:159], v68 offset:16384
 ds_read_b128 v[160:163], v68 offset:18432
 s_waitcnt lgkmcnt(4)
 v_mfma_f32_16x16x32_bf16 v[76:79], a[24:27], v[140:143], v[76:79]
 v_mfma_f32_16x16x32_bf16 v[84:87], a[104:107], v[140:143], v[84:87]
 v_mfma_f32_16x16x32_bf16 v[92:95], a[184:187], v[140:143], v[92:95]
 v_mfma_f32_16x16x32_bf16 v[100:103], v[12:15], v[140:143], v[100:103]
 v_mfma_f32_16x16x32_bf16 v[80:83], a[24:27], v[144:147], v[80:83]
 v_mfma_f32_16x16x32_bf16 v[88:91], a[104:107], v[144:147], v[88:91]
 v_mfma_f32_16x16x32_bf16 v[96:99], a[184:187], v[144:147], v[96:99]
 v_mfma_f32_16x16x32_bf16 v[104:107], v[12:15], v[144:147], v[104:107]
 s_cmp_ge_u32 s27, 128
 s_cbranch_scc1 Lqp_310
 s_cmp_eq_u32 s40, 0
 s_cbranch_scc1 Lqo_314
 s_waitcnt vmcnt(4)
 v_cmp_lt_u32 vcc, s41, v72
 s_nop 0
 s_cmp_eq_u64 vcc, -1
 s_cbranch_scc0 Lqp_310
Lqo_314:
 ds_read_b128 v[140:143], v69 offset:16384
 ds_read_b128 v[144:147], v69 offset:18432
 s_waitcnt lgkmcnt(4)
 v_mfma_f32_16x16x32_bf16 v[76:79], a[28:31], v[148:151], v[76:79]
 s_add_u32 m0, s47, 0
 v_mfma_f32_16x16x32_bf16 v[84:87], a[108:111], v[148:151], v[84:87]
 buffer_load_dwordx4 v3, s[4:7], s46 offen offset:0 sc1 lds
 v_mfma_f32_16x16x32_bf16 v[92:95], a[188:191], v[148:151], v[92:95]
 v_mfma_f32_16x16x32_bf16 v[100:103], v[16:19], v[148:151], v[100:103]
 v_mfma_f32_16x16x32_bf16 v[80:83], a[28:31], v[152:155], v[80:83]
 v_mfma_f32_16x16x32_bf16 v[88:91], a[108:111], v[152:155], v[88:91]
 v_mfma_f32_16x16x32_bf16 v[96:99], a[188:191], v[152:155], v[96:99]
 v_mfma_f32_16x16x32_bf16 v[104:107], v[16:19], v[152:155], v[104:107]
 s_waitcnt vmcnt(4)
 s_barrier
 ds_read_b128 v[148:151], v68 offset:20480
 ds_read_b128 v[152:155], v68 offset:22528
 s_waitcnt lgkmcnt(4)
 v_mfma_f32_16x16x32_bf16 v[76:79], a[32:35], v[156:159], v[76:79]
 s_add_u32 m0, s47, 3968
 v_mfma_f32_16x16x32_bf16 v[84:87], a[112:115], v[156:159], v[84:87]
 buffer_load_dwordx4 v3, s[4:7], s46 offen offset:128 sc1 lds
 v_mfma_f32_16x16x32_bf16 v[92:95], a[192:195], v[156:159], v[92:95]
 v_mfma_f32_16x16x32_bf16 v[100:103], v[20:23], v[156:159], v[100:103]
 v_mfma_f32_16x16x32_bf16 v[80:83], a[32:35], v[160:163], v[80:83]
 v_mfma_f32_16x16x32_bf16 v[88:91], a[112:115], v[160:163], v[88:91]
 v_mfma_f32_16x16x32_bf16 v[96:99], a[192:195], v[160:163], v[96:99]
 v_mfma_f32_16x16x32_bf16 v[104:107], v[20:23], v[160:163], v[104:107]
 ds_read_b128 v[156:159], v69 offset:20480
 ds_read_b128 v[160:163], v69 offset:22528
 s_waitcnt lgkmcnt(4)
 v_mfma_f32_16x16x32_bf16 v[76:79], a[36:39], v[140:143], v[76:79]
 s_add_u32 m0, s47, 7936
 v_mfma_f32_16x16x32_bf16 v[84:87], a[116:119], v[140:143], v[84:87]
 buffer_load_dwordx4 v3, s[4:7], s46 offen offset:256 sc1 lds
 v_mfma_f32_16x16x32_bf16 v[92:95], a[196:199], v[140:143], v[92:95]
 v_mfma_f32_16x16x32_bf16 v[100:103], v[24:27], v[140:143], v[100:103]
 v_mfma_f32_16x16x32_bf16 v[80:83], a[36:39], v[144:147], v[80:83]
 v_mfma_f32_16x16x32_bf16 v[88:91], a[116:119], v[144:147], v[88:91]
 v_mfma_f32_16x16x32_bf16 v[96:99], a[196:199], v[144:147], v[96:99]
 v_mfma_f32_16x16x32_bf16 v[104:107], v[24:27], v[144:147], v[104:107]
 ds_read_b128 v[140:143], v68 offset:24576
 ds_read_b128 v[144:147], v68 offset:26624
 s_waitcnt lgkmcnt(4)
 v_mfma_f32_16x16x32_bf16 v[76:79], a[40:43], v[148:151], v[76:79]
 s_add_u32 m0, s47, 11904
 v_mfma_f32_16x16x32_bf16 v[84:87], a[120:123], v[148:151], v[84:87]
 buffer_load_dwordx4 v3, s[4:7], s46 offen offset:384 sc1 lds
 v_mfma_f32_16x16x32_bf16 v[92:95], a[200:203], v[148:151], v[92:95]
 v_mfma_f32_16x16x32_bf16 v[100:103], v[28:31], v[148:151], v[100:103]
 v_mfma_f32_16x16x32_bf16 v[80:83], a[40:43], v[152:155], v[80:83]
 v_mfma_f32_16x16x32_bf16 v[88:91], a[120:123], v[152:155], v[88:91]
 v_mfma_f32_16x16x32_bf16 v[96:99], a[200:203], v[152:155], v[96:99]
 v_mfma_f32_16x16x32_bf16 v[104:107], v[28:31], v[152:155], v[104:107]
 s_cmp_eq_u32 s42, 1
 s_cbranch_scc0 Lqn_315
 s_waitcnt vmcnt(4)
 s_mov_b64 exec, 1
 v_mov_b32 v74, s49
 buffer_store_dword v74, off, s[4:7], s48 sc1
 s_mov_b64 exec, -1
Lqn_315:
 ds_read_b128 v[148:151], v69 offset:24576
 ds_read_b128 v[152:155], v69 offset:26624
 s_waitcnt lgkmcnt(4)
 v_mfma_f32_16x16x32_bf16 v[76:79], a[44:47], v[156:159], v[76:79]
 s_add_u32 m0, s47, 15872
 v_mfma_f32_16x16x32_bf16 v[84:87], a[124:127], v[156:159], v[84:87]
 buffer_load_dwordx4 v3, s[4:7], s46 offen offset:512 sc1 lds
 v_mfma_f32_16x16x32_bf16 v[92:95], a[204:207], v[156:159], v[92:95]
 v_mfma_f32_16x16x32_bf16 v[100:103], v[32:35], v[156:159], v[100:103]
 v_mfma_f32_16x16x32_bf16 v[80:83], a[44:47], v[160:163], v[80:83]
 v_mfma_f32_16x16x32_bf16 v[88:91], a[124:127], v[160:163], v[88:91]
 v_mfma_f32_16x16x32_bf16 v[96:99], a[204:207], v[160:163], v[96:99]
 v_mfma_f32_16x16x32_bf16 v[104:107], v[32:35], v[160:163], v[104:107]
 s_waitcnt vmcnt(5)
 s_barrier
 ds_read_b128 v[156:159], v68 offset:28672
 ds_read_b128 v[160:163], v68 offset:30720
 s_waitcnt lgkmcnt(4)
 v_mfma_f32_16x16x32_bf16 v[76:79], a[48:51], v[140:143], v[76:79]
 s_add_u32 m0, s47, 19840
 v_mfma_f32_16x16x32_bf16 v[84:87], a[128:131], v[140:143], v[84:87]
 buffer_load_dwordx4 v3, s[4:7], s46 offen offset:640 sc1 lds
 v_mfma_f32_16x16x32_bf16 v[92:95], a[208:211], v[140:143], v[92:95]
 v_mfma_f32_16x16x32_bf16 v[100:103], v[36:39], v[140:143], v[100:103]
 v_mfma_f32_16x16x32_bf16 v[80:83], a[48:51], v[144:147], v[80:83]
 v_mfma_f32_16x16x32_bf16 v[88:91], a[128:131], v[144:147], v[88:91]
 v_mfma_f32_16x16x32_bf16 v[96:99], a[208:211], v[144:147], v[96:99]
 v_mfma_f32_16x16x32_bf16 v[104:107], v[36:39], v[144:147], v[104:107]
 ds_read_b128 v[140:143], v69 offset:28672
 ds_read_b128 v[144:147], v69 offset:30720
 s_waitcnt lgkmcnt(4)
 v_mfma_f32_16x16x32_bf16 v[76:79], a[52:55], v[148:151], v[76:79]
 s_add_u32 m0, s47, 23808
 v_mfma_f32_16x16x32_bf16 v[84:87], a[132:135], v[148:151], v[84:87]
 buffer_load_dwordx4 v3, s[4:7], s46 offen offset:768 sc1 lds
 v_mfma_f32_16x16x32_bf16 v[92:95], a[212:215], v[148:151], v[92:95]
 v_mfma_f32_16x16x32_bf16 v[100:103], v[40:43], v[148:151], v[100:103]
 v_mfma_f32_16x16x32_bf16 v[80:83], a[52:55], v[152:155], v[80:83]
 v_mfma_f32_16x16x32_bf16 v[88:91], a[132:135], v[152:155], v[88:91]
 v_mfma_f32_16x16x32_bf16 v[96:99], a[212:215], v[152:155], v[96:99]
 v_mfma_f32_16x16x32_bf16 v[104:107], v[40:43], v[152:155], v[104:107]
 ds_read_b128 v[148:151], v68 offset:32768
 ds_read_b128 v[152:155], v68 offset:34816
 s_waitcnt lgkmcnt(4)
 v_mfma_f32_16x16x32_bf16 v[76:79], a[56:59], v[156:159], v[76:79]
 s_add_u32 m0, s47, 27776
 v_mfma_f32_16x16x32_bf16 v[84:87], a[136:139], v[156:159], v[84:87]
 buffer_load_dwordx4 v3, s[4:7], s46 offen offset:896 sc1 lds
 v_mfma_f32_16x16x32_bf16 v[92:95], a[216:219], v[156:159], v[92:95]
 v_mfma_f32_16x16x32_bf16 v[100:103], v[44:47], v[156:159], v[100:103]
 v_mfma_f32_16x16x32_bf16 v[80:83], a[56:59], v[160:163], v[80:83]
 v_mfma_f32_16x16x32_bf16 v[88:91], a[136:139], v[160:163], v[88:91]
 v_mfma_f32_16x16x32_bf16 v[96:99], a[216:219], v[160:163], v[96:99]
 v_mfma_f32_16x16x32_bf16 v[104:107], v[44:47], v[160:163], v[104:107]
 ds_read_b128 v[156:159], v69 offset:32768
 ds_read_b128 v[160:163], v69 offset:34816
 s_waitcnt lgkmcnt(4)
 v_mfma_f32_16x16x32_bf16 v[76:79], a[60:63], v[140:143], v[76:79]
 s_add_u32 m0, s47, 31744
 v_mfma_f32_16x16x32_bf16 v[84:87], a[140:143], v[140:143], v[84:87]
 buffer_load_dwordx4 v3, s[4:7], s46 offen offset:1024 sc1 lds
 v_mfma_f32_16x16x32_bf16 v[92:95], a[220:223], v[140:143], v[92:95]
 v_mfma_f32_16x16x32_bf16 v[100:103], v[48:51], v[140:143], v[100:103]
 v_mfma_f32_16x16x32_bf16 v[80:83], a[60:63], v[144:147], v[80:83]
 v_mfma_f32_16x16x32_bf16 v[88:91], a[140:143], v[144:147], v[88:91]
 v_mfma_f32_16x16x32_bf16 v[96:99], a[220:223], v[144:147], v[96:99]
 v_mfma_f32_16x16x32_bf16 v[104:107], v[48:51], v[144:147], v[104:107]
 ds_read_b128 v[140:143], v68 offset:36864
 ds_read_b128 v[144:147], v68 offset:38912
 s_waitcnt lgkmcnt(4)
 v_mfma_f32_16x16x32_bf16 v[76:79], a[64:67], v[148:151], v[76:79]
 s_add_u32 m0, s47, 35712
 v_mfma_f32_16x16x32_bf16 v[84:87], a[144:147], v[148:151], v[84:87]
 buffer_load_dwordx4 v3, s[4:7], s46 offen offset:1152 sc1 lds
 v_mfma_f32_16x16x32_bf16 v[92:95], a[224:227], v[148:151], v[92:95]
 v_mfma_f32_16x16x32_bf16 v[100:103], v[52:55], v[148:151], v[100:103]
 v_mfma_f32_16x16x32_bf16 v[80:83], a[64:67], v[152:155], v[80:83]
 v_mfma_f32_16x16x32_bf16 v[88:91], a[144:147], v[152:155], v[88:91]
 v_mfma_f32_16x16x32_bf16 v[96:99], a[224:227], v[152:155], v[96:99]
 v_mfma_f32_16x16x32_bf16 v[104:107], v[52:55], v[152:155], v[104:107]
 ds_read_b128 v[148:151], v69 offset:36864
 ds_read_b128 v[152:155], v69 offset:38912
 s_waitcnt lgkmcnt(4)
 v_mfma_f32_16x16x32_bf16 v[76:79], a[68:71], v[156:159], v[76:79]
 v_mfma_f32_16x16x32_bf16 v[84:87], a[148:151], v[156:159], v[84:87]
 v_mfma_f32_16x16x32_bf16 v[92:95], a[228:231], v[156:159], v[92:95]
 v_mfma_f32_16x16x32_bf16 v[100:103], v[56:59], v[156:159], v[100:103]
 v_mfma_f32_16x16x32_bf16 v[80:83], a[68:71], v[160:163], v[80:83]
 v_mfma_f32_16x16x32_bf16 v[88:91], a[148:151], v[160:163], v[88:91]
 v_mfma_f32_16x16x32_bf16 v[96:99], a[228:231], v[160:163], v[96:99]
 v_mfma_f32_16x16x32_bf16 v[104:107], v[56:59], v[160:163], v[104:107]
 s_waitcnt lgkmcnt(3)
 v_mfma_f32_16x16x32_bf16 v[76:79], a[72:75], v[140:143], v[76:79]
 v_mfma_f32_16x16x32_bf16 v[84:87], a[152:155], v[140:143], v[84:87]
 v_mfma_f32_16x16x32_bf16 v[92:95], a[232:235], v[140:143], v[92:95]
 v_mfma_f32_16x16x32_bf16 v[100:103], v[60:63], v[140:143], v[100:103]
 s_waitcnt lgkmcnt(2)
 v_mfma_f32_16x16x32_bf16 v[80:83], a[72:75], v[144:147], v[80:83]
 v_mfma_f32_16x16x32_bf16 v[88:91], a[152:155], v[144:147], v[88:91]
 v_mfma_f32_16x16x32_bf16 v[96:99], a[232:235], v[144:147], v[96:99]
 v_mfma_f32_16x16x32_bf16 v[104:107], v[60:63], v[144:147], v[104:107]
 s_waitcnt lgkmcnt(1)
 v_mfma_f32_16x16x32_bf16 v[76:79], a[76:79], v[148:151], v[76:79]
 s_mov_b32 s50, s53
 v_mfma_f32_16x16x32_bf16 v[84:87], a[156:159], v[148:151], v[84:87]
 s_mov_b32 s48, s51
 v_mfma_f32_16x16x32_bf16 v[92:95], a[236:239], v[148:151], v[92:95]
 s_mov_b32 s49, s52
 v_mfma_f32_16x16x32_bf16 v[100:103], v[64:67], v[148:151], v[100:103]
 s_waitcnt lgkmcnt(0)
 v_mfma_f32_16x16x32_bf16 v[80:83], a[76:79], v[152:155], v[80:83]
 v_mfma_f32_16x16x32_bf16 v[88:91], a[156:159], v[152:155], v[88:91]
 v_mfma_f32_16x16x32_bf16 v[96:99], a[236:239], v[152:155], v[96:99]
 v_mfma_f32_16x16x32_bf16 v[104:107], v[64:67], v[152:155], v[104:107]
 s_branch Lqw_307
Lqp_310:
 ds_read_b128 v[140:143], v69 offset:16384
 ds_read_b128 v[144:147], v69 offset:18432
 s_waitcnt lgkmcnt(4)
 v_mfma_f32_16x16x32_bf16 v[76:79], a[28:31], v[148:151], v[76:79]
 v_mfma_f32_16x16x32_bf16 v[84:87], a[108:111], v[148:151], v[84:87]
 v_mfma_f32_16x16x32_bf16 v[92:95], a[188:191], v[148:151], v[92:95]
 v_mfma_f32_16x16x32_bf16 v[100:103], v[16:19], v[148:151], v[100:103]
 v_mfma_f32_16x16x32_bf16 v[80:83], a[28:31], v[152:155], v[80:83]
 v_mfma_f32_16x16x32_bf16 v[88:91], a[108:111], v[152:155], v[88:91]
 v_mfma_f32_16x16x32_bf16 v[96:99], a[188:191], v[152:155], v[96:99]
 v_mfma_f32_16x16x32_bf16 v[104:107], v[16:19], v[152:155], v[104:107]
 s_waitcnt vmcnt(3)
 s_barrier
 ds_read_b128 v[148:151], v68 offset:20480
 ds_read_b128 v[152:155], v68 offset:22528
 s_waitcnt lgkmcnt(4)
 v_mfma_f32_16x16x32_bf16 v[76:79], a[32:35], v[156:159], v[76:79]
 v_mfma_f32_16x16x32_bf16 v[84:87], a[112:115], v[156:159], v[84:87]
 v_mfma_f32_16x16x32_bf16 v[92:95], a[192:195], v[156:159], v[92:95]
 v_mfma_f32_16x16x32_bf16 v[100:103], v[20:23], v[156:159], v[100:103]
 v_mfma_f32_16x16x32_bf16 v[80:83], a[32:35], v[160:163], v[80:83]
 v_mfma_f32_16x16x32_bf16 v[88:91], a[112:115], v[160:163], v[88:91]
 v_mfma_f32_16x16x32_bf16 v[96:99], a[192:195], v[160:163], v[96:99]
 v_mfma_f32_16x16x32_bf16 v[104:107], v[20:23], v[160:163], v[104:107]
 ds_read_b128 v[156:159], v69 offset:20480
 ds_read_b128 v[160:163], v69 offset:22528
 s_waitcnt lgkmcnt(4)
 v_mfma_f32_16x16x32_bf16 v[76:79], a[36:39], v[140:143], v[76:79]
 v_mfma_f32_16x16x32_bf16 v[84:87], a[116:119], v[140:143], v[84:87]
 v_mfma_f32_16x16x32_bf16 v[92:95], a[196:199], v[140:143], v[92:95]
 v_mfma_f32_16x16x32_bf16 v[100:103], v[24:27], v[140:143], v[100:103]
 v_mfma_f32_16x16x32_bf16 v[80:83], a[36:39], v[144:147], v[80:83]
 v_mfma_f32_16x16x32_bf16 v[88:91], a[116:119], v[144:147], v[88:91]
 v_mfma_f32_16x16x32_bf16 v[96:99], a[196:199], v[144:147], v[96:99]
 v_mfma_f32_16x16x32_bf16 v[104:107], v[24:27], v[144:147], v[104:107]
 ds_read_b128 v[140:143], v68 offset:24576
 ds_read_b128 v[144:147], v68 offset:26624
 s_waitcnt lgkmcnt(4)
 v_mfma_f32_16x16x32_bf16 v[76:79], a[40:43], v[148:151], v[76:79]
 v_mfma_f32_16x16x32_bf16 v[84:87], a[120:123], v[148:151], v[84:87]
 v_mfma_f32_16x16x32_bf16 v[92:95], a[200:203], v[148:151], v[92:95]
 v_mfma_f32_16x16x32_bf16 v[100:103], v[28:31], v[148:151], v[100:103]
 v_mfma_f32_16x16x32_bf16 v[80:83], a[40:43], v[152:155], v[80:83]
 v_mfma_f32_16x16x32_bf16 v[88:91], a[120:123], v[152:155], v[88:91]
 v_mfma_f32_16x16x32_bf16 v[96:99], a[200:203], v[152:155], v[96:99]
 v_mfma_f32_16x16x32_bf16 v[104:107], v[28:31], v[152:155], v[104:107]
 s_cmp_eq_u32 s42, 1
 s_cbranch_scc0 Lqn_316
 s_waitcnt vmcnt(0)
 s_mov_b64 exec, 1
 v_mov_b32 v74, s49
 buffer_store_dword v74, off, s[4:7], s48 sc1
 s_mov_b64 exec, -1
Lqn_316:
 ds_read_b128 v[148:151], v69 offset:24576
 ds_read_b128 v[152:155], v69 offset:26624
 s_waitcnt lgkmcnt(4)
 v_mfma_f32_16x16x32_bf16 v[76:79], a[44:47], v[156:159], v[76:79]
 v_mfma_f32_16x16x32_bf16 v[84:87], a[124:127], v[156:159], v[84:87]
 v_mfma_f32_16x16x32_bf16 v[92:95], a[204:207], v[156:159], v[92:95]
 v_mfma_f32_16x16x32_bf16 v[100:103], v[32:35], v[156:159], v[100:103]
 v_mfma_f32_16x16x32_bf16 v[80:83], a[44:47], v[160:163], v[80:83]
 v_mfma_f32_16x16x32_bf16 v[88:91], a[124:127], v[160:163], v[88:91]
 v_mfma_f32_16x16x32_bf16 v[96:99], a[204:207], v[160:163], v[96:99]
 v_mfma_f32_16x16x32_bf16 v[104:107], v[32:35], v[160:163], v[104:107]
 s_waitcnt vmcnt(0)
 s_barrier
 ds_read_b128 v[156:159], v68 offset:28672
 ds_read_b128 v[160:163], v68 offset:30720
 s_waitcnt lgkmcnt(4)
 v_mfma_f32_16x16x32_bf16 v[76:79], a[48:51], v[140:143], v[76:79]
 v_mfma_f32_16x16x32_bf16 v[84:87], a[128:131], v[140:143], v[84:87]
 v_mfma_f32_16x16x32_bf16 v[92:95], a[208:211], v[140:143], v[92:95]
 v_mfma_f32_16x16x32_bf16 v[100:103], v[36:39], v[140:143], v[100:103]
 v_mfma_f32_16x16x32_bf16 v[80:83], a[48:51], v[144:147], v[80:83]
 v_mfma_f32_16x16x32_bf16 v[88:91], a[128:131], v[144:147], v[88:91]
 v_mfma_f32_16x16x32_bf16 v[96:99], a[208:211], v[144:147], v[96:99]
 v_mfma_f32_16x16x32_bf16 v[104:107], v[36:39], v[144:147], v[104:107]
 ds_read_b128 v[140:143], v69 offset:28672
 ds_read_b128 v[144:147], v69 offset:30720
 s_waitcnt lgkmcnt(4)
 v_mfma_f32_16x16x32_bf16 v[76:79], a[52:55], v[148:151], v[76:79]
 v_mfma_f32_16x16x32_bf16 v[84:87], a[132:135], v[148:151], v[84:87]
 v_mfma_f32_16x16x32_bf16 v[92:95], a[212:215], v[148:151], v[92:95]
 v_mfma_f32_16x16x32_bf16 v[100:103], v[40:43], v[148:151], v[100:103]
 v_mfma_f32_16x16x32_bf16 v[80:83], a[52:55], v[152:155], v[80:83]
 v_mfma_f32_16x16x32_bf16 v[88:91], a[132:135], v[152:155], v[88:91]
 v_mfma_f32_16x16x32_bf16 v[96:99], a[212:215], v[152:155], v[96:99]
 v_mfma_f32_16x16x32_bf16 v[104:107], v[40:43], v[152:155], v[104:107]
 ds_read_b128 v[148:151], v68 offset:32768
 ds_read_b128 v[152:155], v68 offset:34816
 s_waitcnt lgkmcnt(4)
 v_mfma_f32_16x16x32_bf16 v[76:79], a[56:59], v[156:159], v[76:79]
 v_mfma_f32_16x16x32_bf16 v[84:87], a[136:139], v[156:159], v[84:87]
 v_mfma_f32_16x16x32_bf16 v[92:95], a[216:219], v[156:159], v[92:95]
 v_mfma_f32_16x16x32_bf16 v[100:103], v[44:47], v[156:159], v[100:103]
 v_mfma_f32_16x16x32_bf16 v[80:83], a[56:59], v[160:163], v[80:83]
 v_mfma_f32_16x16x32_bf16 v[88:91], a[136:139], v[160:163], v[88:91]
 v_mfma_f32_16x16x32_bf16 v[96:99], a[216:219], v[160:163], v[96:99]
 v_mfma_f32_16x16x32_bf16 v[104:107], v[44:47], v[160:163], v[104:107]
 ds_read_b128 v[156:159], v69 offset:32768
 ds_read_b128 v[160:163], v69 offset:34816
 s_waitcnt lgkmcnt(4)
 v_mfma_f32_16x16x32_bf16 v[76:79], a[60:63], v[140:143], v[76:79]
 v_mfma_f32_16x16x32_bf16 v[84:87], a[140:143], v[140:143], v[84:87]
 v_mfma_f32_16x16x32_bf16 v[92:95], a[220:223], v[140:143], v[92:95]
 v_mfma_f32_16x16x32_bf16 v[100:103], v[48:51], v[140:143], v[100:103]
 v_mfma_f32_16x16x32_bf16 v[80:83], a[60:63], v[144:147], v[80:83]
 v_mfma_f32_16x16x32_bf16 v[88:91], a[140:143], v[144:147], v[88:91]
 v_mfma_f32_16x16x32_bf16 v[96:99], a[220:223], v[144:147], v[96:99]
 v_mfma_f32_16x16x32_bf16 v[104:107], v[48:51], v[144:147], v[104:107]
 ds_read_b128 v[140:143], v68 offset:36864
 ds_read_b128 v[144:147], v68 offset:38912
 s_waitcnt lgkmcnt(4)
 v_mfma_f32_16x16x32_bf16 v[76:79], a[64:67], v[148:151], v[76:79]
 v_mfma_f32_16x16x32_bf16 v[84:87], a[144:147], v[148:151], v[84:87]
 v_mfma_f32_16x16x32_bf16 v[92:95], a[224:227], v[148:151], v[92:95]
 v_mfma_f32_16x16x32_bf16 v[100:103], v[52:55], v[148:151], v[100:103]
 v_mfma_f32_16x16x32_bf16 v[80:83], a[64:67], v[152:155], v[80:83]
 v_mfma_f32_16x16x32_bf16 v[88:91], a[144:147], v[152:155], v[88:91]
 v_mfma_f32_16x16x32_bf16 v[96:99], a[224:227], v[152:155], v[96:99]
 v_mfma_f32_16x16x32_bf16 v[104:107], v[52:55], v[152:155], v[104:107]
 ds_read_b128 v[148:151], v69 offset:36864
 ds_read_b128 v[152:155], v69 offset:38912
 s_waitcnt lgkmcnt(4)
 v_mfma_f32_16x16x32_bf16 v[76:79], a[68:71], v[156:159], v[76:79]
 v_mfma_f32_16x16x32_bf16 v[84:87], a[148:151], v[156:159], v[84:87]
 v_mfma_f32_16x16x32_bf16 v[92:95], a[228:231], v[156:159], v[92:95]
 v_mfma_f32_16x16x32_bf16 v[100:103], v[56:59], v[156:159], v[100:103]
 v_mfma_f32_16x16x32_bf16 v[80:83], a[68:71], v[160:163], v[80:83]
 v_mfma_f32_16x16x32_bf16 v[88:91], a[148:151], v[160:163], v[88:91]
 v_mfma_f32_16x16x32_bf16 v[96:99], a[228:231], v[160:163], v[96:99]
 v_mfma_f32_16x16x32_bf16 v[104:107], v[56:59], v[160:163], v[104:107]
 s_waitcnt lgkmcnt(3)
 v_mfma_f32_16x16x32_bf16 v[76:79], a[72:75], v[140:143], v[76:79]
 v_mfma_f32_16x16x32_bf16 v[84:87], a[152:155], v[140:143], v[84:87]
 v_mfma_f32_16x16x32_bf16 v[92:95], a[232:235], v[140:143], v[92:95]
 v_mfma_f32_16x16x32_bf16 v[100:103], v[60:63], v[140:143], v[100:103]
 s_waitcnt lgkmcnt(2)
 v_mfma_f32_16x16x32_bf16 v[80:83], a[72:75], v[144:147], v[80:83]
 v_mfma_f32_16x16x32_bf16 v[88:91], a[152:155], v[144:147], v[88:91]
 v_mfma_f32_16x16x32_bf16 v[96:99], a[232:235], v[144:147], v[96:99]
 v_mfma_f32_16x16x32_bf16 v[104:107], v[60:63], v[144:147], v[104:107]
 s_waitcnt lgkmcnt(1)
 v_mfma_f32_16x16x32_bf16 v[76:79], a[76:79], v[148:151], v[76:79]
 s_mov_b32 s50, s53
 v_mfma_f32_16x16x32_bf16 v[84:87], a[156:159], v[148:151], v[84:87]
 s_mov_b32 s48, s51
 v_mfma_f32_16x16x32_bf16 v[92:95], a[236:239], v[148:151], v[92:95]
 s_mov_b32 s49, s52
 v_mfma_f32_16x16x32_bf16 v[100:103], v[64:67], v[148:151], v[100:103]
 s_waitcnt lgkmcnt(0)
 v_mfma_f32_16x16x32_bf16 v[80:83], a[76:79], v[152:155], v[80:83]
 v_mfma_f32_16x16x32_bf16 v[88:91], a[156:159], v[152:155], v[88:91]
 v_mfma_f32_16x16x32_bf16 v[96:99], a[236:239], v[152:155], v[96:99]
 v_mfma_f32_16x16x32_bf16 v[104:107], v[64:67], v[152:155], v[104:107]
 s_branch Lqc_305
Lqd_311:
 s_endpgm
Lqc_305:
 v_cvt_pk_bf16_f32 v164, v76, v77
 v_cvt_pk_bf16_f32 v165, v78, v79
 v_cvt_pk_bf16_f32 v166, v84, v85
 v_cvt_pk_bf16_f32 v167, v86, v87
 buffer_store_dwordx4 v[164:167], v2, s[4:7], s50 offen offset:0 sc1
 v_cvt_pk_bf16_f32 v168, v80, v81
 v_cvt_pk_bf16_f32 v169, v82, v83
 v_cvt_pk_bf16_f32 v170, v88, v89
 v_cvt_pk_bf16_f32 v171, v90, v91
 buffer_store_dwordx4 v[168:171], v2, s[4:7], s50 offen offset:1024 sc1
 v_cvt_pk_bf16_f32 v172, v92, v93
 v_cvt_pk_bf16_f32 v173, v94, v95
 v_cvt_pk_bf16_f32 v174, v100, v101
 v_cvt_pk_bf16_f32 v175, v102, v103
 buffer_store_dwordx4 v[172:175], v2, s[4:7], s50 offen offset:2048 sc1
 v_cvt_pk_bf16_f32 v176, v96, v97
 v_cvt_pk_bf16_f32 v177, v98, v99
 v_cvt_pk_bf16_f32 v178, v104, v105
 v_cvt_pk_bf16_f32 v179, v106, v107
 buffer_store_dwordx4 v[176:179], v2, s[4:7], s50 offen offset:3072 sc1
 buffer_load_dword v72, v73, s[4:7], 0 offen sc1
 s_waitcnt vmcnt(1)
 s_mov_b64 exec, 1
 v_mov_b32 v74, s49
 buffer_store_dword v74, off, s[4:7], s48 sc1
 s_mov_b64 exec, -1
 s_cmp_ge_u32 s27, 128
 s_cbranch_scc1 Lqd_320
 s_waitcnt vmcnt(1)
 v_cmp_lt_u32 vcc, s41, v72
 s_nop 0
 s_cmp_eq_u64 vcc, -1
 s_cbranch_scc1 Lqs_321
 s_cmp_eq_u32 s40, 0
 s_cbranch_scc1 Lqs_321
 s_add_u32 s22, s41, 1
 s_mov_b32 s24, 0
Lw_322:
 s_add_u32 s24, s24, 1
 s_cmp_gt_u32 s24, 200000
 s_cbranch_scc1 L_fail
 buffer_load_dword v72, v73, s[4:7], 0 offen sc1
 s_waitcnt vmcnt(0)
 v_cmp_le_u32 vcc, s22, v72
 s_nop 0
 s_cmp_eq_u64 vcc, -1
 s_cbranch_scc0 Lw_322
Lqs_321:
 buffer_load_dword v72, v73, s[4:7], 0 offen sc1
 s_mov_b32 s42, 0
 s_add_u32 m0, s47, 0
 s_nop 0
 buffer_load_dwordx4 v3, s[4:7], s46 offen offset:0 sc1 lds
 s_add_u32 m0, s47, 3968
 s_nop 0
 buffer_load_dwordx4 v3, s[4:7], s46 offen offset:128 sc1 lds
 s_add_u32 m0, s47, 7936
 s_nop 0
 buffer_load_dwordx4 v3, s[4:7], s46 offen offset:256 sc1 lds
 s_add_u32 m0, s47, 11904
 s_nop 0
 buffer_load_dwordx4 v3, s[4:7], s46 offen offset:384 sc1 lds
 s_add_u32 m0, s47, 15872
 s_nop 0
 buffer_load_dwordx4 v3, s[4:7], s46 offen offset:512 sc1 lds
 s_add_u32 m0, s47, 19840
 s_nop 0
 buffer_load_dwordx4 v3, s[4:7], s46 offen offset:640 sc1 lds
 s_add_u32 m0, s47, 23808
 s_nop 0
 buffer_load_dwordx4 v3, s[4:7], s46 offen offset:768 sc1 lds
 s_add_u32 m0, s47, 27776
 s_nop 0
 buffer_load_dwordx4 v3, s[4:7], s46 offen offset:896 sc1 lds
 s_add_u32 m0, s47, 31744
 s_nop 0
 buffer_load_dwordx4 v3, s[4:7], s46 offen offset:1024 sc1 lds
 s_add_u32 m0, s47, 35712
 s_nop 0
 buffer_load_dwordx4 v3, s[4:7], s46 offen offset:1152 sc1 lds
 s_waitcnt vmcnt(9)
 s_barrier
 ds_read_b128 v[140:143], v70 offset:0
 ds_read_b128 v[144:147], v70 offset:2048
 ds_read_b128 v[148:151], v71 offset:0
 ds_read_b128 v[152:155], v71 offset:2048
 s_waitcnt vmcnt(7)
 s_barrier
 ds_read_b128 v[156:159], v70 offset:4096
 ds_read_b128 v[160:163], v70 offset:6144
 s_waitcnt lgkmcnt(5)
 v_mfma_f32_16x16x32_bf16 v[108:111], a[0:3], v[140:143], 0
 s_mul_i32 s19, s41, 393216
 v_mfma_f32_16x16x32_bf16 v[116:119], a[80:83], v[140:143], 0
 s_cmp_eq_u32 s40, 0
 v_mfma_f32_16x16x32_bf16 v[124:127], a[160:163], v[140:143], 0
 s_cselect_b32 s20, s43, s44
 v_mfma_f32_16x16x32_bf16 v[132:135], a[240:243], v[140:143], 0
 s_add_u32 s53, s19, s20
 s_waitcnt lgkmcnt(4)
 v_mfma_f32_16x16x32_bf16 v[112:115], a[0:3], v[144:147], 0
 s_lshl_b32 s51, s40, 16
 v_mfma_f32_16x16x32_bf16 v[120:123], a[80:83], v[144:147], 0
 s_add_u32 s51, s51, s45
 v_mfma_f32_16x16x32_bf16 v[128:131], a[160:163], v[144:147], 0
 s_add_u32 s52, s41, 1
 v_mfma_f32_16x16x32_bf16 v[136:139], a[240:243], v[144:147], 0
 ds_read_b128 v[140:143], v71 offset:4096
 ds_read_b128 v[144:147], v71 offset:6144
 s_waitcnt lgkmcnt(4)
 v_mfma_f32_16x16x32_bf16 v[108:111], a[4:7], v[148:151], v[108:111]
 s_add_u32 s27, s27, 1
 v_mfma_f32_16x16x32_bf16 v[116:119], a[84:87], v[148:151], v[116:119]
 s_sub_u32 s19, s27, 13
 v_mfma_f32_16x16x32_bf16 v[124:127], a[164:167], v[148:151], v[124:127]
 s_lshr_b32 s20, s19, 1
 v_mfma_f32_16x16x32_bf16 v[132:135], a[244:247], v[148:151], v[132:135]
 s_add_u32 s21, s20, 13
 v_mfma_f32_16x16x32_bf16 v[112:115], a[4:7], v[152:155], v[112:115]
 s_bitcmp1_b32 s19, 0
 v_mfma_f32_16x16x32_bf16 v[120:123], a[84:87], v[152:155], v[120:123]
 s_cselect_b32 s41, s21, s20
 v_mfma_f32_16x16x32_bf16 v[128:131], a[164:167], v[152:155], v[128:131]
 s_cselect_b32 s40, 0, 1
 v_mfma_f32_16x16x32_bf16 v[136:139], a[244:247], v[152:155], v[136:139]
 ds_read_b128 v[148:151], v70 offset:8192
 ds_read_b128 v[152:155], v70 offset:10240
 s_waitcnt lgkmcnt(4)
 v_mfma_f32_16x16x32_bf16 v[108:111], a[8:11], v[156:159], v[108:111]
 s_cmp_lt_u32 s27, 13
 v_mfma_f32_16x16x32_bf16 v[116:119], a[88:91], v[156:159], v[116:119]
 s_cselect_b32 s41, s27, s41
 v_mfma_f32_16x16x32_bf16 v[124:127], a[168:171], v[156:159], v[124:127]
 s_cselect_b32 s40, 0, s40
 v_mfma_f32_16x16x32_bf16 v[132:135], a[248:251], v[156:159], v[132:135]
 s_sub_u32 s19, s27, 64
 v_mfma_f32_16x16x32_bf16 v[112:115], a[8:11], v[160:163], v[112:115]
 s_cmp_ge_u32 s27, 115
 v_mfma_f32_16x16x32_bf16 v[120:123], a[88:91], v[160:163], v[120:123]
 s_cselect_b32 s41, s19, s41
 v_mfma_f32_16x16x32_bf16 v[128:131], a[168:171], v[160:163], v[128:131]
 s_cselect_b32 s40, 1, s40
 v_mfma_f32_16x16x32_bf16 v[136:139], a[248:251], v[160:163], v[136:139]
 ds_read_b128 v[156:159], v71 offset:8192
 ds_read_b128 v[160:163], v71 offset:10240
 s_waitcnt lgkmcnt(4)
 v_mfma_f32_16x16x32_bf16 v[108:111], a[12:15], v[140:143], v[108:111]
 s_mul_i32 s46, s41, 40960
 v_mfma_f32_16x16x32_bf16 v[116:119], a[92:95], v[140:143], v[116:119]
 s_cmp_eq_u32 s40, 0
 v_mfma_f32_16x16x32_bf16 v[124:127], a[172:175], v[140:143], v[124:127]
 s_cselect_b32 s19, 0, 2621440
 v_mfma_f32_16x16x32_bf16 v[132:135], a[252:255], v[140:143], v[132:135]
 s_add_u32 s46, s46, s19
 v_mfma_f32_16x16x32_bf16 v[112:115], a[12:15], v[144:147], v[112:115]
 s_add_u32 s46, s46, 184975360
 v_mfma_f32_16x16x32_bf16 v[120:123], a[92:95], v[144:147], v[120:123]
 s_xor_b32 s47, s47, 40960
 v_mfma_f32_16x16x32_bf16 v[128:131], a[172:175], v[144:147], v[128:131]
 v_mfma_f32_16x16x32_bf16 v[136:139], a[252:255], v[144:147], v[136:139]
 s_branch Lqm_317
Lqw_307:
 buffer_load_dword v72, v73, s[4:7], 0 offen sc1
 s_mov_b32 s42, 1
 s_waitcnt vmcnt(9)
 s_barrier
 ds_read_b128 v[140:143], v70 offset:0
 ds_read_b128 v[144:147], v70 offset:2048
 ds_read_b128 v[148:151], v71 offset:0
 ds_read_b128 v[152:155], v71 offset:2048
 s_waitcnt vmcnt(7)
 s_barrier
 ds_read_b128 v[156:159], v70 offset:4096
 ds_read_b128 v[160:163], v70 offset:6144
 s_waitcnt lgkmcnt(5)
 v_mfma_f32_16x16x32_bf16 v[108:111], a[0:3], v[140:143], 0
 v_cvt_pk_bf16_f32 v164, v76, v77
 v_cvt_pk_bf16_f32 v165, v78, v79
 v_mfma_f32_16x16x32_bf16 v[116:119], a[80:83], v[140:143], 0
 v_cvt_pk_bf16_f32 v166, v84, v85
 v_cvt_pk_bf16_f32 v167, v86, v87
 v_mfma_f32_16x16x32_bf16 v[124:127], a[160:163], v[140:143], 0
 buffer_store_dwordx4 v[164:167], v2, s[4:7], s50 offen offset:0 sc1
 s_mul_i32 s19, s41, 393216
 v_mfma_f32_16x16x32_bf16 v[132:135], a[240:243], v[140:143], 0
 s_cmp_eq_u32 s40, 0
 s_cselect_b32 s20, s43, s44
 s_waitcnt lgkmcnt(4)
 v_mfma_f32_16x16x32_bf16 v[112:115], a[0:3], v[144:147], 0
 s_add_u32 s53, s19, s20
 v_mfma_f32_16x16x32_bf16 v[120:123], a[80:83], v[144:147], 0
 s_lshl_b32 s51, s40, 16
 v_mfma_f32_16x16x32_bf16 v[128:131], a[160:163], v[144:147], 0
 s_add_u32 s51, s51, s45
 v_mfma_f32_16x16x32_bf16 v[136:139], a[240:243], v[144:147], 0
 s_add_u32 s52, s41, 1
 ds_read_b128 v[140:143], v71 offset:4096
 ds_read_b128 v[144:147], v71 offset:6144
 s_waitcnt lgkmcnt(4)
 v_mfma_f32_16x16x32_bf16 v[108:111], a[4:7], v[148:151], v[108:111]
 v_cvt_pk_bf16_f32 v168, v80, v81
 v_cvt_pk_bf16_f32 v169, v82, v83
 v_mfma_f32_16x16x32_bf16 v[116:119], a[84:87], v[148:151], v[116:119]
 v_cvt_pk_bf16_f32 v170, v88, v89
 v_cvt_pk_bf16_f32 v171, v90, v91
 v_mfma_f32_16x16x32_bf16 v[124:127], a[164:167], v[148:151], v[124:127]
 buffer_store_dwordx4 v[168:171], v2, s[4:7], s50 offen offset:1024 sc1
 s_add_u32 s27, s27, 1
 v_mfma_f32_16x16x32_bf16 v[132:135], a[244:247], v[148:151], v[132:135]
 s_sub_u32 s19, s27, 13
 s_lshr_b32 s20, s19, 1
 v_mfma_f32_16x16x32_bf16 v[112:115], a[4:7], v[152:155], v[112:115]
 s_add_u32 s21, s20, 13
 v_mfma_f32_16x16x32_bf16 v[120:123], a[84:87], v[152:155], v[120:123]
 s_bitcmp1_b32 s19, 0
 v_mfma_f32_16x16x32_bf16 v[128:131], a[164:167], v[152:155], v[128:131]
 s_cselect_b32 s41, s21, s20
 v_mfma_f32_16x16x32_bf16 v[136:139], a[244:247], v[152:155], v[136:139]
 s_cselect_b32 s40, 0, 1
 ds_read_b128 v[148:151], v70 offset:8192
 ds_read_b128 v[152:155], v70 offset:10240
 s_waitcnt lgkmcnt(4)
 v_mfma_f32_16x16x32_bf16 v[108:111], a[8:11], v[156:159], v[108:111]
 v_cvt_pk_bf16_f32 v172, v92, v93
 v_cvt_pk_bf16_f32 v173, v94, v95
 v_mfma_f32_16x16x32_bf16 v[116:119], a[88:91], v[156:159], v[116:119]
 v_cvt_pk_bf16_f32 v174, v100, v101
 v_cvt_pk_bf16_f32 v175, v102, v103
 v_mfma_f32_16x16x32_bf16 v[124:127], a[168:171], v[156:159], v[124:127]
 buffer_store_dwordx4 v[172:175], v2, s[4:7], s50 offen offset:2048 sc1
 s_cmp_lt_u32 s27, 13
 v_mfma_f32_16x16x32_bf16 v[132:135], a[248:251], v[156:159], v[132:135]
 s_cselect_b32 s41, s27, s41
 s_cselect_b32 s40, 0, s40
 v_mfma_f32_16x16x32_bf16 v[112:115], a[8:11], v[160:163], v[112:115]
 s_sub_u32 s19, s27, 64
 v_mfma_f32_16x16x32_bf16 v[120:123], a[88:91], v[160:163], v[120:123]
 s_cmp_ge_u32 s27, 115
 v_mfma_f32_16x16x32_bf16 v[128:131], a[168:171], v[160:163], v[128:131]
 s_cselect_b32 s41, s19, s41
 v_mfma_f32_16x16x32_bf16 v[136:139], a[248:251], v[160:163], v[136:139]
 s_cselect_b32 s40, 1, s40
 ds_read_b128 v[156:159], v71 offset:8192
 ds_read_b128 v[160:163], v71 offset:10240
 s_waitcnt lgkmcnt(4)
 v_mfma_f32_16x16x32_bf16 v[108:111], a[12:15], v[140:143], v[108:111]
 v_cvt_pk_bf16_f32 v176, v96, v97
 v_cvt_pk_bf16_f32 v177, v98, v99
 v_mfma_f32_16x16x32_bf16 v[116:119], a[92:95], v[140:143], v[116:119]
 v_cvt_pk_bf16_f32 v178, v104, v105
 v_cvt_pk_bf16_f32 v179, v106, v107
 v_mfma_f32_16x16x32_bf16 v[124:127], a[172:175], v[140:143], v[124:127]
 buffer_store_dwordx4 v[176:179], v2, s[4:7], s50 offen offset:3072 sc1
 s_mul_i32 s46, s41, 40960
 v_mfma_f32_16x16x32_bf16 v[132:135], a[252:255], v[140:143], v[132:135]
 s_cmp_eq_u32 s40, 0
 v_mfma_f32_16x16x32_bf16 v[112:115], a[12:15], v[144:147], v[112:115]
 s_cselect_b32 s19, 0, 2621440
 v_mfma_f32_16x16x32_bf16 v[120:123], a[92:95], v[144:147], v[120:123]
 s_add_u32 s46, s46, s19
 v_mfma_f32_16x16x32_bf16 v[128:131], a[172:175], v[144:147], v[128:131]
 s_add_u32 s46, s46, 184975360
 v_mfma_f32_16x16x32_bf16 v[136:139], a[252:255], v[144:147], v[136:139]
 s_xor_b32 s47, s47, 40960
Lqm_317:
 s_waitcnt vmcnt(5)
 s_barrier
 ds_read_b128 v[140:143], v70 offset:12288
 ds_read_b128 v[144:147], v70 offset:14336
 s_waitcnt lgkmcnt(4)
 v_mfma_f32_16x16x32_bf16 v[108:111], a[16:19], v[148:151], v[108:111]
 v_mfma_f32_16x16x32_bf16 v[116:119], a[96:99], v[148:151], v[116:119]
 v_mfma_f32_16x16x32_bf16 v[124:127], a[176:179], v[148:151], v[124:127]
 v_mfma_f32_16x16x32_bf16 v[132:135], v[4:7], v[148:151], v[132:135]
 v_mfma_f32_16x16x32_bf16 v[112:115], a[16:19], v[152:155], v[112:115]
 v_mfma_f32_16x16x32_bf16 v[120:123], a[96:99], v[152:155], v[120:123]
 v_mfma_f32_16x16x32_bf16 v[128:131], a[176:179], v[152:155], v[128:131]
 v_mfma_f32_16x16x32_bf16 v[136:139], v[4:7], v[152:155], v[136:139]
 ds_read_b128 v[148:151], v71 offset:12288
 ds_read_b128 v[152:155], v71 offset:14336
 s_waitcnt lgkmcnt(4)
 v_mfma_f32_16x16x32_bf16 v[108:111], a[20:23], v[156:159], v[108:111]
 v_mfma_f32_16x16x32_bf16 v[116:119], a[100:103], v[156:159], v[116:119]
 v_mfma_f32_16x16x32_bf16 v[124:127], a[180:183], v[156:159], v[124:127]
 v_mfma_f32_16x16x32_bf16 v[132:135], v[8:11], v[156:159], v[132:135]
 v_mfma_f32_16x16x32_bf16 v[112:115], a[20:23], v[160:163], v[112:115]
 v_mfma_f32_16x16x32_bf16 v[120:123], a[100:103], v[160:163], v[120:123]
 v_mfma_f32_16x16x32_bf16 v[128:131], a[180:183], v[160:163], v[128:131]
 v_mfma_f32_16x16x32_bf16 v[136:139], v[8:11], v[160:163], v[136:139]
 ds_read_b128 v[156:159], v70 offset:16384
 ds_read_b128 v[160:163], v70 offset:18432
 s_waitcnt lgkmcnt(4)
 v_mfma_f32_16x16x32_bf16 v[108:111], a[24:27], v[140:143], v[108:111]
 v_mfma_f32_16x16x32_bf16 v[116:119], a[104:107], v[140:143], v[116:119]
 v_mfma_f32_16x16x32_bf16 v[124:127], a[184:187], v[140:143], v[124:127]
 v_mfma_f32_16x16x32_bf16 v[132:135], v[12:15], v[140:143], v[132:135]
 v_mfma_f32_16x16x32_bf16 v[112:115], a[24:27], v[144:147], v[112:115]
 v_mfma_f32_16x16x32_bf16 v[120:123], a[104:107], v[144:147], v[120:123]
 v_mfma_f32_16x16x32_bf16 v[128:131], a[184:187], v[144:147], v[128:131]
 v_mfma_f32_16x16x32_bf16 v[136:139], v[12:15], v[144:147], v[136:139]
 s_cmp_ge_u32 s27, 128
 s_cbranch_scc1 Lqp_319
 s_cmp_eq_u32 s40, 0
 s_cbranch_scc1 Lqo_323
 s_waitcnt vmcnt(4)
 v_cmp_lt_u32 vcc, s41, v72
 s_nop 0
 s_cmp_eq_u64 vcc, -1
 s_cbranch_scc0 Lqp_319
Lqo_323:
 ds_read_b128 v[140:143], v71 offset:16384
 ds_read_b128 v[144:147], v71 offset:18432
 s_waitcnt lgkmcnt(4)
 v_mfma_f32_16x16x32_bf16 v[108:111], a[28:31], v[148:151], v[108:111]
 s_add_u32 m0, s47, 0
 v_mfma_f32_16x16x32_bf16 v[116:119], a[108:111], v[148:151], v[116:119]
 buffer_load_dwordx4 v3, s[4:7], s46 offen offset:0 sc1 lds
 v_mfma_f32_16x16x32_bf16 v[124:127], a[188:191], v[148:151], v[124:127]
 v_mfma_f32_16x16x32_bf16 v[132:135], v[16:19], v[148:151], v[132:135]
 v_mfma_f32_16x16x32_bf16 v[112:115], a[28:31], v[152:155], v[112:115]
 v_mfma_f32_16x16x32_bf16 v[120:123], a[108:111], v[152:155], v[120:123]
 v_mfma_f32_16x16x32_bf16 v[128:131], a[188:191], v[152:155], v[128:131]
 v_mfma_f32_16x16x32_bf16 v[136:139], v[16:19], v[152:155], v[136:139]
 s_waitcnt vmcnt(4)
 s_barrier
 ds_read_b128 v[148:151], v70 offset:20480
 ds_read_b128 v[152:155], v70 offset:22528
 s_waitcnt lgkmcnt(4)
 v_mfma_f32_16x16x32_bf16 v[108:111], a[32:35], v[156:159], v[108:111]
 s_add_u32 m0, s47, 3968
 v_mfma_f32_16x16x32_bf16 v[116:119], a[112:115], v[156:159], v[116:119]
 buffer_load_dwordx4 v3, s[4:7], s46 offen offset:128 sc1 lds
 v_mfma_f32_16x16x32_bf16 v[124:127], a[192:195], v[156:159], v[124:127]
 v_mfma_f32_16x16x32_bf16 v[132:135], v[20:23], v[156:159], v[132:135]
 v_mfma_f32_16x16x32_bf16 v[112:115], a[32:35], v[160:163], v[112:115]
 v_mfma_f32_16x16x32_bf16 v[120:123], a[112:115], v[160:163], v[120:123]
 v_mfma_f32_16x16x32_bf16 v[128:131], a[192:195], v[160:163], v[128:131]
 v_mfma_f32_16x16x32_bf16 v[136:139], v[20:23], v[160:163], v[136:139]
 ds_read_b128 v[156:159], v71 offset:20480
 ds_read_b128 v[160:163], v71 offset:22528
 s_waitcnt lgkmcnt(4)
 v_mfma_f32_16x16x32_bf16 v[108:111], a[36:39], v[140:143], v[108:111]
 s_add_u32 m0, s47, 7936
 v_mfma_f32_16x16x32_bf16 v[116:119], a[116:119], v[140:143], v[116:119]
 buffer_load_dwordx4 v3, s[4:7], s46 offen offset:256 sc1 lds
 v_mfma_f32_16x16x32_bf16 v[124:127], a[196:199], v[140:143], v[124:127]
 v_mfma_f32_16x16x32_bf16 v[132:135], v[24:27], v[140:143], v[132:135]
 v_mfma_f32_16x16x32_bf16 v[112:115], a[36:39], v[144:147], v[112:115]
 v_mfma_f32_16x16x32_bf16 v[120:123], a[116:119], v[144:147], v[120:123]
 v_mfma_f32_16x16x32_bf16 v[128:131], a[196:199], v[144:147], v[128:131]
 v_mfma_f32_16x16x32_bf16 v[136:139], v[24:27], v[144:147], v[136:139]
 ds_read_b128 v[140:143], v70 offset:24576
 ds_read_b128 v[144:147], v70 offset:26624
 s_waitcnt lgkmcnt(4)
 v_mfma_f32_16x16x32_bf16 v[108:111], a[40:43], v[148:151], v[108:111]
 s_add_u32 m0, s47, 11904
 v_mfma_f32_16x16x32_bf16 v[116:119], a[120:123], v[148:151], v[116:119]
 buffer_load_dwordx4 v3, s[4:7], s46 offen offset:384 sc1 lds
 v_mfma_f32_16x16x32_bf16 v[124:127], a[200:203], v[148:151], v[124:127]
 v_mfma_f32_16x16x32_bf16 v[132:135], v[28:31], v[148:151], v[132:135]
 v_mfma_f32_16x16x32_bf16 v[112:115], a[40:43], v[152:155], v[112:115]
 v_mfma_f32_16x16x32_bf16 v[120:123], a[120:123], v[152:155], v[120:123]
 v_mfma_f32_16x16x32_bf16 v[128:131], a[200:203], v[152:155], v[128:131]
 v_mfma_f32_16x16x32_bf16 v[136:139], v[28:31], v[152:155], v[136:139]
 s_cmp_eq_u32 s42, 1
 s_cbranch_scc0 Lqn_324
 s_waitcnt vmcnt(4)
 s_mov_b64 exec, 1
 v_mov_b32 v74, s49
 buffer_store_dword v74, off, s[4:7], s48 sc1
 s_mov_b64 exec, -1
Lqn_324:
 ds_read_b128 v[148:151], v71 offset:24576
 ds_read_b128 v[152:155], v71 offset:26624
 s_waitcnt lgkmcnt(4)
 v_mfma_f32_16x16x32_bf16 v[108:111], a[44:47], v[156:159], v[108:111]
 s_add_u32 m0, s47, 15872
 v_mfma_f32_16x16x32_bf16 v[116:119], a[124:127], v[156:159], v[116:119]
 buffer_load_dwordx4 v3, s[4:7], s46 offen offset:512 sc1 lds
 v_mfma_f32_16x16x32_bf16 v[124:127], a[204:207], v[156:159], v[124:127]
 v_mfma_f32_16x16x32_bf16 v[132:135], v[32:35], v[156:159], v[132:135]
 v_mfma_f32_16x16x32_bf16 v[112:115], a[44:47], v[160:163], v[112:115]
 v_mfma_f32_16x16x32_bf16 v[120:123], a[124:127], v[160:163], v[120:123]
 v_mfma_f32_16x16x32_bf16 v[128:131], a[204:207], v[160:163], v[128:131]
 v_mfma_f32_16x16x32_bf16 v[136:139], v[32:35], v[160:163], v[136:139]
 s_waitcnt vmcnt(5)
 s_barrier
 ds_read_b128 v[156:159], v70 offset:28672
 ds_read_b128 v[160:163], v70 offset:30720
 s_waitcnt lgkmcnt(4)
 v_mfma_f32_16x16x32_bf16 v[108:111], a[48:51], v[140:143], v[108:111]
 s_add_u32 m0, s47, 19840
 v_mfma_f32_16x16x32_bf16 v[116:119], a[128:131], v[140:143], v[116:119]
 buffer_load_dwordx4 v3, s[4:7], s46 offen offset:640 sc1 lds
 v_mfma_f32_16x16x32_bf16 v[124:127], a[208:211], v[140:143], v[124:127]
 v_mfma_f32_16x16x32_bf16 v[132:135], v[36:39], v[140:143], v[132:135]
 v_mfma_f32_16x16x32_bf16 v[112:115], a[48:51], v[144:147], v[112:115]
 v_mfma_f32_16x16x32_bf16 v[120:123], a[128:131], v[144:147], v[120:123]
 v_mfma_f32_16x16x32_bf16 v[128:131], a[208:211], v[144:147], v[128:131]
 v_mfma_f32_16x16x32_bf16 v[136:139], v[36:39], v[144:147], v[136:139]
 ds_read_b128 v[140:143], v71 offset:28672
 ds_read_b128 v[144:147], v71 offset:30720
 s_waitcnt lgkmcnt(4)
 v_mfma_f32_16x16x32_bf16 v[108:111], a[52:55], v[148:151], v[108:111]
 s_add_u32 m0, s47, 23808
 v_mfma_f32_16x16x32_bf16 v[116:119], a[132:135], v[148:151], v[116:119]
 buffer_load_dwordx4 v3, s[4:7], s46 offen offset:768 sc1 lds
 v_mfma_f32_16x16x32_bf16 v[124:127], a[212:215], v[148:151], v[124:127]
 v_mfma_f32_16x16x32_bf16 v[132:135], v[40:43], v[148:151], v[132:135]
 v_mfma_f32_16x16x32_bf16 v[112:115], a[52:55], v[152:155], v[112:115]
 v_mfma_f32_16x16x32_bf16 v[120:123], a[132:135], v[152:155], v[120:123]
 v_mfma_f32_16x16x32_bf16 v[128:131], a[212:215], v[152:155], v[128:131]
 v_mfma_f32_16x16x32_bf16 v[136:139], v[40:43], v[152:155], v[136:139]
 ds_read_b128 v[148:151], v70 offset:32768
 ds_read_b128 v[152:155], v70 offset:34816
 s_waitcnt lgkmcnt(4)
 v_mfma_f32_16x16x32_bf16 v[108:111], a[56:59], v[156:159], v[108:111]
 s_add_u32 m0, s47, 27776
 v_mfma_f32_16x16x32_bf16 v[116:119], a[136:139], v[156:159], v[116:119]
 buffer_load_dwordx4 v3, s[4:7], s46 offen offset:896 sc1 lds
 v_mfma_f32_16x16x32_bf16 v[124:127], a[216:219], v[156:159], v[124:127]
 v_mfma_f32_16x16x32_bf16 v[132:135], v[44:47], v[156:159], v[132:135]
 v_mfma_f32_16x16x32_bf16 v[112:115], a[56:59], v[160:163], v[112:115]
 v_mfma_f32_16x16x32_bf16 v[120:123], a[136:139], v[160:163], v[120:123]
 v_mfma_f32_16x16x32_bf16 v[128:131], a[216:219], v[160:163], v[128:131]
 v_mfma_f32_16x16x32_bf16 v[136:139], v[44:47], v[160:163], v[136:139]
 ds_read_b128 v[156:159], v71 offset:32768
 ds_read_b128 v[160:163], v71 offset:34816
 s_waitcnt lgkmcnt(4)
 v_mfma_f32_16x16x32_bf16 v[108:111], a[60:63], v[140:143], v[108:111]
 s_add_u32 m0, s47, 31744
 v_mfma_f32_16x16x32_bf16 v[116:119], a[140:143], v[140:143], v[116:119]
 buffer_load_dwordx4 v3, s[4:7], s46 offen offset:1024 sc1 lds
 v_mfma_f32_16x16x32_bf16 v[124:127], a[220:223], v[140:143], v[124:127]
 v_mfma_f32_16x16x32_bf16 v[132:135], v[48:51], v[140:143], v[132:135]
 v_mfma_f32_16x16x32_bf16 v[112:115], a[60:63], v[144:147], v[112:115]
 v_mfma_f32_16x16x32_bf16 v[120:123], a[140:143], v[144:147], v[120:123]
 v_mfma_f32_16x16x32_bf16 v[128:131], a[220:223], v[144:147], v[128:131]
 v_mfma_f32_16x16x32_bf16 v[136:139], v[48:51], v[144:147], v[136:139]
 ds_read_b128 v[140:143], v70 offset:36864
 ds_read_b128 v[144:147], v70 offset:38912
 s_waitcnt lgkmcnt(4)
 v_mfma_f32_16x16x32_bf16 v[108:111], a[64:67], v[148:151], v[108:111]
 s_add_u32 m0, s47, 35712
 v_mfma_f32_16x16x32_bf16 v[116:119], a[144:147], v[148:151], v[116:119]
 buffer_load_dwordx4 v3, s[4:7], s46 offen offset:1152 sc1 lds
 v_mfma_f32_16x16x32_bf16 v[124:127], a[224:227], v[148:151], v[124:127]
 v_mfma_f32_16x16x32_bf16 v[132:135], v[52:55], v[148:151], v[132:135]
 v_mfma_f32_16x16x32_bf16 v[112:115], a[64:67], v[152:155], v[112:115]
 v_mfma_f32_16x16x32_bf16 v[120:123], a[144:147], v[152:155], v[120:123]
 v_mfma_f32_16x16x32_bf16 v[128:131], a[224:227], v[152:155], v[128:131]
 v_mfma_f32_16x16x32_bf16 v[136:139], v[52:55], v[152:155], v[136:139]
 ds_read_b128 v[148:151], v71 offset:36864
 ds_read_b128 v[152:155], v71 offset:38912
 s_waitcnt lgkmcnt(4)
 v_mfma_f32_16x16x32_bf16 v[108:111], a[68:71], v[156:159], v[108:111]
 v_mfma_f32_16x16x32_bf16 v[116:119], a[148:151], v[156:159], v[116:119]
 v_mfma_f32_16x16x32_bf16 v[124:127], a[228:231], v[156:159], v[124:127]
 v_mfma_f32_16x16x32_bf16 v[132:135], v[56:59], v[156:159], v[132:135]
 v_mfma_f32_16x16x32_bf16 v[112:115], a[68:71], v[160:163], v[112:115]
 v_mfma_f32_16x16x32_bf16 v[120:123], a[148:151], v[160:163], v[120:123]
 v_mfma_f32_16x16x32_bf16 v[128:131], a[228:231], v[160:163], v[128:131]
 v_mfma_f32_16x16x32_bf16 v[136:139], v[56:59], v[160:163], v[136:139]
 s_waitcnt lgkmcnt(3)
 v_mfma_f32_16x16x32_bf16 v[108:111], a[72:75], v[140:143], v[108:111]
 v_mfma_f32_16x16x32_bf16 v[116:119], a[152:155], v[140:143], v[116:119]
 v_mfma_f32_16x16x32_bf16 v[124:127], a[232:235], v[140:143], v[124:127]
 v_mfma_f32_16x16x32_bf16 v[132:135], v[60:63], v[140:143], v[132:135]
 s_waitcnt lgkmcnt(2)
 v_mfma_f32_16x16x32_bf16 v[112:115], a[72:75], v[144:147], v[112:115]
 v_mfma_f32_16x16x32_bf16 v[120:123], a[152:155], v[144:147], v[120:123]
 v_mfma_f32_16x16x32_bf16 v[128:131], a[232:235], v[144:147], v[128:131]
 v_mfma_f32_16x16x32_bf16 v[136:139], v[60:63], v[144:147], v[136:139]
 s_waitcnt lgkmcnt(1)
 v_mfma_f32_16x16x32_bf16 v[108:111], a[76:79], v[148:151], v[108:111]
 s_mov_b32 s50, s53
 v_mfma_f32_16x16x32_bf16 v[116:119], a[156:159], v[148:151], v[116:119]
 s_mov_b32 s48, s51
 v_mfma_f32_16x16x32_bf16 v[124:127], a[236:239], v[148:151], v[124:127]
 s_mov_b32 s49, s52
 v_mfma_f32_16x16x32_bf16 v[132:135], v[64:67], v[148:151], v[132:135]
 s_waitcnt lgkmcnt(0)
 v_mfma_f32_16x16x32_bf16 v[112:115], a[76:79], v[152:155], v[112:115]
 v_mfma_f32_16x16x32_bf16 v[120:123], a[156:159], v[152:155], v[120:123]
 v_mfma_f32_16x16x32_bf16 v[128:131], a[236:239], v[152:155], v[128:131]
 v_mfma_f32_16x16x32_bf16 v[136:139], v[64:67], v[152:155], v[136:139]
 s_branch Lqw_306
Lqp_319:
 ds_read_b128 v[140:143], v71 offset:16384
 ds_read_b128 v[144:147], v71 offset:18432
 s_waitcnt lgkmcnt(4)
 v_mfma_f32_16x16x32_bf16 v[108:111], a[28:31], v[148:151], v[108:111]
 v_mfma_f32_16x16x32_bf16 v[116:119], a[108:111], v[148:151], v[116:119]
 v_mfma_f32_16x16x32_bf16 v[124:127], a[188:191], v[148:151], v[124:127]
 v_mfma_f32_16x16x32_bf16 v[132:135], v[16:19], v[148:151], v[132:135]
 v_mfma_f32_16x16x32_bf16 v[112:115], a[28:31], v[152:155], v[112:115]
 v_mfma_f32_16x16x32_bf16 v[120:123], a[108:111], v[152:155], v[120:123]
 v_mfma_f32_16x16x32_bf16 v[128:131], a[188:191], v[152:155], v[128:131]
 v_mfma_f32_16x16x32_bf16 v[136:139], v[16:19], v[152:155], v[136:139]
 s_waitcnt vmcnt(3)
 s_barrier
 ds_read_b128 v[148:151], v70 offset:20480
 ds_read_b128 v[152:155], v70 offset:22528
 s_waitcnt lgkmcnt(4)
 v_mfma_f32_16x16x32_bf16 v[108:111], a[32:35], v[156:159], v[108:111]
 v_mfma_f32_16x16x32_bf16 v[116:119], a[112:115], v[156:159], v[116:119]
 v_mfma_f32_16x16x32_bf16 v[124:127], a[192:195], v[156:159], v[124:127]
 v_mfma_f32_16x16x32_bf16 v[132:135], v[20:23], v[156:159], v[132:135]
 v_mfma_f32_16x16x32_bf16 v[112:115], a[32:35], v[160:163], v[112:115]
 v_mfma_f32_16x16x32_bf16 v[120:123], a[112:115], v[160:163], v[120:123]
 v_mfma_f32_16x16x32_bf16 v[128:131], a[192:195], v[160:163], v[128:131]
 v_mfma_f32_16x16x32_bf16 v[136:139], v[20:23], v[160:163], v[136:139]
 ds_read_b128 v[156:159], v71 offset:20480
 ds_read_b128 v[160:163], v71 offset:22528
 s_waitcnt lgkmcnt(4)
 v_mfma_f32_16x16x32_bf16 v[108:111], a[36:39], v[140:143], v[108:111]
 v_mfma_f32_16x16x32_bf16 v[116:119], a[116:119], v[140:143], v[116:119]
 v_mfma_f32_16x16x32_bf16 v[124:127], a[196:199], v[140:143], v[124:127]
 v_mfma_f32_16x16x32_bf16 v[132:135], v[24:27], v[140:143], v[132:135]
 v_mfma_f32_16x16x32_bf16 v[112:115], a[36:39], v[144:147], v[112:115]
 v_mfma_f32_16x16x32_bf16 v[120:123], a[116:119], v[144:147], v[120:123]
 v_mfma_f32_16x16x32_bf16 v[128:131], a[196:199], v[144:147], v[128:131]
 v_mfma_f32_16x16x32_bf16 v[136:139], v[24:27], v[144:147], v[136:139]
 ds_read_b128 v[140:143], v70 offset:24576
 ds_read_b128 v[144:147], v70 offset:26624
 s_waitcnt lgkmcnt(4)
 v_mfma_f32_16x16x32_bf16 v[108:111], a[40:43], v[148:151], v[108:111]
 v_mfma_f32_16x16x32_bf16 v[116:119], a[120:123], v[148:151], v[116:119]
 v_mfma_f32_16x16x32_bf16 v[124:127], a[200:203], v[148:151], v[124:127]
 v_mfma_f32_16x16x32_bf16 v[132:135], v[28:31], v[148:151], v[132:135]
 v_mfma_f32_16x16x32_bf16 v[112:115], a[40:43], v[152:155], v[112:115]
 v_mfma_f32_16x16x32_bf16 v[120:123], a[120:123], v[152:155], v[120:123]
 v_mfma_f32_16x16x32_bf16 v[128:131], a[200:203], v[152:155], v[128:131]
 v_mfma_f32_16x16x32_bf16 v[136:139], v[28:31], v[152:155], v[136:139]
 s_cmp_eq_u32 s42, 1
 s_cbranch_scc0 Lqn_325
 s_waitcnt vmcnt(0)
 s_mov_b64 exec, 1
 v_mov_b32 v74, s49
 buffer_store_dword v74, off, s[4:7], s48 sc1
 s_mov_b64 exec, -1
Lqn_325:
 ds_read_b128 v[148:151], v71 offset:24576
 ds_read_b128 v[152:155], v71 offset:26624
 s_waitcnt lgkmcnt(4)
 v_mfma_f32_16x16x32_bf16 v[108:111], a[44:47], v[156:159], v[108:111]
 v_mfma_f32_16x16x32_bf16 v[116:119], a[124:127], v[156:159], v[116:119]
 v_mfma_f32_16x16x32_bf16 v[124:127], a[204:207], v[156:159], v[124:127]
 v_mfma_f32_16x16x32_bf16 v[132:135], v[32:35], v[156:159], v[132:135]
 v_mfma_f32_16x16x32_bf16 v[112:115], a[44:47], v[160:163], v[112:115]
 v_mfma_f32_16x16x32_bf16 v[120:123], a[124:127], v[160:163], v[120:123]
 v_mfma_f32_16x16x32_bf16 v[128:131], a[204:207], v[160:163], v[128:131]
 v_mfma_f32_16x16x32_bf16 v[136:139], v[32:35], v[160:163], v[136:139]
 s_waitcnt vmcnt(0)
 s_barrier
 ds_read_b128 v[156:159], v70 offset:28672
 ds_read_b128 v[160:163], v70 offset:30720
 s_waitcnt lgkmcnt(4)
 v_mfma_f32_16x16x32_bf16 v[108:111], a[48:51], v[140:143], v[108:111]
 v_mfma_f32_16x16x32_bf16 v[116:119], a[128:131], v[140:143], v[116:119]
 v_mfma_f32_16x16x32_bf16 v[124:127], a[208:211], v[140:143], v[124:127]
 v_mfma_f32_16x16x32_bf16 v[132:135], v[36:39], v[140:143], v[132:135]
 v_mfma_f32_16x16x32_bf16 v[112:115], a[48:51], v[144:147], v[112:115]
 v_mfma_f32_16x16x32_bf16 v[120:123], a[128:131], v[144:147], v[120:123]
 v_mfma_f32_16x16x32_bf16 v[128:131], a[208:211], v[144:147], v[128:131]
 v_mfma_f32_16x16x32_bf16 v[136:139], v[36:39], v[144:147], v[136:139]
 ds_read_b128 v[140:143], v71 offset:28672
 ds_read_b128 v[144:147], v71 offset:30720
 s_waitcnt lgkmcnt(4)
 v_mfma_f32_16x16x32_bf16 v[108:111], a[52:55], v[148:151], v[108:111]
 v_mfma_f32_16x16x32_bf16 v[116:119], a[132:135], v[148:151], v[116:119]
 v_mfma_f32_16x16x32_bf16 v[124:127], a[212:215], v[148:151], v[124:127]
 v_mfma_f32_16x16x32_bf16 v[132:135], v[40:43], v[148:151], v[132:135]
 v_mfma_f32_16x16x32_bf16 v[112:115], a[52:55], v[152:155], v[112:115]
 v_mfma_f32_16x16x32_bf16 v[120:123], a[132:135], v[152:155], v[120:123]
 v_mfma_f32_16x16x32_bf16 v[128:131], a[212:215], v[152:155], v[128:131]
 v_mfma_f32_16x16x32_bf16 v[136:139], v[40:43], v[152:155], v[136:139]
 ds_read_b128 v[148:151], v70 offset:32768
 ds_read_b128 v[152:155], v70 offset:34816
 s_waitcnt lgkmcnt(4)
 v_mfma_f32_16x16x32_bf16 v[108:111], a[56:59], v[156:159], v[108:111]
 v_mfma_f32_16x16x32_bf16 v[116:119], a[136:139], v[156:159], v[116:119]
 v_mfma_f32_16x16x32_bf16 v[124:127], a[216:219], v[156:159], v[124:127]
 v_mfma_f32_16x16x32_bf16 v[132:135], v[44:47], v[156:159], v[132:135]
 v_mfma_f32_16x16x32_bf16 v[112:115], a[56:59], v[160:163], v[112:115]
 v_mfma_f32_16x16x32_bf16 v[120:123], a[136:139], v[160:163], v[120:123]
 v_mfma_f32_16x16x32_bf16 v[128:131], a[216:219], v[160:163], v[128:131]
 v_mfma_f32_16x16x32_bf16 v[136:139], v[44:47], v[160:163], v[136:139]
 ds_read_b128 v[156:159], v71 offset:32768
 ds_read_b128 v[160:163], v71 offset:34816
 s_waitcnt lgkmcnt(4)
 v_mfma_f32_16x16x32_bf16 v[108:111], a[60:63], v[140:143], v[108:111]
 v_mfma_f32_16x16x32_bf16 v[116:119], a[140:143], v[140:143], v[116:119]
 v_mfma_f32_16x16x32_bf16 v[124:127], a[220:223], v[140:143], v[124:127]
 v_mfma_f32_16x16x32_bf16 v[132:135], v[48:51], v[140:143], v[132:135]
 v_mfma_f32_16x16x32_bf16 v[112:115], a[60:63], v[144:147], v[112:115]
 v_mfma_f32_16x16x32_bf16 v[120:123], a[140:143], v[144:147], v[120:123]
 v_mfma_f32_16x16x32_bf16 v[128:131], a[220:223], v[144:147], v[128:131]
 v_mfma_f32_16x16x32_bf16 v[136:139], v[48:51], v[144:147], v[136:139]
 ds_read_b128 v[140:143], v70 offset:36864
 ds_read_b128 v[144:147], v70 offset:38912
 s_waitcnt lgkmcnt(4)
 v_mfma_f32_16x16x32_bf16 v[108:111], a[64:67], v[148:151], v[108:111]
 v_mfma_f32_16x16x32_bf16 v[116:119], a[144:147], v[148:151], v[116:119]
 v_mfma_f32_16x16x32_bf16 v[124:127], a[224:227], v[148:151], v[124:127]
 v_mfma_f32_16x16x32_bf16 v[132:135], v[52:55], v[148:151], v[132:135]
 v_mfma_f32_16x16x32_bf16 v[112:115], a[64:67], v[152:155], v[112:115]
 v_mfma_f32_16x16x32_bf16 v[120:123], a[144:147], v[152:155], v[120:123]
 v_mfma_f32_16x16x32_bf16 v[128:131], a[224:227], v[152:155], v[128:131]
 v_mfma_f32_16x16x32_bf16 v[136:139], v[52:55], v[152:155], v[136:139]
 ds_read_b128 v[148:151], v71 offset:36864
 ds_read_b128 v[152:155], v71 offset:38912
 s_waitcnt lgkmcnt(4)
 v_mfma_f32_16x16x32_bf16 v[108:111], a[68:71], v[156:159], v[108:111]
 v_mfma_f32_16x16x32_bf16 v[116:119], a[148:151], v[156:159], v[116:119]
 v_mfma_f32_16x16x32_bf16 v[124:127], a[228:231], v[156:159], v[124:127]
 v_mfma_f32_16x16x32_bf16 v[132:135], v[56:59], v[156:159], v[132:135]
 v_mfma_f32_16x16x32_bf16 v[112:115], a[68:71], v[160:163], v[112:115]
 v_mfma_f32_16x16x32_bf16 v[120:123], a[148:151], v[160:163], v[120:123]
 v_mfma_f32_16x16x32_bf16 v[128:131], a[228:231], v[160:163], v[128:131]
 v_mfma_f32_16x16x32_bf16 v[136:139], v[56:59], v[160:163], v[136:139]
 s_waitcnt lgkmcnt(3)
 v_mfma_f32_16x16x32_bf16 v[108:111], a[72:75], v[140:143], v[108:111]
 v_mfma_f32_16x16x32_bf16 v[116:119], a[152:155], v[140:143], v[116:119]
 v_mfma_f32_16x16x32_bf16 v[124:127], a[232:235], v[140:143], v[124:127]
 v_mfma_f32_16x16x32_bf16 v[132:135], v[60:63], v[140:143], v[132:135]
 s_waitcnt lgkmcnt(2)
 v_mfma_f32_16x16x32_bf16 v[112:115], a[72:75], v[144:147], v[112:115]
 v_mfma_f32_16x16x32_bf16 v[120:123], a[152:155], v[144:147], v[120:123]
 v_mfma_f32_16x16x32_bf16 v[128:131], a[232:235], v[144:147], v[128:131]
 v_mfma_f32_16x16x32_bf16 v[136:139], v[60:63], v[144:147], v[136:139]
 s_waitcnt lgkmcnt(1)
 v_mfma_f32_16x16x32_bf16 v[108:111], a[76:79], v[148:151], v[108:111]
 s_mov_b32 s50, s53
 v_mfma_f32_16x16x32_bf16 v[116:119], a[156:159], v[148:151], v[116:119]
 s_mov_b32 s48, s51
 v_mfma_f32_16x16x32_bf16 v[124:127], a[236:239], v[148:151], v[124:127]
 s_mov_b32 s49, s52
 v_mfma_f32_16x16x32_bf16 v[132:135], v[64:67], v[148:151], v[132:135]
 s_waitcnt lgkmcnt(0)
 v_mfma_f32_16x16x32_bf16 v[112:115], a[76:79], v[152:155], v[112:115]
 v_mfma_f32_16x16x32_bf16 v[120:123], a[156:159], v[152:155], v[120:123]
 v_mfma_f32_16x16x32_bf16 v[128:131], a[236:239], v[152:155], v[128:131]
 v_mfma_f32_16x16x32_bf16 v[136:139], v[64:67], v[152:155], v[136:139]
 s_branch Lqc_304
Lqd_320:
 s_endpgm
L_qkv_v:
 s_branch Lqf_326
Lqc_327:
 v_cvt_pk_bf16_f32 v164, v108, v109
 v_cvt_pk_bf16_f32 v165, v110, v111
 v_cvt_pk_bf16_f32 v166, v112, v113
 v_cvt_pk_bf16_f32 v167, v114, v115
 buffer_store_dwordx4 v[164:167], v2, s[4:7], s50 offen offset:0 sc1
 v_cvt_pk_bf16_f32 v168, v116, v117
 v_cvt_pk_bf16_f32 v169, v118, v119
 v_cvt_pk_bf16_f32 v170, v120, v121
 v_cvt_pk_bf16_f32 v171, v122, v123
 buffer_store_dwordx4 v[168:171], v2, s[4:7], s50 offen offset:1024 sc1
 v_cvt_pk_bf16_f32 v172, v124, v125
 v_cvt_pk_bf16_f32 v173, v126, v127
 v_cvt_pk_bf16_f32 v174, v128, v129
 v_cvt_pk_bf16_f32 v175, v130, v131
 buffer_store_dwordx4 v[172:175], v2, s[4:7], s50 offen offset:2048 sc1
 v_cvt_pk_bf16_f32 v176, v132, v133
 v_cvt_pk_bf16_f32 v177, v134, v135
 v_cvt_pk_bf16_f32 v178, v136, v137
 v_cvt_pk_bf16_f32 v179, v138, v139
 buffer_store_dwordx4 v[176:179], v2, s[4:7], s50 offen offset:3072 sc1
 buffer_load_dword v72, v73, s[4:7], 0 offen sc1
 s_waitcnt vmcnt(1)
 s_mov_b64 exec, 1
 v_mov_b32 v74, s49
 buffer_store_dword v74, off, s[4:7], s48 sc1
 s_mov_b64 exec, -1
 s_cmp_ge_u32 s27, 128
 s_cbranch_scc1 Lqd_334
 s_waitcnt vmcnt(1)
 v_cmp_lt_u32 vcc, s41, v72
 s_nop 0
 s_cmp_eq_u64 vcc, -1
 s_cbranch_scc1 Lqs_335
Lqf_326:
 s_cmp_eq_u32 s40, 0
 s_cbranch_scc1 Lqs_335
 s_add_u32 s22, s41, 1
 s_mov_b32 s24, 0
Lw_336:
 s_add_u32 s24, s24, 1
 s_cmp_gt_u32 s24, 200000
 s_cbranch_scc1 L_fail
 buffer_load_dword v72, v73, s[4:7], 0 offen sc1
 s_waitcnt vmcnt(0)
 v_cmp_le_u32 vcc, s22, v72
 s_nop 0
 s_cmp_eq_u64 vcc, -1
 s_cbranch_scc0 Lw_336
Lqs_335:
 buffer_load_dword v72, v73, s[4:7], 0 offen sc1
 s_mov_b32 s42, 0
 s_add_u32 m0, s47, 0
 s_nop 0
 buffer_load_dwordx4 v3, s[4:7], s46 offen offset:0 sc1 lds
 s_add_u32 m0, s47, 3968
 s_nop 0
 buffer_load_dwordx4 v3, s[4:7], s46 offen offset:128 sc1 lds
 s_add_u32 m0, s47, 7936
 s_nop 0
 buffer_load_dwordx4 v3, s[4:7], s46 offen offset:256 sc1 lds
 s_add_u32 m0, s47, 11904
 s_nop 0
 buffer_load_dwordx4 v3, s[4:7], s46 offen offset:384 sc1 lds
 s_add_u32 m0, s47, 15872
 s_nop 0
 buffer_load_dwordx4 v3, s[4:7], s46 offen offset:512 sc1 lds
 s_add_u32 m0, s47, 19840
 s_nop 0
 buffer_load_dwordx4 v3, s[4:7], s46 offen offset:640 sc1 lds
 s_add_u32 m0, s47, 23808
 s_nop 0
 buffer_load_dwordx4 v3, s[4:7], s46 offen offset:768 sc1 lds
 s_add_u32 m0, s47, 27776
 s_nop 0
 buffer_load_dwordx4 v3, s[4:7], s46 offen offset:896 sc1 lds
 s_add_u32 m0, s47, 31744
 s_nop 0
 buffer_load_dwordx4 v3, s[4:7], s46 offen offset:1024 sc1 lds
 s_add_u32 m0, s47, 35712
 s_nop 0
 buffer_load_dwordx4 v3, s[4:7], s46 offen offset:1152 sc1 lds
 s_waitcnt vmcnt(9)
 s_barrier
 ds_read_b128 v[140:143], v68 offset:0
 ds_read_b128 v[144:147], v68 offset:2048
 ds_read_b128 v[148:151], v69 offset:0
 ds_read_b128 v[152:155], v69 offset:2048
 s_waitcnt vmcnt(7)
 s_barrier
 ds_read_b128 v[156:159], v68 offset:4096
 ds_read_b128 v[160:163], v68 offset:6144
 s_waitcnt lgkmcnt(5)
 v_mfma_f32_16x16x32_bf16 v[76:79], v[140:143], a[0:3], 0
 s_mul_i32 s19, s41, 393216
 v_mfma_f32_16x16x32_bf16 v[84:87], v[140:143], a[80:83], 0
 s_cmp_eq_u32 s40, 0
 v_mfma_f32_16x16x32_bf16 v[92:95], v[140:143], a[160:163], 0
 s_cselect_b32 s20, s43, s44
 v_mfma_f32_16x16x32_bf16 v[100:103], v[140:143], a[240:243], 0
 s_add_u32 s53, s19, s20
 s_waitcnt lgkmcnt(4)
 v_mfma_f32_16x16x32_bf16 v[80:83], v[144:147], a[0:3], 0
 s_lshl_b32 s51, s40, 16
 v_mfma_f32_16x16x32_bf16 v[88:91], v[144:147], a[80:83], 0
 s_add_u32 s51, s51, s45
 v_mfma_f32_16x16x32_bf16 v[96:99], v[144:147], a[160:163], 0
 s_add_u32 s52, s41, 1
 v_mfma_f32_16x16x32_bf16 v[104:107], v[144:147], a[240:243], 0
 ds_read_b128 v[140:143], v69 offset:4096
 ds_read_b128 v[144:147], v69 offset:6144
 s_waitcnt lgkmcnt(4)
 v_mfma_f32_16x16x32_bf16 v[76:79], v[148:151], a[4:7], v[76:79]
 s_add_u32 s27, s27, 1
 v_mfma_f32_16x16x32_bf16 v[84:87], v[148:151], a[84:87], v[84:87]
 s_sub_u32 s19, s27, 13
 v_mfma_f32_16x16x32_bf16 v[92:95], v[148:151], a[164:167], v[92:95]
 s_lshr_b32 s20, s19, 1
 v_mfma_f32_16x16x32_bf16 v[100:103], v[148:151], a[244:247], v[100:103]
 s_add_u32 s21, s20, 13
 v_mfma_f32_16x16x32_bf16 v[80:83], v[152:155], a[4:7], v[80:83]
 s_bitcmp1_b32 s19, 0
 v_mfma_f32_16x16x32_bf16 v[88:91], v[152:155], a[84:87], v[88:91]
 s_cselect_b32 s41, s21, s20
 v_mfma_f32_16x16x32_bf16 v[96:99], v[152:155], a[164:167], v[96:99]
 s_cselect_b32 s40, 0, 1
 v_mfma_f32_16x16x32_bf16 v[104:107], v[152:155], a[244:247], v[104:107]
 ds_read_b128 v[148:151], v68 offset:8192
 ds_read_b128 v[152:155], v68 offset:10240
 s_waitcnt lgkmcnt(4)
 v_mfma_f32_16x16x32_bf16 v[76:79], v[156:159], a[8:11], v[76:79]
 s_cmp_lt_u32 s27, 13
 v_mfma_f32_16x16x32_bf16 v[84:87], v[156:159], a[88:91], v[84:87]
 s_cselect_b32 s41, s27, s41
 v_mfma_f32_16x16x32_bf16 v[92:95], v[156:159], a[168:171], v[92:95]
 s_cselect_b32 s40, 0, s40
 v_mfma_f32_16x16x32_bf16 v[100:103], v[156:159], a[248:251], v[100:103]
 s_sub_u32 s19, s27, 64
 v_mfma_f32_16x16x32_bf16 v[80:83], v[160:163], a[8:11], v[80:83]
 s_cmp_ge_u32 s27, 115
 v_mfma_f32_16x16x32_bf16 v[88:91], v[160:163], a[88:91], v[88:91]
 s_cselect_b32 s41, s19, s41
 v_mfma_f32_16x16x32_bf16 v[96:99], v[160:163], a[168:171], v[96:99]
 s_cselect_b32 s40, 1, s40
 v_mfma_f32_16x16x32_bf16 v[104:107], v[160:163], a[248:251], v[104:107]
 ds_read_b128 v[156:159], v69 offset:8192
 ds_read_b128 v[160:163], v69 offset:10240
 s_waitcnt lgkmcnt(4)
 v_mfma_f32_16x16x32_bf16 v[76:79], v[140:143], a[12:15], v[76:79]
 s_mul_i32 s46, s41, 40960
 v_mfma_f32_16x16x32_bf16 v[84:87], v[140:143], a[92:95], v[84:87]
 s_cmp_eq_u32 s40, 0
 v_mfma_f32_16x16x32_bf16 v[92:95], v[140:143], a[172:175], v[92:95]
 s_cselect_b32 s19, 0, 2621440
 v_mfma_f32_16x16x32_bf16 v[100:103], v[140:143], a[252:255], v[100:103]
 s_add_u32 s46, s46, s19
 v_mfma_f32_16x16x32_bf16 v[80:83], v[144:147], a[12:15], v[80:83]
 s_add_u32 s46, s46, 184975360
 v_mfma_f32_16x16x32_bf16 v[88:91], v[144:147], a[92:95], v[88:91]
 s_xor_b32 s47, s47, 40960
 v_mfma_f32_16x16x32_bf16 v[96:99], v[144:147], a[172:175], v[96:99]
 v_mfma_f32_16x16x32_bf16 v[104:107], v[144:147], a[252:255], v[104:107]
 s_branch Lqm_331
Lqw_329:
 buffer_load_dword v72, v73, s[4:7], 0 offen sc1
 s_mov_b32 s42, 1
 s_waitcnt vmcnt(9)
 s_barrier
 ds_read_b128 v[140:143], v68 offset:0
 ds_read_b128 v[144:147], v68 offset:2048
 ds_read_b128 v[148:151], v69 offset:0
 ds_read_b128 v[152:155], v69 offset:2048
 s_waitcnt vmcnt(7)
 s_barrier
 ds_read_b128 v[156:159], v68 offset:4096
 ds_read_b128 v[160:163], v68 offset:6144
 s_waitcnt lgkmcnt(5)
 v_mfma_f32_16x16x32_bf16 v[76:79], v[140:143], a[0:3], 0
 v_cvt_pk_bf16_f32 v164, v108, v109
 v_cvt_pk_bf16_f32 v165, v110, v111
 v_mfma_f32_16x16x32_bf16 v[84:87], v[140:143], a[80:83], 0
 v_cvt_pk_bf16_f32 v166, v112, v113
 v_cvt_pk_bf16_f32 v167, v114, v115
 v_mfma_f32_16x16x32_bf16 v[92:95], v[140:143], a[160:163], 0
 buffer_store_dwordx4 v[164:167], v2, s[4:7], s50 offen offset:0 sc1
 s_mul_i32 s19, s41, 393216
 v_mfma_f32_16x16x32_bf16 v[100:103], v[140:143], a[240:243], 0
 s_cmp_eq_u32 s40, 0
 s_cselect_b32 s20, s43, s44
 s_waitcnt lgkmcnt(4)
 v_mfma_f32_16x16x32_bf16 v[80:83], v[144:147], a[0:3], 0
 s_add_u32 s53, s19, s20
 v_mfma_f32_16x16x32_bf16 v[88:91], v[144:147], a[80:83], 0
 s_lshl_b32 s51, s40, 16
 v_mfma_f32_16x16x32_bf16 v[96:99], v[144:147], a[160:163], 0
 s_add_u32 s51, s51, s45
 v_mfma_f32_16x16x32_bf16 v[104:107], v[144:147], a[240:243], 0
 s_add_u32 s52, s41, 1
 ds_read_b128 v[140:143], v69 offset:4096
 ds_read_b128 v[144:147], v69 offset:6144
 s_waitcnt lgkmcnt(4)
 v_mfma_f32_16x16x32_bf16 v[76:79], v[148:151], a[4:7], v[76:79]
 v_cvt_pk_bf16_f32 v168, v116, v117
 v_cvt_pk_bf16_f32 v169, v118, v119
 v_mfma_f32_16x16x32_bf16 v[84:87], v[148:151], a[84:87], v[84:87]
 v_cvt_pk_bf16_f32 v170, v120, v121
 v_cvt_pk_bf16_f32 v171, v122, v123
 v_mfma_f32_16x16x32_bf16 v[92:95], v[148:151], a[164:167], v[92:95]
 buffer_store_dwordx4 v[168:171], v2, s[4:7], s50 offen offset:1024 sc1
 s_add_u32 s27, s27, 1
 v_mfma_f32_16x16x32_bf16 v[100:103], v[148:151], a[244:247], v[100:103]
 s_sub_u32 s19, s27, 13
 s_lshr_b32 s20, s19, 1
 v_mfma_f32_16x16x32_bf16 v[80:83], v[152:155], a[4:7], v[80:83]
 s_add_u32 s21, s20, 13
 v_mfma_f32_16x16x32_bf16 v[88:91], v[152:155], a[84:87], v[88:91]
 s_bitcmp1_b32 s19, 0
 v_mfma_f32_16x16x32_bf16 v[96:99], v[152:155], a[164:167], v[96:99]
 s_cselect_b32 s41, s21, s20
 v_mfma_f32_16x16x32_bf16 v[104:107], v[152:155], a[244:247], v[104:107]
 s_cselect_b32 s40, 0, 1
 ds_read_b128 v[148:151], v68 offset:8192
 ds_read_b128 v[152:155], v68 offset:10240
 s_waitcnt lgkmcnt(4)
 v_mfma_f32_16x16x32_bf16 v[76:79], v[156:159], a[8:11], v[76:79]
 v_cvt_pk_bf16_f32 v172, v124, v125
 v_cvt_pk_bf16_f32 v173, v126, v127
 v_mfma_f32_16x16x32_bf16 v[84:87], v[156:159], a[88:91], v[84:87]
 v_cvt_pk_bf16_f32 v174, v128, v129
 v_cvt_pk_bf16_f32 v175, v130, v131
 v_mfma_f32_16x16x32_bf16 v[92:95], v[156:159], a[168:171], v[92:95]
 buffer_store_dwordx4 v[172:175], v2, s[4:7], s50 offen offset:2048 sc1
 s_cmp_lt_u32 s27, 13
 v_mfma_f32_16x16x32_bf16 v[100:103], v[156:159], a[248:251], v[100:103]
 s_cselect_b32 s41, s27, s41
 s_cselect_b32 s40, 0, s40
 v_mfma_f32_16x16x32_bf16 v[80:83], v[160:163], a[8:11], v[80:83]
 s_sub_u32 s19, s27, 64
 v_mfma_f32_16x16x32_bf16 v[88:91], v[160:163], a[88:91], v[88:91]
 s_cmp_ge_u32 s27, 115
 v_mfma_f32_16x16x32_bf16 v[96:99], v[160:163], a[168:171], v[96:99]
 s_cselect_b32 s41, s19, s41
 v_mfma_f32_16x16x32_bf16 v[104:107], v[160:163], a[248:251], v[104:107]
 s_cselect_b32 s40, 1, s40
 ds_read_b128 v[156:159], v69 offset:8192
 ds_read_b128 v[160:163], v69 offset:10240
 s_waitcnt lgkmcnt(4)
 v_mfma_f32_16x16x32_bf16 v[76:79], v[140:143], a[12:15], v[76:79]
 v_cvt_pk_bf16_f32 v176, v132, v133
 v_cvt_pk_bf16_f32 v177, v134, v135
 v_mfma_f32_16x16x32_bf16 v[84:87], v[140:143], a[92:95], v[84:87]
 v_cvt_pk_bf16_f32 v178, v136, v137
 v_cvt_pk_bf16_f32 v179, v138, v139
 v_mfma_f32_16x16x32_bf16 v[92:95], v[140:143], a[172:175], v[92:95]
 buffer_store_dwordx4 v[176:179], v2, s[4:7], s50 offen offset:3072 sc1
 s_mul_i32 s46, s41, 40960
 v_mfma_f32_16x16x32_bf16 v[100:103], v[140:143], a[252:255], v[100:103]
 s_cmp_eq_u32 s40, 0
 v_mfma_f32_16x16x32_bf16 v[80:83], v[144:147], a[12:15], v[80:83]
 s_cselect_b32 s19, 0, 2621440
 v_mfma_f32_16x16x32_bf16 v[88:91], v[144:147], a[92:95], v[88:91]
 s_add_u32 s46, s46, s19
 v_mfma_f32_16x16x32_bf16 v[96:99], v[144:147], a[172:175], v[96:99]
 s_add_u32 s46, s46, 184975360
 v_mfma_f32_16x16x32_bf16 v[104:107], v[144:147], a[252:255], v[104:107]
 s_xor_b32 s47, s47, 40960
Lqm_331:
 s_waitcnt vmcnt(5)
 s_barrier
 ds_read_b128 v[140:143], v68 offset:12288
 ds_read_b128 v[144:147], v68 offset:14336
 s_waitcnt lgkmcnt(4)
 v_mfma_f32_16x16x32_bf16 v[76:79], v[148:151], a[16:19], v[76:79]
 v_mfma_f32_16x16x32_bf16 v[84:87], v[148:151], a[96:99], v[84:87]
 v_mfma_f32_16x16x32_bf16 v[92:95], v[148:151], a[176:179], v[92:95]
 v_mfma_f32_16x16x32_bf16 v[100:103], v[148:151], v[4:7], v[100:103]
 v_mfma_f32_16x16x32_bf16 v[80:83], v[152:155], a[16:19], v[80:83]
 v_mfma_f32_16x16x32_bf16 v[88:91], v[152:155], a[96:99], v[88:91]
 v_mfma_f32_16x16x32_bf16 v[96:99], v[152:155], a[176:179], v[96:99]
 v_mfma_f32_16x16x32_bf16 v[104:107], v[152:155], v[4:7], v[104:107]
 ds_read_b128 v[148:151], v69 offset:12288
 ds_read_b128 v[152:155], v69 offset:14336
 s_waitcnt lgkmcnt(4)
 v_mfma_f32_16x16x32_bf16 v[76:79], v[156:159], a[20:23], v[76:79]
 v_mfma_f32_16x16x32_bf16 v[84:87], v[156:159], a[100:103], v[84:87]
 v_mfma_f32_16x16x32_bf16 v[92:95], v[156:159], a[180:183], v[92:95]
 v_mfma_f32_16x16x32_bf16 v[100:103], v[156:159], v[8:11], v[100:103]
 v_mfma_f32_16x16x32_bf16 v[80:83], v[160:163], a[20:23], v[80:83]
 v_mfma_f32_16x16x32_bf16 v[88:91], v[160:163], a[100:103], v[88:91]
 v_mfma_f32_16x16x32_bf16 v[96:99], v[160:163], a[180:183], v[96:99]
 v_mfma_f32_16x16x32_bf16 v[104:107], v[160:163], v[8:11], v[104:107]
 ds_read_b128 v[156:159], v68 offset:16384
 ds_read_b128 v[160:163], v68 offset:18432
 s_waitcnt lgkmcnt(4)
 v_mfma_f32_16x16x32_bf16 v[76:79], v[140:143], a[24:27], v[76:79]
 v_mfma_f32_16x16x32_bf16 v[84:87], v[140:143], a[104:107], v[84:87]
 v_mfma_f32_16x16x32_bf16 v[92:95], v[140:143], a[184:187], v[92:95]
 v_mfma_f32_16x16x32_bf16 v[100:103], v[140:143], v[12:15], v[100:103]
 v_mfma_f32_16x16x32_bf16 v[80:83], v[144:147], a[24:27], v[80:83]
 v_mfma_f32_16x16x32_bf16 v[88:91], v[144:147], a[104:107], v[88:91]
 v_mfma_f32_16x16x32_bf16 v[96:99], v[144:147], a[184:187], v[96:99]
 v_mfma_f32_16x16x32_bf16 v[104:107], v[144:147], v[12:15], v[104:107]
 s_cmp_ge_u32 s27, 128
 s_cbranch_scc1 Lqp_333
 s_cmp_eq_u32 s40, 0
 s_cbranch_scc1 Lqo_337
 s_waitcnt vmcnt(4)
 v_cmp_lt_u32 vcc, s41, v72
 s_nop 0
 s_cmp_eq_u64 vcc, -1
 s_cbranch_scc0 Lqp_333
Lqo_337:
 ds_read_b128 v[140:143], v69 offset:16384
 ds_read_b128 v[144:147], v69 offset:18432
 s_waitcnt lgkmcnt(4)
 v_mfma_f32_16x16x32_bf16 v[76:79], v[148:151], a[28:31], v[76:79]
 s_add_u32 m0, s47, 0
 v_mfma_f32_16x16x32_bf16 v[84:87], v[148:151], a[108:111], v[84:87]
 buffer_load_dwordx4 v3, s[4:7], s46 offen offset:0 sc1 lds
 v_mfma_f32_16x16x32_bf16 v[92:95], v[148:151], a[188:191], v[92:95]
 v_mfma_f32_16x16x32_bf16 v[100:103], v[148:151], v[16:19], v[100:103]
 v_mfma_f32_16x16x32_bf16 v[80:83], v[152:155], a[28:31], v[80:83]
 v_mfma_f32_16x16x32_bf16 v[88:91], v[152:155], a[108:111], v[88:91]
 v_mfma_f32_16x16x32_bf16 v[96:99], v[152:155], a[188:191], v[96:99]
 v_mfma_f32_16x16x32_bf16 v[104:107], v[152:155], v[16:19], v[104:107]
 s_waitcnt vmcnt(4)
 s_barrier
 ds_read_b128 v[148:151], v68 offset:20480
 ds_read_b128 v[152:155], v68 offset:22528
 s_waitcnt lgkmcnt(4)
 v_mfma_f32_16x16x32_bf16 v[76:79], v[156:159], a[32:35], v[76:79]
 s_add_u32 m0, s47, 3968
 v_mfma_f32_16x16x32_bf16 v[84:87], v[156:159], a[112:115], v[84:87]
 buffer_load_dwordx4 v3, s[4:7], s46 offen offset:128 sc1 lds
 v_mfma_f32_16x16x32_bf16 v[92:95], v[156:159], a[192:195], v[92:95]
 v_mfma_f32_16x16x32_bf16 v[100:103], v[156:159], v[20:23], v[100:103]
 v_mfma_f32_16x16x32_bf16 v[80:83], v[160:163], a[32:35], v[80:83]
 v_mfma_f32_16x16x32_bf16 v[88:91], v[160:163], a[112:115], v[88:91]
 v_mfma_f32_16x16x32_bf16 v[96:99], v[160:163], a[192:195], v[96:99]
 v_mfma_f32_16x16x32_bf16 v[104:107], v[160:163], v[20:23], v[104:107]
 ds_read_b128 v[156:159], v69 offset:20480
 ds_read_b128 v[160:163], v69 offset:22528
 s_waitcnt lgkmcnt(4)
 v_mfma_f32_16x16x32_bf16 v[76:79], v[140:143], a[36:39], v[76:79]
 s_add_u32 m0, s47, 7936
 v_mfma_f32_16x16x32_bf16 v[84:87], v[140:143], a[116:119], v[84:87]
 buffer_load_dwordx4 v3, s[4:7], s46 offen offset:256 sc1 lds
 v_mfma_f32_16x16x32_bf16 v[92:95], v[140:143], a[196:199], v[92:95]
 v_mfma_f32_16x16x32_bf16 v[100:103], v[140:143], v[24:27], v[100:103]
 v_mfma_f32_16x16x32_bf16 v[80:83], v[144:147], a[36:39], v[80:83]
 v_mfma_f32_16x16x32_bf16 v[88:91], v[144:147], a[116:119], v[88:91]
 v_mfma_f32_16x16x32_bf16 v[96:99], v[144:147], a[196:199], v[96:99]
 v_mfma_f32_16x16x32_bf16 v[104:107], v[144:147], v[24:27], v[104:107]
 ds_read_b128 v[140:143], v68 offset:24576
 ds_read_b128 v[144:147], v68 offset:26624
 s_waitcnt lgkmcnt(4)
 v_mfma_f32_16x16x32_bf16 v[76:79], v[148:151], a[40:43], v[76:79]
 s_add_u32 m0, s47, 11904
 v_mfma_f32_16x16x32_bf16 v[84:87], v[148:151], a[120:123], v[84:87]
 buffer_load_dwordx4 v3, s[4:7], s46 offen offset:384 sc1 lds
 v_mfma_f32_16x16x32_bf16 v[92:95], v[148:151], a[200:203], v[92:95]
 v_mfma_f32_16x16x32_bf16 v[100:103], v[148:151], v[28:31], v[100:103]
 v_mfma_f32_16x16x32_bf16 v[80:83], v[152:155], a[40:43], v[80:83]
 v_mfma_f32_16x16x32_bf16 v[88:91], v[152:155], a[120:123], v[88:91]
 v_mfma_f32_16x16x32_bf16 v[96:99], v[152:155], a[200:203], v[96:99]
 v_mfma_f32_16x16x32_bf16 v[104:107], v[152:155], v[28:31], v[104:107]
 s_cmp_eq_u32 s42, 1
 s_cbranch_scc0 Lqn_338
 s_waitcnt vmcnt(4)
 s_mov_b64 exec, 1
 v_mov_b32 v74, s49
 buffer_store_dword v74, off, s[4:7], s48 sc1
 s_mov_b64 exec, -1
Lqn_338:
 ds_read_b128 v[148:151], v69 offset:24576
 ds_read_b128 v[152:155], v69 offset:26624
 s_waitcnt lgkmcnt(4)
 v_mfma_f32_16x16x32_bf16 v[76:79], v[156:159], a[44:47], v[76:79]
 s_add_u32 m0, s47, 15872
 v_mfma_f32_16x16x32_bf16 v[84:87], v[156:159], a[124:127], v[84:87]
 buffer_load_dwordx4 v3, s[4:7], s46 offen offset:512 sc1 lds
 v_mfma_f32_16x16x32_bf16 v[92:95], v[156:159], a[204:207], v[92:95]
 v_mfma_f32_16x16x32_bf16 v[100:103], v[156:159], v[32:35], v[100:103]
 v_mfma_f32_16x16x32_bf16 v[80:83], v[160:163], a[44:47], v[80:83]
 v_mfma_f32_16x16x32_bf16 v[88:91], v[160:163], a[124:127], v[88:91]
 v_mfma_f32_16x16x32_bf16 v[96:99], v[160:163], a[204:207], v[96:99]
 v_mfma_f32_16x16x32_bf16 v[104:107], v[160:163], v[32:35], v[104:107]
 s_waitcnt vmcnt(5)
 s_barrier
 ds_read_b128 v[156:159], v68 offset:28672
 ds_read_b128 v[160:163], v68 offset:30720
 s_waitcnt lgkmcnt(4)
 v_mfma_f32_16x16x32_bf16 v[76:79], v[140:143], a[48:51], v[76:79]
 s_add_u32 m0, s47, 19840
 v_mfma_f32_16x16x32_bf16 v[84:87], v[140:143], a[128:131], v[84:87]
 buffer_load_dwordx4 v3, s[4:7], s46 offen offset:640 sc1 lds
 v_mfma_f32_16x16x32_bf16 v[92:95], v[140:143], a[208:211], v[92:95]
 v_mfma_f32_16x16x32_bf16 v[100:103], v[140:143], v[36:39], v[100:103]
 v_mfma_f32_16x16x32_bf16 v[80:83], v[144:147], a[48:51], v[80:83]
 v_mfma_f32_16x16x32_bf16 v[88:91], v[144:147], a[128:131], v[88:91]
 v_mfma_f32_16x16x32_bf16 v[96:99], v[144:147], a[208:211], v[96:99]
 v_mfma_f32_16x16x32_bf16 v[104:107], v[144:147], v[36:39], v[104:107]
 ds_read_b128 v[140:143], v69 offset:28672
 ds_read_b128 v[144:147], v69 offset:30720
 s_waitcnt lgkmcnt(4)
 v_mfma_f32_16x16x32_bf16 v[76:79], v[148:151], a[52:55], v[76:79]
 s_add_u32 m0, s47, 23808
 v_mfma_f32_16x16x32_bf16 v[84:87], v[148:151], a[132:135], v[84:87]
 buffer_load_dwordx4 v3, s[4:7], s46 offen offset:768 sc1 lds
 v_mfma_f32_16x16x32_bf16 v[92:95], v[148:151], a[212:215], v[92:95]
 v_mfma_f32_16x16x32_bf16 v[100:103], v[148:151], v[40:43], v[100:103]
 v_mfma_f32_16x16x32_bf16 v[80:83], v[152:155], a[52:55], v[80:83]
 v_mfma_f32_16x16x32_bf16 v[88:91], v[152:155], a[132:135], v[88:91]
 v_mfma_f32_16x16x32_bf16 v[96:99], v[152:155], a[212:215], v[96:99]
 v_mfma_f32_16x16x32_bf16 v[104:107], v[152:155], v[40:43], v[104:107]
 ds_read_b128 v[148:151], v68 offset:32768
 ds_read_b128 v[152:155], v68 offset:34816
 s_waitcnt lgkmcnt(4)
 v_mfma_f32_16x16x32_bf16 v[76:79], v[156:159], a[56:59], v[76:79]
 s_add_u32 m0, s47, 27776
 v_mfma_f32_16x16x32_bf16 v[84:87], v[156:159], a[136:139], v[84:87]
 buffer_load_dwordx4 v3, s[4:7], s46 offen offset:896 sc1 lds
 v_mfma_f32_16x16x32_bf16 v[92:95], v[156:159], a[216:219], v[92:95]
 v_mfma_f32_16x16x32_bf16 v[100:103], v[156:159], v[44:47], v[100:103]
 v_mfma_f32_16x16x32_bf16 v[80:83], v[160:163], a[56:59], v[80:83]
 v_mfma_f32_16x16x32_bf16 v[88:91], v[160:163], a[136:139], v[88:91]
 v_mfma_f32_16x16x32_bf16 v[96:99], v[160:163], a[216:219], v[96:99]
 v_mfma_f32_16x16x32_bf16 v[104:107], v[160:163], v[44:47], v[104:107]
 ds_read_b128 v[156:159], v69 offset:32768
 ds_read_b128 v[160:163], v69 offset:34816
 s_waitcnt lgkmcnt(4)
 v_mfma_f32_16x16x32_bf16 v[76:79], v[140:143], a[60:63], v[76:79]
 s_add_u32 m0, s47, 31744
 v_mfma_f32_16x16x32_bf16 v[84:87], v[140:143], a[140:143], v[84:87]
 buffer_load_dwordx4 v3, s[4:7], s46 offen offset:1024 sc1 lds
 v_mfma_f32_16x16x32_bf16 v[92:95], v[140:143], a[220:223], v[92:95]
 v_mfma_f32_16x16x32_bf16 v[100:103], v[140:143], v[48:51], v[100:103]
 v_mfma_f32_16x16x32_bf16 v[80:83], v[144:147], a[60:63], v[80:83]
 v_mfma_f32_16x16x32_bf16 v[88:91], v[144:147], a[140:143], v[88:91]
 v_mfma_f32_16x16x32_bf16 v[96:99], v[144:147], a[220:223], v[96:99]
 v_mfma_f32_16x16x32_bf16 v[104:107], v[144:147], v[48:51], v[104:107]
 ds_read_b128 v[140:143], v68 offset:36864
 ds_read_b128 v[144:147], v68 offset:38912
 s_waitcnt lgkmcnt(4)
 v_mfma_f32_16x16x32_bf16 v[76:79], v[148:151], a[64:67], v[76:79]
 s_add_u32 m0, s47, 35712
 v_mfma_f32_16x16x32_bf16 v[84:87], v[148:151], a[144:147], v[84:87]
 buffer_load_dwordx4 v3, s[4:7], s46 offen offset:1152 sc1 lds
 v_mfma_f32_16x16x32_bf16 v[92:95], v[148:151], a[224:227], v[92:95]
 v_mfma_f32_16x16x32_bf16 v[100:103], v[148:151], v[52:55], v[100:103]
 v_mfma_f32_16x16x32_bf16 v[80:83], v[152:155], a[64:67], v[80:83]
 v_mfma_f32_16x16x32_bf16 v[88:91], v[152:155], a[144:147], v[88:91]
 v_mfma_f32_16x16x32_bf16 v[96:99], v[152:155], a[224:227], v[96:99]
 v_mfma_f32_16x16x32_bf16 v[104:107], v[152:155], v[52:55], v[104:107]
 ds_read_b128 v[148:151], v69 offset:36864
 ds_read_b128 v[152:155], v69 offset:38912
 s_waitcnt lgkmcnt(4)
 v_mfma_f32_16x16x32_bf16 v[76:79], v[156:159], a[68:71], v[76:79]
 v_mfma_f32_16x16x32_bf16 v[84:87], v[156:159], a[148:151], v[84:87]
 v_mfma_f32_16x16x32_bf16 v[92:95], v[156:159], a[228:231], v[92:95]
 v_mfma_f32_16x16x32_bf16 v[100:103], v[156:159], v[56:59], v[100:103]
 v_mfma_f32_16x16x32_bf16 v[80:83], v[160:163], a[68:71], v[80:83]
 v_mfma_f32_16x16x32_bf16 v[88:91], v[160:163], a[148:151], v[88:91]
 v_mfma_f32_16x16x32_bf16 v[96:99], v[160:163], a[228:231], v[96:99]
 v_mfma_f32_16x16x32_bf16 v[104:107], v[160:163], v[56:59], v[104:107]
 s_waitcnt lgkmcnt(3)
 v_mfma_f32_16x16x32_bf16 v[76:79], v[140:143], a[72:75], v[76:79]
 v_mfma_f32_16x16x32_bf16 v[84:87], v[140:143], a[152:155], v[84:87]
 v_mfma_f32_16x16x32_bf16 v[92:95], v[140:143], a[232:235], v[92:95]
 v_mfma_f32_16x16x32_bf16 v[100:103], v[140:143], v[60:63], v[100:103]
 s_waitcnt lgkmcnt(2)
 v_mfma_f32_16x16x32_bf16 v[80:83], v[144:147], a[72:75], v[80:83]
 v_mfma_f32_16x16x32_bf16 v[88:91], v[144:147], a[152:155], v[88:91]
 v_mfma_f32_16x16x32_bf16 v[96:99], v[144:147], a[232:235], v[96:99]
 v_mfma_f32_16x16x32_bf16 v[104:107], v[144:147], v[60:63], v[104:107]
 s_waitcnt lgkmcnt(1)
 v_mfma_f32_16x16x32_bf16 v[76:79], v[148:151], a[76:79], v[76:79]
 s_mov_b32 s50, s53
 v_mfma_f32_16x16x32_bf16 v[84:87], v[148:151], a[156:159], v[84:87]
 s_mov_b32 s48, s51
 v_mfma_f32_16x16x32_bf16 v[92:95], v[148:151], a[236:239], v[92:95]
 s_mov_b32 s49, s52
 v_mfma_f32_16x16x32_bf16 v[100:103], v[148:151], v[64:67], v[100:103]
 s_waitcnt lgkmcnt(0)
 v_mfma_f32_16x16x32_bf16 v[80:83], v[152:155], a[76:79], v[80:83]
 v_mfma_f32_16x16x32_bf16 v[88:91], v[152:155], a[156:159], v[88:91]
 v_mfma_f32_16x16x32_bf16 v[96:99], v[152:155], a[236:239], v[96:99]
 v_mfma_f32_16x16x32_bf16 v[104:107], v[152:155], v[64:67], v[104:107]
 s_branch Lqw_330
Lqp_333:
 ds_read_b128 v[140:143], v69 offset:16384
 ds_read_b128 v[144:147], v69 offset:18432
 s_waitcnt lgkmcnt(4)
 v_mfma_f32_16x16x32_bf16 v[76:79], v[148:151], a[28:31], v[76:79]
 v_mfma_f32_16x16x32_bf16 v[84:87], v[148:151], a[108:111], v[84:87]
 v_mfma_f32_16x16x32_bf16 v[92:95], v[148:151], a[188:191], v[92:95]
 v_mfma_f32_16x16x32_bf16 v[100:103], v[148:151], v[16:19], v[100:103]
 v_mfma_f32_16x16x32_bf16 v[80:83], v[152:155], a[28:31], v[80:83]
 v_mfma_f32_16x16x32_bf16 v[88:91], v[152:155], a[108:111], v[88:91]
 v_mfma_f32_16x16x32_bf16 v[96:99], v[152:155], a[188:191], v[96:99]
 v_mfma_f32_16x16x32_bf16 v[104:107], v[152:155], v[16:19], v[104:107]
 s_waitcnt vmcnt(3)
 s_barrier
 ds_read_b128 v[148:151], v68 offset:20480
 ds_read_b128 v[152:155], v68 offset:22528
 s_waitcnt lgkmcnt(4)
 v_mfma_f32_16x16x32_bf16 v[76:79], v[156:159], a[32:35], v[76:79]
 v_mfma_f32_16x16x32_bf16 v[84:87], v[156:159], a[112:115], v[84:87]
 v_mfma_f32_16x16x32_bf16 v[92:95], v[156:159], a[192:195], v[92:95]
 v_mfma_f32_16x16x32_bf16 v[100:103], v[156:159], v[20:23], v[100:103]
 v_mfma_f32_16x16x32_bf16 v[80:83], v[160:163], a[32:35], v[80:83]
 v_mfma_f32_16x16x32_bf16 v[88:91], v[160:163], a[112:115], v[88:91]
 v_mfma_f32_16x16x32_bf16 v[96:99], v[160:163], a[192:195], v[96:99]
 v_mfma_f32_16x16x32_bf16 v[104:107], v[160:163], v[20:23], v[104:107]
 ds_read_b128 v[156:159], v69 offset:20480
 ds_read_b128 v[160:163], v69 offset:22528
 s_waitcnt lgkmcnt(4)
 v_mfma_f32_16x16x32_bf16 v[76:79], v[140:143], a[36:39], v[76:79]
 v_mfma_f32_16x16x32_bf16 v[84:87], v[140:143], a[116:119], v[84:87]
 v_mfma_f32_16x16x32_bf16 v[92:95], v[140:143], a[196:199], v[92:95]
 v_mfma_f32_16x16x32_bf16 v[100:103], v[140:143], v[24:27], v[100:103]
 v_mfma_f32_16x16x32_bf16 v[80:83], v[144:147], a[36:39], v[80:83]
 v_mfma_f32_16x16x32_bf16 v[88:91], v[144:147], a[116:119], v[88:91]
 v_mfma_f32_16x16x32_bf16 v[96:99], v[144:147], a[196:199], v[96:99]
 v_mfma_f32_16x16x32_bf16 v[104:107], v[144:147], v[24:27], v[104:107]
 ds_read_b128 v[140:143], v68 offset:24576
 ds_read_b128 v[144:147], v68 offset:26624
 s_waitcnt lgkmcnt(4)
 v_mfma_f32_16x16x32_bf16 v[76:79], v[148:151], a[40:43], v[76:79]
 v_mfma_f32_16x16x32_bf16 v[84:87], v[148:151], a[120:123], v[84:87]
 v_mfma_f32_16x16x32_bf16 v[92:95], v[148:151], a[200:203], v[92:95]
 v_mfma_f32_16x16x32_bf16 v[100:103], v[148:151], v[28:31], v[100:103]
 v_mfma_f32_16x16x32_bf16 v[80:83], v[152:155], a[40:43], v[80:83]
 v_mfma_f32_16x16x32_bf16 v[88:91], v[152:155], a[120:123], v[88:91]
 v_mfma_f32_16x16x32_bf16 v[96:99], v[152:155], a[200:203], v[96:99]
 v_mfma_f32_16x16x32_bf16 v[104:107], v[152:155], v[28:31], v[104:107]
 s_cmp_eq_u32 s42, 1
 s_cbranch_scc0 Lqn_339
 s_waitcnt vmcnt(0)
 s_mov_b64 exec, 1
 v_mov_b32 v74, s49
 buffer_store_dword v74, off, s[4:7], s48 sc1
 s_mov_b64 exec, -1
Lqn_339:
 ds_read_b128 v[148:151], v69 offset:24576
 ds_read_b128 v[152:155], v69 offset:26624
 s_waitcnt lgkmcnt(4)
 v_mfma_f32_16x16x32_bf16 v[76:79], v[156:159], a[44:47], v[76:79]
 v_mfma_f32_16x16x32_bf16 v[84:87], v[156:159], a[124:127], v[84:87]
 v_mfma_f32_16x16x32_bf16 v[92:95], v[156:159], a[204:207], v[92:95]
 v_mfma_f32_16x16x32_bf16 v[100:103], v[156:159], v[32:35], v[100:103]
 v_mfma_f32_16x16x32_bf16 v[80:83], v[160:163], a[44:47], v[80:83]
 v_mfma_f32_16x16x32_bf16 v[88:91], v[160:163], a[124:127], v[88:91]
 v_mfma_f32_16x16x32_bf16 v[96:99], v[160:163], a[204:207], v[96:99]
 v_mfma_f32_16x16x32_bf16 v[104:107], v[160:163], v[32:35], v[104:107]
 s_waitcnt vmcnt(0)
 s_barrier
 ds_read_b128 v[156:159], v68 offset:28672
 ds_read_b128 v[160:163], v68 offset:30720
 s_waitcnt lgkmcnt(4)
 v_mfma_f32_16x16x32_bf16 v[76:79], v[140:143], a[48:51], v[76:79]
 v_mfma_f32_16x16x32_bf16 v[84:87], v[140:143], a[128:131], v[84:87]
 v_mfma_f32_16x16x32_bf16 v[92:95], v[140:143], a[208:211], v[92:95]
 v_mfma_f32_16x16x32_bf16 v[100:103], v[140:143], v[36:39], v[100:103]
 v_mfma_f32_16x16x32_bf16 v[80:83], v[144:147], a[48:51], v[80:83]
 v_mfma_f32_16x16x32_bf16 v[88:91], v[144:147], a[128:131], v[88:91]
 v_mfma_f32_16x16x32_bf16 v[96:99], v[144:147], a[208:211], v[96:99]
 v_mfma_f32_16x16x32_bf16 v[104:107], v[144:147], v[36:39], v[104:107]
 ds_read_b128 v[140:143], v69 offset:28672
 ds_read_b128 v[144:147], v69 offset:30720
 s_waitcnt lgkmcnt(4)
 v_mfma_f32_16x16x32_bf16 v[76:79], v[148:151], a[52:55], v[76:79]
 v_mfma_f32_16x16x32_bf16 v[84:87], v[148:151], a[132:135], v[84:87]
 v_mfma_f32_16x16x32_bf16 v[92:95], v[148:151], a[212:215], v[92:95]
 v_mfma_f32_16x16x32_bf16 v[100:103], v[148:151], v[40:43], v[100:103]
 v_mfma_f32_16x16x32_bf16 v[80:83], v[152:155], a[52:55], v[80:83]
 v_mfma_f32_16x16x32_bf16 v[88:91], v[152:155], a[132:135], v[88:91]
 v_mfma_f32_16x16x32_bf16 v[96:99], v[152:155], a[212:215], v[96:99]
 v_mfma_f32_16x16x32_bf16 v[104:107], v[152:155], v[40:43], v[104:107]
 ds_read_b128 v[148:151], v68 offset:32768
 ds_read_b128 v[152:155], v68 offset:34816
 s_waitcnt lgkmcnt(4)
 v_mfma_f32_16x16x32_bf16 v[76:79], v[156:159], a[56:59], v[76:79]
 v_mfma_f32_16x16x32_bf16 v[84:87], v[156:159], a[136:139], v[84:87]
 v_mfma_f32_16x16x32_bf16 v[92:95], v[156:159], a[216:219], v[92:95]
 v_mfma_f32_16x16x32_bf16 v[100:103], v[156:159], v[44:47], v[100:103]
 v_mfma_f32_16x16x32_bf16 v[80:83], v[160:163], a[56:59], v[80:83]
 v_mfma_f32_16x16x32_bf16 v[88:91], v[160:163], a[136:139], v[88:91]
 v_mfma_f32_16x16x32_bf16 v[96:99], v[160:163], a[216:219], v[96:99]
 v_mfma_f32_16x16x32_bf16 v[104:107], v[160:163], v[44:47], v[104:107]
 ds_read_b128 v[156:159], v69 offset:32768
 ds_read_b128 v[160:163], v69 offset:34816
 s_waitcnt lgkmcnt(4)
 v_mfma_f32_16x16x32_bf16 v[76:79], v[140:143], a[60:63], v[76:79]
 v_mfma_f32_16x16x32_bf16 v[84:87], v[140:143], a[140:143], v[84:87]
 v_mfma_f32_16x16x32_bf16 v[92:95], v[140:143], a[220:223], v[92:95]
 v_mfma_f32_16x16x32_bf16 v[100:103], v[140:143], v[48:51], v[100:103]
 v_mfma_f32_16x16x32_bf16 v[80:83], v[144:147], a[60:63], v[80:83]
 v_mfma_f32_16x16x32_bf16 v[88:91], v[144:147], a[140:143], v[88:91]
 v_mfma_f32_16x16x32_bf16 v[96:99], v[144:147], a[220:223], v[96:99]
 v_mfma_f32_16x16x32_bf16 v[104:107], v[144:147], v[48:51], v[104:107]
 ds_read_b128 v[140:143], v68 offset:36864
 ds_read_b128 v[144:147], v68 offset:38912
 s_waitcnt lgkmcnt(4)
 v_mfma_f32_16x16x32_bf16 v[76:79], v[148:151], a[64:67], v[76:79]
 v_mfma_f32_16x16x32_bf16 v[84:87], v[148:151], a[144:147], v[84:87]
 v_mfma_f32_16x16x32_bf16 v[92:95], v[148:151], a[224:227], v[92:95]
 v_mfma_f32_16x16x32_bf16 v[100:103], v[148:151], v[52:55], v[100:103]
 v_mfma_f32_16x16x32_bf16 v[80:83], v[152:155], a[64:67], v[80:83]
 v_mfma_f32_16x16x32_bf16 v[88:91], v[152:155], a[144:147], v[88:91]
 v_mfma_f32_16x16x32_bf16 v[96:99], v[152:155], a[224:227], v[96:99]
 v_mfma_f32_16x16x32_bf16 v[104:107], v[152:155], v[52:55], v[104:107]
 ds_read_b128 v[148:151], v69 offset:36864
 ds_read_b128 v[152:155], v69 offset:38912
 s_waitcnt lgkmcnt(4)
 v_mfma_f32_16x16x32_bf16 v[76:79], v[156:159], a[68:71], v[76:79]
 v_mfma_f32_16x16x32_bf16 v[84:87], v[156:159], a[148:151], v[84:87]
 v_mfma_f32_16x16x32_bf16 v[92:95], v[156:159], a[228:231], v[92:95]
 v_mfma_f32_16x16x32_bf16 v[100:103], v[156:159], v[56:59], v[100:103]
 v_mfma_f32_16x16x32_bf16 v[80:83], v[160:163], a[68:71], v[80:83]
 v_mfma_f32_16x16x32_bf16 v[88:91], v[160:163], a[148:151], v[88:91]
 v_mfma_f32_16x16x32_bf16 v[96:99], v[160:163], a[228:231], v[96:99]
 v_mfma_f32_16x16x32_bf16 v[104:107], v[160:163], v[56:59], v[104:107]
 s_waitcnt lgkmcnt(3)
 v_mfma_f32_16x16x32_bf16 v[76:79], v[140:143], a[72:75], v[76:79]
 v_mfma_f32_16x16x32_bf16 v[84:87], v[140:143], a[152:155], v[84:87]
 v_mfma_f32_16x16x32_bf16 v[92:95], v[140:143], a[232:235], v[92:95]
 v_mfma_f32_16x16x32_bf16 v[100:103], v[140:143], v[60:63], v[100:103]
 s_waitcnt lgkmcnt(2)
 v_mfma_f32_16x16x32_bf16 v[80:83], v[144:147], a[72:75], v[80:83]
 v_mfma_f32_16x16x32_bf16 v[88:91], v[144:147], a[152:155], v[88:91]
 v_mfma_f32_16x16x32_bf16 v[96:99], v[144:147], a[232:235], v[96:99]
 v_mfma_f32_16x16x32_bf16 v[104:107], v[144:147], v[60:63], v[104:107]
 s_waitcnt lgkmcnt(1)
 v_mfma_f32_16x16x32_bf16 v[76:79], v[148:151], a[76:79], v[76:79]
 s_mov_b32 s50, s53
 v_mfma_f32_16x16x32_bf16 v[84:87], v[148:151], a[156:159], v[84:87]
 s_mov_b32 s48, s51
 v_mfma_f32_16x16x32_bf16 v[92:95], v[148:151], a[236:239], v[92:95]
 s_mov_b32 s49, s52
 v_mfma_f32_16x16x32_bf16 v[100:103], v[148:151], v[64:67], v[100:103]
 s_waitcnt lgkmcnt(0)
 v_mfma_f32_16x16x32_bf16 v[80:83], v[152:155], a[76:79], v[80:83]
 v_mfma_f32_16x16x32_bf16 v[88:91], v[152:155], a[156:159], v[88:91]
 v_mfma_f32_16x16x32_bf16 v[96:99], v[152:155], a[236:239], v[96:99]
 v_mfma_f32_16x16x32_bf16 v[104:107], v[152:155], v[64:67], v[104:107]
 s_branch Lqc_328
Lqd_334:
 s_endpgm
Lqc_328:
 v_cvt_pk_bf16_f32 v164, v76, v77
 v_cvt_pk_bf16_f32 v165, v78, v79
 v_cvt_pk_bf16_f32 v166, v80, v81
 v_cvt_pk_bf16_f32 v167, v82, v83
 buffer_store_dwordx4 v[164:167], v2, s[4:7], s50 offen offset:0 sc1
 v_cvt_pk_bf16_f32 v168, v84, v85
 v_cvt_pk_bf16_f32 v169, v86, v87
 v_cvt_pk_bf16_f32 v170, v88, v89
 v_cvt_pk_bf16_f32 v171, v90, v91
 buffer_store_dwordx4 v[168:171], v2, s[4:7], s50 offen offset:1024 sc1
 v_cvt_pk_bf16_f32 v172, v92, v93
 v_cvt_pk_bf16_f32 v173, v94, v95
 v_cvt_pk_bf16_f32 v174, v96, v97
 v_cvt_pk_bf16_f32 v175, v98, v99
 buffer_store_dwordx4 v[172:175], v2, s[4:7], s50 offen offset:2048 sc1
 v_cvt_pk_bf16_f32 v176, v100, v101
 v_cvt_pk_bf16_f32 v177, v102, v103
 v_cvt_pk_bf16_f32 v178, v104, v105
 v_cvt_pk_bf16_f32 v179, v106, v107
 buffer_store_dwordx4 v[176:179], v2, s[4:7], s50 offen offset:3072 sc1
 buffer_load_dword v72, v73, s[4:7], 0 offen sc1
 s_waitcnt vmcnt(1)
 s_mov_b64 exec, 1
 v_mov_b32 v74, s49
 buffer_store_dword v74, off, s[4:7], s48 sc1
 s_mov_b64 exec, -1
 s_cmp_ge_u32 s27, 128
 s_cbranch_scc1 Lqd_343
 s_waitcnt vmcnt(1)
 v_cmp_lt_u32 vcc, s41, v72
 s_nop 0
 s_cmp_eq_u64 vcc, -1
 s_cbranch_scc1 Lqs_344
 s_cmp_eq_u32 s40, 0
 s_cbranch_scc1 Lqs_344
 s_add_u32 s22, s41, 1
 s_mov_b32 s24, 0
Lw_345:
 s_add_u32 s24, s24, 1
 s_cmp_gt_u32 s24, 200000
 s_cbranch_scc1 L_fail
 buffer_load_dword v72, v73, s[4:7], 0 offen sc1
 s_waitcnt vmcnt(0)
 v_cmp_le_u32 vcc, s22, v72
 s_nop 0
 s_cmp_eq_u64 vcc, -1
 s_cbranch_scc0 Lw_345
Lqs_344:
 buffer_load_dword v72, v73, s[4:7], 0 offen sc1
 s_mov_b32 s42, 0
 s_add_u32 m0, s47, 0
 s_nop 0
 buffer_load_dwordx4 v3, s[4:7], s46 offen offset:0 sc1 lds
 s_add_u32 m0, s47, 3968
 s_nop 0
 buffer_load_dwordx4 v3, s[4:7], s46 offen offset:128 sc1 lds
 s_add_u32 m0, s47, 7936
 s_nop 0
 buffer_load_dwordx4 v3, s[4:7], s46 offen offset:256 sc1 lds
 s_add_u32 m0, s47, 11904
 s_nop 0
 buffer_load_dwordx4 v3, s[4:7], s46 offen offset:384 sc1 lds
 s_add_u32 m0, s47, 15872
 s_nop 0
 buffer_load_dwordx4 v3, s[4:7], s46 offen offset:512 sc1 lds
 s_add_u32 m0, s47, 19840
 s_nop 0
 buffer_load_dwordx4 v3, s[4:7], s46 offen offset:640 sc1 lds
 s_add_u32 m0, s47, 23808
 s_nop 0
 buffer_load_dwordx4 v3, s[4:7], s46 offen offset:768 sc1 lds
 s_add_u32 m0, s47, 27776
 s_nop 0
 buffer_load_dwordx4 v3, s[4:7], s46 offen offset:896 sc1 lds
 s_add_u32 m0, s47, 31744
 s_nop 0
 buffer_load_dwordx4 v3, s[4:7], s46 offen offset:1024 sc1 lds
 s_add_u32 m0, s47, 35712
 s_nop 0
 buffer_load_dwordx4 v3, s[4:7], s46 offen offset:1152 sc1 lds
 s_waitcnt vmcnt(9)
 s_barrier
 ds_read_b128 v[140:143], v70 offset:0
 ds_read_b128 v[144:147], v70 offset:2048
 ds_read_b128 v[148:151], v71 offset:0
 ds_read_b128 v[152:155], v71 offset:2048
 s_waitcnt vmcnt(7)
 s_barrier
 ds_read_b128 v[156:159], v70 offset:4096
 ds_read_b128 v[160:163], v70 offset:6144
 s_waitcnt lgkmcnt(5)
 v_mfma_f32_16x16x32_bf16 v[108:111], v[140:143], a[0:3], 0
 s_mul_i32 s19, s41, 393216
 v_mfma_f32_16x16x32_bf16 v[116:119], v[140:143], a[80:83], 0
 s_cmp_eq_u32 s40, 0
 v_mfma_f32_16x16x32_bf16 v[124:127], v[140:143], a[160:163], 0
 s_cselect_b32 s20, s43, s44
 v_mfma_f32_16x16x32_bf16 v[132:135], v[140:143], a[240:243], 0
 s_add_u32 s53, s19, s20
 s_waitcnt lgkmcnt(4)
 v_mfma_f32_16x16x32_bf16 v[112:115], v[144:147], a[0:3], 0
 s_lshl_b32 s51, s40, 16
 v_mfma_f32_16x16x32_bf16 v[120:123], v[144:147], a[80:83], 0
 s_add_u32 s51, s51, s45
 v_mfma_f32_16x16x32_bf16 v[128:131], v[144:147], a[160:163], 0
 s_add_u32 s52, s41, 1
 v_mfma_f32_16x16x32_bf16 v[136:139], v[144:147], a[240:243], 0
 ds_read_b128 v[140:143], v71 offset:4096
 ds_read_b128 v[144:147], v71 offset:6144
 s_waitcnt lgkmcnt(4)
 v_mfma_f32_16x16x32_bf16 v[108:111], v[148:151], a[4:7], v[108:111]
 s_add_u32 s27, s27, 1
 v_mfma_f32_16x16x32_bf16 v[116:119], v[148:151], a[84:87], v[116:119]
 s_sub_u32 s19, s27, 13
 v_mfma_f32_16x16x32_bf16 v[124:127], v[148:151], a[164:167], v[124:127]
 s_lshr_b32 s20, s19, 1
 v_mfma_f32_16x16x32_bf16 v[132:135], v[148:151], a[244:247], v[132:135]
 s_add_u32 s21, s20, 13
 v_mfma_f32_16x16x32_bf16 v[112:115], v[152:155], a[4:7], v[112:115]
 s_bitcmp1_b32 s19, 0
 v_mfma_f32_16x16x32_bf16 v[120:123], v[152:155], a[84:87], v[120:123]
 s_cselect_b32 s41, s21, s20
 v_mfma_f32_16x16x32_bf16 v[128:131], v[152:155], a[164:167], v[128:131]
 s_cselect_b32 s40, 0, 1
 v_mfma_f32_16x16x32_bf16 v[136:139], v[152:155], a[244:247], v[136:139]
 ds_read_b128 v[148:151], v70 offset:8192
 ds_read_b128 v[152:155], v70 offset:10240
 s_waitcnt lgkmcnt(4)
 v_mfma_f32_16x16x32_bf16 v[108:111], v[156:159], a[8:11], v[108:111]
 s_cmp_lt_u32 s27, 13
 v_mfma_f32_16x16x32_bf16 v[116:119], v[156:159], a[88:91], v[116:119]
 s_cselect_b32 s41, s27, s41
 v_mfma_f32_16x16x32_bf16 v[124:127], v[156:159], a[168:171], v[124:127]
 s_cselect_b32 s40, 0, s40
 v_mfma_f32_16x16x32_bf16 v[132:135], v[156:159], a[248:251], v[132:135]
 s_sub_u32 s19, s27, 64
 v_mfma_f32_16x16x32_bf16 v[112:115], v[160:163], a[8:11], v[112:115]
 s_cmp_ge_u32 s27, 115
 v_mfma_f32_16x16x32_bf16 v[120:123], v[160:163], a[88:91], v[120:123]
 s_cselect_b32 s41, s19, s41
 v_mfma_f32_16x16x32_bf16 v[128:131], v[160:163], a[168:171], v[128:131]
 s_cselect_b32 s40, 1, s40
 v_mfma_f32_16x16x32_bf16 v[136:139], v[160:163], a[248:251], v[136:139]
 ds_read_b128 v[156:159], v71 offset:8192
 ds_read_b128 v[160:163], v71 offset:10240
 s_waitcnt lgkmcnt(4)
 v_mfma_f32_16x16x32_bf16 v[108:111], v[140:143], a[12:15], v[108:111]
 s_mul_i32 s46, s41, 40960
 v_mfma_f32_16x16x32_bf16 v[116:119], v[140:143], a[92:95], v[116:119]
 s_cmp_eq_u32 s40, 0
 v_mfma_f32_16x16x32_bf16 v[124:127], v[140:143], a[172:175], v[124:127]
 s_cselect_b32 s19, 0, 2621440
 v_mfma_f32_16x16x32_bf16 v[132:135], v[140:143], a[252:255], v[132:135]
 s_add_u32 s46, s46, s19
 v_mfma_f32_16x16x32_bf16 v[112:115], v[144:147], a[12:15], v[112:115]
 s_add_u32 s46, s46, 184975360
 v_mfma_f32_16x16x32_bf16 v[120:123], v[144:147], a[92:95], v[120:123]
 s_xor_b32 s47, s47, 40960
 v_mfma_f32_16x16x32_bf16 v[128:131], v[144:147], a[172:175], v[128:131]
 v_mfma_f32_16x16x32_bf16 v[136:139], v[144:147], a[252:255], v[136:139]
 s_branch Lqm_340
Lqw_330:
 buffer_load_dword v72, v73, s[4:7], 0 offen sc1
 s_mov_b32 s42, 1
 s_waitcnt vmcnt(9)
 s_barrier
 ds_read_b128 v[140:143], v70 offset:0
 ds_read_b128 v[144:147], v70 offset:2048
 ds_read_b128 v[148:151], v71 offset:0
 ds_read_b128 v[152:155], v71 offset:2048
 s_waitcnt vmcnt(7)
 s_barrier
 ds_read_b128 v[156:159], v70 offset:4096
 ds_read_b128 v[160:163], v70 offset:6144
 s_waitcnt lgkmcnt(5)
 v_mfma_f32_16x16x32_bf16 v[108:111], v[140:143], a[0:3], 0
 v_cvt_pk_bf16_f32 v164, v76, v77
 v_cvt_pk_bf16_f32 v165, v78, v79
 v_mfma_f32_16x16x32_bf16 v[116:119], v[140:143], a[80:83], 0
 v_cvt_pk_bf16_f32 v166, v80, v81
 v_cvt_pk_bf16_f32 v167, v82, v83
 v_mfma_f32_16x16x32_bf16 v[124:127], v[140:143], a[160:163], 0
 buffer_store_dwordx4 v[164:167], v2, s[4:7], s50 offen offset:0 sc1
 s_mul_i32 s19, s41, 393216
 v_mfma_f32_16x16x32_bf16 v[132:135], v[140:143], a[240:243], 0
 s_cmp_eq_u32 s40, 0
 s_cselect_b32 s20, s43, s44
 s_waitcnt lgkmcnt(4)
 v_mfma_f32_16x16x32_bf16 v[112:115], v[144:147], a[0:3], 0
 s_add_u32 s53, s19, s20
 v_mfma_f32_16x16x32_bf16 v[120:123], v[144:147], a[80:83], 0
 s_lshl_b32 s51, s40, 16
 v_mfma_f32_16x16x32_bf16 v[128:131], v[144:147], a[160:163], 0
 s_add_u32 s51, s51, s45
 v_mfma_f32_16x16x32_bf16 v[136:139], v[144:147], a[240:243], 0
 s_add_u32 s52, s41, 1
 ds_read_b128 v[140:143], v71 offset:4096
 ds_read_b128 v[144:147], v71 offset:6144
 s_waitcnt lgkmcnt(4)
 v_mfma_f32_16x16x32_bf16 v[108:111], v[148:151], a[4:7], v[108:111]
 v_cvt_pk_bf16_f32 v168, v84, v85
 v_cvt_pk_bf16_f32 v169, v86, v87
 v_mfma_f32_16x16x32_bf16 v[116:119], v[148:151], a[84:87], v[116:119]
 v_cvt_pk_bf16_f32 v170, v88, v89
 v_cvt_pk_bf16_f32 v171, v90, v91
 v_mfma_f32_16x16x32_bf16 v[124:127], v[148:151], a[164:167], v[124:127]
 buffer_store_dwordx4 v[168:171], v2, s[4:7], s50 offen offset:1024 sc1
 s_add_u32 s27, s27, 1
 v_mfma_f32_16x16x32_bf16 v[132:135], v[148:151], a[244:247], v[132:135]
 s_sub_u32 s19, s27, 13
 s_lshr_b32 s20, s19, 1
 v_mfma_f32_16x16x32_bf16 v[112:115], v[152:155], a[4:7], v[112:115]
 s_add_u32 s21, s20, 13
 v_mfma_f32_16x16x32_bf16 v[120:123], v[152:155], a[84:87], v[120:123]
 s_bitcmp1_b32 s19, 0
 v_mfma_f32_16x16x32_bf16 v[128:131], v[152:155], a[164:167], v[128:131]
 s_cselect_b32 s41, s21, s20
 v_mfma_f32_16x16x32_bf16 v[136:139], v[152:155], a[244:247], v[136:139]
 s_cselect_b32 s40, 0, 1
 ds_read_b128 v[148:151], v70 offset:8192
 ds_read_b128 v[152:155], v70 offset:10240
 s_waitcnt lgkmcnt(4)
 v_mfma_f32_16x16x32_bf16 v[108:111], v[156:159], a[8:11], v[108:111]
 v_cvt_pk_bf16_f32 v172, v92, v93
 v_cvt_pk_bf16_f32 v173, v94, v95
 v_mfma_f32_16x16x32_bf16 v[116:119], v[156:159], a[88:91], v[116:119]
 v_cvt_pk_bf16_f32 v174, v96, v97
 v_cvt_pk_bf16_f32 v175, v98, v99
 v_mfma_f32_16x16x32_bf16 v[124:127], v[156:159], a[168:171], v[124:127]
 buffer_store_dwordx4 v[172:175], v2, s[4:7], s50 offen offset:2048 sc1
 s_cmp_lt_u32 s27, 13
 v_mfma_f32_16x16x32_bf16 v[132:135], v[156:159], a[248:251], v[132:135]
 s_cselect_b32 s41, s27, s41
 s_cselect_b32 s40, 0, s40
 v_mfma_f32_16x16x32_bf16 v[112:115], v[160:163], a[8:11], v[112:115]
 s_sub_u32 s19, s27, 64
 v_mfma_f32_16x16x32_bf16 v[120:123], v[160:163], a[88:91], v[120:123]
 s_cmp_ge_u32 s27, 115
 v_mfma_f32_16x16x32_bf16 v[128:131], v[160:163], a[168:171], v[128:131]
 s_cselect_b32 s41, s19, s41
 v_mfma_f32_16x16x32_bf16 v[136:139], v[160:163], a[248:251], v[136:139]
 s_cselect_b32 s40, 1, s40
 ds_read_b128 v[156:159], v71 offset:8192
 ds_read_b128 v[160:163], v71 offset:10240
 s_waitcnt lgkmcnt(4)
 v_mfma_f32_16x16x32_bf16 v[108:111], v[140:143], a[12:15], v[108:111]
 v_cvt_pk_bf16_f32 v176, v100, v101
 v_cvt_pk_bf16_f32 v177, v102, v103
 v_mfma_f32_16x16x32_bf16 v[116:119], v[140:143], a[92:95], v[116:119]
 v_cvt_pk_bf16_f32 v178, v104, v105
 v_cvt_pk_bf16_f32 v179, v106, v107
 v_mfma_f32_16x16x32_bf16 v[124:127], v[140:143], a[172:175], v[124:127]
 buffer_store_dwordx4 v[176:179], v2, s[4:7], s50 offen offset:3072 sc1
 s_mul_i32 s46, s41, 40960
 v_mfma_f32_16x16x32_bf16 v[132:135], v[140:143], a[252:255], v[132:135]
 s_cmp_eq_u32 s40, 0
 v_mfma_f32_16x16x32_bf16 v[112:115], v[144:147], a[12:15], v[112:115]
 s_cselect_b32 s19, 0, 2621440
 v_mfma_f32_16x16x32_bf16 v[120:123], v[144:147], a[92:95], v[120:123]
 s_add_u32 s46, s46, s19
 v_mfma_f32_16x16x32_bf16 v[128:131], v[144:147], a[172:175], v[128:131]
 s_add_u32 s46, s46, 184975360
 v_mfma_f32_16x16x32_bf16 v[136:139], v[144:147], a[252:255], v[136:139]
 s_xor_b32 s47, s47, 40960
Lqm_340:
 s_waitcnt vmcnt(5)
 s_barrier
 ds_read_b128 v[140:143], v70 offset:12288
 ds_read_b128 v[144:147], v70 offset:14336
 s_waitcnt lgkmcnt(4)
 v_mfma_f32_16x16x32_bf16 v[108:111], v[148:151], a[16:19], v[108:111]
 v_mfma_f32_16x16x32_bf16 v[116:119], v[148:151], a[96:99], v[116:119]
 v_mfma_f32_16x16x32_bf16 v[124:127], v[148:151], a[176:179], v[124:127]
 v_mfma_f32_16x16x32_bf16 v[132:135], v[148:151], v[4:7], v[132:135]
 v_mfma_f32_16x16x32_bf16 v[112:115], v[152:155], a[16:19], v[112:115]
 v_mfma_f32_16x16x32_bf16 v[120:123], v[152:155], a[96:99], v[120:123]
 v_mfma_f32_16x16x32_bf16 v[128:131], v[152:155], a[176:179], v[128:131]
 v_mfma_f32_16x16x32_bf16 v[136:139], v[152:155], v[4:7], v[136:139]
 ds_read_b128 v[148:151], v71 offset:12288
 ds_read_b128 v[152:155], v71 offset:14336
 s_waitcnt lgkmcnt(4)
 v_mfma_f32_16x16x32_bf16 v[108:111], v[156:159], a[20:23], v[108:111]
 v_mfma_f32_16x16x32_bf16 v[116:119], v[156:159], a[100:103], v[116:119]
 v_mfma_f32_16x16x32_bf16 v[124:127], v[156:159], a[180:183], v[124:127]
 v_mfma_f32_16x16x32_bf16 v[132:135], v[156:159], v[8:11], v[132:135]
 v_mfma_f32_16x16x32_bf16 v[112:115], v[160:163], a[20:23], v[112:115]
 v_mfma_f32_16x16x32_bf16 v[120:123], v[160:163], a[100:103], v[120:123]
 v_mfma_f32_16x16x32_bf16 v[128:131], v[160:163], a[180:183], v[128:131]
 v_mfma_f32_16x16x32_bf16 v[136:139], v[160:163], v[8:11], v[136:139]
 ds_read_b128 v[156:159], v70 offset:16384
 ds_read_b128 v[160:163], v70 offset:18432
 s_waitcnt lgkmcnt(4)
 v_mfma_f32_16x16x32_bf16 v[108:111], v[140:143], a[24:27], v[108:111]
 v_mfma_f32_16x16x32_bf16 v[116:119], v[140:143], a[104:107], v[116:119]
 v_mfma_f32_16x16x32_bf16 v[124:127], v[140:143], a[184:187], v[124:127]
 v_mfma_f32_16x16x32_bf16 v[132:135], v[140:143], v[12:15], v[132:135]
 v_mfma_f32_16x16x32_bf16 v[112:115], v[144:147], a[24:27], v[112:115]
 v_mfma_f32_16x16x32_bf16 v[120:123], v[144:147], a[104:107], v[120:123]
 v_mfma_f32_16x16x32_bf16 v[128:131], v[144:147], a[184:187], v[128:131]
 v_mfma_f32_16x16x32_bf16 v[136:139], v[144:147], v[12:15], v[136:139]
 s_cmp_ge_u32 s27, 128
 s_cbranch_scc1 Lqp_342
 s_cmp_eq_u32 s40, 0
 s_cbranch_scc1 Lqo_346
 s_waitcnt vmcnt(4)
 v_cmp_lt_u32 vcc, s41, v72
 s_nop 0
 s_cmp_eq_u64 vcc, -1
 s_cbranch_scc0 Lqp_342
Lqo_346:
 ds_read_b128 v[140:143], v71 offset:16384
 ds_read_b128 v[144:147], v71 offset:18432
 s_waitcnt lgkmcnt(4)
 v_mfma_f32_16x16x32_bf16 v[108:111], v[148:151], a[28:31], v[108:111]
 s_add_u32 m0, s47, 0
 v_mfma_f32_16x16x32_bf16 v[116:119], v[148:151], a[108:111], v[116:119]
 buffer_load_dwordx4 v3, s[4:7], s46 offen offset:0 sc1 lds
 v_mfma_f32_16x16x32_bf16 v[124:127], v[148:151], a[188:191], v[124:127]
 v_mfma_f32_16x16x32_bf16 v[132:135], v[148:151], v[16:19], v[132:135]
 v_mfma_f32_16x16x32_bf16 v[112:115], v[152:155], a[28:31], v[112:115]
 v_mfma_f32_16x16x32_bf16 v[120:123], v[152:155], a[108:111], v[120:123]
 v_mfma_f32_16x16x32_bf16 v[128:131], v[152:155], a[188:191], v[128:131]
 v_mfma_f32_16x16x32_bf16 v[136:139], v[152:155], v[16:19], v[136:139]
 s_waitcnt vmcnt(4)
 s_barrier
 ds_read_b128 v[148:151], v70 offset:20480
 ds_read_b128 v[152:155], v70 offset:22528
 s_waitcnt lgkmcnt(4)
 v_mfma_f32_16x16x32_bf16 v[108:111], v[156:159], a[32:35], v[108:111]
 s_add_u32 m0, s47, 3968
 v_mfma_f32_16x16x32_bf16 v[116:119], v[156:159], a[112:115], v[116:119]
 buffer_load_dwordx4 v3, s[4:7], s46 offen offset:128 sc1 lds
 v_mfma_f32_16x16x32_bf16 v[124:127], v[156:159], a[192:195], v[124:127]
 v_mfma_f32_16x16x32_bf16 v[132:135], v[156:159], v[20:23], v[132:135]
 v_mfma_f32_16x16x32_bf16 v[112:115], v[160:163], a[32:35], v[112:115]
 v_mfma_f32_16x16x32_bf16 v[120:123], v[160:163], a[112:115], v[120:123]
 v_mfma_f32_16x16x32_bf16 v[128:131], v[160:163], a[192:195], v[128:131]
 v_mfma_f32_16x16x32_bf16 v[136:139], v[160:163], v[20:23], v[136:139]
 ds_read_b128 v[156:159], v71 offset:20480
 ds_read_b128 v[160:163], v71 offset:22528
 s_waitcnt lgkmcnt(4)
 v_mfma_f32_16x16x32_bf16 v[108:111], v[140:143], a[36:39], v[108:111]
 s_add_u32 m0, s47, 7936
 v_mfma_f32_16x16x32_bf16 v[116:119], v[140:143], a[116:119], v[116:119]
 buffer_load_dwordx4 v3, s[4:7], s46 offen offset:256 sc1 lds
 v_mfma_f32_16x16x32_bf16 v[124:127], v[140:143], a[196:199], v[124:127]
 v_mfma_f32_16x16x32_bf16 v[132:135], v[140:143], v[24:27], v[132:135]
 v_mfma_f32_16x16x32_bf16 v[112:115], v[144:147], a[36:39], v[112:115]
 v_mfma_f32_16x16x32_bf16 v[120:123], v[144:147], a[116:119], v[120:123]
 v_mfma_f32_16x16x32_bf16 v[128:131], v[144:147], a[196:199], v[128:131]
 v_mfma_f32_16x16x32_bf16 v[136:139], v[144:147], v[24:27], v[136:139]
 ds_read_b128 v[140:143], v70 offset:24576
 ds_read_b128 v[144:147], v70 offset:26624
 s_waitcnt lgkmcnt(4)
 v_mfma_f32_16x16x32_bf16 v[108:111], v[148:151], a[40:43], v[108:111]
 s_add_u32 m0, s47, 11904
 v_mfma_f32_16x16x32_bf16 v[116:119], v[148:151], a[120:123], v[116:119]
 buffer_load_dwordx4 v3, s[4:7], s46 offen offset:384 sc1 lds
 v_mfma_f32_16x16x32_bf16 v[124:127], v[148:151], a[200:203], v[124:127]
 v_mfma_f32_16x16x32_bf16 v[132:135], v[148:151], v[28:31], v[132:135]
 v_mfma_f32_16x16x32_bf16 v[112:115], v[152:155], a[40:43], v[112:115]
 v_mfma_f32_16x16x32_bf16 v[120:123], v[152:155], a[120:123], v[120:123]
 v_mfma_f32_16x16x32_bf16 v[128:131], v[152:155], a[200:203], v[128:131]
 v_mfma_f32_16x16x32_bf16 v[136:139], v[152:155], v[28:31], v[136:139]
 s_cmp_eq_u32 s42, 1
 s_cbranch_scc0 Lqn_347
 s_waitcnt vmcnt(4)
 s_mov_b64 exec, 1
 v_mov_b32 v74, s49
 buffer_store_dword v74, off, s[4:7], s48 sc1
 s_mov_b64 exec, -1
Lqn_347:
 ds_read_b128 v[148:151], v71 offset:24576
 ds_read_b128 v[152:155], v71 offset:26624
 s_waitcnt lgkmcnt(4)
 v_mfma_f32_16x16x32_bf16 v[108:111], v[156:159], a[44:47], v[108:111]
 s_add_u32 m0, s47, 15872
 v_mfma_f32_16x16x32_bf16 v[116:119], v[156:159], a[124:127], v[116:119]
 buffer_load_dwordx4 v3, s[4:7], s46 offen offset:512 sc1 lds
 v_mfma_f32_16x16x32_bf16 v[124:127], v[156:159], a[204:207], v[124:127]
 v_mfma_f32_16x16x32_bf16 v[132:135], v[156:159], v[32:35], v[132:135]
 v_mfma_f32_16x16x32_bf16 v[112:115], v[160:163], a[44:47], v[112:115]
 v_mfma_f32_16x16x32_bf16 v[120:123], v[160:163], a[124:127], v[120:123]
 v_mfma_f32_16x16x32_bf16 v[128:131], v[160:163], a[204:207], v[128:131]
 v_mfma_f32_16x16x32_bf16 v[136:139], v[160:163], v[32:35], v[136:139]
 s_waitcnt vmcnt(5)
 s_barrier
 ds_read_b128 v[156:159], v70 offset:28672
 ds_read_b128 v[160:163], v70 offset:30720
 s_waitcnt lgkmcnt(4)
 v_mfma_f32_16x16x32_bf16 v[108:111], v[140:143], a[48:51], v[108:111]
 s_add_u32 m0, s47, 19840
 v_mfma_f32_16x16x32_bf16 v[116:119], v[140:143], a[128:131], v[116:119]
 buffer_load_dwordx4 v3, s[4:7], s46 offen offset:640 sc1 lds
 v_mfma_f32_16x16x32_bf16 v[124:127], v[140:143], a[208:211], v[124:127]
 v_mfma_f32_16x16x32_bf16 v[132:135], v[140:143], v[36:39], v[132:135]
 v_mfma_f32_16x16x32_bf16 v[112:115], v[144:147], a[48:51], v[112:115]
 v_mfma_f32_16x16x32_bf16 v[120:123], v[144:147], a[128:131], v[120:123]
 v_mfma_f32_16x16x32_bf16 v[128:131], v[144:147], a[208:211], v[128:131]
 v_mfma_f32_16x16x32_bf16 v[136:139], v[144:147], v[36:39], v[136:139]
 ds_read_b128 v[140:143], v71 offset:28672
 ds_read_b128 v[144:147], v71 offset:30720
 s_waitcnt lgkmcnt(4)
 v_mfma_f32_16x16x32_bf16 v[108:111], v[148:151], a[52:55], v[108:111]
 s_add_u32 m0, s47, 23808
 v_mfma_f32_16x16x32_bf16 v[116:119], v[148:151], a[132:135], v[116:119]
 buffer_load_dwordx4 v3, s[4:7], s46 offen offset:768 sc1 lds
 v_mfma_f32_16x16x32_bf16 v[124:127], v[148:151], a[212:215], v[124:127]
 v_mfma_f32_16x16x32_bf16 v[132:135], v[148:151], v[40:43], v[132:135]
 v_mfma_f32_16x16x32_bf16 v[112:115], v[152:155], a[52:55], v[112:115]
 v_mfma_f32_16x16x32_bf16 v[120:123], v[152:155], a[132:135], v[120:123]
 v_mfma_f32_16x16x32_bf16 v[128:131], v[152:155], a[212:215], v[128:131]
 v_mfma_f32_16x16x32_bf16 v[136:139], v[152:155], v[40:43], v[136:139]
 ds_read_b128 v[148:151], v70 offset:32768
 ds_read_b128 v[152:155], v70 offset:34816
 s_waitcnt lgkmcnt(4)
 v_mfma_f32_16x16x32_bf16 v[108:111], v[156:159], a[56:59], v[108:111]
 s_add_u32 m0, s47, 27776
 v_mfma_f32_16x16x32_bf16 v[116:119], v[156:159], a[136:139], v[116:119]
 buffer_load_dwordx4 v3, s[4:7], s46 offen offset:896 sc1 lds
 v_mfma_f32_16x16x32_bf16 v[124:127], v[156:159], a[216:219], v[124:127]
 v_mfma_f32_16x16x32_bf16 v[132:135], v[156:159], v[44:47], v[132:135]
 v_mfma_f32_16x16x32_bf16 v[112:115], v[160:163], a[56:59], v[112:115]
 v_mfma_f32_16x16x32_bf16 v[120:123], v[160:163], a[136:139], v[120:123]
 v_mfma_f32_16x16x32_bf16 v[128:131], v[160:163], a[216:219], v[128:131]
 v_mfma_f32_16x16x32_bf16 v[136:139], v[160:163], v[44:47], v[136:139]
 ds_read_b128 v[156:159], v71 offset:32768
 ds_read_b128 v[160:163], v71 offset:34816
 s_waitcnt lgkmcnt(4)
 v_mfma_f32_16x16x32_bf16 v[108:111], v[140:143], a[60:63], v[108:111]
 s_add_u32 m0, s47, 31744
 v_mfma_f32_16x16x32_bf16 v[116:119], v[140:143], a[140:143], v[116:119]
 buffer_load_dwordx4 v3, s[4:7], s46 offen offset:1024 sc1 lds
 v_mfma_f32_16x16x32_bf16 v[124:127], v[140:143], a[220:223], v[124:127]
 v_mfma_f32_16x16x32_bf16 v[132:135], v[140:143], v[48:51], v[132:135]
 v_mfma_f32_16x16x32_bf16 v[112:115], v[144:147], a[60:63], v[112:115]
 v_mfma_f32_16x16x32_bf16 v[120:123], v[144:147], a[140:143], v[120:123]
 v_mfma_f32_16x16x32_bf16 v[128:131], v[144:147], a[220:223], v[128:131]
 v_mfma_f32_16x16x32_bf16 v[136:139], v[144:147], v[48:51], v[136:139]
 ds_read_b128 v[140:143], v70 offset:36864
 ds_read_b128 v[144:147], v70 offset:38912
 s_waitcnt lgkmcnt(4)
 v_mfma_f32_16x16x32_bf16 v[108:111], v[148:151], a[64:67], v[108:111]
 s_add_u32 m0, s47, 35712
 v_mfma_f32_16x16x32_bf16 v[116:119], v[148:151], a[144:147], v[116:119]
 buffer_load_dwordx4 v3, s[4:7], s46 offen offset:1152 sc1 lds
 v_mfma_f32_16x16x32_bf16 v[124:127], v[148:151], a[224:227], v[124:127]
 v_mfma_f32_16x16x32_bf16 v[132:135], v[148:151], v[52:55], v[132:135]
 v_mfma_f32_16x16x32_bf16 v[112:115], v[152:155], a[64:67], v[112:115]
 v_mfma_f32_16x16x32_bf16 v[120:123], v[152:155], a[144:147], v[120:123]
 v_mfma_f32_16x16x32_bf16 v[128:131], v[152:155], a[224:227], v[128:131]
 v_mfma_f32_16x16x32_bf16 v[136:139], v[152:155], v[52:55], v[136:139]
 ds_read_b128 v[148:151], v71 offset:36864
 ds_read_b128 v[152:155], v71 offset:38912
 s_waitcnt lgkmcnt(4)
 v_mfma_f32_16x16x32_bf16 v[108:111], v[156:159], a[68:71], v[108:111]
 v_mfma_f32_16x16x32_bf16 v[116:119], v[156:159], a[148:151], v[116:119]
 v_mfma_f32_16x16x32_bf16 v[124:127], v[156:159], a[228:231], v[124:127]
 v_mfma_f32_16x16x32_bf16 v[132:135], v[156:159], v[56:59], v[132:135]
 v_mfma_f32_16x16x32_bf16 v[112:115], v[160:163], a[68:71], v[112:115]
 v_mfma_f32_16x16x32_bf16 v[120:123], v[160:163], a[148:151], v[120:123]
 v_mfma_f32_16x16x32_bf16 v[128:131], v[160:163], a[228:231], v[128:131]
 v_mfma_f32_16x16x32_bf16 v[136:139], v[160:163], v[56:59], v[136:139]
 s_waitcnt lgkmcnt(3)
 v_mfma_f32_16x16x32_bf16 v[108:111], v[140:143], a[72:75], v[108:111]
 v_mfma_f32_16x16x32_bf16 v[116:119], v[140:143], a[152:155], v[116:119]
 v_mfma_f32_16x16x32_bf16 v[124:127], v[140:143], a[232:235], v[124:127]
 v_mfma_f32_16x16x32_bf16 v[132:135], v[140:143], v[60:63], v[132:135]
 s_waitcnt lgkmcnt(2)
 v_mfma_f32_16x16x32_bf16 v[112:115], v[144:147], a[72:75], v[112:115]
 v_mfma_f32_16x16x32_bf16 v[120:123], v[144:147], a[152:155], v[120:123]
 v_mfma_f32_16x16x32_bf16 v[128:131], v[144:147], a[232:235], v[128:131]
 v_mfma_f32_16x16x32_bf16 v[136:139], v[144:147], v[60:63], v[136:139]
 s_waitcnt lgkmcnt(1)
 v_mfma_f32_16x16x32_bf16 v[108:111], v[148:151], a[76:79], v[108:111]
 s_mov_b32 s50, s53
 v_mfma_f32_16x16x32_bf16 v[116:119], v[148:151], a[156:159], v[116:119]
 s_mov_b32 s48, s51
 v_mfma_f32_16x16x32_bf16 v[124:127], v[148:151], a[236:239], v[124:127]
 s_mov_b32 s49, s52
 v_mfma_f32_16x16x32_bf16 v[132:135], v[148:151], v[64:67], v[132:135]
 s_waitcnt lgkmcnt(0)
 v_mfma_f32_16x16x32_bf16 v[112:115], v[152:155], a[76:79], v[112:115]
 v_mfma_f32_16x16x32_bf16 v[120:123], v[152:155], a[156:159], v[120:123]
 v_mfma_f32_16x16x32_bf16 v[128:131], v[152:155], a[236:239], v[128:131]
 v_mfma_f32_16x16x32_bf16 v[136:139], v[152:155], v[64:67], v[136:139]
 s_branch Lqw_329
Lqp_342:
 ds_read_b128 v[140:143], v71 offset:16384
 ds_read_b128 v[144:147], v71 offset:18432
 s_waitcnt lgkmcnt(4)
 v_mfma_f32_16x16x32_bf16 v[108:111], v[148:151], a[28:31], v[108:111]
 v_mfma_f32_16x16x32_bf16 v[116:119], v[148:151], a[108:111], v[116:119]
 v_mfma_f32_16x16x32_bf16 v[124:127], v[148:151], a[188:191], v[124:127]
 v_mfma_f32_16x16x32_bf16 v[132:135], v[148:151], v[16:19], v[132:135]
 v_mfma_f32_16x16x32_bf16 v[112:115], v[152:155], a[28:31], v[112:115]
 v_mfma_f32_16x16x32_bf16 v[120:123], v[152:155], a[108:111], v[120:123]
 v_mfma_f32_16x16x32_bf16 v[128:131], v[152:155], a[188:191], v[128:131]
 v_mfma_f32_16x16x32_bf16 v[136:139], v[152:155], v[16:19], v[136:139]
 s_waitcnt vmcnt(3)
 s_barrier
 ds_read_b128 v[148:151], v70 offset:20480
 ds_read_b128 v[152:155], v70 offset:22528
 s_waitcnt lgkmcnt(4)
 v_mfma_f32_16x16x32_bf16 v[108:111], v[156:159], a[32:35], v[108:111]
 v_mfma_f32_16x16x32_bf16 v[116:119], v[156:159], a[112:115], v[116:119]
 v_mfma_f32_16x16x32_bf16 v[124:127], v[156:159], a[192:195], v[124:127]
 v_mfma_f32_16x16x32_bf16 v[132:135], v[156:159], v[20:23], v[132:135]
 v_mfma_f32_16x16x32_bf16 v[112:115], v[160:163], a[32:35], v[112:115]
 v_mfma_f32_16x16x32_bf16 v[120:123], v[160:163], a[112:115], v[120:123]
 v_mfma_f32_16x16x32_bf16 v[128:131], v[160:163], a[192:195], v[128:131]
 v_mfma_f32_16x16x32_bf16 v[136:139], v[160:163], v[20:23], v[136:139]
 ds_read_b128 v[156:159], v71 offset:20480
 ds_read_b128 v[160:163], v71 offset:22528
 s_waitcnt lgkmcnt(4)
 v_mfma_f32_16x16x32_bf16 v[108:111], v[140:143], a[36:39], v[108:111]
 v_mfma_f32_16x16x32_bf16 v[116:119], v[140:143], a[116:119], v[116:119]
 v_mfma_f32_16x16x32_bf16 v[124:127], v[140:143], a[196:199], v[124:127]
 v_mfma_f32_16x16x32_bf16 v[132:135], v[140:143], v[24:27], v[132:135]
 v_mfma_f32_16x16x32_bf16 v[112:115], v[144:147], a[36:39], v[112:115]
 v_mfma_f32_16x16x32_bf16 v[120:123], v[144:147], a[116:119], v[120:123]
 v_mfma_f32_16x16x32_bf16 v[128:131], v[144:147], a[196:199], v[128:131]
 v_mfma_f32_16x16x32_bf16 v[136:139], v[144:147], v[24:27], v[136:139]
 ds_read_b128 v[140:143], v70 offset:24576
 ds_read_b128 v[144:147], v70 offset:26624
 s_waitcnt lgkmcnt(4)
 v_mfma_f32_16x16x32_bf16 v[108:111], v[148:151], a[40:43], v[108:111]
 v_mfma_f32_16x16x32_bf16 v[116:119], v[148:151], a[120:123], v[116:119]
 v_mfma_f32_16x16x32_bf16 v[124:127], v[148:151], a[200:203], v[124:127]
 v_mfma_f32_16x16x32_bf16 v[132:135], v[148:151], v[28:31], v[132:135]
 v_mfma_f32_16x16x32_bf16 v[112:115], v[152:155], a[40:43], v[112:115]
 v_mfma_f32_16x16x32_bf16 v[120:123], v[152:155], a[120:123], v[120:123]
 v_mfma_f32_16x16x32_bf16 v[128:131], v[152:155], a[200:203], v[128:131]
 v_mfma_f32_16x16x32_bf16 v[136:139], v[152:155], v[28:31], v[136:139]
 s_cmp_eq_u32 s42, 1
 s_cbranch_scc0 Lqn_348
 s_waitcnt vmcnt(0)
 s_mov_b64 exec, 1
 v_mov_b32 v74, s49
 buffer_store_dword v74, off, s[4:7], s48 sc1
 s_mov_b64 exec, -1
Lqn_348:
 ds_read_b128 v[148:151], v71 offset:24576
 ds_read_b128 v[152:155], v71 offset:26624
 s_waitcnt lgkmcnt(4)
 v_mfma_f32_16x16x32_bf16 v[108:111], v[156:159], a[44:47], v[108:111]
 v_mfma_f32_16x16x32_bf16 v[116:119], v[156:159], a[124:127], v[116:119]
 v_mfma_f32_16x16x32_bf16 v[124:127], v[156:159], a[204:207], v[124:127]
 v_mfma_f32_16x16x32_bf16 v[132:135], v[156:159], v[32:35], v[132:135]
 v_mfma_f32_16x16x32_bf16 v[112:115], v[160:163], a[44:47], v[112:115]
 v_mfma_f32_16x16x32_bf16 v[120:123], v[160:163], a[124:127], v[120:123]
 v_mfma_f32_16x16x32_bf16 v[128:131], v[160:163], a[204:207], v[128:131]
 v_mfma_f32_16x16x32_bf16 v[136:139], v[160:163], v[32:35], v[136:139]
 s_waitcnt vmcnt(0)
 s_barrier
 ds_read_b128 v[156:159], v70 offset:28672
 ds_read_b128 v[160:163], v70 offset:30720
 s_waitcnt lgkmcnt(4)
 v_mfma_f32_16x16x32_bf16 v[108:111], v[140:143], a[48:51], v[108:111]
 v_mfma_f32_16x16x32_bf16 v[116:119], v[140:143], a[128:131], v[116:119]
 v_mfma_f32_16x16x32_bf16 v[124:127], v[140:143], a[208:211], v[124:127]
 v_mfma_f32_16x16x32_bf16 v[132:135], v[140:143], v[36:39], v[132:135]
 v_mfma_f32_16x16x32_bf16 v[112:115], v[144:147], a[48:51], v[112:115]
 v_mfma_f32_16x16x32_bf16 v[120:123], v[144:147], a[128:131], v[120:123]
 v_mfma_f32_16x16x32_bf16 v[128:131], v[144:147], a[208:211], v[128:131]
 v_mfma_f32_16x16x32_bf16 v[136:139], v[144:147], v[36:39], v[136:139]
 ds_read_b128 v[140:143], v71 offset:28672
 ds_read_b128 v[144:147], v71 offset:30720
 s_waitcnt lgkmcnt(4)
 v_mfma_f32_16x16x32_bf16 v[108:111], v[148:151], a[52:55], v[108:111]
 v_mfma_f32_16x16x32_bf16 v[116:119], v[148:151], a[132:135], v[116:119]
 v_mfma_f32_16x16x32_bf16 v[124:127], v[148:151], a[212:215], v[124:127]
 v_mfma_f32_16x16x32_bf16 v[132:135], v[148:151], v[40:43], v[132:135]
 v_mfma_f32_16x16x32_bf16 v[112:115], v[152:155], a[52:55], v[112:115]
 v_mfma_f32_16x16x32_bf16 v[120:123], v[152:155], a[132:135], v[120:123]
 v_mfma_f32_16x16x32_bf16 v[128:131], v[152:155], a[212:215], v[128:131]
 v_mfma_f32_16x16x32_bf16 v[136:139], v[152:155], v[40:43], v[136:139]
 ds_read_b128 v[148:151], v70 offset:32768
 ds_read_b128 v[152:155], v70 offset:34816
 s_waitcnt lgkmcnt(4)
 v_mfma_f32_16x16x32_bf16 v[108:111], v[156:159], a[56:59], v[108:111]
 v_mfma_f32_16x16x32_bf16 v[116:119], v[156:159], a[136:139], v[116:119]
 v_mfma_f32_16x16x32_bf16 v[124:127], v[156:159], a[216:219], v[124:127]
 v_mfma_f32_16x16x32_bf16 v[132:135], v[156:159], v[44:47], v[132:135]
 v_mfma_f32_16x16x32_bf16 v[112:115], v[160:163], a[56:59], v[112:115]
 v_mfma_f32_16x16x32_bf16 v[120:123], v[160:163], a[136:139], v[120:123]
 v_mfma_f32_16x16x32_bf16 v[128:131], v[160:163], a[216:219], v[128:131]
 v_mfma_f32_16x16x32_bf16 v[136:139], v[160:163], v[44:47], v[136:139]
 ds_read_b128 v[156:159], v71 offset:32768
 ds_read_b128 v[160:163], v71 offset:34816
 s_waitcnt lgkmcnt(4)
 v_mfma_f32_16x16x32_bf16 v[108:111], v[140:143], a[60:63], v[108:111]
 v_mfma_f32_16x16x32_bf16 v[116:119], v[140:143], a[140:143], v[116:119]
 v_mfma_f32_16x16x32_bf16 v[124:127], v[140:143], a[220:223], v[124:127]
 v_mfma_f32_16x16x32_bf16 v[132:135], v[140:143], v[48:51], v[132:135]
 v_mfma_f32_16x16x32_bf16 v[112:115], v[144:147], a[60:63], v[112:115]
 v_mfma_f32_16x16x32_bf16 v[120:123], v[144:147], a[140:143], v[120:123]
 v_mfma_f32_16x16x32_bf16 v[128:131], v[144:147], a[220:223], v[128:131]
 v_mfma_f32_16x16x32_bf16 v[136:139], v[144:147], v[48:51], v[136:139]
 ds_read_b128 v[140:143], v70 offset:36864
 ds_read_b128 v[144:147], v70 offset:38912
 s_waitcnt lgkmcnt(4)
 v_mfma_f32_16x16x32_bf16 v[108:111], v[148:151], a[64:67], v[108:111]
 v_mfma_f32_16x16x32_bf16 v[116:119], v[148:151], a[144:147], v[116:119]
 v_mfma_f32_16x16x32_bf16 v[124:127], v[148:151], a[224:227], v[124:127]
 v_mfma_f32_16x16x32_bf16 v[132:135], v[148:151], v[52:55], v[132:135]
 v_mfma_f32_16x16x32_bf16 v[112:115], v[152:155], a[64:67], v[112:115]
 v_mfma_f32_16x16x32_bf16 v[120:123], v[152:155], a[144:147], v[120:123]
 v_mfma_f32_16x16x32_bf16 v[128:131], v[152:155], a[224:227], v[128:131]
 v_mfma_f32_16x16x32_bf16 v[136:139], v[152:155], v[52:55], v[136:139]
 ds_read_b128 v[148:151], v71 offset:36864
 ds_read_b128 v[152:155], v71 offset:38912
 s_waitcnt lgkmcnt(4)
 v_mfma_f32_16x16x32_bf16 v[108:111], v[156:159], a[68:71], v[108:111]
 v_mfma_f32_16x16x32_bf16 v[116:119], v[156:159], a[148:151], v[116:119]
 v_mfma_f32_16x16x32_bf16 v[124:127], v[156:159], a[228:231], v[124:127]
 v_mfma_f32_16x16x32_bf16 v[132:135], v[156:159], v[56:59], v[132:135]
 v_mfma_f32_16x16x32_bf16 v[112:115], v[160:163], a[68:71], v[112:115]
 v_mfma_f32_16x16x32_bf16 v[120:123], v[160:163], a[148:151], v[120:123]
 v_mfma_f32_16x16x32_bf16 v[128:131], v[160:163], a[228:231], v[128:131]
 v_mfma_f32_16x16x32_bf16 v[136:139], v[160:163], v[56:59], v[136:139]
 s_waitcnt lgkmcnt(3)
 v_mfma_f32_16x16x32_bf16 v[108:111], v[140:143], a[72:75], v[108:111]
 v_mfma_f32_16x16x32_bf16 v[116:119], v[140:143], a[152:155], v[116:119]
 v_mfma_f32_16x16x32_bf16 v[124:127], v[140:143], a[232:235], v[124:127]
 v_mfma_f32_16x16x32_bf16 v[132:135], v[140:143], v[60:63], v[132:135]
 s_waitcnt lgkmcnt(2)
 v_mfma_f32_16x16x32_bf16 v[112:115], v[144:147], a[72:75], v[112:115]
 v_mfma_f32_16x16x32_bf16 v[120:123], v[144:147], a[152:155], v[120:123]
 v_mfma_f32_16x16x32_bf16 v[128:131], v[144:147], a[232:235], v[128:131]
 v_mfma_f32_16x16x32_bf16 v[136:139], v[144:147], v[60:63], v[136:139]
 s_waitcnt lgkmcnt(1)
 v_mfma_f32_16x16x32_bf16 v[108:111], v[148:151], a[76:79], v[108:111]
 s_mov_b32 s50, s53
 v_mfma_f32_16x16x32_bf16 v[116:119], v[148:151], a[156:159], v[116:119]
 s_mov_b32 s48, s51
 v_mfma_f32_16x16x32_bf16 v[124:127], v[148:151], a[236:239], v[124:127]
 s_mov_b32 s49, s52
 v_mfma_f32_16x16x32_bf16 v[132:135], v[148:151], v[64:67], v[132:135]
 s_waitcnt lgkmcnt(0)
 v_mfma_f32_16x16x32_bf16 v[112:115], v[152:155], a[76:79], v[112:115]
 v_mfma_f32_16x16x32_bf16 v[120:123], v[152:155], a[156:159], v[120:123]
 v_mfma_f32_16x16x32_bf16 v[128:131], v[152:155], a[236:239], v[128:131]
 v_mfma_f32_16x16x32_bf16 v[136:139], v[152:155], v[64:67], v[136:139]
 s_branch Lqc_327
Lqd_343:
 s_endpgm
L_role_o:
 s_sub_u32 s12, s12, 136
 v_and_b32 v1, 63, v0
 v_lshlrev_b32 v2, 4, v1
 s_load_dwordx2 s[26:27], s[0:1], 40
 s_cmp_ge_u32 s12, 20
 s_cselect_b32 s25, 1, 0
 s_mul_i32 s19, s25, 20
 s_sub_u32 s19, s12, s19
 s_lshl_b32 s38, s25, 7
 s_add_u32 s38, s38, s19
 s_lshl_b32 s38, s38, 7
 s_add_u32 s38, s38, 155648
 s_mul_i32 s36, s19, 0x3334
 s_lshr_b32 s36, s36, 16
 s_mul_i32 s20, s36, 5
 s_sub_u32 s37, s19, s20
 s_lshl_b32 s19, s37, 8
 s_lshl_b32 s20, s3, 6
 s_add_u32 s19, s19, s20
 s_mov_b32 s42, s19
 s_lshl_b32 s41, s19, 6
 s_mul_i32 s23, s36, 1966080
 s_add_u32 s23, s23, s19
 s_mul_i32 s20, s36, 81920
 s_add_u32 s41, s41, s20
 s_add_u32 s41, s41, 213811200
 s_waitcnt lgkmcnt(0)
 s_mov_b32 s28, s26
 s_mov_b32 s29, s27
 s_mov_b32 s30, 7864320
 s_mov_b32 s31, 0x20000
 v_lshrrev_b32 v132, 2, v1
 v_mul_u32_u24 v132, 1280, v132
 v_and_b32 v3, 3, v1
 v_lshl_add_u32 v132, v3, 4, v132
 v_lshrrev_b32 v133, 4, v1
 v_lshlrev_b32 v133, 2, v133
 v_bfe_u32 v3, v1, 2, 2
 v_add_u32 v133, v133, v3
 v_mul_u32_u24 v133, 64, v133
 v_and_b32 v3, 3, v1
 v_lshl_add_u32 v133, v3, 4, v133
 s_mul_i32 s19, s3, 40960
 s_add_u32 s19, s19, 0
 v_add_u32 v133, s19, v133
 s_mul_i32 s19, s3, 40960
 s_add_u32 m0, s19, 0
 s_add_u32 s20, s23, 0
 buffer_load_dwordx4 v132, s[28:31], s20 offen lds
 s_add_u32 m0, s19, 1024
 s_add_u32 s20, s23, 20480
 buffer_load_dwordx4 v132, s[28:31], s20 offen lds
 s_add_u32 m0, s19, 2048
 s_add_u32 s20, s23, 40960
 buffer_load_dwordx4 v132, s[28:31], s20 offen lds
 s_add_u32 m0, s19, 3072
 s_add_u32 s20, s23, 61440
 buffer_load_dwordx4 v132, s[28:31], s20 offen lds
 s_add_u32 m0, s19, 4096
 s_add_u32 s20, s23, 81920
 buffer_load_dwordx4 v132, s[28:31], s20 offen lds
 s_add_u32 m0, s19, 5120
 s_add_u32 s20, s23, 102400
 buffer_load_dwordx4 v132, s[28:31], s20 offen lds
 s_add_u32 m0, s19, 6144
 s_add_u32 s20, s23, 122880
 buffer_load_dwordx4 v132, s[28:31], s20 offen lds
 s_add_u32 m0, s19, 7168
 s_add_u32 s20, s23, 143360
 buffer_load_dwordx4 v132, s[28:31], s20 offen lds
 s_add_u32 m0, s19, 8192
 s_add_u32 s20, s23, 163840
 buffer_load_dwordx4 v132, s[28:31], s20 offen lds
 s_add_u32 m0, s19, 9216
 s_add_u32 s20, s23, 184320
 buffer_load_dwordx4 v132, s[28:31], s20 offen lds
 s_add_u32 m0, s19, 10240
 s_add_u32 s20, s23, 204800
 buffer_load_dwordx4 v132, s[28:31], s20 offen lds
 s_add_u32 m0, s19, 11264
 s_add_u32 s20, s23, 225280
 buffer_load_dwordx4 v132, s[28:31], s20 offen lds
 s_add_u32 m0, s19, 12288
 s_add_u32 s20, s23, 245760
 buffer_load_dwordx4 v132, s[28:31], s20 offen lds
 s_add_u32 m0, s19, 13312
 s_add_u32 s20, s23, 266240
 buffer_load_dwordx4 v132, s[28:31], s20 offen lds
 s_add_u32 m0, s19, 14336
 s_add_u32 s20, s23, 286720
 buffer_load_dwordx4 v132, s[28:31], s20 offen lds
 s_add_u32 m0, s19, 15360
 s_add_u32 s20, s23, 307200
 buffer_load_dwordx4 v132, s[28:31], s20 offen lds
 s_add_u32 m0, s19, 16384
 s_add_u32 s20, s23, 327680
 buffer_load_dwordx4 v132, s[28:31], s20 offen lds
 s_add_u32 m0, s19, 17408
 s_add_u32 s20, s23, 348160
 buffer_load_dwordx4 v132, s[28:31], s20 offen lds
 s_add_u32 m0, s19, 18432
 s_add_u32 s20, s23, 368640
 buffer_load_dwordx4 v132, s[28:31], s20 offen lds
 s_add_u32 m0, s19, 19456
 s_add_u32 s20, s23, 389120
 buffer_load_dwordx4 v132, s[28:31], s20 offen lds
 s_mul_i32 s19, s3, 40960
 s_add_u32 m0, s19, 20480
 s_add_u32 s20, s23, 409600
 buffer_load_dwordx4 v132, s[28:31], s20 offen lds
 s_add_u32 m0, s19, 21504
 s_add_u32 s20, s23, 430080
 buffer_load_dwordx4 v132, s[28:31], s20 offen lds
 s_add_u32 m0, s19, 22528
 s_add_u32 s20, s23, 450560
 buffer_load_dwordx4 v132, s[28:31], s20 offen lds
 s_add_u32 m0, s19, 23552
 s_add_u32 s20, s23, 471040
 buffer_load_dwordx4 v132, s[28:31], s20 offen lds
 s_add_u32 m0, s19, 24576
 s_add_u32 s20, s23, 491520
 buffer_load_dwordx4 v132, s[28:31], s20 offen lds
 s_add_u32 m0, s19, 25600
 s_add_u32 s20, s23, 512000
 buffer_load_dwordx4 v132, s[28:31], s20 offen lds
 s_add_u32 m0, s19, 26624
 s_add_u32 s20, s23, 532480
 buffer_load_dwordx4 v132, s[28:31], s20 offen lds
 s_add_u32 m0, s19, 27648
 s_add_u32 s20, s23, 552960
 buffer_load_dwordx4 v132, s[28:31], s20 offen lds
 s_add_u32 m0, s19, 28672
 s_add_u32 s20, s23, 573440
 buffer_load_dwordx4 v132, s[28:31], s20 offen lds
 s_add_u32 m0, s19, 29696
 s_add_u32 s20, s23, 593920
 buffer_load_dwordx4 v132, s[28:31], s20 offen lds
 s_add_u32 m0, s19, 30720
 s_add_u32 s20, s23, 614400
 buffer_load_dwordx4 v132, s[28:31], s20 offen lds
 s_add_u32 m0, s19, 31744
 s_add_u32 s20, s23, 634880
 buffer_load_dwordx4 v132, s[28:31], s20 offen lds
 s_add_u32 m0, s19, 32768
 s_add_u32 s20, s23, 655360
 buffer_load_dwordx4 v132, s[28:31], s20 offen lds
 s_add_u32 m0, s19, 33792
 s_add_u32 s20, s23, 675840
 buffer_load_dwordx4 v132, s[28:31], s20 offen lds
 s_add_u32 m0, s19, 34816
 s_add_u32 s20, s23, 696320
 buffer_load_dwordx4 v132, s[28:31], s20 offen lds
 s_add_u32 m0, s19, 35840
 s_add_u32 s20, s23, 716800
 buffer_load_dwordx4 v132, s[28:31], s20 offen lds
 s_add_u32 m0, s19, 36864
 s_add_u32 s20, s23, 737280
 buffer_load_dwordx4 v132, s[28:31], s20 offen lds
 s_add_u32 m0, s19, 37888
 s_add_u32 s20, s23, 757760
 buffer_load_dwordx4 v132, s[28:31], s20 offen lds
 s_add_u32 m0, s19, 38912
 s_add_u32 s20, s23, 778240
 buffer_load_dwordx4 v132, s[28:31], s20 offen lds
 s_add_u32 m0, s19, 39936
 s_add_u32 s20, s23, 798720
 buffer_load_dwordx4 v132, s[28:31], s20 offen lds
 s_waitcnt vmcnt(20)
 ds_read_b64_tr_b16 a[0:1], v133 offset:0
 ds_read_b64_tr_b16 a[2:3], v133 offset:1024
 ds_read_b64_tr_b16 a[192:193], v133 offset:8
 ds_read_b64_tr_b16 a[194:195], v133 offset:1032
 ds_read_b64_tr_b16 a[4:5], v133 offset:2048
 ds_read_b64_tr_b16 a[6:7], v133 offset:3072
 ds_read_b64_tr_b16 a[196:197], v133 offset:2056
 ds_read_b64_tr_b16 a[198:199], v133 offset:3080
 ds_read_b64_tr_b16 a[8:9], v133 offset:4096
 ds_read_b64_tr_b16 a[10:11], v133 offset:5120
 ds_read_b64_tr_b16 a[200:201], v133 offset:4104
 ds_read_b64_tr_b16 a[202:203], v133 offset:5128
 ds_read_b64_tr_b16 a[12:13], v133 offset:6144
 ds_read_b64_tr_b16 a[14:15], v133 offset:7168
 ds_read_b64_tr_b16 a[204:205], v133 offset:6152
 ds_read_b64_tr_b16 a[206:207], v133 offset:7176
 ds_read_b64_tr_b16 a[16:17], v133 offset:8192
 ds_read_b64_tr_b16 a[18:19], v133 offset:9216
 ds_read_b64_tr_b16 a[208:209], v133 offset:8200
 ds_read_b64_tr_b16 a[210:211], v133 offset:9224
 ds_read_b64_tr_b16 a[20:21], v133 offset:10240
 ds_read_b64_tr_b16 a[22:23], v133 offset:11264
 ds_read_b64_tr_b16 a[212:213], v133 offset:10248
 ds_read_b64_tr_b16 a[214:215], v133 offset:11272
 ds_read_b64_tr_b16 a[24:25], v133 offset:12288
 ds_read_b64_tr_b16 a[26:27], v133 offset:13312
 ds_read_b64_tr_b16 a[216:217], v133 offset:12296
 ds_read_b64_tr_b16 a[218:219], v133 offset:13320
 ds_read_b64_tr_b16 a[28:29], v133 offset:14336
 ds_read_b64_tr_b16 a[30:31], v133 offset:15360
 ds_read_b64_tr_b16 a[220:221], v133 offset:14344
 ds_read_b64_tr_b16 a[222:223], v133 offset:15368
 ds_read_b64_tr_b16 a[32:33], v133 offset:16384
 ds_read_b64_tr_b16 a[34:35], v133 offset:17408
 ds_read_b64_tr_b16 a[224:225], v133 offset:16392
 ds_read_b64_tr_b16 a[226:227], v133 offset:17416
 ds_read_b64_tr_b16 a[36:37], v133 offset:18432
 ds_read_b64_tr_b16 a[38:39], v133 offset:19456
 ds_read_b64_tr_b16 a[228:229], v133 offset:18440
 ds_read_b64_tr_b16 a[230:231], v133 offset:19464
 s_waitcnt lgkmcnt(0)
 s_mul_i32 s19, s3, 40960
 s_add_u32 m0, s19, 0
 s_add_u32 s20, s23, 819200
 buffer_load_dwordx4 v132, s[28:31], s20 offen lds
 s_add_u32 m0, s19, 1024
 s_add_u32 s20, s23, 839680
 buffer_load_dwordx4 v132, s[28:31], s20 offen lds
 s_add_u32 m0, s19, 2048
 s_add_u32 s20, s23, 860160
 buffer_load_dwordx4 v132, s[28:31], s20 offen lds
 s_add_u32 m0, s19, 3072
 s_add_u32 s20, s23, 880640
 buffer_load_dwordx4 v132, s[28:31], s20 offen lds
 s_add_u32 m0, s19, 4096
 s_add_u32 s20, s23, 901120
 buffer_load_dwordx4 v132, s[28:31], s20 offen lds
 s_add_u32 m0, s19, 5120
 s_add_u32 s20, s23, 921600
 buffer_load_dwordx4 v132, s[28:31], s20 offen lds
 s_add_u32 m0, s19, 6144
 s_add_u32 s20, s23, 942080
 buffer_load_dwordx4 v132, s[28:31], s20 offen lds
 s_add_u32 m0, s19, 7168
 s_add_u32 s20, s23, 962560
 buffer_load_dwordx4 v132, s[28:31], s20 offen lds
 s_add_u32 m0, s19, 8192
 s_add_u32 s20, s23, 983040
 buffer_load_dwordx4 v132, s[28:31], s20 offen lds
 s_add_u32 m0, s19, 9216
 s_add_u32 s20, s23, 1003520
 buffer_load_dwordx4 v132, s[28:31], s20 offen lds
 s_add_u32 m0, s19, 10240
 s_add_u32 s20, s23, 1024000
 buffer_load_dwordx4 v132, s[28:31], s20 offen lds
 s_add_u32 m0, s19, 11264
 s_add_u32 s20, s23, 1044480
 buffer_load_dwordx4 v132, s[28:31], s20 offen lds
 s_add_u32 m0, s19, 12288
 s_add_u32 s20, s23, 1064960
 buffer_load_dwordx4 v132, s[28:31], s20 offen lds
 s_add_u32 m0, s19, 13312
 s_add_u32 s20, s23, 1085440
 buffer_load_dwordx4 v132, s[28:31], s20 offen lds
 s_add_u32 m0, s19, 14336
 s_add_u32 s20, s23, 1105920
 buffer_load_dwordx4 v132, s[28:31], s20 offen lds
 s_add_u32 m0, s19, 15360
 s_add_u32 s20, s23, 1126400
 buffer_load_dwordx4 v132, s[28:31], s20 offen lds
 s_add_u32 m0, s19, 16384
 s_add_u32 s20, s23, 1146880
 buffer_load_dwordx4 v132, s[28:31], s20 offen lds
 s_add_u32 m0, s19, 17408
 s_add_u32 s20, s23, 1167360
 buffer_load_dwordx4 v132, s[28:31], s20 offen lds
 s_add_u32 m0, s19, 18432
 s_add_u32 s20, s23, 1187840
 buffer_load_dwordx4 v132, s[28:31], s20 offen lds
 s_add_u32 m0, s19, 19456
 s_add_u32 s20, s23, 1208320
 buffer_load_dwordx4 v132, s[28:31], s20 offen lds
 s_waitcnt vmcnt(20)
 ds_read_b64_tr_b16 a[40:41], v133 offset:20480
 ds_read_b64_tr_b16 a[42:43], v133 offset:21504
 ds_read_b64_tr_b16 a[232:233], v133 offset:20488
 ds_read_b64_tr_b16 a[234:235], v133 offset:21512
 ds_read_b64_tr_b16 a[44:45], v133 offset:22528
 ds_read_b64_tr_b16 a[46:47], v133 offset:23552
 ds_read_b64_tr_b16 a[236:237], v133 offset:22536
 ds_read_b64_tr_b16 a[238:239], v133 offset:23560
 ds_read_b64_tr_b16 a[48:49], v133 offset:24576
 ds_read_b64_tr_b16 a[50:51], v133 offset:25600
 ds_read_b64_tr_b16 a[240:241], v133 offset:24584
 ds_read_b64_tr_b16 a[242:243], v133 offset:25608
 ds_read_b64_tr_b16 a[52:53], v133 offset:26624
 ds_read_b64_tr_b16 a[54:55], v133 offset:27648
 ds_read_b64_tr_b16 a[244:245], v133 offset:26632
 ds_read_b64_tr_b16 a[246:247], v133 offset:27656
 ds_read_b64_tr_b16 a[56:57], v133 offset:28672
 ds_read_b64_tr_b16 a[58:59], v133 offset:29696
 ds_read_b64_tr_b16 a[248:249], v133 offset:28680
 ds_read_b64_tr_b16 a[250:251], v133 offset:29704
 ds_read_b64_tr_b16 a[60:61], v133 offset:30720
 ds_read_b64_tr_b16 a[62:63], v133 offset:31744
 ds_read_b64_tr_b16 a[252:253], v133 offset:30728
 ds_read_b64_tr_b16 a[254:255], v133 offset:31752
 ds_read_b64_tr_b16 a[64:65], v133 offset:32768
 ds_read_b64_tr_b16 a[66:67], v133 offset:33792
 ds_read_b64_tr_b16 v[4:5], v133 offset:32776
 ds_read_b64_tr_b16 v[6:7], v133 offset:33800
 ds_read_b64_tr_b16 a[68:69], v133 offset:34816
 ds_read_b64_tr_b16 a[70:71], v133 offset:35840
 ds_read_b64_tr_b16 v[8:9], v133 offset:34824
 ds_read_b64_tr_b16 v[10:11], v133 offset:35848
 ds_read_b64_tr_b16 a[72:73], v133 offset:36864
 ds_read_b64_tr_b16 a[74:75], v133 offset:37888
 ds_read_b64_tr_b16 v[12:13], v133 offset:36872
 ds_read_b64_tr_b16 v[14:15], v133 offset:37896
 ds_read_b64_tr_b16 a[76:77], v133 offset:38912
 ds_read_b64_tr_b16 a[78:79], v133 offset:39936
 ds_read_b64_tr_b16 v[16:17], v133 offset:38920
 ds_read_b64_tr_b16 v[18:19], v133 offset:39944
 s_waitcnt lgkmcnt(0)
 s_mul_i32 s19, s3, 40960
 s_add_u32 m0, s19, 20480
 s_add_u32 s20, s23, 1228800
 buffer_load_dwordx4 v132, s[28:31], s20 offen lds
 s_add_u32 m0, s19, 21504
 s_add_u32 s20, s23, 1249280
 buffer_load_dwordx4 v132, s[28:31], s20 offen lds
 s_add_u32 m0, s19, 22528
 s_add_u32 s20, s23, 1269760
 buffer_load_dwordx4 v132, s[28:31], s20 offen lds
 s_add_u32 m0, s19, 23552
 s_add_u32 s20, s23, 1290240
 buffer_load_dwordx4 v132, s[28:31], s20 offen lds
 s_add_u32 m0, s19, 24576
 s_add_u32 s20, s23, 1310720
 buffer_load_dwordx4 v132, s[28:31], s20 offen lds
 s_add_u32 m0, s19, 25600
 s_add_u32 s20, s23, 1331200
 buffer_load_dwordx4 v132, s[28:31], s20 offen lds
 s_add_u32 m0, s19, 26624
 s_add_u32 s20, s23, 1351680
 buffer_load_dwordx4 v132, s[28:31], s20 offen lds
 s_add_u32 m0, s19, 27648
 s_add_u32 s20, s23, 1372160
 buffer_load_dwordx4 v132, s[28:31], s20 offen lds
 s_add_u32 m0, s19, 28672
 s_add_u32 s20, s23, 1392640
 buffer_load_dwordx4 v132, s[28:31], s20 offen lds
 s_add_u32 m0, s19, 29696
 s_add_u32 s20, s23, 1413120
 buffer_load_dwordx4 v132, s[28:31], s20 offen lds
 s_add_u32 m0, s19, 30720
 s_add_u32 s20, s23, 1433600
 buffer_load_dwordx4 v132, s[28:31], s20 offen lds
 s_add_u32 m0, s19, 31744
 s_add_u32 s20, s23, 1454080
 buffer_load_dwordx4 v132, s[28:31], s20 offen lds
 s_add_u32 m0, s19, 32768
 s_add_u32 s20, s23, 1474560
 buffer_load_dwordx4 v132, s[28:31], s20 offen lds
 s_add_u32 m0, s19, 33792
 s_add_u32 s20, s23, 1495040
 buffer_load_dwordx4 v132, s[28:31], s20 offen lds
 s_add_u32 m0, s19, 34816
 s_add_u32 s20, s23, 1515520
 buffer_load_dwordx4 v132, s[28:31], s20 offen lds
 s_add_u32 m0, s19, 35840
 s_add_u32 s20, s23, 1536000
 buffer_load_dwordx4 v132, s[28:31], s20 offen lds
 s_add_u32 m0, s19, 36864
 s_add_u32 s20, s23, 1556480
 buffer_load_dwordx4 v132, s[28:31], s20 offen lds
 s_add_u32 m0, s19, 37888
 s_add_u32 s20, s23, 1576960
 buffer_load_dwordx4 v132, s[28:31], s20 offen lds
 s_add_u32 m0, s19, 38912
 s_add_u32 s20, s23, 1597440
 buffer_load_dwordx4 v132, s[28:31], s20 offen lds
 s_add_u32 m0, s19, 39936
 s_add_u32 s20, s23, 1617920
 buffer_load_dwordx4 v132, s[28:31], s20 offen lds
 s_waitcnt vmcnt(20)
 ds_read_b64_tr_b16 a[80:81], v133 offset:0
 ds_read_b64_tr_b16 a[82:83], v133 offset:1024
 ds_read_b64_tr_b16 v[20:21], v133 offset:8
 ds_read_b64_tr_b16 v[22:23], v133 offset:1032
 ds_read_b64_tr_b16 a[84:85], v133 offset:2048
 ds_read_b64_tr_b16 a[86:87], v133 offset:3072
 ds_read_b64_tr_b16 v[24:25], v133 offset:2056
 ds_read_b64_tr_b16 v[26:27], v133 offset:3080
 ds_read_b64_tr_b16 a[88:89], v133 offset:4096
 ds_read_b64_tr_b16 a[90:91], v133 offset:5120
 ds_read_b64_tr_b16 v[28:29], v133 offset:4104
 ds_read_b64_tr_b16 v[30:31], v133 offset:5128
 ds_read_b64_tr_b16 a[92:93], v133 offset:6144
 ds_read_b64_tr_b16 a[94:95], v133 offset:7168
 ds_read_b64_tr_b16 v[32:33], v133 offset:6152
 ds_read_b64_tr_b16 v[34:35], v133 offset:7176
 ds_read_b64_tr_b16 a[96:97], v133 offset:8192
 ds_read_b64_tr_b16 a[98:99], v133 offset:9216
 ds_read_b64_tr_b16 v[36:37], v133 offset:8200
 ds_read_b64_tr_b16 v[38:39], v133 offset:9224
 ds_read_b64_tr_b16 a[100:101], v133 offset:10240
 ds_read_b64_tr_b16 a[102:103], v133 offset:11264
 ds_read_b64_tr_b16 v[40:41], v133 offset:10248
 ds_read_b64_tr_b16 v[42:43], v133 offset:11272
 ds_read_b64_tr_b16 a[104:105], v133 offset:12288
 ds_read_b64_tr_b16 a[106:107], v133 offset:13312
 ds_read_b64_tr_b16 v[44:45], v133 offset:12296
 ds_read_b64_tr_b16 v[46:47], v133 offset:13320
 ds_read_b64_tr_b16 a[108:109], v133 offset:14336
 ds_read_b64_tr_b16 a[110:111], v133 offset:15360
 ds_read_b64_tr_b16 v[48:49], v133 offset:14344
 ds_read_b64_tr_b16 v[50:51], v133 offset:15368
 ds_read_b64_tr_b16 a[112:113], v133 offset:16384
 ds_read_b64_tr_b16 a[114:115], v133 offset:17408
 ds_read_b64_tr_b16 v[52:53], v133 offset:16392
 ds_read_b64_tr_b16 v[54:55], v133 offset:17416
 ds_read_b64_tr_b16 a[116:117], v133 offset:18432
 ds_read_b64_tr_b16 a[118:119], v133 offset:19456
 ds_read_b64_tr_b16 v[56:57], v133 offset:18440
 ds_read_b64_tr_b16 v[58:59], v133 offset:19464
 s_waitcnt lgkmcnt(0)
 s_mul_i32 s19, s3, 40960
 s_add_u32 m0, s19, 0
 s_add_u32 s20, s23, 1638400
 buffer_load_dwordx4 v132, s[28:31], s20 offen lds
 s_add_u32 m0, s19, 1024
 s_add_u32 s20, s23, 1658880
 buffer_load_dwordx4 v132, s[28:31], s20 offen lds
 s_add_u32 m0, s19, 2048
 s_add_u32 s20, s23, 1679360
 buffer_load_dwordx4 v132, s[28:31], s20 offen lds
 s_add_u32 m0, s19, 3072
 s_add_u32 s20, s23, 1699840
 buffer_load_dwordx4 v132, s[28:31], s20 offen lds
 s_add_u32 m0, s19, 4096
 s_add_u32 s20, s23, 1720320
 buffer_load_dwordx4 v132, s[28:31], s20 offen lds
 s_add_u32 m0, s19, 5120
 s_add_u32 s20, s23, 1740800
 buffer_load_dwordx4 v132, s[28:31], s20 offen lds
 s_add_u32 m0, s19, 6144
 s_add_u32 s20, s23, 1761280
 buffer_load_dwordx4 v132, s[28:31], s20 offen lds
 s_add_u32 m0, s19, 7168
 s_add_u32 s20, s23, 1781760
 buffer_load_dwordx4 v132, s[28:31], s20 offen lds
 s_add_u32 m0, s19, 8192
 s_add_u32 s20, s23, 1802240
 buffer_load_dwordx4 v132, s[28:31], s20 offen lds
 s_add_u32 m0, s19, 9216
 s_add_u32 s20, s23, 1822720
 buffer_load_dwordx4 v132, s[28:31], s20 offen lds
 s_add_u32 m0, s19, 10240
 s_add_u32 s20, s23, 1843200
 buffer_load_dwordx4 v132, s[28:31], s20 offen lds
 s_add_u32 m0, s19, 11264
 s_add_u32 s20, s23, 1863680
 buffer_load_dwordx4 v132, s[28:31], s20 offen lds
 s_add_u32 m0, s19, 12288
 s_add_u32 s20, s23, 1884160
 buffer_load_dwordx4 v132, s[28:31], s20 offen lds
 s_add_u32 m0, s19, 13312
 s_add_u32 s20, s23, 1904640
 buffer_load_dwordx4 v132, s[28:31], s20 offen lds
 s_add_u32 m0, s19, 14336
 s_add_u32 s20, s23, 1925120
 buffer_load_dwordx4 v132, s[28:31], s20 offen lds
 s_add_u32 m0, s19, 15360
 s_add_u32 s20, s23, 1945600
 buffer_load_dwordx4 v132, s[28:31], s20 offen lds
 s_waitcnt vmcnt(16)
 ds_read_b64_tr_b16 a[120:121], v133 offset:20480
 ds_read_b64_tr_b16 a[122:123], v133 offset:21504
 ds_read_b64_tr_b16 v[60:61], v133 offset:20488
 ds_read_b64_tr_b16 v[62:63], v133 offset:21512
 ds_read_b64_tr_b16 a[124:125], v133 offset:22528
 ds_read_b64_tr_b16 a[126:127], v133 offset:23552
 ds_read_b64_tr_b16 v[64:65], v133 offset:22536
 ds_read_b64_tr_b16 v[66:67], v133 offset:23560
 ds_read_b64_tr_b16 a[128:129], v133 offset:24576
 ds_read_b64_tr_b16 a[130:131], v133 offset:25600
 ds_read_b64_tr_b16 v[68:69], v133 offset:24584
 ds_read_b64_tr_b16 v[70:71], v133 offset:25608
 ds_read_b64_tr_b16 a[132:133], v133 offset:26624
 ds_read_b64_tr_b16 a[134:135], v133 offset:27648
 ds_read_b64_tr_b16 v[72:73], v133 offset:26632
 ds_read_b64_tr_b16 v[74:75], v133 offset:27656
 ds_read_b64_tr_b16 a[136:137], v133 offset:28672
 ds_read_b64_tr_b16 a[138:139], v133 offset:29696
 ds_read_b64_tr_b16 v[76:77], v133 offset:28680
 ds_read_b64_tr_b16 v[78:79], v133 offset:29704
 ds_read_b64_tr_b16 a[140:141], v133 offset:30720
 ds_read_b64_tr_b16 a[142:143], v133 offset:31744
 ds_read_b64_tr_b16 v[80:81], v133 offset:30728
 ds_read_b64_tr_b16 v[82:83], v133 offset:31752
 ds_read_b64_tr_b16 a[144:145], v133 offset:32768
 ds_read_b64_tr_b16 a[146:147], v133 offset:33792
 ds_read_b64_tr_b16 v[84:85], v133 offset:32776
 ds_read_b64_tr_b16 v[86:87], v133 offset:33800
 ds_read_b64_tr_b16 a[148:149], v133 offset:34816
 ds_read_b64_tr_b16 a[150:151], v133 offset:35840
 ds_read_b64_tr_b16 v[88:89], v133 offset:34824
 ds_read_b64_tr_b16 v[90:91], v133 offset:35848
 ds_read_b64_tr_b16 a[152:153], v133 offset:36864
 ds_read_b64_tr_b16 a[154:155], v133 offset:37888
 ds_read_b64_tr_b16 v[92:93], v133 offset:36872
 ds_read_b64_tr_b16 v[94:95], v133 offset:37896
 ds_read_b64_tr_b16 a[156:157], v133 offset:38912
 ds_read_b64_tr_b16 a[158:159], v133 offset:39936
 ds_read_b64_tr_b16 v[96:97], v133 offset:38920
 ds_read_b64_tr_b16 v[98:99], v133 offset:39944
 s_waitcnt lgkmcnt(0)
 s_waitcnt vmcnt(0)
 ds_read_b64_tr_b16 a[160:161], v133 offset:0
 ds_read_b64_tr_b16 a[162:163], v133 offset:1024
 ds_read_b64_tr_b16 v[100:101], v133 offset:8
 ds_read_b64_tr_b16 v[102:103], v133 offset:1032
 ds_read_b64_tr_b16 a[164:165], v133 offset:2048
 ds_read_b64_tr_b16 a[166:167], v133 offset:3072
 ds_read_b64_tr_b16 v[104:105], v133 offset:2056
 ds_read_b64_tr_b16 v[106:107], v133 offset:3080
 ds_read_b64_tr_b16 a[168:169], v133 offset:4096
 ds_read_b64_tr_b16 a[170:171], v133 offset:5120
 ds_read_b64_tr_b16 v[108:109], v133 offset:4104
 ds_read_b64_tr_b16 v[110:111], v133 offset:5128
 ds_read_b64_tr_b16 a[172:173], v133 offset:6144
 ds_read_b64_tr_b16 a[174:175], v133 offset:7168
 ds_read_b64_tr_b16 v[112:113], v133 offset:6152
 ds_read_b64_tr_b16 v[114:115], v133 offset:7176
 ds_read_b64_tr_b16 a[176:177], v133 offset:8192
 ds_read_b64_tr_b16 a[178:179], v133 offset:9216
 ds_read_b64_tr_b16 v[116:117], v133 offset:8200
 ds_read_b64_tr_b16 v[118:119], v133 offset:9224
 ds_read_b64_tr_b16 a[180:181], v133 offset:10240
 ds_read_b64_tr_b16 a[182:183], v133 offset:11264
 ds_read_b64_tr_b16 v[120:121], v133 offset:10248
 ds_read_b64_tr_b16 v[122:123], v133 offset:11272
 ds_read_b64_tr_b16 a[184:185], v133 offset:12288
 ds_read_b64_tr_b16 a[186:187], v133 offset:13312
 ds_read_b64_tr_b16 v[124:125], v133 offset:12296
 ds_read_b64_tr_b16 v[126:127], v133 offset:13320
 ds_read_b64_tr_b16 a[188:189], v133 offset:14336
 ds_read_b64_tr_b16 a[190:191], v133 offset:15360
 ds_read_b64_tr_b16 v[128:129], v133 offset:14344
 ds_read_b64_tr_b16 v[130:131], v133 offset:15368
 s_waitcnt lgkmcnt(0)
 s_barrier
 s_cmp_eq_u32 s13, 1
 s_cbranch_scc1 Lverok_350
 s_mov_b32 s18, 0
Lver_349:
 s_add_u32 s18, s18, 1
 s_cmp_gt_u32 s18, 200000
 s_cbranch_scc1 L_fail
 v_and_b32 v254, 7, v0
 v_lshlrev_b32 v254, 2, v254
 buffer_load_dword v255, v254, s[8:11], 0 offen sc1
 s_waitcnt vmcnt(0)
 v_cmp_eq_u32 vcc, 32, v255
 s_nop 0
 s_cmp_eq_u64 vcc, -1
 s_cbranch_scc1 Lverok_350
 s_mov_b32 s17, 0
 v_readlane_b32 s14, v255, 0
 s_nop 0
 s_add_u32 s17, s17, s14
 v_readlane_b32 s14, v255, 1
 s_nop 0
 s_add_u32 s17, s17, s14
 v_readlane_b32 s14, v255, 2
 s_nop 0
 s_add_u32 s17, s17, s14
 v_readlane_b32 s14, v255, 3
 s_nop 0
 s_add_u32 s17, s17, s14
 v_readlane_b32 s14, v255, 4
 s_nop 0
 s_add_u32 s17, s17, s14
 v_readlane_b32 s14, v255, 5
 s_nop 0
 s_add_u32 s17, s17, s14
 v_readlane_b32 s14, v255, 6
 s_nop 0
 s_add_u32 s17, s17, s14
 v_readlane_b32 s14, v255, 7
 s_nop 0
 s_add_u32 s17, s17, s14
 s_cmp_eq_u32 s17, 256
 s_cbranch_scc1 L_fallback
 s_branch Lver_349
Lverok_350:
 v_and_b32 v132, 3, v1
 s_lshl_b32 s19, s36, 2
 v_add_u32 v132, s19, v132
 v_lshlrev_b32 v132, 7, v132
 s_lshl_b32 s19, s25, 13
 s_add_u32 s19, s19, 139264
 v_add_u32 v132, s19, v132
 v_and_b32 v133, 15, v1
 v_lshrrev_b32 v136, 4, v1
 v_mul_u32_u24 v135, 1280, v133
 v_lshl_add_u32 v135, v136, 4, v135
 v_add_u32 v135, s42, v135
 v_lshlrev_b32 v133, 6, v133
 v_lshl_add_u32 v133, v136, 4, v133
 v_add_u32 v134, 49152, v2
 s_lshl_b32 s40, s3, 10
 v_lshlrev_b32 v136, 1, v135
 v_mov_b32 v137, 163776
 v_mov_b32 v194, 0
 ds_write_b32 v137, v194
 s_waitcnt lgkmcnt(0)
 s_barrier
 s_mov_b32 s44, 0
 s_mov_b32 s45, 1
 s_mul_i32 s39, s44, 393216
 s_mul_i32 s19, s36, 98304
 s_add_u32 s39, s39, s19
 s_add_u32 s39, s39, 159809536
 s_add_u32 s39, s39, s40
 s_mov_b32 s24, 0
 s_branch Los_357
Loc_351:
 s_mov_b32 s24, 0
 s_waitcnt vmcnt(0)
 s_mov_b64 exec, 1
 v_mov_b32 v194, 1
 ds_add_rtn_u32 v194, v137, v194
 s_waitcnt lgkmcnt(0)
 v_readfirstlane_b32 s48, v194
 s_nop 0
 s_and_b32 s48, s48, 3
 s_cmp_eq_u32 s48, 3
 s_cbranch_scc0 Lar_359
 v_mov_b32 v194, s47
 buffer_store_dword v194, off, s[4:7], s38 sc1
Lar_359:
 s_mov_b64 exec, -1
 s_cmp_ge_u32 s44, 64
 s_cbranch_scc1 Lod_356
Los_357:
 s_add_u32 s24, s24, 1
 s_cmp_gt_u32 s24, 200000
 s_cbranch_scc1 L_fail
 buffer_load_dword v3, v132, s[4:7], 0 offen sc1
 s_waitcnt vmcnt(0)
 v_cmp_le_u32 vcc, s45, v3
 s_nop 0
 s_cmp_eq_u64 vcc, -1
 s_cbranch_scc0 Los_357
Log_358:
 s_add_u32 m0, s40, 0
 s_add_u32 s19, s39, 0
 buffer_load_dwordx4 v2, s[4:7], s19 offen sc1 lds
 s_add_u32 m0, s40, 4096
 s_add_u32 s19, s39, 4096
 buffer_load_dwordx4 v2, s[4:7], s19 offen sc1 lds
 s_add_u32 m0, s40, 8192
 s_add_u32 s19, s39, 8192
 buffer_load_dwordx4 v2, s[4:7], s19 offen sc1 lds
 s_add_u32 m0, s40, 12288
 s_add_u32 s19, s39, 12288
 buffer_load_dwordx4 v2, s[4:7], s19 offen sc1 lds
 s_add_u32 m0, s40, 16384
 s_add_u32 s19, s39, 16384
 buffer_load_dwordx4 v2, s[4:7], s19 offen sc1 lds
 s_add_u32 m0, s40, 20480
 s_add_u32 s19, s39, 20480
 buffer_load_dwordx4 v2, s[4:7], s19 offen sc1 lds
 s_add_u32 m0, s40, 24576
 s_add_u32 s19, s39, 24576
 buffer_load_dwordx4 v2, s[4:7], s19 offen sc1 lds
 s_add_u32 m0, s40, 28672
 s_add_u32 s19, s39, 28672
 buffer_load_dwordx4 v2, s[4:7], s19 offen sc1 lds
 s_add_u32 m0, s40, 32768
 s_add_u32 s19, s39, 32768
 buffer_load_dwordx4 v2, s[4:7], s19 offen sc1 lds
 s_mov_b32 s46, 0
 s_waitcnt vmcnt(8)
 s_barrier
 ds_read_b128 v[154:157], v2 offset:0
 ds_read_b128 v[158:161], v2 offset:1024
 ds_read_b128 v[162:165], v2 offset:2048
 ds_read_b128 v[166:169], v2 offset:3072
 s_waitcnt vmcnt(6)
 s_barrier
 ds_read_b128 v[170:173], v2 offset:4096
 ds_read_b128 v[174:177], v2 offset:5120
 s_waitcnt lgkmcnt(5)
 v_mfma_f32_16x16x32_bf16 v[138:141], a[0:3], v[154:157], 0
 s_add_u32 m0, s40, 36864
 s_add_u32 s19, s39, 36864
 buffer_load_dwordx4 v2, s[4:7], s19 offen sc1 lds
 v_mfma_f32_16x16x32_bf16 v[146:149], a[192:195], v[154:157], 0
 s_waitcnt lgkmcnt(4)
 v_mfma_f32_16x16x32_bf16 v[142:145], a[0:3], v[158:161], 0
 v_mfma_f32_16x16x32_bf16 v[150:153], a[192:195], v[158:161], 0
 ds_read_b128 v[154:157], v2 offset:6144
 ds_read_b128 v[158:161], v2 offset:7168
 s_waitcnt lgkmcnt(4)
 v_mfma_f32_16x16x32_bf16 v[138:141], a[4:7], v[162:165], v[138:141]
 s_add_u32 m0, s40, 40960
 s_add_u32 s19, s39, 40960
 buffer_load_dwordx4 v2, s[4:7], s19 offen sc1 lds
 v_mfma_f32_16x16x32_bf16 v[146:149], a[196:199], v[162:165], v[146:149]
 v_mfma_f32_16x16x32_bf16 v[142:145], a[4:7], v[166:169], v[142:145]
 v_mfma_f32_16x16x32_bf16 v[150:153], a[196:199], v[166:169], v[150:153]
 ds_read_b128 v[162:165], v2 offset:8192
 ds_read_b128 v[166:169], v2 offset:9216
 s_waitcnt lgkmcnt(4)
 v_mfma_f32_16x16x32_bf16 v[138:141], a[8:11], v[170:173], v[138:141]
 s_add_u32 m0, s40, 45056
 s_add_u32 s19, s39, 45056
 buffer_load_dwordx4 v2, s[4:7], s19 offen sc1 lds
 v_mfma_f32_16x16x32_bf16 v[146:149], a[200:203], v[170:173], v[146:149]
 v_mfma_f32_16x16x32_bf16 v[142:145], a[8:11], v[174:177], v[142:145]
 v_mfma_f32_16x16x32_bf16 v[150:153], a[200:203], v[174:177], v[150:153]
 ds_read_b128 v[170:173], v2 offset:10240
 ds_read_b128 v[174:177], v2 offset:11264
 s_waitcnt lgkmcnt(4)
 v_mfma_f32_16x16x32_bf16 v[138:141], a[12:15], v[154:157], v[138:141]
 s_add_u32 m0, s40, 49152
 s_add_u32 s19, s39, 49152
 buffer_load_dwordx4 v2, s[4:7], s19 offen sc1 lds
 v_mfma_f32_16x16x32_bf16 v[146:149], a[204:207], v[154:157], v[146:149]
 v_mfma_f32_16x16x32_bf16 v[142:145], a[12:15], v[158:161], v[142:145]
 v_mfma_f32_16x16x32_bf16 v[150:153], a[204:207], v[158:161], v[150:153]
 s_waitcnt vmcnt(8)
 s_barrier
 ds_read_b128 v[154:157], v2 offset:12288
 ds_read_b128 v[158:161], v2 offset:13312
 s_waitcnt lgkmcnt(4)
 v_mfma_f32_16x16x32_bf16 v[138:141], a[16:19], v[162:165], v[138:141]
 s_add_u32 m0, s40, 53248
 s_add_u32 s19, s39, 53248
 buffer_load_dwordx4 v2, s[4:7], s19 offen sc1 lds
 v_mfma_f32_16x16x32_bf16 v[146:149], a[208:211], v[162:165], v[146:149]
 v_mfma_f32_16x16x32_bf16 v[142:145], a[16:19], v[166:169], v[142:145]
 v_mfma_f32_16x16x32_bf16 v[150:153], a[208:211], v[166:169], v[150:153]
 ds_read_b128 v[162:165], v2 offset:14336
 ds_read_b128 v[166:169], v2 offset:15360
 s_waitcnt lgkmcnt(4)
 v_mfma_f32_16x16x32_bf16 v[138:141], a[20:23], v[170:173], v[138:141]
 s_add_u32 m0, s40, 57344
 s_add_u32 s19, s39, 57344
 buffer_load_dwordx4 v2, s[4:7], s19 offen sc1 lds
 v_mfma_f32_16x16x32_bf16 v[146:149], a[212:215], v[170:173], v[146:149]
 v_mfma_f32_16x16x32_bf16 v[142:145], a[20:23], v[174:177], v[142:145]
 v_mfma_f32_16x16x32_bf16 v[150:153], a[212:215], v[174:177], v[150:153]
 ds_read_b128 v[170:173], v2 offset:16384
 ds_read_b128 v[174:177], v2 offset:17408
 s_waitcnt lgkmcnt(4)
 v_mfma_f32_16x16x32_bf16 v[138:141], a[24:27], v[154:157], v[138:141]
 s_add_u32 m0, s40, 61440
 s_add_u32 s19, s39, 61440
 buffer_load_dwordx4 v2, s[4:7], s19 offen sc1 lds
 v_mfma_f32_16x16x32_bf16 v[146:149], a[216:219], v[154:157], v[146:149]
 v_mfma_f32_16x16x32_bf16 v[142:145], a[24:27], v[158:161], v[142:145]
 v_mfma_f32_16x16x32_bf16 v[150:153], a[216:219], v[158:161], v[150:153]
 ds_read_b128 v[154:157], v2 offset:18432
 ds_read_b128 v[158:161], v2 offset:19456
 s_waitcnt lgkmcnt(4)
 v_mfma_f32_16x16x32_bf16 v[138:141], a[28:31], v[162:165], v[138:141]
 s_add_u32 m0, s40, 65536
 s_add_u32 s19, s39, 65536
 buffer_load_dwordx4 v2, s[4:7], s19 offen sc1 lds
 v_mfma_f32_16x16x32_bf16 v[146:149], a[220:223], v[162:165], v[146:149]
 v_mfma_f32_16x16x32_bf16 v[142:145], a[28:31], v[166:169], v[142:145]
 v_mfma_f32_16x16x32_bf16 v[150:153], a[220:223], v[166:169], v[150:153]
 s_waitcnt vmcnt(10)
 s_barrier
 ds_read_b128 v[162:165], v2 offset:20480
 ds_read_b128 v[166:169], v2 offset:21504
 s_waitcnt lgkmcnt(4)
 v_mfma_f32_16x16x32_bf16 v[138:141], a[32:35], v[170:173], v[138:141]
 s_add_u32 m0, s40, 69632
 s_add_u32 s19, s39, 69632
 buffer_load_dwordx4 v2, s[4:7], s19 offen sc1 lds
 v_mfma_f32_16x16x32_bf16 v[146:149], a[224:227], v[170:173], v[146:149]
 v_mfma_f32_16x16x32_bf16 v[142:145], a[32:35], v[174:177], v[142:145]
 v_mfma_f32_16x16x32_bf16 v[150:153], a[224:227], v[174:177], v[150:153]
 ds_read_b128 v[170:173], v2 offset:22528
 ds_read_b128 v[174:177], v2 offset:23552
 s_waitcnt lgkmcnt(4)
 v_mfma_f32_16x16x32_bf16 v[138:141], a[36:39], v[154:157], v[138:141]
 s_add_u32 m0, s40, 73728
 s_add_u32 s19, s39, 73728
 buffer_load_dwordx4 v2, s[4:7], s19 offen sc1 lds
 v_mfma_f32_16x16x32_bf16 v[146:149], a[228:231], v[154:157], v[146:149]
 v_mfma_f32_16x16x32_bf16 v[142:145], a[36:39], v[158:161], v[142:145]
 v_mfma_f32_16x16x32_bf16 v[150:153], a[228:231], v[158:161], v[150:153]
 ds_read_b128 v[154:157], v2 offset:24576
 ds_read_b128 v[158:161], v2 offset:25600
 s_waitcnt lgkmcnt(4)
 v_mfma_f32_16x16x32_bf16 v[138:141], a[40:43], v[162:165], v[138:141]
 s_add_u32 m0, s40, 77824
 s_add_u32 s19, s39, 77824
 buffer_load_dwordx4 v2, s[4:7], s19 offen sc1 lds
 v_mfma_f32_16x16x32_bf16 v[146:149], a[232:235], v[162:165], v[146:149]
 v_mfma_f32_16x16x32_bf16 v[142:145], a[40:43], v[166:169], v[142:145]
 v_mfma_f32_16x16x32_bf16 v[150:153], a[232:235], v[166:169], v[150:153]
 ds_read_b128 v[162:165], v2 offset:26624
 ds_read_b128 v[166:169], v2 offset:27648
 s_waitcnt lgkmcnt(4)
 v_mfma_f32_16x16x32_bf16 v[138:141], a[44:47], v[170:173], v[138:141]
 s_add_u32 m0, s40, 81920
 s_add_u32 s19, s39, 81920
 buffer_load_dwordx4 v2, s[4:7], s19 offen sc1 lds
 v_mfma_f32_16x16x32_bf16 v[146:149], a[236:239], v[170:173], v[146:149]
 v_mfma_f32_16x16x32_bf16 v[142:145], a[44:47], v[174:177], v[142:145]
 v_mfma_f32_16x16x32_bf16 v[150:153], a[236:239], v[174:177], v[150:153]
 s_branch Lom_354
Low_352:
 s_mov_b32 s46, 1
 s_waitcnt vmcnt(12)
 s_barrier
 ds_read_b128 v[154:157], v2 offset:0
 ds_read_b128 v[158:161], v2 offset:1024
 ds_read_b128 v[162:165], v2 offset:2048
 ds_read_b128 v[166:169], v2 offset:3072
 s_waitcnt vmcnt(10)
 s_barrier
 ds_read_b128 v[170:173], v2 offset:4096
 ds_read_b128 v[174:177], v2 offset:5120
 s_waitcnt lgkmcnt(5)
 v_mfma_f32_16x16x32_bf16 v[138:141], a[0:3], v[154:157], 0
 s_add_u32 m0, s40, 36864
 s_add_u32 s19, s39, 36864
 buffer_load_dwordx4 v2, s[4:7], s19 offen sc1 lds
 v_mfma_f32_16x16x32_bf16 v[146:149], a[192:195], v[154:157], 0
 s_waitcnt lgkmcnt(4)
 v_mfma_f32_16x16x32_bf16 v[142:145], a[0:3], v[158:161], 0
 v_mfma_f32_16x16x32_bf16 v[150:153], a[192:195], v[158:161], 0
 ds_read_b128 v[154:157], v2 offset:6144
 ds_read_b128 v[158:161], v2 offset:7168
 s_waitcnt lgkmcnt(4)
 v_mfma_f32_16x16x32_bf16 v[138:141], a[4:7], v[162:165], v[138:141]
 s_add_u32 m0, s40, 40960
 s_add_u32 s19, s39, 40960
 buffer_load_dwordx4 v2, s[4:7], s19 offen sc1 lds
 v_mfma_f32_16x16x32_bf16 v[146:149], a[196:199], v[162:165], v[146:149]
 v_mfma_f32_16x16x32_bf16 v[142:145], a[4:7], v[166:169], v[142:145]
 v_mfma_f32_16x16x32_bf16 v[150:153], a[196:199], v[166:169], v[150:153]
 ds_read_b128 v[162:165], v2 offset:8192
 ds_read_b128 v[166:169], v2 offset:9216
 s_waitcnt lgkmcnt(4)
 v_mfma_f32_16x16x32_bf16 v[138:141], a[8:11], v[170:173], v[138:141]
 s_add_u32 m0, s40, 45056
 s_add_u32 s19, s39, 45056
 buffer_load_dwordx4 v2, s[4:7], s19 offen sc1 lds
 v_mfma_f32_16x16x32_bf16 v[146:149], a[200:203], v[170:173], v[146:149]
 v_mfma_f32_16x16x32_bf16 v[142:145], a[8:11], v[174:177], v[142:145]
 v_mfma_f32_16x16x32_bf16 v[150:153], a[200:203], v[174:177], v[150:153]
 ds_read_b128 v[170:173], v2 offset:10240
 ds_read_b128 v[174:177], v2 offset:11264
 s_waitcnt lgkmcnt(4)
 v_mfma_f32_16x16x32_bf16 v[138:141], a[12:15], v[154:157], v[138:141]
 s_add_u32 m0, s40, 49152
 s_add_u32 s19, s39, 49152
 buffer_load_dwordx4 v2, s[4:7], s19 offen sc1 lds
 v_mfma_f32_16x16x32_bf16 v[146:149], a[204:207], v[154:157], v[146:149]
 v_mfma_f32_16x16x32_bf16 v[142:145], a[12:15], v[158:161], v[142:145]
 v_mfma_f32_16x16x32_bf16 v[150:153], a[204:207], v[158:161], v[150:153]
 s_waitcnt vmcnt(12)
 s_barrier
 ds_read_b128 v[154:157], v2 offset:12288
 ds_read_b128 v[158:161], v2 offset:13312
 s_waitcnt lgkmcnt(4)
 v_mfma_f32_16x16x32_bf16 v[138:141], a[16:19], v[162:165], v[138:141]
 s_add_u32 m0, s40, 53248
 s_add_u32 s19, s39, 53248
 buffer_load_dwordx4 v2, s[4:7], s19 offen sc1 lds
 v_mfma_f32_16x16x32_bf16 v[146:149], a[208:211], v[162:165], v[146:149]
 v_mfma_f32_16x16x32_bf16 v[142:145], a[16:19], v[166:169], v[142:145]
 v_mfma_f32_16x16x32_bf16 v[150:153], a[208:211], v[166:169], v[150:153]
 ds_read_b128 v[162:165], v2 offset:14336
 ds_read_b128 v[166:169], v2 offset:15360
 s_waitcnt lgkmcnt(4)
 v_mfma_f32_16x16x32_bf16 v[138:141], a[20:23], v[170:173], v[138:141]
 s_add_u32 m0, s40, 57344
 s_add_u32 s19, s39, 57344
 buffer_load_dwordx4 v2, s[4:7], s19 offen sc1 lds
 v_mfma_f32_16x16x32_bf16 v[146:149], a[212:215], v[170:173], v[146:149]
 v_mfma_f32_16x16x32_bf16 v[142:145], a[20:23], v[174:177], v[142:145]
 v_mfma_f32_16x16x32_bf16 v[150:153], a[212:215], v[174:177], v[150:153]
 ds_read_b128 v[170:173], v2 offset:16384
 ds_read_b128 v[174:177], v2 offset:17408
 s_waitcnt lgkmcnt(4)
 v_mfma_f32_16x16x32_bf16 v[138:141], a[24:27], v[154:157], v[138:141]
 s_add_u32 m0, s40, 61440
 s_add_u32 s19, s39, 61440
 buffer_load_dwordx4 v2, s[4:7], s19 offen sc1 lds
 v_mfma_f32_16x16x32_bf16 v[146:149], a[216:219], v[154:157], v[146:149]
 v_mfma_f32_16x16x32_bf16 v[142:145], a[24:27], v[158:161], v[142:145]
 v_mfma_f32_16x16x32_bf16 v[150:153], a[216:219], v[158:161], v[150:153]
 ds_read_b128 v[154:157], v2 offset:18432
 ds_read_b128 v[158:161], v2 offset:19456
 s_waitcnt lgkmcnt(4)
 v_mfma_f32_16x16x32_bf16 v[138:141], a[28:31], v[162:165], v[138:141]
 s_add_u32 m0, s40, 65536
 s_add_u32 s19, s39, 65536
 buffer_load_dwordx4 v2, s[4:7], s19 offen sc1 lds
 v_mfma_f32_16x16x32_bf16 v[146:149], a[220:223], v[162:165], v[146:149]
 v_mfma_f32_16x16x32_bf16 v[142:145], a[28:31], v[166:169], v[142:145]
 v_mfma_f32_16x16x32_bf16 v[150:153], a[220:223], v[166:169], v[150:153]
 s_waitcnt vmcnt(14)
 s_barrier
 ds_read_b128 v[162:165], v2 offset:20480
 ds_read_b128 v[166:169], v2 offset:21504
 s_waitcnt lgkmcnt(4)
 v_mfma_f32_16x16x32_bf16 v[138:141], a[32:35], v[170:173], v[138:141]
 s_add_u32 m0, s40, 69632
 s_add_u32 s19, s39, 69632
 buffer_load_dwordx4 v2, s[4:7], s19 offen sc1 lds
 v_mfma_f32_16x16x32_bf16 v[146:149], a[224:227], v[170:173], v[146:149]
 v_mfma_f32_16x16x32_bf16 v[142:145], a[32:35], v[174:177], v[142:145]
 v_mfma_f32_16x16x32_bf16 v[150:153], a[224:227], v[174:177], v[150:153]
 ds_read_b128 v[170:173], v2 offset:22528
 ds_read_b128 v[174:177], v2 offset:23552
 s_waitcnt lgkmcnt(4)
 v_mfma_f32_16x16x32_bf16 v[138:141], a[36:39], v[154:157], v[138:141]
 s_add_u32 m0, s40, 73728
 s_add_u32 s19, s39, 73728
 buffer_load_dwordx4 v2, s[4:7], s19 offen sc1 lds
 v_mfma_f32_16x16x32_bf16 v[146:149], a[228:231], v[154:157], v[146:149]
 v_mfma_f32_16x16x32_bf16 v[142:145], a[36:39], v[158:161], v[142:145]
 v_mfma_f32_16x16x32_bf16 v[150:153], a[228:231], v[158:161], v[150:153]
 ds_read_b128 v[154:157], v2 offset:24576
 ds_read_b128 v[158:161], v2 offset:25600
 s_waitcnt lgkmcnt(4)
 v_mfma_f32_16x16x32_bf16 v[138:141], a[40:43], v[162:165], v[138:141]
 s_add_u32 m0, s40, 77824
 s_add_u32 s19, s39, 77824
 buffer_load_dwordx4 v2, s[4:7], s19 offen sc1 lds
 v_mfma_f32_16x16x32_bf16 v[146:149], a[232:235], v[162:165], v[146:149]
 v_mfma_f32_16x16x32_bf16 v[142:145], a[40:43], v[166:169], v[142:145]
 v_mfma_f32_16x16x32_bf16 v[150:153], a[232:235], v[166:169], v[150:153]
 ds_read_b128 v[162:165], v2 offset:26624
 ds_read_b128 v[166:169], v2 offset:27648
 s_waitcnt lgkmcnt(4)
 v_mfma_f32_16x16x32_bf16 v[138:141], a[44:47], v[170:173], v[138:141]
 s_add_u32 m0, s40, 81920
 s_add_u32 s19, s39, 81920
 buffer_load_dwordx4 v2, s[4:7], s19 offen sc1 lds
 v_mfma_f32_16x16x32_bf16 v[146:149], a[236:239], v[170:173], v[146:149]
 v_mfma_f32_16x16x32_bf16 v[142:145], a[44:47], v[174:177], v[142:145]
 v_mfma_f32_16x16x32_bf16 v[150:153], a[236:239], v[174:177], v[150:153]
Lom_354:
 s_waitcnt vmcnt(11)
 s_barrier
 ds_read_b128 v[170:173], v2 offset:28672
 ds_read_b128 v[174:177], v2 offset:29696
 s_waitcnt lgkmcnt(4)
 v_mfma_f32_16x16x32_bf16 v[138:141], a[48:51], v[154:157], v[138:141]
 s_add_u32 m0, s40, 86016
 s_add_u32 s19, s39, 86016
 buffer_load_dwordx4 v2, s[4:7], s19 offen sc1 lds
 v_mfma_f32_16x16x32_bf16 v[146:149], a[240:243], v[154:157], v[146:149]
 v_mfma_f32_16x16x32_bf16 v[142:145], a[48:51], v[158:161], v[142:145]
 v_mfma_f32_16x16x32_bf16 v[150:153], a[240:243], v[158:161], v[150:153]
 ds_read_b128 v[154:157], v2 offset:30720
 ds_read_b128 v[158:161], v2 offset:31744
 s_waitcnt lgkmcnt(4)
 v_mfma_f32_16x16x32_bf16 v[138:141], a[52:55], v[162:165], v[138:141]
 s_add_u32 m0, s40, 90112
 s_add_u32 s19, s39, 90112
 buffer_load_dwordx4 v2, s[4:7], s19 offen sc1 lds
 v_mfma_f32_16x16x32_bf16 v[146:149], a[244:247], v[162:165], v[146:149]
 v_mfma_f32_16x16x32_bf16 v[142:145], a[52:55], v[166:169], v[142:145]
 v_mfma_f32_16x16x32_bf16 v[150:153], a[244:247], v[166:169], v[150:153]
 ds_read_b128 v[162:165], v2 offset:32768
 ds_read_b128 v[166:169], v2 offset:33792
 s_waitcnt lgkmcnt(4)
 v_mfma_f32_16x16x32_bf16 v[138:141], a[56:59], v[170:173], v[138:141]
 s_add_u32 m0, s40, 94208
 s_add_u32 s19, s39, 94208
 buffer_load_dwordx4 v2, s[4:7], s19 offen sc1 lds
 v_mfma_f32_16x16x32_bf16 v[146:149], a[248:251], v[170:173], v[146:149]
 v_mfma_f32_16x16x32_bf16 v[142:145], a[56:59], v[174:177], v[142:145]
 v_mfma_f32_16x16x32_bf16 v[150:153], a[248:251], v[174:177], v[150:153]
 ds_read_b128 v[170:173], v2 offset:34816
 ds_read_b128 v[174:177], v2 offset:35840
 s_waitcnt lgkmcnt(4)
 v_mfma_f32_16x16x32_bf16 v[138:141], a[60:63], v[154:157], v[138:141]
 v_mfma_f32_16x16x32_bf16 v[146:149], a[252:255], v[154:157], v[146:149]
 v_mfma_f32_16x16x32_bf16 v[142:145], a[60:63], v[158:161], v[142:145]
 v_mfma_f32_16x16x32_bf16 v[150:153], a[252:255], v[158:161], v[150:153]
 ds_read_b128 v[154:157], v2 offset:36864
 ds_read_b128 v[158:161], v2 offset:37888
 s_waitcnt lgkmcnt(4)
 v_mfma_f32_16x16x32_bf16 v[138:141], a[64:67], v[162:165], v[138:141]
 v_mfma_f32_16x16x32_bf16 v[146:149], v[4:7], v[162:165], v[146:149]
 v_mfma_f32_16x16x32_bf16 v[142:145], a[64:67], v[166:169], v[142:145]
 v_mfma_f32_16x16x32_bf16 v[150:153], v[4:7], v[166:169], v[150:153]
 s_cmp_eq_u32 s46, 1
 s_cbranch_scc0 Lnp_360
 s_waitcnt vmcnt(15)
 s_mov_b64 exec, 1
 v_mov_b32 v194, 1
 ds_add_rtn_u32 v194, v137, v194
 s_waitcnt lgkmcnt(0)
 v_readfirstlane_b32 s48, v194
 s_nop 0
 s_and_b32 s48, s48, 3
 s_cmp_eq_u32 s48, 3
 s_cbranch_scc0 Lar_361
 v_mov_b32 v194, s47
 buffer_store_dword v194, off, s[4:7], s38 sc1
Lar_361:
 s_mov_b64 exec, -1
Lnp_360:
 ds_read_b128 v[162:165], v2 offset:38912
 ds_read_b128 v[166:169], v2 offset:39936
 s_waitcnt lgkmcnt(4)
 v_mfma_f32_16x16x32_bf16 v[138:141], a[68:71], v[170:173], v[138:141]
 v_mfma_f32_16x16x32_bf16 v[146:149], v[8:11], v[170:173], v[146:149]
 v_mfma_f32_16x16x32_bf16 v[142:145], a[68:71], v[174:177], v[142:145]
 v_mfma_f32_16x16x32_bf16 v[150:153], v[8:11], v[174:177], v[150:153]
 s_waitcnt vmcnt(9)
 s_barrier
 ds_read_b128 v[170:173], v2 offset:40960
 ds_read_b128 v[174:177], v2 offset:41984
 s_waitcnt lgkmcnt(4)
 v_mfma_f32_16x16x32_bf16 v[138:141], a[72:75], v[154:157], v[138:141]
 v_mfma_f32_16x16x32_bf16 v[146:149], v[12:15], v[154:157], v[146:149]
 v_mfma_f32_16x16x32_bf16 v[142:145], a[72:75], v[158:161], v[142:145]
 v_mfma_f32_16x16x32_bf16 v[150:153], v[12:15], v[158:161], v[150:153]
 ds_read_b128 v[154:157], v2 offset:43008
 ds_read_b128 v[158:161], v2 offset:44032
 s_waitcnt lgkmcnt(4)
 v_mfma_f32_16x16x32_bf16 v[138:141], a[76:79], v[162:165], v[138:141]
 v_mfma_f32_16x16x32_bf16 v[146:149], v[16:19], v[162:165], v[146:149]
 v_mfma_f32_16x16x32_bf16 v[142:145], a[76:79], v[166:169], v[142:145]
 v_mfma_f32_16x16x32_bf16 v[150:153], v[16:19], v[166:169], v[150:153]
 ds_read_b128 v[162:165], v2 offset:45056
 ds_read_b128 v[166:169], v2 offset:46080
 s_waitcnt lgkmcnt(4)
 v_mfma_f32_16x16x32_bf16 v[138:141], a[80:83], v[170:173], v[138:141]
 v_mfma_f32_16x16x32_bf16 v[146:149], v[20:23], v[170:173], v[146:149]
 v_mfma_f32_16x16x32_bf16 v[142:145], a[80:83], v[174:177], v[142:145]
 v_mfma_f32_16x16x32_bf16 v[150:153], v[20:23], v[174:177], v[150:153]
 ds_read_b128 v[170:173], v2 offset:47104
 ds_read_b128 v[174:177], v2 offset:48128
 s_waitcnt lgkmcnt(4)
 v_mfma_f32_16x16x32_bf16 v[138:141], a[84:87], v[154:157], v[138:141]
 v_mfma_f32_16x16x32_bf16 v[146:149], v[24:27], v[154:157], v[146:149]
 v_mfma_f32_16x16x32_bf16 v[142:145], a[84:87], v[158:161], v[142:145]
 v_mfma_f32_16x16x32_bf16 v[150:153], v[24:27], v[158:161], v[150:153]
 ds_read_b128 v[154:157], v134 offset:0
 ds_read_b128 v[158:161], v134 offset:1024
 s_waitcnt lgkmcnt(4)
 v_mfma_f32_16x16x32_bf16 v[138:141], a[88:91], v[162:165], v[138:141]
 v_mfma_f32_16x16x32_bf16 v[146:149], v[28:31], v[162:165], v[146:149]
 v_mfma_f32_16x16x32_bf16 v[142:145], a[88:91], v[166:169], v[142:145]
 v_mfma_f32_16x16x32_bf16 v[150:153], v[28:31], v[166:169], v[150:153]
 ds_read_b128 v[162:165], v134 offset:2048
 ds_read_b128 v[166:169], v134 offset:3072
 s_waitcnt lgkmcnt(4)
 v_mfma_f32_16x16x32_bf16 v[138:141], a[92:95], v[170:173], v[138:141]
 v_mfma_f32_16x16x32_bf16 v[146:149], v[32:35], v[170:173], v[146:149]
 v_mfma_f32_16x16x32_bf16 v[142:145], a[92:95], v[174:177], v[142:145]
 v_mfma_f32_16x16x32_bf16 v[150:153], v[32:35], v[174:177], v[150:153]
 ds_read_b128 v[170:173], v134 offset:4096
 ds_read_b128 v[174:177], v134 offset:5120
 s_waitcnt lgkmcnt(4)
 v_mfma_f32_16x16x32_bf16 v[138:141], a[96:99], v[154:157], v[138:141]
 v_mfma_f32_16x16x32_bf16 v[146:149], v[36:39], v[154:157], v[146:149]
 v_mfma_f32_16x16x32_bf16 v[142:145], a[96:99], v[158:161], v[142:145]
 v_mfma_f32_16x16x32_bf16 v[150:153], v[36:39], v[158:161], v[150:153]
 ds_read_b128 v[154:157], v134 offset:6144
 ds_read_b128 v[158:161], v134 offset:7168
 s_waitcnt lgkmcnt(4)
 v_mfma_f32_16x16x32_bf16 v[138:141], a[100:103], v[162:165], v[138:141]
 v_mfma_f32_16x16x32_bf16 v[146:149], v[40:43], v[162:165], v[146:149]
 v_mfma_f32_16x16x32_bf16 v[142:145], a[100:103], v[166:169], v[142:145]
 v_mfma_f32_16x16x32_bf16 v[150:153], v[40:43], v[166:169], v[150:153]
 ds_read_b128 v[162:165], v134 offset:8192
 ds_read_b128 v[166:169], v134 offset:9216
 s_waitcnt lgkmcnt(4)
 v_mfma_f32_16x16x32_bf16 v[138:141], a[104:107], v[170:173], v[138:141]
 v_mfma_f32_16x16x32_bf16 v[146:149], v[44:47], v[170:173], v[146:149]
 v_mfma_f32_16x16x32_bf16 v[142:145], a[104:107], v[174:177], v[142:145]
 v_mfma_f32_16x16x32_bf16 v[150:153], v[44:47], v[174:177], v[150:153]
 ds_read_b128 v[170:173], v134 offset:10240
 ds_read_b128 v[174:177], v134 offset:11264
 s_waitcnt lgkmcnt(4)
 v_mfma_f32_16x16x32_bf16 v[138:141], a[108:111], v[154:157], v[138:141]
 v_mfma_f32_16x16x32_bf16 v[146:149], v[48:51], v[154:157], v[146:149]
 v_mfma_f32_16x16x32_bf16 v[142:145], a[108:111], v[158:161], v[142:145]
 v_mfma_f32_16x16x32_bf16 v[150:153], v[48:51], v[158:161], v[150:153]
 s_waitcnt vmcnt(0)
 s_barrier
 ds_read_b128 v[154:157], v134 offset:12288
 ds_read_b128 v[158:161], v134 offset:13312
 s_waitcnt lgkmcnt(4)
 v_mfma_f32_16x16x32_bf16 v[138:141], a[112:115], v[162:165], v[138:141]
 v_mfma_f32_16x16x32_bf16 v[146:149], v[52:55], v[162:165], v[146:149]
 v_mfma_f32_16x16x32_bf16 v[142:145], a[112:115], v[166:169], v[142:145]
 v_mfma_f32_16x16x32_bf16 v[150:153], v[52:55], v[166:169], v[150:153]
 ds_read_b128 v[162:165], v134 offset:14336
 ds_read_b128 v[166:169], v134 offset:15360
 s_waitcnt lgkmcnt(4)
 v_mfma_f32_16x16x32_bf16 v[138:141], a[116:119], v[170:173], v[138:141]
 v_mfma_f32_16x16x32_bf16 v[146:149], v[56:59], v[170:173], v[146:149]
 v_mfma_f32_16x16x32_bf16 v[142:145], a[116:119], v[174:177], v[142:145]
 v_mfma_f32_16x16x32_bf16 v[150:153], v[56:59], v[174:177], v[150:153]
 ds_read_b128 v[170:173], v134 offset:16384
 ds_read_b128 v[174:177], v134 offset:17408
 s_waitcnt lgkmcnt(4)
 v_mfma_f32_16x16x32_bf16 v[138:141], a[120:123], v[154:157], v[138:141]
 buffer_load_dword v3, v132, s[4:7], 0 offen sc1
 v_mfma_f32_16x16x32_bf16 v[146:149], v[60:63], v[154:157], v[146:149]
 v_mfma_f32_16x16x32_bf16 v[142:145], a[120:123], v[158:161], v[142:145]
 v_mfma_f32_16x16x32_bf16 v[150:153], v[60:63], v[158:161], v[150:153]
 ds_read_b128 v[154:157], v134 offset:18432
 ds_read_b128 v[158:161], v134 offset:19456
 s_waitcnt lgkmcnt(4)
 v_mfma_f32_16x16x32_bf16 v[138:141], a[124:127], v[162:165], v[138:141]
 v_mfma_f32_16x16x32_bf16 v[146:149], v[64:67], v[162:165], v[146:149]
 v_mfma_f32_16x16x32_bf16 v[142:145], a[124:127], v[166:169], v[142:145]
 v_mfma_f32_16x16x32_bf16 v[150:153], v[64:67], v[166:169], v[150:153]
 ds_read_b128 v[162:165], v134 offset:20480
 ds_read_b128 v[166:169], v134 offset:21504
 s_waitcnt lgkmcnt(4)
 v_mfma_f32_16x16x32_bf16 v[138:141], a[128:131], v[170:173], v[138:141]
 v_mfma_f32_16x16x32_bf16 v[146:149], v[68:71], v[170:173], v[146:149]
 v_mfma_f32_16x16x32_bf16 v[142:145], a[128:131], v[174:177], v[142:145]
 v_mfma_f32_16x16x32_bf16 v[150:153], v[68:71], v[174:177], v[150:153]
 ds_read_b128 v[170:173], v134 offset:22528
 ds_read_b128 v[174:177], v134 offset:23552
 s_waitcnt lgkmcnt(4)
 v_mfma_f32_16x16x32_bf16 v[138:141], a[132:135], v[154:157], v[138:141]
 v_mfma_f32_16x16x32_bf16 v[146:149], v[72:75], v[154:157], v[146:149]
 v_mfma_f32_16x16x32_bf16 v[142:145], a[132:135], v[158:161], v[142:145]
 v_mfma_f32_16x16x32_bf16 v[150:153], v[72:75], v[158:161], v[150:153]
 ds_read_b128 v[154:157], v134 offset:24576
 ds_read_b128 v[158:161], v134 offset:25600
 s_waitcnt lgkmcnt(4)
 v_mfma_f32_16x16x32_bf16 v[138:141], a[136:139], v[162:165], v[138:141]
 v_mfma_f32_16x16x32_bf16 v[146:149], v[76:79], v[162:165], v[146:149]
 v_mfma_f32_16x16x32_bf16 v[142:145], a[136:139], v[166:169], v[142:145]
 v_mfma_f32_16x16x32_bf16 v[150:153], v[76:79], v[166:169], v[150:153]
 ds_read_b128 v[162:165], v134 offset:26624
 ds_read_b128 v[166:169], v134 offset:27648
 s_waitcnt lgkmcnt(4)
 v_mfma_f32_16x16x32_bf16 v[138:141], a[140:143], v[170:173], v[138:141]
 v_mfma_f32_16x16x32_bf16 v[146:149], v[80:83], v[170:173], v[146:149]
 v_mfma_f32_16x16x32_bf16 v[142:145], a[140:143], v[174:177], v[142:145]
 v_mfma_f32_16x16x32_bf16 v[150:153], v[80:83], v[174:177], v[150:153]
 ds_read_b128 v[170:173], v134 offset:28672
 ds_read_b128 v[174:177], v134 offset:29696
 s_waitcnt lgkmcnt(4)
 v_mfma_f32_16x16x32_bf16 v[138:141], a[144:147], v[154:157], v[138:141]
 v_mfma_f32_16x16x32_bf16 v[146:149], v[84:87], v[154:157], v[146:149]
 v_mfma_f32_16x16x32_bf16 v[142:145], a[144:147], v[158:161], v[142:145]
 v_mfma_f32_16x16x32_bf16 v[150:153], v[84:87], v[158:161], v[150:153]
 ds_read_b128 v[154:157], v134 offset:30720
 ds_read_b128 v[158:161], v134 offset:31744
 s_waitcnt lgkmcnt(4)
 v_mfma_f32_16x16x32_bf16 v[138:141], a[148:151], v[162:165], v[138:141]
 v_mfma_f32_16x16x32_bf16 v[146:149], v[88:91], v[162:165], v[146:149]
 v_mfma_f32_16x16x32_bf16 v[142:145], a[148:151], v[166:169], v[142:145]
 v_mfma_f32_16x16x32_bf16 v[150:153], v[88:91], v[166:169], v[150:153]
 s_mov_b32 s47, s45
 s_cmp_ge_u32 s45, 64
 s_cbranch_scc1 Lon_355
 s_waitcnt vmcnt(0)
 v_cmp_lt_u32 vcc, s45, v3
 s_nop 0
 s_cmp_eq_u64 vcc, -1
 s_cbranch_scc0 Lon_355
 s_mul_i32 s43, s44, 327680
 s_add_u32 s43, s43, s41
 s_mul_i32 s39, s45, 393216
 s_mul_i32 s19, s36, 98304
 s_add_u32 s39, s39, s19
 s_add_u32 s39, s39, 159809536
 s_add_u32 s39, s39, s40
 ds_read_b128 v[162:165], v134 offset:32768
 ds_read_b128 v[166:169], v134 offset:33792
 s_waitcnt lgkmcnt(4)
 v_mfma_f32_16x16x32_bf16 v[138:141], a[152:155], v[170:173], v[138:141]
 s_add_u32 m0, s40, 0
 s_add_u32 s19, s39, 0
 buffer_load_dwordx4 v2, s[4:7], s19 offen sc1 lds
 v_mfma_f32_16x16x32_bf16 v[146:149], v[92:95], v[170:173], v[146:149]
 v_mfma_f32_16x16x32_bf16 v[142:145], a[152:155], v[174:177], v[142:145]
 v_mfma_f32_16x16x32_bf16 v[150:153], v[92:95], v[174:177], v[150:153]
 ds_read_b128 v[170:173], v134 offset:34816
 ds_read_b128 v[174:177], v134 offset:35840
 s_waitcnt lgkmcnt(4)
 v_mfma_f32_16x16x32_bf16 v[138:141], a[156:159], v[154:157], v[138:141]
 s_add_u32 m0, s40, 4096
 s_add_u32 s19, s39, 4096
 buffer_load_dwordx4 v2, s[4:7], s19 offen sc1 lds
 v_mfma_f32_16x16x32_bf16 v[146:149], v[96:99], v[154:157], v[146:149]
 v_mfma_f32_16x16x32_bf16 v[142:145], a[156:159], v[158:161], v[142:145]
 v_mfma_f32_16x16x32_bf16 v[150:153], v[96:99], v[158:161], v[150:153]
 ds_read_b128 v[154:157], v134 offset:36864
 ds_read_b128 v[158:161], v134 offset:37888
 s_waitcnt lgkmcnt(4)
 v_mfma_f32_16x16x32_bf16 v[138:141], a[160:163], v[162:165], v[138:141]
 s_add_u32 m0, s40, 8192
 s_add_u32 s19, s39, 8192
 buffer_load_dwordx4 v2, s[4:7], s19 offen sc1 lds
 v_mfma_f32_16x16x32_bf16 v[146:149], v[100:103], v[162:165], v[146:149]
 v_mfma_f32_16x16x32_bf16 v[142:145], a[160:163], v[166:169], v[142:145]
 v_mfma_f32_16x16x32_bf16 v[150:153], v[100:103], v[166:169], v[150:153]
 ds_read_b128 v[162:165], v134 offset:38912
 ds_read_b128 v[166:169], v134 offset:39936
 s_waitcnt lgkmcnt(4)
 v_mfma_f32_16x16x32_bf16 v[138:141], a[164:167], v[170:173], v[138:141]
 s_add_u32 m0, s40, 12288
 s_add_u32 s19, s39, 12288
 buffer_load_dwordx4 v2, s[4:7], s19 offen sc1 lds
 v_mfma_f32_16x16x32_bf16 v[146:149], v[104:107], v[170:173], v[146:149]
 v_mfma_f32_16x16x32_bf16 v[142:145], a[164:167], v[174:177], v[142:145]
 v_mfma_f32_16x16x32_bf16 v[150:153], v[104:107], v[174:177], v[150:153]
 ds_read_b128 v[170:173], v134 offset:40960
 ds_read_b128 v[174:177], v134 offset:41984
 s_waitcnt lgkmcnt(4)
 v_mfma_f32_16x16x32_bf16 v[138:141], a[168:171], v[154:157], v[138:141]
 s_add_u32 m0, s40, 16384
 s_add_u32 s19, s39, 16384
 buffer_load_dwordx4 v2, s[4:7], s19 offen sc1 lds
 v_mfma_f32_16x16x32_bf16 v[146:149], v[108:111], v[154:157], v[146:149]
 v_mfma_f32_16x16x32_bf16 v[142:145], a[168:171], v[158:161], v[142:145]
 v_mfma_f32_16x16x32_bf16 v[150:153], v[108:111], v[158:161], v[150:153]
 ds_read_b128 v[154:157], v134 offset:43008
 ds_read_b128 v[158:161], v134 offset:44032
 s_waitcnt lgkmcnt(4)
 v_mfma_f32_16x16x32_bf16 v[138:141], a[172:175], v[162:165], v[138:141]
 s_add_u32 m0, s40, 20480
 s_add_u32 s19, s39, 20480
 buffer_load_dwordx4 v2, s[4:7], s19 offen sc1 lds
 v_mfma_f32_16x16x32_bf16 v[146:149], v[112:115], v[162:165], v[146:149]
 v_mfma_f32_16x16x32_bf16 v[142:145], a[172:175], v[166:169], v[142:145]
 v_mfma_f32_16x16x32_bf16 v[150:153], v[112:115], v[166:169], v[150:153]
 ds_read_b128 v[162:165], v134 offset:45056
 ds_read_b128 v[166:169], v134 offset:46080
 s_waitcnt lgkmcnt(4)
 v_mfma_f32_16x16x32_bf16 v[138:141], a[176:179], v[170:173], v[138:141]
 s_add_u32 m0, s40, 24576
 s_add_u32 s19, s39, 24576
 buffer_load_dwordx4 v2, s[4:7], s19 offen sc1 lds
 v_mfma_f32_16x16x32_bf16 v[146:149], v[116:119], v[170:173], v[146:149]
 v_mfma_f32_16x16x32_bf16 v[142:145], a[176:179], v[174:177], v[142:145]
 v_mfma_f32_16x16x32_bf16 v[150:153], v[116:119], v[174:177], v[150:153]
 ds_read_b128 v[170:173], v134 offset:47104
 ds_read_b128 v[174:177], v134 offset:48128
 s_waitcnt lgkmcnt(4)
 v_mfma_f32_16x16x32_bf16 v[138:141], a[180:183], v[154:157], v[138:141]
 s_add_u32 m0, s40, 28672
 s_add_u32 s19, s39, 28672
 buffer_load_dwordx4 v2, s[4:7], s19 offen sc1 lds
 v_mfma_f32_16x16x32_bf16 v[146:149], v[120:123], v[154:157], v[146:149]
 v_mfma_f32_16x16x32_bf16 v[142:145], a[180:183], v[158:161], v[142:145]
 v_mfma_f32_16x16x32_bf16 v[150:153], v[120:123], v[158:161], v[150:153]
 s_waitcnt lgkmcnt(3)
 v_mfma_f32_16x16x32_bf16 v[138:141], a[184:187], v[162:165], v[138:141]
 s_add_u32 m0, s40, 32768
 s_add_u32 s19, s39, 32768
 buffer_load_dwordx4 v2, s[4:7], s19 offen sc1 lds
 v_mfma_f32_16x16x32_bf16 v[146:149], v[124:127], v[162:165], v[146:149]
 s_waitcnt lgkmcnt(2)
 v_mfma_f32_16x16x32_bf16 v[142:145], a[184:187], v[166:169], v[142:145]
 v_mfma_f32_16x16x32_bf16 v[150:153], v[124:127], v[166:169], v[150:153]
 s_waitcnt lgkmcnt(1)
 v_mfma_f32_16x16x32_bf16 v[138:141], a[188:191], v[170:173], v[138:141]
 v_mfma_f32_16x16x32_bf16 v[146:149], v[128:131], v[170:173], v[146:149]
 s_waitcnt lgkmcnt(0)
 v_mfma_f32_16x16x32_bf16 v[142:145], a[188:191], v[174:177], v[142:145]
 v_mfma_f32_16x16x32_bf16 v[150:153], v[128:131], v[174:177], v[150:153]
 buffer_store_dwordx4 v[138:141], v133, s[4:7], s43 offen offset:0 sc1
 s_nop 0
 buffer_store_dwordx4 v[146:149], v133, s[4:7], s43 offen offset:1024 sc1
 s_nop 1
 buffer_store_dwordx4 v[142:145], v133, s[4:7], s43 offen offset:2048 sc1
 s_nop 1
 buffer_store_dwordx4 v[150:153], v133, s[4:7], s43 offen offset:3072 sc1
 s_mov_b32 s44, s45
 s_add_u32 s45, s45, 1
 s_branch Low_352
Lon_355:
 s_mul_i32 s43, s44, 327680
 s_add_u32 s43, s43, s41
 s_mul_i32 s39, s45, 393216
 s_mul_i32 s19, s36, 98304
 s_add_u32 s39, s39, s19
 s_add_u32 s39, s39, 159809536
 s_add_u32 s39, s39, s40
 ds_read_b128 v[162:165], v134 offset:32768
 ds_read_b128 v[166:169], v134 offset:33792
 s_waitcnt lgkmcnt(4)
 v_mfma_f32_16x16x32_bf16 v[138:141], a[152:155], v[170:173], v[138:141]
 v_mfma_f32_16x16x32_bf16 v[146:149], v[92:95], v[170:173], v[146:149]
 v_mfma_f32_16x16x32_bf16 v[142:145], a[152:155], v[174:177], v[142:145]
 v_mfma_f32_16x16x32_bf16 v[150:153], v[92:95], v[174:177], v[150:153]
 ds_read_b128 v[170:173], v134 offset:34816
 ds_read_b128 v[174:177], v134 offset:35840
 s_waitcnt lgkmcnt(4)
 v_mfma_f32_16x16x32_bf16 v[138:141], a[156:159], v[154:157], v[138:141]
 v_mfma_f32_16x16x32_bf16 v[146:149], v[96:99], v[154:157], v[146:149]
 v_mfma_f32_16x16x32_bf16 v[142:145], a[156:159], v[158:161], v[142:145]
 v_mfma_f32_16x16x32_bf16 v[150:153], v[96:99], v[158:161], v[150:153]
 ds_read_b128 v[154:157], v134 offset:36864
 ds_read_b128 v[158:161], v134 offset:37888
 s_waitcnt lgkmcnt(4)
 v_mfma_f32_16x16x32_bf16 v[138:141], a[160:163], v[162:165], v[138:141]
 v_mfma_f32_16x16x32_bf16 v[146:149], v[100:103], v[162:165], v[146:149]
 v_mfma_f32_16x16x32_bf16 v[142:145], a[160:163], v[166:169], v[142:145]
 v_mfma_f32_16x16x32_bf16 v[150:153], v[100:103], v[166:169], v[150:153]
 ds_read_b128 v[162:165], v134 offset:38912
 ds_read_b128 v[166:169], v134 offset:39936
 s_waitcnt lgkmcnt(4)
 v_mfma_f32_16x16x32_bf16 v[138:141], a[164:167], v[170:173], v[138:141]
 v_mfma_f32_16x16x32_bf16 v[146:149], v[104:107], v[170:173], v[146:149]
 v_mfma_f32_16x16x32_bf16 v[142:145], a[164:167], v[174:177], v[142:145]
 v_mfma_f32_16x16x32_bf16 v[150:153], v[104:107], v[174:177], v[150:153]
 ds_read_b128 v[170:173], v134 offset:40960
 ds_read_b128 v[174:177], v134 offset:41984
 s_waitcnt lgkmcnt(4)
 v_mfma_f32_16x16x32_bf16 v[138:141], a[168:171], v[154:157], v[138:141]
 v_mfma_f32_16x16x32_bf16 v[146:149], v[108:111], v[154:157], v[146:149]
 v_mfma_f32_16x16x32_bf16 v[142:145], a[168:171], v[158:161], v[142:145]
 v_mfma_f32_16x16x32_bf16 v[150:153], v[108:111], v[158:161], v[150:153]
 ds_read_b128 v[154:157], v134 offset:43008
 ds_read_b128 v[158:161], v134 offset:44032
 s_waitcnt lgkmcnt(4)
 v_mfma_f32_16x16x32_bf16 v[138:141], a[172:175], v[162:165], v[138:141]
 v_mfma_f32_16x16x32_bf16 v[146:149], v[112:115], v[162:165], v[146:149]
 v_mfma_f32_16x16x32_bf16 v[142:145], a[172:175], v[166:169], v[142:145]
 v_mfma_f32_16x16x32_bf16 v[150:153], v[112:115], v[166:169], v[150:153]
 ds_read_b128 v[162:165], v134 offset:45056
 ds_read_b128 v[166:169], v134 offset:46080
 s_waitcnt lgkmcnt(4)
 v_mfma_f32_16x16x32_bf16 v[138:141], a[176:179], v[170:173], v[138:141]
 v_mfma_f32_16x16x32_bf16 v[146:149], v[116:119], v[170:173], v[146:149]
 v_mfma_f32_16x16x32_bf16 v[142:145], a[176:179], v[174:177], v[142:145]
 v_mfma_f32_16x16x32_bf16 v[150:153], v[116:119], v[174:177], v[150:153]
 ds_read_b128 v[170:173], v134 offset:47104
 ds_read_b128 v[174:177], v134 offset:48128
 s_waitcnt lgkmcnt(4)
 v_mfma_f32_16x16x32_bf16 v[138:141], a[180:183], v[154:157], v[138:141]
 v_mfma_f32_16x16x32_bf16 v[146:149], v[120:123], v[154:157], v[146:149]
 v_mfma_f32_16x16x32_bf16 v[142:145], a[180:183], v[158:161], v[142:145]
 v_mfma_f32_16x16x32_bf16 v[150:153], v[120:123], v[158:161], v[150:153]
 s_waitcnt lgkmcnt(3)
 v_mfma_f32_16x16x32_bf16 v[138:141], a[184:187], v[162:165], v[138:141]
 v_mfma_f32_16x16x32_bf16 v[146:149], v[124:127], v[162:165], v[146:149]
 s_waitcnt lgkmcnt(2)
 v_mfma_f32_16x16x32_bf16 v[142:145], a[184:187], v[166:169], v[142:145]
 v_mfma_f32_16x16x32_bf16 v[150:153], v[124:127], v[166:169], v[150:153]
 s_waitcnt lgkmcnt(1)
 v_mfma_f32_16x16x32_bf16 v[138:141], a[188:191], v[170:173], v[138:141]
 v_mfma_f32_16x16x32_bf16 v[146:149], v[128:131], v[170:173], v[146:149]
 s_waitcnt lgkmcnt(0)
 v_mfma_f32_16x16x32_bf16 v[142:145], a[188:191], v[174:177], v[142:145]
 v_mfma_f32_16x16x32_bf16 v[150:153], v[128:131], v[174:177], v[150:153]
 buffer_store_dwordx4 v[138:141], v133, s[4:7], s43 offen offset:0 sc1
 s_nop 0
 buffer_store_dwordx4 v[146:149], v133, s[4:7], s43 offen offset:1024 sc1
 s_nop 1
 buffer_store_dwordx4 v[142:145], v133, s[4:7], s43 offen offset:2048 sc1
 s_nop 1
 buffer_store_dwordx4 v[150:153], v133, s[4:7], s43 offen offset:3072 sc1
 s_mov_b32 s44, s45
 s_add_u32 s45, s45, 1
 s_branch Loc_351
Lod_356:
 s_endpgm
L_role_at:
 s_sub_u32 s12, s12, 176
 s_cmp_eq_u32 s13, 1
 s_cbranch_scc1 Lverok_363
 s_mov_b32 s18, 0
Lver_362:
 s_add_u32 s18, s18, 1
 s_cmp_gt_u32 s18, 200000
 s_cbranch_scc1 L_fail
 v_and_b32 v254, 7, v0
 v_lshlrev_b32 v254, 2, v254
 buffer_load_dword v255, v254, s[8:11], 0 offen sc1
 s_waitcnt vmcnt(0)
 v_cmp_eq_u32 vcc, 32, v255
 s_nop 0
 s_cmp_eq_u64 vcc, -1
 s_cbranch_scc1 Lverok_363
 s_mov_b32 s17, 0
 v_readlane_b32 s14, v255, 0
 s_nop 0
 s_add_u32 s17, s17, s14
 v_readlane_b32 s14, v255, 1
 s_nop 0
 s_add_u32 s17, s17, s14
 v_readlane_b32 s14, v255, 2
 s_nop 0
 s_add_u32 s17, s17, s14
 v_readlane_b32 s14, v255, 3
 s_nop 0
 s_add_u32 s17, s17, s14
 v_readlane_b32 s14, v255, 4
 s_nop 0
 s_add_u32 s17, s17, s14
 v_readlane_b32 s14, v255, 5
 s_nop 0
 s_add_u32 s17, s17, s14
 v_readlane_b32 s14, v255, 6
 s_nop 0
 s_add_u32 s17, s17, s14
 v_readlane_b32 s14, v255, 7
 s_nop 0
 s_add_u32 s17, s17, s14
 s_cmp_eq_u32 s17, 256
 s_cbranch_scc1 L_fallback
 s_branch Lver_362
Lverok_363:
 v_and_b32 v1, 63, v0
 v_lshlrev_b32 v2, 4, v1
 s_mov_b32 s31, 0x3dd53b95
 s_lshr_b32 s26, s12, 4
 s_and_b32 s19, s12, 15
 s_lshl_b32 s19, s19, 1
 s_lshr_b32 s20, s3, 1
 s_add_u32 s19, s19, s20
 s_and_b32 s20, s3, 1
 s_mul_i32 s21, s19, 12288
 s_lshl_b32 s22, s20, 10
 s_add_u32 s22, s22, s21
 s_add_u32 s32, s22, 33980416
 s_add_u32 s35, s22, 159809536
 s_mul_i32 s23, s26, 50331648
 s_add_u32 s23, s23, s21
 s_add_u32 s33, s23, 59146240
 s_add_u32 s34, s23, 84312064
 s_mul_i32 s36, s19, 6144
 s_mul_i32 s23, s26, 1769472
 s_add_u32 s36, s36, s23
 s_add_u32 s36, s36, 2523136
 s_lshl_b32 s30, s26, 6
 s_lshr_b32 s23, s19, 1
 s_add_u32 s30, s30, s23
 s_lshl_b32 s30, s30, 7
 s_add_u32 s30, s30, 139264
 v_and_b32 v4, 3, v1
 v_min_u32 v4, 2, v4
 v_bfe_u32 v6, v1, 2, 2
 v_min_u32 v6, 2, v6
 v_mul_u32_u24 v6, 96, v6
 v_add_u32 v4, v4, v6
 s_mul_i32 s23, s19, 3
 s_lshl_b32 s24, s26, 9
 s_add_u32 s23, s23, s24
 v_add_u32 v4, s23, v4
 v_lshlrev_b32 v4, 7, v4
 v_add_u32 v4, 0, v4
 v_and_b32 v5, 1, v1
 s_lshl_b32 s23, s19, 1
 v_add_u32 v5, s23, v5
 v_lshlrev_b32 v5, 7, v5
 v_add_u32 v5, 131072, v5
 v_mov_b32 v7, 0xf149f2ca
 v_lshrrev_b32 v6, 5, v1
 v_cmp_eq_u32 vcc, s26, v6
 s_nop 1
 v_cndmask_b32 v12, v7, 0, vcc
 v_mov_b32 v16, 0x3f803f80
 v_lshrrev_b32 v6, 4, v1
 v_lshlrev_b32 v6, 2, v6
 v_add_u32 v6, 0, v6
 v_and_b32 v3, 15, v1
 v_cmp_le_u32 vcc, v6, v3
 s_nop 1
 v_cndmask_b32 v8, v7, 0, vcc
 v_mov_b32 v13, v12
 v_mov_b32 v17, 0x3f803f80
 v_lshrrev_b32 v6, 4, v1
 v_lshlrev_b32 v6, 2, v6
 v_add_u32 v6, 1, v6
 v_and_b32 v3, 15, v1
 v_cmp_le_u32 vcc, v6, v3
 s_nop 1
 v_cndmask_b32 v9, v7, 0, vcc
 v_mov_b32 v14, v12
 v_mov_b32 v18, 0x3f803f80
 v_lshrrev_b32 v6, 4, v1
 v_lshlrev_b32 v6, 2, v6
 v_add_u32 v6, 2, v6
 v_and_b32 v3, 15, v1
 v_cmp_le_u32 vcc, v6, v3
 s_nop 1
 v_cndmask_b32 v10, v7, 0, vcc
 v_mov_b32 v15, v12
 v_mov_b32 v19, 0x3f803f80
 v_lshrrev_b32 v6, 4, v1
 v_lshlrev_b32 v6, 2, v6
 v_add_u32 v6, 3, v6
 v_and_b32 v3, 15, v1
 v_cmp_le_u32 vcc, v6, v3
 s_nop 1
 v_cndmask_b32 v11, v7, 0, vcc
 v_mov_b32 v202, 0
 v_mov_b32 v203, 0
 s_mov_b32 s27, 0
 s_bitcmp1_b32 s3, 0
 s_cbranch_scc1 L_at_1
Lat_364:
 s_add_u32 s28, s27, 1
 s_mul_i32 s29, s26, 9
 s_add_u32 s29, s29, s28
 s_mov_b32 s25, 0
Lw_365:
 s_add_u32 s25, s25, 1
 s_cmp_gt_u32 s25, 200000
 s_cbranch_scc1 L_fail
 buffer_load_dword v3, v4, s[4:7], 0 offen sc1
 s_waitcnt vmcnt(0)
 v_cmp_le_u32 vcc, s28, v3
 s_nop 0
 s_cmp_eq_u64 vcc, -1
 s_cbranch_scc0 Lw_365
 s_mul_i32 s20, s27, 393216
 s_add_u32 s21, s20, s32
 s_add_u32 s22, s20, s33
 s_add_u32 s23, s20, s34
 s_add_u32 s24, s21, 0
 buffer_load_dwordx4 v[20:23], v2, s[4:7], s24 offen offset:0 sc1
 buffer_load_dwordx4 v[24:27], v2, s[4:7], s24 offen offset:2048 sc1
 s_add_u32 s24, s21, 4096
 buffer_load_dwordx4 v[28:31], v2, s[4:7], s24 offen offset:0 sc1
 buffer_load_dwordx4 v[32:35], v2, s[4:7], s24 offen offset:2048 sc1
 s_add_u32 s24, s21, 8192
 buffer_load_dwordx4 v[36:39], v2, s[4:7], s24 offen offset:0 sc1
 buffer_load_dwordx4 v[40:43], v2, s[4:7], s24 offen offset:2048 sc1
 s_add_u32 s24, s22, 0
 buffer_load_dwordx4 v[44:47], v2, s[4:7], s24 offen offset:0 sc1
 buffer_load_dwordx4 v[48:51], v2, s[4:7], s24 offen offset:2048 sc1
 s_add_u32 s24, s22, 4096
 buffer_load_dwordx4 v[52:55], v2, s[4:7], s24 offen offset:0 sc1
 buffer_load_dwordx4 v[56:59], v2, s[4:7], s24 offen offset:2048 sc1
 s_add_u32 s24, s22, 8192
 buffer_load_dwordx4 v[60:63], v2, s[4:7], s24 offen offset:0 sc1
 buffer_load_dwordx4 v[64:67], v2, s[4:7], s24 offen offset:2048 sc1
 s_add_u32 s24, s23, 0
 buffer_load_dwordx4 v[92:95], v2, s[4:7], s24 offen offset:0 sc1
 buffer_load_dwordx4 v[96:99], v2, s[4:7], s24 offen offset:1024 sc1
 buffer_load_dwordx4 v[100:103], v2, s[4:7], s24 offen offset:2048 sc1
 buffer_load_dwordx4 v[104:107], v2, s[4:7], s24 offen offset:3072 sc1
 s_add_u32 s24, s23, 4096
 buffer_load_dwordx4 v[108:111], v2, s[4:7], s24 offen offset:0 sc1
 buffer_load_dwordx4 v[112:115], v2, s[4:7], s24 offen offset:1024 sc1
 buffer_load_dwordx4 v[116:119], v2, s[4:7], s24 offen offset:2048 sc1
 buffer_load_dwordx4 v[120:123], v2, s[4:7], s24 offen offset:3072 sc1
 s_add_u32 s24, s23, 8192
 buffer_load_dwordx4 v[124:127], v2, s[4:7], s24 offen offset:0 sc1
 buffer_load_dwordx4 v[128:131], v2, s[4:7], s24 offen offset:1024 sc1
 buffer_load_dwordx4 v[132:135], v2, s[4:7], s24 offen offset:2048 sc1
 buffer_load_dwordx4 v[136:139], v2, s[4:7], s24 offen offset:3072 sc1
 s_waitcnt vmcnt(12)
 v_mfma_f32_16x16x32_bf16 v[188:191], v[44:47], v[20:23], v[8:11]
 v_mfma_f32_16x16x32_bf16 v[188:191], v[48:51], v[24:27], v[188:191]
 v_mfma_f32_16x16x32_bf16 v[188:191], v[52:55], v[28:31], v[188:191]
 v_mfma_f32_16x16x32_bf16 v[188:191], v[56:59], v[32:35], v[188:191]
 v_mfma_f32_16x16x32_bf16 v[188:191], v[60:63], v[36:39], v[188:191]
 v_mfma_f32_16x16x32_bf16 v[188:191], v[64:67], v[40:43], v[188:191]
 s_mov_b32 s25, 0
Lw_366:
 s_add_u32 s25, s25, 1
 s_cmp_gt_u32 s25, 200000
 s_cbranch_scc1 L_fail
 buffer_load_dword v3, v5, s[4:7], 0 offen sc1
 s_waitcnt vmcnt(0)
 v_cmp_le_u32 vcc, s29, v3
 s_nop 0
 s_cmp_eq_u64 vcc, -1
 s_cbranch_scc0 Lw_366
 s_mul_i32 s21, s27, 196608
 s_add_u32 s21, s21, s36
 s_add_u32 s22, s21, 15728640
 s_add_u32 s24, s21, 0
 buffer_load_dwordx4 v[140:143], v2, s[4:7], s24 offen offset:0 sc1
 buffer_load_dwordx4 v[144:147], v2, s[4:7], s24 offen offset:1024 sc1
 buffer_load_dwordx4 v[148:151], v2, s[4:7], s24 offen offset:2048 sc1
 buffer_load_dwordx4 v[152:155], v2, s[4:7], s24 offen offset:3072 sc1
 s_add_u32 s24, s21, 4096
 buffer_load_dwordx4 v[156:159], v2, s[4:7], s24 offen offset:0 sc1
 buffer_load_dwordx4 v[160:163], v2, s[4:7], s24 offen offset:1024 sc1
 s_add_u32 s24, s22, 0
 buffer_load_dwordx4 v[164:167], v2, s[4:7], s24 offen offset:0 sc1
 buffer_load_dwordx4 v[168:171], v2, s[4:7], s24 offen offset:1024 sc1
 buffer_load_dwordx4 v[172:175], v2, s[4:7], s24 offen offset:2048 sc1
 buffer_load_dwordx4 v[176:179], v2, s[4:7], s24 offen offset:3072 sc1
 s_add_u32 s24, s22, 4096
 buffer_load_dwordx4 v[180:183], v2, s[4:7], s24 offen offset:0 sc1
 buffer_load_dwordx4 v[184:187], v2, s[4:7], s24 offen offset:1024 sc1
 s_waitcnt vmcnt(11)
 v_mfma_f32_16x16x32_bf16 v[196:199], v[140:143], v[20:23], v[12:15]
 s_waitcnt vmcnt(10)
 v_mfma_f32_16x16x32_bf16 v[196:199], v[144:147], v[24:27], v[196:199]
 s_waitcnt vmcnt(9)
 v_mfma_f32_16x16x32_bf16 v[196:199], v[148:151], v[28:31], v[196:199]
 s_waitcnt vmcnt(8)
 v_mfma_f32_16x16x32_bf16 v[196:199], v[152:155], v[32:35], v[196:199]
 s_waitcnt vmcnt(7)
 v_mfma_f32_16x16x32_bf16 v[196:199], v[156:159], v[36:39], v[196:199]
 s_waitcnt vmcnt(6)
 v_mfma_f32_16x16x32_bf16 v[196:199], v[160:163], v[40:43], v[196:199]
 v_max3_f32 v1, v188, v189, v190
 s_nop 6
 v_max3_f32 v208, v191, v196, v197
 v_max3_f32 v1, v1, v198, v199
 v_max_f32 v1, v1, v208
 v_mov_b32 v208, v1
 s_nop 1
 v_permlane32_swap_b32 v1, v208
 v_max_f32 v1, v1, v208
 v_mov_b32 v208, v1
 s_nop 1
 v_permlane16_swap_b32 v1, v208
 v_max_f32 v1, v1, v208
 v_mul_f32 v1, s31, v1
 v_fma_f32 v188, v188, s31, -v1
 v_fma_f32 v189, v189, s31, -v1
 v_fma_f32 v190, v190, s31, -v1
 v_fma_f32 v191, v191, s31, -v1
 v_fma_f32 v196, v196, s31, -v1
 v_fma_f32 v197, v197, s31, -v1
 v_fma_f32 v198, v198, s31, -v1
 v_fma_f32 v199, v199, s31, -v1
 v_exp_f32 v188, v188
 v_exp_f32 v189, v189
 v_exp_f32 v190, v190
 v_exp_f32 v191, v191
 v_exp_f32 v196, v196
 v_exp_f32 v197, v197
 v_exp_f32 v198, v198
 v_exp_f32 v199, v199
 v_cvt_pk_bf16_f32 v200, v188, v189
 v_cvt_pk_bf16_f32 v201, v190, v191
 v_cvt_pk_bf16_f32 v6, v196, v197
 v_cvt_pk_bf16_f32 v7, v198, v199
 v_mfma_f32_16x16x32_bf16 v[204:207], v[16:19], v[200:203], 0
 v_mfma_f32_16x16x32_bf16 v[44:47], v[92:95], v[200:203], 0
 v_mfma_f32_16x16x32_bf16 v[48:51], v[96:99], v[200:203], 0
 v_mfma_f32_16x16x16_bf16 v[204:207], v[16:17], v[6:7], v[204:207]
 v_mfma_f32_16x16x32_bf16 v[52:55], v[100:103], v[200:203], 0
 v_mfma_f32_16x16x32_bf16 v[56:59], v[104:107], v[200:203], 0
 v_mfma_f32_16x16x32_bf16 v[60:63], v[108:111], v[200:203], 0
 v_mfma_f32_16x16x32_bf16 v[64:67], v[112:115], v[200:203], 0
 v_rcp_f32 v208, v204
 s_add_u32 s21, s20, s35
 s_waitcnt vmcnt(0)
 v_mfma_f32_16x16x32_bf16 v[68:71], v[116:119], v[200:203], 0
 v_mfma_f32_16x16x32_bf16 v[72:75], v[120:123], v[200:203], 0
 v_mfma_f32_16x16x32_bf16 v[76:79], v[124:127], v[200:203], 0
 v_mfma_f32_16x16x32_bf16 v[80:83], v[128:131], v[200:203], 0
 v_mfma_f32_16x16x32_bf16 v[84:87], v[132:135], v[200:203], 0
 v_mfma_f32_16x16x32_bf16 v[88:91], v[136:139], v[200:203], 0
 v_mfma_f32_16x16x16_bf16 v[44:47], v[164:165], v[6:7], v[44:47]
 v_mfma_f32_16x16x16_bf16 v[48:51], v[166:167], v[6:7], v[48:51]
 v_mfma_f32_16x16x16_bf16 v[52:55], v[168:169], v[6:7], v[52:55]
 v_mfma_f32_16x16x16_bf16 v[56:59], v[170:171], v[6:7], v[56:59]
 v_mfma_f32_16x16x16_bf16 v[60:63], v[172:173], v[6:7], v[60:63]
 v_mfma_f32_16x16x16_bf16 v[64:67], v[174:175], v[6:7], v[64:67]
 v_mul_f32 v44, v44, v208
 v_mul_f32 v45, v45, v208
 v_mul_f32 v46, v46, v208
 v_mul_f32 v47, v47, v208
 v_mul_f32 v48, v48, v208
 v_mul_f32 v49, v49, v208
 v_mul_f32 v50, v50, v208
 v_mul_f32 v51, v51, v208
 v_cvt_pk_bf16_f32 v20, v44, v45
 v_cvt_pk_bf16_f32 v21, v46, v47
 v_cvt_pk_bf16_f32 v22, v48, v49
 v_cvt_pk_bf16_f32 v23, v50, v51
 s_add_u32 s24, s21, 0
 buffer_store_dwordx4 v[20:23], v2, s[4:7], s24 offen offset:0 sc1
 v_mfma_f32_16x16x16_bf16 v[68:71], v[176:177], v[6:7], v[68:71]
 v_mfma_f32_16x16x16_bf16 v[72:75], v[178:179], v[6:7], v[72:75]
 v_mul_f32 v52, v52, v208
 v_mul_f32 v53, v53, v208
 v_mul_f32 v54, v54, v208
 v_mul_f32 v55, v55, v208
 v_mul_f32 v56, v56, v208
 v_mul_f32 v57, v57, v208
 v_mul_f32 v58, v58, v208
 v_mul_f32 v59, v59, v208
 v_cvt_pk_bf16_f32 v24, v52, v53
 v_cvt_pk_bf16_f32 v25, v54, v55
 v_cvt_pk_bf16_f32 v26, v56, v57
 v_cvt_pk_bf16_f32 v27, v58, v59
 buffer_store_dwordx4 v[24:27], v2, s[4:7], s24 offen offset:2048 sc1
 v_mfma_f32_16x16x16_bf16 v[76:79], v[180:181], v[6:7], v[76:79]
 v_mfma_f32_16x16x16_bf16 v[80:83], v[182:183], v[6:7], v[80:83]
 v_mul_f32 v60, v60, v208
 v_mul_f32 v61, v61, v208
 v_mul_f32 v62, v62, v208
 v_mul_f32 v63, v63, v208
 v_mul_f32 v64, v64, v208
 v_mul_f32 v65, v65, v208
 v_mul_f32 v66, v66, v208
 v_mul_f32 v67, v67, v208
 v_cvt_pk_bf16_f32 v28, v60, v61
 v_cvt_pk_bf16_f32 v29, v62, v63
 v_cvt_pk_bf16_f32 v30, v64, v65
 v_cvt_pk_bf16_f32 v31, v66, v67
 s_add_u32 s24, s21, 4096
 buffer_store_dwordx4 v[28:31], v2, s[4:7], s24 offen offset:0 sc1
 v_mfma_f32_16x16x16_bf16 v[84:87], v[184:185], v[6:7], v[84:87]
 v_mfma_f32_16x16x16_bf16 v[88:91], v[186:187], v[6:7], v[88:91]
 v_mul_f32 v68, v68, v208
 v_mul_f32 v69, v69, v208
 v_mul_f32 v70, v70, v208
 v_mul_f32 v71, v71, v208
 v_mul_f32 v72, v72, v208
 v_mul_f32 v73, v73, v208
 v_mul_f32 v74, v74, v208
 v_mul_f32 v75, v75, v208
 v_cvt_pk_bf16_f32 v32, v68, v69
 v_cvt_pk_bf16_f32 v33, v70, v71
 v_cvt_pk_bf16_f32 v34, v72, v73
 v_cvt_pk_bf16_f32 v35, v74, v75
 buffer_store_dwordx4 v[32:35], v2, s[4:7], s24 offen offset:2048 sc1
 v_mul_f32 v76, v76, v208
 v_mul_f32 v77, v77, v208
 v_mul_f32 v78, v78, v208
 v_mul_f32 v79, v79, v208
 v_mul_f32 v80, v80, v208
 v_mul_f32 v81, v81, v208
 v_mul_f32 v82, v82, v208
 v_mul_f32 v83, v83, v208
 v_cvt_pk_bf16_f32 v36, v76, v77
 v_cvt_pk_bf16_f32 v37, v78, v79
 v_cvt_pk_bf16_f32 v38, v80, v81
 v_cvt_pk_bf16_f32 v39, v82, v83
 s_add_u32 s24, s21, 8192
 buffer_store_dwordx4 v[36:39], v2, s[4:7], s24 offen offset:0 sc1
 v_mul_f32 v84, v84, v208
 v_mul_f32 v85, v85, v208
 v_mul_f32 v86, v86, v208
 v_mul_f32 v87, v87, v208
 v_mul_f32 v88, v88, v208
 v_mul_f32 v89, v89, v208
 v_mul_f32 v90, v90, v208
 v_mul_f32 v91, v91, v208
 v_cvt_pk_bf16_f32 v40, v84, v85
 v_cvt_pk_bf16_f32 v41, v86, v87
 v_cvt_pk_bf16_f32 v42, v88, v89
 v_cvt_pk_bf16_f32 v43, v90, v91
 buffer_store_dwordx4 v[40:43], v2, s[4:7], s24 offen offset:2048 sc1
 s_waitcnt vmcnt(0)
 s_barrier
 s_cmp_eq_u32 s3, 0
 s_cbranch_scc0 Lbp_367
 s_mov_b64 exec, 1
 v_mov_b32 v3, s28
 buffer_store_dword v3, off, s[4:7], s30 sc1
 s_mov_b64 exec, -1
Lbp_367:
 s_mov_b32 s27, s28
 s_cmp_lt_u32 s27, 64
 s_cbranch_scc1 Lat_364
 s_endpgm
L_at_1:
Lat_368:
 s_add_u32 s28, s27, 1
 s_mul_i32 s29, s26, 9
 s_add_u32 s29, s29, s28
 s_mov_b32 s25, 0
Lw_369:
 s_add_u32 s25, s25, 1
 s_cmp_gt_u32 s25, 200000
 s_cbranch_scc1 L_fail
 buffer_load_dword v3, v4, s[4:7], 0 offen sc1
 s_waitcnt vmcnt(0)
 v_cmp_le_u32 vcc, s28, v3
 s_nop 0
 s_cmp_eq_u64 vcc, -1
 s_cbranch_scc0 Lw_369
 s_mul_i32 s20, s27, 393216
 s_add_u32 s21, s20, s32
 s_add_u32 s22, s20, s33
 s_add_u32 s23, s20, s34
 s_add_u32 s24, s21, 0
 buffer_load_dwordx4 v[20:23], v2, s[4:7], s24 offen offset:0 sc1
 buffer_load_dwordx4 v[24:27], v2, s[4:7], s24 offen offset:2048 sc1
 s_add_u32 s24, s21, 4096
 buffer_load_dwordx4 v[28:31], v2, s[4:7], s24 offen offset:0 sc1
 buffer_load_dwordx4 v[32:35], v2, s[4:7], s24 offen offset:2048 sc1
 s_add_u32 s24, s21, 8192
 buffer_load_dwordx4 v[36:39], v2, s[4:7], s24 offen offset:0 sc1
 buffer_load_dwordx4 v[40:43], v2, s[4:7], s24 offen offset:2048 sc1
 s_add_u32 s24, s22, 0
 buffer_load_dwordx4 v[44:47], v2, s[4:7], s24 offen offset:0 sc1
 buffer_load_dwordx4 v[48:51], v2, s[4:7], s24 offen offset:1024 sc1
 buffer_load_dwordx4 v[52:55], v2, s[4:7], s24 offen offset:2048 sc1
 buffer_load_dwordx4 v[56:59], v2, s[4:7], s24 offen offset:3072 sc1
 s_add_u32 s24, s22, 4096
 buffer_load_dwordx4 v[60:63], v2, s[4:7], s24 offen offset:0 sc1
 buffer_load_dwordx4 v[64:67], v2, s[4:7], s24 offen offset:1024 sc1
 buffer_load_dwordx4 v[68:71], v2, s[4:7], s24 offen offset:2048 sc1
 buffer_load_dwordx4 v[72:75], v2, s[4:7], s24 offen offset:3072 sc1
 s_add_u32 s24, s22, 8192
 buffer_load_dwordx4 v[76:79], v2, s[4:7], s24 offen offset:0 sc1
 buffer_load_dwordx4 v[80:83], v2, s[4:7], s24 offen offset:1024 sc1
 buffer_load_dwordx4 v[84:87], v2, s[4:7], s24 offen offset:2048 sc1
 buffer_load_dwordx4 v[88:91], v2, s[4:7], s24 offen offset:3072 sc1
 s_add_u32 s24, s23, 0
 buffer_load_dwordx4 v[92:95], v2, s[4:7], s24 offen offset:0 sc1
 buffer_load_dwordx4 v[96:99], v2, s[4:7], s24 offen offset:1024 sc1
 buffer_load_dwordx4 v[100:103], v2, s[4:7], s24 offen offset:2048 sc1
 buffer_load_dwordx4 v[104:107], v2, s[4:7], s24 offen offset:3072 sc1
 s_add_u32 s24, s23, 4096
 buffer_load_dwordx4 v[108:111], v2, s[4:7], s24 offen offset:0 sc1
 buffer_load_dwordx4 v[112:115], v2, s[4:7], s24 offen offset:1024 sc1
 buffer_load_dwordx4 v[116:119], v2, s[4:7], s24 offen offset:2048 sc1
 buffer_load_dwordx4 v[120:123], v2, s[4:7], s24 offen offset:3072 sc1
 s_add_u32 s24, s23, 8192
 buffer_load_dwordx4 v[124:127], v2, s[4:7], s24 offen offset:0 sc1
 buffer_load_dwordx4 v[128:131], v2, s[4:7], s24 offen offset:1024 sc1
 buffer_load_dwordx4 v[132:135], v2, s[4:7], s24 offen offset:2048 sc1
 buffer_load_dwordx4 v[136:139], v2, s[4:7], s24 offen offset:3072 sc1
 s_waitcnt vmcnt(12)
 v_mfma_f32_16x16x32_bf16 v[188:191], v[44:47], v[20:23], 0
 v_mfma_f32_16x16x32_bf16 v[192:195], v[48:51], v[20:23], v[8:11]
 v_mfma_f32_16x16x32_bf16 v[188:191], v[52:55], v[24:27], v[188:191]
 v_mfma_f32_16x16x32_bf16 v[192:195], v[56:59], v[24:27], v[192:195]
 v_mfma_f32_16x16x32_bf16 v[188:191], v[60:63], v[28:31], v[188:191]
 v_mfma_f32_16x16x32_bf16 v[192:195], v[64:67], v[28:31], v[192:195]
 v_mfma_f32_16x16x32_bf16 v[188:191], v[68:71], v[32:35], v[188:191]
 v_mfma_f32_16x16x32_bf16 v[192:195], v[72:75], v[32:35], v[192:195]
 v_mfma_f32_16x16x32_bf16 v[188:191], v[76:79], v[36:39], v[188:191]
 v_mfma_f32_16x16x32_bf16 v[192:195], v[80:83], v[36:39], v[192:195]
 v_mfma_f32_16x16x32_bf16 v[188:191], v[84:87], v[40:43], v[188:191]
 v_mfma_f32_16x16x32_bf16 v[192:195], v[88:91], v[40:43], v[192:195]
 s_mov_b32 s25, 0
Lw_370:
 s_add_u32 s25, s25, 1
 s_cmp_gt_u32 s25, 200000
 s_cbranch_scc1 L_fail
 buffer_load_dword v3, v5, s[4:7], 0 offen sc1
 s_waitcnt vmcnt(0)
 v_cmp_le_u32 vcc, s29, v3
 s_nop 0
 s_cmp_eq_u64 vcc, -1
 s_cbranch_scc0 Lw_370
 s_mul_i32 s21, s27, 196608
 s_add_u32 s21, s21, s36
 s_add_u32 s22, s21, 15728640
 s_add_u32 s24, s21, 0
 buffer_load_dwordx4 v[140:143], v2, s[4:7], s24 offen offset:0 sc1
 buffer_load_dwordx4 v[144:147], v2, s[4:7], s24 offen offset:1024 sc1
 buffer_load_dwordx4 v[148:151], v2, s[4:7], s24 offen offset:2048 sc1
 buffer_load_dwordx4 v[152:155], v2, s[4:7], s24 offen offset:3072 sc1
 s_add_u32 s24, s21, 4096
 buffer_load_dwordx4 v[156:159], v2, s[4:7], s24 offen offset:0 sc1
 buffer_load_dwordx4 v[160:163], v2, s[4:7], s24 offen offset:1024 sc1
 s_add_u32 s24, s22, 0
 buffer_load_dwordx4 v[164:167], v2, s[4:7], s24 offen offset:0 sc1
 buffer_load_dwordx4 v[168:171], v2, s[4:7], s24 offen offset:1024 sc1
 buffer_load_dwordx4 v[172:175], v2, s[4:7], s24 offen offset:2048 sc1
 buffer_load_dwordx4 v[176:179], v2, s[4:7], s24 offen offset:3072 sc1
 s_add_u32 s24, s22, 4096
 buffer_load_dwordx4 v[180:183], v2, s[4:7], s24 offen offset:0 sc1
 buffer_load_dwordx4 v[184:187], v2, s[4:7], s24 offen offset:1024 sc1
 s_waitcnt vmcnt(11)
 v_mfma_f32_16x16x32_bf16 v[196:199], v[140:143], v[20:23], v[12:15]
 s_waitcnt vmcnt(10)
 v_mfma_f32_16x16x32_bf16 v[196:199], v[144:147], v[24:27], v[196:199]
 s_waitcnt vmcnt(9)
 v_mfma_f32_16x16x32_bf16 v[196:199], v[148:151], v[28:31], v[196:199]
 s_waitcnt vmcnt(8)
 v_mfma_f32_16x16x32_bf16 v[196:199], v[152:155], v[32:35], v[196:199]
 s_waitcnt vmcnt(7)
 v_mfma_f32_16x16x32_bf16 v[196:199], v[156:159], v[36:39], v[196:199]
 s_waitcnt vmcnt(6)
 v_mfma_f32_16x16x32_bf16 v[196:199], v[160:163], v[40:43], v[196:199]
 v_max3_f32 v1, v188, v189, v190
 v_max3_f32 v1, v1, v192, v193
 v_max3_f32 v1, v1, v194, v195
 s_nop 4
 v_max3_f32 v208, v191, v196, v197
 v_max3_f32 v1, v1, v198, v199
 v_max_f32 v1, v1, v208
 v_mov_b32 v208, v1
 s_nop 1
 v_permlane32_swap_b32 v1, v208
 v_max_f32 v1, v1, v208
 v_mov_b32 v208, v1
 s_nop 1
 v_permlane16_swap_b32 v1, v208
 v_max_f32 v1, v1, v208
 v_mul_f32 v1, s31, v1
 v_fma_f32 v188, v188, s31, -v1
 v_fma_f32 v189, v189, s31, -v1
 v_fma_f32 v190, v190, s31, -v1
 v_fma_f32 v191, v191, s31, -v1
 v_fma_f32 v192, v192, s31, -v1
 v_fma_f32 v193, v193, s31, -v1
 v_fma_f32 v194, v194, s31, -v1
 v_fma_f32 v195, v195, s31, -v1
 v_fma_f32 v196, v196, s31, -v1
 v_fma_f32 v197, v197, s31, -v1
 v_fma_f32 v198, v198, s31, -v1
 v_fma_f32 v199, v199, s31, -v1
 v_exp_f32 v188, v188
 v_exp_f32 v189, v189
 v_exp_f32 v190, v190
 v_exp_f32 v191, v191
 v_exp_f32 v192, v192
 v_exp_f32 v193, v193
 v_exp_f32 v194, v194
 v_exp_f32 v195, v195
 v_exp_f32 v196, v196
 v_exp_f32 v197, v197
 v_exp_f32 v198, v198
 v_exp_f32 v199, v199
 v_cvt_pk_bf16_f32 v200, v188, v189
 v_cvt_pk_bf16_f32 v201, v190, v191
 v_cvt_pk_bf16_f32 v202, v192, v193
 v_cvt_pk_bf16_f32 v203, v194, v195
 v_cvt_pk_bf16_f32 v6, v196, v197
 v_cvt_pk_bf16_f32 v7, v198, v199
 v_mfma_f32_16x16x32_bf16 v[204:207], v[16:19], v[200:203], 0
 v_mfma_f32_16x16x32_bf16 v[44:47], v[92:95], v[200:203], 0
 v_mfma_f32_16x16x32_bf16 v[48:51], v[96:99], v[200:203], 0
 v_mfma_f32_16x16x16_bf16 v[204:207], v[16:17], v[6:7], v[204:207]
 v_mfma_f32_16x16x32_bf16 v[52:55], v[100:103], v[200:203], 0
 v_mfma_f32_16x16x32_bf16 v[56:59], v[104:107], v[200:203], 0
 v_mfma_f32_16x16x32_bf16 v[60:63], v[108:111], v[200:203], 0
 v_mfma_f32_16x16x32_bf16 v[64:67], v[112:115], v[200:203], 0
 v_rcp_f32 v208, v204
 s_add_u32 s21, s20, s35
 s_waitcnt vmcnt(0)
 v_mfma_f32_16x16x32_bf16 v[68:71], v[116:119], v[200:203], 0
 v_mfma_f32_16x16x32_bf16 v[72:75], v[120:123], v[200:203], 0
 v_mfma_f32_16x16x32_bf16 v[76:79], v[124:127], v[200:203], 0
 v_mfma_f32_16x16x32_bf16 v[80:83], v[128:131], v[200:203], 0
 v_mfma_f32_16x16x32_bf16 v[84:87], v[132:135], v[200:203], 0
 v_mfma_f32_16x16x32_bf16 v[88:91], v[136:139], v[200:203], 0
 v_mfma_f32_16x16x16_bf16 v[44:47], v[164:165], v[6:7], v[44:47]
 v_mfma_f32_16x16x16_bf16 v[48:51], v[166:167], v[6:7], v[48:51]
 v_mfma_f32_16x16x16_bf16 v[52:55], v[168:169], v[6:7], v[52:55]
 v_mfma_f32_16x16x16_bf16 v[56:59], v[170:171], v[6:7], v[56:59]
 v_mfma_f32_16x16x16_bf16 v[60:63], v[172:173], v[6:7], v[60:63]
 v_mfma_f32_16x16x16_bf16 v[64:67], v[174:175], v[6:7], v[64:67]
 v_mul_f32 v44, v44, v208
 v_mul_f32 v45, v45, v208
 v_mul_f32 v46, v46, v208
 v_mul_f32 v47, v47, v208
 v_mul_f32 v48, v48, v208
 v_mul_f32 v49, v49, v208
 v_mul_f32 v50, v50, v208
 v_mul_f32 v51, v51, v208
 v_cvt_pk_bf16_f32 v20, v44, v45
 v_cvt_pk_bf16_f32 v21, v46, v47
 v_cvt_pk_bf16_f32 v22, v48, v49
 v_cvt_pk_bf16_f32 v23, v50, v51
 s_add_u32 s24, s21, 0
 buffer_store_dwordx4 v[20:23], v2, s[4:7], s24 offen offset:0 sc1
 v_mfma_f32_16x16x16_bf16 v[68:71], v[176:177], v[6:7], v[68:71]
 v_mfma_f32_16x16x16_bf16 v[72:75], v[178:179], v[6:7], v[72:75]
 v_mul_f32 v52, v52, v208
 v_mul_f32 v53, v53, v208
 v_mul_f32 v54, v54, v208
 v_mul_f32 v55, v55, v208
 v_mul_f32 v56, v56, v208
 v_mul_f32 v57, v57, v208
 v_mul_f32 v58, v58, v208
 v_mul_f32 v59, v59, v208
 v_cvt_pk_bf16_f32 v24, v52, v53
 v_cvt_pk_bf16_f32 v25, v54, v55
 v_cvt_pk_bf16_f32 v26, v56, v57
 v_cvt_pk_bf16_f32 v27, v58, v59
 buffer_store_dwordx4 v[24:27], v2, s[4:7], s24 offen offset:2048 sc1
 v_mfma_f32_16x16x16_bf16 v[76:79], v[180:181], v[6:7], v[76:79]
 v_mfma_f32_16x16x16_bf16 v[80:83], v[182:183], v[6:7], v[80:83]
 v_mul_f32 v60, v60, v208
 v_mul_f32 v61, v61, v208
 v_mul_f32 v62, v62, v208
 v_mul_f32 v63, v63, v208
 v_mul_f32 v64, v64, v208
 v_mul_f32 v65, v65, v208
 v_mul_f32 v66, v66, v208
 v_mul_f32 v67, v67, v208
 v_cvt_pk_bf16_f32 v28, v60, v61
 v_cvt_pk_bf16_f32 v29, v62, v63
 v_cvt_pk_bf16_f32 v30, v64, v65
 v_cvt_pk_bf16_f32 v31, v66, v67
 s_add_u32 s24, s21, 4096
 buffer_store_dwordx4 v[28:31], v2, s[4:7], s24 offen offset:0 sc1
 v_mfma_f32_16x16x16_bf16 v[84:87], v[184:185], v[6:7], v[84:87]
 v_mfma_f32_16x16x16_bf16 v[88:91], v[186:187], v[6:7], v[88:91]
 v_mul_f32 v68, v68, v208
 v_mul_f32 v69, v69, v208
 v_mul_f32 v70, v70, v208
 v_mul_f32 v71, v71, v208
 v_mul_f32 v72, v72, v208
 v_mul_f32 v73, v73, v208
 v_mul_f32 v74, v74, v208
 v_mul_f32 v75, v75, v208
 v_cvt_pk_bf16_f32 v32, v68, v69
 v_cvt_pk_bf16_f32 v33, v70, v71
 v_cvt_pk_bf16_f32 v34, v72, v73
 v_cvt_pk_bf16_f32 v35, v74, v75
 buffer_store_dwordx4 v[32:35], v2, s[4:7], s24 offen offset:2048 sc1
 v_mul_f32 v76, v76, v208
 v_mul_f32 v77, v77, v208
 v_mul_f32 v78, v78, v208
 v_mul_f32 v79, v79, v208
 v_mul_f32 v80, v80, v208
 v_mul_f32 v81, v81, v208
 v_mul_f32 v82, v82, v208
 v_mul_f32 v83, v83, v208
 v_cvt_pk_bf16_f32 v36, v76, v77
 v_cvt_pk_bf16_f32 v37, v78, v79
 v_cvt_pk_bf16_f32 v38, v80, v81
 v_cvt_pk_bf16_f32 v39, v82, v83
 s_add_u32 s24, s21, 8192
 buffer_store_dwordx4 v[36:39], v2, s[4:7], s24 offen offset:0 sc1
 v_mul_f32 v84, v84, v208
 v_mul_f32 v85, v85, v208
 v_mul_f32 v86, v86, v208
 v_mul_f32 v87, v87, v208
 v_mul_f32 v88, v88, v208
 v_mul_f32 v89, v89, v208
 v_mul_f32 v90, v90, v208
 v_mul_f32 v91, v91, v208
 v_cvt_pk_bf16_f32 v40, v84, v85
 v_cvt_pk_bf16_f32 v41, v86, v87
 v_cvt_pk_bf16_f32 v42, v88, v89
 v_cvt_pk_bf16_f32 v43, v90, v91
 buffer_store_dwordx4 v[40:43], v2, s[4:7], s24 offen offset:2048 sc1
 s_waitcnt vmcnt(0)
 s_barrier
 s_cmp_eq_u32 s3, 0
 s_cbranch_scc0 Lbp_371
 s_mov_b64 exec, 1
 v_mov_b32 v3, s28
 buffer_store_dword v3, off, s[4:7], s30 sc1
 s_mov_b64 exec, -1
Lbp_371:
 s_mov_b32 s27, s28
 s_cmp_lt_u32 s27, 64
 s_cbranch_scc1 Lat_368
 s_endpgm
L_role_gu:
 s_sub_u32 s12, s12, 208
 v_and_b32 v1, 63, v0
 v_lshlrev_b32 v2, 4, v1
 s_load_dwordx4 s[36:39], s[0:1], 64
 s_cmp_ge_u32 s12, 12
 s_cselect_b32 s25, 1, 0
 s_mul_i32 s19, s25, 12
 s_sub_u32 s19, s12, s19
 s_lshl_b32 s26, s19, 2
 s_add_u32 s26, s26, s3
 s_lshl_b32 s27, s25, 6
 s_add_u32 s27, s27, s19
 s_lshl_b32 s27, s27, 7
 s_add_u32 s27, s27, 204800
 s_lshl_b32 s23, s26, 6
 s_waitcnt lgkmcnt(0)
 s_mov_b32 s28, s36
 s_mov_b32 s29, s37
 s_mov_b32 s30, 1966080
 s_mov_b32 s31, 0x20000
 s_mov_b32 s32, s38
 s_mov_b32 s33, s39
 s_mov_b32 s34, 1966080
 s_mov_b32 s35, 0x20000
 v_lshrrev_b32 v68, 2, v1
 v_mul_u32_u24 v68, 3072, v68
 v_and_b32 v3, 3, v1
 v_lshl_add_u32 v68, v3, 4, v68
 v_lshrrev_b32 v69, 4, v1
 v_lshlrev_b32 v69, 3, v69
 v_bfe_u32 v3, v1, 2, 2
 v_add_u32 v69, v69, v3
 v_mul_u32_u24 v69, 64, v69
 v_and_b32 v3, 3, v1
 v_lshl_add_u32 v69, v3, 3, v69
 s_mul_i32 s19, s3, 40960
 s_add_u32 s19, s19, 0
 v_add_u32 v69, s19, v69
 v_lshrrev_b32 v70, 2, v1
 v_mul_u32_u24 v70, 3072, v70
 v_and_b32 v3, 3, v1
 v_lshl_add_u32 v70, v3, 4, v70
 v_lshrrev_b32 v71, 4, v1
 v_lshlrev_b32 v71, 3, v71
 v_bfe_u32 v3, v1, 2, 2
 v_add_u32 v71, v71, v3
 v_mul_u32_u24 v71, 64, v71
 v_and_b32 v3, 3, v1
 v_lshl_add_u32 v71, v3, 3, v71
 s_mul_i32 s19, s3, 40960
 s_add_u32 s19, s19, 10240
 v_add_u32 v71, s19, v71
 s_mul_i32 s19, s3, 40960
 s_add_u32 m0, s19, 0
 s_add_u32 s20, s23, 0
 buffer_load_dwordx4 v68, s[28:31], s20 offen lds
 s_add_u32 m0, s19, 1024
 s_add_u32 s20, s23, 49152
 buffer_load_dwordx4 v68, s[28:31], s20 offen lds
 s_add_u32 m0, s19, 2048
 s_add_u32 s20, s23, 98304
 buffer_load_dwordx4 v68, s[28:31], s20 offen lds
 s_add_u32 m0, s19, 3072
 s_add_u32 s20, s23, 147456
 buffer_load_dwordx4 v68, s[28:31], s20 offen lds
 s_add_u32 m0, s19, 4096
 s_add_u32 s20, s23, 196608
 buffer_load_dwordx4 v68, s[28:31], s20 offen lds
 s_add_u32 m0, s19, 5120
 s_add_u32 s20, s23, 245760
 buffer_load_dwordx4 v68, s[28:31], s20 offen lds
 s_add_u32 m0, s19, 6144
 s_add_u32 s20, s23, 294912
 buffer_load_dwordx4 v68, s[28:31], s20 offen lds
 s_add_u32 m0, s19, 7168
 s_add_u32 s20, s23, 344064
 buffer_load_dwordx4 v68, s[28:31], s20 offen lds
 s_add_u32 m0, s19, 8192
 s_add_u32 s20, s23, 393216
 buffer_load_dwordx4 v68, s[28:31], s20 offen lds
 s_add_u32 m0, s19, 9216
 s_add_u32 s20, s23, 442368
 buffer_load_dwordx4 v68, s[28:31], s20 offen lds
 s_add_u32 m0, s19, 10240
 s_add_u32 s20, s23, 0
 buffer_load_dwordx4 v70, s[32:35], s20 offen lds
 s_add_u32 m0, s19, 11264
 s_add_u32 s20, s23, 49152
 buffer_load_dwordx4 v70, s[32:35], s20 offen lds
 s_add_u32 m0, s19, 12288
 s_add_u32 s20, s23, 98304
 buffer_load_dwordx4 v70, s[32:35], s20 offen lds
 s_add_u32 m0, s19, 13312
 s_add_u32 s20, s23, 147456
 buffer_load_dwordx4 v70, s[32:35], s20 offen lds
 s_add_u32 m0, s19, 14336
 s_add_u32 s20, s23, 196608
 buffer_load_dwordx4 v70, s[32:35], s20 offen lds
 s_add_u32 m0, s19, 15360
 s_add_u32 s20, s23, 245760
 buffer_load_dwordx4 v70, s[32:35], s20 offen lds
 s_add_u32 m0, s19, 16384
 s_add_u32 s20, s23, 294912
 buffer_load_dwordx4 v70, s[32:35], s20 offen lds
 s_add_u32 m0, s19, 17408
 s_add_u32 s20, s23, 344064
 buffer_load_dwordx4 v70, s[32:35], s20 offen lds
 s_add_u32 m0, s19, 18432
 s_add_u32 s20, s23, 393216
 buffer_load_dwordx4 v70, s[32:35], s20 offen lds
 s_add_u32 m0, s19, 19456
 s_add_u32 s20, s23, 442368
 buffer_load_dwordx4 v70, s[32:35], s20 offen lds
 s_mul_i32 s19, s3, 40960
 s_add_u32 m0, s19, 20480
 s_add_u32 s20, s23, 491520
 buffer_load_dwordx4 v68, s[28:31], s20 offen lds
 s_add_u32 m0, s19, 21504
 s_add_u32 s20, s23, 540672
 buffer_load_dwordx4 v68, s[28:31], s20 offen lds
 s_add_u32 m0, s19, 22528
 s_add_u32 s20, s23, 589824
 buffer_load_dwordx4 v68, s[28:31], s20 offen lds
 s_add_u32 m0, s19, 23552
 s_add_u32 s20, s23, 638976
 buffer_load_dwordx4 v68, s[28:31], s20 offen lds
 s_add_u32 m0, s19, 24576
 s_add_u32 s20, s23, 688128
 buffer_load_dwordx4 v68, s[28:31], s20 offen lds
 s_add_u32 m0, s19, 25600
 s_add_u32 s20, s23, 737280
 buffer_load_dwordx4 v68, s[28:31], s20 offen lds
 s_add_u32 m0, s19, 26624
 s_add_u32 s20, s23, 786432
 buffer_load_dwordx4 v68, s[28:31], s20 offen lds
 s_add_u32 m0, s19, 27648
 s_add_u32 s20, s23, 835584
 buffer_load_dwordx4 v68, s[28:31], s20 offen lds
 s_add_u32 m0, s19, 28672
 s_add_u32 s20, s23, 884736
 buffer_load_dwordx4 v68, s[28:31], s20 offen lds
 s_add_u32 m0, s19, 29696
 s_add_u32 s20, s23, 933888
 buffer_load_dwordx4 v68, s[28:31], s20 offen lds
 s_add_u32 m0, s19, 30720
 s_add_u32 s20, s23, 491520
 buffer_load_dwordx4 v70, s[32:35], s20 offen lds
 s_add_u32 m0, s19, 31744
 s_add_u32 s20, s23, 540672
 buffer_load_dwordx4 v70, s[32:35], s20 offen lds
 s_add_u32 m0, s19, 32768
 s_add_u32 s20, s23, 589824
 buffer_load_dwordx4 v70, s[32:35], s20 offen lds
 s_add_u32 m0, s19, 33792
 s_add_u32 s20, s23, 638976
 buffer_load_dwordx4 v70, s[32:35], s20 offen lds
 s_add_u32 m0, s19, 34816
 s_add_u32 s20, s23, 688128
 buffer_load_dwordx4 v70, s[32:35], s20 offen lds
 s_add_u32 m0, s19, 35840
 s_add_u32 s20, s23, 737280
 buffer_load_dwordx4 v70, s[32:35], s20 offen lds
 s_add_u32 m0, s19, 36864
 s_add_u32 s20, s23, 786432
 buffer_load_dwordx4 v70, s[32:35], s20 offen lds
 s_add_u32 m0, s19, 37888
 s_add_u32 s20, s23, 835584
 buffer_load_dwordx4 v70, s[32:35], s20 offen lds
 s_add_u32 m0, s19, 38912
 s_add_u32 s20, s23, 884736
 buffer_load_dwordx4 v70, s[32:35], s20 offen lds
 s_add_u32 m0, s19, 39936
 s_add_u32 s20, s23, 933888
 buffer_load_dwordx4 v70, s[32:35], s20 offen lds
 s_waitcnt vmcnt(20)
 ds_read_b64_tr_b16 a[0:1], v69 offset:0
 ds_read_b64_tr_b16 a[2:3], v69 offset:256
 ds_read_b64_tr_b16 a[80:81], v69 offset:32
 ds_read_b64_tr_b16 a[82:83], v69 offset:288
 ds_read_b64_tr_b16 a[160:161], v71 offset:0
 ds_read_b64_tr_b16 a[162:163], v71 offset:256
 ds_read_b64_tr_b16 a[240:241], v71 offset:32
 ds_read_b64_tr_b16 a[242:243], v71 offset:288
 ds_read_b64_tr_b16 a[4:5], v69 offset:2048
 ds_read_b64_tr_b16 a[6:7], v69 offset:2304
 ds_read_b64_tr_b16 a[84:85], v69 offset:2080
 ds_read_b64_tr_b16 a[86:87], v69 offset:2336
 ds_read_b64_tr_b16 a[164:165], v71 offset:2048
 ds_read_b64_tr_b16 a[166:167], v71 offset:2304
 ds_read_b64_tr_b16 a[244:245], v71 offset:2080
 ds_read_b64_tr_b16 a[246:247], v71 offset:2336
 ds_read_b64_tr_b16 a[8:9], v69 offset:4096
 ds_read_b64_tr_b16 a[10:11], v69 offset:4352
 ds_read_b64_tr_b16 a[88:89], v69 offset:4128
 ds_read_b64_tr_b16 a[90:91], v69 offset:4384
 ds_read_b64_tr_b16 a[168:169], v71 offset:4096
 ds_read_b64_tr_b16 a[170:171], v71 offset:4352
 ds_read_b64_tr_b16 a[248:249], v71 offset:4128
 ds_read_b64_tr_b16 a[250:251], v71 offset:4384
 ds_read_b64_tr_b16 a[12:13], v69 offset:6144
 ds_read_b64_tr_b16 a[14:15], v69 offset:6400
 ds_read_b64_tr_b16 a[92:93], v69 offset:6176
 ds_read_b64_tr_b16 a[94:95], v69 offset:6432
 ds_read_b64_tr_b16 a[172:173], v71 offset:6144
 ds_read_b64_tr_b16 a[174:175], v71 offset:6400
 ds_read_b64_tr_b16 a[252:253], v71 offset:6176
 ds_read_b64_tr_b16 a[254:255], v71 offset:6432
 ds_read_b64_tr_b16 a[16:17], v69 offset:8192
 ds_read_b64_tr_b16 a[18:19], v69 offset:8448
 ds_read_b64_tr_b16 a[96:97], v69 offset:8224
 ds_read_b64_tr_b16 a[98:99], v69 offset:8480
 ds_read_b64_tr_b16 a[176:177], v71 offset:8192
 ds_read_b64_tr_b16 a[178:179], v71 offset:8448
 ds_read_b64_tr_b16 v[4:5], v71 offset:8224
 ds_read_b64_tr_b16 v[6:7], v71 offset:8480
 s_waitcnt lgkmcnt(0)
 s_mul_i32 s19, s3, 40960
 s_add_u32 m0, s19, 0
 s_add_u32 s20, s23, 983040
 buffer_load_dwordx4 v68, s[28:31], s20 offen lds
 s_add_u32 m0, s19, 1024
 s_add_u32 s20, s23, 1032192
 buffer_load_dwordx4 v68, s[28:31], s20 offen lds
 s_add_u32 m0, s19, 2048
 s_add_u32 s20, s23, 1081344
 buffer_load_dwordx4 v68, s[28:31], s20 offen lds
 s_add_u32 m0, s19, 3072
 s_add_u32 s20, s23, 1130496
 buffer_load_dwordx4 v68, s[28:31], s20 offen lds
 s_add_u32 m0, s19, 4096
 s_add_u32 s20, s23, 1179648
 buffer_load_dwordx4 v68, s[28:31], s20 offen lds
 s_add_u32 m0, s19, 5120
 s_add_u32 s20, s23, 1228800
 buffer_load_dwordx4 v68, s[28:31], s20 offen lds
 s_add_u32 m0, s19, 6144
 s_add_u32 s20, s23, 1277952
 buffer_load_dwordx4 v68, s[28:31], s20 offen lds
 s_add_u32 m0, s19, 7168
 s_add_u32 s20, s23, 1327104
 buffer_load_dwordx4 v68, s[28:31], s20 offen lds
 s_add_u32 m0, s19, 8192
 s_add_u32 s20, s23, 1376256
 buffer_load_dwordx4 v68, s[28:31], s20 offen lds
 s_add_u32 m0, s19, 9216
 s_add_u32 s20, s23, 1425408
 buffer_load_dwordx4 v68, s[28:31], s20 offen lds
 s_add_u32 m0, s19, 10240
 s_add_u32 s20, s23, 983040
 buffer_load_dwordx4 v70, s[32:35], s20 offen lds
 s_add_u32 m0, s19, 11264
 s_add_u32 s20, s23, 1032192
 buffer_load_dwordx4 v70, s[32:35], s20 offen lds
 s_add_u32 m0, s19, 12288
 s_add_u32 s20, s23, 1081344
 buffer_load_dwordx4 v70, s[32:35], s20 offen lds
 s_add_u32 m0, s19, 13312
 s_add_u32 s20, s23, 1130496
 buffer_load_dwordx4 v70, s[32:35], s20 offen lds
 s_add_u32 m0, s19, 14336
 s_add_u32 s20, s23, 1179648
 buffer_load_dwordx4 v70, s[32:35], s20 offen lds
 s_add_u32 m0, s19, 15360
 s_add_u32 s20, s23, 1228800
 buffer_load_dwordx4 v70, s[32:35], s20 offen lds
 s_add_u32 m0, s19, 16384
 s_add_u32 s20, s23, 1277952
 buffer_load_dwordx4 v70, s[32:35], s20 offen lds
 s_add_u32 m0, s19, 17408
 s_add_u32 s20, s23, 1327104
 buffer_load_dwordx4 v70, s[32:35], s20 offen lds
 s_add_u32 m0, s19, 18432
 s_add_u32 s20, s23, 1376256
 buffer_load_dwordx4 v70, s[32:35], s20 offen lds
 s_add_u32 m0, s19, 19456
 s_add_u32 s20, s23, 1425408
 buffer_load_dwordx4 v70, s[32:35], s20 offen lds
 s_waitcnt vmcnt(20)
 ds_read_b64_tr_b16 a[20:21], v69 offset:20480
 ds_read_b64_tr_b16 a[22:23], v69 offset:20736
 ds_read_b64_tr_b16 a[100:101], v69 offset:20512
 ds_read_b64_tr_b16 a[102:103], v69 offset:20768
 ds_read_b64_tr_b16 a[180:181], v71 offset:20480
 ds_read_b64_tr_b16 a[182:183], v71 offset:20736
 ds_read_b64_tr_b16 v[8:9], v71 offset:20512
 ds_read_b64_tr_b16 v[10:11], v71 offset:20768
 ds_read_b64_tr_b16 a[24:25], v69 offset:22528
 ds_read_b64_tr_b16 a[26:27], v69 offset:22784
 ds_read_b64_tr_b16 a[104:105], v69 offset:22560
 ds_read_b64_tr_b16 a[106:107], v69 offset:22816
 ds_read_b64_tr_b16 a[184:185], v71 offset:22528
 ds_read_b64_tr_b16 a[186:187], v71 offset:22784
 ds_read_b64_tr_b16 v[12:13], v71 offset:22560
 ds_read_b64_tr_b16 v[14:15], v71 offset:22816
 ds_read_b64_tr_b16 a[28:29], v69 offset:24576
 ds_read_b64_tr_b16 a[30:31], v69 offset:24832
 ds_read_b64_tr_b16 a[108:109], v69 offset:24608
 ds_read_b64_tr_b16 a[110:111], v69 offset:24864
 ds_read_b64_tr_b16 a[188:189], v71 offset:24576
 ds_read_b64_tr_b16 a[190:191], v71 offset:24832
 ds_read_b64_tr_b16 v[16:17], v71 offset:24608
 ds_read_b64_tr_b16 v[18:19], v71 offset:24864
 ds_read_b64_tr_b16 a[32:33], v69 offset:26624
 ds_read_b64_tr_b16 a[34:35], v69 offset:26880
 ds_read_b64_tr_b16 a[112:113], v69 offset:26656
 ds_read_b64_tr_b16 a[114:115], v69 offset:26912
 ds_read_b64_tr_b16 a[192:193], v71 offset:26624
 ds_read_b64_tr_b16 a[194:195], v71 offset:26880
 ds_read_b64_tr_b16 v[20:21], v71 offset:26656
 ds_read_b64_tr_b16 v[22:23], v71 offset:26912
 ds_read_b64_tr_b16 a[36:37], v69 offset:28672
 ds_read_b64_tr_b16 a[38:39], v69 offset:28928
 ds_read_b64_tr_b16 a[116:117], v69 offset:28704
 ds_read_b64_tr_b16 a[118:119], v69 offset:28960
 ds_read_b64_tr_b16 a[196:197], v71 offset:28672
 ds_read_b64_tr_b16 a[198:199], v71 offset:28928
 ds_read_b64_tr_b16 v[24:25], v71 offset:28704
 ds_read_b64_tr_b16 v[26:27], v71 offset:28960
 s_waitcnt lgkmcnt(0)
 s_mul_i32 s19, s3, 40960
 s_add_u32 m0, s19, 20480
 s_add_u32 s20, s23, 1474560
 buffer_load_dwordx4 v68, s[28:31], s20 offen lds
 s_add_u32 m0, s19, 21504
 s_add_u32 s20, s23, 1523712
 buffer_load_dwordx4 v68, s[28:31], s20 offen lds
 s_add_u32 m0, s19, 22528
 s_add_u32 s20, s23, 1572864
 buffer_load_dwordx4 v68, s[28:31], s20 offen lds
 s_add_u32 m0, s19, 23552
 s_add_u32 s20, s23, 1622016
 buffer_load_dwordx4 v68, s[28:31], s20 offen lds
 s_add_u32 m0, s19, 24576
 s_add_u32 s20, s23, 1671168
 buffer_load_dwordx4 v68, s[28:31], s20 offen lds
 s_add_u32 m0, s19, 25600
 s_add_u32 s20, s23, 1720320
 buffer_load_dwordx4 v68, s[28:31], s20 offen lds
 s_add_u32 m0, s19, 26624
 s_add_u32 s20, s23, 1769472
 buffer_load_dwordx4 v68, s[28:31], s20 offen lds
 s_add_u32 m0, s19, 27648
 s_add_u32 s20, s23, 1818624
 buffer_load_dwordx4 v68, s[28:31], s20 offen lds
 s_add_u32 m0, s19, 28672
 s_add_u32 s20, s23, 1867776
 buffer_load_dwordx4 v68, s[28:31], s20 offen lds
 s_add_u32 m0, s19, 29696
 s_add_u32 s20, s23, 1916928
 buffer_load_dwordx4 v68, s[28:31], s20 offen lds
 s_add_u32 m0, s19, 30720
 s_add_u32 s20, s23, 1474560
 buffer_load_dwordx4 v70, s[32:35], s20 offen lds
 s_add_u32 m0, s19, 31744
 s_add_u32 s20, s23, 1523712
 buffer_load_dwordx4 v70, s[32:35], s20 offen lds
 s_add_u32 m0, s19, 32768
 s_add_u32 s20, s23, 1572864
 buffer_load_dwordx4 v70, s[32:35], s20 offen lds
 s_add_u32 m0, s19, 33792
 s_add_u32 s20, s23, 1622016
 buffer_load_dwordx4 v70, s[32:35], s20 offen lds
 s_add_u32 m0, s19, 34816
 s_add_u32 s20, s23, 1671168
 buffer_load_dwordx4 v70, s[32:35], s20 offen lds
 s_add_u32 m0, s19, 35840
 s_add_u32 s20, s23, 1720320
 buffer_load_dwordx4 v70, s[32:35], s20 offen lds
 s_add_u32 m0, s19, 36864
 s_add_u32 s20, s23, 1769472
 buffer_load_dwordx4 v70, s[32:35], s20 offen lds
 s_add_u32 m0, s19, 37888
 s_add_u32 s20, s23, 1818624
 buffer_load_dwordx4 v70, s[32:35], s20 offen lds
 s_add_u32 m0, s19, 38912
 s_add_u32 s20, s23, 1867776
 buffer_load_dwordx4 v70, s[32:35], s20 offen lds
 s_add_u32 m0, s19, 39936
 s_add_u32 s20, s23, 1916928
 buffer_load_dwordx4 v70, s[32:35], s20 offen lds
 s_waitcnt vmcnt(20)
 ds_read_b64_tr_b16 a[40:41], v69 offset:0
 ds_read_b64_tr_b16 a[42:43], v69 offset:256
 ds_read_b64_tr_b16 a[120:121], v69 offset:32
 ds_read_b64_tr_b16 a[122:123], v69 offset:288
 ds_read_b64_tr_b16 a[200:201], v71 offset:0
 ds_read_b64_tr_b16 a[202:203], v71 offset:256
 ds_read_b64_tr_b16 v[28:29], v71 offset:32
 ds_read_b64_tr_b16 v[30:31], v71 offset:288
 ds_read_b64_tr_b16 a[44:45], v69 offset:2048
 ds_read_b64_tr_b16 a[46:47], v69 offset:2304
 ds_read_b64_tr_b16 a[124:125], v69 offset:2080
 ds_read_b64_tr_b16 a[126:127], v69 offset:2336
 ds_read_b64_tr_b16 a[204:205], v71 offset:2048
 ds_read_b64_tr_b16 a[206:207], v71 offset:2304
 ds_read_b64_tr_b16 v[32:33], v71 offset:2080
 ds_read_b64_tr_b16 v[34:35], v71 offset:2336
 ds_read_b64_tr_b16 a[48:49], v69 offset:4096
 ds_read_b64_tr_b16 a[50:51], v69 offset:4352
 ds_read_b64_tr_b16 a[128:129], v69 offset:4128
 ds_read_b64_tr_b16 a[130:131], v69 offset:4384
 ds_read_b64_tr_b16 a[208:209], v71 offset:4096
 ds_read_b64_tr_b16 a[210:211], v71 offset:4352
 ds_read_b64_tr_b16 v[36:37], v71 offset:4128
 ds_read_b64_tr_b16 v[38:39], v71 offset:4384
 ds_read_b64_tr_b16 a[52:53], v69 offset:6144
 ds_read_b64_tr_b16 a[54:55], v69 offset:6400
 ds_read_b64_tr_b16 a[132:133], v69 offset:6176
 ds_read_b64_tr_b16 a[134:135], v69 offset:6432
 ds_read_b64_tr_b16 a[212:213], v71 offset:6144
 ds_read_b64_tr_b16 a[214:215], v71 offset:6400
 ds_read_b64_tr_b16 v[40:41], v71 offset:6176
 ds_read_b64_tr_b16 v[42:43], v71 offset:6432
 ds_read_b64_tr_b16 a[56:57], v69 offset:8192
 ds_read_b64_tr_b16 a[58:59], v69 offset:8448
 ds_read_b64_tr_b16 a[136:137], v69 offset:8224
 ds_read_b64_tr_b16 a[138:139], v69 offset:8480
 ds_read_b64_tr_b16 a[216:217], v71 offset:8192
 ds_read_b64_tr_b16 a[218:219], v71 offset:8448
 ds_read_b64_tr_b16 v[44:45], v71 offset:8224
 ds_read_b64_tr_b16 v[46:47], v71 offset:8480
 s_waitcnt lgkmcnt(0)
 s_waitcnt vmcnt(0)
 ds_read_b64_tr_b16 a[60:61], v69 offset:20480
 ds_read_b64_tr_b16 a[62:63], v69 offset:20736
 ds_read_b64_tr_b16 a[140:141], v69 offset:20512
 ds_read_b64_tr_b16 a[142:143], v69 offset:20768
 ds_read_b64_tr_b16 a[220:221], v71 offset:20480
 ds_read_b64_tr_b16 a[222:223], v71 offset:20736
 ds_read_b64_tr_b16 v[48:49], v71 offset:20512
 ds_read_b64_tr_b16 v[50:51], v71 offset:20768
 ds_read_b64_tr_b16 a[64:65], v69 offset:22528
 ds_read_b64_tr_b16 a[66:67], v69 offset:22784
 ds_read_b64_tr_b16 a[144:145], v69 offset:22560
 ds_read_b64_tr_b16 a[146:147], v69 offset:22816
 ds_read_b64_tr_b16 a[224:225], v71 offset:22528
 ds_read_b64_tr_b16 a[226:227], v71 offset:22784
 ds_read_b64_tr_b16 v[52:53], v71 offset:22560
 ds_read_b64_tr_b16 v[54:55], v71 offset:22816
 ds_read_b64_tr_b16 a[68:69], v69 offset:24576
 ds_read_b64_tr_b16 a[70:71], v69 offset:24832
 ds_read_b64_tr_b16 a[148:149], v69 offset:24608
 ds_read_b64_tr_b16 a[150:151], v69 offset:24864
 ds_read_b64_tr_b16 a[228:229], v71 offset:24576
 ds_read_b64_tr_b16 a[230:231], v71 offset:24832
 ds_read_b64_tr_b16 v[56:57], v71 offset:24608
 ds_read_b64_tr_b16 v[58:59], v71 offset:24864
 ds_read_b64_tr_b16 a[72:73], v69 offset:26624
 ds_read_b64_tr_b16 a[74:75], v69 offset:26880
 ds_read_b64_tr_b16 a[152:153], v69 offset:26656
 ds_read_b64_tr_b16 a[154:155], v69 offset:26912
 ds_read_b64_tr_b16 a[232:233], v71 offset:26624
 ds_read_b64_tr_b16 a[234:235], v71 offset:26880
 ds_read_b64_tr_b16 v[60:61], v71 offset:26656
 ds_read_b64_tr_b16 v[62:63], v71 offset:26912
 ds_read_b64_tr_b16 a[76:77], v69 offset:28672
 ds_read_b64_tr_b16 a[78:79], v69 offset:28928
 ds_read_b64_tr_b16 a[156:157], v69 offset:28704
 ds_read_b64_tr_b16 a[158:159], v69 offset:28960
 ds_read_b64_tr_b16 a[236:237], v71 offset:28672
 ds_read_b64_tr_b16 a[238:239], v71 offset:28928
 ds_read_b64_tr_b16 v[64:65], v71 offset:28704
 ds_read_b64_tr_b16 v[66:67], v71 offset:28960
 s_waitcnt lgkmcnt(0)
 s_barrier
 s_cmp_eq_u32 s13, 1
 s_cbranch_scc1 Lverok_373
 s_mov_b32 s18, 0
Lver_372:
 s_add_u32 s18, s18, 1
 s_cmp_gt_u32 s18, 200000
 s_cbranch_scc1 L_fail
 v_and_b32 v254, 7, v0
 v_lshlrev_b32 v254, 2, v254
 buffer_load_dword v255, v254, s[8:11], 0 offen sc1
 s_waitcnt vmcnt(0)
 v_cmp_eq_u32 vcc, 32, v255
 s_nop 0
 s_cmp_eq_u64 vcc, -1
 s_cbranch_scc1 Lverok_373
 s_mov_b32 s17, 0
 v_readlane_b32 s14, v255, 0
 s_nop 0
 s_add_u32 s17, s17, s14
 v_readlane_b32 s14, v255, 1
 s_nop 0
 s_add_u32 s17, s17, s14
 v_readlane_b32 s14, v255, 2
 s_nop 0
 s_add_u32 s17, s17, s14
 v_readlane_b32 s14, v255, 3
 s_nop 0
 s_add_u32 s17, s17, s14
 v_readlane_b32 s14, v255, 4
 s_nop 0
 s_add_u32 s17, s17, s14
 v_readlane_b32 s14, v255, 5
 s_nop 0
 s_add_u32 s17, s17, s14
 v_readlane_b32 s14, v255, 6
 s_nop 0
 s_add_u32 s17, s17, s14
 v_readlane_b32 s14, v255, 7
 s_nop 0
 s_add_u32 s17, s17, s14
 s_cmp_eq_u32 s17, 256
 s_cbranch_scc1 L_fallback
 s_branch Lver_372
Lverok_373:
 v_lshrrev_b32 v70, 3, v1
 s_lshl_b32 s19, s3, 3
 v_add_u32 v70, s19, v70
 v_bfe_u32 v71, v70, 1, 3
 v_mul_u32_u24 v70, 1280, v70
 v_and_b32 v3, 7, v1
 v_xor_b32 v3, v3, v71
 v_lshl_add_u32 v3, v3, 4, v70
 v_and_b32 v70, 15, v1
 v_bfe_u32 v71, v1, 1, 3
 v_lshrrev_b32 v68, 4, v1
 v_add_u32 v69, 4, v68
 v_xor_b32 v68, v68, v71
 v_xor_b32 v69, v69, v71
 v_lshlrev_b32 v70, 7, v70
 v_lshl_add_u32 v68, v68, 4, v70
 v_lshl_add_u32 v69, v69, 4, v70
 v_and_b32 v71, 3, v1
 v_lshlrev_b32 v71, 7, v71
 s_lshl_b32 s19, s25, 13
 s_add_u32 s19, s19, 188416
 v_add_u32 v71, s19, v71
 s_lshl_b32 s41, s3, 10
 s_mov_b32 s42, 0xbfb8aa3b
 s_xor_b32 s41, s41, 40960
 v_mov_b32 v136, 163776
 v_mov_b32 v137, 0
 ds_write_b32 v136, v137
 s_waitcnt lgkmcnt(0)
 s_barrier
 s_mov_b32 s44, 0
 s_mov_b32 s45, 1
 s_mul_i32 s40, s44, 40960
 s_add_u32 s40, s40, 190218240
 s_xor_b32 s41, s41, 40960
 s_mov_b32 s24, 0
 s_branch Lgus_380
Lguc_374:
 s_mov_b32 s24, 0
 s_waitcnt vmcnt(0)
 s_mov_b64 exec, 1
 v_mov_b32 v137, 1
 ds_add_rtn_u32 v137, v136, v137
 s_waitcnt lgkmcnt(0)
 v_readfirstlane_b32 s48, v137
 s_nop 0
 s_and_b32 s48, s48, 3
 s_cmp_eq_u32 s48, 3
 s_cbranch_scc0 Lar_382
 v_mov_b32 v137, s47
 buffer_store_dword v137, off, s[4:7], s27 sc1
Lar_382:
 s_mov_b64 exec, -1
 s_cmp_ge_u32 s44, 64
 s_cbranch_scc1 Lgud_379
Lgus_380:
 s_add_u32 s24, s24, 1
 s_cmp_gt_u32 s24, 200000
 s_cbranch_scc1 L_fail
 buffer_load_dword v70, v71, s[4:7], 0 offen sc1
 s_waitcnt vmcnt(0)
 v_cmp_le_u32 vcc, s45, v70
 s_nop 0
 s_cmp_eq_u64 vcc, -1
 s_cbranch_scc0 Lgus_380
Lgug_381:
 s_add_u32 m0, s41, 0
 s_nop 0
 buffer_load_dwordx4 v3, s[4:7], s40 offen offset:0 sc1 lds
 s_add_u32 m0, s41, 3968
 s_nop 0
 buffer_load_dwordx4 v3, s[4:7], s40 offen offset:128 sc1 lds
 s_add_u32 m0, s41, 7936
 s_nop 0
 buffer_load_dwordx4 v3, s[4:7], s40 offen offset:256 sc1 lds
 s_add_u32 m0, s41, 11904
 s_nop 0
 buffer_load_dwordx4 v3, s[4:7], s40 offen offset:384 sc1 lds
 s_add_u32 m0, s41, 15872
 s_nop 0
 buffer_load_dwordx4 v3, s[4:7], s40 offen offset:512 sc1 lds
 s_add_u32 m0, s41, 19840
 s_nop 0
 buffer_load_dwordx4 v3, s[4:7], s40 offen offset:640 sc1 lds
 s_add_u32 m0, s41, 23808
 s_nop 0
 buffer_load_dwordx4 v3, s[4:7], s40 offen offset:768 sc1 lds
 s_add_u32 m0, s41, 27776
 s_nop 0
 buffer_load_dwordx4 v3, s[4:7], s40 offen offset:896 sc1 lds
 s_add_u32 m0, s41, 31744
 s_nop 0
 buffer_load_dwordx4 v3, s[4:7], s40 offen offset:1024 sc1 lds
 s_add_u32 m0, s41, 35712
 s_nop 0
 buffer_load_dwordx4 v3, s[4:7], s40 offen offset:1152 sc1 lds
 s_mov_b32 s46, 0
 s_waitcnt vmcnt(9)
 s_barrier
 ds_read_b128 v[104:107], v68 offset:0
 ds_read_b128 v[108:111], v68 offset:2048
 ds_read_b128 v[112:115], v69 offset:0
 ds_read_b128 v[116:119], v69 offset:2048
 s_waitcnt vmcnt(7)
 s_barrier
 ds_read_b128 v[120:123], v68 offset:4096
 ds_read_b128 v[124:127], v68 offset:6144
 s_waitcnt lgkmcnt(5)
 v_mfma_f32_16x16x32_bf16 v[72:75], a[0:3], v[104:107], 0
 v_mfma_f32_16x16x32_bf16 v[80:83], a[80:83], v[104:107], 0
 v_mfma_f32_16x16x32_bf16 v[88:91], a[160:163], v[104:107], 0
 v_mfma_f32_16x16x32_bf16 v[96:99], a[240:243], v[104:107], 0
 s_waitcnt lgkmcnt(4)
 v_mfma_f32_16x16x32_bf16 v[76:79], a[0:3], v[108:111], 0
 v_mfma_f32_16x16x32_bf16 v[84:87], a[80:83], v[108:111], 0
 v_mfma_f32_16x16x32_bf16 v[92:95], a[160:163], v[108:111], 0
 v_mfma_f32_16x16x32_bf16 v[100:103], a[240:243], v[108:111], 0
 s_branch Lgum_377
Lguw_375:
 s_mov_b32 s46, 1
 s_waitcnt vmcnt(11)
 s_barrier
 ds_read_b128 v[104:107], v68 offset:0
 ds_read_b128 v[108:111], v68 offset:2048
 ds_read_b128 v[112:115], v69 offset:0
 ds_read_b128 v[116:119], v69 offset:2048
 s_waitcnt vmcnt(9)
 s_barrier
 ds_read_b128 v[120:123], v68 offset:4096
 ds_read_b128 v[124:127], v68 offset:6144
 s_waitcnt lgkmcnt(5)
 v_mfma_f32_16x16x32_bf16 v[72:75], a[0:3], v[104:107], 0
 v_mfma_f32_16x16x32_bf16 v[80:83], a[80:83], v[104:107], 0
 v_mfma_f32_16x16x32_bf16 v[88:91], a[160:163], v[104:107], 0
 v_mfma_f32_16x16x32_bf16 v[96:99], a[240:243], v[104:107], 0
 s_waitcnt lgkmcnt(4)
 v_mfma_f32_16x16x32_bf16 v[76:79], a[0:3], v[108:111], 0
 v_mfma_f32_16x16x32_bf16 v[84:87], a[80:83], v[108:111], 0
 v_mfma_f32_16x16x32_bf16 v[92:95], a[160:163], v[108:111], 0
 v_mfma_f32_16x16x32_bf16 v[100:103], a[240:243], v[108:111], 0
Lgum_377:
 ds_read_b128 v[104:107], v69 offset:4096
 ds_read_b128 v[108:111], v69 offset:6144
 s_waitcnt lgkmcnt(4)
 v_mfma_f32_16x16x32_bf16 v[72:75], a[4:7], v[112:115], v[72:75]
 v_mfma_f32_16x16x32_bf16 v[80:83], a[84:87], v[112:115], v[80:83]
 v_mfma_f32_16x16x32_bf16 v[88:91], a[164:167], v[112:115], v[88:91]
 v_mfma_f32_16x16x32_bf16 v[96:99], a[244:247], v[112:115], v[96:99]
 v_mfma_f32_16x16x32_bf16 v[76:79], a[4:7], v[116:119], v[76:79]
 v_mfma_f32_16x16x32_bf16 v[84:87], a[84:87], v[116:119], v[84:87]
 v_mfma_f32_16x16x32_bf16 v[92:95], a[164:167], v[116:119], v[92:95]
 v_mfma_f32_16x16x32_bf16 v[100:103], a[244:247], v[116:119], v[100:103]
 ds_read_b128 v[112:115], v68 offset:8192
 ds_read_b128 v[116:119], v68 offset:10240
 s_waitcnt lgkmcnt(4)
 v_mfma_f32_16x16x32_bf16 v[72:75], a[8:11], v[120:123], v[72:75]
 v_mfma_f32_16x16x32_bf16 v[80:83], a[88:91], v[120:123], v[80:83]
 v_mfma_f32_16x16x32_bf16 v[88:91], a[168:171], v[120:123], v[88:91]
 v_mfma_f32_16x16x32_bf16 v[96:99], a[248:251], v[120:123], v[96:99]
 v_mfma_f32_16x16x32_bf16 v[76:79], a[8:11], v[124:127], v[76:79]
 v_mfma_f32_16x16x32_bf16 v[84:87], a[88:91], v[124:127], v[84:87]
 v_mfma_f32_16x16x32_bf16 v[92:95], a[168:171], v[124:127], v[92:95]
 v_mfma_f32_16x16x32_bf16 v[100:103], a[248:251], v[124:127], v[100:103]
 ds_read_b128 v[120:123], v69 offset:8192
 ds_read_b128 v[124:127], v69 offset:10240
 s_waitcnt lgkmcnt(4)
 v_mfma_f32_16x16x32_bf16 v[72:75], a[12:15], v[104:107], v[72:75]
 v_mfma_f32_16x16x32_bf16 v[80:83], a[92:95], v[104:107], v[80:83]
 v_mfma_f32_16x16x32_bf16 v[88:91], a[172:175], v[104:107], v[88:91]
 v_mfma_f32_16x16x32_bf16 v[96:99], a[252:255], v[104:107], v[96:99]
 v_mfma_f32_16x16x32_bf16 v[76:79], a[12:15], v[108:111], v[76:79]
 v_mfma_f32_16x16x32_bf16 v[84:87], a[92:95], v[108:111], v[84:87]
 v_mfma_f32_16x16x32_bf16 v[92:95], a[172:175], v[108:111], v[92:95]
 v_mfma_f32_16x16x32_bf16 v[100:103], a[252:255], v[108:111], v[100:103]
 s_waitcnt vmcnt(5)
 s_barrier
 ds_read_b128 v[104:107], v68 offset:12288
 ds_read_b128 v[108:111], v68 offset:14336
 s_waitcnt lgkmcnt(4)
 v_mfma_f32_16x16x32_bf16 v[72:75], a[16:19], v[112:115], v[72:75]
 v_mfma_f32_16x16x32_bf16 v[80:83], a[96:99], v[112:115], v[80:83]
 v_mfma_f32_16x16x32_bf16 v[88:91], a[176:179], v[112:115], v[88:91]
 v_mfma_f32_16x16x32_bf16 v[96:99], v[4:7], v[112:115], v[96:99]
 v_mfma_f32_16x16x32_bf16 v[76:79], a[16:19], v[116:119], v[76:79]
 v_mfma_f32_16x16x32_bf16 v[84:87], a[96:99], v[116:119], v[84:87]
 v_mfma_f32_16x16x32_bf16 v[92:95], a[176:179], v[116:119], v[92:95]
 v_mfma_f32_16x16x32_bf16 v[100:103], v[4:7], v[116:119], v[100:103]
 ds_read_b128 v[112:115], v69 offset:12288
 ds_read_b128 v[116:119], v69 offset:14336
 s_waitcnt lgkmcnt(4)
 v_mfma_f32_16x16x32_bf16 v[72:75], a[20:23], v[120:123], v[72:75]
 v_mfma_f32_16x16x32_bf16 v[80:83], a[100:103], v[120:123], v[80:83]
 v_mfma_f32_16x16x32_bf16 v[88:91], a[180:183], v[120:123], v[88:91]
 v_mfma_f32_16x16x32_bf16 v[96:99], v[8:11], v[120:123], v[96:99]
 v_mfma_f32_16x16x32_bf16 v[76:79], a[20:23], v[124:127], v[76:79]
 v_mfma_f32_16x16x32_bf16 v[84:87], a[100:103], v[124:127], v[84:87]
 v_mfma_f32_16x16x32_bf16 v[92:95], a[180:183], v[124:127], v[92:95]
 v_mfma_f32_16x16x32_bf16 v[100:103], v[8:11], v[124:127], v[100:103]
 ds_read_b128 v[120:123], v68 offset:16384
 ds_read_b128 v[124:127], v68 offset:18432
 s_waitcnt lgkmcnt(4)
 v_mfma_f32_16x16x32_bf16 v[72:75], a[24:27], v[104:107], v[72:75]
 v_mfma_f32_16x16x32_bf16 v[80:83], a[104:107], v[104:107], v[80:83]
 v_mfma_f32_16x16x32_bf16 v[88:91], a[184:187], v[104:107], v[88:91]
 v_mfma_f32_16x16x32_bf16 v[96:99], v[12:15], v[104:107], v[96:99]
 v_mfma_f32_16x16x32_bf16 v[76:79], a[24:27], v[108:111], v[76:79]
 v_mfma_f32_16x16x32_bf16 v[84:87], a[104:107], v[108:111], v[84:87]
 v_mfma_f32_16x16x32_bf16 v[92:95], a[184:187], v[108:111], v[92:95]
 v_mfma_f32_16x16x32_bf16 v[100:103], v[12:15], v[108:111], v[100:103]
 ds_read_b128 v[104:107], v69 offset:16384
 ds_read_b128 v[108:111], v69 offset:18432
 s_waitcnt lgkmcnt(4)
 v_mfma_f32_16x16x32_bf16 v[72:75], a[28:31], v[112:115], v[72:75]
 v_mfma_f32_16x16x32_bf16 v[80:83], a[108:111], v[112:115], v[80:83]
 v_mfma_f32_16x16x32_bf16 v[88:91], a[188:191], v[112:115], v[88:91]
 v_mfma_f32_16x16x32_bf16 v[96:99], v[16:19], v[112:115], v[96:99]
 v_mfma_f32_16x16x32_bf16 v[76:79], a[28:31], v[116:119], v[76:79]
 v_mfma_f32_16x16x32_bf16 v[84:87], a[108:111], v[116:119], v[84:87]
 v_mfma_f32_16x16x32_bf16 v[92:95], a[188:191], v[116:119], v[92:95]
 v_mfma_f32_16x16x32_bf16 v[100:103], v[16:19], v[116:119], v[100:103]
 s_cmp_eq_u32 s46, 1
 s_cbranch_scc0 Lnp_383
 s_waitcnt vmcnt(0)
 s_mov_b64 exec, 1
 v_mov_b32 v137, 1
 ds_add_rtn_u32 v137, v136, v137
 s_waitcnt lgkmcnt(0)
 v_readfirstlane_b32 s48, v137
 s_nop 0
 s_and_b32 s48, s48, 3
 s_cmp_eq_u32 s48, 3
 s_cbranch_scc0 Lar_384
 v_mov_b32 v137, s47
 buffer_store_dword v137, off, s[4:7], s27 sc1
Lar_384:
 s_mov_b64 exec, -1
Lnp_383:
 s_waitcnt vmcnt(3)
 s_barrier
 ds_read_b128 v[112:115], v68 offset:20480
 ds_read_b128 v[116:119], v68 offset:22528
 s_waitcnt lgkmcnt(4)
 v_mfma_f32_16x16x32_bf16 v[72:75], a[32:35], v[120:123], v[72:75]
 v_mfma_f32_16x16x32_bf16 v[80:83], a[112:115], v[120:123], v[80:83]
 v_mfma_f32_16x16x32_bf16 v[88:91], a[192:195], v[120:123], v[88:91]
 v_mfma_f32_16x16x32_bf16 v[96:99], v[20:23], v[120:123], v[96:99]
 v_mfma_f32_16x16x32_bf16 v[76:79], a[32:35], v[124:127], v[76:79]
 v_mfma_f32_16x16x32_bf16 v[84:87], a[112:115], v[124:127], v[84:87]
 v_mfma_f32_16x16x32_bf16 v[92:95], a[192:195], v[124:127], v[92:95]
 v_mfma_f32_16x16x32_bf16 v[100:103], v[20:23], v[124:127], v[100:103]
 ds_read_b128 v[120:123], v69 offset:20480
 ds_read_b128 v[124:127], v69 offset:22528
 s_waitcnt lgkmcnt(4)
 v_mfma_f32_16x16x32_bf16 v[72:75], a[36:39], v[104:107], v[72:75]
 buffer_load_dword v70, v71, s[4:7], 0 offen sc1
 v_mfma_f32_16x16x32_bf16 v[80:83], a[116:119], v[104:107], v[80:83]
 v_mfma_f32_16x16x32_bf16 v[88:91], a[196:199], v[104:107], v[88:91]
 v_mfma_f32_16x16x32_bf16 v[96:99], v[24:27], v[104:107], v[96:99]
 v_mfma_f32_16x16x32_bf16 v[76:79], a[36:39], v[108:111], v[76:79]
 v_mfma_f32_16x16x32_bf16 v[84:87], a[116:119], v[108:111], v[84:87]
 v_mfma_f32_16x16x32_bf16 v[92:95], a[196:199], v[108:111], v[92:95]
 v_mfma_f32_16x16x32_bf16 v[100:103], v[24:27], v[108:111], v[100:103]
 ds_read_b128 v[104:107], v68 offset:24576
 ds_read_b128 v[108:111], v68 offset:26624
 s_waitcnt lgkmcnt(4)
 v_mfma_f32_16x16x32_bf16 v[72:75], a[40:43], v[112:115], v[72:75]
 v_mfma_f32_16x16x32_bf16 v[80:83], a[120:123], v[112:115], v[80:83]
 v_mfma_f32_16x16x32_bf16 v[88:91], a[200:203], v[112:115], v[88:91]
 v_mfma_f32_16x16x32_bf16 v[96:99], v[28:31], v[112:115], v[96:99]
 v_mfma_f32_16x16x32_bf16 v[76:79], a[40:43], v[116:119], v[76:79]
 v_mfma_f32_16x16x32_bf16 v[84:87], a[120:123], v[116:119], v[84:87]
 v_mfma_f32_16x16x32_bf16 v[92:95], a[200:203], v[116:119], v[92:95]
 v_mfma_f32_16x16x32_bf16 v[100:103], v[28:31], v[116:119], v[100:103]
 ds_read_b128 v[112:115], v69 offset:24576
 ds_read_b128 v[116:119], v69 offset:26624
 s_waitcnt lgkmcnt(4)
 v_mfma_f32_16x16x32_bf16 v[72:75], a[44:47], v[120:123], v[72:75]
 v_mfma_f32_16x16x32_bf16 v[80:83], a[124:127], v[120:123], v[80:83]
 v_mfma_f32_16x16x32_bf16 v[88:91], a[204:207], v[120:123], v[88:91]
 v_mfma_f32_16x16x32_bf16 v[96:99], v[32:35], v[120:123], v[96:99]
 v_mfma_f32_16x16x32_bf16 v[76:79], a[44:47], v[124:127], v[76:79]
 v_mfma_f32_16x16x32_bf16 v[84:87], a[124:127], v[124:127], v[84:87]
 v_mfma_f32_16x16x32_bf16 v[92:95], a[204:207], v[124:127], v[92:95]
 v_mfma_f32_16x16x32_bf16 v[100:103], v[32:35], v[124:127], v[100:103]
 s_waitcnt vmcnt(1)
 s_barrier
 ds_read_b128 v[120:123], v68 offset:28672
 ds_read_b128 v[124:127], v68 offset:30720
 s_waitcnt lgkmcnt(4)
 v_mfma_f32_16x16x32_bf16 v[72:75], a[48:51], v[104:107], v[72:75]
 v_mfma_f32_16x16x32_bf16 v[80:83], a[128:131], v[104:107], v[80:83]
 v_mfma_f32_16x16x32_bf16 v[88:91], a[208:211], v[104:107], v[88:91]
 v_mfma_f32_16x16x32_bf16 v[96:99], v[36:39], v[104:107], v[96:99]
 v_mfma_f32_16x16x32_bf16 v[76:79], a[48:51], v[108:111], v[76:79]
 v_mfma_f32_16x16x32_bf16 v[84:87], a[128:131], v[108:111], v[84:87]
 v_mfma_f32_16x16x32_bf16 v[92:95], a[208:211], v[108:111], v[92:95]
 v_mfma_f32_16x16x32_bf16 v[100:103], v[36:39], v[108:111], v[100:103]
 ds_read_b128 v[104:107], v69 offset:28672
 ds_read_b128 v[108:111], v69 offset:30720
 s_waitcnt lgkmcnt(4)
 v_mfma_f32_16x16x32_bf16 v[72:75], a[52:55], v[112:115], v[72:75]
 v_mfma_f32_16x16x32_bf16 v[80:83], a[132:135], v[112:115], v[80:83]
 v_mfma_f32_16x16x32_bf16 v[88:91], a[212:215], v[112:115], v[88:91]
 v_mfma_f32_16x16x32_bf16 v[96:99], v[40:43], v[112:115], v[96:99]
 v_mfma_f32_16x16x32_bf16 v[76:79], a[52:55], v[116:119], v[76:79]
 v_mfma_f32_16x16x32_bf16 v[84:87], a[132:135], v[116:119], v[84:87]
 v_mfma_f32_16x16x32_bf16 v[92:95], a[212:215], v[116:119], v[92:95]
 v_mfma_f32_16x16x32_bf16 v[100:103], v[40:43], v[116:119], v[100:103]
 s_mov_b32 s47, s45
 s_cmp_ge_u32 s45, 64
 s_cbranch_scc1 Lgun_378
 s_waitcnt vmcnt(0)
 v_cmp_lt_u32 vcc, s45, v70
 s_nop 0
 s_cmp_eq_u64 vcc, -1
 s_cbranch_scc0 Lgun_378
 s_mul_i32 s19, s44, 98304
 s_lshl_b32 s20, s26, 11
 s_add_u32 s19, s19, s20
 s_add_u32 s43, s19, 234782720
 s_mul_i32 s40, s45, 40960
 s_add_u32 s40, s40, 190218240
 s_xor_b32 s41, s41, 40960
 ds_read_b128 v[112:115], v68 offset:32768
 ds_read_b128 v[116:119], v68 offset:34816
 s_waitcnt lgkmcnt(4)
 v_mfma_f32_16x16x32_bf16 v[72:75], a[56:59], v[120:123], v[72:75]
 s_add_u32 m0, s41, 0
 s_nop 0
 buffer_load_dwordx4 v3, s[4:7], s40 offen offset:0 sc1 lds
 v_mfma_f32_16x16x32_bf16 v[80:83], a[136:139], v[120:123], v[80:83]
 s_add_u32 m0, s41, 3968
 s_nop 0
 buffer_load_dwordx4 v3, s[4:7], s40 offen offset:128 sc1 lds
 v_mfma_f32_16x16x32_bf16 v[88:91], a[216:219], v[120:123], v[88:91]
 v_mfma_f32_16x16x32_bf16 v[96:99], v[44:47], v[120:123], v[96:99]
 v_mfma_f32_16x16x32_bf16 v[76:79], a[56:59], v[124:127], v[76:79]
 v_mfma_f32_16x16x32_bf16 v[84:87], a[136:139], v[124:127], v[84:87]
 v_mfma_f32_16x16x32_bf16 v[92:95], a[216:219], v[124:127], v[92:95]
 v_mfma_f32_16x16x32_bf16 v[100:103], v[44:47], v[124:127], v[100:103]
 ds_read_b128 v[120:123], v69 offset:32768
 ds_read_b128 v[124:127], v69 offset:34816
 s_waitcnt lgkmcnt(4)
 v_mfma_f32_16x16x32_bf16 v[72:75], a[60:63], v[104:107], v[72:75]
 s_add_u32 m0, s41, 7936
 s_nop 0
 buffer_load_dwordx4 v3, s[4:7], s40 offen offset:256 sc1 lds
 v_mfma_f32_16x16x32_bf16 v[80:83], a[140:143], v[104:107], v[80:83]
 s_add_u32 m0, s41, 11904
 s_nop 0
 buffer_load_dwordx4 v3, s[4:7], s40 offen offset:384 sc1 lds
 v_mfma_f32_16x16x32_bf16 v[88:91], a[220:223], v[104:107], v[88:91]
 v_mfma_f32_16x16x32_bf16 v[96:99], v[48:51], v[104:107], v[96:99]
 v_mfma_f32_16x16x32_bf16 v[76:79], a[60:63], v[108:111], v[76:79]
 v_mfma_f32_16x16x32_bf16 v[84:87], a[140:143], v[108:111], v[84:87]
 v_mfma_f32_16x16x32_bf16 v[92:95], a[220:223], v[108:111], v[92:95]
 v_mfma_f32_16x16x32_bf16 v[100:103], v[48:51], v[108:111], v[100:103]
 ds_read_b128 v[104:107], v68 offset:36864
 ds_read_b128 v[108:111], v68 offset:38912
 s_waitcnt lgkmcnt(4)
 v_mfma_f32_16x16x32_bf16 v[72:75], a[64:67], v[112:115], v[72:75]
 s_add_u32 m0, s41, 15872
 s_nop 0
 buffer_load_dwordx4 v3, s[4:7], s40 offen offset:512 sc1 lds
 v_mfma_f32_16x16x32_bf16 v[80:83], a[144:147], v[112:115], v[80:83]
 s_add_u32 m0, s41, 19840
 s_nop 0
 buffer_load_dwordx4 v3, s[4:7], s40 offen offset:640 sc1 lds
 v_mfma_f32_16x16x32_bf16 v[88:91], a[224:227], v[112:115], v[88:91]
 v_mfma_f32_16x16x32_bf16 v[96:99], v[52:55], v[112:115], v[96:99]
 v_mfma_f32_16x16x32_bf16 v[76:79], a[64:67], v[116:119], v[76:79]
 v_mfma_f32_16x16x32_bf16 v[84:87], a[144:147], v[116:119], v[84:87]
 v_mfma_f32_16x16x32_bf16 v[92:95], a[224:227], v[116:119], v[92:95]
 v_mfma_f32_16x16x32_bf16 v[100:103], v[52:55], v[116:119], v[100:103]
 ds_read_b128 v[112:115], v69 offset:36864
 ds_read_b128 v[116:119], v69 offset:38912
 s_waitcnt lgkmcnt(4)
 v_mfma_f32_16x16x32_bf16 v[72:75], a[68:71], v[120:123], v[72:75]
 s_add_u32 m0, s41, 23808
 s_nop 0
 buffer_load_dwordx4 v3, s[4:7], s40 offen offset:768 sc1 lds
 v_mfma_f32_16x16x32_bf16 v[80:83], a[148:151], v[120:123], v[80:83]
 s_add_u32 m0, s41, 27776
 s_nop 0
 buffer_load_dwordx4 v3, s[4:7], s40 offen offset:896 sc1 lds
 v_mfma_f32_16x16x32_bf16 v[88:91], a[228:231], v[120:123], v[88:91]
 v_mfma_f32_16x16x32_bf16 v[96:99], v[56:59], v[120:123], v[96:99]
 v_mfma_f32_16x16x32_bf16 v[76:79], a[68:71], v[124:127], v[76:79]
 v_mfma_f32_16x16x32_bf16 v[84:87], a[148:151], v[124:127], v[84:87]
 v_mfma_f32_16x16x32_bf16 v[92:95], a[228:231], v[124:127], v[92:95]
 v_mfma_f32_16x16x32_bf16 v[100:103], v[56:59], v[124:127], v[100:103]
 s_waitcnt lgkmcnt(3)
 v_mfma_f32_16x16x32_bf16 v[72:75], a[72:75], v[104:107], v[72:75]
 s_add_u32 m0, s41, 31744
 s_nop 0
 buffer_load_dwordx4 v3, s[4:7], s40 offen offset:1024 sc1 lds
 v_mfma_f32_16x16x32_bf16 v[80:83], a[152:155], v[104:107], v[80:83]
 v_mfma_f32_16x16x32_bf16 v[88:91], a[232:235], v[104:107], v[88:91]
 v_mfma_f32_16x16x32_bf16 v[96:99], v[60:63], v[104:107], v[96:99]
 s_waitcnt lgkmcnt(2)
 v_mfma_f32_16x16x32_bf16 v[76:79], a[72:75], v[108:111], v[76:79]
 v_mfma_f32_16x16x32_bf16 v[84:87], a[152:155], v[108:111], v[84:87]
 v_mfma_f32_16x16x32_bf16 v[92:95], a[232:235], v[108:111], v[92:95]
 v_mfma_f32_16x16x32_bf16 v[100:103], v[60:63], v[108:111], v[100:103]
 s_waitcnt lgkmcnt(1)
 v_mfma_f32_16x16x32_bf16 v[72:75], a[76:79], v[112:115], v[72:75]
 s_add_u32 m0, s41, 35712
 s_nop 0
 buffer_load_dwordx4 v3, s[4:7], s40 offen offset:1152 sc1 lds
 v_mfma_f32_16x16x32_bf16 v[80:83], a[156:159], v[112:115], v[80:83]
 v_mfma_f32_16x16x32_bf16 v[88:91], a[236:239], v[112:115], v[88:91]
 v_mfma_f32_16x16x32_bf16 v[96:99], v[64:67], v[112:115], v[96:99]
 s_waitcnt lgkmcnt(0)
 v_mfma_f32_16x16x32_bf16 v[76:79], a[76:79], v[116:119], v[76:79]
 v_mfma_f32_16x16x32_bf16 v[84:87], a[156:159], v[116:119], v[84:87]
 v_mfma_f32_16x16x32_bf16 v[92:95], a[236:239], v[116:119], v[92:95]
 v_mfma_f32_16x16x32_bf16 v[100:103], v[64:67], v[116:119], v[100:103]
 v_mul_f32 v72, s42, v72
 v_mul_f32 v73, s42, v73
 v_mul_f32 v74, s42, v74
 v_mul_f32 v75, s42, v75
 v_mul_f32 v80, s42, v80
 v_mul_f32 v81, s42, v81
 v_mul_f32 v82, s42, v82
 v_mul_f32 v83, s42, v83
 v_exp_f32 v72, v72
 v_exp_f32 v73, v73
 v_exp_f32 v74, v74
 v_exp_f32 v75, v75
 v_exp_f32 v80, v80
 v_exp_f32 v81, v81
 v_exp_f32 v82, v82
 v_exp_f32 v83, v83
 v_add_f32 v72, 1.0, v72
 v_add_f32 v73, 1.0, v73
 v_add_f32 v74, 1.0, v74
 v_add_f32 v75, 1.0, v75
 v_add_f32 v80, 1.0, v80
 v_add_f32 v81, 1.0, v81
 v_add_f32 v82, 1.0, v82
 v_add_f32 v83, 1.0, v83
 v_rcp_f32 v72, v72
 v_rcp_f32 v73, v73
 v_rcp_f32 v74, v74
 v_rcp_f32 v75, v75
 v_rcp_f32 v80, v80
 v_rcp_f32 v81, v81
 v_rcp_f32 v82, v82
 v_rcp_f32 v83, v83
 v_mul_f32 v72, v72, v88
 v_mul_f32 v73, v73, v89
 v_mul_f32 v74, v74, v90
 v_mul_f32 v75, v75, v91
 v_mul_f32 v80, v80, v96
 v_mul_f32 v81, v81, v97
 v_mul_f32 v82, v82, v98
 v_mul_f32 v83, v83, v99
 v_cvt_pk_bf16_f32 v128, v72, v73
 v_cvt_pk_bf16_f32 v129, v74, v75
 v_cvt_pk_bf16_f32 v130, v80, v81
 v_cvt_pk_bf16_f32 v131, v82, v83
 buffer_store_dwordx4 v[128:131], v2, s[4:7], s43 offen offset:0 sc1
 v_mul_f32 v76, s42, v76
 v_mul_f32 v77, s42, v77
 v_mul_f32 v78, s42, v78
 v_mul_f32 v79, s42, v79
 v_mul_f32 v84, s42, v84
 v_mul_f32 v85, s42, v85
 v_mul_f32 v86, s42, v86
 v_mul_f32 v87, s42, v87
 v_exp_f32 v76, v76
 v_exp_f32 v77, v77
 v_exp_f32 v78, v78
 v_exp_f32 v79, v79
 v_exp_f32 v84, v84
 v_exp_f32 v85, v85
 v_exp_f32 v86, v86
 v_exp_f32 v87, v87
 v_add_f32 v76, 1.0, v76
 v_add_f32 v77, 1.0, v77
 v_add_f32 v78, 1.0, v78
 v_add_f32 v79, 1.0, v79
 v_add_f32 v84, 1.0, v84
 v_add_f32 v85, 1.0, v85
 v_add_f32 v86, 1.0, v86
 v_add_f32 v87, 1.0, v87
 v_rcp_f32 v76, v76
 v_rcp_f32 v77, v77
 v_rcp_f32 v78, v78
 v_rcp_f32 v79, v79
 v_rcp_f32 v84, v84
 v_rcp_f32 v85, v85
 v_rcp_f32 v86, v86
 v_rcp_f32 v87, v87
 v_mul_f32 v76, v76, v92
 v_mul_f32 v77, v77, v93
 v_mul_f32 v78, v78, v94
 v_mul_f32 v79, v79, v95
 v_mul_f32 v84, v84, v100
 v_mul_f32 v85, v85, v101
 v_mul_f32 v86, v86, v102
 v_mul_f32 v87, v87, v103
 v_cvt_pk_bf16_f32 v132, v76, v77
 v_cvt_pk_bf16_f32 v133, v78, v79
 v_cvt_pk_bf16_f32 v134, v84, v85
 v_cvt_pk_bf16_f32 v135, v86, v87
 buffer_store_dwordx4 v[132:135], v2, s[4:7], s43 offen offset:1024 sc1
 s_mov_b32 s44, s45
 s_add_u32 s45, s45, 1
 v_xor_b32 v68, 40960, v68
 v_xor_b32 v69, 40960, v69
 s_branch Lguw_375
Lgun_378:
 s_mul_i32 s19, s44, 98304
 s_lshl_b32 s20, s26, 11
 s_add_u32 s19, s19, s20
 s_add_u32 s43, s19, 234782720
 s_mul_i32 s40, s45, 40960
 s_add_u32 s40, s40, 190218240
 s_xor_b32 s41, s41, 40960
 ds_read_b128 v[112:115], v68 offset:32768
 ds_read_b128 v[116:119], v68 offset:34816
 s_waitcnt lgkmcnt(4)
 v_mfma_f32_16x16x32_bf16 v[72:75], a[56:59], v[120:123], v[72:75]
 v_mfma_f32_16x16x32_bf16 v[80:83], a[136:139], v[120:123], v[80:83]
 v_mfma_f32_16x16x32_bf16 v[88:91], a[216:219], v[120:123], v[88:91]
 v_mfma_f32_16x16x32_bf16 v[96:99], v[44:47], v[120:123], v[96:99]
 v_mfma_f32_16x16x32_bf16 v[76:79], a[56:59], v[124:127], v[76:79]
 v_mfma_f32_16x16x32_bf16 v[84:87], a[136:139], v[124:127], v[84:87]
 v_mfma_f32_16x16x32_bf16 v[92:95], a[216:219], v[124:127], v[92:95]
 v_mfma_f32_16x16x32_bf16 v[100:103], v[44:47], v[124:127], v[100:103]
 ds_read_b128 v[120:123], v69 offset:32768
 ds_read_b128 v[124:127], v69 offset:34816
 s_waitcnt lgkmcnt(4)
 v_mfma_f32_16x16x32_bf16 v[72:75], a[60:63], v[104:107], v[72:75]
 v_mfma_f32_16x16x32_bf16 v[80:83], a[140:143], v[104:107], v[80:83]
 v_mfma_f32_16x16x32_bf16 v[88:91], a[220:223], v[104:107], v[88:91]
 v_mfma_f32_16x16x32_bf16 v[96:99], v[48:51], v[104:107], v[96:99]
 v_mfma_f32_16x16x32_bf16 v[76:79], a[60:63], v[108:111], v[76:79]
 v_mfma_f32_16x16x32_bf16 v[84:87], a[140:143], v[108:111], v[84:87]
 v_mfma_f32_16x16x32_bf16 v[92:95], a[220:223], v[108:111], v[92:95]
 v_mfma_f32_16x16x32_bf16 v[100:103], v[48:51], v[108:111], v[100:103]
 ds_read_b128 v[104:107], v68 offset:36864
 ds_read_b128 v[108:111], v68 offset:38912
 s_waitcnt lgkmcnt(4)
 v_mfma_f32_16x16x32_bf16 v[72:75], a[64:67], v[112:115], v[72:75]
 v_mfma_f32_16x16x32_bf16 v[80:83], a[144:147], v[112:115], v[80:83]
 v_mfma_f32_16x16x32_bf16 v[88:91], a[224:227], v[112:115], v[88:91]
 v_mfma_f32_16x16x32_bf16 v[96:99], v[52:55], v[112:115], v[96:99]
 v_mfma_f32_16x16x32_bf16 v[76:79], a[64:67], v[116:119], v[76:79]
 v_mfma_f32_16x16x32_bf16 v[84:87], a[144:147], v[116:119], v[84:87]
 v_mfma_f32_16x16x32_bf16 v[92:95], a[224:227], v[116:119], v[92:95]
 v_mfma_f32_16x16x32_bf16 v[100:103], v[52:55], v[116:119], v[100:103]
 ds_read_b128 v[112:115], v69 offset:36864
 ds_read_b128 v[116:119], v69 offset:38912
 s_waitcnt lgkmcnt(4)
 v_mfma_f32_16x16x32_bf16 v[72:75], a[68:71], v[120:123], v[72:75]
 v_mfma_f32_16x16x32_bf16 v[80:83], a[148:151], v[120:123], v[80:83]
 v_mfma_f32_16x16x32_bf16 v[88:91], a[228:231], v[120:123], v[88:91]
 v_mfma_f32_16x16x32_bf16 v[96:99], v[56:59], v[120:123], v[96:99]
 v_mfma_f32_16x16x32_bf16 v[76:79], a[68:71], v[124:127], v[76:79]
 v_mfma_f32_16x16x32_bf16 v[84:87], a[148:151], v[124:127], v[84:87]
 v_mfma_f32_16x16x32_bf16 v[92:95], a[228:231], v[124:127], v[92:95]
 v_mfma_f32_16x16x32_bf16 v[100:103], v[56:59], v[124:127], v[100:103]
 s_waitcnt lgkmcnt(3)
 v_mfma_f32_16x16x32_bf16 v[72:75], a[72:75], v[104:107], v[72:75]
 v_mfma_f32_16x16x32_bf16 v[80:83], a[152:155], v[104:107], v[80:83]
 v_mfma_f32_16x16x32_bf16 v[88:91], a[232:235], v[104:107], v[88:91]
 v_mfma_f32_16x16x32_bf16 v[96:99], v[60:63], v[104:107], v[96:99]
 s_waitcnt lgkmcnt(2)
 v_mfma_f32_16x16x32_bf16 v[76:79], a[72:75], v[108:111], v[76:79]
 v_mfma_f32_16x16x32_bf16 v[84:87], a[152:155], v[108:111], v[84:87]
 v_mfma_f32_16x16x32_bf16 v[92:95], a[232:235], v[108:111], v[92:95]
 v_mfma_f32_16x16x32_bf16 v[100:103], v[60:63], v[108:111], v[100:103]
 s_waitcnt lgkmcnt(1)
 v_mfma_f32_16x16x32_bf16 v[72:75], a[76:79], v[112:115], v[72:75]
 v_mfma_f32_16x16x32_bf16 v[80:83], a[156:159], v[112:115], v[80:83]
 v_mfma_f32_16x16x32_bf16 v[88:91], a[236:239], v[112:115], v[88:91]
 v_mfma_f32_16x16x32_bf16 v[96:99], v[64:67], v[112:115], v[96:99]
 s_waitcnt lgkmcnt(0)
 v_mfma_f32_16x16x32_bf16 v[76:79], a[76:79], v[116:119], v[76:79]
 v_mfma_f32_16x16x32_bf16 v[84:87], a[156:159], v[116:119], v[84:87]
 v_mfma_f32_16x16x32_bf16 v[92:95], a[236:239], v[116:119], v[92:95]
 v_mfma_f32_16x16x32_bf16 v[100:103], v[64:67], v[116:119], v[100:103]
 v_mul_f32 v72, s42, v72
 v_mul_f32 v73, s42, v73
 v_mul_f32 v74, s42, v74
 v_mul_f32 v75, s42, v75
 v_mul_f32 v80, s42, v80
 v_mul_f32 v81, s42, v81
 v_mul_f32 v82, s42, v82
 v_mul_f32 v83, s42, v83
 v_exp_f32 v72, v72
 v_exp_f32 v73, v73
 v_exp_f32 v74, v74
 v_exp_f32 v75, v75
 v_exp_f32 v80, v80
 v_exp_f32 v81, v81
 v_exp_f32 v82, v82
 v_exp_f32 v83, v83
 v_add_f32 v72, 1.0, v72
 v_add_f32 v73, 1.0, v73
 v_add_f32 v74, 1.0, v74
 v_add_f32 v75, 1.0, v75
 v_add_f32 v80, 1.0, v80
 v_add_f32 v81, 1.0, v81
 v_add_f32 v82, 1.0, v82
 v_add_f32 v83, 1.0, v83
 v_rcp_f32 v72, v72
 v_rcp_f32 v73, v73
 v_rcp_f32 v74, v74
 v_rcp_f32 v75, v75
 v_rcp_f32 v80, v80
 v_rcp_f32 v81, v81
 v_rcp_f32 v82, v82
 v_rcp_f32 v83, v83
 v_mul_f32 v72, v72, v88
 v_mul_f32 v73, v73, v89
 v_mul_f32 v74, v74, v90
 v_mul_f32 v75, v75, v91
 v_mul_f32 v80, v80, v96
 v_mul_f32 v81, v81, v97
 v_mul_f32 v82, v82, v98
 v_mul_f32 v83, v83, v99
 v_cvt_pk_bf16_f32 v128, v72, v73
 v_cvt_pk_bf16_f32 v129, v74, v75
 v_cvt_pk_bf16_f32 v130, v80, v81
 v_cvt_pk_bf16_f32 v131, v82, v83
 buffer_store_dwordx4 v[128:131], v2, s[4:7], s43 offen offset:0 sc1
 v_mul_f32 v76, s42, v76
 v_mul_f32 v77, s42, v77
 v_mul_f32 v78, s42, v78
 v_mul_f32 v79, s42, v79
 v_mul_f32 v84, s42, v84
 v_mul_f32 v85, s42, v85
 v_mul_f32 v86, s42, v86
 v_mul_f32 v87, s42, v87
 v_exp_f32 v76, v76
 v_exp_f32 v77, v77
 v_exp_f32 v78, v78
 v_exp_f32 v79, v79
 v_exp_f32 v84, v84
 v_exp_f32 v85, v85
 v_exp_f32 v86, v86
 v_exp_f32 v87, v87
 v_add_f32 v76, 1.0, v76
 v_add_f32 v77, 1.0, v77
 v_add_f32 v78, 1.0, v78
 v_add_f32 v79, 1.0, v79
 v_add_f32 v84, 1.0, v84
 v_add_f32 v85, 1.0, v85
 v_add_f32 v86, 1.0, v86
 v_add_f32 v87, 1.0, v87
 v_rcp_f32 v76, v76
 v_rcp_f32 v77, v77
 v_rcp_f32 v78, v78
 v_rcp_f32 v79, v79
 v_rcp_f32 v84, v84
 v_rcp_f32 v85, v85
 v_rcp_f32 v86, v86
 v_rcp_f32 v87, v87
 v_mul_f32 v76, v76, v92
 v_mul_f32 v77, v77, v93
 v_mul_f32 v78, v78, v94
 v_mul_f32 v79, v79, v95
 v_mul_f32 v84, v84, v100
 v_mul_f32 v85, v85, v101
 v_mul_f32 v86, v86, v102
 v_mul_f32 v87, v87, v103
 v_cvt_pk_bf16_f32 v132, v76, v77
 v_cvt_pk_bf16_f32 v133, v78, v79
 v_cvt_pk_bf16_f32 v134, v84, v85
 v_cvt_pk_bf16_f32 v135, v86, v87
 buffer_store_dwordx4 v[132:135], v2, s[4:7], s43 offen offset:1024 sc1
 s_mov_b32 s44, s45
 s_add_u32 s45, s45, 1
 v_xor_b32 v68, 40960, v68
 v_xor_b32 v69, 40960, v69
 s_branch Lguc_374
Lgud_379:
 s_endpgm
L_role_d:
 s_sub_u32 s12, s12, 232
 v_and_b32 v1, 63, v0
 v_lshlrev_b32 v2, 4, v1
 s_load_dwordx2 s[26:27], s[0:1], 80
 s_cmp_ge_u32 s12, 5
 s_cselect_b32 s25, 1, 0
 s_mul_i32 s19, s25, 5
 s_sub_u32 s19, s12, s19
 s_lshl_b32 s38, s25, 7
 s_add_u32 s38, s38, s19
 s_lshl_b32 s38, s38, 7
 s_add_u32 s38, s38, 221184
 s_mul_i32 s36, s19, 0x3334
 s_lshr_b32 s36, s36, 16
 s_mul_i32 s20, s36, 5
 s_sub_u32 s37, s19, s20
 s_lshl_b32 s19, s37, 8
 s_lshl_b32 s20, s3, 6
 s_add_u32 s19, s19, s20
 s_mov_b32 s42, s19
 s_lshl_b32 s41, s19, 6
 s_mul_i32 s23, s36, 1966080
 s_add_u32 s23, s23, s19
 s_mul_i32 s20, s36, 81920
 s_add_u32 s41, s41, s20
 s_add_u32 s41, s41, 208568320
 s_waitcnt lgkmcnt(0)
 s_mov_b32 s28, s26
 s_mov_b32 s29, s27
 s_mov_b32 s30, 1966080
 s_mov_b32 s31, 0x20000
 s_load_dwordx2 s[26:27], s[0:1], 88
 s_waitcnt lgkmcnt(0)
 s_mov_b32 s32, s26
 s_mov_b32 s33, s27
 s_mov_b32 s34, 2621440
 s_mov_b32 s35, 0x20000
 v_lshrrev_b32 v132, 2, v1
 v_mul_u32_u24 v132, 1280, v132
 v_and_b32 v3, 3, v1
 v_lshl_add_u32 v132, v3, 4, v132
 v_lshrrev_b32 v133, 4, v1
 v_lshlrev_b32 v133, 2, v133
 v_bfe_u32 v3, v1, 2, 2
 v_add_u32 v133, v133, v3
 v_mul_u32_u24 v133, 64, v133
 v_and_b32 v3, 3, v1
 v_lshl_add_u32 v133, v3, 4, v133
 s_mul_i32 s19, s3, 40960
 s_add_u32 s19, s19, 0
 v_add_u32 v133, s19, v133
 s_mul_i32 s19, s3, 40960
 s_add_u32 m0, s19, 0
 s_add_u32 s20, s23, 0
 buffer_load_dwordx4 v132, s[28:31], s20 offen lds
 s_add_u32 m0, s19, 1024
 s_add_u32 s20, s23, 20480
 buffer_load_dwordx4 v132, s[28:31], s20 offen lds
 s_add_u32 m0, s19, 2048
 s_add_u32 s20, s23, 40960
 buffer_load_dwordx4 v132, s[28:31], s20 offen lds
 s_add_u32 m0, s19, 3072
 s_add_u32 s20, s23, 61440
 buffer_load_dwordx4 v132, s[28:31], s20 offen lds
 s_add_u32 m0, s19, 4096
 s_add_u32 s20, s23, 81920
 buffer_load_dwordx4 v132, s[28:31], s20 offen lds
 s_add_u32 m0, s19, 5120
 s_add_u32 s20, s23, 102400
 buffer_load_dwordx4 v132, s[28:31], s20 offen lds
 s_add_u32 m0, s19, 6144
 s_add_u32 s20, s23, 122880
 buffer_load_dwordx4 v132, s[28:31], s20 offen lds
 s_add_u32 m0, s19, 7168
 s_add_u32 s20, s23, 143360
 buffer_load_dwordx4 v132, s[28:31], s20 offen lds
 s_add_u32 m0, s19, 8192
 s_add_u32 s20, s23, 163840
 buffer_load_dwordx4 v132, s[28:31], s20 offen lds
 s_add_u32 m0, s19, 9216
 s_add_u32 s20, s23, 184320
 buffer_load_dwordx4 v132, s[28:31], s20 offen lds
 s_add_u32 m0, s19, 10240
 s_add_u32 s20, s23, 204800
 buffer_load_dwordx4 v132, s[28:31], s20 offen lds
 s_add_u32 m0, s19, 11264
 s_add_u32 s20, s23, 225280
 buffer_load_dwordx4 v132, s[28:31], s20 offen lds
 s_add_u32 m0, s19, 12288
 s_add_u32 s20, s23, 245760
 buffer_load_dwordx4 v132, s[28:31], s20 offen lds
 s_add_u32 m0, s19, 13312
 s_add_u32 s20, s23, 266240
 buffer_load_dwordx4 v132, s[28:31], s20 offen lds
 s_add_u32 m0, s19, 14336
 s_add_u32 s20, s23, 286720
 buffer_load_dwordx4 v132, s[28:31], s20 offen lds
 s_add_u32 m0, s19, 15360
 s_add_u32 s20, s23, 307200
 buffer_load_dwordx4 v132, s[28:31], s20 offen lds
 s_add_u32 m0, s19, 16384
 s_add_u32 s20, s23, 327680
 buffer_load_dwordx4 v132, s[28:31], s20 offen lds
 s_add_u32 m0, s19, 17408
 s_add_u32 s20, s23, 348160
 buffer_load_dwordx4 v132, s[28:31], s20 offen lds
 s_add_u32 m0, s19, 18432
 s_add_u32 s20, s23, 368640
 buffer_load_dwordx4 v132, s[28:31], s20 offen lds
 s_add_u32 m0, s19, 19456
 s_add_u32 s20, s23, 389120
 buffer_load_dwordx4 v132, s[28:31], s20 offen lds
 s_mul_i32 s19, s3, 40960
 s_add_u32 m0, s19, 20480
 s_add_u32 s20, s23, 409600
 buffer_load_dwordx4 v132, s[28:31], s20 offen lds
 s_add_u32 m0, s19, 21504
 s_add_u32 s20, s23, 430080
 buffer_load_dwordx4 v132, s[28:31], s20 offen lds
 s_add_u32 m0, s19, 22528
 s_add_u32 s20, s23, 450560
 buffer_load_dwordx4 v132, s[28:31], s20 offen lds
 s_add_u32 m0, s19, 23552
 s_add_u32 s20, s23, 471040
 buffer_load_dwordx4 v132, s[28:31], s20 offen lds
 s_add_u32 m0, s19, 24576
 s_add_u32 s20, s23, 491520
 buffer_load_dwordx4 v132, s[28:31], s20 offen lds
 s_add_u32 m0, s19, 25600
 s_add_u32 s20, s23, 512000
 buffer_load_dwordx4 v132, s[28:31], s20 offen lds
 s_add_u32 m0, s19, 26624
 s_add_u32 s20, s23, 532480
 buffer_load_dwordx4 v132, s[28:31], s20 offen lds
 s_add_u32 m0, s19, 27648
 s_add_u32 s20, s23, 552960
 buffer_load_dwordx4 v132, s[28:31], s20 offen lds
 s_add_u32 m0, s19, 28672
 s_add_u32 s20, s23, 573440
 buffer_load_dwordx4 v132, s[28:31], s20 offen lds
 s_add_u32 m0, s19, 29696
 s_add_u32 s20, s23, 593920
 buffer_load_dwordx4 v132, s[28:31], s20 offen lds
 s_add_u32 m0, s19, 30720
 s_add_u32 s20, s23, 614400
 buffer_load_dwordx4 v132, s[28:31], s20 offen lds
 s_add_u32 m0, s19, 31744
 s_add_u32 s20, s23, 634880
 buffer_load_dwordx4 v132, s[28:31], s20 offen lds
 s_add_u32 m0, s19, 32768
 s_add_u32 s20, s23, 655360
 buffer_load_dwordx4 v132, s[28:31], s20 offen lds
 s_add_u32 m0, s19, 33792
 s_add_u32 s20, s23, 675840
 buffer_load_dwordx4 v132, s[28:31], s20 offen lds
 s_add_u32 m0, s19, 34816
 s_add_u32 s20, s23, 696320
 buffer_load_dwordx4 v132, s[28:31], s20 offen lds
 s_add_u32 m0, s19, 35840
 s_add_u32 s20, s23, 716800
 buffer_load_dwordx4 v132, s[28:31], s20 offen lds
 s_add_u32 m0, s19, 36864
 s_add_u32 s20, s23, 737280
 buffer_load_dwordx4 v132, s[28:31], s20 offen lds
 s_add_u32 m0, s19, 37888
 s_add_u32 s20, s23, 757760
 buffer_load_dwordx4 v132, s[28:31], s20 offen lds
 s_add_u32 m0, s19, 38912
 s_add_u32 s20, s23, 778240
 buffer_load_dwordx4 v132, s[28:31], s20 offen lds
 s_add_u32 m0, s19, 39936
 s_add_u32 s20, s23, 798720
 buffer_load_dwordx4 v132, s[28:31], s20 offen lds
 s_waitcnt vmcnt(20)
 ds_read_b64_tr_b16 a[0:1], v133 offset:0
 ds_read_b64_tr_b16 a[2:3], v133 offset:1024
 ds_read_b64_tr_b16 a[192:193], v133 offset:8
 ds_read_b64_tr_b16 a[194:195], v133 offset:1032
 ds_read_b64_tr_b16 a[4:5], v133 offset:2048
 ds_read_b64_tr_b16 a[6:7], v133 offset:3072
 ds_read_b64_tr_b16 a[196:197], v133 offset:2056
 ds_read_b64_tr_b16 a[198:199], v133 offset:3080
 ds_read_b64_tr_b16 a[8:9], v133 offset:4096
 ds_read_b64_tr_b16 a[10:11], v133 offset:5120
 ds_read_b64_tr_b16 a[200:201], v133 offset:4104
 ds_read_b64_tr_b16 a[202:203], v133 offset:5128
 ds_read_b64_tr_b16 a[12:13], v133 offset:6144
 ds_read_b64_tr_b16 a[14:15], v133 offset:7168
 ds_read_b64_tr_b16 a[204:205], v133 offset:6152
 ds_read_b64_tr_b16 a[206:207], v133 offset:7176
 ds_read_b64_tr_b16 a[16:17], v133 offset:8192
 ds_read_b64_tr_b16 a[18:19], v133 offset:9216
 ds_read_b64_tr_b16 a[208:209], v133 offset:8200
 ds_read_b64_tr_b16 a[210:211], v133 offset:9224
 ds_read_b64_tr_b16 a[20:21], v133 offset:10240
 ds_read_b64_tr_b16 a[22:23], v133 offset:11264
 ds_read_b64_tr_b16 a[212:213], v133 offset:10248
 ds_read_b64_tr_b16 a[214:215], v133 offset:11272
 ds_read_b64_tr_b16 a[24:25], v133 offset:12288
 ds_read_b64_tr_b16 a[26:27], v133 offset:13312
 ds_read_b64_tr_b16 a[216:217], v133 offset:12296
 ds_read_b64_tr_b16 a[218:219], v133 offset:13320
 ds_read_b64_tr_b16 a[28:29], v133 offset:14336
 ds_read_b64_tr_b16 a[30:31], v133 offset:15360
 ds_read_b64_tr_b16 a[220:221], v133 offset:14344
 ds_read_b64_tr_b16 a[222:223], v133 offset:15368
 ds_read_b64_tr_b16 a[32:33], v133 offset:16384
 ds_read_b64_tr_b16 a[34:35], v133 offset:17408
 ds_read_b64_tr_b16 a[224:225], v133 offset:16392
 ds_read_b64_tr_b16 a[226:227], v133 offset:17416
 ds_read_b64_tr_b16 a[36:37], v133 offset:18432
 ds_read_b64_tr_b16 a[38:39], v133 offset:19456
 ds_read_b64_tr_b16 a[228:229], v133 offset:18440
 ds_read_b64_tr_b16 a[230:231], v133 offset:19464
 s_waitcnt lgkmcnt(0)
 s_mul_i32 s19, s3, 40960
 s_add_u32 m0, s19, 0
 s_add_u32 s20, s23, 819200
 buffer_load_dwordx4 v132, s[28:31], s20 offen lds
 s_add_u32 m0, s19, 1024
 s_add_u32 s20, s23, 839680
 buffer_load_dwordx4 v132, s[28:31], s20 offen lds
 s_add_u32 m0, s19, 2048
 s_add_u32 s20, s23, 860160
 buffer_load_dwordx4 v132, s[28:31], s20 offen lds
 s_add_u32 m0, s19, 3072
 s_add_u32 s20, s23, 880640
 buffer_load_dwordx4 v132, s[28:31], s20 offen lds
 s_add_u32 m0, s19, 4096
 s_add_u32 s20, s23, 901120
 buffer_load_dwordx4 v132, s[28:31], s20 offen lds
 s_add_u32 m0, s19, 5120
 s_add_u32 s20, s23, 921600
 buffer_load_dwordx4 v132, s[28:31], s20 offen lds
 s_add_u32 m0, s19, 6144
 s_add_u32 s20, s23, 942080
 buffer_load_dwordx4 v132, s[28:31], s20 offen lds
 s_add_u32 m0, s19, 7168
 s_add_u32 s20, s23, 962560
 buffer_load_dwordx4 v132, s[28:31], s20 offen lds
 s_add_u32 m0, s19, 8192
 s_add_u32 s20, s23, 983040
 buffer_load_dwordx4 v132, s[28:31], s20 offen lds
 s_add_u32 m0, s19, 9216
 s_add_u32 s20, s23, 1003520
 buffer_load_dwordx4 v132, s[28:31], s20 offen lds
 s_add_u32 m0, s19, 10240
 s_add_u32 s20, s23, 1024000
 buffer_load_dwordx4 v132, s[28:31], s20 offen lds
 s_add_u32 m0, s19, 11264
 s_add_u32 s20, s23, 1044480
 buffer_load_dwordx4 v132, s[28:31], s20 offen lds
 s_add_u32 m0, s19, 12288
 s_add_u32 s20, s23, 1064960
 buffer_load_dwordx4 v132, s[28:31], s20 offen lds
 s_add_u32 m0, s19, 13312
 s_add_u32 s20, s23, 1085440
 buffer_load_dwordx4 v132, s[28:31], s20 offen lds
 s_add_u32 m0, s19, 14336
 s_add_u32 s20, s23, 1105920
 buffer_load_dwordx4 v132, s[28:31], s20 offen lds
 s_add_u32 m0, s19, 15360
 s_add_u32 s20, s23, 1126400
 buffer_load_dwordx4 v132, s[28:31], s20 offen lds
 s_add_u32 m0, s19, 16384
 s_add_u32 s20, s23, 1146880
 buffer_load_dwordx4 v132, s[28:31], s20 offen lds
 s_add_u32 m0, s19, 17408
 s_add_u32 s20, s23, 1167360
 buffer_load_dwordx4 v132, s[28:31], s20 offen lds
 s_add_u32 m0, s19, 18432
 s_add_u32 s20, s23, 1187840
 buffer_load_dwordx4 v132, s[28:31], s20 offen lds
 s_add_u32 m0, s19, 19456
 s_add_u32 s20, s23, 1208320
 buffer_load_dwordx4 v132, s[28:31], s20 offen lds
 s_waitcnt vmcnt(20)
 ds_read_b64_tr_b16 a[40:41], v133 offset:20480
 ds_read_b64_tr_b16 a[42:43], v133 offset:21504
 ds_read_b64_tr_b16 a[232:233], v133 offset:20488
 ds_read_b64_tr_b16 a[234:235], v133 offset:21512
 ds_read_b64_tr_b16 a[44:45], v133 offset:22528
 ds_read_b64_tr_b16 a[46:47], v133 offset:23552
 ds_read_b64_tr_b16 a[236:237], v133 offset:22536
 ds_read_b64_tr_b16 a[238:239], v133 offset:23560
 ds_read_b64_tr_b16 a[48:49], v133 offset:24576
 ds_read_b64_tr_b16 a[50:51], v133 offset:25600
 ds_read_b64_tr_b16 a[240:241], v133 offset:24584
 ds_read_b64_tr_b16 a[242:243], v133 offset:25608
 ds_read_b64_tr_b16 a[52:53], v133 offset:26624
 ds_read_b64_tr_b16 a[54:55], v133 offset:27648
 ds_read_b64_tr_b16 a[244:245], v133 offset:26632
 ds_read_b64_tr_b16 a[246:247], v133 offset:27656
 ds_read_b64_tr_b16 a[56:57], v133 offset:28672
 ds_read_b64_tr_b16 a[58:59], v133 offset:29696
 ds_read_b64_tr_b16 a[248:249], v133 offset:28680
 ds_read_b64_tr_b16 a[250:251], v133 offset:29704
 ds_read_b64_tr_b16 a[60:61], v133 offset:30720
 ds_read_b64_tr_b16 a[62:63], v133 offset:31744
 ds_read_b64_tr_b16 a[252:253], v133 offset:30728
 ds_read_b64_tr_b16 a[254:255], v133 offset:31752
 ds_read_b64_tr_b16 a[64:65], v133 offset:32768
 ds_read_b64_tr_b16 a[66:67], v133 offset:33792
 ds_read_b64_tr_b16 v[4:5], v133 offset:32776
 ds_read_b64_tr_b16 v[6:7], v133 offset:33800
 ds_read_b64_tr_b16 a[68:69], v133 offset:34816
 ds_read_b64_tr_b16 a[70:71], v133 offset:35840
 ds_read_b64_tr_b16 v[8:9], v133 offset:34824
 ds_read_b64_tr_b16 v[10:11], v133 offset:35848
 ds_read_b64_tr_b16 a[72:73], v133 offset:36864
 ds_read_b64_tr_b16 a[74:75], v133 offset:37888
 ds_read_b64_tr_b16 v[12:13], v133 offset:36872
 ds_read_b64_tr_b16 v[14:15], v133 offset:37896
 ds_read_b64_tr_b16 a[76:77], v133 offset:38912
 ds_read_b64_tr_b16 a[78:79], v133 offset:39936
 ds_read_b64_tr_b16 v[16:17], v133 offset:38920
 ds_read_b64_tr_b16 v[18:19], v133 offset:39944
 s_waitcnt lgkmcnt(0)
 s_mul_i32 s19, s3, 40960
 s_add_u32 m0, s19, 20480
 s_add_u32 s20, s23, 1228800
 buffer_load_dwordx4 v132, s[28:31], s20 offen lds
 s_add_u32 m0, s19, 21504
 s_add_u32 s20, s23, 1249280
 buffer_load_dwordx4 v132, s[28:31], s20 offen lds
 s_add_u32 m0, s19, 22528
 s_add_u32 s20, s23, 1269760
 buffer_load_dwordx4 v132, s[28:31], s20 offen lds
 s_add_u32 m0, s19, 23552
 s_add_u32 s20, s23, 1290240
 buffer_load_dwordx4 v132, s[28:31], s20 offen lds
 s_add_u32 m0, s19, 24576
 s_add_u32 s20, s23, 1310720
 buffer_load_dwordx4 v132, s[28:31], s20 offen lds
 s_add_u32 m0, s19, 25600
 s_add_u32 s20, s23, 1331200
 buffer_load_dwordx4 v132, s[28:31], s20 offen lds
 s_add_u32 m0, s19, 26624
 s_add_u32 s20, s23, 1351680
 buffer_load_dwordx4 v132, s[28:31], s20 offen lds
 s_add_u32 m0, s19, 27648
 s_add_u32 s20, s23, 1372160
 buffer_load_dwordx4 v132, s[28:31], s20 offen lds
 s_add_u32 m0, s19, 28672
 s_add_u32 s20, s23, 1392640
 buffer_load_dwordx4 v132, s[28:31], s20 offen lds
 s_add_u32 m0, s19, 29696
 s_add_u32 s20, s23, 1413120
 buffer_load_dwordx4 v132, s[28:31], s20 offen lds
 s_add_u32 m0, s19, 30720
 s_add_u32 s20, s23, 1433600
 buffer_load_dwordx4 v132, s[28:31], s20 offen lds
 s_add_u32 m0, s19, 31744
 s_add_u32 s20, s23, 1454080
 buffer_load_dwordx4 v132, s[28:31], s20 offen lds
 s_add_u32 m0, s19, 32768
 s_add_u32 s20, s23, 1474560
 buffer_load_dwordx4 v132, s[28:31], s20 offen lds
 s_add_u32 m0, s19, 33792
 s_add_u32 s20, s23, 1495040
 buffer_load_dwordx4 v132, s[28:31], s20 offen lds
 s_add_u32 m0, s19, 34816
 s_add_u32 s20, s23, 1515520
 buffer_load_dwordx4 v132, s[28:31], s20 offen lds
 s_add_u32 m0, s19, 35840
 s_add_u32 s20, s23, 1536000
 buffer_load_dwordx4 v132, s[28:31], s20 offen lds
 s_add_u32 m0, s19, 36864
 s_add_u32 s20, s23, 1556480
 buffer_load_dwordx4 v132, s[28:31], s20 offen lds
 s_add_u32 m0, s19, 37888
 s_add_u32 s20, s23, 1576960
 buffer_load_dwordx4 v132, s[28:31], s20 offen lds
 s_add_u32 m0, s19, 38912
 s_add_u32 s20, s23, 1597440
 buffer_load_dwordx4 v132, s[28:31], s20 offen lds
 s_add_u32 m0, s19, 39936
 s_add_u32 s20, s23, 1617920
 buffer_load_dwordx4 v132, s[28:31], s20 offen lds
 s_waitcnt vmcnt(20)
 ds_read_b64_tr_b16 a[80:81], v133 offset:0
 ds_read_b64_tr_b16 a[82:83], v133 offset:1024
 ds_read_b64_tr_b16 v[20:21], v133 offset:8
 ds_read_b64_tr_b16 v[22:23], v133 offset:1032
 ds_read_b64_tr_b16 a[84:85], v133 offset:2048
 ds_read_b64_tr_b16 a[86:87], v133 offset:3072
 ds_read_b64_tr_b16 v[24:25], v133 offset:2056
 ds_read_b64_tr_b16 v[26:27], v133 offset:3080
 ds_read_b64_tr_b16 a[88:89], v133 offset:4096
 ds_read_b64_tr_b16 a[90:91], v133 offset:5120
 ds_read_b64_tr_b16 v[28:29], v133 offset:4104
 ds_read_b64_tr_b16 v[30:31], v133 offset:5128
 ds_read_b64_tr_b16 a[92:93], v133 offset:6144
 ds_read_b64_tr_b16 a[94:95], v133 offset:7168
 ds_read_b64_tr_b16 v[32:33], v133 offset:6152
 ds_read_b64_tr_b16 v[34:35], v133 offset:7176
 ds_read_b64_tr_b16 a[96:97], v133 offset:8192
 ds_read_b64_tr_b16 a[98:99], v133 offset:9216
 ds_read_b64_tr_b16 v[36:37], v133 offset:8200
 ds_read_b64_tr_b16 v[38:39], v133 offset:9224
 ds_read_b64_tr_b16 a[100:101], v133 offset:10240
 ds_read_b64_tr_b16 a[102:103], v133 offset:11264
 ds_read_b64_tr_b16 v[40:41], v133 offset:10248
 ds_read_b64_tr_b16 v[42:43], v133 offset:11272
 ds_read_b64_tr_b16 a[104:105], v133 offset:12288
 ds_read_b64_tr_b16 a[106:107], v133 offset:13312
 ds_read_b64_tr_b16 v[44:45], v133 offset:12296
 ds_read_b64_tr_b16 v[46:47], v133 offset:13320
 ds_read_b64_tr_b16 a[108:109], v133 offset:14336
 ds_read_b64_tr_b16 a[110:111], v133 offset:15360
 ds_read_b64_tr_b16 v[48:49], v133 offset:14344
 ds_read_b64_tr_b16 v[50:51], v133 offset:15368
 ds_read_b64_tr_b16 a[112:113], v133 offset:16384
 ds_read_b64_tr_b16 a[114:115], v133 offset:17408
 ds_read_b64_tr_b16 v[52:53], v133 offset:16392
 ds_read_b64_tr_b16 v[54:55], v133 offset:17416
 ds_read_b64_tr_b16 a[116:117], v133 offset:18432
 ds_read_b64_tr_b16 a[118:119], v133 offset:19456
 ds_read_b64_tr_b16 v[56:57], v133 offset:18440
 ds_read_b64_tr_b16 v[58:59], v133 offset:19464
 s_waitcnt lgkmcnt(0)
 s_mul_i32 s19, s3, 40960
 s_add_u32 m0, s19, 0
 s_add_u32 s20, s23, 1638400
 buffer_load_dwordx4 v132, s[28:31], s20 offen lds
 s_add_u32 m0, s19, 1024
 s_add_u32 s20, s23, 1658880
 buffer_load_dwordx4 v132, s[28:31], s20 offen lds
 s_add_u32 m0, s19, 2048
 s_add_u32 s20, s23, 1679360
 buffer_load_dwordx4 v132, s[28:31], s20 offen lds
 s_add_u32 m0, s19, 3072
 s_add_u32 s20, s23, 1699840
 buffer_load_dwordx4 v132, s[28:31], s20 offen lds
 s_add_u32 m0, s19, 4096
 s_add_u32 s20, s23, 1720320
 buffer_load_dwordx4 v132, s[28:31], s20 offen lds
 s_add_u32 m0, s19, 5120
 s_add_u32 s20, s23, 1740800
 buffer_load_dwordx4 v132, s[28:31], s20 offen lds
 s_add_u32 m0, s19, 6144
 s_add_u32 s20, s23, 1761280
 buffer_load_dwordx4 v132, s[28:31], s20 offen lds
 s_add_u32 m0, s19, 7168
 s_add_u32 s20, s23, 1781760
 buffer_load_dwordx4 v132, s[28:31], s20 offen lds
 s_add_u32 m0, s19, 8192
 s_add_u32 s20, s23, 1802240
 buffer_load_dwordx4 v132, s[28:31], s20 offen lds
 s_add_u32 m0, s19, 9216
 s_add_u32 s20, s23, 1822720
 buffer_load_dwordx4 v132, s[28:31], s20 offen lds
 s_add_u32 m0, s19, 10240
 s_add_u32 s20, s23, 1843200
 buffer_load_dwordx4 v132, s[28:31], s20 offen lds
 s_add_u32 m0, s19, 11264
 s_add_u32 s20, s23, 1863680
 buffer_load_dwordx4 v132, s[28:31], s20 offen lds
 s_add_u32 m0, s19, 12288
 s_add_u32 s20, s23, 1884160
 buffer_load_dwordx4 v132, s[28:31], s20 offen lds
 s_add_u32 m0, s19, 13312
 s_add_u32 s20, s23, 1904640
 buffer_load_dwordx4 v132, s[28:31], s20 offen lds
 s_add_u32 m0, s19, 14336
 s_add_u32 s20, s23, 1925120
 buffer_load_dwordx4 v132, s[28:31], s20 offen lds
 s_add_u32 m0, s19, 15360
 s_add_u32 s20, s23, 1945600
 buffer_load_dwordx4 v132, s[28:31], s20 offen lds
 s_waitcnt vmcnt(16)
 ds_read_b64_tr_b16 a[120:121], v133 offset:20480
 ds_read_b64_tr_b16 a[122:123], v133 offset:21504
 ds_read_b64_tr_b16 v[60:61], v133 offset:20488
 ds_read_b64_tr_b16 v[62:63], v133 offset:21512
 ds_read_b64_tr_b16 a[124:125], v133 offset:22528
 ds_read_b64_tr_b16 a[126:127], v133 offset:23552
 ds_read_b64_tr_b16 v[64:65], v133 offset:22536
 ds_read_b64_tr_b16 v[66:67], v133 offset:23560
 ds_read_b64_tr_b16 a[128:129], v133 offset:24576
 ds_read_b64_tr_b16 a[130:131], v133 offset:25600
 ds_read_b64_tr_b16 v[68:69], v133 offset:24584
 ds_read_b64_tr_b16 v[70:71], v133 offset:25608
 ds_read_b64_tr_b16 a[132:133], v133 offset:26624
 ds_read_b64_tr_b16 a[134:135], v133 offset:27648
 ds_read_b64_tr_b16 v[72:73], v133 offset:26632
 ds_read_b64_tr_b16 v[74:75], v133 offset:27656
 ds_read_b64_tr_b16 a[136:137], v133 offset:28672
 ds_read_b64_tr_b16 a[138:139], v133 offset:29696
 ds_read_b64_tr_b16 v[76:77], v133 offset:28680
 ds_read_b64_tr_b16 v[78:79], v133 offset:29704
 ds_read_b64_tr_b16 a[140:141], v133 offset:30720
 ds_read_b64_tr_b16 a[142:143], v133 offset:31744
 ds_read_b64_tr_b16 v[80:81], v133 offset:30728
 ds_read_b64_tr_b16 v[82:83], v133 offset:31752
 ds_read_b64_tr_b16 a[144:145], v133 offset:32768
 ds_read_b64_tr_b16 a[146:147], v133 offset:33792
 ds_read_b64_tr_b16 v[84:85], v133 offset:32776
 ds_read_b64_tr_b16 v[86:87], v133 offset:33800
 ds_read_b64_tr_b16 a[148:149], v133 offset:34816
 ds_read_b64_tr_b16 a[150:151], v133 offset:35840
 ds_read_b64_tr_b16 v[88:89], v133 offset:34824
 ds_read_b64_tr_b16 v[90:91], v133 offset:35848
 ds_read_b64_tr_b16 a[152:153], v133 offset:36864
 ds_read_b64_tr_b16 a[154:155], v133 offset:37888
 ds_read_b64_tr_b16 v[92:93], v133 offset:36872
 ds_read_b64_tr_b16 v[94:95], v133 offset:37896
 ds_read_b64_tr_b16 a[156:157], v133 offset:38912
 ds_read_b64_tr_b16 a[158:159], v133 offset:39936
 ds_read_b64_tr_b16 v[96:97], v133 offset:38920
 ds_read_b64_tr_b16 v[98:99], v133 offset:39944
 s_waitcnt lgkmcnt(0)
 s_waitcnt vmcnt(0)
 ds_read_b64_tr_b16 a[160:161], v133 offset:0
 ds_read_b64_tr_b16 a[162:163], v133 offset:1024
 ds_read_b64_tr_b16 v[100:101], v133 offset:8
 ds_read_b64_tr_b16 v[102:103], v133 offset:1032
 ds_read_b64_tr_b16 a[164:165], v133 offset:2048
 ds_read_b64_tr_b16 a[166:167], v133 offset:3072
 ds_read_b64_tr_b16 v[104:105], v133 offset:2056
 ds_read_b64_tr_b16 v[106:107], v133 offset:3080
 ds_read_b64_tr_b16 a[168:169], v133 offset:4096
 ds_read_b64_tr_b16 a[170:171], v133 offset:5120
 ds_read_b64_tr_b16 v[108:109], v133 offset:4104
 ds_read_b64_tr_b16 v[110:111], v133 offset:5128
 ds_read_b64_tr_b16 a[172:173], v133 offset:6144
 ds_read_b64_tr_b16 a[174:175], v133 offset:7168
 ds_read_b64_tr_b16 v[112:113], v133 offset:6152
 ds_read_b64_tr_b16 v[114:115], v133 offset:7176
 ds_read_b64_tr_b16 a[176:177], v133 offset:8192
 ds_read_b64_tr_b16 a[178:179], v133 offset:9216
 ds_read_b64_tr_b16 v[116:117], v133 offset:8200
 ds_read_b64_tr_b16 v[118:119], v133 offset:9224
 ds_read_b64_tr_b16 a[180:181], v133 offset:10240
 ds_read_b64_tr_b16 a[182:183], v133 offset:11264
 ds_read_b64_tr_b16 v[120:121], v133 offset:10248
 ds_read_b64_tr_b16 v[122:123], v133 offset:11272
 ds_read_b64_tr_b16 a[184:185], v133 offset:12288
 ds_read_b64_tr_b16 a[186:187], v133 offset:13312
 ds_read_b64_tr_b16 v[124:125], v133 offset:12296
 ds_read_b64_tr_b16 v[126:127], v133 offset:13320
 ds_read_b64_tr_b16 a[188:189], v133 offset:14336
 ds_read_b64_tr_b16 a[190:191], v133 offset:15360
 ds_read_b64_tr_b16 v[128:129], v133 offset:14344
 ds_read_b64_tr_b16 v[130:131], v133 offset:15368
 s_waitcnt lgkmcnt(0)
 s_barrier
 s_cmp_eq_u32 s13, 1
 s_cbranch_scc1 Lverok_386
 s_mov_b32 s18, 0
Lver_385:
 s_add_u32 s18, s18, 1
 s_cmp_gt_u32 s18, 200000
 s_cbranch_scc1 L_fail
 v_and_b32 v254, 7, v0
 v_lshlrev_b32 v254, 2, v254
 buffer_load_dword v255, v254, s[8:11], 0 offen sc1
 s_waitcnt vmcnt(0)
 v_cmp_eq_u32 vcc, 32, v255
 s_nop 0
 s_cmp_eq_u64 vcc, -1
 s_cbranch_scc1 Lverok_386
 s_mov_b32 s17, 0
 v_readlane_b32 s14, v255, 0
 s_nop 0
 s_add_u32 s17, s17, s14
 v_readlane_b32 s14, v255, 1
 s_nop 0
 s_add_u32 s17, s17, s14
 v_readlane_b32 s14, v255, 2
 s_nop 0
 s_add_u32 s17, s17, s14
 v_readlane_b32 s14, v255, 3
 s_nop 0
 s_add_u32 s17, s17, s14
 v_readlane_b32 s14, v255, 4
 s_nop 0
 s_add_u32 s17, s17, s14
 v_readlane_b32 s14, v255, 5
 s_nop 0
 s_add_u32 s17, s17, s14
 v_readlane_b32 s14, v255, 6
 s_nop 0
 s_add_u32 s17, s17, s14
 v_readlane_b32 s14, v255, 7
 s_nop 0
 s_add_u32 s17, s17, s14
 s_cmp_eq_u32 s17, 256
 s_cbranch_scc1 L_fallback
 s_branch Lver_385
Lverok_386:
 v_min_u32 v132, 11, v1
 v_lshlrev_b32 v132, 7, v132
 s_lshl_b32 s19, s25, 13
 s_add_u32 s19, s19, 204800
 v_add_u32 v132, s19, v132
 v_and_b32 v133, 15, v1
 v_lshrrev_b32 v136, 4, v1
 v_mul_u32_u24 v135, 1280, v133
 v_lshl_add_u32 v135, v136, 4, v135
 v_add_u32 v135, s42, v135
 v_lshlrev_b32 v133, 6, v133
 v_lshl_add_u32 v133, v136, 4, v133
 v_add_u32 v134, 49152, v2
 s_lshl_b32 s40, s3, 10
 v_lshlrev_b32 v136, 1, v135
 s_cmp_eq_u32 s25, 1
 s_cbranch_scc1 L_d_final
 v_mov_b32 v137, 163776
 v_mov_b32 v194, 0
 ds_write_b32 v137, v194
 s_waitcnt lgkmcnt(0)
 s_barrier
 s_mov_b32 s44, 0
 s_mov_b32 s45, 1
 s_mul_i32 s39, s44, 98304
 s_add_u32 s39, s39, 234782720
 s_add_u32 s39, s39, s40
 s_mov_b32 s24, 0
 s_branch Lds_393
Ldc_387:
 s_mov_b32 s24, 0
 s_waitcnt vmcnt(0)
 s_mov_b64 exec, 1
 v_mov_b32 v194, 1
 ds_add_rtn_u32 v194, v137, v194
 s_waitcnt lgkmcnt(0)
 v_readfirstlane_b32 s48, v194
 s_nop 0
 s_and_b32 s48, s48, 3
 s_cmp_eq_u32 s48, 3
 s_cbranch_scc0 Lar_395
 v_mov_b32 v194, s47
 buffer_store_dword v194, off, s[4:7], s38 sc1
Lar_395:
 s_mov_b64 exec, -1
 s_cmp_ge_u32 s44, 64
 s_cbranch_scc1 Ldd_392
Lds_393:
 s_add_u32 s24, s24, 1
 s_cmp_gt_u32 s24, 200000
 s_cbranch_scc1 L_fail
 buffer_load_dword v3, v132, s[4:7], 0 offen sc1
 s_waitcnt vmcnt(0)
 v_cmp_le_u32 vcc, s45, v3
 s_nop 0
 s_cmp_eq_u64 vcc, -1
 s_cbranch_scc0 Lds_393
Ldg_394:
 s_add_u32 m0, s40, 0
 s_add_u32 s19, s39, 0
 buffer_load_dwordx4 v2, s[4:7], s19 offen sc1 lds
 s_add_u32 m0, s40, 4096
 s_add_u32 s19, s39, 4096
 buffer_load_dwordx4 v2, s[4:7], s19 offen sc1 lds
 s_add_u32 m0, s40, 8192
 s_add_u32 s19, s39, 8192
 buffer_load_dwordx4 v2, s[4:7], s19 offen sc1 lds
 s_add_u32 m0, s40, 12288
 s_add_u32 s19, s39, 12288
 buffer_load_dwordx4 v2, s[4:7], s19 offen sc1 lds
 s_add_u32 m0, s40, 16384
 s_add_u32 s19, s39, 16384
 buffer_load_dwordx4 v2, s[4:7], s19 offen sc1 lds
 s_add_u32 m0, s40, 20480
 s_add_u32 s19, s39, 20480
 buffer_load_dwordx4 v2, s[4:7], s19 offen sc1 lds
 s_add_u32 m0, s40, 24576
 s_add_u32 s19, s39, 24576
 buffer_load_dwordx4 v2, s[4:7], s19 offen sc1 lds
 s_add_u32 m0, s40, 28672
 s_add_u32 s19, s39, 28672
 buffer_load_dwordx4 v2, s[4:7], s19 offen sc1 lds
 s_add_u32 m0, s40, 32768
 s_add_u32 s19, s39, 32768
 buffer_load_dwordx4 v2, s[4:7], s19 offen sc1 lds
 s_mov_b32 s46, 0
 s_waitcnt vmcnt(8)
 s_barrier
 ds_read_b128 v[154:157], v2 offset:0
 ds_read_b128 v[158:161], v2 offset:1024
 ds_read_b128 v[162:165], v2 offset:2048
 ds_read_b128 v[166:169], v2 offset:3072
 s_waitcnt vmcnt(6)
 s_barrier
 ds_read_b128 v[170:173], v2 offset:4096
 ds_read_b128 v[174:177], v2 offset:5120
 s_waitcnt lgkmcnt(5)
 v_mfma_f32_16x16x32_bf16 v[138:141], a[0:3], v[154:157], 0
 s_add_u32 m0, s40, 36864
 s_add_u32 s19, s39, 36864
 buffer_load_dwordx4 v2, s[4:7], s19 offen sc1 lds
 v_mfma_f32_16x16x32_bf16 v[146:149], a[192:195], v[154:157], 0
 s_waitcnt lgkmcnt(4)
 v_mfma_f32_16x16x32_bf16 v[142:145], a[0:3], v[158:161], 0
 v_mfma_f32_16x16x32_bf16 v[150:153], a[192:195], v[158:161], 0
 ds_read_b128 v[154:157], v2 offset:6144
 ds_read_b128 v[158:161], v2 offset:7168
 s_waitcnt lgkmcnt(4)
 v_mfma_f32_16x16x32_bf16 v[138:141], a[4:7], v[162:165], v[138:141]
 s_add_u32 m0, s40, 40960
 s_add_u32 s19, s39, 40960
 buffer_load_dwordx4 v2, s[4:7], s19 offen sc1 lds
 v_mfma_f32_16x16x32_bf16 v[146:149], a[196:199], v[162:165], v[146:149]
 v_mfma_f32_16x16x32_bf16 v[142:145], a[4:7], v[166:169], v[142:145]
 v_mfma_f32_16x16x32_bf16 v[150:153], a[196:199], v[166:169], v[150:153]
 ds_read_b128 v[162:165], v2 offset:8192
 ds_read_b128 v[166:169], v2 offset:9216
 s_waitcnt lgkmcnt(4)
 v_mfma_f32_16x16x32_bf16 v[138:141], a[8:11], v[170:173], v[138:141]
 s_add_u32 m0, s40, 45056
 s_add_u32 s19, s39, 45056
 buffer_load_dwordx4 v2, s[4:7], s19 offen sc1 lds
 v_mfma_f32_16x16x32_bf16 v[146:149], a[200:203], v[170:173], v[146:149]
 v_mfma_f32_16x16x32_bf16 v[142:145], a[8:11], v[174:177], v[142:145]
 v_mfma_f32_16x16x32_bf16 v[150:153], a[200:203], v[174:177], v[150:153]
 ds_read_b128 v[170:173], v2 offset:10240
 ds_read_b128 v[174:177], v2 offset:11264
 s_waitcnt lgkmcnt(4)
 v_mfma_f32_16x16x32_bf16 v[138:141], a[12:15], v[154:157], v[138:141]
 s_add_u32 m0, s40, 49152
 s_add_u32 s19, s39, 49152
 buffer_load_dwordx4 v2, s[4:7], s19 offen sc1 lds
 v_mfma_f32_16x16x32_bf16 v[146:149], a[204:207], v[154:157], v[146:149]
 v_mfma_f32_16x16x32_bf16 v[142:145], a[12:15], v[158:161], v[142:145]
 v_mfma_f32_16x16x32_bf16 v[150:153], a[204:207], v[158:161], v[150:153]
 s_waitcnt vmcnt(8)
 s_barrier
 ds_read_b128 v[154:157], v2 offset:12288
 ds_read_b128 v[158:161], v2 offset:13312
 s_waitcnt lgkmcnt(4)
 v_mfma_f32_16x16x32_bf16 v[138:141], a[16:19], v[162:165], v[138:141]
 s_add_u32 m0, s40, 53248
 s_add_u32 s19, s39, 53248
 buffer_load_dwordx4 v2, s[4:7], s19 offen sc1 lds
 v_mfma_f32_16x16x32_bf16 v[146:149], a[208:211], v[162:165], v[146:149]
 v_mfma_f32_16x16x32_bf16 v[142:145], a[16:19], v[166:169], v[142:145]
 v_mfma_f32_16x16x32_bf16 v[150:153], a[208:211], v[166:169], v[150:153]
 ds_read_b128 v[162:165], v2 offset:14336
 ds_read_b128 v[166:169], v2 offset:15360
 s_waitcnt lgkmcnt(4)
 v_mfma_f32_16x16x32_bf16 v[138:141], a[20:23], v[170:173], v[138:141]
 s_add_u32 m0, s40, 57344
 s_add_u32 s19, s39, 57344
 buffer_load_dwordx4 v2, s[4:7], s19 offen sc1 lds
 v_mfma_f32_16x16x32_bf16 v[146:149], a[212:215], v[170:173], v[146:149]
 v_mfma_f32_16x16x32_bf16 v[142:145], a[20:23], v[174:177], v[142:145]
 v_mfma_f32_16x16x32_bf16 v[150:153], a[212:215], v[174:177], v[150:153]
 ds_read_b128 v[170:173], v2 offset:16384
 ds_read_b128 v[174:177], v2 offset:17408
 s_waitcnt lgkmcnt(4)
 v_mfma_f32_16x16x32_bf16 v[138:141], a[24:27], v[154:157], v[138:141]
 s_add_u32 m0, s40, 61440
 s_add_u32 s19, s39, 61440
 buffer_load_dwordx4 v2, s[4:7], s19 offen sc1 lds
 v_mfma_f32_16x16x32_bf16 v[146:149], a[216:219], v[154:157], v[146:149]
 v_mfma_f32_16x16x32_bf16 v[142:145], a[24:27], v[158:161], v[142:145]
 v_mfma_f32_16x16x32_bf16 v[150:153], a[216:219], v[158:161], v[150:153]
 ds_read_b128 v[154:157], v2 offset:18432
 ds_read_b128 v[158:161], v2 offset:19456
 s_waitcnt lgkmcnt(4)
 v_mfma_f32_16x16x32_bf16 v[138:141], a[28:31], v[162:165], v[138:141]
 s_add_u32 m0, s40, 65536
 s_add_u32 s19, s39, 65536
 buffer_load_dwordx4 v2, s[4:7], s19 offen sc1 lds
 v_mfma_f32_16x16x32_bf16 v[146:149], a[220:223], v[162:165], v[146:149]
 v_mfma_f32_16x16x32_bf16 v[142:145], a[28:31], v[166:169], v[142:145]
 v_mfma_f32_16x16x32_bf16 v[150:153], a[220:223], v[166:169], v[150:153]
 s_waitcnt vmcnt(10)
 s_barrier
 ds_read_b128 v[162:165], v2 offset:20480
 ds_read_b128 v[166:169], v2 offset:21504
 s_waitcnt lgkmcnt(4)
 v_mfma_f32_16x16x32_bf16 v[138:141], a[32:35], v[170:173], v[138:141]
 s_add_u32 m0, s40, 69632
 s_add_u32 s19, s39, 69632
 buffer_load_dwordx4 v2, s[4:7], s19 offen sc1 lds
 v_mfma_f32_16x16x32_bf16 v[146:149], a[224:227], v[170:173], v[146:149]
 v_mfma_f32_16x16x32_bf16 v[142:145], a[32:35], v[174:177], v[142:145]
 v_mfma_f32_16x16x32_bf16 v[150:153], a[224:227], v[174:177], v[150:153]
 ds_read_b128 v[170:173], v2 offset:22528
 ds_read_b128 v[174:177], v2 offset:23552
 s_waitcnt lgkmcnt(4)
 v_mfma_f32_16x16x32_bf16 v[138:141], a[36:39], v[154:157], v[138:141]
 s_add_u32 m0, s40, 73728
 s_add_u32 s19, s39, 73728
 buffer_load_dwordx4 v2, s[4:7], s19 offen sc1 lds
 v_mfma_f32_16x16x32_bf16 v[146:149], a[228:231], v[154:157], v[146:149]
 v_mfma_f32_16x16x32_bf16 v[142:145], a[36:39], v[158:161], v[142:145]
 v_mfma_f32_16x16x32_bf16 v[150:153], a[228:231], v[158:161], v[150:153]
 ds_read_b128 v[154:157], v2 offset:24576
 ds_read_b128 v[158:161], v2 offset:25600
 s_waitcnt lgkmcnt(4)
 v_mfma_f32_16x16x32_bf16 v[138:141], a[40:43], v[162:165], v[138:141]
 s_add_u32 m0, s40, 77824
 s_add_u32 s19, s39, 77824
 buffer_load_dwordx4 v2, s[4:7], s19 offen sc1 lds
 v_mfma_f32_16x16x32_bf16 v[146:149], a[232:235], v[162:165], v[146:149]
 v_mfma_f32_16x16x32_bf16 v[142:145], a[40:43], v[166:169], v[142:145]
 v_mfma_f32_16x16x32_bf16 v[150:153], a[232:235], v[166:169], v[150:153]
 ds_read_b128 v[162:165], v2 offset:26624
 ds_read_b128 v[166:169], v2 offset:27648
 s_waitcnt lgkmcnt(4)
 v_mfma_f32_16x16x32_bf16 v[138:141], a[44:47], v[170:173], v[138:141]
 s_add_u32 m0, s40, 81920
 s_add_u32 s19, s39, 81920
 buffer_load_dwordx4 v2, s[4:7], s19 offen sc1 lds
 v_mfma_f32_16x16x32_bf16 v[146:149], a[236:239], v[170:173], v[146:149]
 v_mfma_f32_16x16x32_bf16 v[142:145], a[44:47], v[174:177], v[142:145]
 v_mfma_f32_16x16x32_bf16 v[150:153], a[236:239], v[174:177], v[150:153]
 s_branch Ldm_390
Ldw_388:
 s_mov_b32 s46, 1
 s_waitcnt vmcnt(12)
 s_barrier
 ds_read_b128 v[154:157], v2 offset:0
 ds_read_b128 v[158:161], v2 offset:1024
 ds_read_b128 v[162:165], v2 offset:2048
 ds_read_b128 v[166:169], v2 offset:3072
 s_waitcnt vmcnt(10)
 s_barrier
 ds_read_b128 v[170:173], v2 offset:4096
 ds_read_b128 v[174:177], v2 offset:5120
 s_waitcnt lgkmcnt(5)
 v_mfma_f32_16x16x32_bf16 v[138:141], a[0:3], v[154:157], 0
 s_add_u32 m0, s40, 36864
 s_add_u32 s19, s39, 36864
 buffer_load_dwordx4 v2, s[4:7], s19 offen sc1 lds
 v_mfma_f32_16x16x32_bf16 v[146:149], a[192:195], v[154:157], 0
 s_waitcnt lgkmcnt(4)
 v_mfma_f32_16x16x32_bf16 v[142:145], a[0:3], v[158:161], 0
 v_mfma_f32_16x16x32_bf16 v[150:153], a[192:195], v[158:161], 0
 ds_read_b128 v[154:157], v2 offset:6144
 ds_read_b128 v[158:161], v2 offset:7168
 s_waitcnt lgkmcnt(4)
 v_mfma_f32_16x16x32_bf16 v[138:141], a[4:7], v[162:165], v[138:141]
 s_add_u32 m0, s40, 40960
 s_add_u32 s19, s39, 40960
 buffer_load_dwordx4 v2, s[4:7], s19 offen sc1 lds
 v_mfma_f32_16x16x32_bf16 v[146:149], a[196:199], v[162:165], v[146:149]
 v_mfma_f32_16x16x32_bf16 v[142:145], a[4:7], v[166:169], v[142:145]
 v_mfma_f32_16x16x32_bf16 v[150:153], a[196:199], v[166:169], v[150:153]
 ds_read_b128 v[162:165], v2 offset:8192
 ds_read_b128 v[166:169], v2 offset:9216
 s_waitcnt lgkmcnt(4)
 v_mfma_f32_16x16x32_bf16 v[138:141], a[8:11], v[170:173], v[138:141]
 s_add_u32 m0, s40, 45056
 s_add_u32 s19, s39, 45056
 buffer_load_dwordx4 v2, s[4:7], s19 offen sc1 lds
 v_mfma_f32_16x16x32_bf16 v[146:149], a[200:203], v[170:173], v[146:149]
 v_mfma_f32_16x16x32_bf16 v[142:145], a[8:11], v[174:177], v[142:145]
 v_mfma_f32_16x16x32_bf16 v[150:153], a[200:203], v[174:177], v[150:153]
 ds_read_b128 v[170:173], v2 offset:10240
 ds_read_b128 v[174:177], v2 offset:11264
 s_waitcnt lgkmcnt(4)
 v_mfma_f32_16x16x32_bf16 v[138:141], a[12:15], v[154:157], v[138:141]
 s_add_u32 m0, s40, 49152
 s_add_u32 s19, s39, 49152
 buffer_load_dwordx4 v2, s[4:7], s19 offen sc1 lds
 v_mfma_f32_16x16x32_bf16 v[146:149], a[204:207], v[154:157], v[146:149]
 v_mfma_f32_16x16x32_bf16 v[142:145], a[12:15], v[158:161], v[142:145]
 v_mfma_f32_16x16x32_bf16 v[150:153], a[204:207], v[158:161], v[150:153]
 s_waitcnt vmcnt(12)
 s_barrier
 ds_read_b128 v[154:157], v2 offset:12288
 ds_read_b128 v[158:161], v2 offset:13312
 s_waitcnt lgkmcnt(4)
 v_mfma_f32_16x16x32_bf16 v[138:141], a[16:19], v[162:165], v[138:141]
 s_add_u32 m0, s40, 53248
 s_add_u32 s19, s39, 53248
 buffer_load_dwordx4 v2, s[4:7], s19 offen sc1 lds
 v_mfma_f32_16x16x32_bf16 v[146:149], a[208:211], v[162:165], v[146:149]
 v_mfma_f32_16x16x32_bf16 v[142:145], a[16:19], v[166:169], v[142:145]
 v_mfma_f32_16x16x32_bf16 v[150:153], a[208:211], v[166:169], v[150:153]
 ds_read_b128 v[162:165], v2 offset:14336
 ds_read_b128 v[166:169], v2 offset:15360
 s_waitcnt lgkmcnt(4)
 v_mfma_f32_16x16x32_bf16 v[138:141], a[20:23], v[170:173], v[138:141]
 s_add_u32 m0, s40, 57344
 s_add_u32 s19, s39, 57344
 buffer_load_dwordx4 v2, s[4:7], s19 offen sc1 lds
 v_mfma_f32_16x16x32_bf16 v[146:149], a[212:215], v[170:173], v[146:149]
 v_mfma_f32_16x16x32_bf16 v[142:145], a[20:23], v[174:177], v[142:145]
 v_mfma_f32_16x16x32_bf16 v[150:153], a[212:215], v[174:177], v[150:153]
 ds_read_b128 v[170:173], v2 offset:16384
 ds_read_b128 v[174:177], v2 offset:17408
 s_waitcnt lgkmcnt(4)
 v_mfma_f32_16x16x32_bf16 v[138:141], a[24:27], v[154:157], v[138:141]
 s_add_u32 m0, s40, 61440
 s_add_u32 s19, s39, 61440
 buffer_load_dwordx4 v2, s[4:7], s19 offen sc1 lds
 v_mfma_f32_16x16x32_bf16 v[146:149], a[216:219], v[154:157], v[146:149]
 v_mfma_f32_16x16x32_bf16 v[142:145], a[24:27], v[158:161], v[142:145]
 v_mfma_f32_16x16x32_bf16 v[150:153], a[216:219], v[158:161], v[150:153]
 ds_read_b128 v[154:157], v2 offset:18432
 ds_read_b128 v[158:161], v2 offset:19456
 s_waitcnt lgkmcnt(4)
 v_mfma_f32_16x16x32_bf16 v[138:141], a[28:31], v[162:165], v[138:141]
 s_add_u32 m0, s40, 65536
 s_add_u32 s19, s39, 65536
 buffer_load_dwordx4 v2, s[4:7], s19 offen sc1 lds
 v_mfma_f32_16x16x32_bf16 v[146:149], a[220:223], v[162:165], v[146:149]
 v_mfma_f32_16x16x32_bf16 v[142:145], a[28:31], v[166:169], v[142:145]
 v_mfma_f32_16x16x32_bf16 v[150:153], a[220:223], v[166:169], v[150:153]
 s_waitcnt vmcnt(14)
 s_barrier
 ds_read_b128 v[162:165], v2 offset:20480
 ds_read_b128 v[166:169], v2 offset:21504
 s_waitcnt lgkmcnt(4)
 v_mfma_f32_16x16x32_bf16 v[138:141], a[32:35], v[170:173], v[138:141]
 s_add_u32 m0, s40, 69632
 s_add_u32 s19, s39, 69632
 buffer_load_dwordx4 v2, s[4:7], s19 offen sc1 lds
 v_mfma_f32_16x16x32_bf16 v[146:149], a[224:227], v[170:173], v[146:149]
 v_mfma_f32_16x16x32_bf16 v[142:145], a[32:35], v[174:177], v[142:145]
 v_mfma_f32_16x16x32_bf16 v[150:153], a[224:227], v[174:177], v[150:153]
 ds_read_b128 v[170:173], v2 offset:22528
 ds_read_b128 v[174:177], v2 offset:23552
 s_waitcnt lgkmcnt(4)
 v_mfma_f32_16x16x32_bf16 v[138:141], a[36:39], v[154:157], v[138:141]
 s_add_u32 m0, s40, 73728
 s_add_u32 s19, s39, 73728
 buffer_load_dwordx4 v2, s[4:7], s19 offen sc1 lds
 v_mfma_f32_16x16x32_bf16 v[146:149], a[228:231], v[154:157], v[146:149]
 v_mfma_f32_16x16x32_bf16 v[142:145], a[36:39], v[158:161], v[142:145]
 v_mfma_f32_16x16x32_bf16 v[150:153], a[228:231], v[158:161], v[150:153]
 ds_read_b128 v[154:157], v2 offset:24576
 ds_read_b128 v[158:161], v2 offset:25600
 s_waitcnt lgkmcnt(4)
 v_mfma_f32_16x16x32_bf16 v[138:141], a[40:43], v[162:165], v[138:141]
 s_add_u32 m0, s40, 77824
 s_add_u32 s19, s39, 77824
 buffer_load_dwordx4 v2, s[4:7], s19 offen sc1 lds
 v_mfma_f32_16x16x32_bf16 v[146:149], a[232:235], v[162:165], v[146:149]
 v_mfma_f32_16x16x32_bf16 v[142:145], a[40:43], v[166:169], v[142:145]
 v_mfma_f32_16x16x32_bf16 v[150:153], a[232:235], v[166:169], v[150:153]
 ds_read_b128 v[162:165], v2 offset:26624
 ds_read_b128 v[166:169], v2 offset:27648
 s_waitcnt lgkmcnt(4)
 v_mfma_f32_16x16x32_bf16 v[138:141], a[44:47], v[170:173], v[138:141]
 s_add_u32 m0, s40, 81920
 s_add_u32 s19, s39, 81920
 buffer_load_dwordx4 v2, s[4:7], s19 offen sc1 lds
 v_mfma_f32_16x16x32_bf16 v[146:149], a[236:239], v[170:173], v[146:149]
 v_mfma_f32_16x16x32_bf16 v[142:145], a[44:47], v[174:177], v[142:145]
 v_mfma_f32_16x16x32_bf16 v[150:153], a[236:239], v[174:177], v[150:153]
Ldm_390:
 s_waitcnt vmcnt(11)
 s_barrier
 ds_read_b128 v[170:173], v2 offset:28672
 ds_read_b128 v[174:177], v2 offset:29696
 s_waitcnt lgkmcnt(4)
 v_mfma_f32_16x16x32_bf16 v[138:141], a[48:51], v[154:157], v[138:141]
 s_add_u32 m0, s40, 86016
 s_add_u32 s19, s39, 86016
 buffer_load_dwordx4 v2, s[4:7], s19 offen sc1 lds
 v_mfma_f32_16x16x32_bf16 v[146:149], a[240:243], v[154:157], v[146:149]
 v_mfma_f32_16x16x32_bf16 v[142:145], a[48:51], v[158:161], v[142:145]
 v_mfma_f32_16x16x32_bf16 v[150:153], a[240:243], v[158:161], v[150:153]
 ds_read_b128 v[154:157], v2 offset:30720
 ds_read_b128 v[158:161], v2 offset:31744
 s_waitcnt lgkmcnt(4)
 v_mfma_f32_16x16x32_bf16 v[138:141], a[52:55], v[162:165], v[138:141]
 s_add_u32 m0, s40, 90112
 s_add_u32 s19, s39, 90112
 buffer_load_dwordx4 v2, s[4:7], s19 offen sc1 lds
 v_mfma_f32_16x16x32_bf16 v[146:149], a[244:247], v[162:165], v[146:149]
 v_mfma_f32_16x16x32_bf16 v[142:145], a[52:55], v[166:169], v[142:145]
 v_mfma_f32_16x16x32_bf16 v[150:153], a[244:247], v[166:169], v[150:153]
 ds_read_b128 v[162:165], v2 offset:32768
 ds_read_b128 v[166:169], v2 offset:33792
 s_waitcnt lgkmcnt(4)
 v_mfma_f32_16x16x32_bf16 v[138:141], a[56:59], v[170:173], v[138:141]
 s_add_u32 m0, s40, 94208
 s_add_u32 s19, s39, 94208
 buffer_load_dwordx4 v2, s[4:7], s19 offen sc1 lds
 v_mfma_f32_16x16x32_bf16 v[146:149], a[248:251], v[170:173], v[146:149]
 v_mfma_f32_16x16x32_bf16 v[142:145], a[56:59], v[174:177], v[142:145]
 v_mfma_f32_16x16x32_bf16 v[150:153], a[248:251], v[174:177], v[150:153]
 ds_read_b128 v[170:173], v2 offset:34816
 ds_read_b128 v[174:177], v2 offset:35840
 s_waitcnt lgkmcnt(4)
 v_mfma_f32_16x16x32_bf16 v[138:141], a[60:63], v[154:157], v[138:141]
 v_mfma_f32_16x16x32_bf16 v[146:149], a[252:255], v[154:157], v[146:149]
 v_mfma_f32_16x16x32_bf16 v[142:145], a[60:63], v[158:161], v[142:145]
 v_mfma_f32_16x16x32_bf16 v[150:153], a[252:255], v[158:161], v[150:153]
 ds_read_b128 v[154:157], v2 offset:36864
 ds_read_b128 v[158:161], v2 offset:37888
 s_waitcnt lgkmcnt(4)
 v_mfma_f32_16x16x32_bf16 v[138:141], a[64:67], v[162:165], v[138:141]
 v_mfma_f32_16x16x32_bf16 v[146:149], v[4:7], v[162:165], v[146:149]
 v_mfma_f32_16x16x32_bf16 v[142:145], a[64:67], v[166:169], v[142:145]
 v_mfma_f32_16x16x32_bf16 v[150:153], v[4:7], v[166:169], v[150:153]
 s_cmp_eq_u32 s46, 1
 s_cbranch_scc0 Lnp_396
 s_waitcnt vmcnt(15)
 s_mov_b64 exec, 1
 v_mov_b32 v194, 1
 ds_add_rtn_u32 v194, v137, v194
 s_waitcnt lgkmcnt(0)
 v_readfirstlane_b32 s48, v194
 s_nop 0
 s_and_b32 s48, s48, 3
 s_cmp_eq_u32 s48, 3
 s_cbranch_scc0 Lar_397
 v_mov_b32 v194, s47
 buffer_store_dword v194, off, s[4:7], s38 sc1
Lar_397:
 s_mov_b64 exec, -1
Lnp_396:
 ds_read_b128 v[162:165], v2 offset:38912
 ds_read_b128 v[166:169], v2 offset:39936
 s_waitcnt lgkmcnt(4)
 v_mfma_f32_16x16x32_bf16 v[138:141], a[68:71], v[170:173], v[138:141]
 v_mfma_f32_16x16x32_bf16 v[146:149], v[8:11], v[170:173], v[146:149]
 v_mfma_f32_16x16x32_bf16 v[142:145], a[68:71], v[174:177], v[142:145]
 v_mfma_f32_16x16x32_bf16 v[150:153], v[8:11], v[174:177], v[150:153]
 s_waitcnt vmcnt(9)
 s_barrier
 ds_read_b128 v[170:173], v2 offset:40960
 ds_read_b128 v[174:177], v2 offset:41984
 s_waitcnt lgkmcnt(4)
 v_mfma_f32_16x16x32_bf16 v[138:141], a[72:75], v[154:157], v[138:141]
 v_mfma_f32_16x16x32_bf16 v[146:149], v[12:15], v[154:157], v[146:149]
 v_mfma_f32_16x16x32_bf16 v[142:145], a[72:75], v[158:161], v[142:145]
 v_mfma_f32_16x16x32_bf16 v[150:153], v[12:15], v[158:161], v[150:153]
 ds_read_b128 v[154:157], v2 offset:43008
 ds_read_b128 v[158:161], v2 offset:44032
 s_waitcnt lgkmcnt(4)
 v_mfma_f32_16x16x32_bf16 v[138:141], a[76:79], v[162:165], v[138:141]
 v_mfma_f32_16x16x32_bf16 v[146:149], v[16:19], v[162:165], v[146:149]
 v_mfma_f32_16x16x32_bf16 v[142:145], a[76:79], v[166:169], v[142:145]
 v_mfma_f32_16x16x32_bf16 v[150:153], v[16:19], v[166:169], v[150:153]
 ds_read_b128 v[162:165], v2 offset:45056
 ds_read_b128 v[166:169], v2 offset:46080
 s_waitcnt lgkmcnt(4)
 v_mfma_f32_16x16x32_bf16 v[138:141], a[80:83], v[170:173], v[138:141]
 v_mfma_f32_16x16x32_bf16 v[146:149], v[20:23], v[170:173], v[146:149]
 v_mfma_f32_16x16x32_bf16 v[142:145], a[80:83], v[174:177], v[142:145]
 v_mfma_f32_16x16x32_bf16 v[150:153], v[20:23], v[174:177], v[150:153]
 ds_read_b128 v[170:173], v2 offset:47104
 ds_read_b128 v[174:177], v2 offset:48128
 s_waitcnt lgkmcnt(4)
 v_mfma_f32_16x16x32_bf16 v[138:141], a[84:87], v[154:157], v[138:141]
 v_mfma_f32_16x16x32_bf16 v[146:149], v[24:27], v[154:157], v[146:149]
 v_mfma_f32_16x16x32_bf16 v[142:145], a[84:87], v[158:161], v[142:145]
 v_mfma_f32_16x16x32_bf16 v[150:153], v[24:27], v[158:161], v[150:153]
 ds_read_b128 v[154:157], v134 offset:0
 ds_read_b128 v[158:161], v134 offset:1024
 s_waitcnt lgkmcnt(4)
 v_mfma_f32_16x16x32_bf16 v[138:141], a[88:91], v[162:165], v[138:141]
 v_mfma_f32_16x16x32_bf16 v[146:149], v[28:31], v[162:165], v[146:149]
 v_mfma_f32_16x16x32_bf16 v[142:145], a[88:91], v[166:169], v[142:145]
 v_mfma_f32_16x16x32_bf16 v[150:153], v[28:31], v[166:169], v[150:153]
 ds_read_b128 v[162:165], v134 offset:2048
 ds_read_b128 v[166:169], v134 offset:3072
 s_waitcnt lgkmcnt(4)
 v_mfma_f32_16x16x32_bf16 v[138:141], a[92:95], v[170:173], v[138:141]
 v_mfma_f32_16x16x32_bf16 v[146:149], v[32:35], v[170:173], v[146:149]
 v_mfma_f32_16x16x32_bf16 v[142:145], a[92:95], v[174:177], v[142:145]
 v_mfma_f32_16x16x32_bf16 v[150:153], v[32:35], v[174:177], v[150:153]
 ds_read_b128 v[170:173], v134 offset:4096
 ds_read_b128 v[174:177], v134 offset:5120
 s_waitcnt lgkmcnt(4)
 v_mfma_f32_16x16x32_bf16 v[138:141], a[96:99], v[154:157], v[138:141]
 v_mfma_f32_16x16x32_bf16 v[146:149], v[36:39], v[154:157], v[146:149]
 v_mfma_f32_16x16x32_bf16 v[142:145], a[96:99], v[158:161], v[142:145]
 v_mfma_f32_16x16x32_bf16 v[150:153], v[36:39], v[158:161], v[150:153]
 ds_read_b128 v[154:157], v134 offset:6144
 ds_read_b128 v[158:161], v134 offset:7168
 s_waitcnt lgkmcnt(4)
 v_mfma_f32_16x16x32_bf16 v[138:141], a[100:103], v[162:165], v[138:141]
 v_mfma_f32_16x16x32_bf16 v[146:149], v[40:43], v[162:165], v[146:149]
 v_mfma_f32_16x16x32_bf16 v[142:145], a[100:103], v[166:169], v[142:145]
 v_mfma_f32_16x16x32_bf16 v[150:153], v[40:43], v[166:169], v[150:153]
 ds_read_b128 v[162:165], v134 offset:8192
 ds_read_b128 v[166:169], v134 offset:9216
 s_waitcnt lgkmcnt(4)
 v_mfma_f32_16x16x32_bf16 v[138:141], a[104:107], v[170:173], v[138:141]
 v_mfma_f32_16x16x32_bf16 v[146:149], v[44:47], v[170:173], v[146:149]
 v_mfma_f32_16x16x32_bf16 v[142:145], a[104:107], v[174:177], v[142:145]
 v_mfma_f32_16x16x32_bf16 v[150:153], v[44:47], v[174:177], v[150:153]
 ds_read_b128 v[170:173], v134 offset:10240
 ds_read_b128 v[174:177], v134 offset:11264
 s_waitcnt lgkmcnt(4)
 v_mfma_f32_16x16x32_bf16 v[138:141], a[108:111], v[154:157], v[138:141]
 v_mfma_f32_16x16x32_bf16 v[146:149], v[48:51], v[154:157], v[146:149]
 v_mfma_f32_16x16x32_bf16 v[142:145], a[108:111], v[158:161], v[142:145]
 v_mfma_f32_16x16x32_bf16 v[150:153], v[48:51], v[158:161], v[150:153]
 s_waitcnt vmcnt(0)
 s_barrier
 ds_read_b128 v[154:157], v134 offset:12288
 ds_read_b128 v[158:161], v134 offset:13312
 s_waitcnt lgkmcnt(4)
 v_mfma_f32_16x16x32_bf16 v[138:141], a[112:115], v[162:165], v[138:141]
 v_mfma_f32_16x16x32_bf16 v[146:149], v[52:55], v[162:165], v[146:149]
 v_mfma_f32_16x16x32_bf16 v[142:145], a[112:115], v[166:169], v[142:145]
 v_mfma_f32_16x16x32_bf16 v[150:153], v[52:55], v[166:169], v[150:153]
 ds_read_b128 v[162:165], v134 offset:14336
 ds_read_b128 v[166:169], v134 offset:15360
 s_waitcnt lgkmcnt(4)
 v_mfma_f32_16x16x32_bf16 v[138:141], a[116:119], v[170:173], v[138:141]
 v_mfma_f32_16x16x32_bf16 v[146:149], v[56:59], v[170:173], v[146:149]
 v_mfma_f32_16x16x32_bf16 v[142:145], a[116:119], v[174:177], v[142:145]
 v_mfma_f32_16x16x32_bf16 v[150:153], v[56:59], v[174:177], v[150:153]
 ds_read_b128 v[170:173], v134 offset:16384
 ds_read_b128 v[174:177], v134 offset:17408
 s_waitcnt lgkmcnt(4)
 v_mfma_f32_16x16x32_bf16 v[138:141], a[120:123], v[154:157], v[138:141]
 buffer_load_dword v3, v132, s[4:7], 0 offen sc1
 v_mfma_f32_16x16x32_bf16 v[146:149], v[60:63], v[154:157], v[146:149]
 v_mfma_f32_16x16x32_bf16 v[142:145], a[120:123], v[158:161], v[142:145]
 v_mfma_f32_16x16x32_bf16 v[150:153], v[60:63], v[158:161], v[150:153]
 ds_read_b128 v[154:157], v134 offset:18432
 ds_read_b128 v[158:161], v134 offset:19456
 s_waitcnt lgkmcnt(4)
 v_mfma_f32_16x16x32_bf16 v[138:141], a[124:127], v[162:165], v[138:141]
 v_mfma_f32_16x16x32_bf16 v[146:149], v[64:67], v[162:165], v[146:149]
 v_mfma_f32_16x16x32_bf16 v[142:145], a[124:127], v[166:169], v[142:145]
 v_mfma_f32_16x16x32_bf16 v[150:153], v[64:67], v[166:169], v[150:153]
 ds_read_b128 v[162:165], v134 offset:20480
 ds_read_b128 v[166:169], v134 offset:21504
 s_waitcnt lgkmcnt(4)
 v_mfma_f32_16x16x32_bf16 v[138:141], a[128:131], v[170:173], v[138:141]
 v_mfma_f32_16x16x32_bf16 v[146:149], v[68:71], v[170:173], v[146:149]
 v_mfma_f32_16x16x32_bf16 v[142:145], a[128:131], v[174:177], v[142:145]
 v_mfma_f32_16x16x32_bf16 v[150:153], v[68:71], v[174:177], v[150:153]
 ds_read_b128 v[170:173], v134 offset:22528
 ds_read_b128 v[174:177], v134 offset:23552
 s_waitcnt lgkmcnt(4)
 v_mfma_f32_16x16x32_bf16 v[138:141], a[132:135], v[154:157], v[138:141]
 v_mfma_f32_16x16x32_bf16 v[146:149], v[72:75], v[154:157], v[146:149]
 v_mfma_f32_16x16x32_bf16 v[142:145], a[132:135], v[158:161], v[142:145]
 v_mfma_f32_16x16x32_bf16 v[150:153], v[72:75], v[158:161], v[150:153]
 ds_read_b128 v[154:157], v134 offset:24576
 ds_read_b128 v[158:161], v134 offset:25600
 s_waitcnt lgkmcnt(4)
 v_mfma_f32_16x16x32_bf16 v[138:141], a[136:139], v[162:165], v[138:141]
 v_mfma_f32_16x16x32_bf16 v[146:149], v[76:79], v[162:165], v[146:149]
 v_mfma_f32_16x16x32_bf16 v[142:145], a[136:139], v[166:169], v[142:145]
 v_mfma_f32_16x16x32_bf16 v[150:153], v[76:79], v[166:169], v[150:153]
 ds_read_b128 v[162:165], v134 offset:26624
 ds_read_b128 v[166:169], v134 offset:27648
 s_waitcnt lgkmcnt(4)
 v_mfma_f32_16x16x32_bf16 v[138:141], a[140:143], v[170:173], v[138:141]
 v_mfma_f32_16x16x32_bf16 v[146:149], v[80:83], v[170:173], v[146:149]
 v_mfma_f32_16x16x32_bf16 v[142:145], a[140:143], v[174:177], v[142:145]
 v_mfma_f32_16x16x32_bf16 v[150:153], v[80:83], v[174:177], v[150:153]
 ds_read_b128 v[170:173], v134 offset:28672
 ds_read_b128 v[174:177], v134 offset:29696
 s_waitcnt lgkmcnt(4)
 v_mfma_f32_16x16x32_bf16 v[138:141], a[144:147], v[154:157], v[138:141]
 v_mfma_f32_16x16x32_bf16 v[146:149], v[84:87], v[154:157], v[146:149]
 v_mfma_f32_16x16x32_bf16 v[142:145], a[144:147], v[158:161], v[142:145]
 v_mfma_f32_16x16x32_bf16 v[150:153], v[84:87], v[158:161], v[150:153]
 ds_read_b128 v[154:157], v134 offset:30720
 ds_read_b128 v[158:161], v134 offset:31744
 s_waitcnt lgkmcnt(4)
 v_mfma_f32_16x16x32_bf16 v[138:141], a[148:151], v[162:165], v[138:141]
 v_mfma_f32_16x16x32_bf16 v[146:149], v[88:91], v[162:165], v[146:149]
 v_mfma_f32_16x16x32_bf16 v[142:145], a[148:151], v[166:169], v[142:145]
 v_mfma_f32_16x16x32_bf16 v[150:153], v[88:91], v[166:169], v[150:153]
 s_mov_b32 s47, s45
 s_cmp_ge_u32 s45, 64
 s_cbranch_scc1 Ldn_391
 s_waitcnt vmcnt(0)
 v_cmp_lt_u32 vcc, s45, v3
 s_nop 0
 s_cmp_eq_u64 vcc, -1
 s_cbranch_scc0 Ldn_391
 s_mul_i32 s43, s44, 81920
 s_add_u32 s43, s43, s41
 s_mul_i32 s39, s45, 98304
 s_add_u32 s39, s39, 234782720
 s_add_u32 s39, s39, s40
 ds_read_b128 v[162:165], v134 offset:32768
 ds_read_b128 v[166:169], v134 offset:33792
 s_waitcnt lgkmcnt(4)
 v_mfma_f32_16x16x32_bf16 v[138:141], a[152:155], v[170:173], v[138:141]
 s_add_u32 m0, s40, 0
 s_add_u32 s19, s39, 0
 buffer_load_dwordx4 v2, s[4:7], s19 offen sc1 lds
 v_mfma_f32_16x16x32_bf16 v[146:149], v[92:95], v[170:173], v[146:149]
 v_mfma_f32_16x16x32_bf16 v[142:145], a[152:155], v[174:177], v[142:145]
 v_mfma_f32_16x16x32_bf16 v[150:153], v[92:95], v[174:177], v[150:153]
 ds_read_b128 v[170:173], v134 offset:34816
 ds_read_b128 v[174:177], v134 offset:35840
 s_waitcnt lgkmcnt(4)
 v_mfma_f32_16x16x32_bf16 v[138:141], a[156:159], v[154:157], v[138:141]
 s_add_u32 m0, s40, 4096
 s_add_u32 s19, s39, 4096
 buffer_load_dwordx4 v2, s[4:7], s19 offen sc1 lds
 v_mfma_f32_16x16x32_bf16 v[146:149], v[96:99], v[154:157], v[146:149]
 v_mfma_f32_16x16x32_bf16 v[142:145], a[156:159], v[158:161], v[142:145]
 v_mfma_f32_16x16x32_bf16 v[150:153], v[96:99], v[158:161], v[150:153]
 ds_read_b128 v[154:157], v134 offset:36864
 ds_read_b128 v[158:161], v134 offset:37888
 s_waitcnt lgkmcnt(4)
 v_mfma_f32_16x16x32_bf16 v[138:141], a[160:163], v[162:165], v[138:141]
 s_add_u32 m0, s40, 8192
 s_add_u32 s19, s39, 8192
 buffer_load_dwordx4 v2, s[4:7], s19 offen sc1 lds
 v_mfma_f32_16x16x32_bf16 v[146:149], v[100:103], v[162:165], v[146:149]
 v_mfma_f32_16x16x32_bf16 v[142:145], a[160:163], v[166:169], v[142:145]
 v_mfma_f32_16x16x32_bf16 v[150:153], v[100:103], v[166:169], v[150:153]
 ds_read_b128 v[162:165], v134 offset:38912
 ds_read_b128 v[166:169], v134 offset:39936
 s_waitcnt lgkmcnt(4)
 v_mfma_f32_16x16x32_bf16 v[138:141], a[164:167], v[170:173], v[138:141]
 s_add_u32 m0, s40, 12288
 s_add_u32 s19, s39, 12288
 buffer_load_dwordx4 v2, s[4:7], s19 offen sc1 lds
 v_mfma_f32_16x16x32_bf16 v[146:149], v[104:107], v[170:173], v[146:149]
 v_mfma_f32_16x16x32_bf16 v[142:145], a[164:167], v[174:177], v[142:145]
 v_mfma_f32_16x16x32_bf16 v[150:153], v[104:107], v[174:177], v[150:153]
 ds_read_b128 v[170:173], v134 offset:40960
 ds_read_b128 v[174:177], v134 offset:41984
 s_waitcnt lgkmcnt(4)
 v_mfma_f32_16x16x32_bf16 v[138:141], a[168:171], v[154:157], v[138:141]
 s_add_u32 m0, s40, 16384
 s_add_u32 s19, s39, 16384
 buffer_load_dwordx4 v2, s[4:7], s19 offen sc1 lds
 v_mfma_f32_16x16x32_bf16 v[146:149], v[108:111], v[154:157], v[146:149]
 v_mfma_f32_16x16x32_bf16 v[142:145], a[168:171], v[158:161], v[142:145]
 v_mfma_f32_16x16x32_bf16 v[150:153], v[108:111], v[158:161], v[150:153]
 ds_read_b128 v[154:157], v134 offset:43008
 ds_read_b128 v[158:161], v134 offset:44032
 s_waitcnt lgkmcnt(4)
 v_mfma_f32_16x16x32_bf16 v[138:141], a[172:175], v[162:165], v[138:141]
 s_add_u32 m0, s40, 20480
 s_add_u32 s19, s39, 20480
 buffer_load_dwordx4 v2, s[4:7], s19 offen sc1 lds
 v_mfma_f32_16x16x32_bf16 v[146:149], v[112:115], v[162:165], v[146:149]
 v_mfma_f32_16x16x32_bf16 v[142:145], a[172:175], v[166:169], v[142:145]
 v_mfma_f32_16x16x32_bf16 v[150:153], v[112:115], v[166:169], v[150:153]
 ds_read_b128 v[162:165], v134 offset:45056
 ds_read_b128 v[166:169], v134 offset:46080
 s_waitcnt lgkmcnt(4)
 v_mfma_f32_16x16x32_bf16 v[138:141], a[176:179], v[170:173], v[138:141]
 s_add_u32 m0, s40, 24576
 s_add_u32 s19, s39, 24576
 buffer_load_dwordx4 v2, s[4:7], s19 offen sc1 lds
 v_mfma_f32_16x16x32_bf16 v[146:149], v[116:119], v[170:173], v[146:149]
 v_mfma_f32_16x16x32_bf16 v[142:145], a[176:179], v[174:177], v[142:145]
 v_mfma_f32_16x16x32_bf16 v[150:153], v[116:119], v[174:177], v[150:153]
 ds_read_b128 v[170:173], v134 offset:47104
 ds_read_b128 v[174:177], v134 offset:48128
 s_waitcnt lgkmcnt(4)
 v_mfma_f32_16x16x32_bf16 v[138:141], a[180:183], v[154:157], v[138:141]
 s_add_u32 m0, s40, 28672
 s_add_u32 s19, s39, 28672
 buffer_load_dwordx4 v2, s[4:7], s19 offen sc1 lds
 v_mfma_f32_16x16x32_bf16 v[146:149], v[120:123], v[154:157], v[146:149]
 v_mfma_f32_16x16x32_bf16 v[142:145], a[180:183], v[158:161], v[142:145]
 v_mfma_f32_16x16x32_bf16 v[150:153], v[120:123], v[158:161], v[150:153]
 s_waitcnt lgkmcnt(3)
 v_mfma_f32_16x16x32_bf16 v[138:141], a[184:187], v[162:165], v[138:141]
 s_add_u32 m0, s40, 32768
 s_add_u32 s19, s39, 32768
 buffer_load_dwordx4 v2, s[4:7], s19 offen sc1 lds
 v_mfma_f32_16x16x32_bf16 v[146:149], v[124:127], v[162:165], v[146:149]
 s_waitcnt lgkmcnt(2)
 v_mfma_f32_16x16x32_bf16 v[142:145], a[184:187], v[166:169], v[142:145]
 v_mfma_f32_16x16x32_bf16 v[150:153], v[124:127], v[166:169], v[150:153]
 s_waitcnt lgkmcnt(1)
 v_mfma_f32_16x16x32_bf16 v[138:141], a[188:191], v[170:173], v[138:141]
 v_mfma_f32_16x16x32_bf16 v[146:149], v[128:131], v[170:173], v[146:149]
 s_waitcnt lgkmcnt(0)
 v_mfma_f32_16x16x32_bf16 v[142:145], a[188:191], v[174:177], v[142:145]
 v_mfma_f32_16x16x32_bf16 v[150:153], v[128:131], v[174:177], v[150:153]
 buffer_store_dwordx4 v[138:141], v133, s[4:7], s43 offen offset:0 sc1
 s_nop 0
 buffer_store_dwordx4 v[146:149], v133, s[4:7], s43 offen offset:1024 sc1
 s_nop 1
 buffer_store_dwordx4 v[142:145], v133, s[4:7], s43 offen offset:2048 sc1
 s_nop 1
 buffer_store_dwordx4 v[150:153], v133, s[4:7], s43 offen offset:3072 sc1
 s_mov_b32 s44, s45
 s_add_u32 s45, s45, 1
 s_branch Ldw_388
Ldn_391:
 s_mul_i32 s43, s44, 81920
 s_add_u32 s43, s43, s41
 s_mul_i32 s39, s45, 98304
 s_add_u32 s39, s39, 234782720
 s_add_u32 s39, s39, s40
 ds_read_b128 v[162:165], v134 offset:32768
 ds_read_b128 v[166:169], v134 offset:33792
 s_waitcnt lgkmcnt(4)
 v_mfma_f32_16x16x32_bf16 v[138:141], a[152:155], v[170:173], v[138:141]
 v_mfma_f32_16x16x32_bf16 v[146:149], v[92:95], v[170:173], v[146:149]
 v_mfma_f32_16x16x32_bf16 v[142:145], a[152:155], v[174:177], v[142:145]
 v_mfma_f32_16x16x32_bf16 v[150:153], v[92:95], v[174:177], v[150:153]
 ds_read_b128 v[170:173], v134 offset:34816
 ds_read_b128 v[174:177], v134 offset:35840
 s_waitcnt lgkmcnt(4)
 v_mfma_f32_16x16x32_bf16 v[138:141], a[156:159], v[154:157], v[138:141]
 v_mfma_f32_16x16x32_bf16 v[146:149], v[96:99], v[154:157], v[146:149]
 v_mfma_f32_16x16x32_bf16 v[142:145], a[156:159], v[158:161], v[142:145]
 v_mfma_f32_16x16x32_bf16 v[150:153], v[96:99], v[158:161], v[150:153]
 ds_read_b128 v[154:157], v134 offset:36864
 ds_read_b128 v[158:161], v134 offset:37888
 s_waitcnt lgkmcnt(4)
 v_mfma_f32_16x16x32_bf16 v[138:141], a[160:163], v[162:165], v[138:141]
 v_mfma_f32_16x16x32_bf16 v[146:149], v[100:103], v[162:165], v[146:149]
 v_mfma_f32_16x16x32_bf16 v[142:145], a[160:163], v[166:169], v[142:145]
 v_mfma_f32_16x16x32_bf16 v[150:153], v[100:103], v[166:169], v[150:153]
 ds_read_b128 v[162:165], v134 offset:38912
 ds_read_b128 v[166:169], v134 offset:39936
 s_waitcnt lgkmcnt(4)
 v_mfma_f32_16x16x32_bf16 v[138:141], a[164:167], v[170:173], v[138:141]
 v_mfma_f32_16x16x32_bf16 v[146:149], v[104:107], v[170:173], v[146:149]
 v_mfma_f32_16x16x32_bf16 v[142:145], a[164:167], v[174:177], v[142:145]
 v_mfma_f32_16x16x32_bf16 v[150:153], v[104:107], v[174:177], v[150:153]
 ds_read_b128 v[170:173], v134 offset:40960
 ds_read_b128 v[174:177], v134 offset:41984
 s_waitcnt lgkmcnt(4)
 v_mfma_f32_16x16x32_bf16 v[138:141], a[168:171], v[154:157], v[138:141]
 v_mfma_f32_16x16x32_bf16 v[146:149], v[108:111], v[154:157], v[146:149]
 v_mfma_f32_16x16x32_bf16 v[142:145], a[168:171], v[158:161], v[142:145]
 v_mfma_f32_16x16x32_bf16 v[150:153], v[108:111], v[158:161], v[150:153]
 ds_read_b128 v[154:157], v134 offset:43008
 ds_read_b128 v[158:161], v134 offset:44032
 s_waitcnt lgkmcnt(4)
 v_mfma_f32_16x16x32_bf16 v[138:141], a[172:175], v[162:165], v[138:141]
 v_mfma_f32_16x16x32_bf16 v[146:149], v[112:115], v[162:165], v[146:149]
 v_mfma_f32_16x16x32_bf16 v[142:145], a[172:175], v[166:169], v[142:145]
 v_mfma_f32_16x16x32_bf16 v[150:153], v[112:115], v[166:169], v[150:153]
 ds_read_b128 v[162:165], v134 offset:45056
 ds_read_b128 v[166:169], v134 offset:46080
 s_waitcnt lgkmcnt(4)
 v_mfma_f32_16x16x32_bf16 v[138:141], a[176:179], v[170:173], v[138:141]
 v_mfma_f32_16x16x32_bf16 v[146:149], v[116:119], v[170:173], v[146:149]
 v_mfma_f32_16x16x32_bf16 v[142:145], a[176:179], v[174:177], v[142:145]
 v_mfma_f32_16x16x32_bf16 v[150:153], v[116:119], v[174:177], v[150:153]
 ds_read_b128 v[170:173], v134 offset:47104
 ds_read_b128 v[174:177], v134 offset:48128
 s_waitcnt lgkmcnt(4)
 v_mfma_f32_16x16x32_bf16 v[138:141], a[180:183], v[154:157], v[138:141]
 v_mfma_f32_16x16x32_bf16 v[146:149], v[120:123], v[154:157], v[146:149]
 v_mfma_f32_16x16x32_bf16 v[142:145], a[180:183], v[158:161], v[142:145]
 v_mfma_f32_16x16x32_bf16 v[150:153], v[120:123], v[158:161], v[150:153]
 s_waitcnt lgkmcnt(3)
 v_mfma_f32_16x16x32_bf16 v[138:141], a[184:187], v[162:165], v[138:141]
 v_mfma_f32_16x16x32_bf16 v[146:149], v[124:127], v[162:165], v[146:149]
 s_waitcnt lgkmcnt(2)
 v_mfma_f32_16x16x32_bf16 v[142:145], a[184:187], v[166:169], v[142:145]
 v_mfma_f32_16x16x32_bf16 v[150:153], v[124:127], v[166:169], v[150:153]
 s_waitcnt lgkmcnt(1)
 v_mfma_f32_16x16x32_bf16 v[138:141], a[188:191], v[170:173], v[138:141]
 v_mfma_f32_16x16x32_bf16 v[146:149], v[128:131], v[170:173], v[146:149]
 s_waitcnt lgkmcnt(0)
 v_mfma_f32_16x16x32_bf16 v[142:145], a[188:191], v[174:177], v[142:145]
 v_mfma_f32_16x16x32_bf16 v[150:153], v[128:131], v[174:177], v[150:153]
 buffer_store_dwordx4 v[138:141], v133, s[4:7], s43 offen offset:0 sc1
 s_nop 0
 buffer_store_dwordx4 v[146:149], v133, s[4:7], s43 offen offset:1024 sc1
 s_nop 1
 buffer_store_dwordx4 v[142:145], v133, s[4:7], s43 offen offset:2048 sc1
 s_nop 1
 buffer_store_dwordx4 v[150:153], v133, s[4:7], s43 offen offset:3072 sc1
 s_mov_b32 s44, s45
 s_add_u32 s45, s45, 1
 s_branch Ldc_387
Ldd_392:
 s_endpgm
L_d_final:
 s_mov_b32 s49, 0
 s_mov_b32 s50, 1
 s_mul_i32 s39, s49, 98304
 s_add_u32 s39, s39, 234782720
 s_add_u32 s39, s39, s40
 s_mov_b32 s24, 0
 s_branch Lds_404
Ldc_398:
 s_mov_b32 s24, 0
 s_waitcnt vmcnt(0)
 s_cmp_ge_u32 s49, 64
 s_cbranch_scc1 Ldd_403
Lds_404:
 s_add_u32 s24, s24, 1
 s_cmp_gt_u32 s24, 200000
 s_cbranch_scc1 L_fail
 buffer_load_dword v3, v132, s[4:7], 0 offen sc1
 s_waitcnt vmcnt(0)
 v_cmp_le_u32 vcc, s50, v3
 s_nop 0
 s_cmp_eq_u64 vcc, -1
 s_cbranch_scc0 Lds_404
Ldg_405:
 s_add_u32 m0, s40, 0
 s_add_u32 s19, s39, 0
 buffer_load_dwordx4 v2, s[4:7], s19 offen sc1 lds
 s_add_u32 m0, s40, 4096
 s_add_u32 s19, s39, 4096
 buffer_load_dwordx4 v2, s[4:7], s19 offen sc1 lds
 s_add_u32 m0, s40, 8192
 s_add_u32 s19, s39, 8192
 buffer_load_dwordx4 v2, s[4:7], s19 offen sc1 lds
 s_add_u32 m0, s40, 12288
 s_add_u32 s19, s39, 12288
 buffer_load_dwordx4 v2, s[4:7], s19 offen sc1 lds
 s_add_u32 m0, s40, 16384
 s_add_u32 s19, s39, 16384
 buffer_load_dwordx4 v2, s[4:7], s19 offen sc1 lds
 s_add_u32 m0, s40, 20480
 s_add_u32 s19, s39, 20480
 buffer_load_dwordx4 v2, s[4:7], s19 offen sc1 lds
 s_add_u32 m0, s40, 24576
 s_add_u32 s19, s39, 24576
 buffer_load_dwordx4 v2, s[4:7], s19 offen sc1 lds
 s_add_u32 m0, s40, 28672
 s_add_u32 s19, s39, 28672
 buffer_load_dwordx4 v2, s[4:7], s19 offen sc1 lds
 s_add_u32 m0, s40, 32768
 s_add_u32 s19, s39, 32768
 buffer_load_dwordx4 v2, s[4:7], s19 offen sc1 lds
 s_mov_b32 s51, 0
 s_waitcnt vmcnt(8)
 s_barrier
 ds_read_b128 v[154:157], v2 offset:0
 ds_read_b128 v[158:161], v2 offset:1024
 ds_read_b128 v[162:165], v2 offset:2048
 ds_read_b128 v[166:169], v2 offset:3072
 s_waitcnt vmcnt(6)
 s_barrier
 ds_read_b128 v[170:173], v2 offset:4096
 ds_read_b128 v[174:177], v2 offset:5120
 s_waitcnt lgkmcnt(5)
 v_mfma_f32_16x16x32_bf16 v[138:141], a[0:3], v[154:157], 0
 s_add_u32 m0, s40, 36864
 s_add_u32 s19, s39, 36864
 buffer_load_dwordx4 v2, s[4:7], s19 offen sc1 lds
 v_mfma_f32_16x16x32_bf16 v[146:149], a[192:195], v[154:157], 0
 s_waitcnt lgkmcnt(4)
 v_mfma_f32_16x16x32_bf16 v[142:145], a[0:3], v[158:161], 0
 v_mfma_f32_16x16x32_bf16 v[150:153], a[192:195], v[158:161], 0
 ds_read_b128 v[154:157], v2 offset:6144
 ds_read_b128 v[158:161], v2 offset:7168
 s_waitcnt lgkmcnt(4)
 v_mfma_f32_16x16x32_bf16 v[138:141], a[4:7], v[162:165], v[138:141]
 s_add_u32 m0, s40, 40960
 s_add_u32 s19, s39, 40960
 buffer_load_dwordx4 v2, s[4:7], s19 offen sc1 lds
 v_mfma_f32_16x16x32_bf16 v[146:149], a[196:199], v[162:165], v[146:149]
 v_mfma_f32_16x16x32_bf16 v[142:145], a[4:7], v[166:169], v[142:145]
 v_mfma_f32_16x16x32_bf16 v[150:153], a[196:199], v[166:169], v[150:153]
 ds_read_b128 v[162:165], v2 offset:8192
 ds_read_b128 v[166:169], v2 offset:9216
 s_waitcnt lgkmcnt(4)
 v_mfma_f32_16x16x32_bf16 v[138:141], a[8:11], v[170:173], v[138:141]
 s_add_u32 m0, s40, 45056
 s_add_u32 s19, s39, 45056
 buffer_load_dwordx4 v2, s[4:7], s19 offen sc1 lds
 v_mfma_f32_16x16x32_bf16 v[146:149], a[200:203], v[170:173], v[146:149]
 v_mfma_f32_16x16x32_bf16 v[142:145], a[8:11], v[174:177], v[142:145]
 v_mfma_f32_16x16x32_bf16 v[150:153], a[200:203], v[174:177], v[150:153]
 ds_read_b128 v[170:173], v2 offset:10240
 ds_read_b128 v[174:177], v2 offset:11264
 s_waitcnt lgkmcnt(4)
 v_mfma_f32_16x16x32_bf16 v[138:141], a[12:15], v[154:157], v[138:141]
 s_add_u32 m0, s40, 49152
 s_add_u32 s19, s39, 49152
 buffer_load_dwordx4 v2, s[4:7], s19 offen sc1 lds
 v_mfma_f32_16x16x32_bf16 v[146:149], a[204:207], v[154:157], v[146:149]
 v_mfma_f32_16x16x32_bf16 v[142:145], a[12:15], v[158:161], v[142:145]
 v_mfma_f32_16x16x32_bf16 v[150:153], a[204:207], v[158:161], v[150:153]
 s_waitcnt vmcnt(8)
 s_barrier
 ds_read_b128 v[154:157], v2 offset:12288
 ds_read_b128 v[158:161], v2 offset:13312
 s_waitcnt lgkmcnt(4)
 v_mfma_f32_16x16x32_bf16 v[138:141], a[16:19], v[162:165], v[138:141]
 s_add_u32 m0, s40, 53248
 s_add_u32 s19, s39, 53248
 buffer_load_dwordx4 v2, s[4:7], s19 offen sc1 lds
 v_mfma_f32_16x16x32_bf16 v[146:149], a[208:211], v[162:165], v[146:149]
 v_mfma_f32_16x16x32_bf16 v[142:145], a[16:19], v[166:169], v[142:145]
 v_mfma_f32_16x16x32_bf16 v[150:153], a[208:211], v[166:169], v[150:153]
 ds_read_b128 v[162:165], v2 offset:14336
 ds_read_b128 v[166:169], v2 offset:15360
 s_waitcnt lgkmcnt(4)
 v_mfma_f32_16x16x32_bf16 v[138:141], a[20:23], v[170:173], v[138:141]
 s_add_u32 m0, s40, 57344
 s_add_u32 s19, s39, 57344
 buffer_load_dwordx4 v2, s[4:7], s19 offen sc1 lds
 v_mfma_f32_16x16x32_bf16 v[146:149], a[212:215], v[170:173], v[146:149]
 v_mfma_f32_16x16x32_bf16 v[142:145], a[20:23], v[174:177], v[142:145]
 v_mfma_f32_16x16x32_bf16 v[150:153], a[212:215], v[174:177], v[150:153]
 ds_read_b128 v[170:173], v2 offset:16384
 ds_read_b128 v[174:177], v2 offset:17408
 s_waitcnt lgkmcnt(4)
 v_mfma_f32_16x16x32_bf16 v[138:141], a[24:27], v[154:157], v[138:141]
 s_add_u32 m0, s40, 61440
 s_add_u32 s19, s39, 61440
 buffer_load_dwordx4 v2, s[4:7], s19 offen sc1 lds
 v_mfma_f32_16x16x32_bf16 v[146:149], a[216:219], v[154:157], v[146:149]
 v_mfma_f32_16x16x32_bf16 v[142:145], a[24:27], v[158:161], v[142:145]
 v_mfma_f32_16x16x32_bf16 v[150:153], a[216:219], v[158:161], v[150:153]
 ds_read_b128 v[154:157], v2 offset:18432
 ds_read_b128 v[158:161], v2 offset:19456
 s_waitcnt lgkmcnt(4)
 v_mfma_f32_16x16x32_bf16 v[138:141], a[28:31], v[162:165], v[138:141]
 s_add_u32 m0, s40, 65536
 s_add_u32 s19, s39, 65536
 buffer_load_dwordx4 v2, s[4:7], s19 offen sc1 lds
 v_mfma_f32_16x16x32_bf16 v[146:149], a[220:223], v[162:165], v[146:149]
 v_mfma_f32_16x16x32_bf16 v[142:145], a[28:31], v[166:169], v[142:145]
 v_mfma_f32_16x16x32_bf16 v[150:153], a[220:223], v[166:169], v[150:153]
 s_waitcnt vmcnt(10)
 s_barrier
 ds_read_b128 v[162:165], v2 offset:20480
 ds_read_b128 v[166:169], v2 offset:21504
 s_waitcnt lgkmcnt(4)
 v_mfma_f32_16x16x32_bf16 v[138:141], a[32:35], v[170:173], v[138:141]
 s_add_u32 m0, s40, 69632
 s_add_u32 s19, s39, 69632
 buffer_load_dwordx4 v2, s[4:7], s19 offen sc1 lds
 v_mfma_f32_16x16x32_bf16 v[146:149], a[224:227], v[170:173], v[146:149]
 v_mfma_f32_16x16x32_bf16 v[142:145], a[32:35], v[174:177], v[142:145]
 v_mfma_f32_16x16x32_bf16 v[150:153], a[224:227], v[174:177], v[150:153]
 ds_read_b128 v[170:173], v2 offset:22528
 ds_read_b128 v[174:177], v2 offset:23552
 s_waitcnt lgkmcnt(4)
 v_mfma_f32_16x16x32_bf16 v[138:141], a[36:39], v[154:157], v[138:141]
 s_add_u32 m0, s40, 73728
 s_add_u32 s19, s39, 73728
 buffer_load_dwordx4 v2, s[4:7], s19 offen sc1 lds
 v_mfma_f32_16x16x32_bf16 v[146:149], a[228:231], v[154:157], v[146:149]
 v_mfma_f32_16x16x32_bf16 v[142:145], a[36:39], v[158:161], v[142:145]
 v_mfma_f32_16x16x32_bf16 v[150:153], a[228:231], v[158:161], v[150:153]
 ds_read_b128 v[154:157], v2 offset:24576
 ds_read_b128 v[158:161], v2 offset:25600
 s_waitcnt lgkmcnt(4)
 v_mfma_f32_16x16x32_bf16 v[138:141], a[40:43], v[162:165], v[138:141]
 s_add_u32 m0, s40, 77824
 s_add_u32 s19, s39, 77824
 buffer_load_dwordx4 v2, s[4:7], s19 offen sc1 lds
 v_mfma_f32_16x16x32_bf16 v[146:149], a[232:235], v[162:165], v[146:149]
 v_mfma_f32_16x16x32_bf16 v[142:145], a[40:43], v[166:169], v[142:145]
 v_mfma_f32_16x16x32_bf16 v[150:153], a[232:235], v[166:169], v[150:153]
 ds_read_b128 v[162:165], v2 offset:26624
 ds_read_b128 v[166:169], v2 offset:27648
 s_waitcnt lgkmcnt(4)
 v_mfma_f32_16x16x32_bf16 v[138:141], a[44:47], v[170:173], v[138:141]
 s_add_u32 m0, s40, 81920
 s_add_u32 s19, s39, 81920
 buffer_load_dwordx4 v2, s[4:7], s19 offen sc1 lds
 v_mfma_f32_16x16x32_bf16 v[146:149], a[236:239], v[170:173], v[146:149]
 v_mfma_f32_16x16x32_bf16 v[142:145], a[44:47], v[174:177], v[142:145]
 v_mfma_f32_16x16x32_bf16 v[150:153], a[236:239], v[174:177], v[150:153]
 s_branch Ldm_401
Ldw_399:
 s_mov_b32 s51, 1
 s_waitcnt vmcnt(10)
 s_barrier
 ds_read_b128 v[154:157], v2 offset:0
 ds_read_b128 v[158:161], v2 offset:1024
 ds_read_b128 v[162:165], v2 offset:2048
 ds_read_b128 v[166:169], v2 offset:3072
 s_waitcnt vmcnt(8)
 s_barrier
 ds_read_b128 v[170:173], v2 offset:4096
 ds_read_b128 v[174:177], v2 offset:5120
 s_waitcnt lgkmcnt(5)
 v_mfma_f32_16x16x32_bf16 v[138:141], a[0:3], v[154:157], 0
 s_add_u32 m0, s40, 36864
 s_add_u32 s19, s39, 36864
 buffer_load_dwordx4 v2, s[4:7], s19 offen sc1 lds
 v_mfma_f32_16x16x32_bf16 v[146:149], a[192:195], v[154:157], 0
 s_waitcnt lgkmcnt(4)
 v_mfma_f32_16x16x32_bf16 v[142:145], a[0:3], v[158:161], 0
 v_mfma_f32_16x16x32_bf16 v[150:153], a[192:195], v[158:161], 0
 ds_read_b128 v[154:157], v2 offset:6144
 ds_read_b128 v[158:161], v2 offset:7168
 s_waitcnt lgkmcnt(4)
 v_mfma_f32_16x16x32_bf16 v[138:141], a[4:7], v[162:165], v[138:141]
 s_add_u32 m0, s40, 40960
 s_add_u32 s19, s39, 40960
 buffer_load_dwordx4 v2, s[4:7], s19 offen sc1 lds
 v_mfma_f32_16x16x32_bf16 v[146:149], a[196:199], v[162:165], v[146:149]
 v_mfma_f32_16x16x32_bf16 v[142:145], a[4:7], v[166:169], v[142:145]
 v_mfma_f32_16x16x32_bf16 v[150:153], a[196:199], v[166:169], v[150:153]
 ds_read_b128 v[162:165], v2 offset:8192
 ds_read_b128 v[166:169], v2 offset:9216
 s_waitcnt lgkmcnt(4)
 v_mfma_f32_16x16x32_bf16 v[138:141], a[8:11], v[170:173], v[138:141]
 s_add_u32 m0, s40, 45056
 s_add_u32 s19, s39, 45056
 buffer_load_dwordx4 v2, s[4:7], s19 offen sc1 lds
 v_mfma_f32_16x16x32_bf16 v[146:149], a[200:203], v[170:173], v[146:149]
 v_mfma_f32_16x16x32_bf16 v[142:145], a[8:11], v[174:177], v[142:145]
 v_mfma_f32_16x16x32_bf16 v[150:153], a[200:203], v[174:177], v[150:153]
 ds_read_b128 v[170:173], v2 offset:10240
 ds_read_b128 v[174:177], v2 offset:11264
 s_waitcnt lgkmcnt(4)
 v_mfma_f32_16x16x32_bf16 v[138:141], a[12:15], v[154:157], v[138:141]
 s_add_u32 m0, s40, 49152
 s_add_u32 s19, s39, 49152
 buffer_load_dwordx4 v2, s[4:7], s19 offen sc1 lds
 v_mfma_f32_16x16x32_bf16 v[146:149], a[204:207], v[154:157], v[146:149]
 v_mfma_f32_16x16x32_bf16 v[142:145], a[12:15], v[158:161], v[142:145]
 v_mfma_f32_16x16x32_bf16 v[150:153], a[204:207], v[158:161], v[150:153]
 s_waitcnt vmcnt(10)
 s_barrier
 ds_read_b128 v[154:157], v2 offset:12288
 ds_read_b128 v[158:161], v2 offset:13312
 s_waitcnt lgkmcnt(4)
 v_mfma_f32_16x16x32_bf16 v[138:141], a[16:19], v[162:165], v[138:141]
 s_add_u32 m0, s40, 53248
 s_add_u32 s19, s39, 53248
 buffer_load_dwordx4 v2, s[4:7], s19 offen sc1 lds
 v_mfma_f32_16x16x32_bf16 v[146:149], a[208:211], v[162:165], v[146:149]
 v_mfma_f32_16x16x32_bf16 v[142:145], a[16:19], v[166:169], v[142:145]
 v_mfma_f32_16x16x32_bf16 v[150:153], a[208:211], v[166:169], v[150:153]
 ds_read_b128 v[162:165], v2 offset:14336
 ds_read_b128 v[166:169], v2 offset:15360
 s_waitcnt lgkmcnt(4)
 v_mfma_f32_16x16x32_bf16 v[138:141], a[20:23], v[170:173], v[138:141]
 s_add_u32 m0, s40, 57344
 s_add_u32 s19, s39, 57344
 buffer_load_dwordx4 v2, s[4:7], s19 offen sc1 lds
 v_mfma_f32_16x16x32_bf16 v[146:149], a[212:215], v[170:173], v[146:149]
 v_mfma_f32_16x16x32_bf16 v[142:145], a[20:23], v[174:177], v[142:145]
 v_mfma_f32_16x16x32_bf16 v[150:153], a[212:215], v[174:177], v[150:153]
 ds_read_b128 v[170:173], v2 offset:16384
 ds_read_b128 v[174:177], v2 offset:17408
 s_waitcnt lgkmcnt(4)
 v_mfma_f32_16x16x32_bf16 v[138:141], a[24:27], v[154:157], v[138:141]
 s_add_u32 m0, s40, 61440
 s_add_u32 s19, s39, 61440
 buffer_load_dwordx4 v2, s[4:7], s19 offen sc1 lds
 v_mfma_f32_16x16x32_bf16 v[146:149], a[216:219], v[154:157], v[146:149]
 v_mfma_f32_16x16x32_bf16 v[142:145], a[24:27], v[158:161], v[142:145]
 v_mfma_f32_16x16x32_bf16 v[150:153], a[216:219], v[158:161], v[150:153]
 ds_read_b128 v[154:157], v2 offset:18432
 ds_read_b128 v[158:161], v2 offset:19456
 s_waitcnt lgkmcnt(4)
 v_mfma_f32_16x16x32_bf16 v[138:141], a[28:31], v[162:165], v[138:141]
 s_add_u32 m0, s40, 65536
 s_add_u32 s19, s39, 65536
 buffer_load_dwordx4 v2, s[4:7], s19 offen sc1 lds
 v_mfma_f32_16x16x32_bf16 v[146:149], a[220:223], v[162:165], v[146:149]
 v_mfma_f32_16x16x32_bf16 v[142:145], a[28:31], v[166:169], v[142:145]
 v_mfma_f32_16x16x32_bf16 v[150:153], a[220:223], v[166:169], v[150:153]
 s_waitcnt vmcnt(12)
 s_barrier
 ds_read_b128 v[162:165], v2 offset:20480
 ds_read_b128 v[166:169], v2 offset:21504
 s_waitcnt lgkmcnt(4)
 v_mfma_f32_16x16x32_bf16 v[138:141], a[32:35], v[170:173], v[138:141]
 s_add_u32 m0, s40, 69632
 s_add_u32 s19, s39, 69632
 buffer_load_dwordx4 v2, s[4:7], s19 offen sc1 lds
 v_mfma_f32_16x16x32_bf16 v[146:149], a[224:227], v[170:173], v[146:149]
 v_mfma_f32_16x16x32_bf16 v[142:145], a[32:35], v[174:177], v[142:145]
 v_mfma_f32_16x16x32_bf16 v[150:153], a[224:227], v[174:177], v[150:153]
 ds_read_b128 v[170:173], v2 offset:22528
 ds_read_b128 v[174:177], v2 offset:23552
 s_waitcnt lgkmcnt(4)
 v_mfma_f32_16x16x32_bf16 v[138:141], a[36:39], v[154:157], v[138:141]
 s_add_u32 m0, s40, 73728
 s_add_u32 s19, s39, 73728
 buffer_load_dwordx4 v2, s[4:7], s19 offen sc1 lds
 v_mfma_f32_16x16x32_bf16 v[146:149], a[228:231], v[154:157], v[146:149]
 v_mfma_f32_16x16x32_bf16 v[142:145], a[36:39], v[158:161], v[142:145]
 v_mfma_f32_16x16x32_bf16 v[150:153], a[228:231], v[158:161], v[150:153]
 ds_read_b128 v[154:157], v2 offset:24576
 ds_read_b128 v[158:161], v2 offset:25600
 s_waitcnt lgkmcnt(4)
 v_mfma_f32_16x16x32_bf16 v[138:141], a[40:43], v[162:165], v[138:141]
 s_add_u32 m0, s40, 77824
 s_add_u32 s19, s39, 77824
 buffer_load_dwordx4 v2, s[4:7], s19 offen sc1 lds
 v_mfma_f32_16x16x32_bf16 v[146:149], a[232:235], v[162:165], v[146:149]
 v_mfma_f32_16x16x32_bf16 v[142:145], a[40:43], v[166:169], v[142:145]
 v_mfma_f32_16x16x32_bf16 v[150:153], a[232:235], v[166:169], v[150:153]
 ds_read_b128 v[162:165], v2 offset:26624
 ds_read_b128 v[166:169], v2 offset:27648
 s_waitcnt lgkmcnt(4)
 v_mfma_f32_16x16x32_bf16 v[138:141], a[44:47], v[170:173], v[138:141]
 s_add_u32 m0, s40, 81920
 s_add_u32 s19, s39, 81920
 buffer_load_dwordx4 v2, s[4:7], s19 offen sc1 lds
 v_mfma_f32_16x16x32_bf16 v[146:149], a[236:239], v[170:173], v[146:149]
 v_mfma_f32_16x16x32_bf16 v[142:145], a[44:47], v[174:177], v[142:145]
 v_mfma_f32_16x16x32_bf16 v[150:153], a[236:239], v[174:177], v[150:153]
Ldm_401:
 s_waitcnt vmcnt(11)
 s_barrier
 ds_read_b128 v[170:173], v2 offset:28672
 ds_read_b128 v[174:177], v2 offset:29696
 s_waitcnt lgkmcnt(4)
 v_mfma_f32_16x16x32_bf16 v[138:141], a[48:51], v[154:157], v[138:141]
 s_add_u32 m0, s40, 86016
 s_add_u32 s19, s39, 86016
 buffer_load_dwordx4 v2, s[4:7], s19 offen sc1 lds
 v_mfma_f32_16x16x32_bf16 v[146:149], a[240:243], v[154:157], v[146:149]
 v_mfma_f32_16x16x32_bf16 v[142:145], a[48:51], v[158:161], v[142:145]
 v_mfma_f32_16x16x32_bf16 v[150:153], a[240:243], v[158:161], v[150:153]
 ds_read_b128 v[154:157], v2 offset:30720
 ds_read_b128 v[158:161], v2 offset:31744
 s_waitcnt lgkmcnt(4)
 v_mfma_f32_16x16x32_bf16 v[138:141], a[52:55], v[162:165], v[138:141]
 s_add_u32 m0, s40, 90112
 s_add_u32 s19, s39, 90112
 buffer_load_dwordx4 v2, s[4:7], s19 offen sc1 lds
 v_mfma_f32_16x16x32_bf16 v[146:149], a[244:247], v[162:165], v[146:149]
 v_mfma_f32_16x16x32_bf16 v[142:145], a[52:55], v[166:169], v[142:145]
 v_mfma_f32_16x16x32_bf16 v[150:153], a[244:247], v[166:169], v[150:153]
 ds_read_b128 v[162:165], v2 offset:32768
 ds_read_b128 v[166:169], v2 offset:33792
 s_waitcnt lgkmcnt(4)
 v_mfma_f32_16x16x32_bf16 v[138:141], a[56:59], v[170:173], v[138:141]
 s_add_u32 m0, s40, 94208
 s_add_u32 s19, s39, 94208
 buffer_load_dwordx4 v2, s[4:7], s19 offen sc1 lds
 v_mfma_f32_16x16x32_bf16 v[146:149], a[248:251], v[170:173], v[146:149]
 v_mfma_f32_16x16x32_bf16 v[142:145], a[56:59], v[174:177], v[142:145]
 v_mfma_f32_16x16x32_bf16 v[150:153], a[248:251], v[174:177], v[150:153]
 ds_read_b128 v[170:173], v2 offset:34816
 ds_read_b128 v[174:177], v2 offset:35840
 s_waitcnt lgkmcnt(4)
 v_mfma_f32_16x16x32_bf16 v[138:141], a[60:63], v[154:157], v[138:141]
 v_mfma_f32_16x16x32_bf16 v[146:149], a[252:255], v[154:157], v[146:149]
 v_mfma_f32_16x16x32_bf16 v[142:145], a[60:63], v[158:161], v[142:145]
 v_mfma_f32_16x16x32_bf16 v[150:153], a[252:255], v[158:161], v[150:153]
 ds_read_b128 v[154:157], v2 offset:36864
 ds_read_b128 v[158:161], v2 offset:37888
 s_waitcnt lgkmcnt(4)
 v_mfma_f32_16x16x32_bf16 v[138:141], a[64:67], v[162:165], v[138:141]
 v_mfma_f32_16x16x32_bf16 v[146:149], v[4:7], v[162:165], v[146:149]
 v_mfma_f32_16x16x32_bf16 v[142:145], a[64:67], v[166:169], v[142:145]
 v_mfma_f32_16x16x32_bf16 v[150:153], v[4:7], v[166:169], v[150:153]
 ds_read_b128 v[162:165], v2 offset:38912
 ds_read_b128 v[166:169], v2 offset:39936
 s_waitcnt lgkmcnt(4)
 v_mfma_f32_16x16x32_bf16 v[138:141], a[68:71], v[170:173], v[138:141]
 v_mfma_f32_16x16x32_bf16 v[146:149], v[8:11], v[170:173], v[146:149]
 v_mfma_f32_16x16x32_bf16 v[142:145], a[68:71], v[174:177], v[142:145]
 v_mfma_f32_16x16x32_bf16 v[150:153], v[8:11], v[174:177], v[150:153]
 s_waitcnt vmcnt(9)
 s_barrier
 ds_read_b128 v[170:173], v2 offset:40960
 ds_read_b128 v[174:177], v2 offset:41984
 s_waitcnt lgkmcnt(4)
 v_mfma_f32_16x16x32_bf16 v[138:141], a[72:75], v[154:157], v[138:141]
 v_mfma_f32_16x16x32_bf16 v[146:149], v[12:15], v[154:157], v[146:149]
 v_mfma_f32_16x16x32_bf16 v[142:145], a[72:75], v[158:161], v[142:145]
 v_mfma_f32_16x16x32_bf16 v[150:153], v[12:15], v[158:161], v[150:153]
 ds_read_b128 v[154:157], v2 offset:43008
 ds_read_b128 v[158:161], v2 offset:44032
 s_waitcnt lgkmcnt(4)
 v_mfma_f32_16x16x32_bf16 v[138:141], a[76:79], v[162:165], v[138:141]
 v_mfma_f32_16x16x32_bf16 v[146:149], v[16:19], v[162:165], v[146:149]
 v_mfma_f32_16x16x32_bf16 v[142:145], a[76:79], v[166:169], v[142:145]
 v_mfma_f32_16x16x32_bf16 v[150:153], v[16:19], v[166:169], v[150:153]
 ds_read_b128 v[162:165], v2 offset:45056
 ds_read_b128 v[166:169], v2 offset:46080
 s_waitcnt lgkmcnt(4)
 v_mfma_f32_16x16x32_bf16 v[138:141], a[80:83], v[170:173], v[138:141]
 v_mfma_f32_16x16x32_bf16 v[146:149], v[20:23], v[170:173], v[146:149]
 v_mfma_f32_16x16x32_bf16 v[142:145], a[80:83], v[174:177], v[142:145]
 v_mfma_f32_16x16x32_bf16 v[150:153], v[20:23], v[174:177], v[150:153]
 ds_read_b128 v[170:173], v2 offset:47104
 ds_read_b128 v[174:177], v2 offset:48128
 s_waitcnt lgkmcnt(4)
 v_mfma_f32_16x16x32_bf16 v[138:141], a[84:87], v[154:157], v[138:141]
 v_mfma_f32_16x16x32_bf16 v[146:149], v[24:27], v[154:157], v[146:149]
 v_mfma_f32_16x16x32_bf16 v[142:145], a[84:87], v[158:161], v[142:145]
 v_mfma_f32_16x16x32_bf16 v[150:153], v[24:27], v[158:161], v[150:153]
 ds_read_b128 v[154:157], v134 offset:0
 ds_read_b128 v[158:161], v134 offset:1024
 s_waitcnt lgkmcnt(4)
 v_mfma_f32_16x16x32_bf16 v[138:141], a[88:91], v[162:165], v[138:141]
 s_mul_i32 s20, s49, 81920
 s_add_u32 s20, s20, 192839680
 s_add_u32 s21, s20, 40960
 buffer_load_dwordx4 v[178:181], v136, s[4:7], s20 offen offset:0 sc1
 v_mfma_f32_16x16x32_bf16 v[146:149], v[28:31], v[162:165], v[146:149]
 v_mfma_f32_16x16x32_bf16 v[142:145], a[88:91], v[166:169], v[142:145]
 v_mfma_f32_16x16x32_bf16 v[150:153], v[28:31], v[166:169], v[150:153]
 ds_read_b128 v[162:165], v134 offset:2048
 ds_read_b128 v[166:169], v134 offset:3072
 s_waitcnt lgkmcnt(4)
 v_mfma_f32_16x16x32_bf16 v[138:141], a[92:95], v[170:173], v[138:141]
 v_mfma_f32_16x16x32_bf16 v[146:149], v[32:35], v[170:173], v[146:149]
 v_mfma_f32_16x16x32_bf16 v[142:145], a[92:95], v[174:177], v[142:145]
 v_mfma_f32_16x16x32_bf16 v[150:153], v[32:35], v[174:177], v[150:153]
 ds_read_b128 v[170:173], v134 offset:4096
 ds_read_b128 v[174:177], v134 offset:5120
 s_waitcnt lgkmcnt(4)
 v_mfma_f32_16x16x32_bf16 v[138:141], a[96:99], v[154:157], v[138:141]
 buffer_load_dwordx4 v[182:185], v136, s[4:7], s20 offen offset:16 sc1
 v_mfma_f32_16x16x32_bf16 v[146:149], v[36:39], v[154:157], v[146:149]
 v_mfma_f32_16x16x32_bf16 v[142:145], a[96:99], v[158:161], v[142:145]
 v_mfma_f32_16x16x32_bf16 v[150:153], v[36:39], v[158:161], v[150:153]
 ds_read_b128 v[154:157], v134 offset:6144
 ds_read_b128 v[158:161], v134 offset:7168
 s_waitcnt lgkmcnt(4)
 v_mfma_f32_16x16x32_bf16 v[138:141], a[100:103], v[162:165], v[138:141]
 v_mfma_f32_16x16x32_bf16 v[146:149], v[40:43], v[162:165], v[146:149]
 v_mfma_f32_16x16x32_bf16 v[142:145], a[100:103], v[166:169], v[142:145]
 v_mfma_f32_16x16x32_bf16 v[150:153], v[40:43], v[166:169], v[150:153]
 ds_read_b128 v[162:165], v134 offset:8192
 ds_read_b128 v[166:169], v134 offset:9216
 s_waitcnt lgkmcnt(4)
 v_mfma_f32_16x16x32_bf16 v[138:141], a[104:107], v[170:173], v[138:141]
 buffer_load_dwordx4 v[186:189], v136, s[4:7], s21 offen offset:0 sc1
 v_mfma_f32_16x16x32_bf16 v[146:149], v[44:47], v[170:173], v[146:149]
 v_mfma_f32_16x16x32_bf16 v[142:145], a[104:107], v[174:177], v[142:145]
 v_mfma_f32_16x16x32_bf16 v[150:153], v[44:47], v[174:177], v[150:153]
 ds_read_b128 v[170:173], v134 offset:10240
 ds_read_b128 v[174:177], v134 offset:11264
 s_waitcnt lgkmcnt(4)
 v_mfma_f32_16x16x32_bf16 v[138:141], a[108:111], v[154:157], v[138:141]
 v_mfma_f32_16x16x32_bf16 v[146:149], v[48:51], v[154:157], v[146:149]
 v_mfma_f32_16x16x32_bf16 v[142:145], a[108:111], v[158:161], v[142:145]
 v_mfma_f32_16x16x32_bf16 v[150:153], v[48:51], v[158:161], v[150:153]
 s_waitcnt vmcnt(3)
 s_barrier
 ds_read_b128 v[154:157], v134 offset:12288
 ds_read_b128 v[158:161], v134 offset:13312
 s_waitcnt lgkmcnt(4)
 v_mfma_f32_16x16x32_bf16 v[138:141], a[112:115], v[162:165], v[138:141]
 buffer_load_dwordx4 v[190:193], v136, s[4:7], s21 offen offset:16 sc1
 v_mfma_f32_16x16x32_bf16 v[146:149], v[52:55], v[162:165], v[146:149]
 v_mfma_f32_16x16x32_bf16 v[142:145], a[112:115], v[166:169], v[142:145]
 v_mfma_f32_16x16x32_bf16 v[150:153], v[52:55], v[166:169], v[150:153]
 ds_read_b128 v[162:165], v134 offset:14336
 ds_read_b128 v[166:169], v134 offset:15360
 s_waitcnt lgkmcnt(4)
 v_mfma_f32_16x16x32_bf16 v[138:141], a[116:119], v[170:173], v[138:141]
 v_mfma_f32_16x16x32_bf16 v[146:149], v[56:59], v[170:173], v[146:149]
 v_mfma_f32_16x16x32_bf16 v[142:145], a[116:119], v[174:177], v[142:145]
 v_mfma_f32_16x16x32_bf16 v[150:153], v[56:59], v[174:177], v[150:153]
 ds_read_b128 v[170:173], v134 offset:16384
 ds_read_b128 v[174:177], v134 offset:17408
 s_waitcnt lgkmcnt(4)
 v_mfma_f32_16x16x32_bf16 v[138:141], a[120:123], v[154:157], v[138:141]
 buffer_load_dword v3, v132, s[4:7], 0 offen sc1
 v_mfma_f32_16x16x32_bf16 v[146:149], v[60:63], v[154:157], v[146:149]
 v_mfma_f32_16x16x32_bf16 v[142:145], a[120:123], v[158:161], v[142:145]
 v_mfma_f32_16x16x32_bf16 v[150:153], v[60:63], v[158:161], v[150:153]
 ds_read_b128 v[154:157], v134 offset:18432
 ds_read_b128 v[158:161], v134 offset:19456
 s_waitcnt lgkmcnt(4)
 v_mfma_f32_16x16x32_bf16 v[138:141], a[124:127], v[162:165], v[138:141]
 v_mfma_f32_16x16x32_bf16 v[146:149], v[64:67], v[162:165], v[146:149]
 v_mfma_f32_16x16x32_bf16 v[142:145], a[124:127], v[166:169], v[142:145]
 v_mfma_f32_16x16x32_bf16 v[150:153], v[64:67], v[166:169], v[150:153]
 ds_read_b128 v[162:165], v134 offset:20480
 ds_read_b128 v[166:169], v134 offset:21504
 s_waitcnt lgkmcnt(4)
 v_mfma_f32_16x16x32_bf16 v[138:141], a[128:131], v[170:173], v[138:141]
 v_mfma_f32_16x16x32_bf16 v[146:149], v[68:71], v[170:173], v[146:149]
 v_mfma_f32_16x16x32_bf16 v[142:145], a[128:131], v[174:177], v[142:145]
 v_mfma_f32_16x16x32_bf16 v[150:153], v[68:71], v[174:177], v[150:153]
 ds_read_b128 v[170:173], v134 offset:22528
 ds_read_b128 v[174:177], v134 offset:23552
 s_waitcnt lgkmcnt(4)
 v_mfma_f32_16x16x32_bf16 v[138:141], a[132:135], v[154:157], v[138:141]
 v_mfma_f32_16x16x32_bf16 v[146:149], v[72:75], v[154:157], v[146:149]
 v_mfma_f32_16x16x32_bf16 v[142:145], a[132:135], v[158:161], v[142:145]
 v_mfma_f32_16x16x32_bf16 v[150:153], v[72:75], v[158:161], v[150:153]
 ds_read_b128 v[154:157], v134 offset:24576
 ds_read_b128 v[158:161], v134 offset:25600
 s_waitcnt lgkmcnt(4)
 v_mfma_f32_16x16x32_bf16 v[138:141], a[136:139], v[162:165], v[138:141]
 v_mfma_f32_16x16x32_bf16 v[146:149], v[76:79], v[162:165], v[146:149]
 v_mfma_f32_16x16x32_bf16 v[142:145], a[136:139], v[166:169], v[142:145]
 v_mfma_f32_16x16x32_bf16 v[150:153], v[76:79], v[166:169], v[150:153]
 ds_read_b128 v[162:165], v134 offset:26624
 ds_read_b128 v[166:169], v134 offset:27648
 s_waitcnt lgkmcnt(4)
 v_mfma_f32_16x16x32_bf16 v[138:141], a[140:143], v[170:173], v[138:141]
 v_mfma_f32_16x16x32_bf16 v[146:149], v[80:83], v[170:173], v[146:149]
 v_mfma_f32_16x16x32_bf16 v[142:145], a[140:143], v[174:177], v[142:145]
 v_mfma_f32_16x16x32_bf16 v[150:153], v[80:83], v[174:177], v[150:153]
 ds_read_b128 v[170:173], v134 offset:28672
 ds_read_b128 v[174:177], v134 offset:29696
 s_waitcnt lgkmcnt(4)
 v_mfma_f32_16x16x32_bf16 v[138:141], a[144:147], v[154:157], v[138:141]
 v_mfma_f32_16x16x32_bf16 v[146:149], v[84:87], v[154:157], v[146:149]
 v_mfma_f32_16x16x32_bf16 v[142:145], a[144:147], v[158:161], v[142:145]
 v_mfma_f32_16x16x32_bf16 v[150:153], v[84:87], v[158:161], v[150:153]
 ds_read_b128 v[154:157], v134 offset:30720
 ds_read_b128 v[158:161], v134 offset:31744
 s_waitcnt lgkmcnt(4)
 v_mfma_f32_16x16x32_bf16 v[138:141], a[148:151], v[162:165], v[138:141]
 v_mfma_f32_16x16x32_bf16 v[146:149], v[88:91], v[162:165], v[146:149]
 v_mfma_f32_16x16x32_bf16 v[142:145], a[148:151], v[166:169], v[142:145]
 v_mfma_f32_16x16x32_bf16 v[150:153], v[88:91], v[166:169], v[150:153]
 s_mov_b32 s52, s50
 s_cmp_ge_u32 s50, 64
 s_cbranch_scc1 Ldn_402
 s_waitcnt vmcnt(0)
 v_cmp_lt_u32 vcc, s50, v3
 s_nop 0
 s_cmp_eq_u64 vcc, -1
 s_cbranch_scc0 Ldn_402
 s_mul_i32 s43, s49, 40960
 s_mul_i32 s39, s50, 98304
 s_add_u32 s39, s39, 234782720
 s_add_u32 s39, s39, s40
 ds_read_b128 v[162:165], v134 offset:32768
 ds_read_b128 v[166:169], v134 offset:33792
 s_waitcnt lgkmcnt(4)
 v_mfma_f32_16x16x32_bf16 v[138:141], a[152:155], v[170:173], v[138:141]
 s_add_u32 m0, s40, 0
 s_add_u32 s19, s39, 0
 buffer_load_dwordx4 v2, s[4:7], s19 offen sc1 lds
 v_mfma_f32_16x16x32_bf16 v[146:149], v[92:95], v[170:173], v[146:149]
 v_mfma_f32_16x16x32_bf16 v[142:145], a[152:155], v[174:177], v[142:145]
 v_mfma_f32_16x16x32_bf16 v[150:153], v[92:95], v[174:177], v[150:153]
 ds_read_b128 v[170:173], v134 offset:34816
 ds_read_b128 v[174:177], v134 offset:35840
 s_waitcnt lgkmcnt(4)
 v_mfma_f32_16x16x32_bf16 v[138:141], a[156:159], v[154:157], v[138:141]
 s_add_u32 m0, s40, 4096
 s_add_u32 s19, s39, 4096
 buffer_load_dwordx4 v2, s[4:7], s19 offen sc1 lds
 v_mfma_f32_16x16x32_bf16 v[146:149], v[96:99], v[154:157], v[146:149]
 v_mfma_f32_16x16x32_bf16 v[142:145], a[156:159], v[158:161], v[142:145]
 v_mfma_f32_16x16x32_bf16 v[150:153], v[96:99], v[158:161], v[150:153]
 ds_read_b128 v[154:157], v134 offset:36864
 ds_read_b128 v[158:161], v134 offset:37888
 s_waitcnt lgkmcnt(4)
 v_mfma_f32_16x16x32_bf16 v[138:141], a[160:163], v[162:165], v[138:141]
 s_add_u32 m0, s40, 8192
 s_add_u32 s19, s39, 8192
 buffer_load_dwordx4 v2, s[4:7], s19 offen sc1 lds
 v_mfma_f32_16x16x32_bf16 v[146:149], v[100:103], v[162:165], v[146:149]
 v_mfma_f32_16x16x32_bf16 v[142:145], a[160:163], v[166:169], v[142:145]
 v_mfma_f32_16x16x32_bf16 v[150:153], v[100:103], v[166:169], v[150:153]
 ds_read_b128 v[162:165], v134 offset:38912
 ds_read_b128 v[166:169], v134 offset:39936
 s_waitcnt lgkmcnt(4)
 v_mfma_f32_16x16x32_bf16 v[138:141], a[164:167], v[170:173], v[138:141]
 s_add_u32 m0, s40, 12288
 s_add_u32 s19, s39, 12288
 buffer_load_dwordx4 v2, s[4:7], s19 offen sc1 lds
 v_mfma_f32_16x16x32_bf16 v[146:149], v[104:107], v[170:173], v[146:149]
 v_mfma_f32_16x16x32_bf16 v[142:145], a[164:167], v[174:177], v[142:145]
 v_mfma_f32_16x16x32_bf16 v[150:153], v[104:107], v[174:177], v[150:153]
 ds_read_b128 v[170:173], v134 offset:40960
 ds_read_b128 v[174:177], v134 offset:41984
 s_waitcnt lgkmcnt(4)
 v_mfma_f32_16x16x32_bf16 v[138:141], a[168:171], v[154:157], v[138:141]
 s_add_u32 m0, s40, 16384
 s_add_u32 s19, s39, 16384
 buffer_load_dwordx4 v2, s[4:7], s19 offen sc1 lds
 v_mfma_f32_16x16x32_bf16 v[146:149], v[108:111], v[154:157], v[146:149]
 v_mfma_f32_16x16x32_bf16 v[142:145], a[168:171], v[158:161], v[142:145]
 v_mfma_f32_16x16x32_bf16 v[150:153], v[108:111], v[158:161], v[150:153]
 ds_read_b128 v[154:157], v134 offset:43008
 ds_read_b128 v[158:161], v134 offset:44032
 s_waitcnt lgkmcnt(4)
 v_mfma_f32_16x16x32_bf16 v[138:141], a[172:175], v[162:165], v[138:141]
 s_add_u32 m0, s40, 20480
 s_add_u32 s19, s39, 20480
 buffer_load_dwordx4 v2, s[4:7], s19 offen sc1 lds
 v_mfma_f32_16x16x32_bf16 v[146:149], v[112:115], v[162:165], v[146:149]
 v_mfma_f32_16x16x32_bf16 v[142:145], a[172:175], v[166:169], v[142:145]
 v_mfma_f32_16x16x32_bf16 v[150:153], v[112:115], v[166:169], v[150:153]
 ds_read_b128 v[162:165], v134 offset:45056
 ds_read_b128 v[166:169], v134 offset:46080
 s_waitcnt lgkmcnt(4)
 v_mfma_f32_16x16x32_bf16 v[138:141], a[176:179], v[170:173], v[138:141]
 s_add_u32 m0, s40, 24576
 s_add_u32 s19, s39, 24576
 buffer_load_dwordx4 v2, s[4:7], s19 offen sc1 lds
 v_mfma_f32_16x16x32_bf16 v[146:149], v[116:119], v[170:173], v[146:149]
 v_mfma_f32_16x16x32_bf16 v[142:145], a[176:179], v[174:177], v[142:145]
 v_mfma_f32_16x16x32_bf16 v[150:153], v[116:119], v[174:177], v[150:153]
 ds_read_b128 v[170:173], v134 offset:47104
 ds_read_b128 v[174:177], v134 offset:48128
 s_waitcnt lgkmcnt(4)
 v_mfma_f32_16x16x32_bf16 v[138:141], a[180:183], v[154:157], v[138:141]
 s_add_u32 m0, s40, 28672
 s_add_u32 s19, s39, 28672
 buffer_load_dwordx4 v2, s[4:7], s19 offen sc1 lds
 v_mfma_f32_16x16x32_bf16 v[146:149], v[120:123], v[154:157], v[146:149]
 v_mfma_f32_16x16x32_bf16 v[142:145], a[180:183], v[158:161], v[142:145]
 v_mfma_f32_16x16x32_bf16 v[150:153], v[120:123], v[158:161], v[150:153]
 s_waitcnt lgkmcnt(3)
 v_mfma_f32_16x16x32_bf16 v[138:141], a[184:187], v[162:165], v[138:141]
 s_add_u32 m0, s40, 32768
 s_add_u32 s19, s39, 32768
 buffer_load_dwordx4 v2, s[4:7], s19 offen sc1 lds
 v_mfma_f32_16x16x32_bf16 v[146:149], v[124:127], v[162:165], v[146:149]
 s_waitcnt lgkmcnt(2)
 v_mfma_f32_16x16x32_bf16 v[142:145], a[184:187], v[166:169], v[142:145]
 v_mfma_f32_16x16x32_bf16 v[150:153], v[124:127], v[166:169], v[150:153]
 s_waitcnt lgkmcnt(1)
 v_mfma_f32_16x16x32_bf16 v[138:141], a[188:191], v[170:173], v[138:141]
 v_mfma_f32_16x16x32_bf16 v[146:149], v[128:131], v[170:173], v[146:149]
 s_waitcnt lgkmcnt(0)
 v_mfma_f32_16x16x32_bf16 v[142:145], a[188:191], v[174:177], v[142:145]
 v_mfma_f32_16x16x32_bf16 v[150:153], v[128:131], v[174:177], v[150:153]
 s_add_u32 s20, s43, 20480
 s_waitcnt vmcnt(9)
 v_add_f32 v138, v138, v178
 v_add_f32 v139, v139, v179
 v_add_f32 v140, v140, v180
 v_add_f32 v141, v141, v181
 v_add_f32 v146, v146, v182
 v_add_f32 v147, v147, v183
 v_add_f32 v148, v148, v184
 v_add_f32 v149, v149, v185
 v_cvt_pk_bf16_f32 v178, v138, v139
 v_cvt_pk_bf16_f32 v179, v140, v141
 v_cvt_pk_bf16_f32 v180, v146, v147
 v_cvt_pk_bf16_f32 v181, v148, v149
 buffer_store_dwordx4 v[178:181], v135, s[32:35], s43 offen
 v_add_f32 v142, v142, v186
 v_add_f32 v143, v143, v187
 v_add_f32 v144, v144, v188
 v_add_f32 v145, v145, v189
 v_add_f32 v150, v150, v190
 v_add_f32 v151, v151, v191
 v_add_f32 v152, v152, v192
 v_add_f32 v153, v153, v193
 v_cvt_pk_bf16_f32 v186, v142, v143
 v_cvt_pk_bf16_f32 v187, v144, v145
 v_cvt_pk_bf16_f32 v188, v150, v151
 v_cvt_pk_bf16_f32 v189, v152, v153
 buffer_store_dwordx4 v[186:189], v135, s[32:35], s20 offen
 s_mov_b32 s49, s50
 s_add_u32 s50, s50, 1
 s_branch Ldw_399
Ldn_402:
 s_mul_i32 s43, s49, 40960
 s_mul_i32 s39, s50, 98304
 s_add_u32 s39, s39, 234782720
 s_add_u32 s39, s39, s40
 ds_read_b128 v[162:165], v134 offset:32768
 ds_read_b128 v[166:169], v134 offset:33792
 s_waitcnt lgkmcnt(4)
 v_mfma_f32_16x16x32_bf16 v[138:141], a[152:155], v[170:173], v[138:141]
 v_mfma_f32_16x16x32_bf16 v[146:149], v[92:95], v[170:173], v[146:149]
 v_mfma_f32_16x16x32_bf16 v[142:145], a[152:155], v[174:177], v[142:145]
 v_mfma_f32_16x16x32_bf16 v[150:153], v[92:95], v[174:177], v[150:153]
 ds_read_b128 v[170:173], v134 offset:34816
 ds_read_b128 v[174:177], v134 offset:35840
 s_waitcnt lgkmcnt(4)
 v_mfma_f32_16x16x32_bf16 v[138:141], a[156:159], v[154:157], v[138:141]
 v_mfma_f32_16x16x32_bf16 v[146:149], v[96:99], v[154:157], v[146:149]
 v_mfma_f32_16x16x32_bf16 v[142:145], a[156:159], v[158:161], v[142:145]
 v_mfma_f32_16x16x32_bf16 v[150:153], v[96:99], v[158:161], v[150:153]
 ds_read_b128 v[154:157], v134 offset:36864
 ds_read_b128 v[158:161], v134 offset:37888
 s_waitcnt lgkmcnt(4)
 v_mfma_f32_16x16x32_bf16 v[138:141], a[160:163], v[162:165], v[138:141]
 v_mfma_f32_16x16x32_bf16 v[146:149], v[100:103], v[162:165], v[146:149]
 v_mfma_f32_16x16x32_bf16 v[142:145], a[160:163], v[166:169], v[142:145]
 v_mfma_f32_16x16x32_bf16 v[150:153], v[100:103], v[166:169], v[150:153]
 ds_read_b128 v[162:165], v134 offset:38912
 ds_read_b128 v[166:169], v134 offset:39936
 s_waitcnt lgkmcnt(4)
 v_mfma_f32_16x16x32_bf16 v[138:141], a[164:167], v[170:173], v[138:141]
 v_mfma_f32_16x16x32_bf16 v[146:149], v[104:107], v[170:173], v[146:149]
 v_mfma_f32_16x16x32_bf16 v[142:145], a[164:167], v[174:177], v[142:145]
 v_mfma_f32_16x16x32_bf16 v[150:153], v[104:107], v[174:177], v[150:153]
 ds_read_b128 v[170:173], v134 offset:40960
 ds_read_b128 v[174:177], v134 offset:41984
 s_waitcnt lgkmcnt(4)
 v_mfma_f32_16x16x32_bf16 v[138:141], a[168:171], v[154:157], v[138:141]
 v_mfma_f32_16x16x32_bf16 v[146:149], v[108:111], v[154:157], v[146:149]
 v_mfma_f32_16x16x32_bf16 v[142:145], a[168:171], v[158:161], v[142:145]
 v_mfma_f32_16x16x32_bf16 v[150:153], v[108:111], v[158:161], v[150:153]
 ds_read_b128 v[154:157], v134 offset:43008
 ds_read_b128 v[158:161], v134 offset:44032
 s_waitcnt lgkmcnt(4)
 v_mfma_f32_16x16x32_bf16 v[138:141], a[172:175], v[162:165], v[138:141]
 v_mfma_f32_16x16x32_bf16 v[146:149], v[112:115], v[162:165], v[146:149]
 v_mfma_f32_16x16x32_bf16 v[142:145], a[172:175], v[166:169], v[142:145]
 v_mfma_f32_16x16x32_bf16 v[150:153], v[112:115], v[166:169], v[150:153]
 ds_read_b128 v[162:165], v134 offset:45056
 ds_read_b128 v[166:169], v134 offset:46080
 s_waitcnt lgkmcnt(4)
 v_mfma_f32_16x16x32_bf16 v[138:141], a[176:179], v[170:173], v[138:141]
 v_mfma_f32_16x16x32_bf16 v[146:149], v[116:119], v[170:173], v[146:149]
 v_mfma_f32_16x16x32_bf16 v[142:145], a[176:179], v[174:177], v[142:145]
 v_mfma_f32_16x16x32_bf16 v[150:153], v[116:119], v[174:177], v[150:153]
 ds_read_b128 v[170:173], v134 offset:47104
 ds_read_b128 v[174:177], v134 offset:48128
 s_waitcnt lgkmcnt(4)
 v_mfma_f32_16x16x32_bf16 v[138:141], a[180:183], v[154:157], v[138:141]
 v_mfma_f32_16x16x32_bf16 v[146:149], v[120:123], v[154:157], v[146:149]
 v_mfma_f32_16x16x32_bf16 v[142:145], a[180:183], v[158:161], v[142:145]
 v_mfma_f32_16x16x32_bf16 v[150:153], v[120:123], v[158:161], v[150:153]
 s_waitcnt lgkmcnt(3)
 v_mfma_f32_16x16x32_bf16 v[138:141], a[184:187], v[162:165], v[138:141]
 v_mfma_f32_16x16x32_bf16 v[146:149], v[124:127], v[162:165], v[146:149]
 s_waitcnt lgkmcnt(2)
 v_mfma_f32_16x16x32_bf16 v[142:145], a[184:187], v[166:169], v[142:145]
 v_mfma_f32_16x16x32_bf16 v[150:153], v[124:127], v[166:169], v[150:153]
 s_waitcnt lgkmcnt(1)
 v_mfma_f32_16x16x32_bf16 v[138:141], a[188:191], v[170:173], v[138:141]
 v_mfma_f32_16x16x32_bf16 v[146:149], v[128:131], v[170:173], v[146:149]
 s_waitcnt lgkmcnt(0)
 v_mfma_f32_16x16x32_bf16 v[142:145], a[188:191], v[174:177], v[142:145]
 v_mfma_f32_16x16x32_bf16 v[150:153], v[128:131], v[174:177], v[150:153]
 s_add_u32 s20, s43, 20480
 s_waitcnt vmcnt(0)
 v_add_f32 v138, v138, v178
 v_add_f32 v139, v139, v179
 v_add_f32 v140, v140, v180
 v_add_f32 v141, v141, v181
 v_add_f32 v146, v146, v182
 v_add_f32 v147, v147, v183
 v_add_f32 v148, v148, v184
 v_add_f32 v149, v149, v185
 v_cvt_pk_bf16_f32 v178, v138, v139
 v_cvt_pk_bf16_f32 v179, v140, v141
 v_cvt_pk_bf16_f32 v180, v146, v147
 v_cvt_pk_bf16_f32 v181, v148, v149
 buffer_store_dwordx4 v[178:181], v135, s[32:35], s43 offen
 v_add_f32 v142, v142, v186
 v_add_f32 v143, v143, v187
 v_add_f32 v144, v144, v188
 v_add_f32 v145, v145, v189
 v_add_f32 v150, v150, v190
 v_add_f32 v151, v151, v191
 v_add_f32 v152, v152, v192
 v_add_f32 v153, v153, v193
 v_cvt_pk_bf16_f32 v186, v142, v143
 v_cvt_pk_bf16_f32 v187, v144, v145
 v_cvt_pk_bf16_f32 v188, v150, v151
 v_cvt_pk_bf16_f32 v189, v152, v153
 buffer_store_dwordx4 v[186:189], v135, s[32:35], s20 offen
 s_mov_b32 s49, s50
 s_add_u32 s50, s50, 1
 s_branch Ldc_398
Ldd_403:
 s_endpgm
L_role_r1:
 s_sub_u32 s12, s12, 242
 s_cmp_eq_u32 s13, 1
 s_cbranch_scc1 Lverok_407
 s_mov_b32 s18, 0
Lver_406:
 s_add_u32 s18, s18, 1
 s_cmp_gt_u32 s18, 200000
 s_cbranch_scc1 L_fail
 v_and_b32 v254, 7, v0
 v_lshlrev_b32 v254, 2, v254
 buffer_load_dword v255, v254, s[8:11], 0 offen sc1
 s_waitcnt vmcnt(0)
 v_cmp_eq_u32 vcc, 32, v255
 s_nop 0
 s_cmp_eq_u64 vcc, -1
 s_cbranch_scc1 Lverok_407
 s_mov_b32 s17, 0
 v_readlane_b32 s14, v255, 0
 s_nop 0
 s_add_u32 s17, s17, s14
 v_readlane_b32 s14, v255, 1
 s_nop 0
 s_add_u32 s17, s17, s14
 v_readlane_b32 s14, v255, 2
 s_nop 0
 s_add_u32 s17, s17, s14
 v_readlane_b32 s14, v255, 3
 s_nop 0
 s_add_u32 s17, s17, s14
 v_readlane_b32 s14, v255, 4
 s_nop 0
 s_add_u32 s17, s17, s14
 v_readlane_b32 s14, v255, 5
 s_nop 0
 s_add_u32 s17, s17, s14
 v_readlane_b32 s14, v255, 6
 s_nop 0
 s_add_u32 s17, s17, s14
 v_readlane_b32 s14, v255, 7
 s_nop 0
 s_add_u32 s17, s17, s14
 s_cmp_eq_u32 s17, 256
 s_cbranch_scc1 L_fallback
 s_branch Lver_406
Lverok_407:
 v_and_b32 v1, 63, v0
 s_lshr_b32 s25, s12, 2
 s_and_b32 s28, s12, 3
 s_lshl_b32 s28, s28, 2
 s_add_u32 s28, s28, s3
 s_mov_b32 s29, 0x3acccccd
 s_lshl_b32 s19, s25, 6
 s_lshr_b32 s30, s28, 2
 s_add_u32 s30, s19, s30
 s_lshl_b32 s30, s30, 7
 s_add_u32 s30, s30, 188416
 s_lshl_b32 s19, s25, 7
 v_min_u32 v6, 19, v1
 v_add_u32 v6, s19, v6
 v_lshlrev_b32 v6, 7, v6
 v_add_u32 v6, 155648, v6
 s_mul_i32 s31, s25, 5242880
 s_add_u32 s31, s31, 198082560
 v_lshrrev_b32 v7, 5, v1
 s_lshl_b32 s19, s28, 1
 v_add_u32 v7, s19, v7
 v_and_b32 v8, 31, v1
 v_mul_u32_u24 v2, 2560, v7
 v_lshl_add_u32 v2, v8, 4, v2
 v_lshrrev_b32 v3, 1, v2
 v_lshrrev_b32 v4, 3, v8
 v_lshlrev_b32 v4, 1, v4
 v_lshrrev_b32 v5, 4, v7
 v_add_u32 v4, v4, v5
 v_lshlrev_b32 v4, 1, v4
 v_and_b32 v5, 1, v8
 v_add_u32 v4, v4, v5
 v_lshlrev_b32 v4, 4, v4
 v_and_b32 v5, 15, v7
 v_add_u32 v4, v4, v5
 v_lshlrev_b32 v4, 2, v4
 v_bfe_u32 v5, v8, 1, 2
 v_add_u32 v4, v4, v5
 v_lshlrev_b32 v4, 4, v4
 s_mov_b32 s26, 0
Lr_408:
 s_add_u32 s27, s26, 1
 s_mul_i32 s19, s26, 81920
 s_add_u32 s22, s19, s31
 s_mul_i32 s20, s26, 327680
 s_add_u32 s20, s20, 213811200
 s_mov_b32 s24, 0
Lrs_409:
 s_add_u32 s24, s24, 1
 s_cmp_gt_u32 s24, 200000
 s_cbranch_scc1 L_fail
 buffer_load_dword v5, v6, s[4:7], 0 offen sc1
 s_waitcnt vmcnt(0)
 v_cmp_le_u32 vcc, s27, v5
 s_nop 0
 s_cmp_eq_u64 vcc, -1
 s_cbranch_scc0 Lrs_409
 buffer_load_dwordx4 v[10:13], v2, s[4:7], s22 offen offset:0 sc1
 s_add_u32 s21, s20, 0
 buffer_load_dwordx4 v[40:43], v4, s[4:7], s21 offen sc1
 s_add_u32 s21, s20, 81920
 buffer_load_dwordx4 v[60:63], v4, s[4:7], s21 offen sc1
 s_add_u32 s21, s20, 163840
 buffer_load_dwordx4 v[80:83], v4, s[4:7], s21 offen sc1
 s_add_u32 s21, s20, 245760
 buffer_load_dwordx4 v[100:103], v4, s[4:7], s21 offen sc1
 buffer_load_dwordx4 v[14:17], v2, s[4:7], s22 offen offset:512 sc1
 s_add_u32 s21, s20, 16384
 buffer_load_dwordx4 v[44:47], v4, s[4:7], s21 offen sc1
 s_add_u32 s21, s20, 98304
 buffer_load_dwordx4 v[64:67], v4, s[4:7], s21 offen sc1
 s_add_u32 s21, s20, 180224
 buffer_load_dwordx4 v[84:87], v4, s[4:7], s21 offen sc1
 s_add_u32 s21, s20, 262144
 buffer_load_dwordx4 v[104:107], v4, s[4:7], s21 offen sc1
 buffer_load_dwordx4 v[18:21], v2, s[4:7], s22 offen offset:1024 sc1
 s_add_u32 s21, s20, 32768
 buffer_load_dwordx4 v[48:51], v4, s[4:7], s21 offen sc1
 s_add_u32 s21, s20, 114688
 buffer_load_dwordx4 v[68:71], v4, s[4:7], s21 offen sc1
 s_add_u32 s21, s20, 196608
 buffer_load_dwordx4 v[88:91], v4, s[4:7], s21 offen sc1
 s_add_u32 s21, s20, 278528
 buffer_load_dwordx4 v[108:111], v4, s[4:7], s21 offen sc1
 buffer_load_dwordx4 v[22:25], v2, s[4:7], s22 offen offset:1536 sc1
 s_add_u32 s21, s20, 49152
 buffer_load_dwordx4 v[52:55], v4, s[4:7], s21 offen sc1
 s_add_u32 s21, s20, 131072
 buffer_load_dwordx4 v[72:75], v4, s[4:7], s21 offen sc1
 s_add_u32 s21, s20, 212992
 buffer_load_dwordx4 v[92:95], v4, s[4:7], s21 offen sc1
 s_add_u32 s21, s20, 294912
 buffer_load_dwordx4 v[112:115], v4, s[4:7], s21 offen sc1
 buffer_load_dwordx4 v[26:29], v2, s[4:7], s22 offen offset:2048 sc1
 s_add_u32 s21, s20, 65536
 buffer_load_dwordx4 v[56:59], v4, s[4:7], s21 offen sc1
 s_add_u32 s21, s20, 147456
 buffer_load_dwordx4 v[76:79], v4, s[4:7], s21 offen sc1
 s_add_u32 s21, s20, 229376
 buffer_load_dwordx4 v[96:99], v4, s[4:7], s21 offen sc1
 s_add_u32 s21, s20, 311296
 buffer_load_dwordx4 v[116:119], v4, s[4:7], s21 offen sc1
 s_waitcnt vmcnt(20)
 v_add_f32 v10, v10, v40
 v_add_f32 v11, v11, v41
 v_add_f32 v12, v12, v42
 v_add_f32 v13, v13, v43
 v_add_f32 v10, v10, v60
 v_add_f32 v11, v11, v61
 v_add_f32 v12, v12, v62
 v_add_f32 v13, v13, v63
 v_add_f32 v10, v10, v80
 v_add_f32 v11, v11, v81
 v_add_f32 v12, v12, v82
 v_add_f32 v13, v13, v83
 v_add_f32 v10, v10, v100
 v_add_f32 v11, v11, v101
 v_add_f32 v12, v12, v102
 v_add_f32 v13, v13, v103
 s_waitcnt vmcnt(15)
 v_add_f32 v14, v14, v44
 v_add_f32 v15, v15, v45
 v_add_f32 v16, v16, v46
 v_add_f32 v17, v17, v47
 v_add_f32 v14, v14, v64
 v_add_f32 v15, v15, v65
 v_add_f32 v16, v16, v66
 v_add_f32 v17, v17, v67
 v_add_f32 v14, v14, v84
 v_add_f32 v15, v15, v85
 v_add_f32 v16, v16, v86
 v_add_f32 v17, v17, v87
 v_add_f32 v14, v14, v104
 v_add_f32 v15, v15, v105
 v_add_f32 v16, v16, v106
 v_add_f32 v17, v17, v107
 s_waitcnt vmcnt(10)
 v_add_f32 v18, v18, v48
 v_add_f32 v19, v19, v49
 v_add_f32 v20, v20, v50
 v_add_f32 v21, v21, v51
 v_add_f32 v18, v18, v68
 v_add_f32 v19, v19, v69
 v_add_f32 v20, v20, v70
 v_add_f32 v21, v21, v71
 v_add_f32 v18, v18, v88
 v_add_f32 v19, v19, v89
 v_add_f32 v20, v20, v90
 v_add_f32 v21, v21, v91
 v_add_f32 v18, v18, v108
 v_add_f32 v19, v19, v109
 v_add_f32 v20, v20, v110
 v_add_f32 v21, v21, v111
 s_waitcnt vmcnt(5)
 v_add_f32 v22, v22, v52
 v_add_f32 v23, v23, v53
 v_add_f32 v24, v24, v54
 v_add_f32 v25, v25, v55
 v_add_f32 v22, v22, v72
 v_add_f32 v23, v23, v73
 v_add_f32 v24, v24, v74
 v_add_f32 v25, v25, v75
 v_add_f32 v22, v22, v92
 v_add_f32 v23, v23, v93
 v_add_f32 v24, v24, v94
 v_add_f32 v25, v25, v95
 v_add_f32 v22, v22, v112
 v_add_f32 v23, v23, v113
 v_add_f32 v24, v24, v114
 v_add_f32 v25, v25, v115
 s_waitcnt vmcnt(0)
 v_add_f32 v26, v26, v56
 v_add_f32 v27, v27, v57
 v_add_f32 v28, v28, v58
 v_add_f32 v29, v29, v59
 v_add_f32 v26, v26, v76
 v_add_f32 v27, v27, v77
 v_add_f32 v28, v28, v78
 v_add_f32 v29, v29, v79
 v_add_f32 v26, v26, v96
 v_add_f32 v27, v27, v97
 v_add_f32 v28, v28, v98
 v_add_f32 v29, v29, v99
 v_add_f32 v26, v26, v116
 v_add_f32 v27, v27, v117
 v_add_f32 v28, v28, v118
 v_add_f32 v29, v29, v119
 s_add_u32 s21, s19, 192839680
 s_lshr_b32 s20, s19, 1
 s_add_u32 s20, s20, 190218240
 buffer_store_dwordx4 v[10:13], v2, s[4:7], s21 offen offset:0 sc1
 buffer_store_dwordx4 v[14:17], v2, s[4:7], s21 offen offset:512 sc1
 buffer_store_dwordx4 v[18:21], v2, s[4:7], s21 offen offset:1024 sc1
 buffer_store_dwordx4 v[22:25], v2, s[4:7], s21 offen offset:1536 sc1
 buffer_store_dwordx4 v[26:29], v2, s[4:7], s21 offen offset:2048 sc1
 v_add_f32 v7, v10, v11
 v_add_f32 v8, v12, v13
 v_add_f32 v7, v7, v14
 v_add_f32 v8, v8, v15
 v_add_f32 v7, v7, v16
 v_add_f32 v8, v8, v17
 v_add_f32 v7, v7, v18
 v_add_f32 v8, v8, v19
 v_add_f32 v7, v7, v20
 v_add_f32 v8, v8, v21
 v_add_f32 v7, v7, v22
 v_add_f32 v8, v8, v23
 v_add_f32 v7, v7, v24
 v_add_f32 v8, v8, v25
 v_add_f32 v7, v7, v26
 v_add_f32 v8, v8, v27
 v_add_f32 v7, v7, v28
 v_add_f32 v8, v8, v29
 v_add_f32 v7, v7, v8
 s_nop 1
 v_add_f32_dpp v7, v7, v7 row_ror:8 row_mask:0xf bank_mask:0xf
 s_nop 1
 v_add_f32_dpp v7, v7, v7 row_ror:4 row_mask:0xf bank_mask:0xf
 s_nop 1
 v_add_f32_dpp v7, v7, v7 row_ror:2 row_mask:0xf bank_mask:0xf
 s_nop 1
 v_add_f32_dpp v7, v7, v7 row_ror:1 row_mask:0xf bank_mask:0xf
 v_mov_b32 v8, v7
 s_nop 1
 v_permlane16_swap_b32 v7, v8
 v_add_f32 v7, v7, v8
 v_mul_f32 v7, s29, v7
 v_sub_f32 v40, v10, v7
 v_sub_f32 v41, v11, v7
 v_sub_f32 v42, v12, v7
 v_sub_f32 v43, v13, v7
 v_sub_f32 v44, v14, v7
 v_sub_f32 v45, v15, v7
 v_sub_f32 v46, v16, v7
 v_sub_f32 v47, v17, v7
 v_sub_f32 v48, v18, v7
 v_sub_f32 v49, v19, v7
 v_sub_f32 v50, v20, v7
 v_sub_f32 v51, v21, v7
 v_sub_f32 v52, v22, v7
 v_sub_f32 v53, v23, v7
 v_sub_f32 v54, v24, v7
 v_sub_f32 v55, v25, v7
 v_sub_f32 v56, v26, v7
 v_sub_f32 v57, v27, v7
 v_sub_f32 v58, v28, v7
 v_sub_f32 v59, v29, v7
 v_mul_f32 v7, v40, v40
 v_mul_f32 v8, v41, v41
 v_fmac_f32 v7, v42, v42
 v_fmac_f32 v8, v43, v43
 v_fmac_f32 v7, v44, v44
 v_fmac_f32 v8, v45, v45
 v_fmac_f32 v7, v46, v46
 v_fmac_f32 v8, v47, v47
 v_fmac_f32 v7, v48, v48
 v_fmac_f32 v8, v49, v49
 v_fmac_f32 v7, v50, v50
 v_fmac_f32 v8, v51, v51
 v_fmac_f32 v7, v52, v52
 v_fmac_f32 v8, v53, v53
 v_fmac_f32 v7, v54, v54
 v_fmac_f32 v8, v55, v55
 v_fmac_f32 v7, v56, v56
 v_fmac_f32 v8, v57, v57
 v_fmac_f32 v7, v58, v58
 v_fmac_f32 v8, v59, v59
 v_add_f32 v7, v7, v8
 s_nop 1
 v_add_f32_dpp v7, v7, v7 row_ror:8 row_mask:0xf bank_mask:0xf
 s_nop 1
 v_add_f32_dpp v7, v7, v7 row_ror:4 row_mask:0xf bank_mask:0xf
 s_nop 1
 v_add_f32_dpp v7, v7, v7 row_ror:2 row_mask:0xf bank_mask:0xf
 s_nop 1
 v_add_f32_dpp v7, v7, v7 row_ror:1 row_mask:0xf bank_mask:0xf
 v_mov_b32 v8, v7
 s_nop 1
 v_permlane16_swap_b32 v7, v8
 v_add_f32 v7, v7, v8
 v_mov_b32 v8, 0x3727c5ac
 v_fma_f32 v7, v7, s29, v8
 v_rsq_f32 v7, v7
 s_nop 0
 v_mul_f32 v40, v40, v7
 v_mul_f32 v41, v41, v7
 v_mul_f32 v42, v42, v7
 v_mul_f32 v43, v43, v7
 v_mul_f32 v44, v44, v7
 v_mul_f32 v45, v45, v7
 v_mul_f32 v46, v46, v7
 v_mul_f32 v47, v47, v7
 v_mul_f32 v48, v48, v7
 v_mul_f32 v49, v49, v7
 v_mul_f32 v50, v50, v7
 v_mul_f32 v51, v51, v7
 v_mul_f32 v52, v52, v7
 v_mul_f32 v53, v53, v7
 v_mul_f32 v54, v54, v7
 v_mul_f32 v55, v55, v7
 v_mul_f32 v56, v56, v7
 v_mul_f32 v57, v57, v7
 v_mul_f32 v58, v58, v7
 v_mul_f32 v59, v59, v7
 v_cvt_pk_bf16_f32 v30, v40, v41
 v_cvt_pk_bf16_f32 v31, v42, v43
 v_cvt_pk_bf16_f32 v32, v44, v45
 v_cvt_pk_bf16_f32 v33, v46, v47
 v_cvt_pk_bf16_f32 v34, v48, v49
 v_cvt_pk_bf16_f32 v35, v50, v51
 v_cvt_pk_bf16_f32 v36, v52, v53
 v_cvt_pk_bf16_f32 v37, v54, v55
 v_cvt_pk_bf16_f32 v38, v56, v57
 v_cvt_pk_bf16_f32 v39, v58, v59
 buffer_store_dwordx2 v[30:31], v3, s[4:7], s20 offen offset:0 sc1
 buffer_store_dwordx2 v[32:33], v3, s[4:7], s20 offen offset:256 sc1
 buffer_store_dwordx2 v[34:35], v3, s[4:7], s20 offen offset:512 sc1
 buffer_store_dwordx2 v[36:37], v3, s[4:7], s20 offen offset:768 sc1
 buffer_store_dwordx2 v[38:39], v3, s[4:7], s20 offen offset:1024 sc1
 s_waitcnt vmcnt(0)
 s_barrier
 s_cmp_eq_u32 s3, 0
 s_cbranch_scc0 Lbp_410
 s_mov_b64 exec, 1
 v_mov_b32 v5, s27
 buffer_store_dword v5, off, s[4:7], s30 sc1
 s_mov_b64 exec, -1
Lbp_410:
 s_mov_b32 s26, s27
 s_cmp_lt_u32 s26, 64
 s_cbranch_scc1 Lr_408
 s_endpgm
L_role_r2:
 s_sub_u32 s12, s12, 250
 s_cmp_eq_u32 s13, 1
 s_cbranch_scc1 Lverok_412
 s_mov_b32 s18, 0
Lver_411:
 s_add_u32 s18, s18, 1
 s_cmp_gt_u32 s18, 200000
 s_cbranch_scc1 L_fail
 v_and_b32 v254, 7, v0
 v_lshlrev_b32 v254, 2, v254
 buffer_load_dword v255, v254, s[8:11], 0 offen sc1
 s_waitcnt vmcnt(0)
 v_cmp_eq_u32 vcc, 32, v255
 s_nop 0
 s_cmp_eq_u64 vcc, -1
 s_cbranch_scc1 Lverok_412
 s_mov_b32 s17, 0
 v_readlane_b32 s14, v255, 0
 s_nop 0
 s_add_u32 s17, s17, s14
 v_readlane_b32 s14, v255, 1
 s_nop 0
 s_add_u32 s17, s17, s14
 v_readlane_b32 s14, v255, 2
 s_nop 0
 s_add_u32 s17, s17, s14
 v_readlane_b32 s14, v255, 3
 s_nop 0
 s_add_u32 s17, s17, s14
 v_readlane_b32 s14, v255, 4
 s_nop 0
 s_add_u32 s17, s17, s14
 v_readlane_b32 s14, v255, 5
 s_nop 0
 s_add_u32 s17, s17, s14
 v_readlane_b32 s14, v255, 6
 s_nop 0
 s_add_u32 s17, s17, s14
 v_readlane_b32 s14, v255, 7
 s_nop 0
 s_add_u32 s17, s17, s14
 s_cmp_eq_u32 s17, 256
 s_cbranch_scc1 L_fallback
 s_branch Lver_411
Lverok_412:
 v_and_b32 v1, 63, v0
 s_lshr_b32 s25, s12, 2
 s_and_b32 s28, s12, 3
 s_lshl_b32 s28, s28, 2
 s_add_u32 s28, s28, s3
 s_mov_b32 s29, 0x3acccccd
 s_lshl_b32 s19, s25, 6
 s_lshr_b32 s30, s28, 2
 s_add_u32 s30, s19, s30
 s_lshl_b32 s30, s30, 7
 s_add_u32 s30, s30, 237568
 s_lshl_b32 s19, s25, 7
 v_min_u32 v6, 4, v1
 v_add_u32 v6, s19, v6
 v_lshlrev_b32 v6, 7, v6
 v_add_u32 v6, 221184, v6
 s_mul_i32 s31, s25, 5242880
 s_add_u32 s31, s31, 192839680
 v_lshrrev_b32 v7, 5, v1
 s_lshl_b32 s19, s28, 1
 v_add_u32 v7, s19, v7
 v_and_b32 v8, 31, v1
 v_mul_u32_u24 v2, 2560, v7
 v_lshl_add_u32 v2, v8, 4, v2
 v_lshrrev_b32 v3, 1, v2
 v_lshrrev_b32 v4, 3, v8
 v_lshlrev_b32 v4, 1, v4
 v_lshrrev_b32 v5, 4, v7
 v_add_u32 v4, v4, v5
 v_lshlrev_b32 v4, 1, v4
 v_and_b32 v5, 1, v8
 v_add_u32 v4, v4, v5
 v_lshlrev_b32 v4, 4, v4
 v_and_b32 v5, 15, v7
 v_add_u32 v4, v4, v5
 v_lshlrev_b32 v4, 2, v4
 v_bfe_u32 v5, v8, 1, 2
 v_add_u32 v4, v4, v5
 v_lshlrev_b32 v4, 4, v4
 s_mov_b32 s26, 0
Lr_413:
 s_add_u32 s27, s26, 1
 s_mul_i32 s19, s26, 81920
 s_add_u32 s22, s19, s31
 s_mul_i32 s20, s26, 81920
 s_add_u32 s20, s20, 208568320
 s_mov_b32 s24, 0
Lrs_414:
 s_add_u32 s24, s24, 1
 s_cmp_gt_u32 s24, 200000
 s_cbranch_scc1 L_fail
 buffer_load_dword v5, v6, s[4:7], 0 offen sc1
 s_waitcnt vmcnt(0)
 v_cmp_le_u32 vcc, s27, v5
 s_nop 0
 s_cmp_eq_u64 vcc, -1
 s_cbranch_scc0 Lrs_414
 buffer_load_dwordx4 v[10:13], v2, s[4:7], s22 offen offset:0 sc1
 s_add_u32 s21, s20, 0
 buffer_load_dwordx4 v[40:43], v4, s[4:7], s21 offen sc1
 buffer_load_dwordx4 v[14:17], v2, s[4:7], s22 offen offset:512 sc1
 s_add_u32 s21, s20, 16384
 buffer_load_dwordx4 v[44:47], v4, s[4:7], s21 offen sc1
 buffer_load_dwordx4 v[18:21], v2, s[4:7], s22 offen offset:1024 sc1
 s_add_u32 s21, s20, 32768
 buffer_load_dwordx4 v[48:51], v4, s[4:7], s21 offen sc1
 buffer_load_dwordx4 v[22:25], v2, s[4:7], s22 offen offset:1536 sc1
 s_add_u32 s21, s20, 49152
 buffer_load_dwordx4 v[52:55], v4, s[4:7], s21 offen sc1
 buffer_load_dwordx4 v[26:29], v2, s[4:7], s22 offen offset:2048 sc1
 s_add_u32 s21, s20, 65536
 buffer_load_dwordx4 v[56:59], v4, s[4:7], s21 offen sc1
 s_waitcnt vmcnt(8)
 v_add_f32 v10, v10, v40
 v_add_f32 v11, v11, v41
 v_add_f32 v12, v12, v42
 v_add_f32 v13, v13, v43
 s_waitcnt vmcnt(6)
 v_add_f32 v14, v14, v44
 v_add_f32 v15, v15, v45
 v_add_f32 v16, v16, v46
 v_add_f32 v17, v17, v47
 s_waitcnt vmcnt(4)
 v_add_f32 v18, v18, v48
 v_add_f32 v19, v19, v49
 v_add_f32 v20, v20, v50
 v_add_f32 v21, v21, v51
 s_waitcnt vmcnt(2)
 v_add_f32 v22, v22, v52
 v_add_f32 v23, v23, v53
 v_add_f32 v24, v24, v54
 v_add_f32 v25, v25, v55
 s_waitcnt vmcnt(0)
 v_add_f32 v26, v26, v56
 v_add_f32 v27, v27, v57
 v_add_f32 v28, v28, v58
 v_add_f32 v29, v29, v59
 s_add_u32 s21, s19, 203325440
 s_lshr_b32 s20, s19, 1
 s_add_u32 s20, s20, 187596800
 buffer_store_dwordx4 v[10:13], v2, s[4:7], s21 offen offset:0 sc1
 buffer_store_dwordx4 v[14:17], v2, s[4:7], s21 offen offset:512 sc1
 buffer_store_dwordx4 v[18:21], v2, s[4:7], s21 offen offset:1024 sc1
 buffer_store_dwordx4 v[22:25], v2, s[4:7], s21 offen offset:1536 sc1
 buffer_store_dwordx4 v[26:29], v2, s[4:7], s21 offen offset:2048 sc1
 v_add_f32 v7, v10, v11
 v_add_f32 v8, v12, v13
 v_add_f32 v7, v7, v14
 v_add_f32 v8, v8, v15
 v_add_f32 v7, v7, v16
 v_add_f32 v8, v8, v17
 v_add_f32 v7, v7, v18
 v_add_f32 v8, v8, v19
 v_add_f32 v7, v7, v20
 v_add_f32 v8, v8, v21
 v_add_f32 v7, v7, v22
 v_add_f32 v8, v8, v23
 v_add_f32 v7, v7, v24
 v_add_f32 v8, v8, v25
 v_add_f32 v7, v7, v26
 v_add_f32 v8, v8, v27
 v_add_f32 v7, v7, v28
 v_add_f32 v8, v8, v29
 v_add_f32 v7, v7, v8
 s_nop 1
 v_add_f32_dpp v7, v7, v7 row_ror:8 row_mask:0xf bank_mask:0xf
 s_nop 1
 v_add_f32_dpp v7, v7, v7 row_ror:4 row_mask:0xf bank_mask:0xf
 s_nop 1
 v_add_f32_dpp v7, v7, v7 row_ror:2 row_mask:0xf bank_mask:0xf
 s_nop 1
 v_add_f32_dpp v7, v7, v7 row_ror:1 row_mask:0xf bank_mask:0xf
 v_mov_b32 v8, v7
 s_nop 1
 v_permlane16_swap_b32 v7, v8
 v_add_f32 v7, v7, v8
 v_mul_f32 v7, s29, v7
 v_sub_f32 v40, v10, v7
 v_sub_f32 v41, v11, v7
 v_sub_f32 v42, v12, v7
 v_sub_f32 v43, v13, v7
 v_sub_f32 v44, v14, v7
 v_sub_f32 v45, v15, v7
 v_sub_f32 v46, v16, v7
 v_sub_f32 v47, v17, v7
 v_sub_f32 v48, v18, v7
 v_sub_f32 v49, v19, v7
 v_sub_f32 v50, v20, v7
 v_sub_f32 v51, v21, v7
 v_sub_f32 v52, v22, v7
 v_sub_f32 v53, v23, v7
 v_sub_f32 v54, v24, v7
 v_sub_f32 v55, v25, v7
 v_sub_f32 v56, v26, v7
 v_sub_f32 v57, v27, v7
 v_sub_f32 v58, v28, v7
 v_sub_f32 v59, v29, v7
 v_mul_f32 v7, v40, v40
 v_mul_f32 v8, v41, v41
 v_fmac_f32 v7, v42, v42
 v_fmac_f32 v8, v43, v43
 v_fmac_f32 v7, v44, v44
 v_fmac_f32 v8, v45, v45
 v_fmac_f32 v7, v46, v46
 v_fmac_f32 v8, v47, v47
 v_fmac_f32 v7, v48, v48
 v_fmac_f32 v8, v49, v49
 v_fmac_f32 v7, v50, v50
 v_fmac_f32 v8, v51, v51
 v_fmac_f32 v7, v52, v52
 v_fmac_f32 v8, v53, v53
 v_fmac_f32 v7, v54, v54
 v_fmac_f32 v8, v55, v55
 v_fmac_f32 v7, v56, v56
 v_fmac_f32 v8, v57, v57
 v_fmac_f32 v7, v58, v58
 v_fmac_f32 v8, v59, v59
 v_add_f32 v7, v7, v8
 s_nop 1
 v_add_f32_dpp v7, v7, v7 row_ror:8 row_mask:0xf bank_mask:0xf
 s_nop 1
 v_add_f32_dpp v7, v7, v7 row_ror:4 row_mask:0xf bank_mask:0xf
 s_nop 1
 v_add_f32_dpp v7, v7, v7 row_ror:2 row_mask:0xf bank_mask:0xf
 s_nop 1
 v_add_f32_dpp v7, v7, v7 row_ror:1 row_mask:0xf bank_mask:0xf
 v_mov_b32 v8, v7
 s_nop 1
 v_permlane16_swap_b32 v7, v8
 v_add_f32 v7, v7, v8
 v_mov_b32 v8, 0x3727c5ac
 v_fma_f32 v7, v7, s29, v8
 v_rsq_f32 v7, v7
 s_nop 0
 v_mul_f32 v40, v40, v7
 v_mul_f32 v41, v41, v7
 v_mul_f32 v42, v42, v7
 v_mul_f32 v43, v43, v7
 v_mul_f32 v44, v44, v7
 v_mul_f32 v45, v45, v7
 v_mul_f32 v46, v46, v7
 v_mul_f32 v47, v47, v7
 v_mul_f32 v48, v48, v7
 v_mul_f32 v49, v49, v7
 v_mul_f32 v50, v50, v7
 v_mul_f32 v51, v51, v7
 v_mul_f32 v52, v52, v7
 v_mul_f32 v53, v53, v7
 v_mul_f32 v54, v54, v7
 v_mul_f32 v55, v55, v7
 v_mul_f32 v56, v56, v7
 v_mul_f32 v57, v57, v7
 v_mul_f32 v58, v58, v7
 v_mul_f32 v59, v59, v7
 v_cvt_pk_bf16_f32 v30, v40, v41
 v_cvt_pk_bf16_f32 v31, v42, v43
 v_cvt_pk_bf16_f32 v32, v44, v45
 v_cvt_pk_bf16_f32 v33, v46, v47
 v_cvt_pk_bf16_f32 v34, v48, v49
 v_cvt_pk_bf16_f32 v35, v50, v51
 v_cvt_pk_bf16_f32 v36, v52, v53
 v_cvt_pk_bf16_f32 v37, v54, v55
 v_cvt_pk_bf16_f32 v38, v56, v57
 v_cvt_pk_bf16_f32 v39, v58, v59
 buffer_store_dwordx2 v[30:31], v3, s[4:7], s20 offen offset:0 sc1
 buffer_store_dwordx2 v[32:33], v3, s[4:7], s20 offen offset:256 sc1
 buffer_store_dwordx2 v[34:35], v3, s[4:7], s20 offen offset:512 sc1
 buffer_store_dwordx2 v[36:37], v3, s[4:7], s20 offen offset:768 sc1
 buffer_store_dwordx2 v[38:39], v3, s[4:7], s20 offen offset:1024 sc1
 s_waitcnt vmcnt(0)
 s_barrier
 s_cmp_eq_u32 s3, 0
 s_cbranch_scc0 Lbp_415
 s_mov_b64 exec, 1
 v_mov_b32 v5, s27
 buffer_store_dword v5, off, s[4:7], s30 sc1
 s_mov_b64 exec, -1
Lbp_415:
 s_mov_b32 s26, s27
 s_cmp_lt_u32 s26, 64
 s_cbranch_scc1 Lr_413
 s_endpgm
.section .rodata,"a"
.p2align 6
.amdhsa_kernel pro_kernel
  .amdhsa_next_free_vgpr 64
  .amdhsa_next_free_sgpr 32
  .amdhsa_accum_offset 64
  .amdhsa_group_segment_fixed_size 0
  .amdhsa_kernarg_size 112
  .amdhsa_user_sgpr_count 2
  .amdhsa_user_sgpr_kernarg_segment_ptr 1
  .amdhsa_system_sgpr_workgroup_id_x 1
  .amdhsa_float_denorm_mode_32 3
.end_amdhsa_kernel
.p2align 6
.amdhsa_kernel main_kernel
  .amdhsa_next_free_vgpr 512
  .amdhsa_next_free_sgpr 102
  .amdhsa_accum_offset 256
  .amdhsa_group_segment_fixed_size 0
  .amdhsa_kernarg_size 112
  .amdhsa_user_sgpr_count 2
  .amdhsa_user_sgpr_kernarg_segment_ptr 1
  .amdhsa_system_sgpr_workgroup_id_x 1
  .amdhsa_float_denorm_mode_32 3
.end_amdhsa_kernel
```
